```python
import torch

def _softmax(x, axis=-1):
    return torch.softmax(x, dim=axis)
def _gelu(x):
    return torch.nn.functional.gelu(x, approximate="tanh")
def _silu(x):
    return torch.nn.functional.silu(x)
def _sigmoid(x):
    return torch.sigmoid(x)
def _layernorm(x, axis=-1, eps=1e-5):
    m = x.mean(dim=axis, keepdim=True)
    v = x.var(dim=axis, keepdim=True, unbiased=False)
    return (x - m) / torch.sqrt(v + eps)
def _scatter_add(tgt, idx, src, axis=0):
    return tgt.clone().index_add_(axis, idx, src)
def _segment_sum(src, seg, n):
    out = torch.zeros((n,) + src.shape[1:], dtype=src.dtype)
    return out.index_add_(0, seg, src)
def _pad(x, pw):
    flat = tuple(v for pair in reversed(pw) for v in pair)
    return torch.nn.functional.pad(x, flat)

kernel_name = 'gated_mix__compressed_kv_cla__moe_arch_mod__prompt'

def setup_inputs():

    _w = (lambda a: (lambda t: t.to(torch.bfloat16) if t.is_floating_point() else t)(torch.as_tensor(a)))
    def _A_setup():
        B, H, Sq, Sk, D, M = 1, 32, 2048, 2048, 128, 512
        Dc = 4 * D
        return {
            "x": _w((lambda *s: torch.randn(*s, dtype=torch.bfloat16) * 0.05)(B, Sq, M)),
            "c_kv": _w((lambda *s: torch.randn(*s, dtype=torch.bfloat16) * 0.8)(B, Sk, Dc)),
            "w_q": _w((lambda *s: torch.randn(*s, dtype=torch.bfloat16) * 6.4)(M, H, D) * (M ** -0.5)),
            "w_uk": _w((lambda *s: torch.randn(*s, dtype=torch.bfloat16) * 6.4)(Dc, H, D) * (Dc ** -0.5)),
            "w_uv": _w((lambda *s: torch.randn(*s, dtype=torch.bfloat16) * 0.8)(Dc, H, D) * (Dc ** -0.5)),
            "w_o": _w((lambda *s: torch.randn(*s, dtype=torch.bfloat16) * 0.8)(H, D, M) * ((H * D) ** -0.5)),
        }
    _A_in = _A_setup()

    def _B_setup():
        B, S, D, F, C = 1, 2048, 512, 1792, 1
        return {
            "x": _w((lambda *s: torch.randn(*s, dtype=torch.bfloat16) * 0.05)(B, S, D)),
            "w_r": _w((lambda *s: torch.randn(*s, dtype=torch.bfloat16) * 3.2)(D)),
            "w_gate": _w((lambda *s: torch.randn(*s, dtype=torch.bfloat16) * 0.4)(D, F)),
            "w_up": _w((lambda *s: torch.randn(*s, dtype=torch.bfloat16) * 0.4)(D, F)),
            "w_down": _w((lambda *s: torch.randn(*s, dtype=torch.bfloat16) * 0.4)(F, D)),
        }
    _B_in = _B_setup()

    return {
        "A_x": _A_in["x"],
        "A_c_kv": _A_in["c_kv"],
        "A_w_q": _A_in["w_q"],
        "A_w_uk": _A_in["w_uk"],
        "A_w_uv": _A_in["w_uv"],
        "A_w_o": _A_in["w_o"],
        "B_x": _B_in["x"],
        "B_w_r": _B_in["w_r"],
        "B_w_gate": _B_in["w_gate"],
        "B_w_up": _B_in["w_up"],
        "B_w_down": _B_in["w_down"],
        "gate_w": _w((lambda *s: torch.randn(*s, dtype=torch.bfloat16) * 0.05)(512) * 16.0),
    }

def reference(A_x, A_c_kv, A_w_q, A_w_uk, A_w_uv, A_w_o, B_x, B_w_r, B_w_gate, B_w_up, B_w_down, gate_w):
    def _A_ref(x, c_kv, w_q, w_uk, w_uv, w_o):
        B, Sq, M = x.shape[0], x.shape[1], x.shape[2]
        Sk = c_kv.shape[1]
        H, D = w_q.shape[1], w_q.shape[2]
        q = torch.einsum("bqm,mhd->bhqd", x, w_q)
        k = torch.einsum("bkc,chd->bhkd", c_kv, w_uk)
        v = torch.einsum("bkc,chd->bhkd", c_kv, w_uv)
        scores = torch.einsum("bhqd,bhkd->bhqk", q, k) * (D ** -0.5)
        off = Sk - Sq
        qi = torch.arange(Sq)[:, None]
        kj = torch.arange(Sk)[None, :]
        cmask = kj <= (qi + off)
        scores = torch.where(cmask[None, None], scores, -1e9)
        p = _softmax(scores, axis=-1)
        ctx = torch.einsum("bhqk,bhkd->bhqd", p, v)
        return torch.einsum("bhqd,hdm->bqm", ctx, w_o)

    def _B_ref(x, w_r, w_gate, w_up, w_down):
        B, S, D = x.shape
        C = 1
        r = x @ w_r
        idx = torch.argsort(-r, axis=-1)[:, :C]
        idx_e = (lambda x, n, axis: torch.repeat_interleave(x, n, dim=axis))(idx.reshape(B, C, 1), D, axis=2)
        x_sel = (lambda x, i, axis: torch.take_along_dim(x, i, dim=axis))(x, idx_e, axis=1)
        g = _silu(x_sel @ w_gate)
        u = x_sel @ w_up
        y = (g * u) @ w_down
        r_sel = _sigmoid((lambda x, i, axis: torch.take_along_dim(x, i, dim=axis))(r, idx, axis=1))
        y = y * r_sel.reshape(B, C, 1)
        b_off = (torch.arange(B) * S).reshape(B, 1)
        flat_idx = (idx + b_off).reshape(B * C)
        zero = (x * 0.0).reshape(B * S, D)
        upd = _scatter_add(zero, flat_idx, y.reshape(B * C, D), axis=0)
        return x + upd.reshape(B, S, D)

    x = A_x
    g = _sigmoid((x * gate_w).sum(-1, keepdims=True))
    a = _A_ref(x, A_c_kv, A_w_q, A_w_uk, A_w_uv, A_w_o)
    b = _B_ref(x, B_w_r, B_w_gate, B_w_up, B_w_down)
    return g * a + (1 - g) * b
```

```asm
; @launch grid=(256,1,1) block=(256,1,1) lds=163840
.amdgcn_target "amdgcn-amd-amdhsa--gfx950"
.text
.globl gated_mix__compressed_kv_cla__moe_arch_mod__prompt_kernel
.p2align 8
.type gated_mix__compressed_kv_cla__moe_arch_mod__prompt_kernel,@function
gated_mix__compressed_kv_cla__moe_arch_mod__prompt_kernel:

  s_cmp_lt_u32 s2, 256
  s_cbranch_scc1 F_go
  s_endpgm
  F_go:
  s_load_dwordx4 s[28:31], s[0:1], 0
  s_load_dwordx4 s[32:35], s[0:1], 16
  s_load_dwordx4 s[36:39], s[0:1], 32
  s_load_dwordx2 s[40:41], s[0:1], 56
  s_load_dwordx2 s[42:43], s[0:1], 88
  s_load_dwordx4 s[44:47], s[0:1], 104
  s_and_b32 s3, s2, 7
  s_lshl_b32 s3, s3, 2
  s_lshr_b32 s4, s2, 3
  s_and_b32 s4, s4, 3
  s_add_u32 s3, s3, s4
  s_lshr_b32 s4, s2, 5
  v_and_b32 v1, 63, v0
  v_lshrrev_b32 v56, 6, v0
  v_lshlrev_b32 v2, 4, v1
  v_readfirstlane_b32 s5, v56
  v_lshrrev_b32 v56, 3, v1
  v_lshlrev_b32 v56, 10, v56
  v_and_b32 v57, 7, v1
  v_lshrrev_b32 v58, 4, v1
  v_xor_b32 v57, v57, v58
  v_lshl_add_u32 v6, v57, 4, v56
  v_xor_b32 v60, 64, v6
  v_add_u32 v7, 7168, v60
  v_add_u32 v8, 14336, v6
  v_add_u32 v9, 21504, v60
  v_lshlrev_b32 v56, 13, v58
  v_and_b32 v57, 15, v1
  v_lshlrev_b32 v59, 2, v58
  v_xor_b32 v57, v57, v59
  v_lshl_add_u32 v10, v57, 4, v56
  v_add_u32 v11, 31744, v10
  v_add_u32 v12, 63488, v10
  v_add_u32 v13, 95232, v10
  v_lshrrev_b32 v56, 4, v1
  v_bfe_u32 v57, v1, 1, 3
  v_xor_b32 v57, v57, v56
  v_and_b32 v58, 1, v1
  v_lshl_add_u32 v57, v57, 1, v58
  v_lshlrev_b32 v57, 4, v57
  v_lshl_add_u32 v44, v56, 13, v57
  v_add_u32 v45, 31744, v44
  v_xor_b32 v58, 128, v44
  v_add_u32 v46, 63488, v58
  v_add_u32 v47, 95232, v58
  s_and_b32 s76, s5, 1
  s_lshr_b32 s77, s5, 1
  s_sub_u32 s48, 15, s4
  s_cmp_eq_u32 s76, 0
  s_cselect_b32 s48, s48, s4
  s_lshl_b32 s48, s48, 17
  s_lshl_b32 s49, s76, 14
  s_lshl_b32 s50, s3, 8
  s_lshl_b32 s51, s76, 14
  s_add_u32 s51, s51, 0x8000
  s_waitcnt lgkmcnt(0)
  s_mov_b32 s60, s30
  s_mov_b32 s61, s31
  s_mov_b32 s62, 0x200000
  s_mov_b32 s63, 0x20000
  s_mov_b32 s12, s28
  s_mov_b32 s13, s29
  s_mov_b32 s14, 0x200000
  s_mov_b32 s15, 0x20000
  s_cmp_eq_u32 s77, 0
  s_cbranch_scc0 F_V
  s_cmp_eq_u32 s76, 0
  s_cselect_b32 s64, s34, s36
  s_cselect_b32 s65, s35, s37
  s_mov_b32 s66, 0x400000
  s_mov_b32 s67, 0x20000
  s_add_u32 s56, s48, 0
  s_add_u32 m0, s49, 0
  s_nop 0
  buffer_load_dwordx4 v6, s[60:63], s56 offen offset:0 lds
  buffer_load_dwordx4 v7, s[60:63], s56 offen offset:1024 lds
  buffer_load_dwordx4 v8, s[60:63], s56 offen offset:2048 lds
  buffer_load_dwordx4 v9, s[60:63], s56 offen offset:3072 lds
  s_add_u32 s56, s48, 32768
  s_add_u32 m0, s49, 4096
  s_nop 0
  buffer_load_dwordx4 v6, s[60:63], s56 offen offset:0 lds
  buffer_load_dwordx4 v7, s[60:63], s56 offen offset:1024 lds
  buffer_load_dwordx4 v8, s[60:63], s56 offen offset:2048 lds
  buffer_load_dwordx4 v9, s[60:63], s56 offen offset:3072 lds
  s_add_u32 s56, s48, 65536
  s_add_u32 m0, s49, 8192
  s_nop 0
  buffer_load_dwordx4 v6, s[60:63], s56 offen offset:0 lds
  buffer_load_dwordx4 v7, s[60:63], s56 offen offset:1024 lds
  buffer_load_dwordx4 v8, s[60:63], s56 offen offset:2048 lds
  buffer_load_dwordx4 v9, s[60:63], s56 offen offset:3072 lds
  s_add_u32 s56, s48, 98304
  s_add_u32 m0, s49, 12288
  s_nop 0
  buffer_load_dwordx4 v6, s[60:63], s56 offen offset:0 lds
  buffer_load_dwordx4 v7, s[60:63], s56 offen offset:1024 lds
  buffer_load_dwordx4 v8, s[60:63], s56 offen offset:2048 lds
  buffer_load_dwordx4 v9, s[60:63], s56 offen offset:3072 lds
  s_add_u32 s56, s50, 0
  s_add_u32 m0, s51, 0
  s_nop 0
  buffer_load_dwordx4 v44, s[64:67], s56 offen offset:0 lds
  buffer_load_dwordx4 v45, s[64:67], s56 offen offset:1024 lds
  buffer_load_dwordx4 v46, s[64:67], s56 offen offset:2048 lds
  buffer_load_dwordx4 v47, s[64:67], s56 offen offset:3072 lds
  s_add_u32 s56, s50, 131072
  s_add_u32 m0, s51, 4096
  s_nop 0
  buffer_load_dwordx4 v44, s[64:67], s56 offen offset:0 lds
  buffer_load_dwordx4 v45, s[64:67], s56 offen offset:1024 lds
  buffer_load_dwordx4 v46, s[64:67], s56 offen offset:2048 lds
  buffer_load_dwordx4 v47, s[64:67], s56 offen offset:3072 lds
  s_add_u32 s56, s50, 262144
  s_add_u32 m0, s51, 8192
  s_nop 0
  buffer_load_dwordx4 v44, s[64:67], s56 offen offset:0 lds
  buffer_load_dwordx4 v45, s[64:67], s56 offen offset:1024 lds
  buffer_load_dwordx4 v46, s[64:67], s56 offen offset:2048 lds
  buffer_load_dwordx4 v47, s[64:67], s56 offen offset:3072 lds
  s_add_u32 s56, s50, 393216
  s_add_u32 m0, s51, 12288
  s_nop 0
  buffer_load_dwordx4 v44, s[64:67], s56 offen offset:0 lds
  buffer_load_dwordx4 v45, s[64:67], s56 offen offset:1024 lds
  buffer_load_dwordx4 v46, s[64:67], s56 offen offset:2048 lds
  buffer_load_dwordx4 v47, s[64:67], s56 offen offset:3072 lds
  s_mov_b32 s68, s32
  s_mov_b32 s69, s33
  s_mov_b32 s70, 0x400000
  s_mov_b32 s71, 0x20000
  s_lshl_b32 s56, s3, 20
  s_add_u32 s56, s56, 0x1000000
  s_add_u32 s8, s46, s56
  s_addc_u32 s9, s47, 0
  s_mov_b32 s10, 0x100000
  s_mov_b32 s11, 0x20000
  s_add_u32 s20, s46, 0x4400000
  s_addc_u32 s21, s47, 0
  s_mov_b32 s22, 0x100000
  s_mov_b32 s23, 0x20000
  s_mov_b32 s16, s44
  s_mov_b32 s17, s45
  s_mov_b32 s18, 0x100
  s_mov_b32 s19, 0x20000
  s_sub_u32 s52, 15, s4
  s_cmp_eq_u32 s76, 0
  s_cselect_b32 s52, s52, s4
  s_lshl_b32 s52, s52, 17
  s_lshl_b32 s53, s76, 14
  s_lshl_b32 s54, s76, 18
  s_lshl_b32 s56, s3, 8
  s_add_u32 s54, s54, s56
  s_lshl_b32 s55, s76, 13
  s_lshr_b32 s57, s52, 1
  v_add_u32 v14, s55, v2
  v_and_b32 v56, 31, v1
  v_lshlrev_b32 v56, 7, v56
  v_lshrrev_b32 v57, 5, v1
  v_bfe_u32 v58, v1, 1, 3
  v_xor_b32 v57, v57, v58
  v_lshl_add_u32 v3, v57, 4, v56
  s_lshl_b32 s56, s76, 14
  v_add_u32 v56, s56, v3
  v_and_b32 v56, 15, v1
  v_lshlrev_b32 v56, 7, v56
  v_lshrrev_b32 v57, 4, v1
  v_bfe_u32 v58, v1, 1, 3
  v_xor_b32 v57, v57, v58
  v_lshl_add_u32 v56, v57, 4, v56
  v_add_u32 v56, s56, v56
  v_mov_b32 v36, v56
  v_xor_b32 v37, 64, v56
  v_add_u32 v38, 0x10000, v36
  v_add_u32 v39, 0x10000, v37
  v_lshrrev_b32 v56, 5, v1
  v_lshlrev_b32 v56, 3, v56
  v_bfe_u32 v57, v1, 2, 2
  v_add_u32 v56, v56, v57
  v_lshlrev_b32 v56, 8, v56
  v_lshl_add_u32 v56, v57, 6, v56
  v_bfe_u32 v58, v1, 4, 1
  v_lshl_add_u32 v56, v58, 5, v56
  v_and_b32 v58, 3, v1
  v_lshl_add_u32 v4, v58, 3, v56
  v_add_u32 v56, 32768, v4
  v_lshrrev_b32 v56, 4, v1
  v_bfe_u32 v57, v1, 2, 2
  v_lshl_add_u32 v58, v56, 3, v57
  v_lshlrev_b32 v58, 8, v58
  v_and_b32 v56, 1, v56
  v_lshl_add_u32 v56, v56, 2, v57
  v_lshl_add_u32 v58, v56, 5, v58
  v_and_b32 v56, 3, v1
  v_lshl_add_u32 v58, v56, 3, v58
  v_add_u32 v58, 32768, v58
  v_xor_b32 v20, 0, v58
  v_add_u32 v28, 0x10000, v20
  v_xor_b32 v21, 32, v58
  v_add_u32 v29, 0x10000, v21
  v_xor_b32 v22, 64, v58
  v_add_u32 v30, 0x10000, v22
  v_xor_b32 v23, 96, v58
  v_add_u32 v31, 0x10000, v23
  v_xor_b32 v24, 128, v58
  v_add_u32 v32, 0x10000, v24
  v_xor_b32 v25, 160, v58
  v_add_u32 v33, 0x10000, v25
  v_xor_b32 v26, 192, v58
  v_add_u32 v34, 0x10000, v26
  v_xor_b32 v27, 224, v58
  v_add_u32 v35, 0x10000, v27
  v_mov_b32 v48, 0
  v_mov_b32 v49, 0
  v_mov_b32 v50, 0
  v_mov_b32 v51, 0
  s_nop 1
  v_mfma_f32_32x32x16_bf16 a[0:15], v[48:51], v[48:51], 0
  v_mfma_f32_32x32x16_bf16 a[16:31], v[48:51], v[48:51], 0
  v_mfma_f32_32x32x16_bf16 a[32:47], v[48:51], v[48:51], 0
  v_mfma_f32_32x32x16_bf16 a[48:63], v[48:51], v[48:51], 0
  v_mfma_f32_32x32x16_bf16 a[64:79], v[48:51], v[48:51], 0
  v_mfma_f32_32x32x16_bf16 a[80:95], v[48:51], v[48:51], 0
  v_mfma_f32_32x32x16_bf16 a[96:111], v[48:51], v[48:51], 0
  v_mfma_f32_32x32x16_bf16 a[112:127], v[48:51], v[48:51], 0
  v_mfma_f32_32x32x16_bf16 a[128:143], v[48:51], v[48:51], 0
  v_mfma_f32_32x32x16_bf16 a[144:159], v[48:51], v[48:51], 0
  v_mfma_f32_32x32x16_bf16 a[160:175], v[48:51], v[48:51], 0
  v_mfma_f32_32x32x16_bf16 a[176:191], v[48:51], v[48:51], 0
  v_mfma_f32_32x32x16_bf16 a[192:207], v[48:51], v[48:51], 0
  v_mfma_f32_32x32x16_bf16 a[208:223], v[48:51], v[48:51], 0
  v_mfma_f32_32x32x16_bf16 a[224:239], v[48:51], v[48:51], 0
  v_mfma_f32_32x32x16_bf16 a[240:255], v[48:51], v[48:51], 0
  s_waitcnt vmcnt(0)
  s_barrier
  ds_read_b128 v[64:67], v36 offset:0
  ds_read_b64_tr_b16 v[96:97], v20 offset:0
  ds_read_b64_tr_b16 v[98:99], v20 offset:1024
  ds_read_b128 v[68:71], v36 offset:2048
  ds_read_b64_tr_b16 v[100:101], v21 offset:0
  ds_read_b64_tr_b16 v[102:103], v21 offset:1024
  ds_read_b128 v[72:75], v36 offset:4096
  ds_read_b64_tr_b16 v[104:105], v22 offset:0
  ds_read_b64_tr_b16 v[106:107], v22 offset:1024
  ds_read_b128 v[76:79], v36 offset:6144
  ds_read_b64_tr_b16 v[108:109], v23 offset:0
  ds_read_b64_tr_b16 v[110:111], v23 offset:1024
  ds_read_b128 v[80:83], v36 offset:8192
  ds_read_b64_tr_b16 v[112:113], v24 offset:0
  ds_read_b64_tr_b16 v[114:115], v24 offset:1024
  ds_read_b128 v[84:87], v36 offset:10240
  ds_read_b64_tr_b16 v[116:117], v25 offset:0
  ds_read_b64_tr_b16 v[118:119], v25 offset:1024
  ds_read_b128 v[88:91], v36 offset:12288
  ds_read_b64_tr_b16 v[120:121], v26 offset:0
  ds_read_b64_tr_b16 v[122:123], v26 offset:1024
  ds_read_b128 v[92:95], v36 offset:14336
  ds_read_b64_tr_b16 v[124:125], v27 offset:0
  ds_read_b64_tr_b16 v[126:127], v27 offset:1024
  s_waitcnt lgkmcnt(0)
  v_mfma_f32_16x16x32_bf16 a[0:3], v[96:99], v[64:67], a[0:3]
  ds_read_b128 v[128:131], v37 offset:0
  v_mfma_f32_16x16x32_bf16 a[32:35], v[100:103], v[64:67], a[32:35]
  v_mfma_f32_16x16x32_bf16 a[64:67], v[104:107], v[64:67], a[64:67]
  ds_read_b64_tr_b16 v[160:161], v20 offset:8192
  v_mfma_f32_16x16x32_bf16 a[96:99], v[108:111], v[64:67], a[96:99]
  v_mfma_f32_16x16x32_bf16 a[128:131], v[112:115], v[64:67], a[128:131]
  ds_read_b64_tr_b16 v[162:163], v20 offset:9216
  v_mfma_f32_16x16x32_bf16 a[160:163], v[116:119], v[64:67], a[160:163]
  v_mfma_f32_16x16x32_bf16 a[192:195], v[120:123], v[64:67], a[192:195]
  ds_read_b128 v[132:135], v37 offset:2048
  v_mfma_f32_16x16x32_bf16 a[224:227], v[124:127], v[64:67], a[224:227]
  v_mfma_f32_16x16x32_bf16 a[4:7], v[96:99], v[68:71], a[4:7]
  ds_read_b64_tr_b16 v[164:165], v21 offset:8192
  v_mfma_f32_16x16x32_bf16 a[36:39], v[100:103], v[68:71], a[36:39]
  v_mfma_f32_16x16x32_bf16 a[68:71], v[104:107], v[68:71], a[68:71]
  ds_read_b64_tr_b16 v[166:167], v21 offset:9216
  v_mfma_f32_16x16x32_bf16 a[100:103], v[108:111], v[68:71], a[100:103]
  v_mfma_f32_16x16x32_bf16 a[132:135], v[112:115], v[68:71], a[132:135]
  ds_read_b128 v[136:139], v37 offset:4096
  v_mfma_f32_16x16x32_bf16 a[164:167], v[116:119], v[68:71], a[164:167]
  v_mfma_f32_16x16x32_bf16 a[196:199], v[120:123], v[68:71], a[196:199]
  ds_read_b64_tr_b16 v[168:169], v22 offset:8192
  v_mfma_f32_16x16x32_bf16 a[228:231], v[124:127], v[68:71], a[228:231]
  v_mfma_f32_16x16x32_bf16 a[8:11], v[96:99], v[72:75], a[8:11]
  ds_read_b64_tr_b16 v[170:171], v22 offset:9216
  v_mfma_f32_16x16x32_bf16 a[40:43], v[100:103], v[72:75], a[40:43]
  v_mfma_f32_16x16x32_bf16 a[72:75], v[104:107], v[72:75], a[72:75]
  ds_read_b128 v[140:143], v37 offset:6144
  v_mfma_f32_16x16x32_bf16 a[104:107], v[108:111], v[72:75], a[104:107]
  v_mfma_f32_16x16x32_bf16 a[136:139], v[112:115], v[72:75], a[136:139]
  ds_read_b64_tr_b16 v[172:173], v23 offset:8192
  v_mfma_f32_16x16x32_bf16 a[168:171], v[116:119], v[72:75], a[168:171]
  v_mfma_f32_16x16x32_bf16 a[200:203], v[120:123], v[72:75], a[200:203]
  ds_read_b64_tr_b16 v[174:175], v23 offset:9216
  v_mfma_f32_16x16x32_bf16 a[232:235], v[124:127], v[72:75], a[232:235]
  v_mfma_f32_16x16x32_bf16 a[12:15], v[96:99], v[76:79], a[12:15]
  ds_read_b128 v[144:147], v37 offset:8192
  v_mfma_f32_16x16x32_bf16 a[44:47], v[100:103], v[76:79], a[44:47]
  v_mfma_f32_16x16x32_bf16 a[76:79], v[104:107], v[76:79], a[76:79]
  ds_read_b64_tr_b16 v[176:177], v24 offset:8192
  v_mfma_f32_16x16x32_bf16 a[108:111], v[108:111], v[76:79], a[108:111]
  v_mfma_f32_16x16x32_bf16 a[140:143], v[112:115], v[76:79], a[140:143]
  ds_read_b64_tr_b16 v[178:179], v24 offset:9216
  v_mfma_f32_16x16x32_bf16 a[172:175], v[116:119], v[76:79], a[172:175]
  v_mfma_f32_16x16x32_bf16 a[204:207], v[120:123], v[76:79], a[204:207]
  ds_read_b128 v[148:151], v37 offset:10240
  v_mfma_f32_16x16x32_bf16 a[236:239], v[124:127], v[76:79], a[236:239]
  v_mfma_f32_16x16x32_bf16 a[16:19], v[96:99], v[80:83], a[16:19]
  ds_read_b64_tr_b16 v[180:181], v25 offset:8192
  v_mfma_f32_16x16x32_bf16 a[48:51], v[100:103], v[80:83], a[48:51]
  v_mfma_f32_16x16x32_bf16 a[80:83], v[104:107], v[80:83], a[80:83]
  ds_read_b64_tr_b16 v[182:183], v25 offset:9216
  v_mfma_f32_16x16x32_bf16 a[112:115], v[108:111], v[80:83], a[112:115]
  v_mfma_f32_16x16x32_bf16 a[144:147], v[112:115], v[80:83], a[144:147]
  ds_read_b128 v[152:155], v37 offset:12288
  v_mfma_f32_16x16x32_bf16 a[176:179], v[116:119], v[80:83], a[176:179]
  v_mfma_f32_16x16x32_bf16 a[208:211], v[120:123], v[80:83], a[208:211]
  ds_read_b64_tr_b16 v[184:185], v26 offset:8192
  v_mfma_f32_16x16x32_bf16 a[240:243], v[124:127], v[80:83], a[240:243]
  v_mfma_f32_16x16x32_bf16 a[20:23], v[96:99], v[84:87], a[20:23]
  ds_read_b64_tr_b16 v[186:187], v26 offset:9216
  v_mfma_f32_16x16x32_bf16 a[52:55], v[100:103], v[84:87], a[52:55]
  v_mfma_f32_16x16x32_bf16 a[84:87], v[104:107], v[84:87], a[84:87]
  ds_read_b128 v[156:159], v37 offset:14336
  v_mfma_f32_16x16x32_bf16 a[116:119], v[108:111], v[84:87], a[116:119]
  v_mfma_f32_16x16x32_bf16 a[148:151], v[112:115], v[84:87], a[148:151]
  ds_read_b64_tr_b16 v[188:189], v27 offset:8192
  v_mfma_f32_16x16x32_bf16 a[180:183], v[116:119], v[84:87], a[180:183]
  v_mfma_f32_16x16x32_bf16 a[212:215], v[120:123], v[84:87], a[212:215]
  ds_read_b64_tr_b16 v[190:191], v27 offset:9216
  v_mfma_f32_16x16x32_bf16 a[244:247], v[124:127], v[84:87], a[244:247]
  v_mfma_f32_16x16x32_bf16 a[24:27], v[96:99], v[88:91], a[24:27]
  v_mfma_f32_16x16x32_bf16 a[56:59], v[100:103], v[88:91], a[56:59]
  v_mfma_f32_16x16x32_bf16 a[88:91], v[104:107], v[88:91], a[88:91]
  v_mfma_f32_16x16x32_bf16 a[120:123], v[108:111], v[88:91], a[120:123]
  v_mfma_f32_16x16x32_bf16 a[152:155], v[112:115], v[88:91], a[152:155]
  v_mfma_f32_16x16x32_bf16 a[184:187], v[116:119], v[88:91], a[184:187]
  v_mfma_f32_16x16x32_bf16 a[216:219], v[120:123], v[88:91], a[216:219]
  v_mfma_f32_16x16x32_bf16 a[248:251], v[124:127], v[88:91], a[248:251]
  v_mfma_f32_16x16x32_bf16 a[28:31], v[96:99], v[92:95], a[28:31]
  v_mfma_f32_16x16x32_bf16 a[60:63], v[100:103], v[92:95], a[60:63]
  v_mfma_f32_16x16x32_bf16 a[92:95], v[104:107], v[92:95], a[92:95]
  v_mfma_f32_16x16x32_bf16 a[124:127], v[108:111], v[92:95], a[124:127]
  v_mfma_f32_16x16x32_bf16 a[156:159], v[112:115], v[92:95], a[156:159]
  v_mfma_f32_16x16x32_bf16 a[188:191], v[116:119], v[92:95], a[188:191]
  v_mfma_f32_16x16x32_bf16 a[220:223], v[120:123], v[92:95], a[220:223]
  v_mfma_f32_16x16x32_bf16 a[252:255], v[124:127], v[92:95], a[252:255]
  s_waitcnt lgkmcnt(0)
  s_barrier
  v_mfma_f32_16x16x32_bf16 a[0:3], v[160:163], v[128:131], a[0:3]
  ds_read_b128 v[64:67], v38 offset:0
  s_add_u32 s56, s48, 256
  s_add_u32 m0, s49, 0
  v_mfma_f32_16x16x32_bf16 a[32:35], v[164:167], v[128:131], a[32:35]
  buffer_load_dwordx4 v6, s[60:63], s56 offen offset:0 lds
  v_mfma_f32_16x16x32_bf16 a[64:67], v[168:171], v[128:131], a[64:67]
  ds_read_b64_tr_b16 v[96:97], v28 offset:0
  v_mfma_f32_16x16x32_bf16 a[96:99], v[172:175], v[128:131], a[96:99]
  v_mfma_f32_16x16x32_bf16 a[128:131], v[176:179], v[128:131], a[128:131]
  ds_read_b64_tr_b16 v[98:99], v28 offset:1024
  v_mfma_f32_16x16x32_bf16 a[160:163], v[180:183], v[128:131], a[160:163]
  v_mfma_f32_16x16x32_bf16 a[192:195], v[184:187], v[128:131], a[192:195]
  ds_read_b128 v[68:71], v38 offset:2048
  v_mfma_f32_16x16x32_bf16 a[224:227], v[188:191], v[128:131], a[224:227]
  buffer_load_dwordx4 v7, s[60:63], s56 offen offset:1024 lds
  v_mfma_f32_16x16x32_bf16 a[4:7], v[160:163], v[132:135], a[4:7]
  ds_read_b64_tr_b16 v[100:101], v29 offset:0
  v_mfma_f32_16x16x32_bf16 a[36:39], v[164:167], v[132:135], a[36:39]
  v_mfma_f32_16x16x32_bf16 a[68:71], v[168:171], v[132:135], a[68:71]
  ds_read_b64_tr_b16 v[102:103], v29 offset:1024
  v_mfma_f32_16x16x32_bf16 a[100:103], v[172:175], v[132:135], a[100:103]
  buffer_load_dwordx4 v8, s[60:63], s56 offen offset:2048 lds
  v_mfma_f32_16x16x32_bf16 a[132:135], v[176:179], v[132:135], a[132:135]
  ds_read_b128 v[72:75], v38 offset:4096
  v_mfma_f32_16x16x32_bf16 a[164:167], v[180:183], v[132:135], a[164:167]
  v_mfma_f32_16x16x32_bf16 a[196:199], v[184:187], v[132:135], a[196:199]
  ds_read_b64_tr_b16 v[104:105], v30 offset:0
  v_mfma_f32_16x16x32_bf16 a[228:231], v[188:191], v[132:135], a[228:231]
  v_mfma_f32_16x16x32_bf16 a[8:11], v[160:163], v[136:139], a[8:11]
  ds_read_b64_tr_b16 v[106:107], v30 offset:1024
  v_mfma_f32_16x16x32_bf16 a[40:43], v[164:167], v[136:139], a[40:43]
  buffer_load_dwordx4 v9, s[60:63], s56 offen offset:3072 lds
  v_mfma_f32_16x16x32_bf16 a[72:75], v[168:171], v[136:139], a[72:75]
  ds_read_b128 v[76:79], v38 offset:6144
  v_mfma_f32_16x16x32_bf16 a[104:107], v[172:175], v[136:139], a[104:107]
  v_mfma_f32_16x16x32_bf16 a[136:139], v[176:179], v[136:139], a[136:139]
  ds_read_b64_tr_b16 v[108:109], v31 offset:0
  v_mfma_f32_16x16x32_bf16 a[168:171], v[180:183], v[136:139], a[168:171]
  v_mfma_f32_16x16x32_bf16 a[200:203], v[184:187], v[136:139], a[200:203]
  ds_read_b64_tr_b16 v[110:111], v31 offset:1024
  s_add_u32 s56, s48, 33024
  s_add_u32 m0, s49, 4096
  v_mfma_f32_16x16x32_bf16 a[232:235], v[188:191], v[136:139], a[232:235]
  buffer_load_dwordx4 v6, s[60:63], s56 offen offset:0 lds
  v_mfma_f32_16x16x32_bf16 a[12:15], v[160:163], v[140:143], a[12:15]
  ds_read_b128 v[80:83], v38 offset:8192
  v_mfma_f32_16x16x32_bf16 a[44:47], v[164:167], v[140:143], a[44:47]
  v_mfma_f32_16x16x32_bf16 a[76:79], v[168:171], v[140:143], a[76:79]
  ds_read_b64_tr_b16 v[112:113], v32 offset:0
  v_mfma_f32_16x16x32_bf16 a[108:111], v[172:175], v[140:143], a[108:111]
  buffer_load_dwordx4 v7, s[60:63], s56 offen offset:1024 lds
  v_mfma_f32_16x16x32_bf16 a[140:143], v[176:179], v[140:143], a[140:143]
  ds_read_b64_tr_b16 v[114:115], v32 offset:1024
  v_mfma_f32_16x16x32_bf16 a[172:175], v[180:183], v[140:143], a[172:175]
  v_mfma_f32_16x16x32_bf16 a[204:207], v[184:187], v[140:143], a[204:207]
  ds_read_b128 v[84:87], v38 offset:10240
  v_mfma_f32_16x16x32_bf16 a[236:239], v[188:191], v[140:143], a[236:239]
  v_mfma_f32_16x16x32_bf16 a[16:19], v[160:163], v[144:147], a[16:19]
  ds_read_b64_tr_b16 v[116:117], v33 offset:0
  v_mfma_f32_16x16x32_bf16 a[48:51], v[164:167], v[144:147], a[48:51]
  buffer_load_dwordx4 v8, s[60:63], s56 offen offset:2048 lds
  v_mfma_f32_16x16x32_bf16 a[80:83], v[168:171], v[144:147], a[80:83]
  ds_read_b64_tr_b16 v[118:119], v33 offset:1024
  v_mfma_f32_16x16x32_bf16 a[112:115], v[172:175], v[144:147], a[112:115]
  v_mfma_f32_16x16x32_bf16 a[144:147], v[176:179], v[144:147], a[144:147]
  ds_read_b128 v[88:91], v38 offset:12288
  v_mfma_f32_16x16x32_bf16 a[176:179], v[180:183], v[144:147], a[176:179]
  v_mfma_f32_16x16x32_bf16 a[208:211], v[184:187], v[144:147], a[208:211]
  ds_read_b64_tr_b16 v[120:121], v34 offset:0
  v_mfma_f32_16x16x32_bf16 a[240:243], v[188:191], v[144:147], a[240:243]
  buffer_load_dwordx4 v9, s[60:63], s56 offen offset:3072 lds
  v_mfma_f32_16x16x32_bf16 a[20:23], v[160:163], v[148:151], a[20:23]
  ds_read_b64_tr_b16 v[122:123], v34 offset:1024
  v_mfma_f32_16x16x32_bf16 a[52:55], v[164:167], v[148:151], a[52:55]
  v_mfma_f32_16x16x32_bf16 a[84:87], v[168:171], v[148:151], a[84:87]
  ds_read_b128 v[92:95], v38 offset:14336
  v_mfma_f32_16x16x32_bf16 a[116:119], v[172:175], v[148:151], a[116:119]
  v_mfma_f32_16x16x32_bf16 a[148:151], v[176:179], v[148:151], a[148:151]
  ds_read_b64_tr_b16 v[124:125], v35 offset:0
  s_add_u32 s56, s48, 65792
  s_add_u32 m0, s49, 8192
  v_mfma_f32_16x16x32_bf16 a[180:183], v[180:183], v[148:151], a[180:183]
  buffer_load_dwordx4 v6, s[60:63], s56 offen offset:0 lds
  v_mfma_f32_16x16x32_bf16 a[212:215], v[184:187], v[148:151], a[212:215]
  ds_read_b64_tr_b16 v[126:127], v35 offset:1024
  v_mfma_f32_16x16x32_bf16 a[244:247], v[188:191], v[148:151], a[244:247]
  v_mfma_f32_16x16x32_bf16 a[24:27], v[160:163], v[152:155], a[24:27]
  v_mfma_f32_16x16x32_bf16 a[56:59], v[164:167], v[152:155], a[56:59]
  buffer_load_dwordx4 v7, s[60:63], s56 offen offset:1024 lds
  v_mfma_f32_16x16x32_bf16 a[88:91], v[168:171], v[152:155], a[88:91]
  v_mfma_f32_16x16x32_bf16 a[120:123], v[172:175], v[152:155], a[120:123]
  v_mfma_f32_16x16x32_bf16 a[152:155], v[176:179], v[152:155], a[152:155]
  v_mfma_f32_16x16x32_bf16 a[184:187], v[180:183], v[152:155], a[184:187]
  v_mfma_f32_16x16x32_bf16 a[216:219], v[184:187], v[152:155], a[216:219]
  buffer_load_dwordx4 v8, s[60:63], s56 offen offset:2048 lds
  v_mfma_f32_16x16x32_bf16 a[248:251], v[188:191], v[152:155], a[248:251]
  v_mfma_f32_16x16x32_bf16 a[28:31], v[160:163], v[156:159], a[28:31]
  v_mfma_f32_16x16x32_bf16 a[60:63], v[164:167], v[156:159], a[60:63]
  v_mfma_f32_16x16x32_bf16 a[92:95], v[168:171], v[156:159], a[92:95]
  v_mfma_f32_16x16x32_bf16 a[124:127], v[172:175], v[156:159], a[124:127]
  v_mfma_f32_16x16x32_bf16 a[156:159], v[176:179], v[156:159], a[156:159]
  buffer_load_dwordx4 v9, s[60:63], s56 offen offset:3072 lds
  v_mfma_f32_16x16x32_bf16 a[188:191], v[180:183], v[156:159], a[188:191]
  v_mfma_f32_16x16x32_bf16 a[220:223], v[184:187], v[156:159], a[220:223]
  v_mfma_f32_16x16x32_bf16 a[252:255], v[188:191], v[156:159], a[252:255]
  s_waitcnt lgkmcnt(0)
  v_mfma_f32_16x16x32_bf16 a[0:3], v[96:99], v[64:67], a[0:3]
  ds_read_b128 v[128:131], v39 offset:0
  s_add_u32 s56, s48, 98560
  s_add_u32 m0, s49, 12288
  v_mfma_f32_16x16x32_bf16 a[32:35], v[100:103], v[64:67], a[32:35]
  buffer_load_dwordx4 v6, s[60:63], s56 offen offset:0 lds
  v_mfma_f32_16x16x32_bf16 a[64:67], v[104:107], v[64:67], a[64:67]
  ds_read_b64_tr_b16 v[160:161], v28 offset:8192
  v_mfma_f32_16x16x32_bf16 a[96:99], v[108:111], v[64:67], a[96:99]
  v_mfma_f32_16x16x32_bf16 a[128:131], v[112:115], v[64:67], a[128:131]
  ds_read_b64_tr_b16 v[162:163], v28 offset:9216
  v_mfma_f32_16x16x32_bf16 a[160:163], v[116:119], v[64:67], a[160:163]
  v_mfma_f32_16x16x32_bf16 a[192:195], v[120:123], v[64:67], a[192:195]
  ds_read_b128 v[132:135], v39 offset:2048
  v_mfma_f32_16x16x32_bf16 a[224:227], v[124:127], v[64:67], a[224:227]
  buffer_load_dwordx4 v7, s[60:63], s56 offen offset:1024 lds
  v_mfma_f32_16x16x32_bf16 a[4:7], v[96:99], v[68:71], a[4:7]
  ds_read_b64_tr_b16 v[164:165], v29 offset:8192
  v_mfma_f32_16x16x32_bf16 a[36:39], v[100:103], v[68:71], a[36:39]
  v_mfma_f32_16x16x32_bf16 a[68:71], v[104:107], v[68:71], a[68:71]
  ds_read_b64_tr_b16 v[166:167], v29 offset:9216
  v_mfma_f32_16x16x32_bf16 a[100:103], v[108:111], v[68:71], a[100:103]
  v_mfma_f32_16x16x32_bf16 a[132:135], v[112:115], v[68:71], a[132:135]
  ds_read_b128 v[136:139], v39 offset:4096
  v_mfma_f32_16x16x32_bf16 a[164:167], v[116:119], v[68:71], a[164:167]
  buffer_load_dwordx4 v8, s[60:63], s56 offen offset:2048 lds
  v_mfma_f32_16x16x32_bf16 a[196:199], v[120:123], v[68:71], a[196:199]
  ds_read_b64_tr_b16 v[168:169], v30 offset:8192
  v_mfma_f32_16x16x32_bf16 a[228:231], v[124:127], v[68:71], a[228:231]
  v_mfma_f32_16x16x32_bf16 a[8:11], v[96:99], v[72:75], a[8:11]
  ds_read_b64_tr_b16 v[170:171], v30 offset:9216
  v_mfma_f32_16x16x32_bf16 a[40:43], v[100:103], v[72:75], a[40:43]
  buffer_load_dwordx4 v9, s[60:63], s56 offen offset:3072 lds
  v_mfma_f32_16x16x32_bf16 a[72:75], v[104:107], v[72:75], a[72:75]
  ds_read_b128 v[140:143], v39 offset:6144
  v_mfma_f32_16x16x32_bf16 a[104:107], v[108:111], v[72:75], a[104:107]
  v_mfma_f32_16x16x32_bf16 a[136:139], v[112:115], v[72:75], a[136:139]
  ds_read_b64_tr_b16 v[172:173], v31 offset:8192
  v_mfma_f32_16x16x32_bf16 a[168:171], v[116:119], v[72:75], a[168:171]
  v_mfma_f32_16x16x32_bf16 a[200:203], v[120:123], v[72:75], a[200:203]
  ds_read_b64_tr_b16 v[174:175], v31 offset:9216
  v_mfma_f32_16x16x32_bf16 a[232:235], v[124:127], v[72:75], a[232:235]
  v_mfma_f32_16x16x32_bf16 a[12:15], v[96:99], v[76:79], a[12:15]
  ds_read_b128 v[144:147], v39 offset:8192
  v_mfma_f32_16x16x32_bf16 a[44:47], v[100:103], v[76:79], a[44:47]
  v_mfma_f32_16x16x32_bf16 a[76:79], v[104:107], v[76:79], a[76:79]
  ds_read_b64_tr_b16 v[176:177], v32 offset:8192
  v_mfma_f32_16x16x32_bf16 a[108:111], v[108:111], v[76:79], a[108:111]
  v_mfma_f32_16x16x32_bf16 a[140:143], v[112:115], v[76:79], a[140:143]
  ds_read_b64_tr_b16 v[178:179], v32 offset:9216
  v_mfma_f32_16x16x32_bf16 a[172:175], v[116:119], v[76:79], a[172:175]
  v_mfma_f32_16x16x32_bf16 a[204:207], v[120:123], v[76:79], a[204:207]
  ds_read_b128 v[148:151], v39 offset:10240
  v_mfma_f32_16x16x32_bf16 a[236:239], v[124:127], v[76:79], a[236:239]
  v_mfma_f32_16x16x32_bf16 a[16:19], v[96:99], v[80:83], a[16:19]
  ds_read_b64_tr_b16 v[180:181], v33 offset:8192
  v_mfma_f32_16x16x32_bf16 a[48:51], v[100:103], v[80:83], a[48:51]
  v_mfma_f32_16x16x32_bf16 a[80:83], v[104:107], v[80:83], a[80:83]
  ds_read_b64_tr_b16 v[182:183], v33 offset:9216
  v_mfma_f32_16x16x32_bf16 a[112:115], v[108:111], v[80:83], a[112:115]
  v_mfma_f32_16x16x32_bf16 a[144:147], v[112:115], v[80:83], a[144:147]
  ds_read_b128 v[152:155], v39 offset:12288
  v_mfma_f32_16x16x32_bf16 a[176:179], v[116:119], v[80:83], a[176:179]
  v_mfma_f32_16x16x32_bf16 a[208:211], v[120:123], v[80:83], a[208:211]
  ds_read_b64_tr_b16 v[184:185], v34 offset:8192
  v_mfma_f32_16x16x32_bf16 a[240:243], v[124:127], v[80:83], a[240:243]
  v_mfma_f32_16x16x32_bf16 a[20:23], v[96:99], v[84:87], a[20:23]
  ds_read_b64_tr_b16 v[186:187], v34 offset:9216
  v_mfma_f32_16x16x32_bf16 a[52:55], v[100:103], v[84:87], a[52:55]
  v_mfma_f32_16x16x32_bf16 a[84:87], v[104:107], v[84:87], a[84:87]
  ds_read_b128 v[156:159], v39 offset:14336
  v_mfma_f32_16x16x32_bf16 a[116:119], v[108:111], v[84:87], a[116:119]
  v_mfma_f32_16x16x32_bf16 a[148:151], v[112:115], v[84:87], a[148:151]
  ds_read_b64_tr_b16 v[188:189], v35 offset:8192
  v_mfma_f32_16x16x32_bf16 a[180:183], v[116:119], v[84:87], a[180:183]
  v_mfma_f32_16x16x32_bf16 a[212:215], v[120:123], v[84:87], a[212:215]
  ds_read_b64_tr_b16 v[190:191], v35 offset:9216
  v_mfma_f32_16x16x32_bf16 a[244:247], v[124:127], v[84:87], a[244:247]
  v_mfma_f32_16x16x32_bf16 a[24:27], v[96:99], v[88:91], a[24:27]
  v_mfma_f32_16x16x32_bf16 a[56:59], v[100:103], v[88:91], a[56:59]
  v_mfma_f32_16x16x32_bf16 a[88:91], v[104:107], v[88:91], a[88:91]
  v_mfma_f32_16x16x32_bf16 a[120:123], v[108:111], v[88:91], a[120:123]
  v_mfma_f32_16x16x32_bf16 a[152:155], v[112:115], v[88:91], a[152:155]
  v_mfma_f32_16x16x32_bf16 a[184:187], v[116:119], v[88:91], a[184:187]
  v_mfma_f32_16x16x32_bf16 a[216:219], v[120:123], v[88:91], a[216:219]
  v_mfma_f32_16x16x32_bf16 a[248:251], v[124:127], v[88:91], a[248:251]
  v_mfma_f32_16x16x32_bf16 a[28:31], v[96:99], v[92:95], a[28:31]
  v_mfma_f32_16x16x32_bf16 a[60:63], v[100:103], v[92:95], a[60:63]
  v_mfma_f32_16x16x32_bf16 a[92:95], v[104:107], v[92:95], a[92:95]
  v_mfma_f32_16x16x32_bf16 a[124:127], v[108:111], v[92:95], a[124:127]
  v_mfma_f32_16x16x32_bf16 a[156:159], v[112:115], v[92:95], a[156:159]
  v_mfma_f32_16x16x32_bf16 a[188:191], v[116:119], v[92:95], a[188:191]
  v_mfma_f32_16x16x32_bf16 a[220:223], v[120:123], v[92:95], a[220:223]
  v_mfma_f32_16x16x32_bf16 a[252:255], v[124:127], v[92:95], a[252:255]
  s_waitcnt vmcnt(0) lgkmcnt(0)
  s_barrier
  v_mfma_f32_16x16x32_bf16 a[0:3], v[160:163], v[128:131], a[0:3]
  ds_read_b128 v[64:67], v36 offset:0
  s_add_u32 s56, s48, 384
  s_add_u32 m0, s49, 65536
  v_mfma_f32_16x16x32_bf16 a[32:35], v[164:167], v[128:131], a[32:35]
  buffer_load_dwordx4 v6, s[60:63], s56 offen offset:0 lds
  v_mfma_f32_16x16x32_bf16 a[64:67], v[168:171], v[128:131], a[64:67]
  ds_read_b64_tr_b16 v[96:97], v20 offset:0
  v_mfma_f32_16x16x32_bf16 a[96:99], v[172:175], v[128:131], a[96:99]
  v_mfma_f32_16x16x32_bf16 a[128:131], v[176:179], v[128:131], a[128:131]
  ds_read_b64_tr_b16 v[98:99], v20 offset:1024
  v_mfma_f32_16x16x32_bf16 a[160:163], v[180:183], v[128:131], a[160:163]
  v_mfma_f32_16x16x32_bf16 a[192:195], v[184:187], v[128:131], a[192:195]
  ds_read_b128 v[68:71], v36 offset:2048
  v_mfma_f32_16x16x32_bf16 a[224:227], v[188:191], v[128:131], a[224:227]
  buffer_load_dwordx4 v7, s[60:63], s56 offen offset:1024 lds
  v_mfma_f32_16x16x32_bf16 a[4:7], v[160:163], v[132:135], a[4:7]
  ds_read_b64_tr_b16 v[100:101], v21 offset:0
  v_mfma_f32_16x16x32_bf16 a[36:39], v[164:167], v[132:135], a[36:39]
  v_mfma_f32_16x16x32_bf16 a[68:71], v[168:171], v[132:135], a[68:71]
  ds_read_b64_tr_b16 v[102:103], v21 offset:1024
  v_mfma_f32_16x16x32_bf16 a[100:103], v[172:175], v[132:135], a[100:103]
  buffer_load_dwordx4 v8, s[60:63], s56 offen offset:2048 lds
  v_mfma_f32_16x16x32_bf16 a[132:135], v[176:179], v[132:135], a[132:135]
  ds_read_b128 v[72:75], v36 offset:4096
  v_mfma_f32_16x16x32_bf16 a[164:167], v[180:183], v[132:135], a[164:167]
  v_mfma_f32_16x16x32_bf16 a[196:199], v[184:187], v[132:135], a[196:199]
  ds_read_b64_tr_b16 v[104:105], v22 offset:0
  v_mfma_f32_16x16x32_bf16 a[228:231], v[188:191], v[132:135], a[228:231]
  v_mfma_f32_16x16x32_bf16 a[8:11], v[160:163], v[136:139], a[8:11]
  ds_read_b64_tr_b16 v[106:107], v22 offset:1024
  v_mfma_f32_16x16x32_bf16 a[40:43], v[164:167], v[136:139], a[40:43]
  buffer_load_dwordx4 v9, s[60:63], s56 offen offset:3072 lds
  v_mfma_f32_16x16x32_bf16 a[72:75], v[168:171], v[136:139], a[72:75]
  ds_read_b128 v[76:79], v36 offset:6144
  v_mfma_f32_16x16x32_bf16 a[104:107], v[172:175], v[136:139], a[104:107]
  v_mfma_f32_16x16x32_bf16 a[136:139], v[176:179], v[136:139], a[136:139]
  ds_read_b64_tr_b16 v[108:109], v23 offset:0
  v_mfma_f32_16x16x32_bf16 a[168:171], v[180:183], v[136:139], a[168:171]
  v_mfma_f32_16x16x32_bf16 a[200:203], v[184:187], v[136:139], a[200:203]
  ds_read_b64_tr_b16 v[110:111], v23 offset:1024
  s_add_u32 s56, s48, 33152
  s_add_u32 m0, s49, 69632
  v_mfma_f32_16x16x32_bf16 a[232:235], v[188:191], v[136:139], a[232:235]
  buffer_load_dwordx4 v6, s[60:63], s56 offen offset:0 lds
  v_mfma_f32_16x16x32_bf16 a[12:15], v[160:163], v[140:143], a[12:15]
  ds_read_b128 v[80:83], v36 offset:8192
  v_mfma_f32_16x16x32_bf16 a[44:47], v[164:167], v[140:143], a[44:47]
  v_mfma_f32_16x16x32_bf16 a[76:79], v[168:171], v[140:143], a[76:79]
  ds_read_b64_tr_b16 v[112:113], v24 offset:0
  v_mfma_f32_16x16x32_bf16 a[108:111], v[172:175], v[140:143], a[108:111]
  buffer_load_dwordx4 v7, s[60:63], s56 offen offset:1024 lds
  v_mfma_f32_16x16x32_bf16 a[140:143], v[176:179], v[140:143], a[140:143]
  ds_read_b64_tr_b16 v[114:115], v24 offset:1024
  v_mfma_f32_16x16x32_bf16 a[172:175], v[180:183], v[140:143], a[172:175]
  v_mfma_f32_16x16x32_bf16 a[204:207], v[184:187], v[140:143], a[204:207]
  ds_read_b128 v[84:87], v36 offset:10240
  v_mfma_f32_16x16x32_bf16 a[236:239], v[188:191], v[140:143], a[236:239]
  v_mfma_f32_16x16x32_bf16 a[16:19], v[160:163], v[144:147], a[16:19]
  ds_read_b64_tr_b16 v[116:117], v25 offset:0
  v_mfma_f32_16x16x32_bf16 a[48:51], v[164:167], v[144:147], a[48:51]
  buffer_load_dwordx4 v8, s[60:63], s56 offen offset:2048 lds
  v_mfma_f32_16x16x32_bf16 a[80:83], v[168:171], v[144:147], a[80:83]
  ds_read_b64_tr_b16 v[118:119], v25 offset:1024
  v_mfma_f32_16x16x32_bf16 a[112:115], v[172:175], v[144:147], a[112:115]
  v_mfma_f32_16x16x32_bf16 a[144:147], v[176:179], v[144:147], a[144:147]
  ds_read_b128 v[88:91], v36 offset:12288
  v_mfma_f32_16x16x32_bf16 a[176:179], v[180:183], v[144:147], a[176:179]
  v_mfma_f32_16x16x32_bf16 a[208:211], v[184:187], v[144:147], a[208:211]
  ds_read_b64_tr_b16 v[120:121], v26 offset:0
  v_mfma_f32_16x16x32_bf16 a[240:243], v[188:191], v[144:147], a[240:243]
  buffer_load_dwordx4 v9, s[60:63], s56 offen offset:3072 lds
  v_mfma_f32_16x16x32_bf16 a[20:23], v[160:163], v[148:151], a[20:23]
  ds_read_b64_tr_b16 v[122:123], v26 offset:1024
  v_mfma_f32_16x16x32_bf16 a[52:55], v[164:167], v[148:151], a[52:55]
  v_mfma_f32_16x16x32_bf16 a[84:87], v[168:171], v[148:151], a[84:87]
  ds_read_b128 v[92:95], v36 offset:14336
  v_mfma_f32_16x16x32_bf16 a[116:119], v[172:175], v[148:151], a[116:119]
  v_mfma_f32_16x16x32_bf16 a[148:151], v[176:179], v[148:151], a[148:151]
  ds_read_b64_tr_b16 v[124:125], v27 offset:0
  s_add_u32 s56, s48, 65920
  s_add_u32 m0, s49, 73728
  v_mfma_f32_16x16x32_bf16 a[180:183], v[180:183], v[148:151], a[180:183]
  buffer_load_dwordx4 v6, s[60:63], s56 offen offset:0 lds
  v_mfma_f32_16x16x32_bf16 a[212:215], v[184:187], v[148:151], a[212:215]
  ds_read_b64_tr_b16 v[126:127], v27 offset:1024
  v_mfma_f32_16x16x32_bf16 a[244:247], v[188:191], v[148:151], a[244:247]
  v_mfma_f32_16x16x32_bf16 a[24:27], v[160:163], v[152:155], a[24:27]
  v_mfma_f32_16x16x32_bf16 a[56:59], v[164:167], v[152:155], a[56:59]
  buffer_load_dwordx4 v7, s[60:63], s56 offen offset:1024 lds
  v_mfma_f32_16x16x32_bf16 a[88:91], v[168:171], v[152:155], a[88:91]
  v_mfma_f32_16x16x32_bf16 a[120:123], v[172:175], v[152:155], a[120:123]
  v_mfma_f32_16x16x32_bf16 a[152:155], v[176:179], v[152:155], a[152:155]
  v_mfma_f32_16x16x32_bf16 a[184:187], v[180:183], v[152:155], a[184:187]
  v_mfma_f32_16x16x32_bf16 a[216:219], v[184:187], v[152:155], a[216:219]
  buffer_load_dwordx4 v8, s[60:63], s56 offen offset:2048 lds
  v_mfma_f32_16x16x32_bf16 a[248:251], v[188:191], v[152:155], a[248:251]
  v_mfma_f32_16x16x32_bf16 a[28:31], v[160:163], v[156:159], a[28:31]
  v_mfma_f32_16x16x32_bf16 a[60:63], v[164:167], v[156:159], a[60:63]
  v_mfma_f32_16x16x32_bf16 a[92:95], v[168:171], v[156:159], a[92:95]
  v_mfma_f32_16x16x32_bf16 a[124:127], v[172:175], v[156:159], a[124:127]
  v_mfma_f32_16x16x32_bf16 a[156:159], v[176:179], v[156:159], a[156:159]
  buffer_load_dwordx4 v9, s[60:63], s56 offen offset:3072 lds
  v_mfma_f32_16x16x32_bf16 a[188:191], v[180:183], v[156:159], a[188:191]
  v_mfma_f32_16x16x32_bf16 a[220:223], v[184:187], v[156:159], a[220:223]
  v_mfma_f32_16x16x32_bf16 a[252:255], v[188:191], v[156:159], a[252:255]
  s_waitcnt lgkmcnt(0)
  v_mfma_f32_16x16x32_bf16 a[0:3], v[96:99], v[64:67], a[0:3]
  ds_read_b128 v[128:131], v37 offset:0
  s_add_u32 s56, s48, 98688
  s_add_u32 m0, s49, 77824
  v_mfma_f32_16x16x32_bf16 a[32:35], v[100:103], v[64:67], a[32:35]
  buffer_load_dwordx4 v6, s[60:63], s56 offen offset:0 lds
  v_mfma_f32_16x16x32_bf16 a[64:67], v[104:107], v[64:67], a[64:67]
  ds_read_b64_tr_b16 v[160:161], v20 offset:8192
  v_mfma_f32_16x16x32_bf16 a[96:99], v[108:111], v[64:67], a[96:99]
  v_mfma_f32_16x16x32_bf16 a[128:131], v[112:115], v[64:67], a[128:131]
  ds_read_b64_tr_b16 v[162:163], v20 offset:9216
  v_mfma_f32_16x16x32_bf16 a[160:163], v[116:119], v[64:67], a[160:163]
  v_mfma_f32_16x16x32_bf16 a[192:195], v[120:123], v[64:67], a[192:195]
  ds_read_b128 v[132:135], v37 offset:2048
  v_mfma_f32_16x16x32_bf16 a[224:227], v[124:127], v[64:67], a[224:227]
  buffer_load_dwordx4 v7, s[60:63], s56 offen offset:1024 lds
  v_mfma_f32_16x16x32_bf16 a[4:7], v[96:99], v[68:71], a[4:7]
  ds_read_b64_tr_b16 v[164:165], v21 offset:8192
  v_mfma_f32_16x16x32_bf16 a[36:39], v[100:103], v[68:71], a[36:39]
  v_mfma_f32_16x16x32_bf16 a[68:71], v[104:107], v[68:71], a[68:71]
  ds_read_b64_tr_b16 v[166:167], v21 offset:9216
  v_mfma_f32_16x16x32_bf16 a[100:103], v[108:111], v[68:71], a[100:103]
  v_mfma_f32_16x16x32_bf16 a[132:135], v[112:115], v[68:71], a[132:135]
  ds_read_b128 v[136:139], v37 offset:4096
  v_mfma_f32_16x16x32_bf16 a[164:167], v[116:119], v[68:71], a[164:167]
  buffer_load_dwordx4 v8, s[60:63], s56 offen offset:2048 lds
  v_mfma_f32_16x16x32_bf16 a[196:199], v[120:123], v[68:71], a[196:199]
  ds_read_b64_tr_b16 v[168:169], v22 offset:8192
  v_mfma_f32_16x16x32_bf16 a[228:231], v[124:127], v[68:71], a[228:231]
  v_mfma_f32_16x16x32_bf16 a[8:11], v[96:99], v[72:75], a[8:11]
  ds_read_b64_tr_b16 v[170:171], v22 offset:9216
  v_mfma_f32_16x16x32_bf16 a[40:43], v[100:103], v[72:75], a[40:43]
  buffer_load_dwordx4 v9, s[60:63], s56 offen offset:3072 lds
  v_mfma_f32_16x16x32_bf16 a[72:75], v[104:107], v[72:75], a[72:75]
  ds_read_b128 v[140:143], v37 offset:6144
  v_mfma_f32_16x16x32_bf16 a[104:107], v[108:111], v[72:75], a[104:107]
  v_mfma_f32_16x16x32_bf16 a[136:139], v[112:115], v[72:75], a[136:139]
  ds_read_b64_tr_b16 v[172:173], v23 offset:8192
  v_mfma_f32_16x16x32_bf16 a[168:171], v[116:119], v[72:75], a[168:171]
  v_mfma_f32_16x16x32_bf16 a[200:203], v[120:123], v[72:75], a[200:203]
  ds_read_b64_tr_b16 v[174:175], v23 offset:9216
  v_mfma_f32_16x16x32_bf16 a[232:235], v[124:127], v[72:75], a[232:235]
  v_mfma_f32_16x16x32_bf16 a[12:15], v[96:99], v[76:79], a[12:15]
  ds_read_b128 v[144:147], v37 offset:8192
  v_mfma_f32_16x16x32_bf16 a[44:47], v[100:103], v[76:79], a[44:47]
  v_mfma_f32_16x16x32_bf16 a[76:79], v[104:107], v[76:79], a[76:79]
  ds_read_b64_tr_b16 v[176:177], v24 offset:8192
  v_mfma_f32_16x16x32_bf16 a[108:111], v[108:111], v[76:79], a[108:111]
  v_mfma_f32_16x16x32_bf16 a[140:143], v[112:115], v[76:79], a[140:143]
  ds_read_b64_tr_b16 v[178:179], v24 offset:9216
  v_mfma_f32_16x16x32_bf16 a[172:175], v[116:119], v[76:79], a[172:175]
  v_mfma_f32_16x16x32_bf16 a[204:207], v[120:123], v[76:79], a[204:207]
  ds_read_b128 v[148:151], v37 offset:10240
  v_mfma_f32_16x16x32_bf16 a[236:239], v[124:127], v[76:79], a[236:239]
  v_mfma_f32_16x16x32_bf16 a[16:19], v[96:99], v[80:83], a[16:19]
  ds_read_b64_tr_b16 v[180:181], v25 offset:8192
  v_mfma_f32_16x16x32_bf16 a[48:51], v[100:103], v[80:83], a[48:51]
  v_mfma_f32_16x16x32_bf16 a[80:83], v[104:107], v[80:83], a[80:83]
  ds_read_b64_tr_b16 v[182:183], v25 offset:9216
  v_mfma_f32_16x16x32_bf16 a[112:115], v[108:111], v[80:83], a[112:115]
  v_mfma_f32_16x16x32_bf16 a[144:147], v[112:115], v[80:83], a[144:147]
  ds_read_b128 v[152:155], v37 offset:12288
  v_mfma_f32_16x16x32_bf16 a[176:179], v[116:119], v[80:83], a[176:179]
  v_mfma_f32_16x16x32_bf16 a[208:211], v[120:123], v[80:83], a[208:211]
  ds_read_b64_tr_b16 v[184:185], v26 offset:8192
  v_mfma_f32_16x16x32_bf16 a[240:243], v[124:127], v[80:83], a[240:243]
  v_mfma_f32_16x16x32_bf16 a[20:23], v[96:99], v[84:87], a[20:23]
  ds_read_b64_tr_b16 v[186:187], v26 offset:9216
  v_mfma_f32_16x16x32_bf16 a[52:55], v[100:103], v[84:87], a[52:55]
  v_mfma_f32_16x16x32_bf16 a[84:87], v[104:107], v[84:87], a[84:87]
  ds_read_b128 v[156:159], v37 offset:14336
  v_mfma_f32_16x16x32_bf16 a[116:119], v[108:111], v[84:87], a[116:119]
  v_mfma_f32_16x16x32_bf16 a[148:151], v[112:115], v[84:87], a[148:151]
  ds_read_b64_tr_b16 v[188:189], v27 offset:8192
  v_mfma_f32_16x16x32_bf16 a[180:183], v[116:119], v[84:87], a[180:183]
  v_mfma_f32_16x16x32_bf16 a[212:215], v[120:123], v[84:87], a[212:215]
  ds_read_b64_tr_b16 v[190:191], v27 offset:9216
  v_mfma_f32_16x16x32_bf16 a[244:247], v[124:127], v[84:87], a[244:247]
  v_mfma_f32_16x16x32_bf16 a[24:27], v[96:99], v[88:91], a[24:27]
  v_mfma_f32_16x16x32_bf16 a[56:59], v[100:103], v[88:91], a[56:59]
  v_mfma_f32_16x16x32_bf16 a[88:91], v[104:107], v[88:91], a[88:91]
  v_mfma_f32_16x16x32_bf16 a[120:123], v[108:111], v[88:91], a[120:123]
  v_mfma_f32_16x16x32_bf16 a[152:155], v[112:115], v[88:91], a[152:155]
  v_mfma_f32_16x16x32_bf16 a[184:187], v[116:119], v[88:91], a[184:187]
  v_mfma_f32_16x16x32_bf16 a[216:219], v[120:123], v[88:91], a[216:219]
  v_mfma_f32_16x16x32_bf16 a[248:251], v[124:127], v[88:91], a[248:251]
  v_mfma_f32_16x16x32_bf16 a[28:31], v[96:99], v[92:95], a[28:31]
  v_mfma_f32_16x16x32_bf16 a[60:63], v[100:103], v[92:95], a[60:63]
  v_mfma_f32_16x16x32_bf16 a[92:95], v[104:107], v[92:95], a[92:95]
  v_mfma_f32_16x16x32_bf16 a[124:127], v[108:111], v[92:95], a[124:127]
  v_mfma_f32_16x16x32_bf16 a[156:159], v[112:115], v[92:95], a[156:159]
  v_mfma_f32_16x16x32_bf16 a[188:191], v[116:119], v[92:95], a[188:191]
  v_mfma_f32_16x16x32_bf16 a[220:223], v[120:123], v[92:95], a[220:223]
  v_mfma_f32_16x16x32_bf16 a[252:255], v[124:127], v[92:95], a[252:255]
  s_waitcnt vmcnt(0) lgkmcnt(0)
  s_barrier
  v_mfma_f32_16x16x32_bf16 a[0:3], v[160:163], v[128:131], a[0:3]
  ds_read_b128 v[64:67], v38 offset:0
  s_add_u32 s56, s48, 512
  s_add_u32 m0, s49, 0
  v_mfma_f32_16x16x32_bf16 a[32:35], v[164:167], v[128:131], a[32:35]
  buffer_load_dwordx4 v6, s[60:63], s56 offen offset:0 lds
  v_mfma_f32_16x16x32_bf16 a[64:67], v[168:171], v[128:131], a[64:67]
  ds_read_b64_tr_b16 v[96:97], v28 offset:0
  v_mfma_f32_16x16x32_bf16 a[96:99], v[172:175], v[128:131], a[96:99]
  v_mfma_f32_16x16x32_bf16 a[128:131], v[176:179], v[128:131], a[128:131]
  ds_read_b64_tr_b16 v[98:99], v28 offset:1024
  v_mfma_f32_16x16x32_bf16 a[160:163], v[180:183], v[128:131], a[160:163]
  v_mfma_f32_16x16x32_bf16 a[192:195], v[184:187], v[128:131], a[192:195]
  ds_read_b128 v[68:71], v38 offset:2048
  v_mfma_f32_16x16x32_bf16 a[224:227], v[188:191], v[128:131], a[224:227]
  buffer_load_dwordx4 v7, s[60:63], s56 offen offset:1024 lds
  v_mfma_f32_16x16x32_bf16 a[4:7], v[160:163], v[132:135], a[4:7]
  ds_read_b64_tr_b16 v[100:101], v29 offset:0
  v_mfma_f32_16x16x32_bf16 a[36:39], v[164:167], v[132:135], a[36:39]
  v_mfma_f32_16x16x32_bf16 a[68:71], v[168:171], v[132:135], a[68:71]
  ds_read_b64_tr_b16 v[102:103], v29 offset:1024
  v_mfma_f32_16x16x32_bf16 a[100:103], v[172:175], v[132:135], a[100:103]
  buffer_load_dwordx4 v8, s[60:63], s56 offen offset:2048 lds
  v_mfma_f32_16x16x32_bf16 a[132:135], v[176:179], v[132:135], a[132:135]
  ds_read_b128 v[72:75], v38 offset:4096
  v_mfma_f32_16x16x32_bf16 a[164:167], v[180:183], v[132:135], a[164:167]
  v_mfma_f32_16x16x32_bf16 a[196:199], v[184:187], v[132:135], a[196:199]
  ds_read_b64_tr_b16 v[104:105], v30 offset:0
  v_mfma_f32_16x16x32_bf16 a[228:231], v[188:191], v[132:135], a[228:231]
  v_mfma_f32_16x16x32_bf16 a[8:11], v[160:163], v[136:139], a[8:11]
  ds_read_b64_tr_b16 v[106:107], v30 offset:1024
  v_mfma_f32_16x16x32_bf16 a[40:43], v[164:167], v[136:139], a[40:43]
  buffer_load_dwordx4 v9, s[60:63], s56 offen offset:3072 lds
  v_mfma_f32_16x16x32_bf16 a[72:75], v[168:171], v[136:139], a[72:75]
  ds_read_b128 v[76:79], v38 offset:6144
  v_mfma_f32_16x16x32_bf16 a[104:107], v[172:175], v[136:139], a[104:107]
  v_mfma_f32_16x16x32_bf16 a[136:139], v[176:179], v[136:139], a[136:139]
  ds_read_b64_tr_b16 v[108:109], v31 offset:0
  v_mfma_f32_16x16x32_bf16 a[168:171], v[180:183], v[136:139], a[168:171]
  v_mfma_f32_16x16x32_bf16 a[200:203], v[184:187], v[136:139], a[200:203]
  ds_read_b64_tr_b16 v[110:111], v31 offset:1024
  s_add_u32 s56, s48, 33280
  s_add_u32 m0, s49, 4096
  v_mfma_f32_16x16x32_bf16 a[232:235], v[188:191], v[136:139], a[232:235]
  buffer_load_dwordx4 v6, s[60:63], s56 offen offset:0 lds
  v_mfma_f32_16x16x32_bf16 a[12:15], v[160:163], v[140:143], a[12:15]
  ds_read_b128 v[80:83], v38 offset:8192
  v_mfma_f32_16x16x32_bf16 a[44:47], v[164:167], v[140:143], a[44:47]
  v_mfma_f32_16x16x32_bf16 a[76:79], v[168:171], v[140:143], a[76:79]
  ds_read_b64_tr_b16 v[112:113], v32 offset:0
  v_mfma_f32_16x16x32_bf16 a[108:111], v[172:175], v[140:143], a[108:111]
  buffer_load_dwordx4 v7, s[60:63], s56 offen offset:1024 lds
  v_mfma_f32_16x16x32_bf16 a[140:143], v[176:179], v[140:143], a[140:143]
  ds_read_b64_tr_b16 v[114:115], v32 offset:1024
  v_mfma_f32_16x16x32_bf16 a[172:175], v[180:183], v[140:143], a[172:175]
  v_mfma_f32_16x16x32_bf16 a[204:207], v[184:187], v[140:143], a[204:207]
  ds_read_b128 v[84:87], v38 offset:10240
  v_mfma_f32_16x16x32_bf16 a[236:239], v[188:191], v[140:143], a[236:239]
  v_mfma_f32_16x16x32_bf16 a[16:19], v[160:163], v[144:147], a[16:19]
  ds_read_b64_tr_b16 v[116:117], v33 offset:0
  v_mfma_f32_16x16x32_bf16 a[48:51], v[164:167], v[144:147], a[48:51]
  buffer_load_dwordx4 v8, s[60:63], s56 offen offset:2048 lds
  v_mfma_f32_16x16x32_bf16 a[80:83], v[168:171], v[144:147], a[80:83]
  ds_read_b64_tr_b16 v[118:119], v33 offset:1024
  v_mfma_f32_16x16x32_bf16 a[112:115], v[172:175], v[144:147], a[112:115]
  v_mfma_f32_16x16x32_bf16 a[144:147], v[176:179], v[144:147], a[144:147]
  ds_read_b128 v[88:91], v38 offset:12288
  v_mfma_f32_16x16x32_bf16 a[176:179], v[180:183], v[144:147], a[176:179]
  v_mfma_f32_16x16x32_bf16 a[208:211], v[184:187], v[144:147], a[208:211]
  ds_read_b64_tr_b16 v[120:121], v34 offset:0
  v_mfma_f32_16x16x32_bf16 a[240:243], v[188:191], v[144:147], a[240:243]
  buffer_load_dwordx4 v9, s[60:63], s56 offen offset:3072 lds
  v_mfma_f32_16x16x32_bf16 a[20:23], v[160:163], v[148:151], a[20:23]
  ds_read_b64_tr_b16 v[122:123], v34 offset:1024
  v_mfma_f32_16x16x32_bf16 a[52:55], v[164:167], v[148:151], a[52:55]
  v_mfma_f32_16x16x32_bf16 a[84:87], v[168:171], v[148:151], a[84:87]
  ds_read_b128 v[92:95], v38 offset:14336
  v_mfma_f32_16x16x32_bf16 a[116:119], v[172:175], v[148:151], a[116:119]
  v_mfma_f32_16x16x32_bf16 a[148:151], v[176:179], v[148:151], a[148:151]
  ds_read_b64_tr_b16 v[124:125], v35 offset:0
  s_add_u32 s56, s48, 66048
  s_add_u32 m0, s49, 8192
  v_mfma_f32_16x16x32_bf16 a[180:183], v[180:183], v[148:151], a[180:183]
  buffer_load_dwordx4 v6, s[60:63], s56 offen offset:0 lds
  v_mfma_f32_16x16x32_bf16 a[212:215], v[184:187], v[148:151], a[212:215]
  ds_read_b64_tr_b16 v[126:127], v35 offset:1024
  v_mfma_f32_16x16x32_bf16 a[244:247], v[188:191], v[148:151], a[244:247]
  v_mfma_f32_16x16x32_bf16 a[24:27], v[160:163], v[152:155], a[24:27]
  v_mfma_f32_16x16x32_bf16 a[56:59], v[164:167], v[152:155], a[56:59]
  buffer_load_dwordx4 v7, s[60:63], s56 offen offset:1024 lds
  v_mfma_f32_16x16x32_bf16 a[88:91], v[168:171], v[152:155], a[88:91]
  v_mfma_f32_16x16x32_bf16 a[120:123], v[172:175], v[152:155], a[120:123]
  v_mfma_f32_16x16x32_bf16 a[152:155], v[176:179], v[152:155], a[152:155]
  v_mfma_f32_16x16x32_bf16 a[184:187], v[180:183], v[152:155], a[184:187]
  v_mfma_f32_16x16x32_bf16 a[216:219], v[184:187], v[152:155], a[216:219]
  buffer_load_dwordx4 v8, s[60:63], s56 offen offset:2048 lds
  v_mfma_f32_16x16x32_bf16 a[248:251], v[188:191], v[152:155], a[248:251]
  v_mfma_f32_16x16x32_bf16 a[28:31], v[160:163], v[156:159], a[28:31]
  v_mfma_f32_16x16x32_bf16 a[60:63], v[164:167], v[156:159], a[60:63]
  v_mfma_f32_16x16x32_bf16 a[92:95], v[168:171], v[156:159], a[92:95]
  v_mfma_f32_16x16x32_bf16 a[124:127], v[172:175], v[156:159], a[124:127]
  v_mfma_f32_16x16x32_bf16 a[156:159], v[176:179], v[156:159], a[156:159]
  buffer_load_dwordx4 v9, s[60:63], s56 offen offset:3072 lds
  v_mfma_f32_16x16x32_bf16 a[188:191], v[180:183], v[156:159], a[188:191]
  v_mfma_f32_16x16x32_bf16 a[220:223], v[184:187], v[156:159], a[220:223]
  v_mfma_f32_16x16x32_bf16 a[252:255], v[188:191], v[156:159], a[252:255]
  s_waitcnt lgkmcnt(0)
  v_mfma_f32_16x16x32_bf16 a[0:3], v[96:99], v[64:67], a[0:3]
  ds_read_b128 v[128:131], v39 offset:0
  s_add_u32 s56, s48, 98816
  s_add_u32 m0, s49, 12288
  v_mfma_f32_16x16x32_bf16 a[32:35], v[100:103], v[64:67], a[32:35]
  buffer_load_dwordx4 v6, s[60:63], s56 offen offset:0 lds
  v_mfma_f32_16x16x32_bf16 a[64:67], v[104:107], v[64:67], a[64:67]
  ds_read_b64_tr_b16 v[160:161], v28 offset:8192
  v_mfma_f32_16x16x32_bf16 a[96:99], v[108:111], v[64:67], a[96:99]
  v_mfma_f32_16x16x32_bf16 a[128:131], v[112:115], v[64:67], a[128:131]
  ds_read_b64_tr_b16 v[162:163], v28 offset:9216
  v_mfma_f32_16x16x32_bf16 a[160:163], v[116:119], v[64:67], a[160:163]
  v_mfma_f32_16x16x32_bf16 a[192:195], v[120:123], v[64:67], a[192:195]
  ds_read_b128 v[132:135], v39 offset:2048
  v_mfma_f32_16x16x32_bf16 a[224:227], v[124:127], v[64:67], a[224:227]
  buffer_load_dwordx4 v7, s[60:63], s56 offen offset:1024 lds
  v_mfma_f32_16x16x32_bf16 a[4:7], v[96:99], v[68:71], a[4:7]
  ds_read_b64_tr_b16 v[164:165], v29 offset:8192
  v_mfma_f32_16x16x32_bf16 a[36:39], v[100:103], v[68:71], a[36:39]
  v_mfma_f32_16x16x32_bf16 a[68:71], v[104:107], v[68:71], a[68:71]
  ds_read_b64_tr_b16 v[166:167], v29 offset:9216
  v_mfma_f32_16x16x32_bf16 a[100:103], v[108:111], v[68:71], a[100:103]
  v_mfma_f32_16x16x32_bf16 a[132:135], v[112:115], v[68:71], a[132:135]
  ds_read_b128 v[136:139], v39 offset:4096
  v_mfma_f32_16x16x32_bf16 a[164:167], v[116:119], v[68:71], a[164:167]
  buffer_load_dwordx4 v8, s[60:63], s56 offen offset:2048 lds
  v_mfma_f32_16x16x32_bf16 a[196:199], v[120:123], v[68:71], a[196:199]
  ds_read_b64_tr_b16 v[168:169], v30 offset:8192
  v_mfma_f32_16x16x32_bf16 a[228:231], v[124:127], v[68:71], a[228:231]
  v_mfma_f32_16x16x32_bf16 a[8:11], v[96:99], v[72:75], a[8:11]
  ds_read_b64_tr_b16 v[170:171], v30 offset:9216
  v_mfma_f32_16x16x32_bf16 a[40:43], v[100:103], v[72:75], a[40:43]
  buffer_load_dwordx4 v9, s[60:63], s56 offen offset:3072 lds
  v_mfma_f32_16x16x32_bf16 a[72:75], v[104:107], v[72:75], a[72:75]
  ds_read_b128 v[140:143], v39 offset:6144
  v_mfma_f32_16x16x32_bf16 a[104:107], v[108:111], v[72:75], a[104:107]
  v_mfma_f32_16x16x32_bf16 a[136:139], v[112:115], v[72:75], a[136:139]
  ds_read_b64_tr_b16 v[172:173], v31 offset:8192
  v_mfma_f32_16x16x32_bf16 a[168:171], v[116:119], v[72:75], a[168:171]
  v_mfma_f32_16x16x32_bf16 a[200:203], v[120:123], v[72:75], a[200:203]
  ds_read_b64_tr_b16 v[174:175], v31 offset:9216
  v_mfma_f32_16x16x32_bf16 a[232:235], v[124:127], v[72:75], a[232:235]
  v_mfma_f32_16x16x32_bf16 a[12:15], v[96:99], v[76:79], a[12:15]
  ds_read_b128 v[144:147], v39 offset:8192
  v_mfma_f32_16x16x32_bf16 a[44:47], v[100:103], v[76:79], a[44:47]
  v_mfma_f32_16x16x32_bf16 a[76:79], v[104:107], v[76:79], a[76:79]
  ds_read_b64_tr_b16 v[176:177], v32 offset:8192
  v_mfma_f32_16x16x32_bf16 a[108:111], v[108:111], v[76:79], a[108:111]
  v_mfma_f32_16x16x32_bf16 a[140:143], v[112:115], v[76:79], a[140:143]
  ds_read_b64_tr_b16 v[178:179], v32 offset:9216
  v_mfma_f32_16x16x32_bf16 a[172:175], v[116:119], v[76:79], a[172:175]
  v_mfma_f32_16x16x32_bf16 a[204:207], v[120:123], v[76:79], a[204:207]
  ds_read_b128 v[148:151], v39 offset:10240
  v_mfma_f32_16x16x32_bf16 a[236:239], v[124:127], v[76:79], a[236:239]
  v_mfma_f32_16x16x32_bf16 a[16:19], v[96:99], v[80:83], a[16:19]
  ds_read_b64_tr_b16 v[180:181], v33 offset:8192
  v_mfma_f32_16x16x32_bf16 a[48:51], v[100:103], v[80:83], a[48:51]
  v_mfma_f32_16x16x32_bf16 a[80:83], v[104:107], v[80:83], a[80:83]
  ds_read_b64_tr_b16 v[182:183], v33 offset:9216
  v_mfma_f32_16x16x32_bf16 a[112:115], v[108:111], v[80:83], a[112:115]
  v_mfma_f32_16x16x32_bf16 a[144:147], v[112:115], v[80:83], a[144:147]
  ds_read_b128 v[152:155], v39 offset:12288
  v_mfma_f32_16x16x32_bf16 a[176:179], v[116:119], v[80:83], a[176:179]
  v_mfma_f32_16x16x32_bf16 a[208:211], v[120:123], v[80:83], a[208:211]
  ds_read_b64_tr_b16 v[184:185], v34 offset:8192
  v_mfma_f32_16x16x32_bf16 a[240:243], v[124:127], v[80:83], a[240:243]
  v_mfma_f32_16x16x32_bf16 a[20:23], v[96:99], v[84:87], a[20:23]
  ds_read_b64_tr_b16 v[186:187], v34 offset:9216
  v_mfma_f32_16x16x32_bf16 a[52:55], v[100:103], v[84:87], a[52:55]
  v_mfma_f32_16x16x32_bf16 a[84:87], v[104:107], v[84:87], a[84:87]
  ds_read_b128 v[156:159], v39 offset:14336
  v_mfma_f32_16x16x32_bf16 a[116:119], v[108:111], v[84:87], a[116:119]
  v_mfma_f32_16x16x32_bf16 a[148:151], v[112:115], v[84:87], a[148:151]
  ds_read_b64_tr_b16 v[188:189], v35 offset:8192
  v_mfma_f32_16x16x32_bf16 a[180:183], v[116:119], v[84:87], a[180:183]
  v_mfma_f32_16x16x32_bf16 a[212:215], v[120:123], v[84:87], a[212:215]
  ds_read_b64_tr_b16 v[190:191], v35 offset:9216
  v_mfma_f32_16x16x32_bf16 a[244:247], v[124:127], v[84:87], a[244:247]
  v_mfma_f32_16x16x32_bf16 a[24:27], v[96:99], v[88:91], a[24:27]
  v_mfma_f32_16x16x32_bf16 a[56:59], v[100:103], v[88:91], a[56:59]
  v_mfma_f32_16x16x32_bf16 a[88:91], v[104:107], v[88:91], a[88:91]
  v_mfma_f32_16x16x32_bf16 a[120:123], v[108:111], v[88:91], a[120:123]
  v_mfma_f32_16x16x32_bf16 a[152:155], v[112:115], v[88:91], a[152:155]
  v_mfma_f32_16x16x32_bf16 a[184:187], v[116:119], v[88:91], a[184:187]
  v_mfma_f32_16x16x32_bf16 a[216:219], v[120:123], v[88:91], a[216:219]
  v_mfma_f32_16x16x32_bf16 a[248:251], v[124:127], v[88:91], a[248:251]
  v_mfma_f32_16x16x32_bf16 a[28:31], v[96:99], v[92:95], a[28:31]
  v_mfma_f32_16x16x32_bf16 a[60:63], v[100:103], v[92:95], a[60:63]
  v_mfma_f32_16x16x32_bf16 a[92:95], v[104:107], v[92:95], a[92:95]
  v_mfma_f32_16x16x32_bf16 a[124:127], v[108:111], v[92:95], a[124:127]
  v_mfma_f32_16x16x32_bf16 a[156:159], v[112:115], v[92:95], a[156:159]
  v_mfma_f32_16x16x32_bf16 a[188:191], v[116:119], v[92:95], a[188:191]
  v_mfma_f32_16x16x32_bf16 a[220:223], v[120:123], v[92:95], a[220:223]
  v_mfma_f32_16x16x32_bf16 a[252:255], v[124:127], v[92:95], a[252:255]
  s_waitcnt vmcnt(0) lgkmcnt(0)
  s_barrier
  v_mfma_f32_16x16x32_bf16 a[0:3], v[160:163], v[128:131], a[0:3]
  ds_read_b128 v[64:67], v36 offset:0
  s_add_u32 s56, s48, 640
  s_add_u32 m0, s49, 65536
  v_mfma_f32_16x16x32_bf16 a[32:35], v[164:167], v[128:131], a[32:35]
  buffer_load_dwordx4 v6, s[60:63], s56 offen offset:0 lds
  v_mfma_f32_16x16x32_bf16 a[64:67], v[168:171], v[128:131], a[64:67]
  ds_read_b64_tr_b16 v[96:97], v20 offset:0
  v_mfma_f32_16x16x32_bf16 a[96:99], v[172:175], v[128:131], a[96:99]
  v_mfma_f32_16x16x32_bf16 a[128:131], v[176:179], v[128:131], a[128:131]
  ds_read_b64_tr_b16 v[98:99], v20 offset:1024
  v_mfma_f32_16x16x32_bf16 a[160:163], v[180:183], v[128:131], a[160:163]
  v_mfma_f32_16x16x32_bf16 a[192:195], v[184:187], v[128:131], a[192:195]
  ds_read_b128 v[68:71], v36 offset:2048
  v_mfma_f32_16x16x32_bf16 a[224:227], v[188:191], v[128:131], a[224:227]
  buffer_load_dwordx4 v7, s[60:63], s56 offen offset:1024 lds
  v_mfma_f32_16x16x32_bf16 a[4:7], v[160:163], v[132:135], a[4:7]
  ds_read_b64_tr_b16 v[100:101], v21 offset:0
  v_mfma_f32_16x16x32_bf16 a[36:39], v[164:167], v[132:135], a[36:39]
  v_mfma_f32_16x16x32_bf16 a[68:71], v[168:171], v[132:135], a[68:71]
  ds_read_b64_tr_b16 v[102:103], v21 offset:1024
  v_mfma_f32_16x16x32_bf16 a[100:103], v[172:175], v[132:135], a[100:103]
  buffer_load_dwordx4 v8, s[60:63], s56 offen offset:2048 lds
  v_mfma_f32_16x16x32_bf16 a[132:135], v[176:179], v[132:135], a[132:135]
  ds_read_b128 v[72:75], v36 offset:4096
  v_mfma_f32_16x16x32_bf16 a[164:167], v[180:183], v[132:135], a[164:167]
  v_mfma_f32_16x16x32_bf16 a[196:199], v[184:187], v[132:135], a[196:199]
  ds_read_b64_tr_b16 v[104:105], v22 offset:0
  v_mfma_f32_16x16x32_bf16 a[228:231], v[188:191], v[132:135], a[228:231]
  v_mfma_f32_16x16x32_bf16 a[8:11], v[160:163], v[136:139], a[8:11]
  ds_read_b64_tr_b16 v[106:107], v22 offset:1024
  v_mfma_f32_16x16x32_bf16 a[40:43], v[164:167], v[136:139], a[40:43]
  buffer_load_dwordx4 v9, s[60:63], s56 offen offset:3072 lds
  v_mfma_f32_16x16x32_bf16 a[72:75], v[168:171], v[136:139], a[72:75]
  ds_read_b128 v[76:79], v36 offset:6144
  v_mfma_f32_16x16x32_bf16 a[104:107], v[172:175], v[136:139], a[104:107]
  v_mfma_f32_16x16x32_bf16 a[136:139], v[176:179], v[136:139], a[136:139]
  ds_read_b64_tr_b16 v[108:109], v23 offset:0
  v_mfma_f32_16x16x32_bf16 a[168:171], v[180:183], v[136:139], a[168:171]
  v_mfma_f32_16x16x32_bf16 a[200:203], v[184:187], v[136:139], a[200:203]
  ds_read_b64_tr_b16 v[110:111], v23 offset:1024
  s_add_u32 s56, s48, 33408
  s_add_u32 m0, s49, 69632
  v_mfma_f32_16x16x32_bf16 a[232:235], v[188:191], v[136:139], a[232:235]
  buffer_load_dwordx4 v6, s[60:63], s56 offen offset:0 lds
  v_mfma_f32_16x16x32_bf16 a[12:15], v[160:163], v[140:143], a[12:15]
  ds_read_b128 v[80:83], v36 offset:8192
  v_mfma_f32_16x16x32_bf16 a[44:47], v[164:167], v[140:143], a[44:47]
  v_mfma_f32_16x16x32_bf16 a[76:79], v[168:171], v[140:143], a[76:79]
  ds_read_b64_tr_b16 v[112:113], v24 offset:0
  v_mfma_f32_16x16x32_bf16 a[108:111], v[172:175], v[140:143], a[108:111]
  buffer_load_dwordx4 v7, s[60:63], s56 offen offset:1024 lds
  v_mfma_f32_16x16x32_bf16 a[140:143], v[176:179], v[140:143], a[140:143]
  ds_read_b64_tr_b16 v[114:115], v24 offset:1024
  v_mfma_f32_16x16x32_bf16 a[172:175], v[180:183], v[140:143], a[172:175]
  v_mfma_f32_16x16x32_bf16 a[204:207], v[184:187], v[140:143], a[204:207]
  ds_read_b128 v[84:87], v36 offset:10240
  v_mfma_f32_16x16x32_bf16 a[236:239], v[188:191], v[140:143], a[236:239]
  v_mfma_f32_16x16x32_bf16 a[16:19], v[160:163], v[144:147], a[16:19]
  ds_read_b64_tr_b16 v[116:117], v25 offset:0
  v_mfma_f32_16x16x32_bf16 a[48:51], v[164:167], v[144:147], a[48:51]
  buffer_load_dwordx4 v8, s[60:63], s56 offen offset:2048 lds
  v_mfma_f32_16x16x32_bf16 a[80:83], v[168:171], v[144:147], a[80:83]
  ds_read_b64_tr_b16 v[118:119], v25 offset:1024
  v_mfma_f32_16x16x32_bf16 a[112:115], v[172:175], v[144:147], a[112:115]
  v_mfma_f32_16x16x32_bf16 a[144:147], v[176:179], v[144:147], a[144:147]
  ds_read_b128 v[88:91], v36 offset:12288
  v_mfma_f32_16x16x32_bf16 a[176:179], v[180:183], v[144:147], a[176:179]
  v_mfma_f32_16x16x32_bf16 a[208:211], v[184:187], v[144:147], a[208:211]
  ds_read_b64_tr_b16 v[120:121], v26 offset:0
  v_mfma_f32_16x16x32_bf16 a[240:243], v[188:191], v[144:147], a[240:243]
  buffer_load_dwordx4 v9, s[60:63], s56 offen offset:3072 lds
  v_mfma_f32_16x16x32_bf16 a[20:23], v[160:163], v[148:151], a[20:23]
  ds_read_b64_tr_b16 v[122:123], v26 offset:1024
  v_mfma_f32_16x16x32_bf16 a[52:55], v[164:167], v[148:151], a[52:55]
  v_mfma_f32_16x16x32_bf16 a[84:87], v[168:171], v[148:151], a[84:87]
  ds_read_b128 v[92:95], v36 offset:14336
  v_mfma_f32_16x16x32_bf16 a[116:119], v[172:175], v[148:151], a[116:119]
  v_mfma_f32_16x16x32_bf16 a[148:151], v[176:179], v[148:151], a[148:151]
  ds_read_b64_tr_b16 v[124:125], v27 offset:0
  s_add_u32 s56, s48, 66176
  s_add_u32 m0, s49, 73728
  v_mfma_f32_16x16x32_bf16 a[180:183], v[180:183], v[148:151], a[180:183]
  buffer_load_dwordx4 v6, s[60:63], s56 offen offset:0 lds
  v_mfma_f32_16x16x32_bf16 a[212:215], v[184:187], v[148:151], a[212:215]
  ds_read_b64_tr_b16 v[126:127], v27 offset:1024
  v_mfma_f32_16x16x32_bf16 a[244:247], v[188:191], v[148:151], a[244:247]
  v_mfma_f32_16x16x32_bf16 a[24:27], v[160:163], v[152:155], a[24:27]
  v_mfma_f32_16x16x32_bf16 a[56:59], v[164:167], v[152:155], a[56:59]
  buffer_load_dwordx4 v7, s[60:63], s56 offen offset:1024 lds
  v_mfma_f32_16x16x32_bf16 a[88:91], v[168:171], v[152:155], a[88:91]
  v_mfma_f32_16x16x32_bf16 a[120:123], v[172:175], v[152:155], a[120:123]
  v_mfma_f32_16x16x32_bf16 a[152:155], v[176:179], v[152:155], a[152:155]
  v_mfma_f32_16x16x32_bf16 a[184:187], v[180:183], v[152:155], a[184:187]
  v_mfma_f32_16x16x32_bf16 a[216:219], v[184:187], v[152:155], a[216:219]
  buffer_load_dwordx4 v8, s[60:63], s56 offen offset:2048 lds
  v_mfma_f32_16x16x32_bf16 a[248:251], v[188:191], v[152:155], a[248:251]
  v_mfma_f32_16x16x32_bf16 a[28:31], v[160:163], v[156:159], a[28:31]
  v_mfma_f32_16x16x32_bf16 a[60:63], v[164:167], v[156:159], a[60:63]
  v_mfma_f32_16x16x32_bf16 a[92:95], v[168:171], v[156:159], a[92:95]
  v_mfma_f32_16x16x32_bf16 a[124:127], v[172:175], v[156:159], a[124:127]
  v_mfma_f32_16x16x32_bf16 a[156:159], v[176:179], v[156:159], a[156:159]
  buffer_load_dwordx4 v9, s[60:63], s56 offen offset:3072 lds
  v_mfma_f32_16x16x32_bf16 a[188:191], v[180:183], v[156:159], a[188:191]
  v_mfma_f32_16x16x32_bf16 a[220:223], v[184:187], v[156:159], a[220:223]
  v_mfma_f32_16x16x32_bf16 a[252:255], v[188:191], v[156:159], a[252:255]
  s_waitcnt lgkmcnt(0)
  v_mfma_f32_16x16x32_bf16 a[0:3], v[96:99], v[64:67], a[0:3]
  ds_read_b128 v[128:131], v37 offset:0
  s_add_u32 s56, s48, 98944
  s_add_u32 m0, s49, 77824
  v_mfma_f32_16x16x32_bf16 a[32:35], v[100:103], v[64:67], a[32:35]
  buffer_load_dwordx4 v6, s[60:63], s56 offen offset:0 lds
  v_mfma_f32_16x16x32_bf16 a[64:67], v[104:107], v[64:67], a[64:67]
  ds_read_b64_tr_b16 v[160:161], v20 offset:8192
  v_mfma_f32_16x16x32_bf16 a[96:99], v[108:111], v[64:67], a[96:99]
  v_mfma_f32_16x16x32_bf16 a[128:131], v[112:115], v[64:67], a[128:131]
  ds_read_b64_tr_b16 v[162:163], v20 offset:9216
  v_mfma_f32_16x16x32_bf16 a[160:163], v[116:119], v[64:67], a[160:163]
  v_mfma_f32_16x16x32_bf16 a[192:195], v[120:123], v[64:67], a[192:195]
  ds_read_b128 v[132:135], v37 offset:2048
  v_mfma_f32_16x16x32_bf16 a[224:227], v[124:127], v[64:67], a[224:227]
  buffer_load_dwordx4 v7, s[60:63], s56 offen offset:1024 lds
  v_mfma_f32_16x16x32_bf16 a[4:7], v[96:99], v[68:71], a[4:7]
  ds_read_b64_tr_b16 v[164:165], v21 offset:8192
  v_mfma_f32_16x16x32_bf16 a[36:39], v[100:103], v[68:71], a[36:39]
  v_mfma_f32_16x16x32_bf16 a[68:71], v[104:107], v[68:71], a[68:71]
  ds_read_b64_tr_b16 v[166:167], v21 offset:9216
  v_mfma_f32_16x16x32_bf16 a[100:103], v[108:111], v[68:71], a[100:103]
  v_mfma_f32_16x16x32_bf16 a[132:135], v[112:115], v[68:71], a[132:135]
  ds_read_b128 v[136:139], v37 offset:4096
  v_mfma_f32_16x16x32_bf16 a[164:167], v[116:119], v[68:71], a[164:167]
  buffer_load_dwordx4 v8, s[60:63], s56 offen offset:2048 lds
  v_mfma_f32_16x16x32_bf16 a[196:199], v[120:123], v[68:71], a[196:199]
  ds_read_b64_tr_b16 v[168:169], v22 offset:8192
  v_mfma_f32_16x16x32_bf16 a[228:231], v[124:127], v[68:71], a[228:231]
  v_mfma_f32_16x16x32_bf16 a[8:11], v[96:99], v[72:75], a[8:11]
  ds_read_b64_tr_b16 v[170:171], v22 offset:9216
  v_mfma_f32_16x16x32_bf16 a[40:43], v[100:103], v[72:75], a[40:43]
  buffer_load_dwordx4 v9, s[60:63], s56 offen offset:3072 lds
  v_mfma_f32_16x16x32_bf16 a[72:75], v[104:107], v[72:75], a[72:75]
  ds_read_b128 v[140:143], v37 offset:6144
  v_mfma_f32_16x16x32_bf16 a[104:107], v[108:111], v[72:75], a[104:107]
  v_mfma_f32_16x16x32_bf16 a[136:139], v[112:115], v[72:75], a[136:139]
  ds_read_b64_tr_b16 v[172:173], v23 offset:8192
  v_mfma_f32_16x16x32_bf16 a[168:171], v[116:119], v[72:75], a[168:171]
  v_mfma_f32_16x16x32_bf16 a[200:203], v[120:123], v[72:75], a[200:203]
  ds_read_b64_tr_b16 v[174:175], v23 offset:9216
  v_mfma_f32_16x16x32_bf16 a[232:235], v[124:127], v[72:75], a[232:235]
  v_mfma_f32_16x16x32_bf16 a[12:15], v[96:99], v[76:79], a[12:15]
  ds_read_b128 v[144:147], v37 offset:8192
  v_mfma_f32_16x16x32_bf16 a[44:47], v[100:103], v[76:79], a[44:47]
  v_mfma_f32_16x16x32_bf16 a[76:79], v[104:107], v[76:79], a[76:79]
  ds_read_b64_tr_b16 v[176:177], v24 offset:8192
  v_mfma_f32_16x16x32_bf16 a[108:111], v[108:111], v[76:79], a[108:111]
  v_mfma_f32_16x16x32_bf16 a[140:143], v[112:115], v[76:79], a[140:143]
  ds_read_b64_tr_b16 v[178:179], v24 offset:9216
  v_mfma_f32_16x16x32_bf16 a[172:175], v[116:119], v[76:79], a[172:175]
  v_mfma_f32_16x16x32_bf16 a[204:207], v[120:123], v[76:79], a[204:207]
  ds_read_b128 v[148:151], v37 offset:10240
  v_mfma_f32_16x16x32_bf16 a[236:239], v[124:127], v[76:79], a[236:239]
  v_mfma_f32_16x16x32_bf16 a[16:19], v[96:99], v[80:83], a[16:19]
  ds_read_b64_tr_b16 v[180:181], v25 offset:8192
  v_mfma_f32_16x16x32_bf16 a[48:51], v[100:103], v[80:83], a[48:51]
  v_mfma_f32_16x16x32_bf16 a[80:83], v[104:107], v[80:83], a[80:83]
  ds_read_b64_tr_b16 v[182:183], v25 offset:9216
  v_mfma_f32_16x16x32_bf16 a[112:115], v[108:111], v[80:83], a[112:115]
  v_mfma_f32_16x16x32_bf16 a[144:147], v[112:115], v[80:83], a[144:147]
  ds_read_b128 v[152:155], v37 offset:12288
  v_mfma_f32_16x16x32_bf16 a[176:179], v[116:119], v[80:83], a[176:179]
  v_mfma_f32_16x16x32_bf16 a[208:211], v[120:123], v[80:83], a[208:211]
  ds_read_b64_tr_b16 v[184:185], v26 offset:8192
  v_mfma_f32_16x16x32_bf16 a[240:243], v[124:127], v[80:83], a[240:243]
  v_mfma_f32_16x16x32_bf16 a[20:23], v[96:99], v[84:87], a[20:23]
  ds_read_b64_tr_b16 v[186:187], v26 offset:9216
  v_mfma_f32_16x16x32_bf16 a[52:55], v[100:103], v[84:87], a[52:55]
  v_mfma_f32_16x16x32_bf16 a[84:87], v[104:107], v[84:87], a[84:87]
  ds_read_b128 v[156:159], v37 offset:14336
  v_mfma_f32_16x16x32_bf16 a[116:119], v[108:111], v[84:87], a[116:119]
  v_mfma_f32_16x16x32_bf16 a[148:151], v[112:115], v[84:87], a[148:151]
  ds_read_b64_tr_b16 v[188:189], v27 offset:8192
  v_mfma_f32_16x16x32_bf16 a[180:183], v[116:119], v[84:87], a[180:183]
  v_mfma_f32_16x16x32_bf16 a[212:215], v[120:123], v[84:87], a[212:215]
  ds_read_b64_tr_b16 v[190:191], v27 offset:9216
  v_mfma_f32_16x16x32_bf16 a[244:247], v[124:127], v[84:87], a[244:247]
  v_mfma_f32_16x16x32_bf16 a[24:27], v[96:99], v[88:91], a[24:27]
  v_mfma_f32_16x16x32_bf16 a[56:59], v[100:103], v[88:91], a[56:59]
  v_mfma_f32_16x16x32_bf16 a[88:91], v[104:107], v[88:91], a[88:91]
  v_mfma_f32_16x16x32_bf16 a[120:123], v[108:111], v[88:91], a[120:123]
  v_mfma_f32_16x16x32_bf16 a[152:155], v[112:115], v[88:91], a[152:155]
  v_mfma_f32_16x16x32_bf16 a[184:187], v[116:119], v[88:91], a[184:187]
  v_mfma_f32_16x16x32_bf16 a[216:219], v[120:123], v[88:91], a[216:219]
  v_mfma_f32_16x16x32_bf16 a[248:251], v[124:127], v[88:91], a[248:251]
  v_mfma_f32_16x16x32_bf16 a[28:31], v[96:99], v[92:95], a[28:31]
  v_mfma_f32_16x16x32_bf16 a[60:63], v[100:103], v[92:95], a[60:63]
  v_mfma_f32_16x16x32_bf16 a[92:95], v[104:107], v[92:95], a[92:95]
  v_mfma_f32_16x16x32_bf16 a[124:127], v[108:111], v[92:95], a[124:127]
  v_mfma_f32_16x16x32_bf16 a[156:159], v[112:115], v[92:95], a[156:159]
  v_mfma_f32_16x16x32_bf16 a[188:191], v[116:119], v[92:95], a[188:191]
  v_mfma_f32_16x16x32_bf16 a[220:223], v[120:123], v[92:95], a[220:223]
  v_mfma_f32_16x16x32_bf16 a[252:255], v[124:127], v[92:95], a[252:255]
  s_waitcnt vmcnt(0) lgkmcnt(0)
  s_barrier
  v_mfma_f32_16x16x32_bf16 a[0:3], v[160:163], v[128:131], a[0:3]
  ds_read_b128 v[64:67], v38 offset:0
  s_add_u32 s56, s48, 768
  s_add_u32 m0, s49, 0
  v_mfma_f32_16x16x32_bf16 a[32:35], v[164:167], v[128:131], a[32:35]
  buffer_load_dwordx4 v6, s[60:63], s56 offen offset:0 lds
  v_mfma_f32_16x16x32_bf16 a[64:67], v[168:171], v[128:131], a[64:67]
  ds_read_b64_tr_b16 v[96:97], v28 offset:0
  v_mfma_f32_16x16x32_bf16 a[96:99], v[172:175], v[128:131], a[96:99]
  v_mfma_f32_16x16x32_bf16 a[128:131], v[176:179], v[128:131], a[128:131]
  ds_read_b64_tr_b16 v[98:99], v28 offset:1024
  v_mfma_f32_16x16x32_bf16 a[160:163], v[180:183], v[128:131], a[160:163]
  v_mfma_f32_16x16x32_bf16 a[192:195], v[184:187], v[128:131], a[192:195]
  ds_read_b128 v[68:71], v38 offset:2048
  v_mfma_f32_16x16x32_bf16 a[224:227], v[188:191], v[128:131], a[224:227]
  buffer_load_dwordx4 v7, s[60:63], s56 offen offset:1024 lds
  v_mfma_f32_16x16x32_bf16 a[4:7], v[160:163], v[132:135], a[4:7]
  ds_read_b64_tr_b16 v[100:101], v29 offset:0
  v_mfma_f32_16x16x32_bf16 a[36:39], v[164:167], v[132:135], a[36:39]
  v_mfma_f32_16x16x32_bf16 a[68:71], v[168:171], v[132:135], a[68:71]
  ds_read_b64_tr_b16 v[102:103], v29 offset:1024
  v_mfma_f32_16x16x32_bf16 a[100:103], v[172:175], v[132:135], a[100:103]
  buffer_load_dwordx4 v8, s[60:63], s56 offen offset:2048 lds
  v_mfma_f32_16x16x32_bf16 a[132:135], v[176:179], v[132:135], a[132:135]
  ds_read_b128 v[72:75], v38 offset:4096
  v_mfma_f32_16x16x32_bf16 a[164:167], v[180:183], v[132:135], a[164:167]
  v_mfma_f32_16x16x32_bf16 a[196:199], v[184:187], v[132:135], a[196:199]
  ds_read_b64_tr_b16 v[104:105], v30 offset:0
  v_mfma_f32_16x16x32_bf16 a[228:231], v[188:191], v[132:135], a[228:231]
  v_mfma_f32_16x16x32_bf16 a[8:11], v[160:163], v[136:139], a[8:11]
  ds_read_b64_tr_b16 v[106:107], v30 offset:1024
  v_mfma_f32_16x16x32_bf16 a[40:43], v[164:167], v[136:139], a[40:43]
  buffer_load_dwordx4 v9, s[60:63], s56 offen offset:3072 lds
  v_mfma_f32_16x16x32_bf16 a[72:75], v[168:171], v[136:139], a[72:75]
  ds_read_b128 v[76:79], v38 offset:6144
  v_mfma_f32_16x16x32_bf16 a[104:107], v[172:175], v[136:139], a[104:107]
  v_mfma_f32_16x16x32_bf16 a[136:139], v[176:179], v[136:139], a[136:139]
  ds_read_b64_tr_b16 v[108:109], v31 offset:0
  v_mfma_f32_16x16x32_bf16 a[168:171], v[180:183], v[136:139], a[168:171]
  v_mfma_f32_16x16x32_bf16 a[200:203], v[184:187], v[136:139], a[200:203]
  ds_read_b64_tr_b16 v[110:111], v31 offset:1024
  s_add_u32 s56, s48, 33536
  s_add_u32 m0, s49, 4096
  v_mfma_f32_16x16x32_bf16 a[232:235], v[188:191], v[136:139], a[232:235]
  buffer_load_dwordx4 v6, s[60:63], s56 offen offset:0 lds
  v_mfma_f32_16x16x32_bf16 a[12:15], v[160:163], v[140:143], a[12:15]
  ds_read_b128 v[80:83], v38 offset:8192
  v_mfma_f32_16x16x32_bf16 a[44:47], v[164:167], v[140:143], a[44:47]
  v_mfma_f32_16x16x32_bf16 a[76:79], v[168:171], v[140:143], a[76:79]
  ds_read_b64_tr_b16 v[112:113], v32 offset:0
  v_mfma_f32_16x16x32_bf16 a[108:111], v[172:175], v[140:143], a[108:111]
  buffer_load_dwordx4 v7, s[60:63], s56 offen offset:1024 lds
  v_mfma_f32_16x16x32_bf16 a[140:143], v[176:179], v[140:143], a[140:143]
  ds_read_b64_tr_b16 v[114:115], v32 offset:1024
  v_mfma_f32_16x16x32_bf16 a[172:175], v[180:183], v[140:143], a[172:175]
  v_mfma_f32_16x16x32_bf16 a[204:207], v[184:187], v[140:143], a[204:207]
  ds_read_b128 v[84:87], v38 offset:10240
  v_mfma_f32_16x16x32_bf16 a[236:239], v[188:191], v[140:143], a[236:239]
  v_mfma_f32_16x16x32_bf16 a[16:19], v[160:163], v[144:147], a[16:19]
  ds_read_b64_tr_b16 v[116:117], v33 offset:0
  v_mfma_f32_16x16x32_bf16 a[48:51], v[164:167], v[144:147], a[48:51]
  buffer_load_dwordx4 v8, s[60:63], s56 offen offset:2048 lds
  v_mfma_f32_16x16x32_bf16 a[80:83], v[168:171], v[144:147], a[80:83]
  ds_read_b64_tr_b16 v[118:119], v33 offset:1024
  v_mfma_f32_16x16x32_bf16 a[112:115], v[172:175], v[144:147], a[112:115]
  v_mfma_f32_16x16x32_bf16 a[144:147], v[176:179], v[144:147], a[144:147]
  ds_read_b128 v[88:91], v38 offset:12288
  v_mfma_f32_16x16x32_bf16 a[176:179], v[180:183], v[144:147], a[176:179]
  v_mfma_f32_16x16x32_bf16 a[208:211], v[184:187], v[144:147], a[208:211]
  ds_read_b64_tr_b16 v[120:121], v34 offset:0
  v_mfma_f32_16x16x32_bf16 a[240:243], v[188:191], v[144:147], a[240:243]
  buffer_load_dwordx4 v9, s[60:63], s56 offen offset:3072 lds
  v_mfma_f32_16x16x32_bf16 a[20:23], v[160:163], v[148:151], a[20:23]
  ds_read_b64_tr_b16 v[122:123], v34 offset:1024
  v_mfma_f32_16x16x32_bf16 a[52:55], v[164:167], v[148:151], a[52:55]
  v_mfma_f32_16x16x32_bf16 a[84:87], v[168:171], v[148:151], a[84:87]
  ds_read_b128 v[92:95], v38 offset:14336
  v_mfma_f32_16x16x32_bf16 a[116:119], v[172:175], v[148:151], a[116:119]
  v_mfma_f32_16x16x32_bf16 a[148:151], v[176:179], v[148:151], a[148:151]
  ds_read_b64_tr_b16 v[124:125], v35 offset:0
  s_add_u32 s56, s48, 66304
  s_add_u32 m0, s49, 8192
  v_mfma_f32_16x16x32_bf16 a[180:183], v[180:183], v[148:151], a[180:183]
  buffer_load_dwordx4 v6, s[60:63], s56 offen offset:0 lds
  v_mfma_f32_16x16x32_bf16 a[212:215], v[184:187], v[148:151], a[212:215]
  ds_read_b64_tr_b16 v[126:127], v35 offset:1024
  v_mfma_f32_16x16x32_bf16 a[244:247], v[188:191], v[148:151], a[244:247]
  v_mfma_f32_16x16x32_bf16 a[24:27], v[160:163], v[152:155], a[24:27]
  v_mfma_f32_16x16x32_bf16 a[56:59], v[164:167], v[152:155], a[56:59]
  buffer_load_dwordx4 v7, s[60:63], s56 offen offset:1024 lds
  v_mfma_f32_16x16x32_bf16 a[88:91], v[168:171], v[152:155], a[88:91]
  v_mfma_f32_16x16x32_bf16 a[120:123], v[172:175], v[152:155], a[120:123]
  v_mfma_f32_16x16x32_bf16 a[152:155], v[176:179], v[152:155], a[152:155]
  v_mfma_f32_16x16x32_bf16 a[184:187], v[180:183], v[152:155], a[184:187]
  v_mfma_f32_16x16x32_bf16 a[216:219], v[184:187], v[152:155], a[216:219]
  buffer_load_dwordx4 v8, s[60:63], s56 offen offset:2048 lds
  v_mfma_f32_16x16x32_bf16 a[248:251], v[188:191], v[152:155], a[248:251]
  v_mfma_f32_16x16x32_bf16 a[28:31], v[160:163], v[156:159], a[28:31]
  v_mfma_f32_16x16x32_bf16 a[60:63], v[164:167], v[156:159], a[60:63]
  v_mfma_f32_16x16x32_bf16 a[92:95], v[168:171], v[156:159], a[92:95]
  v_mfma_f32_16x16x32_bf16 a[124:127], v[172:175], v[156:159], a[124:127]
  v_mfma_f32_16x16x32_bf16 a[156:159], v[176:179], v[156:159], a[156:159]
  buffer_load_dwordx4 v9, s[60:63], s56 offen offset:3072 lds
  v_mfma_f32_16x16x32_bf16 a[188:191], v[180:183], v[156:159], a[188:191]
  v_mfma_f32_16x16x32_bf16 a[220:223], v[184:187], v[156:159], a[220:223]
  v_mfma_f32_16x16x32_bf16 a[252:255], v[188:191], v[156:159], a[252:255]
  s_waitcnt lgkmcnt(0)
  v_mfma_f32_16x16x32_bf16 a[0:3], v[96:99], v[64:67], a[0:3]
  ds_read_b128 v[128:131], v39 offset:0
  s_add_u32 s56, s48, 99072
  s_add_u32 m0, s49, 12288
  v_mfma_f32_16x16x32_bf16 a[32:35], v[100:103], v[64:67], a[32:35]
  buffer_load_dwordx4 v6, s[60:63], s56 offen offset:0 lds
  v_mfma_f32_16x16x32_bf16 a[64:67], v[104:107], v[64:67], a[64:67]
  ds_read_b64_tr_b16 v[160:161], v28 offset:8192
  v_mfma_f32_16x16x32_bf16 a[96:99], v[108:111], v[64:67], a[96:99]
  v_mfma_f32_16x16x32_bf16 a[128:131], v[112:115], v[64:67], a[128:131]
  ds_read_b64_tr_b16 v[162:163], v28 offset:9216
  v_mfma_f32_16x16x32_bf16 a[160:163], v[116:119], v[64:67], a[160:163]
  v_mfma_f32_16x16x32_bf16 a[192:195], v[120:123], v[64:67], a[192:195]
  ds_read_b128 v[132:135], v39 offset:2048
  v_mfma_f32_16x16x32_bf16 a[224:227], v[124:127], v[64:67], a[224:227]
  buffer_load_dwordx4 v7, s[60:63], s56 offen offset:1024 lds
  v_mfma_f32_16x16x32_bf16 a[4:7], v[96:99], v[68:71], a[4:7]
  ds_read_b64_tr_b16 v[164:165], v29 offset:8192
  v_mfma_f32_16x16x32_bf16 a[36:39], v[100:103], v[68:71], a[36:39]
  v_mfma_f32_16x16x32_bf16 a[68:71], v[104:107], v[68:71], a[68:71]
  ds_read_b64_tr_b16 v[166:167], v29 offset:9216
  v_mfma_f32_16x16x32_bf16 a[100:103], v[108:111], v[68:71], a[100:103]
  v_mfma_f32_16x16x32_bf16 a[132:135], v[112:115], v[68:71], a[132:135]
  ds_read_b128 v[136:139], v39 offset:4096
  v_mfma_f32_16x16x32_bf16 a[164:167], v[116:119], v[68:71], a[164:167]
  buffer_load_dwordx4 v8, s[60:63], s56 offen offset:2048 lds
  v_mfma_f32_16x16x32_bf16 a[196:199], v[120:123], v[68:71], a[196:199]
  ds_read_b64_tr_b16 v[168:169], v30 offset:8192
  v_mfma_f32_16x16x32_bf16 a[228:231], v[124:127], v[68:71], a[228:231]
  v_mfma_f32_16x16x32_bf16 a[8:11], v[96:99], v[72:75], a[8:11]
  ds_read_b64_tr_b16 v[170:171], v30 offset:9216
  v_mfma_f32_16x16x32_bf16 a[40:43], v[100:103], v[72:75], a[40:43]
  buffer_load_dwordx4 v9, s[60:63], s56 offen offset:3072 lds
  v_mfma_f32_16x16x32_bf16 a[72:75], v[104:107], v[72:75], a[72:75]
  ds_read_b128 v[140:143], v39 offset:6144
  v_mfma_f32_16x16x32_bf16 a[104:107], v[108:111], v[72:75], a[104:107]
  v_mfma_f32_16x16x32_bf16 a[136:139], v[112:115], v[72:75], a[136:139]
  ds_read_b64_tr_b16 v[172:173], v31 offset:8192
  v_mfma_f32_16x16x32_bf16 a[168:171], v[116:119], v[72:75], a[168:171]
  v_mfma_f32_16x16x32_bf16 a[200:203], v[120:123], v[72:75], a[200:203]
  ds_read_b64_tr_b16 v[174:175], v31 offset:9216
  v_mfma_f32_16x16x32_bf16 a[232:235], v[124:127], v[72:75], a[232:235]
  v_mfma_f32_16x16x32_bf16 a[12:15], v[96:99], v[76:79], a[12:15]
  ds_read_b128 v[144:147], v39 offset:8192
  v_mfma_f32_16x16x32_bf16 a[44:47], v[100:103], v[76:79], a[44:47]
  v_mfma_f32_16x16x32_bf16 a[76:79], v[104:107], v[76:79], a[76:79]
  ds_read_b64_tr_b16 v[176:177], v32 offset:8192
  v_mfma_f32_16x16x32_bf16 a[108:111], v[108:111], v[76:79], a[108:111]
  v_mfma_f32_16x16x32_bf16 a[140:143], v[112:115], v[76:79], a[140:143]
  ds_read_b64_tr_b16 v[178:179], v32 offset:9216
  v_mfma_f32_16x16x32_bf16 a[172:175], v[116:119], v[76:79], a[172:175]
  v_mfma_f32_16x16x32_bf16 a[204:207], v[120:123], v[76:79], a[204:207]
  ds_read_b128 v[148:151], v39 offset:10240
  v_mfma_f32_16x16x32_bf16 a[236:239], v[124:127], v[76:79], a[236:239]
  v_mfma_f32_16x16x32_bf16 a[16:19], v[96:99], v[80:83], a[16:19]
  ds_read_b64_tr_b16 v[180:181], v33 offset:8192
  v_mfma_f32_16x16x32_bf16 a[48:51], v[100:103], v[80:83], a[48:51]
  v_mfma_f32_16x16x32_bf16 a[80:83], v[104:107], v[80:83], a[80:83]
  ds_read_b64_tr_b16 v[182:183], v33 offset:9216
  v_mfma_f32_16x16x32_bf16 a[112:115], v[108:111], v[80:83], a[112:115]
  v_mfma_f32_16x16x32_bf16 a[144:147], v[112:115], v[80:83], a[144:147]
  ds_read_b128 v[152:155], v39 offset:12288
  v_mfma_f32_16x16x32_bf16 a[176:179], v[116:119], v[80:83], a[176:179]
  v_mfma_f32_16x16x32_bf16 a[208:211], v[120:123], v[80:83], a[208:211]
  ds_read_b64_tr_b16 v[184:185], v34 offset:8192
  v_mfma_f32_16x16x32_bf16 a[240:243], v[124:127], v[80:83], a[240:243]
  v_mfma_f32_16x16x32_bf16 a[20:23], v[96:99], v[84:87], a[20:23]
  ds_read_b64_tr_b16 v[186:187], v34 offset:9216
  v_mfma_f32_16x16x32_bf16 a[52:55], v[100:103], v[84:87], a[52:55]
  v_mfma_f32_16x16x32_bf16 a[84:87], v[104:107], v[84:87], a[84:87]
  ds_read_b128 v[156:159], v39 offset:14336
  v_mfma_f32_16x16x32_bf16 a[116:119], v[108:111], v[84:87], a[116:119]
  v_mfma_f32_16x16x32_bf16 a[148:151], v[112:115], v[84:87], a[148:151]
  ds_read_b64_tr_b16 v[188:189], v35 offset:8192
  v_mfma_f32_16x16x32_bf16 a[180:183], v[116:119], v[84:87], a[180:183]
  v_mfma_f32_16x16x32_bf16 a[212:215], v[120:123], v[84:87], a[212:215]
  ds_read_b64_tr_b16 v[190:191], v35 offset:9216
  v_mfma_f32_16x16x32_bf16 a[244:247], v[124:127], v[84:87], a[244:247]
  v_mfma_f32_16x16x32_bf16 a[24:27], v[96:99], v[88:91], a[24:27]
  v_mfma_f32_16x16x32_bf16 a[56:59], v[100:103], v[88:91], a[56:59]
  v_mfma_f32_16x16x32_bf16 a[88:91], v[104:107], v[88:91], a[88:91]
  v_mfma_f32_16x16x32_bf16 a[120:123], v[108:111], v[88:91], a[120:123]
  v_mfma_f32_16x16x32_bf16 a[152:155], v[112:115], v[88:91], a[152:155]
  v_mfma_f32_16x16x32_bf16 a[184:187], v[116:119], v[88:91], a[184:187]
  v_mfma_f32_16x16x32_bf16 a[216:219], v[120:123], v[88:91], a[216:219]
  v_mfma_f32_16x16x32_bf16 a[248:251], v[124:127], v[88:91], a[248:251]
  v_mfma_f32_16x16x32_bf16 a[28:31], v[96:99], v[92:95], a[28:31]
  v_mfma_f32_16x16x32_bf16 a[60:63], v[100:103], v[92:95], a[60:63]
  v_mfma_f32_16x16x32_bf16 a[92:95], v[104:107], v[92:95], a[92:95]
  v_mfma_f32_16x16x32_bf16 a[124:127], v[108:111], v[92:95], a[124:127]
  v_mfma_f32_16x16x32_bf16 a[156:159], v[112:115], v[92:95], a[156:159]
  v_mfma_f32_16x16x32_bf16 a[188:191], v[116:119], v[92:95], a[188:191]
  v_mfma_f32_16x16x32_bf16 a[220:223], v[120:123], v[92:95], a[220:223]
  v_mfma_f32_16x16x32_bf16 a[252:255], v[124:127], v[92:95], a[252:255]
  s_waitcnt vmcnt(0) lgkmcnt(0)
  s_barrier
  v_mfma_f32_16x16x32_bf16 a[0:3], v[160:163], v[128:131], a[0:3]
  ds_read_b128 v[64:67], v36 offset:0
  s_add_u32 s56, s48, 896
  s_add_u32 m0, s49, 65536
  v_mfma_f32_16x16x32_bf16 a[32:35], v[164:167], v[128:131], a[32:35]
  buffer_load_dwordx4 v6, s[60:63], s56 offen offset:0 lds
  v_mfma_f32_16x16x32_bf16 a[64:67], v[168:171], v[128:131], a[64:67]
  ds_read_b64_tr_b16 v[96:97], v20 offset:0
  v_mfma_f32_16x16x32_bf16 a[96:99], v[172:175], v[128:131], a[96:99]
  v_mfma_f32_16x16x32_bf16 a[128:131], v[176:179], v[128:131], a[128:131]
  ds_read_b64_tr_b16 v[98:99], v20 offset:1024
  v_mfma_f32_16x16x32_bf16 a[160:163], v[180:183], v[128:131], a[160:163]
  v_mfma_f32_16x16x32_bf16 a[192:195], v[184:187], v[128:131], a[192:195]
  ds_read_b128 v[68:71], v36 offset:2048
  v_mfma_f32_16x16x32_bf16 a[224:227], v[188:191], v[128:131], a[224:227]
  buffer_load_dwordx4 v7, s[60:63], s56 offen offset:1024 lds
  v_mfma_f32_16x16x32_bf16 a[4:7], v[160:163], v[132:135], a[4:7]
  ds_read_b64_tr_b16 v[100:101], v21 offset:0
  v_mfma_f32_16x16x32_bf16 a[36:39], v[164:167], v[132:135], a[36:39]
  v_mfma_f32_16x16x32_bf16 a[68:71], v[168:171], v[132:135], a[68:71]
  ds_read_b64_tr_b16 v[102:103], v21 offset:1024
  v_mfma_f32_16x16x32_bf16 a[100:103], v[172:175], v[132:135], a[100:103]
  buffer_load_dwordx4 v8, s[60:63], s56 offen offset:2048 lds
  v_mfma_f32_16x16x32_bf16 a[132:135], v[176:179], v[132:135], a[132:135]
  ds_read_b128 v[72:75], v36 offset:4096
  v_mfma_f32_16x16x32_bf16 a[164:167], v[180:183], v[132:135], a[164:167]
  v_mfma_f32_16x16x32_bf16 a[196:199], v[184:187], v[132:135], a[196:199]
  ds_read_b64_tr_b16 v[104:105], v22 offset:0
  v_mfma_f32_16x16x32_bf16 a[228:231], v[188:191], v[132:135], a[228:231]
  v_mfma_f32_16x16x32_bf16 a[8:11], v[160:163], v[136:139], a[8:11]
  ds_read_b64_tr_b16 v[106:107], v22 offset:1024
  v_mfma_f32_16x16x32_bf16 a[40:43], v[164:167], v[136:139], a[40:43]
  buffer_load_dwordx4 v9, s[60:63], s56 offen offset:3072 lds
  v_mfma_f32_16x16x32_bf16 a[72:75], v[168:171], v[136:139], a[72:75]
  ds_read_b128 v[76:79], v36 offset:6144
  v_mfma_f32_16x16x32_bf16 a[104:107], v[172:175], v[136:139], a[104:107]
  v_mfma_f32_16x16x32_bf16 a[136:139], v[176:179], v[136:139], a[136:139]
  ds_read_b64_tr_b16 v[108:109], v23 offset:0
  v_mfma_f32_16x16x32_bf16 a[168:171], v[180:183], v[136:139], a[168:171]
  v_mfma_f32_16x16x32_bf16 a[200:203], v[184:187], v[136:139], a[200:203]
  ds_read_b64_tr_b16 v[110:111], v23 offset:1024
  s_add_u32 s56, s48, 33664
  s_add_u32 m0, s49, 69632
  v_mfma_f32_16x16x32_bf16 a[232:235], v[188:191], v[136:139], a[232:235]
  buffer_load_dwordx4 v6, s[60:63], s56 offen offset:0 lds
  v_mfma_f32_16x16x32_bf16 a[12:15], v[160:163], v[140:143], a[12:15]
  ds_read_b128 v[80:83], v36 offset:8192
  v_mfma_f32_16x16x32_bf16 a[44:47], v[164:167], v[140:143], a[44:47]
  v_mfma_f32_16x16x32_bf16 a[76:79], v[168:171], v[140:143], a[76:79]
  ds_read_b64_tr_b16 v[112:113], v24 offset:0
  v_mfma_f32_16x16x32_bf16 a[108:111], v[172:175], v[140:143], a[108:111]
  buffer_load_dwordx4 v7, s[60:63], s56 offen offset:1024 lds
  v_mfma_f32_16x16x32_bf16 a[140:143], v[176:179], v[140:143], a[140:143]
  ds_read_b64_tr_b16 v[114:115], v24 offset:1024
  v_mfma_f32_16x16x32_bf16 a[172:175], v[180:183], v[140:143], a[172:175]
  v_mfma_f32_16x16x32_bf16 a[204:207], v[184:187], v[140:143], a[204:207]
  ds_read_b128 v[84:87], v36 offset:10240
  v_mfma_f32_16x16x32_bf16 a[236:239], v[188:191], v[140:143], a[236:239]
  v_mfma_f32_16x16x32_bf16 a[16:19], v[160:163], v[144:147], a[16:19]
  ds_read_b64_tr_b16 v[116:117], v25 offset:0
  v_mfma_f32_16x16x32_bf16 a[48:51], v[164:167], v[144:147], a[48:51]
  buffer_load_dwordx4 v8, s[60:63], s56 offen offset:2048 lds
  v_mfma_f32_16x16x32_bf16 a[80:83], v[168:171], v[144:147], a[80:83]
  ds_read_b64_tr_b16 v[118:119], v25 offset:1024
  v_mfma_f32_16x16x32_bf16 a[112:115], v[172:175], v[144:147], a[112:115]
  v_mfma_f32_16x16x32_bf16 a[144:147], v[176:179], v[144:147], a[144:147]
  ds_read_b128 v[88:91], v36 offset:12288
  v_mfma_f32_16x16x32_bf16 a[176:179], v[180:183], v[144:147], a[176:179]
  v_mfma_f32_16x16x32_bf16 a[208:211], v[184:187], v[144:147], a[208:211]
  ds_read_b64_tr_b16 v[120:121], v26 offset:0
  v_mfma_f32_16x16x32_bf16 a[240:243], v[188:191], v[144:147], a[240:243]
  buffer_load_dwordx4 v9, s[60:63], s56 offen offset:3072 lds
  v_mfma_f32_16x16x32_bf16 a[20:23], v[160:163], v[148:151], a[20:23]
  ds_read_b64_tr_b16 v[122:123], v26 offset:1024
  v_mfma_f32_16x16x32_bf16 a[52:55], v[164:167], v[148:151], a[52:55]
  v_mfma_f32_16x16x32_bf16 a[84:87], v[168:171], v[148:151], a[84:87]
  ds_read_b128 v[92:95], v36 offset:14336
  v_mfma_f32_16x16x32_bf16 a[116:119], v[172:175], v[148:151], a[116:119]
  v_mfma_f32_16x16x32_bf16 a[148:151], v[176:179], v[148:151], a[148:151]
  ds_read_b64_tr_b16 v[124:125], v27 offset:0
  s_add_u32 s56, s48, 66432
  s_add_u32 m0, s49, 73728
  v_mfma_f32_16x16x32_bf16 a[180:183], v[180:183], v[148:151], a[180:183]
  buffer_load_dwordx4 v6, s[60:63], s56 offen offset:0 lds
  v_mfma_f32_16x16x32_bf16 a[212:215], v[184:187], v[148:151], a[212:215]
  ds_read_b64_tr_b16 v[126:127], v27 offset:1024
  v_mfma_f32_16x16x32_bf16 a[244:247], v[188:191], v[148:151], a[244:247]
  v_mfma_f32_16x16x32_bf16 a[24:27], v[160:163], v[152:155], a[24:27]
  v_mfma_f32_16x16x32_bf16 a[56:59], v[164:167], v[152:155], a[56:59]
  buffer_load_dwordx4 v7, s[60:63], s56 offen offset:1024 lds
  v_mfma_f32_16x16x32_bf16 a[88:91], v[168:171], v[152:155], a[88:91]
  v_mfma_f32_16x16x32_bf16 a[120:123], v[172:175], v[152:155], a[120:123]
  v_mfma_f32_16x16x32_bf16 a[152:155], v[176:179], v[152:155], a[152:155]
  v_mfma_f32_16x16x32_bf16 a[184:187], v[180:183], v[152:155], a[184:187]
  v_mfma_f32_16x16x32_bf16 a[216:219], v[184:187], v[152:155], a[216:219]
  buffer_load_dwordx4 v8, s[60:63], s56 offen offset:2048 lds
  v_mfma_f32_16x16x32_bf16 a[248:251], v[188:191], v[152:155], a[248:251]
  v_mfma_f32_16x16x32_bf16 a[28:31], v[160:163], v[156:159], a[28:31]
  v_mfma_f32_16x16x32_bf16 a[60:63], v[164:167], v[156:159], a[60:63]
  v_mfma_f32_16x16x32_bf16 a[92:95], v[168:171], v[156:159], a[92:95]
  v_mfma_f32_16x16x32_bf16 a[124:127], v[172:175], v[156:159], a[124:127]
  v_mfma_f32_16x16x32_bf16 a[156:159], v[176:179], v[156:159], a[156:159]
  buffer_load_dwordx4 v9, s[60:63], s56 offen offset:3072 lds
  v_mfma_f32_16x16x32_bf16 a[188:191], v[180:183], v[156:159], a[188:191]
  v_mfma_f32_16x16x32_bf16 a[220:223], v[184:187], v[156:159], a[220:223]
  v_mfma_f32_16x16x32_bf16 a[252:255], v[188:191], v[156:159], a[252:255]
  s_waitcnt lgkmcnt(0)
  v_mfma_f32_16x16x32_bf16 a[0:3], v[96:99], v[64:67], a[0:3]
  ds_read_b128 v[128:131], v37 offset:0
  s_add_u32 s56, s48, 99200
  s_add_u32 m0, s49, 77824
  v_mfma_f32_16x16x32_bf16 a[32:35], v[100:103], v[64:67], a[32:35]
  buffer_load_dwordx4 v6, s[60:63], s56 offen offset:0 lds
  v_mfma_f32_16x16x32_bf16 a[64:67], v[104:107], v[64:67], a[64:67]
  ds_read_b64_tr_b16 v[160:161], v20 offset:8192
  v_mfma_f32_16x16x32_bf16 a[96:99], v[108:111], v[64:67], a[96:99]
  v_mfma_f32_16x16x32_bf16 a[128:131], v[112:115], v[64:67], a[128:131]
  ds_read_b64_tr_b16 v[162:163], v20 offset:9216
  v_mfma_f32_16x16x32_bf16 a[160:163], v[116:119], v[64:67], a[160:163]
  v_mfma_f32_16x16x32_bf16 a[192:195], v[120:123], v[64:67], a[192:195]
  ds_read_b128 v[132:135], v37 offset:2048
  v_mfma_f32_16x16x32_bf16 a[224:227], v[124:127], v[64:67], a[224:227]
  buffer_load_dwordx4 v7, s[60:63], s56 offen offset:1024 lds
  v_mfma_f32_16x16x32_bf16 a[4:7], v[96:99], v[68:71], a[4:7]
  ds_read_b64_tr_b16 v[164:165], v21 offset:8192
  v_mfma_f32_16x16x32_bf16 a[36:39], v[100:103], v[68:71], a[36:39]
  v_mfma_f32_16x16x32_bf16 a[68:71], v[104:107], v[68:71], a[68:71]
  ds_read_b64_tr_b16 v[166:167], v21 offset:9216
  v_mfma_f32_16x16x32_bf16 a[100:103], v[108:111], v[68:71], a[100:103]
  v_mfma_f32_16x16x32_bf16 a[132:135], v[112:115], v[68:71], a[132:135]
  ds_read_b128 v[136:139], v37 offset:4096
  v_mfma_f32_16x16x32_bf16 a[164:167], v[116:119], v[68:71], a[164:167]
  buffer_load_dwordx4 v8, s[60:63], s56 offen offset:2048 lds
  v_mfma_f32_16x16x32_bf16 a[196:199], v[120:123], v[68:71], a[196:199]
  ds_read_b64_tr_b16 v[168:169], v22 offset:8192
  v_mfma_f32_16x16x32_bf16 a[228:231], v[124:127], v[68:71], a[228:231]
  v_mfma_f32_16x16x32_bf16 a[8:11], v[96:99], v[72:75], a[8:11]
  ds_read_b64_tr_b16 v[170:171], v22 offset:9216
  v_mfma_f32_16x16x32_bf16 a[40:43], v[100:103], v[72:75], a[40:43]
  buffer_load_dwordx4 v9, s[60:63], s56 offen offset:3072 lds
  v_mfma_f32_16x16x32_bf16 a[72:75], v[104:107], v[72:75], a[72:75]
  ds_read_b128 v[140:143], v37 offset:6144
  v_mfma_f32_16x16x32_bf16 a[104:107], v[108:111], v[72:75], a[104:107]
  v_mfma_f32_16x16x32_bf16 a[136:139], v[112:115], v[72:75], a[136:139]
  ds_read_b64_tr_b16 v[172:173], v23 offset:8192
  v_mfma_f32_16x16x32_bf16 a[168:171], v[116:119], v[72:75], a[168:171]
  v_mfma_f32_16x16x32_bf16 a[200:203], v[120:123], v[72:75], a[200:203]
  ds_read_b64_tr_b16 v[174:175], v23 offset:9216
  v_mfma_f32_16x16x32_bf16 a[232:235], v[124:127], v[72:75], a[232:235]
  v_mfma_f32_16x16x32_bf16 a[12:15], v[96:99], v[76:79], a[12:15]
  ds_read_b128 v[144:147], v37 offset:8192
  v_mfma_f32_16x16x32_bf16 a[44:47], v[100:103], v[76:79], a[44:47]
  v_mfma_f32_16x16x32_bf16 a[76:79], v[104:107], v[76:79], a[76:79]
  ds_read_b64_tr_b16 v[176:177], v24 offset:8192
  v_mfma_f32_16x16x32_bf16 a[108:111], v[108:111], v[76:79], a[108:111]
  v_mfma_f32_16x16x32_bf16 a[140:143], v[112:115], v[76:79], a[140:143]
  ds_read_b64_tr_b16 v[178:179], v24 offset:9216
  v_mfma_f32_16x16x32_bf16 a[172:175], v[116:119], v[76:79], a[172:175]
  v_mfma_f32_16x16x32_bf16 a[204:207], v[120:123], v[76:79], a[204:207]
  ds_read_b128 v[148:151], v37 offset:10240
  v_mfma_f32_16x16x32_bf16 a[236:239], v[124:127], v[76:79], a[236:239]
  v_mfma_f32_16x16x32_bf16 a[16:19], v[96:99], v[80:83], a[16:19]
  ds_read_b64_tr_b16 v[180:181], v25 offset:8192
  v_mfma_f32_16x16x32_bf16 a[48:51], v[100:103], v[80:83], a[48:51]
  v_mfma_f32_16x16x32_bf16 a[80:83], v[104:107], v[80:83], a[80:83]
  ds_read_b64_tr_b16 v[182:183], v25 offset:9216
  v_mfma_f32_16x16x32_bf16 a[112:115], v[108:111], v[80:83], a[112:115]
  v_mfma_f32_16x16x32_bf16 a[144:147], v[112:115], v[80:83], a[144:147]
  ds_read_b128 v[152:155], v37 offset:12288
  v_mfma_f32_16x16x32_bf16 a[176:179], v[116:119], v[80:83], a[176:179]
  v_mfma_f32_16x16x32_bf16 a[208:211], v[120:123], v[80:83], a[208:211]
  ds_read_b64_tr_b16 v[184:185], v26 offset:8192
  v_mfma_f32_16x16x32_bf16 a[240:243], v[124:127], v[80:83], a[240:243]
  v_mfma_f32_16x16x32_bf16 a[20:23], v[96:99], v[84:87], a[20:23]
  ds_read_b64_tr_b16 v[186:187], v26 offset:9216
  v_mfma_f32_16x16x32_bf16 a[52:55], v[100:103], v[84:87], a[52:55]
  v_mfma_f32_16x16x32_bf16 a[84:87], v[104:107], v[84:87], a[84:87]
  ds_read_b128 v[156:159], v37 offset:14336
  v_mfma_f32_16x16x32_bf16 a[116:119], v[108:111], v[84:87], a[116:119]
  v_mfma_f32_16x16x32_bf16 a[148:151], v[112:115], v[84:87], a[148:151]
  ds_read_b64_tr_b16 v[188:189], v27 offset:8192
  v_mfma_f32_16x16x32_bf16 a[180:183], v[116:119], v[84:87], a[180:183]
  v_mfma_f32_16x16x32_bf16 a[212:215], v[120:123], v[84:87], a[212:215]
  ds_read_b64_tr_b16 v[190:191], v27 offset:9216
  v_mfma_f32_16x16x32_bf16 a[244:247], v[124:127], v[84:87], a[244:247]
  v_mfma_f32_16x16x32_bf16 a[24:27], v[96:99], v[88:91], a[24:27]
  v_mfma_f32_16x16x32_bf16 a[56:59], v[100:103], v[88:91], a[56:59]
  v_mfma_f32_16x16x32_bf16 a[88:91], v[104:107], v[88:91], a[88:91]
  v_mfma_f32_16x16x32_bf16 a[120:123], v[108:111], v[88:91], a[120:123]
  v_mfma_f32_16x16x32_bf16 a[152:155], v[112:115], v[88:91], a[152:155]
  v_mfma_f32_16x16x32_bf16 a[184:187], v[116:119], v[88:91], a[184:187]
  v_mfma_f32_16x16x32_bf16 a[216:219], v[120:123], v[88:91], a[216:219]
  v_mfma_f32_16x16x32_bf16 a[248:251], v[124:127], v[88:91], a[248:251]
  v_mfma_f32_16x16x32_bf16 a[28:31], v[96:99], v[92:95], a[28:31]
  v_mfma_f32_16x16x32_bf16 a[60:63], v[100:103], v[92:95], a[60:63]
  v_mfma_f32_16x16x32_bf16 a[92:95], v[104:107], v[92:95], a[92:95]
  v_mfma_f32_16x16x32_bf16 a[124:127], v[108:111], v[92:95], a[124:127]
  v_mfma_f32_16x16x32_bf16 a[156:159], v[112:115], v[92:95], a[156:159]
  v_mfma_f32_16x16x32_bf16 a[188:191], v[116:119], v[92:95], a[188:191]
  v_mfma_f32_16x16x32_bf16 a[220:223], v[120:123], v[92:95], a[220:223]
  v_mfma_f32_16x16x32_bf16 a[252:255], v[124:127], v[92:95], a[252:255]
  s_waitcnt vmcnt(0) lgkmcnt(0)
  s_barrier
  v_mfma_f32_16x16x32_bf16 a[0:3], v[160:163], v[128:131], a[0:3]
  ds_read_b128 v[64:67], v38 offset:0
  s_add_u32 s56, s52, 0
  s_add_u32 m0, s53, 0
  v_mfma_f32_16x16x32_bf16 a[32:35], v[164:167], v[128:131], a[32:35]
  buffer_load_dwordx4 v6, s[12:15], s56 offen offset:0 lds
  v_mfma_f32_16x16x32_bf16 a[64:67], v[168:171], v[128:131], a[64:67]
  ds_read_b64_tr_b16 v[96:97], v28 offset:0
  v_mfma_f32_16x16x32_bf16 a[96:99], v[172:175], v[128:131], a[96:99]
  v_mfma_f32_16x16x32_bf16 a[128:131], v[176:179], v[128:131], a[128:131]
  ds_read_b64_tr_b16 v[98:99], v28 offset:1024
  v_mfma_f32_16x16x32_bf16 a[160:163], v[180:183], v[128:131], a[160:163]
  buffer_load_dwordx4 v7, s[12:15], s56 offen offset:1024 lds
  v_mfma_f32_16x16x32_bf16 a[192:195], v[184:187], v[128:131], a[192:195]
  ds_read_b128 v[68:71], v38 offset:2048
  v_mfma_f32_16x16x32_bf16 a[224:227], v[188:191], v[128:131], a[224:227]
  buffer_load_dwordx4 v8, s[12:15], s56 offen offset:2048 lds
  v_mfma_f32_16x16x32_bf16 a[4:7], v[160:163], v[132:135], a[4:7]
  ds_read_b64_tr_b16 v[100:101], v29 offset:0
  v_mfma_f32_16x16x32_bf16 a[36:39], v[164:167], v[132:135], a[36:39]
  v_mfma_f32_16x16x32_bf16 a[68:71], v[168:171], v[132:135], a[68:71]
  ds_read_b64_tr_b16 v[102:103], v29 offset:1024
  v_mfma_f32_16x16x32_bf16 a[100:103], v[172:175], v[132:135], a[100:103]
  buffer_load_dwordx4 v9, s[12:15], s56 offen offset:3072 lds
  v_mfma_f32_16x16x32_bf16 a[132:135], v[176:179], v[132:135], a[132:135]
  ds_read_b128 v[72:75], v38 offset:4096
  v_mfma_f32_16x16x32_bf16 a[164:167], v[180:183], v[132:135], a[164:167]
  v_mfma_f32_16x16x32_bf16 a[196:199], v[184:187], v[132:135], a[196:199]
  ds_read_b64_tr_b16 v[104:105], v30 offset:0
  s_add_u32 s56, s52, 32768
  s_add_u32 m0, s53, 4096
  v_mfma_f32_16x16x32_bf16 a[228:231], v[188:191], v[132:135], a[228:231]
  buffer_load_dwordx4 v6, s[12:15], s56 offen offset:0 lds
  v_mfma_f32_16x16x32_bf16 a[8:11], v[160:163], v[136:139], a[8:11]
  ds_read_b64_tr_b16 v[106:107], v30 offset:1024
  v_mfma_f32_16x16x32_bf16 a[40:43], v[164:167], v[136:139], a[40:43]
  buffer_load_dwordx4 v7, s[12:15], s56 offen offset:1024 lds
  v_mfma_f32_16x16x32_bf16 a[72:75], v[168:171], v[136:139], a[72:75]
  ds_read_b128 v[76:79], v38 offset:6144
  v_mfma_f32_16x16x32_bf16 a[104:107], v[172:175], v[136:139], a[104:107]
  v_mfma_f32_16x16x32_bf16 a[136:139], v[176:179], v[136:139], a[136:139]
  ds_read_b64_tr_b16 v[108:109], v31 offset:0
  v_mfma_f32_16x16x32_bf16 a[168:171], v[180:183], v[136:139], a[168:171]
  buffer_load_dwordx4 v8, s[12:15], s56 offen offset:2048 lds
  v_mfma_f32_16x16x32_bf16 a[200:203], v[184:187], v[136:139], a[200:203]
  ds_read_b64_tr_b16 v[110:111], v31 offset:1024
  v_mfma_f32_16x16x32_bf16 a[232:235], v[188:191], v[136:139], a[232:235]
  buffer_load_dwordx4 v9, s[12:15], s56 offen offset:3072 lds
  v_mfma_f32_16x16x32_bf16 a[12:15], v[160:163], v[140:143], a[12:15]
  ds_read_b128 v[80:83], v38 offset:8192
  v_mfma_f32_16x16x32_bf16 a[44:47], v[164:167], v[140:143], a[44:47]
  v_mfma_f32_16x16x32_bf16 a[76:79], v[168:171], v[140:143], a[76:79]
  ds_read_b64_tr_b16 v[112:113], v32 offset:0
  s_add_u32 s56, s52, 65536
  s_add_u32 m0, s53, 8192
  v_mfma_f32_16x16x32_bf16 a[108:111], v[172:175], v[140:143], a[108:111]
  buffer_load_dwordx4 v6, s[12:15], s56 offen offset:0 lds
  v_mfma_f32_16x16x32_bf16 a[140:143], v[176:179], v[140:143], a[140:143]
  ds_read_b64_tr_b16 v[114:115], v32 offset:1024
  v_mfma_f32_16x16x32_bf16 a[172:175], v[180:183], v[140:143], a[172:175]
  v_mfma_f32_16x16x32_bf16 a[204:207], v[184:187], v[140:143], a[204:207]
  ds_read_b128 v[84:87], v38 offset:10240
  v_mfma_f32_16x16x32_bf16 a[236:239], v[188:191], v[140:143], a[236:239]
  buffer_load_dwordx4 v7, s[12:15], s56 offen offset:1024 lds
  v_mfma_f32_16x16x32_bf16 a[16:19], v[160:163], v[144:147], a[16:19]
  ds_read_b64_tr_b16 v[116:117], v33 offset:0
  v_mfma_f32_16x16x32_bf16 a[48:51], v[164:167], v[144:147], a[48:51]
  buffer_load_dwordx4 v8, s[12:15], s56 offen offset:2048 lds
  v_mfma_f32_16x16x32_bf16 a[80:83], v[168:171], v[144:147], a[80:83]
  ds_read_b64_tr_b16 v[118:119], v33 offset:1024
  v_mfma_f32_16x16x32_bf16 a[112:115], v[172:175], v[144:147], a[112:115]
  v_mfma_f32_16x16x32_bf16 a[144:147], v[176:179], v[144:147], a[144:147]
  ds_read_b128 v[88:91], v38 offset:12288
  v_mfma_f32_16x16x32_bf16 a[176:179], v[180:183], v[144:147], a[176:179]
  buffer_load_dwordx4 v9, s[12:15], s56 offen offset:3072 lds
  v_mfma_f32_16x16x32_bf16 a[208:211], v[184:187], v[144:147], a[208:211]
  ds_read_b64_tr_b16 v[120:121], v34 offset:0
  v_mfma_f32_16x16x32_bf16 a[240:243], v[188:191], v[144:147], a[240:243]
  v_mfma_f32_16x16x32_bf16 a[20:23], v[160:163], v[148:151], a[20:23]
  ds_read_b64_tr_b16 v[122:123], v34 offset:1024
  s_add_u32 s56, s52, 98304
  s_add_u32 m0, s53, 12288
  v_mfma_f32_16x16x32_bf16 a[52:55], v[164:167], v[148:151], a[52:55]
  buffer_load_dwordx4 v6, s[12:15], s56 offen offset:0 lds
  v_mfma_f32_16x16x32_bf16 a[84:87], v[168:171], v[148:151], a[84:87]
  ds_read_b128 v[92:95], v38 offset:14336
  v_mfma_f32_16x16x32_bf16 a[116:119], v[172:175], v[148:151], a[116:119]
  buffer_load_dwordx4 v7, s[12:15], s56 offen offset:1024 lds
  v_mfma_f32_16x16x32_bf16 a[148:151], v[176:179], v[148:151], a[148:151]
  ds_read_b64_tr_b16 v[124:125], v35 offset:0
  v_mfma_f32_16x16x32_bf16 a[180:183], v[180:183], v[148:151], a[180:183]
  v_mfma_f32_16x16x32_bf16 a[212:215], v[184:187], v[148:151], a[212:215]
  ds_read_b64_tr_b16 v[126:127], v35 offset:1024
  v_mfma_f32_16x16x32_bf16 a[244:247], v[188:191], v[148:151], a[244:247]
  buffer_load_dwordx4 v8, s[12:15], s56 offen offset:2048 lds
  v_mfma_f32_16x16x32_bf16 a[24:27], v[160:163], v[152:155], a[24:27]
  v_mfma_f32_16x16x32_bf16 a[56:59], v[164:167], v[152:155], a[56:59]
  buffer_load_dwordx4 v9, s[12:15], s56 offen offset:3072 lds
  v_mfma_f32_16x16x32_bf16 a[88:91], v[168:171], v[152:155], a[88:91]
  v_mfma_f32_16x16x32_bf16 a[120:123], v[172:175], v[152:155], a[120:123]
  v_mfma_f32_16x16x32_bf16 a[152:155], v[176:179], v[152:155], a[152:155]
  s_add_u32 s56, s54, 0
  s_add_u32 m0, s55, 32768
  v_mfma_f32_16x16x32_bf16 a[184:187], v[180:183], v[152:155], a[184:187]
  buffer_load_dwordx4 v10, s[68:71], s56 offen offset:0 lds
  v_mfma_f32_16x16x32_bf16 a[216:219], v[184:187], v[152:155], a[216:219]
  v_mfma_f32_16x16x32_bf16 a[248:251], v[188:191], v[152:155], a[248:251]
  v_mfma_f32_16x16x32_bf16 a[28:31], v[160:163], v[156:159], a[28:31]
  buffer_load_dwordx4 v11, s[68:71], s56 offen offset:1024 lds
  v_mfma_f32_16x16x32_bf16 a[60:63], v[164:167], v[156:159], a[60:63]
  v_mfma_f32_16x16x32_bf16 a[92:95], v[168:171], v[156:159], a[92:95]
  v_mfma_f32_16x16x32_bf16 a[124:127], v[172:175], v[156:159], a[124:127]
  buffer_load_dwordx4 v12, s[68:71], s56 offen offset:2048 lds
  v_mfma_f32_16x16x32_bf16 a[156:159], v[176:179], v[156:159], a[156:159]
  v_mfma_f32_16x16x32_bf16 a[188:191], v[180:183], v[156:159], a[188:191]
  v_mfma_f32_16x16x32_bf16 a[220:223], v[184:187], v[156:159], a[220:223]
  buffer_load_dwordx4 v13, s[68:71], s56 offen offset:3072 lds
  v_mfma_f32_16x16x32_bf16 a[252:255], v[188:191], v[156:159], a[252:255]
  s_waitcnt lgkmcnt(0)
  v_mfma_f32_16x16x32_bf16 a[0:3], v[96:99], v[64:67], a[0:3]
  ds_read_b128 v[128:131], v39 offset:0
  v_mfma_f32_16x16x32_bf16 a[32:35], v[100:103], v[64:67], a[32:35]
  v_mfma_f32_16x16x32_bf16 a[64:67], v[104:107], v[64:67], a[64:67]
  ds_read_b64_tr_b16 v[160:161], v28 offset:8192
  s_add_u32 s56, s54, 131072
  s_add_u32 m0, s55, 36864
  v_mfma_f32_16x16x32_bf16 a[96:99], v[108:111], v[64:67], a[96:99]
  buffer_load_dwordx4 v10, s[68:71], s56 offen offset:0 lds
  v_mfma_f32_16x16x32_bf16 a[128:131], v[112:115], v[64:67], a[128:131]
  ds_read_b64_tr_b16 v[162:163], v28 offset:9216
  v_mfma_f32_16x16x32_bf16 a[160:163], v[116:119], v[64:67], a[160:163]
  buffer_load_dwordx4 v11, s[68:71], s56 offen offset:1024 lds
  v_mfma_f32_16x16x32_bf16 a[192:195], v[120:123], v[64:67], a[192:195]
  ds_read_b128 v[132:135], v39 offset:2048
  v_mfma_f32_16x16x32_bf16 a[224:227], v[124:127], v[64:67], a[224:227]
  v_mfma_f32_16x16x32_bf16 a[4:7], v[96:99], v[68:71], a[4:7]
  ds_read_b64_tr_b16 v[164:165], v29 offset:8192
  v_mfma_f32_16x16x32_bf16 a[36:39], v[100:103], v[68:71], a[36:39]
  buffer_load_dwordx4 v12, s[68:71], s56 offen offset:2048 lds
  v_mfma_f32_16x16x32_bf16 a[68:71], v[104:107], v[68:71], a[68:71]
  ds_read_b64_tr_b16 v[166:167], v29 offset:9216
  v_mfma_f32_16x16x32_bf16 a[100:103], v[108:111], v[68:71], a[100:103]
  buffer_load_dwordx4 v13, s[68:71], s56 offen offset:3072 lds
  v_mfma_f32_16x16x32_bf16 a[132:135], v[112:115], v[68:71], a[132:135]
  ds_read_b128 v[136:139], v39 offset:4096
  v_mfma_f32_16x16x32_bf16 a[164:167], v[116:119], v[68:71], a[164:167]
  v_mfma_f32_16x16x32_bf16 a[196:199], v[120:123], v[68:71], a[196:199]
  ds_read_b64_tr_b16 v[168:169], v30 offset:8192
  v_mfma_f32_16x16x32_bf16 a[228:231], v[124:127], v[68:71], a[228:231]
  v_mfma_f32_16x16x32_bf16 a[8:11], v[96:99], v[72:75], a[8:11]
  ds_read_b64_tr_b16 v[170:171], v30 offset:9216
  s_add_u32 s56, s52, 128
  s_add_u32 m0, s53, 131072
  v_mfma_f32_16x16x32_bf16 a[40:43], v[100:103], v[72:75], a[40:43]
  buffer_load_dwordx4 v6, s[12:15], s56 offen offset:0 lds
  v_mfma_f32_16x16x32_bf16 a[72:75], v[104:107], v[72:75], a[72:75]
  ds_read_b128 v[140:143], v39 offset:6144
  v_mfma_f32_16x16x32_bf16 a[104:107], v[108:111], v[72:75], a[104:107]
  buffer_load_dwordx4 v7, s[12:15], s56 offen offset:1024 lds
  v_mfma_f32_16x16x32_bf16 a[136:139], v[112:115], v[72:75], a[136:139]
  ds_read_b64_tr_b16 v[172:173], v31 offset:8192
  v_mfma_f32_16x16x32_bf16 a[168:171], v[116:119], v[72:75], a[168:171]
  v_mfma_f32_16x16x32_bf16 a[200:203], v[120:123], v[72:75], a[200:203]
  ds_read_b64_tr_b16 v[174:175], v31 offset:9216
  v_mfma_f32_16x16x32_bf16 a[232:235], v[124:127], v[72:75], a[232:235]
  buffer_load_dwordx4 v8, s[12:15], s56 offen offset:2048 lds
  v_mfma_f32_16x16x32_bf16 a[12:15], v[96:99], v[76:79], a[12:15]
  ds_read_b128 v[144:147], v39 offset:8192
  v_mfma_f32_16x16x32_bf16 a[44:47], v[100:103], v[76:79], a[44:47]
  buffer_load_dwordx4 v9, s[12:15], s56 offen offset:3072 lds
  v_mfma_f32_16x16x32_bf16 a[76:79], v[104:107], v[76:79], a[76:79]
  ds_read_b64_tr_b16 v[176:177], v32 offset:8192
  v_mfma_f32_16x16x32_bf16 a[108:111], v[108:111], v[76:79], a[108:111]
  v_mfma_f32_16x16x32_bf16 a[140:143], v[112:115], v[76:79], a[140:143]
  ds_read_b64_tr_b16 v[178:179], v32 offset:9216
  s_add_u32 s56, s52, 32896
  s_add_u32 m0, s53, 135168
  v_mfma_f32_16x16x32_bf16 a[172:175], v[116:119], v[76:79], a[172:175]
  buffer_load_dwordx4 v6, s[12:15], s56 offen offset:0 lds
  v_mfma_f32_16x16x32_bf16 a[204:207], v[120:123], v[76:79], a[204:207]
  ds_read_b128 v[148:151], v39 offset:10240
  v_mfma_f32_16x16x32_bf16 a[236:239], v[124:127], v[76:79], a[236:239]
  buffer_load_dwordx4 v7, s[12:15], s56 offen offset:1024 lds
  v_mfma_f32_16x16x32_bf16 a[16:19], v[96:99], v[80:83], a[16:19]
  ds_read_b64_tr_b16 v[180:181], v33 offset:8192
  v_mfma_f32_16x16x32_bf16 a[48:51], v[100:103], v[80:83], a[48:51]
  v_mfma_f32_16x16x32_bf16 a[80:83], v[104:107], v[80:83], a[80:83]
  ds_read_b64_tr_b16 v[182:183], v33 offset:9216
  v_mfma_f32_16x16x32_bf16 a[112:115], v[108:111], v[80:83], a[112:115]
  buffer_load_dwordx4 v8, s[12:15], s56 offen offset:2048 lds
  v_mfma_f32_16x16x32_bf16 a[144:147], v[112:115], v[80:83], a[144:147]
  ds_read_b128 v[152:155], v39 offset:12288
  v_mfma_f32_16x16x32_bf16 a[176:179], v[116:119], v[80:83], a[176:179]
  buffer_load_dwordx4 v9, s[12:15], s56 offen offset:3072 lds
  v_mfma_f32_16x16x32_bf16 a[208:211], v[120:123], v[80:83], a[208:211]
  ds_read_b64_tr_b16 v[184:185], v34 offset:8192
  v_mfma_f32_16x16x32_bf16 a[240:243], v[124:127], v[80:83], a[240:243]
  v_mfma_f32_16x16x32_bf16 a[20:23], v[96:99], v[84:87], a[20:23]
  ds_read_b64_tr_b16 v[186:187], v34 offset:9216
  s_add_u32 s56, s52, 65664
  s_add_u32 m0, s53, 139264
  v_mfma_f32_16x16x32_bf16 a[52:55], v[100:103], v[84:87], a[52:55]
  buffer_load_dwordx4 v6, s[12:15], s56 offen offset:0 lds
  v_mfma_f32_16x16x32_bf16 a[84:87], v[104:107], v[84:87], a[84:87]
  ds_read_b128 v[156:159], v39 offset:14336
  v_mfma_f32_16x16x32_bf16 a[116:119], v[108:111], v[84:87], a[116:119]
  buffer_load_dwordx4 v7, s[12:15], s56 offen offset:1024 lds
  v_mfma_f32_16x16x32_bf16 a[148:151], v[112:115], v[84:87], a[148:151]
  ds_read_b64_tr_b16 v[188:189], v35 offset:8192
  v_mfma_f32_16x16x32_bf16 a[180:183], v[116:119], v[84:87], a[180:183]
  v_mfma_f32_16x16x32_bf16 a[212:215], v[120:123], v[84:87], a[212:215]
  ds_read_b64_tr_b16 v[190:191], v35 offset:9216
  v_mfma_f32_16x16x32_bf16 a[244:247], v[124:127], v[84:87], a[244:247]
  buffer_load_dwordx4 v8, s[12:15], s56 offen offset:2048 lds
  v_mfma_f32_16x16x32_bf16 a[24:27], v[96:99], v[88:91], a[24:27]
  v_mfma_f32_16x16x32_bf16 a[56:59], v[100:103], v[88:91], a[56:59]
  buffer_load_dwordx4 v9, s[12:15], s56 offen offset:3072 lds
  v_mfma_f32_16x16x32_bf16 a[88:91], v[104:107], v[88:91], a[88:91]
  v_mfma_f32_16x16x32_bf16 a[120:123], v[108:111], v[88:91], a[120:123]
  s_add_u32 s56, s52, 98432
  s_add_u32 m0, s53, 143360
  v_mfma_f32_16x16x32_bf16 a[152:155], v[112:115], v[88:91], a[152:155]
  buffer_load_dwordx4 v6, s[12:15], s56 offen offset:0 lds
  v_mfma_f32_16x16x32_bf16 a[184:187], v[116:119], v[88:91], a[184:187]
  v_mfma_f32_16x16x32_bf16 a[216:219], v[120:123], v[88:91], a[216:219]
  buffer_load_dwordx4 v7, s[12:15], s56 offen offset:1024 lds
  v_mfma_f32_16x16x32_bf16 a[248:251], v[124:127], v[88:91], a[248:251]
  v_mfma_f32_16x16x32_bf16 a[28:31], v[96:99], v[92:95], a[28:31]
  v_mfma_f32_16x16x32_bf16 a[60:63], v[100:103], v[92:95], a[60:63]
  buffer_load_dwordx4 v8, s[12:15], s56 offen offset:2048 lds
  v_mfma_f32_16x16x32_bf16 a[92:95], v[104:107], v[92:95], a[92:95]
  v_mfma_f32_16x16x32_bf16 a[124:127], v[108:111], v[92:95], a[124:127]
  v_mfma_f32_16x16x32_bf16 a[156:159], v[112:115], v[92:95], a[156:159]
  buffer_load_dwordx4 v9, s[12:15], s56 offen offset:3072 lds
  v_mfma_f32_16x16x32_bf16 a[188:191], v[116:119], v[92:95], a[188:191]
  v_mfma_f32_16x16x32_bf16 a[220:223], v[120:123], v[92:95], a[220:223]
  s_add_u32 s56, s54, 524288
  s_add_u32 m0, s55, 49152
  v_mfma_f32_16x16x32_bf16 a[252:255], v[124:127], v[92:95], a[252:255]
  buffer_load_dwordx4 v10, s[68:71], s56 offen offset:0 lds
  s_waitcnt vmcnt(17) lgkmcnt(0)
  s_barrier
  v_mfma_f32_16x16x32_bf16 a[0:3], v[160:163], v[128:131], a[0:3]
  v_mfma_f32_16x16x32_bf16 a[32:35], v[164:167], v[128:131], a[32:35]
  v_mfma_f32_16x16x32_bf16 a[64:67], v[168:171], v[128:131], a[64:67]
  buffer_load_dwordx4 v11, s[68:71], s56 offen offset:1024 lds
  v_mfma_f32_16x16x32_bf16 a[96:99], v[172:175], v[128:131], a[96:99]
  v_mfma_f32_16x16x32_bf16 a[128:131], v[176:179], v[128:131], a[128:131]
  v_mfma_f32_16x16x32_bf16 a[160:163], v[180:183], v[128:131], a[160:163]
  buffer_load_dwordx4 v12, s[68:71], s56 offen offset:2048 lds
  v_mfma_f32_16x16x32_bf16 a[192:195], v[184:187], v[128:131], a[192:195]
  v_mfma_f32_16x16x32_bf16 a[224:227], v[188:191], v[128:131], a[224:227]
  v_mfma_f32_16x16x32_bf16 a[4:7], v[160:163], v[132:135], a[4:7]
  buffer_load_dwordx4 v13, s[68:71], s56 offen offset:3072 lds
  v_mfma_f32_16x16x32_bf16 a[36:39], v[164:167], v[132:135], a[36:39]
  v_mfma_f32_16x16x32_bf16 a[68:71], v[168:171], v[132:135], a[68:71]
  s_add_u32 s56, s54, 655360
  s_add_u32 m0, s55, 53248
  v_mfma_f32_16x16x32_bf16 a[100:103], v[172:175], v[132:135], a[100:103]
  buffer_load_dwordx4 v10, s[68:71], s56 offen offset:0 lds
  v_mfma_f32_16x16x32_bf16 a[132:135], v[176:179], v[132:135], a[132:135]
  v_mfma_f32_16x16x32_bf16 a[164:167], v[180:183], v[132:135], a[164:167]
  v_mfma_f32_16x16x32_bf16 a[196:199], v[184:187], v[132:135], a[196:199]
  buffer_load_dwordx4 v11, s[68:71], s56 offen offset:1024 lds
  v_mfma_f32_16x16x32_bf16 a[228:231], v[188:191], v[132:135], a[228:231]
  v_mfma_f32_16x16x32_bf16 a[8:11], v[160:163], v[136:139], a[8:11]
  v_mfma_f32_16x16x32_bf16 a[40:43], v[164:167], v[136:139], a[40:43]
  buffer_load_dwordx4 v12, s[68:71], s56 offen offset:2048 lds
  v_mfma_f32_16x16x32_bf16 a[72:75], v[168:171], v[136:139], a[72:75]
  v_mfma_f32_16x16x32_bf16 a[104:107], v[172:175], v[136:139], a[104:107]
  v_mfma_f32_16x16x32_bf16 a[136:139], v[176:179], v[136:139], a[136:139]
  buffer_load_dwordx4 v13, s[68:71], s56 offen offset:3072 lds
  v_mfma_f32_16x16x32_bf16 a[168:171], v[180:183], v[136:139], a[168:171]
  v_mfma_f32_16x16x32_bf16 a[200:203], v[184:187], v[136:139], a[200:203]
  v_mfma_f32_16x16x32_bf16 a[232:235], v[188:191], v[136:139], a[232:235]
  v_mfma_f32_16x16x32_bf16 a[12:15], v[160:163], v[140:143], a[12:15]
  v_mfma_f32_16x16x32_bf16 a[44:47], v[164:167], v[140:143], a[44:47]
  v_mfma_f32_16x16x32_bf16 a[76:79], v[168:171], v[140:143], a[76:79]
  v_mfma_f32_16x16x32_bf16 a[108:111], v[172:175], v[140:143], a[108:111]
  v_mfma_f32_16x16x32_bf16 a[140:143], v[176:179], v[140:143], a[140:143]
  v_mfma_f32_16x16x32_bf16 a[172:175], v[180:183], v[140:143], a[172:175]
  v_mfma_f32_16x16x32_bf16 a[204:207], v[184:187], v[140:143], a[204:207]
  v_mfma_f32_16x16x32_bf16 a[236:239], v[188:191], v[140:143], a[236:239]
  v_mfma_f32_16x16x32_bf16 a[16:19], v[160:163], v[144:147], a[16:19]
  v_mfma_f32_16x16x32_bf16 a[48:51], v[164:167], v[144:147], a[48:51]
  v_mfma_f32_16x16x32_bf16 a[80:83], v[168:171], v[144:147], a[80:83]
  v_mfma_f32_16x16x32_bf16 a[112:115], v[172:175], v[144:147], a[112:115]
  v_mfma_f32_16x16x32_bf16 a[144:147], v[176:179], v[144:147], a[144:147]
  v_mfma_f32_16x16x32_bf16 a[176:179], v[180:183], v[144:147], a[176:179]
  v_mfma_f32_16x16x32_bf16 a[208:211], v[184:187], v[144:147], a[208:211]
  v_mfma_f32_16x16x32_bf16 a[240:243], v[188:191], v[144:147], a[240:243]
  v_mfma_f32_16x16x32_bf16 a[20:23], v[160:163], v[148:151], a[20:23]
  v_mfma_f32_16x16x32_bf16 a[52:55], v[164:167], v[148:151], a[52:55]
  v_mfma_f32_16x16x32_bf16 a[84:87], v[168:171], v[148:151], a[84:87]
  v_mfma_f32_16x16x32_bf16 a[116:119], v[172:175], v[148:151], a[116:119]
  v_mfma_f32_16x16x32_bf16 a[148:151], v[176:179], v[148:151], a[148:151]
  v_mfma_f32_16x16x32_bf16 a[180:183], v[180:183], v[148:151], a[180:183]
  v_mfma_f32_16x16x32_bf16 a[212:215], v[184:187], v[148:151], a[212:215]
  v_mfma_f32_16x16x32_bf16 a[244:247], v[188:191], v[148:151], a[244:247]
  v_mfma_f32_16x16x32_bf16 a[24:27], v[160:163], v[152:155], a[24:27]
  v_mfma_f32_16x16x32_bf16 a[56:59], v[164:167], v[152:155], a[56:59]
  v_mfma_f32_16x16x32_bf16 a[88:91], v[168:171], v[152:155], a[88:91]
  v_mfma_f32_16x16x32_bf16 a[120:123], v[172:175], v[152:155], a[120:123]
  v_mfma_f32_16x16x32_bf16 a[152:155], v[176:179], v[152:155], a[152:155]
  v_mfma_f32_16x16x32_bf16 a[184:187], v[180:183], v[152:155], a[184:187]
  v_mfma_f32_16x16x32_bf16 a[216:219], v[184:187], v[152:155], a[216:219]
  v_mfma_f32_16x16x32_bf16 a[248:251], v[188:191], v[152:155], a[248:251]
  v_mfma_f32_16x16x32_bf16 a[28:31], v[160:163], v[156:159], a[28:31]
  v_mfma_f32_16x16x32_bf16 a[60:63], v[164:167], v[156:159], a[60:63]
  v_mfma_f32_16x16x32_bf16 a[92:95], v[168:171], v[156:159], a[92:95]
  v_mfma_f32_16x16x32_bf16 a[124:127], v[172:175], v[156:159], a[124:127]
  v_mfma_f32_16x16x32_bf16 a[156:159], v[176:179], v[156:159], a[156:159]
  v_mfma_f32_16x16x32_bf16 a[188:191], v[180:183], v[156:159], a[188:191]
  v_mfma_f32_16x16x32_bf16 a[220:223], v[184:187], v[156:159], a[220:223]
  v_mfma_f32_16x16x32_bf16 a[252:255], v[188:191], v[156:159], a[252:255]
  s_lshl_b32 s39, s5, 12
  v_add_u32 v56, s39, v3
  v_xor_b32 v20, 0, v56
  v_xor_b32 v21, 32, v56
  v_xor_b32 v22, 64, v56
  v_xor_b32 v23, 96, v56
  v_xor_b32 v24, 0, v56
  v_add_u32 v24, 131072, v24
  v_xor_b32 v25, 32, v56
  v_add_u32 v25, 131072, v25
  v_xor_b32 v26, 64, v56
  v_add_u32 v26, 131072, v26
  v_xor_b32 v27, 96, v56
  v_add_u32 v27, 131072, v27
  v_xor_b32 v28, 0, v56
  v_add_u32 v28, 65536, v28
  v_xor_b32 v29, 32, v56
  v_add_u32 v29, 65536, v29
  v_xor_b32 v30, 64, v56
  v_add_u32 v30, 65536, v30
  v_xor_b32 v31, 96, v56
  v_add_u32 v31, 65536, v31
  v_xor_b32 v32, 0, v4
  v_add_u32 v32, 32768, v32
  v_xor_b32 v33, 64, v4
  v_add_u32 v33, 32768, v33
  v_xor_b32 v34, 128, v4
  v_add_u32 v34, 32768, v34
  v_xor_b32 v35, 192, v4
  v_add_u32 v35, 32768, v35
  v_xor_b32 v36, 0, v4
  v_add_u32 v36, 49152, v36
  v_xor_b32 v37, 64, v4
  v_add_u32 v37, 49152, v37
  v_xor_b32 v38, 128, v4
  v_add_u32 v38, 49152, v38
  v_xor_b32 v39, 192, v4
  v_add_u32 v39, 49152, v39
  v_xor_b32 v40, 0, v4
  v_add_u32 v40, 98304, v40
  v_xor_b32 v41, 64, v4
  v_add_u32 v41, 98304, v41
  v_xor_b32 v42, 128, v4
  v_add_u32 v42, 98304, v42
  v_xor_b32 v43, 192, v4
  v_add_u32 v43, 98304, v43
  ds_read_b64_tr_b16 v[64:65], v32 offset:0
  ds_read_b64_tr_b16 v[66:67], v32 offset:1024
  ds_read_b64_tr_b16 v[68:69], v33 offset:0
  ds_read_b64_tr_b16 v[70:71], v33 offset:1024
  ds_read_b64_tr_b16 v[72:73], v34 offset:0
  ds_read_b64_tr_b16 v[74:75], v34 offset:1024
  ds_read_b64_tr_b16 v[76:77], v35 offset:0
  ds_read_b64_tr_b16 v[78:79], v35 offset:1024
  ds_read_b128 v[80:83], v20 offset:0
  ds_read_b128 v[84:87], v20 offset:16384
  s_mov_b32 s36, 0x3e0293ee
  s_waitcnt lgkmcnt(0)
  v_mfma_f32_32x32x16_bf16 v[128:143], v[64:67], v[80:83], 0
  ds_read_b64_tr_b16 v[88:89], v32 offset:4096
  ds_read_b64_tr_b16 v[90:91], v32 offset:5120
  v_mfma_f32_32x32x16_bf16 v[192:207], v[64:67], v[84:87], 0
  ds_read_b64_tr_b16 v[92:93], v33 offset:4096
  s_getpc_b64 s[62:63]
F_pc2:
  s_sub_u32 s62, s62, F_pc2-gated_mix__compressed_kv_cla__moe_arch_mod__prompt_kernel
  s_subb_u32 s63, s63, 0
  s_lshr_b32 s56, s2, 3
  s_lshl_b32 s56, s56, 1
  s_add_u32 s56, s56, s76
  s_lshl_b32 s56, s56, 6
  v_add_u32 v57, s56, v1
  v_lshlrev_b32 v57, 7, v57
  v_min_u32 v57, K2_rare_C-gated_mix__compressed_kv_cla__moe_arch_mod__prompt_kernel-4, v57
  global_load_dword v15, v57, s[62:63]
  v_mfma_f32_32x32x16_bf16 v[144:159], v[68:71], v[80:83], 0
  ds_read_b64_tr_b16 v[94:95], v33 offset:5120
  v_accvgpr_read_b32 v44, a0
  v_accvgpr_read_b32 v45, a1
  v_accvgpr_read_b32 v46, a2
  v_accvgpr_read_b32 v47, a3
  v_accvgpr_read_b32 v48, a32
  v_mfma_f32_32x32x16_bf16 v[208:223], v[68:71], v[84:87], 0
  ds_read_b64_tr_b16 v[96:97], v34 offset:4096
  v_accvgpr_read_b32 v49, a33
  v_accvgpr_read_b32 v50, a34
  v_accvgpr_read_b32 v51, a35
  v_mul_f32 v44, s36, v44
  v_mul_f32 v45, s36, v45
  v_mfma_f32_32x32x16_bf16 v[160:175], v[72:75], v[80:83], 0
  ds_read_b64_tr_b16 v[98:99], v34 offset:5120
  ds_read_b64_tr_b16 v[100:101], v35 offset:4096
  v_mul_f32 v46, s36, v46
  v_mul_f32 v47, s36, v47
  v_mul_f32 v48, s36, v48
  v_mul_f32 v49, s36, v49
  v_mul_f32 v50, s36, v50
  v_mfma_f32_32x32x16_bf16 v[224:239], v[72:75], v[84:87], 0
  ds_read_b64_tr_b16 v[102:103], v35 offset:5120
  v_mul_f32 v51, s36, v51
  v_cvt_pk_bf16_f32 v52, v44, v45
  v_cvt_pk_bf16_f32 v53, v46, v47
  v_cvt_pk_bf16_f32 v54, v48, v49
  v_cvt_pk_bf16_f32 v55, v50, v51
  v_mfma_f32_32x32x16_bf16 v[176:191], v[76:79], v[80:83], 0
  ds_read_b128 v[104:107], v21 offset:0
  s_add_u32 s38, s57, 0
  buffer_store_dwordx4 v[52:55], v2, s[8:11], s38 offen sc1
  v_accvgpr_write_b32 a0, v52
  v_accvgpr_write_b32 a1, v53
  v_mfma_f32_32x32x16_bf16 v[240:255], v[76:79], v[84:87], 0
  ds_read_b128 v[108:111], v21 offset:16384
  v_accvgpr_write_b32 a2, v54
  v_accvgpr_write_b32 a3, v55
  v_accvgpr_read_b32 v112, a64
  v_accvgpr_read_b32 v113, a65
  s_waitcnt lgkmcnt(0)
  v_mfma_f32_32x32x16_bf16 v[128:143], v[88:91], v[104:107], v[128:143]
  ds_read_b64_tr_b16 v[64:65], v32 offset:8192
  ds_read_b64_tr_b16 v[66:67], v32 offset:9216
  v_accvgpr_read_b32 v114, a66
  v_accvgpr_read_b32 v115, a67
  v_accvgpr_read_b32 v116, a96
  v_accvgpr_read_b32 v117, a97
  v_mfma_f32_32x32x16_bf16 v[192:207], v[88:91], v[108:111], v[192:207]
  ds_read_b64_tr_b16 v[68:69], v33 offset:8192
  v_accvgpr_read_b32 v118, a98
  v_accvgpr_read_b32 v119, a99
  v_mul_f32 v112, s36, v112
  v_mul_f32 v113, s36, v113
  v_mul_f32 v114, s36, v114
  v_mfma_f32_32x32x16_bf16 v[144:159], v[92:95], v[104:107], v[144:159]
  ds_read_b64_tr_b16 v[70:71], v33 offset:9216
  v_mul_f32 v115, s36, v115
  v_mul_f32 v116, s36, v116
  v_mul_f32 v117, s36, v117
  v_mul_f32 v118, s36, v118
  v_mul_f32 v119, s36, v119
  v_cvt_pk_bf16_f32 v120, v112, v113
  v_mfma_f32_32x32x16_bf16 v[208:223], v[92:95], v[108:111], v[208:223]
  ds_read_b64_tr_b16 v[72:73], v34 offset:8192
  v_cvt_pk_bf16_f32 v121, v114, v115
  v_cvt_pk_bf16_f32 v122, v116, v117
  v_cvt_pk_bf16_f32 v123, v118, v119
  s_add_u32 s38, s57, 1024
  v_mfma_f32_32x32x16_bf16 v[160:175], v[96:99], v[104:107], v[160:175]
  ds_read_b64_tr_b16 v[74:75], v34 offset:9216
  ds_read_b64_tr_b16 v[76:77], v35 offset:8192
  buffer_store_dwordx4 v[120:123], v2, s[8:11], s38 offen sc1
  v_accvgpr_write_b32 a64, v120
  v_accvgpr_write_b32 a65, v121
  v_accvgpr_write_b32 a66, v122
  v_mfma_f32_32x32x16_bf16 v[224:239], v[96:99], v[108:111], v[224:239]
  ds_read_b64_tr_b16 v[78:79], v35 offset:9216
  v_accvgpr_write_b32 a67, v123
  v_accvgpr_read_b32 v44, a128
  v_accvgpr_read_b32 v45, a129
  v_accvgpr_read_b32 v46, a130
  v_accvgpr_read_b32 v47, a131
  v_mfma_f32_32x32x16_bf16 v[176:191], v[100:103], v[104:107], v[176:191]
  ds_read_b128 v[80:83], v22 offset:0
  v_accvgpr_read_b32 v48, a160
  v_accvgpr_read_b32 v49, a161
  v_accvgpr_read_b32 v50, a162
  v_accvgpr_read_b32 v51, a163
  v_mfma_f32_32x32x16_bf16 v[240:255], v[100:103], v[108:111], v[240:255]
  ds_read_b128 v[84:87], v22 offset:16384
  v_mul_f32 v44, s36, v44
  v_mul_f32 v45, s36, v45
  v_mul_f32 v46, s36, v46
  v_mul_f32 v47, s36, v47
  v_mul_f32 v48, s36, v48
  s_waitcnt lgkmcnt(0)
  v_mfma_f32_32x32x16_bf16 v[128:143], v[64:67], v[80:83], v[128:143]
  ds_read_b64_tr_b16 v[88:89], v32 offset:12288
  ds_read_b64_tr_b16 v[90:91], v32 offset:13312
  v_mul_f32 v49, s36, v49
  v_mul_f32 v50, s36, v50
  v_mul_f32 v51, s36, v51
  v_cvt_pk_bf16_f32 v52, v44, v45
  v_cvt_pk_bf16_f32 v53, v46, v47
  v_mfma_f32_32x32x16_bf16 v[192:207], v[64:67], v[84:87], v[192:207]
  ds_read_b64_tr_b16 v[92:93], v33 offset:12288
  v_cvt_pk_bf16_f32 v54, v48, v49
  v_cvt_pk_bf16_f32 v55, v50, v51
  s_add_u32 s38, s57, 2048
  buffer_store_dwordx4 v[52:55], v2, s[8:11], s38 offen sc1
  v_mfma_f32_32x32x16_bf16 v[144:159], v[68:71], v[80:83], v[144:159]
  ds_read_b64_tr_b16 v[94:95], v33 offset:13312
  v_accvgpr_write_b32 a128, v52
  v_accvgpr_write_b32 a129, v53
  v_accvgpr_write_b32 a130, v54
  v_accvgpr_write_b32 a131, v55
  v_mfma_f32_32x32x16_bf16 v[208:223], v[68:71], v[84:87], v[208:223]
  ds_read_b64_tr_b16 v[96:97], v34 offset:12288
  v_accvgpr_read_b32 v112, a192
  v_accvgpr_read_b32 v113, a193
  v_accvgpr_read_b32 v114, a194
  v_accvgpr_read_b32 v115, a195
  v_accvgpr_read_b32 v116, a224
  v_mfma_f32_32x32x16_bf16 v[160:175], v[72:75], v[80:83], v[160:175]
  ds_read_b64_tr_b16 v[98:99], v34 offset:13312
  ds_read_b64_tr_b16 v[100:101], v35 offset:12288
  v_accvgpr_read_b32 v117, a225
  v_accvgpr_read_b32 v118, a226
  v_accvgpr_read_b32 v119, a227
  v_mul_f32 v112, s36, v112
  v_mul_f32 v113, s36, v113
  v_mfma_f32_32x32x16_bf16 v[224:239], v[72:75], v[84:87], v[224:239]
  ds_read_b64_tr_b16 v[102:103], v35 offset:13312
  v_mul_f32 v114, s36, v114
  v_mul_f32 v115, s36, v115
  v_mul_f32 v116, s36, v116
  v_mul_f32 v117, s36, v117
  v_mul_f32 v118, s36, v118
  v_mul_f32 v119, s36, v119
  v_mfma_f32_32x32x16_bf16 v[176:191], v[76:79], v[80:83], v[176:191]
  ds_read_b128 v[104:107], v23 offset:0
  v_cvt_pk_bf16_f32 v120, v112, v113
  v_cvt_pk_bf16_f32 v121, v114, v115
  v_cvt_pk_bf16_f32 v122, v116, v117
  v_cvt_pk_bf16_f32 v123, v118, v119
  s_add_u32 s38, s57, 3072
  v_mfma_f32_32x32x16_bf16 v[240:255], v[76:79], v[84:87], v[240:255]
  ds_read_b128 v[108:111], v23 offset:16384
  buffer_store_dwordx4 v[120:123], v2, s[8:11], s38 offen sc1
  v_accvgpr_write_b32 a192, v120
  s_waitcnt vmcnt(5) lgkmcnt(0)
  s_barrier
  v_mfma_f32_32x32x16_bf16 v[128:143], v[88:91], v[104:107], v[128:143]
  ds_read_b64_tr_b16 v[64:65], v36 offset:0
  ds_read_b64_tr_b16 v[66:67], v36 offset:1024
  v_accvgpr_write_b32 a193, v121
  v_accvgpr_write_b32 a194, v122
  v_accvgpr_write_b32 a195, v123
  v_accvgpr_read_b32 v44, a4
  v_mfma_f32_32x32x16_bf16 v[192:207], v[88:91], v[108:111], v[192:207]
  ds_read_b64_tr_b16 v[68:69], v37 offset:0
  v_accvgpr_read_b32 v45, a5
  v_accvgpr_read_b32 v46, a6
  v_accvgpr_read_b32 v47, a7
  v_accvgpr_read_b32 v48, a36
  v_mfma_f32_32x32x16_bf16 v[144:159], v[92:95], v[104:107], v[144:159]
  ds_read_b64_tr_b16 v[70:71], v37 offset:1024
  v_accvgpr_read_b32 v49, a37
  v_accvgpr_read_b32 v50, a38
  v_accvgpr_read_b32 v51, a39
  v_mul_f32 v44, s36, v44
  v_mul_f32 v45, s36, v45
  v_mul_f32 v46, s36, v46
  v_mfma_f32_32x32x16_bf16 v[208:223], v[92:95], v[108:111], v[208:223]
  ds_read_b64_tr_b16 v[72:73], v38 offset:0
  v_mul_f32 v47, s36, v47
  v_mul_f32 v48, s36, v48
  v_mul_f32 v49, s36, v49
  v_mul_f32 v50, s36, v50
  v_mul_f32 v51, s36, v51
  v_cvt_pk_bf16_f32 v52, v44, v45
  v_mfma_f32_32x32x16_bf16 v[160:175], v[96:99], v[104:107], v[160:175]
  ds_read_b64_tr_b16 v[74:75], v38 offset:1024
  ds_read_b64_tr_b16 v[76:77], v39 offset:0
  v_cvt_pk_bf16_f32 v53, v46, v47
  v_cvt_pk_bf16_f32 v54, v48, v49
  v_cvt_pk_bf16_f32 v55, v50, v51
  s_add_u32 s38, s57, 4096
  v_mfma_f32_32x32x16_bf16 v[224:239], v[96:99], v[108:111], v[224:239]
  ds_read_b64_tr_b16 v[78:79], v39 offset:1024
  buffer_store_dwordx4 v[52:55], v2, s[8:11], s38 offen sc1
  v_accvgpr_write_b32 a4, v52
  v_accvgpr_write_b32 a5, v53
  v_mfma_f32_32x32x16_bf16 v[176:191], v[100:103], v[104:107], v[176:191]
  ds_read_b128 v[80:83], v24 offset:0
  v_accvgpr_write_b32 a6, v54
  v_accvgpr_write_b32 a7, v55
  v_accvgpr_read_b32 v112, a68
  v_accvgpr_read_b32 v113, a69
  v_accvgpr_read_b32 v114, a70
  v_mfma_f32_32x32x16_bf16 v[240:255], v[100:103], v[108:111], v[240:255]
  ds_read_b128 v[84:87], v24 offset:16384
  v_accvgpr_read_b32 v115, a71
  v_accvgpr_read_b32 v116, a100
  v_accvgpr_read_b32 v117, a101
  v_accvgpr_read_b32 v118, a102
  s_waitcnt lgkmcnt(0)
  v_mfma_f32_32x32x16_bf16 v[128:143], v[64:67], v[80:83], v[128:143]
  ds_read_b64_tr_b16 v[88:89], v36 offset:4096
  ds_read_b64_tr_b16 v[90:91], v36 offset:5120
  v_accvgpr_read_b32 v119, a103
  v_mul_f32 v112, s36, v112
  v_mul_f32 v113, s36, v113
  v_mul_f32 v114, s36, v114
  v_mul_f32 v115, s36, v115
  v_mfma_f32_32x32x16_bf16 v[192:207], v[64:67], v[84:87], v[192:207]
  ds_read_b64_tr_b16 v[92:93], v37 offset:4096
  v_mul_f32 v116, s36, v116
  v_mul_f32 v117, s36, v117
  v_mul_f32 v118, s36, v118
  v_mul_f32 v119, s36, v119
  v_cvt_pk_bf16_f32 v120, v112, v113
  v_cvt_pk_bf16_f32 v121, v114, v115
  v_mfma_f32_32x32x16_bf16 v[144:159], v[68:71], v[80:83], v[144:159]
  ds_read_b64_tr_b16 v[94:95], v37 offset:5120
  v_cvt_pk_bf16_f32 v122, v116, v117
  v_cvt_pk_bf16_f32 v123, v118, v119
  s_add_u32 s38, s57, 5120
  buffer_store_dwordx4 v[120:123], v2, s[8:11], s38 offen sc1
  v_mfma_f32_32x32x16_bf16 v[208:223], v[68:71], v[84:87], v[208:223]
  ds_read_b64_tr_b16 v[96:97], v38 offset:4096
  v_accvgpr_write_b32 a68, v120
  v_accvgpr_write_b32 a69, v121
  v_accvgpr_write_b32 a70, v122
  v_accvgpr_write_b32 a71, v123
  v_mfma_f32_32x32x16_bf16 v[160:175], v[72:75], v[80:83], v[160:175]
  ds_read_b64_tr_b16 v[98:99], v38 offset:5120
  ds_read_b64_tr_b16 v[100:101], v39 offset:4096
  v_accvgpr_read_b32 v44, a132
  v_accvgpr_read_b32 v45, a133
  v_accvgpr_read_b32 v46, a134
  v_accvgpr_read_b32 v47, a135
  v_mfma_f32_32x32x16_bf16 v[224:239], v[72:75], v[84:87], v[224:239]
  ds_read_b64_tr_b16 v[102:103], v39 offset:5120
  v_accvgpr_read_b32 v48, a164
  v_accvgpr_read_b32 v49, a165
  v_accvgpr_read_b32 v50, a166
  v_accvgpr_read_b32 v51, a167
  v_mul_f32 v44, s36, v44
  v_mfma_f32_32x32x16_bf16 v[176:191], v[76:79], v[80:83], v[176:191]
  ds_read_b128 v[104:107], v25 offset:0
  v_mul_f32 v45, s36, v45
  v_mul_f32 v46, s36, v46
  v_mul_f32 v47, s36, v47
  v_mul_f32 v48, s36, v48
  v_mul_f32 v49, s36, v49
  v_mul_f32 v50, s36, v50
  v_mfma_f32_32x32x16_bf16 v[240:255], v[76:79], v[84:87], v[240:255]
  ds_read_b128 v[108:111], v25 offset:16384
  v_mul_f32 v51, s36, v51
  v_cvt_pk_bf16_f32 v52, v44, v45
  v_cvt_pk_bf16_f32 v53, v46, v47
  v_cvt_pk_bf16_f32 v54, v48, v49
  s_waitcnt lgkmcnt(0)
  v_mfma_f32_32x32x16_bf16 v[128:143], v[88:91], v[104:107], v[128:143]
  ds_read_b64_tr_b16 v[64:65], v36 offset:8192
  ds_read_b64_tr_b16 v[66:67], v36 offset:9216
  v_cvt_pk_bf16_f32 v55, v50, v51
  s_add_u32 s38, s57, 6144
  buffer_store_dwordx4 v[52:55], v2, s[8:11], s38 offen sc1
  v_mfma_f32_32x32x16_bf16 v[192:207], v[88:91], v[108:111], v[192:207]
  ds_read_b64_tr_b16 v[68:69], v37 offset:8192
  v_accvgpr_write_b32 a132, v52
  v_accvgpr_write_b32 a133, v53
  v_accvgpr_write_b32 a134, v54
  v_accvgpr_write_b32 a135, v55
  v_accvgpr_read_b32 v112, a196
  v_mfma_f32_32x32x16_bf16 v[144:159], v[92:95], v[104:107], v[144:159]
  ds_read_b64_tr_b16 v[70:71], v37 offset:9216
  v_accvgpr_read_b32 v113, a197
  v_accvgpr_read_b32 v114, a198
  v_accvgpr_read_b32 v115, a199
  v_accvgpr_read_b32 v116, a228
  v_accvgpr_read_b32 v117, a229
  v_mfma_f32_32x32x16_bf16 v[208:223], v[92:95], v[108:111], v[208:223]
  ds_read_b64_tr_b16 v[72:73], v38 offset:8192
  v_accvgpr_read_b32 v118, a230
  v_accvgpr_read_b32 v119, a231
  v_mul_f32 v112, s36, v112
  v_mul_f32 v113, s36, v113
  v_mul_f32 v114, s36, v114
  v_mfma_f32_32x32x16_bf16 v[160:175], v[96:99], v[104:107], v[160:175]
  ds_read_b64_tr_b16 v[74:75], v38 offset:9216
  ds_read_b64_tr_b16 v[76:77], v39 offset:8192
  v_mul_f32 v115, s36, v115
  v_mul_f32 v116, s36, v116
  v_mul_f32 v117, s36, v117
  v_mul_f32 v118, s36, v118
  v_mul_f32 v119, s36, v119
  v_mfma_f32_32x32x16_bf16 v[224:239], v[96:99], v[108:111], v[224:239]
  ds_read_b64_tr_b16 v[78:79], v39 offset:9216
  v_cvt_pk_bf16_f32 v120, v112, v113
  v_cvt_pk_bf16_f32 v121, v114, v115
  v_cvt_pk_bf16_f32 v122, v116, v117
  v_cvt_pk_bf16_f32 v123, v118, v119
  s_add_u32 s38, s57, 7168
  v_mfma_f32_32x32x16_bf16 v[176:191], v[100:103], v[104:107], v[176:191]
  ds_read_b128 v[80:83], v26 offset:0
  buffer_store_dwordx4 v[120:123], v2, s[8:11], s38 offen sc1
  v_accvgpr_write_b32 a196, v120
  v_accvgpr_write_b32 a197, v121
  v_accvgpr_write_b32 a198, v122
  v_mfma_f32_32x32x16_bf16 v[240:255], v[100:103], v[108:111], v[240:255]
  ds_read_b128 v[84:87], v26 offset:16384
  v_accvgpr_write_b32 a199, v123
  v_accvgpr_read_b32 v44, a8
  v_accvgpr_read_b32 v45, a9
  v_accvgpr_read_b32 v46, a10
  s_waitcnt lgkmcnt(0)
  v_mfma_f32_32x32x16_bf16 v[128:143], v[64:67], v[80:83], v[128:143]
  ds_read_b64_tr_b16 v[88:89], v36 offset:12288
  ds_read_b64_tr_b16 v[90:91], v36 offset:13312
  v_accvgpr_read_b32 v47, a11
  v_accvgpr_read_b32 v48, a40
  v_accvgpr_read_b32 v49, a41
  v_accvgpr_read_b32 v50, a42
  v_mfma_f32_32x32x16_bf16 v[192:207], v[64:67], v[84:87], v[192:207]
  ds_read_b64_tr_b16 v[92:93], v37 offset:12288
  v_accvgpr_read_b32 v51, a43
  v_mul_f32 v44, s36, v44
  v_mul_f32 v45, s36, v45
  v_mul_f32 v46, s36, v46
  v_mul_f32 v47, s36, v47
  v_mul_f32 v48, s36, v48
  v_mfma_f32_32x32x16_bf16 v[144:159], v[68:71], v[80:83], v[144:159]
  ds_read_b64_tr_b16 v[94:95], v37 offset:13312
  v_mul_f32 v49, s36, v49
  v_mul_f32 v50, s36, v50
  v_mul_f32 v51, s36, v51
  v_cvt_pk_bf16_f32 v52, v44, v45
  v_cvt_pk_bf16_f32 v53, v46, v47
  v_mfma_f32_32x32x16_bf16 v[208:223], v[68:71], v[84:87], v[208:223]
  ds_read_b64_tr_b16 v[96:97], v38 offset:12288
  v_cvt_pk_bf16_f32 v54, v48, v49
  v_cvt_pk_bf16_f32 v55, v50, v51
  s_add_u32 s38, s57, 8192
  buffer_store_dwordx4 v[52:55], v2, s[8:11], s38 offen sc1
  v_mfma_f32_32x32x16_bf16 v[160:175], v[72:75], v[80:83], v[160:175]
  ds_read_b64_tr_b16 v[98:99], v38 offset:13312
  ds_read_b64_tr_b16 v[100:101], v39 offset:12288
  v_accvgpr_write_b32 a8, v52
  v_accvgpr_write_b32 a9, v53
  v_accvgpr_write_b32 a10, v54
  v_accvgpr_write_b32 a11, v55
  v_mfma_f32_32x32x16_bf16 v[224:239], v[72:75], v[84:87], v[224:239]
  ds_read_b64_tr_b16 v[102:103], v39 offset:13312
  v_accvgpr_read_b32 v112, a72
  v_accvgpr_read_b32 v113, a73
  v_accvgpr_read_b32 v114, a74
  v_accvgpr_read_b32 v115, a75
  v_accvgpr_read_b32 v116, a104
  v_mfma_f32_32x32x16_bf16 v[176:191], v[76:79], v[80:83], v[176:191]
  ds_read_b128 v[104:107], v27 offset:0
  v_accvgpr_read_b32 v117, a105
  v_accvgpr_read_b32 v118, a106
  v_accvgpr_read_b32 v119, a107
  v_mul_f32 v112, s36, v112
  v_mul_f32 v113, s36, v113
  v_mfma_f32_32x32x16_bf16 v[240:255], v[76:79], v[84:87], v[240:255]
  ds_read_b128 v[108:111], v27 offset:16384
  v_mul_f32 v114, s36, v114
  v_mul_f32 v115, s36, v115
  v_mul_f32 v116, s36, v116
  v_mul_f32 v117, s36, v117
  s_waitcnt lgkmcnt(0)
  s_barrier
  v_mfma_f32_32x32x16_bf16 v[128:143], v[88:91], v[104:107], v[128:143]
  ds_read_b64_tr_b16 v[64:65], v40 offset:0
  ds_read_b64_tr_b16 v[66:67], v40 offset:1024
  v_mul_f32 v118, s36, v118
  v_mul_f32 v119, s36, v119
  v_cvt_pk_bf16_f32 v120, v112, v113
  v_cvt_pk_bf16_f32 v121, v114, v115
  v_mfma_f32_32x32x16_bf16 v[192:207], v[88:91], v[108:111], v[192:207]
  ds_read_b64_tr_b16 v[68:69], v41 offset:0
  v_cvt_pk_bf16_f32 v122, v116, v117
  v_cvt_pk_bf16_f32 v123, v118, v119
  s_add_u32 s38, s57, 9216
  buffer_store_dwordx4 v[120:123], v2, s[8:11], s38 offen sc1
  v_mfma_f32_32x32x16_bf16 v[144:159], v[92:95], v[104:107], v[144:159]
  ds_read_b64_tr_b16 v[70:71], v41 offset:1024
  v_accvgpr_write_b32 a72, v120
  v_accvgpr_write_b32 a73, v121
  v_accvgpr_write_b32 a74, v122
  v_accvgpr_write_b32 a75, v123
  v_accvgpr_read_b32 v44, a136
  v_mfma_f32_32x32x16_bf16 v[208:223], v[92:95], v[108:111], v[208:223]
  ds_read_b64_tr_b16 v[72:73], v42 offset:0
  v_accvgpr_read_b32 v45, a137
  v_accvgpr_read_b32 v46, a138
  v_accvgpr_read_b32 v47, a139
  v_accvgpr_read_b32 v48, a168
  v_accvgpr_read_b32 v49, a169
  v_mfma_f32_32x32x16_bf16 v[160:175], v[96:99], v[104:107], v[160:175]
  ds_read_b64_tr_b16 v[74:75], v42 offset:1024
  ds_read_b64_tr_b16 v[76:77], v43 offset:0
  v_accvgpr_read_b32 v50, a170
  v_accvgpr_read_b32 v51, a171
  v_mul_f32 v44, s36, v44
  v_mul_f32 v45, s36, v45
  v_mfma_f32_32x32x16_bf16 v[224:239], v[96:99], v[108:111], v[224:239]
  ds_read_b64_tr_b16 v[78:79], v43 offset:1024
  v_mul_f32 v46, s36, v46
  v_mul_f32 v47, s36, v47
  v_mul_f32 v48, s36, v48
  v_mul_f32 v49, s36, v49
  v_mul_f32 v50, s36, v50
  v_mul_f32 v51, s36, v51
  v_mfma_f32_32x32x16_bf16 v[176:191], v[100:103], v[104:107], v[176:191]
  ds_read_b128 v[80:83], v28 offset:0
  v_cvt_pk_bf16_f32 v52, v44, v45
  v_cvt_pk_bf16_f32 v53, v46, v47
  v_cvt_pk_bf16_f32 v54, v48, v49
  v_cvt_pk_bf16_f32 v55, v50, v51
  s_add_u32 s38, s57, 10240
  v_mfma_f32_32x32x16_bf16 v[240:255], v[100:103], v[108:111], v[240:255]
  ds_read_b128 v[84:87], v28 offset:16384
  buffer_store_dwordx4 v[52:55], v2, s[8:11], s38 offen sc1
  v_accvgpr_write_b32 a136, v52
  v_accvgpr_write_b32 a137, v53
  s_waitcnt lgkmcnt(0)
  v_mfma_f32_32x32x16_bf16 v[128:143], v[64:67], v[80:83], v[128:143]
  ds_read_b64_tr_b16 v[88:89], v40 offset:4096
  ds_read_b64_tr_b16 v[90:91], v40 offset:5120
  v_accvgpr_write_b32 a138, v54
  v_accvgpr_write_b32 a139, v55
  v_accvgpr_read_b32 v112, a200
  v_accvgpr_read_b32 v113, a201
  v_mfma_f32_32x32x16_bf16 v[192:207], v[64:67], v[84:87], v[192:207]
  ds_read_b64_tr_b16 v[92:93], v41 offset:4096
  v_accvgpr_read_b32 v114, a202
  v_accvgpr_read_b32 v115, a203
  v_accvgpr_read_b32 v116, a232
  v_accvgpr_read_b32 v117, a233
  v_mfma_f32_32x32x16_bf16 v[144:159], v[68:71], v[80:83], v[144:159]
  ds_read_b64_tr_b16 v[94:95], v41 offset:5120
  v_accvgpr_read_b32 v118, a234
  v_accvgpr_read_b32 v119, a235
  v_mul_f32 v112, s36, v112
  v_mul_f32 v113, s36, v113
  v_mul_f32 v114, s36, v114
  v_mul_f32 v115, s36, v115
  v_mfma_f32_32x32x16_bf16 v[208:223], v[68:71], v[84:87], v[208:223]
  ds_read_b64_tr_b16 v[96:97], v42 offset:4096
  v_mul_f32 v116, s36, v116
  v_mul_f32 v117, s36, v117
  v_mul_f32 v118, s36, v118
  v_mul_f32 v119, s36, v119
  v_cvt_pk_bf16_f32 v120, v112, v113
  v_cvt_pk_bf16_f32 v121, v114, v115
  v_mfma_f32_32x32x16_bf16 v[160:175], v[72:75], v[80:83], v[160:175]
  ds_read_b64_tr_b16 v[98:99], v42 offset:5120
  ds_read_b64_tr_b16 v[100:101], v43 offset:4096
  v_cvt_pk_bf16_f32 v122, v116, v117
  v_cvt_pk_bf16_f32 v123, v118, v119
  s_add_u32 s38, s57, 11264
  v_mfma_f32_32x32x16_bf16 v[224:239], v[72:75], v[84:87], v[224:239]
  ds_read_b64_tr_b16 v[102:103], v43 offset:5120
  buffer_store_dwordx4 v[120:123], v2, s[8:11], s38 offen sc1
  v_accvgpr_write_b32 a200, v120
  v_accvgpr_write_b32 a201, v121
  v_accvgpr_write_b32 a202, v122
  v_mfma_f32_32x32x16_bf16 v[176:191], v[76:79], v[80:83], v[176:191]
  ds_read_b128 v[104:107], v29 offset:0
  v_accvgpr_write_b32 a203, v123
  v_accvgpr_read_b32 v44, a12
  v_accvgpr_read_b32 v45, a13
  v_accvgpr_read_b32 v46, a14
  v_accvgpr_read_b32 v47, a15
  v_mfma_f32_32x32x16_bf16 v[240:255], v[76:79], v[84:87], v[240:255]
  ds_read_b128 v[108:111], v29 offset:16384
  v_accvgpr_read_b32 v48, a44
  v_accvgpr_read_b32 v49, a45
  v_accvgpr_read_b32 v50, a46
  v_accvgpr_read_b32 v51, a47
  s_waitcnt lgkmcnt(0)
  v_mfma_f32_32x32x16_bf16 v[128:143], v[88:91], v[104:107], v[128:143]
  ds_read_b64_tr_b16 v[64:65], v40 offset:8192
  ds_read_b64_tr_b16 v[66:67], v40 offset:9216
  v_mul_f32 v44, s36, v44
  v_mul_f32 v45, s36, v45
  v_mul_f32 v46, s36, v46
  v_mul_f32 v47, s36, v47
  v_mul_f32 v48, s36, v48
  v_mfma_f32_32x32x16_bf16 v[192:207], v[88:91], v[108:111], v[192:207]
  ds_read_b64_tr_b16 v[68:69], v41 offset:8192
  v_mul_f32 v49, s36, v49
  v_mul_f32 v50, s36, v50
  v_mul_f32 v51, s36, v51
  v_cvt_pk_bf16_f32 v52, v44, v45
  v_cvt_pk_bf16_f32 v53, v46, v47
  v_cvt_pk_bf16_f32 v54, v48, v49
  v_mfma_f32_32x32x16_bf16 v[144:159], v[92:95], v[104:107], v[144:159]
  ds_read_b64_tr_b16 v[70:71], v41 offset:9216
  v_cvt_pk_bf16_f32 v55, v50, v51
  s_add_u32 s38, s57, 12288
  buffer_store_dwordx4 v[52:55], v2, s[8:11], s38 offen sc1
  v_mfma_f32_32x32x16_bf16 v[208:223], v[92:95], v[108:111], v[208:223]
  ds_read_b64_tr_b16 v[72:73], v42 offset:8192
  v_accvgpr_write_b32 a12, v52
  v_accvgpr_write_b32 a13, v53
  v_accvgpr_write_b32 a14, v54
  v_accvgpr_write_b32 a15, v55
  v_accvgpr_read_b32 v112, a76
  v_mfma_f32_32x32x16_bf16 v[160:175], v[96:99], v[104:107], v[160:175]
  ds_read_b64_tr_b16 v[74:75], v42 offset:9216
  ds_read_b64_tr_b16 v[76:77], v43 offset:8192
  v_accvgpr_read_b32 v113, a77
  v_accvgpr_read_b32 v114, a78
  v_accvgpr_read_b32 v115, a79
  v_accvgpr_read_b32 v116, a108
  v_mfma_f32_32x32x16_bf16 v[224:239], v[96:99], v[108:111], v[224:239]
  ds_read_b64_tr_b16 v[78:79], v43 offset:9216
  v_accvgpr_read_b32 v117, a109
  v_accvgpr_read_b32 v118, a110
  v_accvgpr_read_b32 v119, a111
  v_mul_f32 v112, s36, v112
  v_mul_f32 v113, s36, v113
  v_mul_f32 v114, s36, v114
  v_mfma_f32_32x32x16_bf16 v[176:191], v[100:103], v[104:107], v[176:191]
  ds_read_b128 v[80:83], v30 offset:0
  v_mul_f32 v115, s36, v115
  v_mul_f32 v116, s36, v116
  v_mul_f32 v117, s36, v117
  v_mul_f32 v118, s36, v118
  v_mul_f32 v119, s36, v119
  v_mfma_f32_32x32x16_bf16 v[240:255], v[100:103], v[108:111], v[240:255]
  ds_read_b128 v[84:87], v30 offset:16384
  v_cvt_pk_bf16_f32 v120, v112, v113
  v_cvt_pk_bf16_f32 v121, v114, v115
  v_cvt_pk_bf16_f32 v122, v116, v117
  v_cvt_pk_bf16_f32 v123, v118, v119
  s_add_u32 s38, s57, 13312
  s_waitcnt lgkmcnt(0)
  v_mfma_f32_32x32x16_bf16 v[128:143], v[64:67], v[80:83], v[128:143]
  ds_read_b64_tr_b16 v[88:89], v40 offset:12288
  ds_read_b64_tr_b16 v[90:91], v40 offset:13312
  buffer_store_dwordx4 v[120:123], v2, s[8:11], s38 offen sc1
  v_accvgpr_write_b32 a76, v120
  v_mfma_f32_32x32x16_bf16 v[192:207], v[64:67], v[84:87], v[192:207]
  ds_read_b64_tr_b16 v[92:93], v41 offset:12288
  v_accvgpr_write_b32 a77, v121
  v_accvgpr_write_b32 a78, v122
  v_accvgpr_write_b32 a79, v123
  v_accvgpr_read_b32 v44, a140
  v_accvgpr_read_b32 v45, a141
  v_mfma_f32_32x32x16_bf16 v[144:159], v[68:71], v[80:83], v[144:159]
  ds_read_b64_tr_b16 v[94:95], v41 offset:13312
  v_accvgpr_read_b32 v46, a142
  v_accvgpr_read_b32 v47, a143
  v_accvgpr_read_b32 v48, a172
  v_accvgpr_read_b32 v49, a173
  v_accvgpr_read_b32 v50, a174
  v_mfma_f32_32x32x16_bf16 v[208:223], v[68:71], v[84:87], v[208:223]
  ds_read_b64_tr_b16 v[96:97], v42 offset:12288
  v_accvgpr_read_b32 v51, a175
  v_mul_f32 v44, s36, v44
  v_mul_f32 v45, s36, v45
  v_mul_f32 v46, s36, v46
  v_mul_f32 v47, s36, v47
  v_mul_f32 v48, s36, v48
  v_mfma_f32_32x32x16_bf16 v[160:175], v[72:75], v[80:83], v[160:175]
  ds_read_b64_tr_b16 v[98:99], v42 offset:13312
  ds_read_b64_tr_b16 v[100:101], v43 offset:12288
  v_mul_f32 v49, s36, v49
  v_mul_f32 v50, s36, v50
  v_mul_f32 v51, s36, v51
  v_cvt_pk_bf16_f32 v52, v44, v45
  v_mfma_f32_32x32x16_bf16 v[224:239], v[72:75], v[84:87], v[224:239]
  ds_read_b64_tr_b16 v[102:103], v43 offset:13312
  v_cvt_pk_bf16_f32 v53, v46, v47
  v_cvt_pk_bf16_f32 v54, v48, v49
  v_cvt_pk_bf16_f32 v55, v50, v51
  s_add_u32 s38, s57, 14336
  buffer_store_dwordx4 v[52:55], v2, s[8:11], s38 offen sc1
  v_mfma_f32_32x32x16_bf16 v[176:191], v[76:79], v[80:83], v[176:191]
  ds_read_b128 v[104:107], v31 offset:0
  v_accvgpr_write_b32 a140, v52
  v_accvgpr_write_b32 a141, v53
  v_accvgpr_write_b32 a142, v54
  v_accvgpr_write_b32 a143, v55
  v_mfma_f32_32x32x16_bf16 v[240:255], v[76:79], v[84:87], v[240:255]
  ds_read_b128 v[108:111], v31 offset:16384
  v_accvgpr_read_b32 v112, a204
  v_accvgpr_read_b32 v113, a205
  v_accvgpr_read_b32 v114, a206
  s_waitcnt lgkmcnt(0)
  s_barrier
  v_mfma_f32_32x32x16_bf16 v[128:143], v[88:91], v[104:107], v[128:143]
  ds_read_b64_tr_b16 v[64:65], v32 offset:0
  ds_read_b64_tr_b16 v[66:67], v32 offset:1024
  v_accvgpr_read_b32 v115, a207
  v_accvgpr_read_b32 v116, a236
  v_accvgpr_read_b32 v117, a237
  v_accvgpr_read_b32 v118, a238
  v_mfma_f32_32x32x16_bf16 v[192:207], v[88:91], v[108:111], v[192:207]
  ds_read_b64_tr_b16 v[68:69], v33 offset:0
  v_accvgpr_read_b32 v119, a239
  v_mul_f32 v112, s36, v112
  v_mul_f32 v113, s36, v113
  v_mul_f32 v114, s36, v114
  v_mul_f32 v115, s36, v115
  v_mul_f32 v116, s36, v116
  v_mfma_f32_32x32x16_bf16 v[144:159], v[92:95], v[104:107], v[144:159]
  ds_read_b64_tr_b16 v[70:71], v33 offset:1024
  v_mul_f32 v117, s36, v117
  v_mul_f32 v118, s36, v118
  v_mul_f32 v119, s36, v119
  v_cvt_pk_bf16_f32 v120, v112, v113
  v_cvt_pk_bf16_f32 v121, v114, v115
  v_mfma_f32_32x32x16_bf16 v[208:223], v[92:95], v[108:111], v[208:223]
  ds_read_b64_tr_b16 v[72:73], v34 offset:0
  v_cvt_pk_bf16_f32 v122, v116, v117
  v_cvt_pk_bf16_f32 v123, v118, v119
  s_add_u32 s38, s57, 15360
  buffer_store_dwordx4 v[120:123], v2, s[8:11], s38 offen sc1
  v_mfma_f32_32x32x16_bf16 v[160:175], v[96:99], v[104:107], v[160:175]
  ds_read_b64_tr_b16 v[74:75], v34 offset:1024
  ds_read_b64_tr_b16 v[76:77], v35 offset:0
  v_accvgpr_write_b32 a204, v120
  v_accvgpr_write_b32 a205, v121
  v_accvgpr_write_b32 a206, v122
  v_accvgpr_write_b32 a207, v123
  v_mfma_f32_32x32x16_bf16 v[224:239], v[96:99], v[108:111], v[224:239]
  ds_read_b64_tr_b16 v[78:79], v35 offset:1024
  v_accvgpr_read_b32 v44, a16
  v_accvgpr_read_b32 v45, a17
  v_accvgpr_read_b32 v46, a18
  v_accvgpr_read_b32 v47, a19
  v_accvgpr_read_b32 v48, a48
  v_mfma_f32_32x32x16_bf16 v[176:191], v[100:103], v[104:107], v[176:191]
  ds_read_b128 v[80:83], v20 offset:0
  v_accvgpr_read_b32 v49, a49
  v_accvgpr_read_b32 v50, a50
  v_accvgpr_read_b32 v51, a51
  v_mul_f32 v44, s36, v44
  v_mul_f32 v45, s36, v45
  v_mfma_f32_32x32x16_bf16 v[240:255], v[100:103], v[108:111], v[240:255]
  ds_read_b128 v[84:87], v20 offset:16384
  v_mul_f32 v46, s36, v46
  v_mul_f32 v47, s36, v47
  v_mul_f32 v48, s36, v48
  v_mul_f32 v49, s36, v49
  v_mul_f32 v50, s36, v50
  s_waitcnt lgkmcnt(0)
  v_mfma_f32_32x32x16_bf16 v[128:143], v[64:67], v[80:83], v[128:143]
  ds_read_b64_tr_b16 v[88:89], v32 offset:4096
  ds_read_b64_tr_b16 v[90:91], v32 offset:5120
  v_mul_f32 v51, s36, v51
  v_cvt_pk_bf16_f32 v52, v44, v45
  v_cvt_pk_bf16_f32 v53, v46, v47
  v_cvt_pk_bf16_f32 v54, v48, v49
  v_mfma_f32_32x32x16_bf16 v[192:207], v[64:67], v[84:87], v[192:207]
  ds_read_b64_tr_b16 v[92:93], v33 offset:4096
  v_cvt_pk_bf16_f32 v55, v50, v51
  s_add_u32 s38, s57, 32768
  buffer_store_dwordx4 v[52:55], v2, s[8:11], s38 offen sc1
  v_accvgpr_write_b32 a16, v52
  v_mfma_f32_32x32x16_bf16 v[144:159], v[68:71], v[80:83], v[144:159]
  ds_read_b64_tr_b16 v[94:95], v33 offset:5120
  v_accvgpr_write_b32 a17, v53
  v_accvgpr_write_b32 a18, v54
  v_accvgpr_write_b32 a19, v55
  v_accvgpr_read_b32 v112, a80
  v_accvgpr_read_b32 v113, a81
  v_mfma_f32_32x32x16_bf16 v[208:223], v[68:71], v[84:87], v[208:223]
  ds_read_b64_tr_b16 v[96:97], v34 offset:4096
  v_accvgpr_read_b32 v114, a82
  v_accvgpr_read_b32 v115, a83
  v_accvgpr_read_b32 v116, a112
  v_accvgpr_read_b32 v117, a113
  v_accvgpr_read_b32 v118, a114
  v_mfma_f32_32x32x16_bf16 v[160:175], v[72:75], v[80:83], v[160:175]
  ds_read_b64_tr_b16 v[98:99], v34 offset:5120
  ds_read_b64_tr_b16 v[100:101], v35 offset:4096
  v_accvgpr_read_b32 v119, a115
  v_mul_f32 v112, s36, v112
  v_mul_f32 v113, s36, v113
  v_mul_f32 v114, s36, v114
  v_mfma_f32_32x32x16_bf16 v[224:239], v[72:75], v[84:87], v[224:239]
  ds_read_b64_tr_b16 v[102:103], v35 offset:5120
  v_mul_f32 v115, s36, v115
  v_mul_f32 v116, s36, v116
  v_mul_f32 v117, s36, v117
  v_mul_f32 v118, s36, v118
  v_mul_f32 v119, s36, v119
  v_cvt_pk_bf16_f32 v120, v112, v113
  v_mfma_f32_32x32x16_bf16 v[176:191], v[76:79], v[80:83], v[176:191]
  ds_read_b128 v[104:107], v21 offset:0
  v_cvt_pk_bf16_f32 v121, v114, v115
  v_cvt_pk_bf16_f32 v122, v116, v117
  v_cvt_pk_bf16_f32 v123, v118, v119
  s_add_u32 s38, s57, 33792
  v_mfma_f32_32x32x16_bf16 v[240:255], v[76:79], v[84:87], v[240:255]
  ds_read_b128 v[108:111], v21 offset:16384
  buffer_store_dwordx4 v[120:123], v2, s[8:11], s38 offen sc1
  v_accvgpr_write_b32 a80, v120
  v_accvgpr_write_b32 a81, v121
  v_accvgpr_write_b32 a82, v122
  s_waitcnt lgkmcnt(0)
  v_mfma_f32_32x32x16_bf16 v[128:143], v[88:91], v[104:107], v[128:143]
  ds_read_b64_tr_b16 v[64:65], v32 offset:8192
  ds_read_b64_tr_b16 v[66:67], v32 offset:9216
  v_accvgpr_write_b32 a83, v123
  v_accvgpr_read_b32 v44, a144
  v_accvgpr_read_b32 v45, a145
  v_accvgpr_read_b32 v46, a146
  v_mfma_f32_32x32x16_bf16 v[192:207], v[88:91], v[108:111], v[192:207]
  ds_read_b64_tr_b16 v[68:69], v33 offset:8192
  v_accvgpr_read_b32 v47, a147
  v_accvgpr_read_b32 v48, a176
  v_accvgpr_read_b32 v49, a177
  v_accvgpr_read_b32 v50, a178
  v_accvgpr_read_b32 v51, a179
  v_mfma_f32_32x32x16_bf16 v[144:159], v[92:95], v[104:107], v[144:159]
  ds_read_b64_tr_b16 v[70:71], v33 offset:9216
  v_mul_f32 v44, s36, v44
  v_mul_f32 v45, s36, v45
  v_mul_f32 v46, s36, v46
  v_mul_f32 v47, s36, v47
  v_mul_f32 v48, s36, v48
  v_mfma_f32_32x32x16_bf16 v[208:223], v[92:95], v[108:111], v[208:223]
  ds_read_b64_tr_b16 v[72:73], v34 offset:8192
  v_mul_f32 v49, s36, v49
  v_mul_f32 v50, s36, v50
  v_mul_f32 v51, s36, v51
  v_cvt_pk_bf16_f32 v52, v44, v45
  v_cvt_pk_bf16_f32 v53, v46, v47
  v_cvt_pk_bf16_f32 v54, v48, v49
  v_mfma_f32_32x32x16_bf16 v[160:175], v[96:99], v[104:107], v[160:175]
  ds_read_b64_tr_b16 v[74:75], v34 offset:9216
  ds_read_b64_tr_b16 v[76:77], v35 offset:8192
  v_cvt_pk_bf16_f32 v55, v50, v51
  s_add_u32 s38, s57, 34816
  buffer_store_dwordx4 v[52:55], v2, s[8:11], s38 offen sc1
  v_mfma_f32_32x32x16_bf16 v[224:239], v[96:99], v[108:111], v[224:239]
  ds_read_b64_tr_b16 v[78:79], v35 offset:9216
  v_accvgpr_write_b32 a144, v52
  v_accvgpr_write_b32 a145, v53
  v_accvgpr_write_b32 a146, v54
  v_accvgpr_write_b32 a147, v55
  v_mfma_f32_32x32x16_bf16 v[176:191], v[100:103], v[104:107], v[176:191]
  ds_read_b128 v[80:83], v22 offset:0
  v_accvgpr_read_b32 v112, a208
  v_accvgpr_read_b32 v113, a209
  v_accvgpr_read_b32 v114, a210
  v_accvgpr_read_b32 v115, a211
  v_accvgpr_read_b32 v116, a240
  v_mfma_f32_32x32x16_bf16 v[240:255], v[100:103], v[108:111], v[240:255]
  ds_read_b128 v[84:87], v22 offset:16384
  v_accvgpr_read_b32 v117, a241
  v_accvgpr_read_b32 v118, a242
  v_accvgpr_read_b32 v119, a243
  v_mul_f32 v112, s36, v112
  v_mul_f32 v113, s36, v113
  s_waitcnt lgkmcnt(0)
  v_mfma_f32_32x32x16_bf16 v[128:143], v[64:67], v[80:83], v[128:143]
  ds_read_b64_tr_b16 v[88:89], v32 offset:12288
  ds_read_b64_tr_b16 v[90:91], v32 offset:13312
  v_mul_f32 v114, s36, v114
  v_mul_f32 v115, s36, v115
  v_mul_f32 v116, s36, v116
  v_mul_f32 v117, s36, v117
  v_mul_f32 v118, s36, v118
  v_mfma_f32_32x32x16_bf16 v[192:207], v[64:67], v[84:87], v[192:207]
  ds_read_b64_tr_b16 v[92:93], v33 offset:12288
  v_mul_f32 v119, s36, v119
  v_cvt_pk_bf16_f32 v120, v112, v113
  v_cvt_pk_bf16_f32 v121, v114, v115
  v_cvt_pk_bf16_f32 v122, v116, v117
  v_cvt_pk_bf16_f32 v123, v118, v119
  v_mfma_f32_32x32x16_bf16 v[144:159], v[68:71], v[80:83], v[144:159]
  ds_read_b64_tr_b16 v[94:95], v33 offset:13312
  s_add_u32 s38, s57, 35840
  buffer_store_dwordx4 v[120:123], v2, s[8:11], s38 offen sc1
  v_accvgpr_write_b32 a208, v120
  v_mfma_f32_32x32x16_bf16 v[208:223], v[68:71], v[84:87], v[208:223]
  ds_read_b64_tr_b16 v[96:97], v34 offset:12288
  v_accvgpr_write_b32 a209, v121
  v_accvgpr_write_b32 a210, v122
  v_accvgpr_write_b32 a211, v123
  v_accvgpr_read_b32 v44, a20
  v_accvgpr_read_b32 v45, a21
  v_mfma_f32_32x32x16_bf16 v[160:175], v[72:75], v[80:83], v[160:175]
  ds_read_b64_tr_b16 v[98:99], v34 offset:13312
  ds_read_b64_tr_b16 v[100:101], v35 offset:12288
  v_accvgpr_read_b32 v46, a22
  v_accvgpr_read_b32 v47, a23
  v_accvgpr_read_b32 v48, a52
  v_accvgpr_read_b32 v49, a53
  v_mfma_f32_32x32x16_bf16 v[224:239], v[72:75], v[84:87], v[224:239]
  ds_read_b64_tr_b16 v[102:103], v35 offset:13312
  v_accvgpr_read_b32 v50, a54
  v_accvgpr_read_b32 v51, a55
  v_mul_f32 v44, s36, v44
  v_mul_f32 v45, s36, v45
  v_mul_f32 v46, s36, v46
  v_mul_f32 v47, s36, v47
  v_mfma_f32_32x32x16_bf16 v[176:191], v[76:79], v[80:83], v[176:191]
  ds_read_b128 v[104:107], v23 offset:0
  v_mul_f32 v48, s36, v48
  v_mul_f32 v49, s36, v49
  v_mul_f32 v50, s36, v50
  v_mul_f32 v51, s36, v51
  v_cvt_pk_bf16_f32 v52, v44, v45
  v_mfma_f32_32x32x16_bf16 v[240:255], v[76:79], v[84:87], v[240:255]
  ds_read_b128 v[108:111], v23 offset:16384
  v_cvt_pk_bf16_f32 v53, v46, v47
  v_cvt_pk_bf16_f32 v54, v48, v49
  v_cvt_pk_bf16_f32 v55, v50, v51
  s_add_u32 s38, s57, 36864
  s_waitcnt lgkmcnt(0)
  s_barrier
  v_mfma_f32_32x32x16_bf16 v[128:143], v[88:91], v[104:107], v[128:143]
  ds_read_b64_tr_b16 v[64:65], v36 offset:0
  ds_read_b64_tr_b16 v[66:67], v36 offset:1024
  buffer_store_dwordx4 v[52:55], v2, s[8:11], s38 offen sc1
  v_accvgpr_write_b32 a20, v52
  v_accvgpr_write_b32 a21, v53
  v_mfma_f32_32x32x16_bf16 v[192:207], v[88:91], v[108:111], v[192:207]
  ds_read_b64_tr_b16 v[68:69], v37 offset:0
  v_accvgpr_write_b32 a22, v54
  v_accvgpr_write_b32 a23, v55
  v_accvgpr_read_b32 v112, a84
  v_accvgpr_read_b32 v113, a85
  v_mfma_f32_32x32x16_bf16 v[144:159], v[92:95], v[104:107], v[144:159]
  ds_read_b64_tr_b16 v[70:71], v37 offset:1024
  v_accvgpr_read_b32 v114, a86
  v_accvgpr_read_b32 v115, a87
  v_accvgpr_read_b32 v116, a116
  v_accvgpr_read_b32 v117, a117
  v_accvgpr_read_b32 v118, a118
  v_mfma_f32_32x32x16_bf16 v[208:223], v[92:95], v[108:111], v[208:223]
  ds_read_b64_tr_b16 v[72:73], v38 offset:0
  v_accvgpr_read_b32 v119, a119
  v_mul_f32 v112, s36, v112
  v_mul_f32 v113, s36, v113
  v_mul_f32 v114, s36, v114
  v_mul_f32 v115, s36, v115
  v_mul_f32 v116, s36, v116
  v_mfma_f32_32x32x16_bf16 v[160:175], v[96:99], v[104:107], v[160:175]
  ds_read_b64_tr_b16 v[74:75], v38 offset:1024
  ds_read_b64_tr_b16 v[76:77], v39 offset:0
  v_mul_f32 v117, s36, v117
  v_mul_f32 v118, s36, v118
  v_mul_f32 v119, s36, v119
  v_cvt_pk_bf16_f32 v120, v112, v113
  v_cvt_pk_bf16_f32 v121, v114, v115
  v_mfma_f32_32x32x16_bf16 v[224:239], v[96:99], v[108:111], v[224:239]
  ds_read_b64_tr_b16 v[78:79], v39 offset:1024
  v_cvt_pk_bf16_f32 v122, v116, v117
  v_cvt_pk_bf16_f32 v123, v118, v119
  s_add_u32 s38, s57, 37888
  buffer_store_dwordx4 v[120:123], v2, s[8:11], s38 offen sc1
  v_mfma_f32_32x32x16_bf16 v[176:191], v[100:103], v[104:107], v[176:191]
  ds_read_b128 v[80:83], v24 offset:0
  v_accvgpr_write_b32 a84, v120
  v_accvgpr_write_b32 a85, v121
  v_accvgpr_write_b32 a86, v122
  v_accvgpr_write_b32 a87, v123
  v_mfma_f32_32x32x16_bf16 v[240:255], v[100:103], v[108:111], v[240:255]
  ds_read_b128 v[84:87], v24 offset:16384
  v_accvgpr_read_b32 v44, a148
  v_accvgpr_read_b32 v45, a149
  v_accvgpr_read_b32 v46, a150
  v_accvgpr_read_b32 v47, a151
  s_waitcnt lgkmcnt(0)
  v_mfma_f32_32x32x16_bf16 v[128:143], v[64:67], v[80:83], v[128:143]
  ds_read_b64_tr_b16 v[88:89], v36 offset:4096
  ds_read_b64_tr_b16 v[90:91], v36 offset:5120
  v_accvgpr_read_b32 v48, a180
  v_accvgpr_read_b32 v49, a181
  v_accvgpr_read_b32 v50, a182
  v_accvgpr_read_b32 v51, a183
  v_mfma_f32_32x32x16_bf16 v[192:207], v[64:67], v[84:87], v[192:207]
  ds_read_b64_tr_b16 v[92:93], v37 offset:4096
  v_mul_f32 v44, s36, v44
  v_mul_f32 v45, s36, v45
  v_mul_f32 v46, s36, v46
  v_mul_f32 v47, s36, v47
  v_mul_f32 v48, s36, v48
  v_mul_f32 v49, s36, v49
  v_mfma_f32_32x32x16_bf16 v[144:159], v[68:71], v[80:83], v[144:159]
  ds_read_b64_tr_b16 v[94:95], v37 offset:5120
  v_mul_f32 v50, s36, v50
  v_mul_f32 v51, s36, v51
  v_cvt_pk_bf16_f32 v52, v44, v45
  v_cvt_pk_bf16_f32 v53, v46, v47
  v_cvt_pk_bf16_f32 v54, v48, v49
  v_mfma_f32_32x32x16_bf16 v[208:223], v[68:71], v[84:87], v[208:223]
  ds_read_b64_tr_b16 v[96:97], v38 offset:4096
  v_cvt_pk_bf16_f32 v55, v50, v51
  s_add_u32 s38, s57, 38912
  buffer_store_dwordx4 v[52:55], v2, s[8:11], s38 offen sc1
  v_accvgpr_write_b32 a148, v52
  v_mfma_f32_32x32x16_bf16 v[160:175], v[72:75], v[80:83], v[160:175]
  ds_read_b64_tr_b16 v[98:99], v38 offset:5120
  ds_read_b64_tr_b16 v[100:101], v39 offset:4096
  v_accvgpr_write_b32 a149, v53
  v_accvgpr_write_b32 a150, v54
  v_accvgpr_write_b32 a151, v55
  v_accvgpr_read_b32 v112, a212
  v_mfma_f32_32x32x16_bf16 v[224:239], v[72:75], v[84:87], v[224:239]
  ds_read_b64_tr_b16 v[102:103], v39 offset:5120
  v_accvgpr_read_b32 v113, a213
  v_accvgpr_read_b32 v114, a214
  v_accvgpr_read_b32 v115, a215
  v_accvgpr_read_b32 v116, a244
  v_accvgpr_read_b32 v117, a245
  v_mfma_f32_32x32x16_bf16 v[176:191], v[76:79], v[80:83], v[176:191]
  ds_read_b128 v[104:107], v25 offset:0
  v_accvgpr_read_b32 v118, a246
  v_accvgpr_read_b32 v119, a247
  v_mul_f32 v112, s36, v112
  v_mul_f32 v113, s36, v113
  v_mul_f32 v114, s36, v114
  v_mfma_f32_32x32x16_bf16 v[240:255], v[76:79], v[84:87], v[240:255]
  ds_read_b128 v[108:111], v25 offset:16384
  v_mul_f32 v115, s36, v115
  v_mul_f32 v116, s36, v116
  v_mul_f32 v117, s36, v117
  v_mul_f32 v118, s36, v118
  v_mul_f32 v119, s36, v119
  s_waitcnt lgkmcnt(0)
  v_mfma_f32_32x32x16_bf16 v[128:143], v[88:91], v[104:107], v[128:143]
  ds_read_b64_tr_b16 v[64:65], v36 offset:8192
  ds_read_b64_tr_b16 v[66:67], v36 offset:9216
  v_cvt_pk_bf16_f32 v120, v112, v113
  v_cvt_pk_bf16_f32 v121, v114, v115
  v_cvt_pk_bf16_f32 v122, v116, v117
  v_cvt_pk_bf16_f32 v123, v118, v119
  v_mfma_f32_32x32x16_bf16 v[192:207], v[88:91], v[108:111], v[192:207]
  ds_read_b64_tr_b16 v[68:69], v37 offset:8192
  s_add_u32 s38, s57, 39936
  buffer_store_dwordx4 v[120:123], v2, s[8:11], s38 offen sc1
  v_accvgpr_write_b32 a212, v120
  v_accvgpr_write_b32 a213, v121
  v_mfma_f32_32x32x16_bf16 v[144:159], v[92:95], v[104:107], v[144:159]
  ds_read_b64_tr_b16 v[70:71], v37 offset:9216
  v_accvgpr_write_b32 a214, v122
  v_accvgpr_write_b32 a215, v123
  v_accvgpr_read_b32 v44, a24
  v_accvgpr_read_b32 v45, a25
  v_accvgpr_read_b32 v46, a26
  v_mfma_f32_32x32x16_bf16 v[208:223], v[92:95], v[108:111], v[208:223]
  ds_read_b64_tr_b16 v[72:73], v38 offset:8192
  v_accvgpr_read_b32 v47, a27
  v_accvgpr_read_b32 v48, a56
  v_accvgpr_read_b32 v49, a57
  v_accvgpr_read_b32 v50, a58
  v_accvgpr_read_b32 v51, a59
  v_mfma_f32_32x32x16_bf16 v[160:175], v[96:99], v[104:107], v[160:175]
  ds_read_b64_tr_b16 v[74:75], v38 offset:9216
  ds_read_b64_tr_b16 v[76:77], v39 offset:8192
  v_mul_f32 v44, s36, v44
  v_mul_f32 v45, s36, v45
  v_mul_f32 v46, s36, v46
  v_mul_f32 v47, s36, v47
  v_mul_f32 v48, s36, v48
  v_mfma_f32_32x32x16_bf16 v[224:239], v[96:99], v[108:111], v[224:239]
  ds_read_b64_tr_b16 v[78:79], v39 offset:9216
  v_mul_f32 v49, s36, v49
  v_mul_f32 v50, s36, v50
  v_mul_f32 v51, s36, v51
  v_cvt_pk_bf16_f32 v52, v44, v45
  v_cvt_pk_bf16_f32 v53, v46, v47
  v_mfma_f32_32x32x16_bf16 v[176:191], v[100:103], v[104:107], v[176:191]
  ds_read_b128 v[80:83], v26 offset:0
  v_cvt_pk_bf16_f32 v54, v48, v49
  v_cvt_pk_bf16_f32 v55, v50, v51
  s_add_u32 s38, s57, 40960
  buffer_store_dwordx4 v[52:55], v2, s[8:11], s38 offen sc1
  v_mfma_f32_32x32x16_bf16 v[240:255], v[100:103], v[108:111], v[240:255]
  ds_read_b128 v[84:87], v26 offset:16384
  v_accvgpr_write_b32 a24, v52
  v_accvgpr_write_b32 a25, v53
  v_accvgpr_write_b32 a26, v54
  v_accvgpr_write_b32 a27, v55
  s_waitcnt lgkmcnt(0)
  v_mfma_f32_32x32x16_bf16 v[128:143], v[64:67], v[80:83], v[128:143]
  ds_read_b64_tr_b16 v[88:89], v36 offset:12288
  ds_read_b64_tr_b16 v[90:91], v36 offset:13312
  v_accvgpr_read_b32 v112, a88
  v_accvgpr_read_b32 v113, a89
  v_accvgpr_read_b32 v114, a90
  v_accvgpr_read_b32 v115, a91
  v_mfma_f32_32x32x16_bf16 v[192:207], v[64:67], v[84:87], v[192:207]
  ds_read_b64_tr_b16 v[92:93], v37 offset:12288
  v_accvgpr_read_b32 v116, a120
  v_accvgpr_read_b32 v117, a121
  v_accvgpr_read_b32 v118, a122
  v_accvgpr_read_b32 v119, a123
  v_mul_f32 v112, s36, v112
  v_mfma_f32_32x32x16_bf16 v[144:159], v[68:71], v[80:83], v[144:159]
  ds_read_b64_tr_b16 v[94:95], v37 offset:13312
  v_mul_f32 v113, s36, v113
  v_mul_f32 v114, s36, v114
  v_mul_f32 v115, s36, v115
  v_mul_f32 v116, s36, v116
  v_mul_f32 v117, s36, v117
  v_mul_f32 v118, s36, v118
  v_mfma_f32_32x32x16_bf16 v[208:223], v[68:71], v[84:87], v[208:223]
  ds_read_b64_tr_b16 v[96:97], v38 offset:12288
  v_mul_f32 v119, s36, v119
  v_cvt_pk_bf16_f32 v120, v112, v113
  v_cvt_pk_bf16_f32 v121, v114, v115
  v_cvt_pk_bf16_f32 v122, v116, v117
  v_cvt_pk_bf16_f32 v123, v118, v119
  v_mfma_f32_32x32x16_bf16 v[160:175], v[72:75], v[80:83], v[160:175]
  ds_read_b64_tr_b16 v[98:99], v38 offset:13312
  ds_read_b64_tr_b16 v[100:101], v39 offset:12288
  s_add_u32 s38, s57, 41984
  buffer_store_dwordx4 v[120:123], v2, s[8:11], s38 offen sc1
  v_accvgpr_write_b32 a88, v120
  v_mfma_f32_32x32x16_bf16 v[224:239], v[72:75], v[84:87], v[224:239]
  ds_read_b64_tr_b16 v[102:103], v39 offset:13312
  v_accvgpr_write_b32 a89, v121
  v_accvgpr_write_b32 a90, v122
  v_accvgpr_write_b32 a91, v123
  v_accvgpr_read_b32 v44, a152
  v_accvgpr_read_b32 v45, a153
  v_mfma_f32_32x32x16_bf16 v[176:191], v[76:79], v[80:83], v[176:191]
  ds_read_b128 v[104:107], v27 offset:0
  v_accvgpr_read_b32 v46, a154
  v_accvgpr_read_b32 v47, a155
  v_accvgpr_read_b32 v48, a184
  v_accvgpr_read_b32 v49, a185
  v_mfma_f32_32x32x16_bf16 v[240:255], v[76:79], v[84:87], v[240:255]
  ds_read_b128 v[108:111], v27 offset:16384
  v_accvgpr_read_b32 v50, a186
  v_accvgpr_read_b32 v51, a187
  v_mul_f32 v44, s36, v44
  v_mul_f32 v45, s36, v45
  s_waitcnt lgkmcnt(0)
  s_barrier
  v_mfma_f32_32x32x16_bf16 v[128:143], v[88:91], v[104:107], v[128:143]
  ds_read_b64_tr_b16 v[64:65], v40 offset:0
  ds_read_b64_tr_b16 v[66:67], v40 offset:1024
  v_mul_f32 v46, s36, v46
  v_mul_f32 v47, s36, v47
  v_mul_f32 v48, s36, v48
  v_mul_f32 v49, s36, v49
  v_mul_f32 v50, s36, v50
  v_mfma_f32_32x32x16_bf16 v[192:207], v[88:91], v[108:111], v[192:207]
  ds_read_b64_tr_b16 v[68:69], v41 offset:0
  v_mul_f32 v51, s36, v51
  v_cvt_pk_bf16_f32 v52, v44, v45
  v_cvt_pk_bf16_f32 v53, v46, v47
  v_cvt_pk_bf16_f32 v54, v48, v49
  v_cvt_pk_bf16_f32 v55, v50, v51
  v_mfma_f32_32x32x16_bf16 v[144:159], v[92:95], v[104:107], v[144:159]
  ds_read_b64_tr_b16 v[70:71], v41 offset:1024
  s_add_u32 s38, s57, 43008
  buffer_store_dwordx4 v[52:55], v2, s[8:11], s38 offen sc1
  v_accvgpr_write_b32 a152, v52
  v_accvgpr_write_b32 a153, v53
  v_mfma_f32_32x32x16_bf16 v[208:223], v[92:95], v[108:111], v[208:223]
  ds_read_b64_tr_b16 v[72:73], v42 offset:0
  v_accvgpr_write_b32 a154, v54
  v_accvgpr_write_b32 a155, v55
  v_accvgpr_read_b32 v112, a216
  v_accvgpr_read_b32 v113, a217
  v_mfma_f32_32x32x16_bf16 v[160:175], v[96:99], v[104:107], v[160:175]
  ds_read_b64_tr_b16 v[74:75], v42 offset:1024
  ds_read_b64_tr_b16 v[76:77], v43 offset:0
  v_accvgpr_read_b32 v114, a218
  v_accvgpr_read_b32 v115, a219
  v_accvgpr_read_b32 v116, a248
  v_accvgpr_read_b32 v117, a249
  v_mfma_f32_32x32x16_bf16 v[224:239], v[96:99], v[108:111], v[224:239]
  ds_read_b64_tr_b16 v[78:79], v43 offset:1024
  v_accvgpr_read_b32 v118, a250
  v_accvgpr_read_b32 v119, a251
  v_mul_f32 v112, s36, v112
  v_mul_f32 v113, s36, v113
  v_mul_f32 v114, s36, v114
  v_mul_f32 v115, s36, v115
  v_mfma_f32_32x32x16_bf16 v[176:191], v[100:103], v[104:107], v[176:191]
  ds_read_b128 v[80:83], v28 offset:0
  v_mul_f32 v116, s36, v116
  v_mul_f32 v117, s36, v117
  v_mul_f32 v118, s36, v118
  v_mul_f32 v119, s36, v119
  v_cvt_pk_bf16_f32 v120, v112, v113
  v_cvt_pk_bf16_f32 v121, v114, v115
  v_mfma_f32_32x32x16_bf16 v[240:255], v[100:103], v[108:111], v[240:255]
  ds_read_b128 v[84:87], v28 offset:16384
  v_cvt_pk_bf16_f32 v122, v116, v117
  v_cvt_pk_bf16_f32 v123, v118, v119
  s_add_u32 s38, s57, 44032
  s_waitcnt lgkmcnt(0)
  v_mfma_f32_32x32x16_bf16 v[128:143], v[64:67], v[80:83], v[128:143]
  ds_read_b64_tr_b16 v[88:89], v40 offset:4096
  ds_read_b64_tr_b16 v[90:91], v40 offset:5120
  buffer_store_dwordx4 v[120:123], v2, s[8:11], s38 offen sc1
  v_accvgpr_write_b32 a216, v120
  v_accvgpr_write_b32 a217, v121
  v_accvgpr_write_b32 a218, v122
  v_mfma_f32_32x32x16_bf16 v[192:207], v[64:67], v[84:87], v[192:207]
  ds_read_b64_tr_b16 v[92:93], v41 offset:4096
  v_accvgpr_write_b32 a219, v123
  v_accvgpr_read_b32 v44, a28
  v_accvgpr_read_b32 v45, a29
  v_accvgpr_read_b32 v46, a30
  v_mfma_f32_32x32x16_bf16 v[144:159], v[68:71], v[80:83], v[144:159]
  ds_read_b64_tr_b16 v[94:95], v41 offset:5120
  v_accvgpr_read_b32 v47, a31
  v_accvgpr_read_b32 v48, a60
  v_accvgpr_read_b32 v49, a61
  v_accvgpr_read_b32 v50, a62
  v_accvgpr_read_b32 v51, a63
  v_mfma_f32_32x32x16_bf16 v[208:223], v[68:71], v[84:87], v[208:223]
  ds_read_b64_tr_b16 v[96:97], v42 offset:4096
  v_mul_f32 v44, s36, v44
  v_mul_f32 v45, s36, v45
  v_mul_f32 v46, s36, v46
  v_mul_f32 v47, s36, v47
  v_mul_f32 v48, s36, v48
  v_mul_f32 v49, s36, v49
  v_mfma_f32_32x32x16_bf16 v[160:175], v[72:75], v[80:83], v[160:175]
  ds_read_b64_tr_b16 v[98:99], v42 offset:5120
  ds_read_b64_tr_b16 v[100:101], v43 offset:4096
  v_mul_f32 v50, s36, v50
  v_mul_f32 v51, s36, v51
  v_cvt_pk_bf16_f32 v52, v44, v45
  v_cvt_pk_bf16_f32 v53, v46, v47
  v_cvt_pk_bf16_f32 v54, v48, v49
  v_mfma_f32_32x32x16_bf16 v[224:239], v[72:75], v[84:87], v[224:239]
  ds_read_b64_tr_b16 v[102:103], v43 offset:5120
  v_cvt_pk_bf16_f32 v55, v50, v51
  s_add_u32 s38, s57, 45056
  buffer_store_dwordx4 v[52:55], v2, s[8:11], s38 offen sc1
  v_mfma_f32_32x32x16_bf16 v[176:191], v[76:79], v[80:83], v[176:191]
  ds_read_b128 v[104:107], v29 offset:0
  v_accvgpr_write_b32 a28, v52
  v_accvgpr_write_b32 a29, v53
  v_accvgpr_write_b32 a30, v54
  v_accvgpr_write_b32 a31, v55
  v_accvgpr_read_b32 v112, a92
  v_mfma_f32_32x32x16_bf16 v[240:255], v[76:79], v[84:87], v[240:255]
  ds_read_b128 v[108:111], v29 offset:16384
  v_accvgpr_read_b32 v113, a93
  v_accvgpr_read_b32 v114, a94
  v_accvgpr_read_b32 v115, a95
  v_accvgpr_read_b32 v116, a124
  s_waitcnt lgkmcnt(0)
  v_mfma_f32_32x32x16_bf16 v[128:143], v[88:91], v[104:107], v[128:143]
  ds_read_b64_tr_b16 v[64:65], v40 offset:8192
  ds_read_b64_tr_b16 v[66:67], v40 offset:9216
  v_accvgpr_read_b32 v117, a125
  v_accvgpr_read_b32 v118, a126
  v_accvgpr_read_b32 v119, a127
  v_mul_f32 v112, s36, v112
  v_mul_f32 v113, s36, v113
  v_mfma_f32_32x32x16_bf16 v[192:207], v[88:91], v[108:111], v[192:207]
  ds_read_b64_tr_b16 v[68:69], v41 offset:8192
  v_mul_f32 v114, s36, v114
  v_mul_f32 v115, s36, v115
  v_mul_f32 v116, s36, v116
  v_mul_f32 v117, s36, v117
  v_mul_f32 v118, s36, v118
  v_mul_f32 v119, s36, v119
  v_mfma_f32_32x32x16_bf16 v[144:159], v[92:95], v[104:107], v[144:159]
  ds_read_b64_tr_b16 v[70:71], v41 offset:9216
  v_cvt_pk_bf16_f32 v120, v112, v113
  v_cvt_pk_bf16_f32 v121, v114, v115
  v_cvt_pk_bf16_f32 v122, v116, v117
  v_cvt_pk_bf16_f32 v123, v118, v119
  s_add_u32 s38, s57, 46080
  v_mfma_f32_32x32x16_bf16 v[208:223], v[92:95], v[108:111], v[208:223]
  ds_read_b64_tr_b16 v[72:73], v42 offset:8192
  buffer_store_dwordx4 v[120:123], v2, s[8:11], s38 offen sc1
  v_accvgpr_write_b32 a92, v120
  v_accvgpr_write_b32 a93, v121
  v_mfma_f32_32x32x16_bf16 v[160:175], v[96:99], v[104:107], v[160:175]
  ds_read_b64_tr_b16 v[74:75], v42 offset:9216
  ds_read_b64_tr_b16 v[76:77], v43 offset:8192
  v_accvgpr_write_b32 a94, v122
  v_accvgpr_write_b32 a95, v123
  v_accvgpr_read_b32 v44, a156
  v_accvgpr_read_b32 v45, a157
  v_mfma_f32_32x32x16_bf16 v[224:239], v[96:99], v[108:111], v[224:239]
  ds_read_b64_tr_b16 v[78:79], v43 offset:9216
  v_accvgpr_read_b32 v46, a158
  v_accvgpr_read_b32 v47, a159
  v_accvgpr_read_b32 v48, a188
  v_accvgpr_read_b32 v49, a189
  v_accvgpr_read_b32 v50, a190
  v_mfma_f32_32x32x16_bf16 v[176:191], v[100:103], v[104:107], v[176:191]
  ds_read_b128 v[80:83], v30 offset:0
  v_accvgpr_read_b32 v51, a191
  v_mul_f32 v44, s36, v44
  v_mul_f32 v45, s36, v45
  v_mul_f32 v46, s36, v46
  v_mul_f32 v47, s36, v47
  v_mul_f32 v48, s36, v48
  v_mfma_f32_32x32x16_bf16 v[240:255], v[100:103], v[108:111], v[240:255]
  ds_read_b128 v[84:87], v30 offset:16384
  v_mul_f32 v49, s36, v49
  v_mul_f32 v50, s36, v50
  v_mul_f32 v51, s36, v51
  v_cvt_pk_bf16_f32 v52, v44, v45
  s_waitcnt lgkmcnt(0)
  v_mfma_f32_32x32x16_bf16 v[128:143], v[64:67], v[80:83], v[128:143]
  ds_read_b64_tr_b16 v[88:89], v40 offset:12288
  ds_read_b64_tr_b16 v[90:91], v40 offset:13312
  v_cvt_pk_bf16_f32 v53, v46, v47
  v_cvt_pk_bf16_f32 v54, v48, v49
  v_cvt_pk_bf16_f32 v55, v50, v51
  s_add_u32 s38, s57, 47104
  v_mfma_f32_32x32x16_bf16 v[192:207], v[64:67], v[84:87], v[192:207]
  ds_read_b64_tr_b16 v[92:93], v41 offset:12288
  buffer_store_dwordx4 v[52:55], v2, s[8:11], s38 offen sc1
  v_accvgpr_write_b32 a156, v52
  v_accvgpr_write_b32 a157, v53
  v_accvgpr_write_b32 a158, v54
  v_mfma_f32_32x32x16_bf16 v[144:159], v[68:71], v[80:83], v[144:159]
  ds_read_b64_tr_b16 v[94:95], v41 offset:13312
  v_accvgpr_write_b32 a159, v55
  v_accvgpr_read_b32 v112, a220
  v_accvgpr_read_b32 v113, a221
  v_accvgpr_read_b32 v114, a222
  v_accvgpr_read_b32 v115, a223
  v_mfma_f32_32x32x16_bf16 v[208:223], v[68:71], v[84:87], v[208:223]
  ds_read_b64_tr_b16 v[96:97], v42 offset:12288
  v_accvgpr_read_b32 v116, a252
  v_accvgpr_read_b32 v117, a253
  v_accvgpr_read_b32 v118, a254
  v_accvgpr_read_b32 v119, a255
  v_mul_f32 v112, s36, v112
  v_mfma_f32_32x32x16_bf16 v[160:175], v[72:75], v[80:83], v[160:175]
  ds_read_b64_tr_b16 v[98:99], v42 offset:13312
  ds_read_b64_tr_b16 v[100:101], v43 offset:12288
  v_mul_f32 v113, s36, v113
  v_mul_f32 v114, s36, v114
  v_mul_f32 v115, s36, v115
  v_mul_f32 v116, s36, v116
  v_mul_f32 v117, s36, v117
  v_mfma_f32_32x32x16_bf16 v[224:239], v[72:75], v[84:87], v[224:239]
  ds_read_b64_tr_b16 v[102:103], v43 offset:13312
  v_mul_f32 v118, s36, v118
  v_mul_f32 v119, s36, v119
  v_cvt_pk_bf16_f32 v120, v112, v113
  v_cvt_pk_bf16_f32 v121, v114, v115
  v_cvt_pk_bf16_f32 v122, v116, v117
  v_mfma_f32_32x32x16_bf16 v[176:191], v[76:79], v[80:83], v[176:191]
  ds_read_b128 v[104:107], v31 offset:0
  v_cvt_pk_bf16_f32 v123, v118, v119
  s_add_u32 s38, s57, 48128
  buffer_store_dwordx4 v[120:123], v2, s[8:11], s38 offen sc1
  v_accvgpr_write_b32 a220, v120
  v_mfma_f32_32x32x16_bf16 v[240:255], v[76:79], v[84:87], v[240:255]
  ds_read_b128 v[108:111], v31 offset:16384
  v_accvgpr_write_b32 a221, v121
  v_accvgpr_write_b32 a222, v122
  v_accvgpr_write_b32 a223, v123
  s_waitcnt lgkmcnt(0)
  s_barrier
  v_mfma_f32_32x32x16_bf16 v[128:143], v[88:91], v[104:107], v[128:143]
  ds_read_b64_tr_b16 v[64:65], v32 offset:0
  ds_read_b64_tr_b16 v[66:67], v32 offset:1024
  v_mfma_f32_32x32x16_bf16 v[192:207], v[88:91], v[108:111], v[192:207]
  ds_read_b64_tr_b16 v[68:69], v33 offset:0
  v_mfma_f32_32x32x16_bf16 v[144:159], v[92:95], v[104:107], v[144:159]
  ds_read_b64_tr_b16 v[70:71], v33 offset:1024
  v_mfma_f32_32x32x16_bf16 v[208:223], v[92:95], v[108:111], v[208:223]
  ds_read_b64_tr_b16 v[72:73], v34 offset:0
  v_and_b32 v51, 7, v1
  v_lshlrev_b32 v51, 2, v51
  buffer_load_dword v50, v51, s[16:19], 0 offen sc1
  v_mfma_f32_32x32x16_bf16 v[160:175], v[96:99], v[104:107], v[160:175]
  ds_read_b64_tr_b16 v[74:75], v34 offset:1024
  ds_read_b64_tr_b16 v[76:77], v35 offset:0
  v_mfma_f32_32x32x16_bf16 v[224:239], v[96:99], v[108:111], v[224:239]
  ds_read_b64_tr_b16 v[78:79], v35 offset:1024
  v_mfma_f32_32x32x16_bf16 v[176:191], v[100:103], v[104:107], v[176:191]
  ds_read_b128 v[80:83], v20 offset:0
  v_mfma_f32_32x32x16_bf16 v[240:255], v[100:103], v[108:111], v[240:255]
  ds_read_b128 v[84:87], v20 offset:16384
  s_waitcnt lgkmcnt(0)
  v_mfma_f32_32x32x16_bf16 v[128:143], v[64:67], v[80:83], v[128:143]
  ds_read_b64_tr_b16 v[88:89], v32 offset:4096
  ds_read_b64_tr_b16 v[90:91], v32 offset:5120
  s_lshl_b32 s56, s76, 15
  s_add_u32 s56, s56, 65536
  v_add_u32 v56, s56, v2
  ds_write_b128 v56, a[0:3] offset:0
  ds_write_b128 v56, a[64:67] offset:1024
  ds_write_b128 v56, a[128:131] offset:2048
  ds_write_b128 v56, a[192:195] offset:3072
  ds_write_b128 v56, a[4:7] offset:4096
  ds_write_b128 v56, a[68:71] offset:5120
  ds_write_b128 v56, a[132:135] offset:6144
  ds_write_b128 v56, a[196:199] offset:7168
  v_mfma_f32_32x32x16_bf16 v[192:207], v[64:67], v[84:87], v[192:207]
  ds_read_b64_tr_b16 v[92:93], v33 offset:4096
  v_mfma_f32_32x32x16_bf16 v[144:159], v[68:71], v[80:83], v[144:159]
  ds_read_b64_tr_b16 v[94:95], v33 offset:5120
  v_mfma_f32_32x32x16_bf16 v[208:223], v[68:71], v[84:87], v[208:223]
  ds_read_b64_tr_b16 v[96:97], v34 offset:4096
  v_mfma_f32_32x32x16_bf16 v[160:175], v[72:75], v[80:83], v[160:175]
  ds_read_b64_tr_b16 v[98:99], v34 offset:5120
  ds_read_b64_tr_b16 v[100:101], v35 offset:4096
  v_mfma_f32_32x32x16_bf16 v[224:239], v[72:75], v[84:87], v[224:239]
  ds_read_b64_tr_b16 v[102:103], v35 offset:5120
  v_mfma_f32_32x32x16_bf16 v[176:191], v[76:79], v[80:83], v[176:191]
  ds_read_b128 v[104:107], v21 offset:0
  v_mfma_f32_32x32x16_bf16 v[240:255], v[76:79], v[84:87], v[240:255]
  ds_read_b128 v[108:111], v21 offset:16384
  s_waitcnt lgkmcnt(0)
  v_mfma_f32_32x32x16_bf16 v[128:143], v[88:91], v[104:107], v[128:143]
  ds_read_b64_tr_b16 v[64:65], v32 offset:8192
  ds_read_b64_tr_b16 v[66:67], v32 offset:9216
  s_mov_b32 s35, 0x100000
  s_lshl_b32 s39, s5, 12
  s_add_u32 s47, s39, 65536
  s_add_u32 s32, s39, 163840
  s_add_u32 s31, s39, 65536
  s_add_u32 s30, s39, 32768
  s_sub_u32 s28, 15, s4
  s_lshl_b32 s29, s28, 16
  v_add_u32 v5, s39, v2
  v_mfma_f32_32x32x16_bf16 v[192:207], v[88:91], v[108:111], v[192:207]
  ds_read_b64_tr_b16 v[68:69], v33 offset:8192
  s_waitcnt vmcnt(0)
  v_cmp_gt_u32 vcc, 32, v50
  s_nop 4
  s_cbranch_vccz F_rdy_fast
  v_and_b32 v45, 7, v1
  v_lshlrev_b32 v45, 2, v45
  s_mov_b32 s58, 0
F_rpoll:
  buffer_load_dword v44, v45, s[16:19], 0 offen sc1
  s_waitcnt vmcnt(0)
  v_cmp_gt_u32 vcc, 32, v44
  s_add_u32 s58, s58, 1
  s_nop 3
  s_cbranch_vccz F_rpoll_ok
  s_cmp_ge_u32 s58, 1048576
  s_cbranch_scc1 F_rpoll_ok
  s_sleep 4
  s_branch F_rpoll
F_rpoll_ok:
F_rdy_fast:
  v_lshlrev_b32 v51, 8, v1
  s_lshl_b32 s56, s76, 14
  s_add_u32 s56, s56, 65536
  buffer_load_dwordx4 v[112:115], v51, s[20:23], s56 offen sc1
  buffer_load_dwordx4 v[116:119], v51, s[20:23], s56 offen offset:16 sc1
  buffer_load_dwordx4 v[120:123], v51, s[20:23], s56 offen offset:128 sc1
  buffer_load_dwordx4 v[124:127], v51, s[20:23], s56 offen offset:144 sc1
  v_mfma_f32_32x32x16_bf16 v[144:159], v[92:95], v[104:107], v[144:159]
  ds_read_b64_tr_b16 v[70:71], v33 offset:9216
  v_mfma_f32_32x32x16_bf16 v[208:223], v[92:95], v[108:111], v[208:223]
  ds_read_b64_tr_b16 v[72:73], v34 offset:8192
  v_mfma_f32_32x32x16_bf16 v[160:175], v[96:99], v[104:107], v[160:175]
  ds_read_b64_tr_b16 v[74:75], v34 offset:9216
  ds_read_b64_tr_b16 v[76:77], v35 offset:8192
  v_mfma_f32_32x32x16_bf16 v[224:239], v[96:99], v[108:111], v[224:239]
  ds_read_b64_tr_b16 v[78:79], v35 offset:9216
  v_mfma_f32_32x32x16_bf16 v[176:191], v[100:103], v[104:107], v[176:191]
  ds_read_b128 v[80:83], v22 offset:0
  v_mfma_f32_32x32x16_bf16 v[240:255], v[100:103], v[108:111], v[240:255]
  ds_read_b128 v[84:87], v22 offset:16384
  s_waitcnt lgkmcnt(0)
  v_mfma_f32_32x32x16_bf16 v[128:143], v[64:67], v[80:83], v[128:143]
  ds_read_b64_tr_b16 v[88:89], v32 offset:12288
  ds_read_b64_tr_b16 v[90:91], v32 offset:13312
  ds_write_b128 v56, a[8:11] offset:8192
  ds_write_b128 v56, a[72:75] offset:9216
  ds_write_b128 v56, a[136:139] offset:10240
  ds_write_b128 v56, a[200:203] offset:11264
  ds_write_b128 v56, a[12:15] offset:12288
  ds_write_b128 v56, a[76:79] offset:13312
  ds_write_b128 v56, a[140:143] offset:14336
  ds_write_b128 v56, a[204:207] offset:15360
  v_mfma_f32_32x32x16_bf16 v[192:207], v[64:67], v[84:87], v[192:207]
  ds_read_b64_tr_b16 v[92:93], v33 offset:12288
  v_mfma_f32_32x32x16_bf16 v[144:159], v[68:71], v[80:83], v[144:159]
  ds_read_b64_tr_b16 v[94:95], v33 offset:13312
  v_mfma_f32_32x32x16_bf16 v[208:223], v[68:71], v[84:87], v[208:223]
  ds_read_b64_tr_b16 v[96:97], v34 offset:12288
  v_mfma_f32_32x32x16_bf16 v[160:175], v[72:75], v[80:83], v[160:175]
  ds_read_b64_tr_b16 v[98:99], v34 offset:13312
  ds_read_b64_tr_b16 v[100:101], v35 offset:12288
  v_mfma_f32_32x32x16_bf16 v[224:239], v[72:75], v[84:87], v[224:239]
  ds_read_b64_tr_b16 v[102:103], v35 offset:13312
  v_mfma_f32_32x32x16_bf16 v[176:191], v[76:79], v[80:83], v[176:191]
  ds_read_b128 v[104:107], v23 offset:0
  v_mfma_f32_32x32x16_bf16 v[240:255], v[76:79], v[84:87], v[240:255]
  ds_read_b128 v[108:111], v23 offset:16384
  s_waitcnt vmcnt(5) lgkmcnt(0)
  s_barrier
  v_mfma_f32_32x32x16_bf16 v[128:143], v[88:91], v[104:107], v[128:143]
  ds_read_b64_tr_b16 v[64:65], v36 offset:0
  ds_read_b64_tr_b16 v[66:67], v36 offset:1024
  s_cmp_lg_u32 s76, 0
  s_cbranch_scc1 F_noks
  s_lshl_b32 s56, s2, 7
  s_add_u32 s56, s56, 131072
  v_mov_b32 v44, 1
  v_mov_b32 v45, 0
  v_cmp_eq_u32 vcc, 0, v1
  s_and_saveexec_b64 s[40:41], vcc
  buffer_store_dword v44, v45, s[20:23], s56 offen sc1
  s_mov_b64 exec, s[40:41]
F_noks:
  v_mfma_f32_32x32x16_bf16 v[192:207], v[88:91], v[108:111], v[192:207]
  ds_read_b64_tr_b16 v[68:69], v37 offset:0
  v_mfma_f32_32x32x16_bf16 v[144:159], v[92:95], v[104:107], v[144:159]
  ds_read_b64_tr_b16 v[70:71], v37 offset:1024
  v_mfma_f32_32x32x16_bf16 v[208:223], v[92:95], v[108:111], v[208:223]
  ds_read_b64_tr_b16 v[72:73], v38 offset:0
  v_mfma_f32_32x32x16_bf16 v[160:175], v[96:99], v[104:107], v[160:175]
  ds_read_b64_tr_b16 v[74:75], v38 offset:1024
  ds_read_b64_tr_b16 v[76:77], v39 offset:0
  ds_write_b128 v56, a[16:19] offset:16384
  ds_write_b128 v56, a[80:83] offset:17408
  ds_write_b128 v56, a[144:147] offset:18432
  ds_write_b128 v56, a[208:211] offset:19456
  ds_write_b128 v56, a[20:23] offset:20480
  ds_write_b128 v56, a[84:87] offset:21504
  ds_write_b128 v56, a[148:151] offset:22528
  ds_write_b128 v56, a[212:215] offset:23552
  v_mfma_f32_32x32x16_bf16 v[224:239], v[96:99], v[108:111], v[224:239]
  ds_read_b64_tr_b16 v[78:79], v39 offset:1024
  v_mfma_f32_32x32x16_bf16 v[176:191], v[100:103], v[104:107], v[176:191]
  ds_read_b128 v[80:83], v24 offset:0
  v_mfma_f32_32x32x16_bf16 v[240:255], v[100:103], v[108:111], v[240:255]
  ds_read_b128 v[84:87], v24 offset:16384
  s_waitcnt lgkmcnt(0)
  s_waitcnt vmcnt(0)
  v_mfma_f32_32x32x16_bf16 v[128:143], v[64:67], v[80:83], v[128:143]
  ds_read_b64_tr_b16 v[88:89], v36 offset:4096
  ds_read_b64_tr_b16 v[90:91], v36 offset:5120
  v_lshlrev_b32 v52, 4, v1
  s_lshl_b32 s38, s76, 10
  v_add_u32 v52, s38, v52
  v_mov_b32 v53, v112
  v_mov_b32 v54, v52
  v_mfma_f32_32x32x16_bf16 v[192:207], v[64:67], v[84:87], v[192:207]
  ds_read_b64_tr_b16 v[92:93], v37 offset:4096
  v_cmp_gt_f32 vcc, v113, v53
  v_add_u32 v55, 1, v52
  s_nop 0
  v_cndmask_b32 v53, v53, v113, vcc
  v_cndmask_b32 v54, v54, v55, vcc
  v_mfma_f32_32x32x16_bf16 v[144:159], v[68:71], v[80:83], v[144:159]
  ds_read_b64_tr_b16 v[94:95], v37 offset:5120
  v_cmp_gt_f32 vcc, v114, v53
  v_add_u32 v55, 2, v52
  s_nop 0
  v_cndmask_b32 v53, v53, v114, vcc
  v_cndmask_b32 v54, v54, v55, vcc
  v_mfma_f32_32x32x16_bf16 v[208:223], v[68:71], v[84:87], v[208:223]
  ds_read_b64_tr_b16 v[96:97], v38 offset:4096
  v_cmp_gt_f32 vcc, v115, v53
  v_add_u32 v55, 3, v52
  s_nop 0
  v_cndmask_b32 v53, v53, v115, vcc
  v_cndmask_b32 v54, v54, v55, vcc
  v_cmp_gt_f32 vcc, v116, v53
  v_add_u32 v55, 4, v52
  s_nop 0
  v_cndmask_b32 v53, v53, v116, vcc
  v_cndmask_b32 v54, v54, v55, vcc
  v_mfma_f32_32x32x16_bf16 v[160:175], v[72:75], v[80:83], v[160:175]
  ds_read_b64_tr_b16 v[98:99], v38 offset:5120
  ds_read_b64_tr_b16 v[100:101], v39 offset:4096
  v_cmp_gt_f32 vcc, v117, v53
  v_add_u32 v55, 5, v52
  s_nop 0
  v_cndmask_b32 v53, v53, v117, vcc
  v_cndmask_b32 v54, v54, v55, vcc
  v_mfma_f32_32x32x16_bf16 v[224:239], v[72:75], v[84:87], v[224:239]
  ds_read_b64_tr_b16 v[102:103], v39 offset:5120
  v_cmp_gt_f32 vcc, v118, v53
  v_add_u32 v55, 6, v52
  s_nop 0
  v_cndmask_b32 v53, v53, v118, vcc
  v_cndmask_b32 v54, v54, v55, vcc
  v_mfma_f32_32x32x16_bf16 v[176:191], v[76:79], v[80:83], v[176:191]
  ds_read_b128 v[104:107], v25 offset:0
  v_cmp_gt_f32 vcc, v119, v53
  v_add_u32 v55, 7, v52
  s_nop 0
  v_cndmask_b32 v53, v53, v119, vcc
  v_cndmask_b32 v54, v54, v55, vcc
  v_mfma_f32_32x32x16_bf16 v[240:255], v[76:79], v[84:87], v[240:255]
  ds_read_b128 v[108:111], v25 offset:16384
  v_cmp_gt_f32 vcc, v120, v53
  v_add_u32 v55, 8, v52
  s_nop 0
  v_cndmask_b32 v53, v53, v120, vcc
  v_cndmask_b32 v54, v54, v55, vcc
  s_waitcnt lgkmcnt(0)
  v_mfma_f32_32x32x16_bf16 v[128:143], v[88:91], v[104:107], v[128:143]
  ds_read_b64_tr_b16 v[64:65], v36 offset:8192
  ds_read_b64_tr_b16 v[66:67], v36 offset:9216
  v_cmp_gt_f32 vcc, v121, v53
  v_add_u32 v55, 9, v52
  s_nop 0
  v_cndmask_b32 v53, v53, v121, vcc
  v_cndmask_b32 v54, v54, v55, vcc
  v_mfma_f32_32x32x16_bf16 v[192:207], v[88:91], v[108:111], v[192:207]
  ds_read_b64_tr_b16 v[68:69], v37 offset:8192
  v_cmp_gt_f32 vcc, v122, v53
  v_add_u32 v55, 10, v52
  s_nop 0
  v_cndmask_b32 v53, v53, v122, vcc
  v_cndmask_b32 v54, v54, v55, vcc
  v_mfma_f32_32x32x16_bf16 v[144:159], v[92:95], v[104:107], v[144:159]
  ds_read_b64_tr_b16 v[70:71], v37 offset:9216
  v_cmp_gt_f32 vcc, v123, v53
  v_add_u32 v55, 11, v52
  s_nop 0
  v_cndmask_b32 v53, v53, v123, vcc
  v_cndmask_b32 v54, v54, v55, vcc
  v_mfma_f32_32x32x16_bf16 v[208:223], v[92:95], v[108:111], v[208:223]
  ds_read_b64_tr_b16 v[72:73], v38 offset:8192
  v_cmp_gt_f32 vcc, v124, v53
  v_add_u32 v55, 12, v52
  s_nop 0
  v_cndmask_b32 v53, v53, v124, vcc
  v_cndmask_b32 v54, v54, v55, vcc
  v_mfma_f32_32x32x16_bf16 v[160:175], v[96:99], v[104:107], v[160:175]
  ds_read_b64_tr_b16 v[74:75], v38 offset:9216
  ds_read_b64_tr_b16 v[76:77], v39 offset:8192
  ds_write_b128 v56, a[24:27] offset:24576
  ds_write_b128 v56, a[88:91] offset:25600
  ds_write_b128 v56, a[152:155] offset:26624
  ds_write_b128 v56, a[216:219] offset:27648
  ds_write_b128 v56, a[28:31] offset:28672
  ds_write_b128 v56, a[92:95] offset:29696
  ds_write_b128 v56, a[156:159] offset:30720
  ds_write_b128 v56, a[220:223] offset:31744
  v_cmp_gt_f32 vcc, v125, v53
  v_add_u32 v55, 13, v52
  s_nop 0
  v_cndmask_b32 v53, v53, v125, vcc
  v_cndmask_b32 v54, v54, v55, vcc
  v_mfma_f32_32x32x16_bf16 v[224:239], v[96:99], v[108:111], v[224:239]
  ds_read_b64_tr_b16 v[78:79], v39 offset:9216
  v_cmp_gt_f32 vcc, v126, v53
  v_add_u32 v55, 14, v52
  s_nop 0
  v_cndmask_b32 v53, v53, v126, vcc
  v_cndmask_b32 v54, v54, v55, vcc
  v_mfma_f32_32x32x16_bf16 v[176:191], v[100:103], v[104:107], v[176:191]
  ds_read_b128 v[80:83], v26 offset:0
  v_cmp_gt_f32 vcc, v127, v53
  v_add_u32 v55, 15, v52
  s_nop 0
  v_cndmask_b32 v53, v53, v127, vcc
  v_cndmask_b32 v54, v54, v55, vcc
  v_mov_b32 v55, v53
  v_mfma_f32_32x32x16_bf16 v[240:255], v[100:103], v[108:111], v[240:255]
  ds_read_b128 v[84:87], v26 offset:16384
  s_nop 1
  v_max_f32_dpp v55, v55, v55 row_shr:1 row_mask:0xf bank_mask:0xf
  s_nop 1
  v_max_f32_dpp v55, v55, v55 row_shr:2 row_mask:0xf bank_mask:0xf
  s_waitcnt lgkmcnt(0)
  v_mfma_f32_32x32x16_bf16 v[128:143], v[64:67], v[80:83], v[128:143]
  ds_read_b64_tr_b16 v[88:89], v36 offset:12288
  ds_read_b64_tr_b16 v[90:91], v36 offset:13312
  s_nop 1
  v_max_f32_dpp v55, v55, v55 row_shr:4 row_mask:0xf bank_mask:0xf
  v_mfma_f32_32x32x16_bf16 v[192:207], v[64:67], v[84:87], v[192:207]
  ds_read_b64_tr_b16 v[92:93], v37 offset:12288
  s_nop 1
  v_max_f32_dpp v55, v55, v55 row_shr:8 row_mask:0xf bank_mask:0xf
  s_nop 1
  v_max_f32_dpp v55, v55, v55 row_bcast:15 row_mask:0xa bank_mask:0xf
  v_mfma_f32_32x32x16_bf16 v[144:159], v[68:71], v[80:83], v[144:159]
  ds_read_b64_tr_b16 v[94:95], v37 offset:13312
  s_nop 1
  v_max_f32_dpp v55, v55, v55 row_bcast:31 row_mask:0xc bank_mask:0xf
  v_mfma_f32_32x32x16_bf16 v[208:223], v[68:71], v[84:87], v[208:223]
  ds_read_b64_tr_b16 v[96:97], v38 offset:12288
  s_nop 1
  v_readlane_b32 s38, v55, 63
  s_nop 1
  v_cmp_eq_f32 vcc, s38, v53
  v_mov_b32 v55, 0x7fffffff
  s_nop 0
  v_cndmask_b32 v54, v55, v54, vcc
  v_mfma_f32_32x32x16_bf16 v[160:175], v[72:75], v[80:83], v[160:175]
  ds_read_b64_tr_b16 v[98:99], v38 offset:13312
  ds_read_b64_tr_b16 v[100:101], v39 offset:12288
  s_nop 1
  v_min_u32_dpp v54, v54, v54 row_shr:1 row_mask:0xf bank_mask:0xf
  s_nop 1
  v_min_u32_dpp v54, v54, v54 row_shr:2 row_mask:0xf bank_mask:0xf
  v_mfma_f32_32x32x16_bf16 v[224:239], v[72:75], v[84:87], v[224:239]
  ds_read_b64_tr_b16 v[102:103], v39 offset:13312
  s_nop 1
  v_min_u32_dpp v54, v54, v54 row_shr:4 row_mask:0xf bank_mask:0xf
  s_nop 1
  v_min_u32_dpp v54, v54, v54 row_shr:8 row_mask:0xf bank_mask:0xf
  v_mfma_f32_32x32x16_bf16 v[176:191], v[76:79], v[80:83], v[176:191]
  ds_read_b128 v[104:107], v27 offset:0
  s_nop 1
  v_min_u32_dpp v54, v54, v54 row_bcast:15 row_mask:0xa bank_mask:0xf
  s_nop 1
  v_min_u32_dpp v54, v54, v54 row_bcast:31 row_mask:0xc bank_mask:0xf
  v_mfma_f32_32x32x16_bf16 v[240:255], v[76:79], v[84:87], v[240:255]
  ds_read_b128 v[108:111], v27 offset:16384
  s_nop 1
  v_readlane_b32 s65, v54, 63
  s_mov_b32 s64, s38
  s_waitcnt lgkmcnt(0)
  s_barrier
  v_mfma_f32_32x32x16_bf16 v[128:143], v[88:91], v[104:107], v[128:143]
  v_mfma_f32_32x32x16_bf16 v[192:207], v[88:91], v[108:111], v[192:207]
  v_and_b32 v51, 7, v1
  v_lshlrev_b32 v51, 12, v51
  s_and_b32 s56, s2, 31
  s_lshl_b32 s56, s56, 7
  s_add_u32 s56, s56, 131072
  buffer_load_dword v15, v51, s[20:23], s56 offen sc1
  v_mfma_f32_32x32x16_bf16 v[144:159], v[92:95], v[104:107], v[144:159]
  v_mfma_f32_32x32x16_bf16 v[208:223], v[92:95], v[108:111], v[208:223]
  v_mfma_f32_32x32x16_bf16 v[160:175], v[96:99], v[104:107], v[160:175]
  v_mfma_f32_32x32x16_bf16 v[224:239], v[96:99], v[108:111], v[224:239]
  v_mfma_f32_32x32x16_bf16 v[176:191], v[100:103], v[104:107], v[176:191]
  v_mfma_f32_32x32x16_bf16 v[240:255], v[100:103], v[108:111], v[240:255]
  s_load_dwordx2 s[48:49], s[0:1], 112
  s_load_dwordx2 s[66:67], s[0:1], 0
  s_load_dwordx4 s[68:71], s[0:1], 64
  s_load_dwordx2 s[72:73], s[0:1], 80
  s_mov_b32 s38, 0x3e0293ee
  v_mov_b32 v56, s38
  s_nop 7
  v_cvt_pk_bf16_f32 v128, v128, v129
  v_cvt_pk_bf16_f32 v129, v130, v131
  v_cvt_pk_bf16_f32 v130, v132, v133
  v_cvt_pk_bf16_f32 v131, v134, v135
  v_cvt_pk_bf16_f32 v132, v136, v137
  v_cvt_pk_bf16_f32 v133, v138, v139
  v_cvt_pk_bf16_f32 v134, v140, v141
  v_cvt_pk_bf16_f32 v135, v142, v143
  s_nop 1
  v_permlane32_swap_b32 v128, v130
  v_permlane32_swap_b32 v129, v131
  v_permlane32_swap_b32 v132, v134
  v_permlane32_swap_b32 v133, v135
  v_permlane16_swap_b32 v128, v130
  v_permlane16_swap_b32 v129, v131
  v_permlane16_swap_b32 v132, v134
  v_permlane16_swap_b32 v133, v135
  v_accvgpr_write_b32 a128, v128
  v_accvgpr_write_b32 a129, v129
  v_accvgpr_write_b32 a130, v132
  v_accvgpr_write_b32 a131, v133
  v_accvgpr_write_b32 a144, v130
  v_accvgpr_write_b32 a145, v131
  v_accvgpr_write_b32 a146, v134
  v_accvgpr_write_b32 a147, v135
  v_cvt_pk_bf16_f32 v144, v144, v145
  v_cvt_pk_bf16_f32 v145, v146, v147
  v_cvt_pk_bf16_f32 v146, v148, v149
  v_cvt_pk_bf16_f32 v147, v150, v151
  v_cvt_pk_bf16_f32 v148, v152, v153
  v_cvt_pk_bf16_f32 v149, v154, v155
  v_cvt_pk_bf16_f32 v150, v156, v157
  v_cvt_pk_bf16_f32 v151, v158, v159
  s_nop 1
  v_permlane32_swap_b32 v144, v146
  v_permlane32_swap_b32 v145, v147
  v_permlane32_swap_b32 v148, v150
  v_permlane32_swap_b32 v149, v151
  v_permlane16_swap_b32 v144, v146
  v_permlane16_swap_b32 v145, v147
  v_permlane16_swap_b32 v148, v150
  v_permlane16_swap_b32 v149, v151
  v_accvgpr_write_b32 a132, v144
  v_accvgpr_write_b32 a133, v145
  v_accvgpr_write_b32 a134, v148
  v_accvgpr_write_b32 a135, v149
  v_accvgpr_write_b32 a148, v146
  v_accvgpr_write_b32 a149, v147
  v_accvgpr_write_b32 a150, v150
  v_accvgpr_write_b32 a151, v151
  v_cvt_pk_bf16_f32 v160, v160, v161
  v_cvt_pk_bf16_f32 v161, v162, v163
  v_cvt_pk_bf16_f32 v162, v164, v165
  v_cvt_pk_bf16_f32 v163, v166, v167
  v_cvt_pk_bf16_f32 v164, v168, v169
  v_cvt_pk_bf16_f32 v165, v170, v171
  v_cvt_pk_bf16_f32 v166, v172, v173
  v_cvt_pk_bf16_f32 v167, v174, v175
  s_nop 1
  v_permlane32_swap_b32 v160, v162
  v_permlane32_swap_b32 v161, v163
  v_permlane32_swap_b32 v164, v166
  v_permlane32_swap_b32 v165, v167
  v_permlane16_swap_b32 v160, v162
  v_permlane16_swap_b32 v161, v163
  v_permlane16_swap_b32 v164, v166
  v_permlane16_swap_b32 v165, v167
  v_accvgpr_write_b32 a136, v160
  v_accvgpr_write_b32 a137, v161
  v_accvgpr_write_b32 a138, v164
  v_accvgpr_write_b32 a139, v165
  v_accvgpr_write_b32 a152, v162
  v_accvgpr_write_b32 a153, v163
  v_accvgpr_write_b32 a154, v166
  v_accvgpr_write_b32 a155, v167
  v_cvt_pk_bf16_f32 v176, v176, v177
  v_cvt_pk_bf16_f32 v177, v178, v179
  v_cvt_pk_bf16_f32 v178, v180, v181
  v_cvt_pk_bf16_f32 v179, v182, v183
  v_cvt_pk_bf16_f32 v180, v184, v185
  v_cvt_pk_bf16_f32 v181, v186, v187
  v_cvt_pk_bf16_f32 v182, v188, v189
  v_cvt_pk_bf16_f32 v183, v190, v191
  s_nop 1
  v_permlane32_swap_b32 v176, v178
  v_permlane32_swap_b32 v177, v179
  v_permlane32_swap_b32 v180, v182
  v_permlane32_swap_b32 v181, v183
  v_permlane16_swap_b32 v176, v178
  v_permlane16_swap_b32 v177, v179
  v_permlane16_swap_b32 v180, v182
  v_permlane16_swap_b32 v181, v183
  v_accvgpr_write_b32 a140, v176
  v_accvgpr_write_b32 a141, v177
  v_accvgpr_write_b32 a142, v180
  v_accvgpr_write_b32 a143, v181
  v_accvgpr_write_b32 a156, v178
  v_accvgpr_write_b32 a157, v179
  v_accvgpr_write_b32 a158, v182
  v_accvgpr_write_b32 a159, v183
  v_cvt_pk_bf16_f32 v192, v192, v193
  v_cvt_pk_bf16_f32 v193, v194, v195
  v_cvt_pk_bf16_f32 v194, v196, v197
  v_cvt_pk_bf16_f32 v195, v198, v199
  v_cvt_pk_bf16_f32 v196, v200, v201
  v_cvt_pk_bf16_f32 v197, v202, v203
  v_cvt_pk_bf16_f32 v198, v204, v205
  v_cvt_pk_bf16_f32 v199, v206, v207
  s_nop 1
  v_permlane32_swap_b32 v192, v194
  v_permlane32_swap_b32 v193, v195
  v_permlane32_swap_b32 v196, v198
  v_permlane32_swap_b32 v197, v199
  v_permlane16_swap_b32 v192, v194
  v_permlane16_swap_b32 v193, v195
  v_permlane16_swap_b32 v196, v198
  v_permlane16_swap_b32 v197, v199
  v_accvgpr_write_b32 a160, v192
  v_accvgpr_write_b32 a161, v193
  v_accvgpr_write_b32 a162, v196
  v_accvgpr_write_b32 a163, v197
  v_accvgpr_write_b32 a176, v194
  v_accvgpr_write_b32 a177, v195
  v_accvgpr_write_b32 a178, v198
  v_accvgpr_write_b32 a179, v199
  v_cvt_pk_bf16_f32 v208, v208, v209
  v_cvt_pk_bf16_f32 v209, v210, v211
  v_cvt_pk_bf16_f32 v210, v212, v213
  v_cvt_pk_bf16_f32 v211, v214, v215
  v_cvt_pk_bf16_f32 v212, v216, v217
  v_cvt_pk_bf16_f32 v213, v218, v219
  v_cvt_pk_bf16_f32 v214, v220, v221
  v_cvt_pk_bf16_f32 v215, v222, v223
  s_nop 1
  v_permlane32_swap_b32 v208, v210
  v_permlane32_swap_b32 v209, v211
  v_permlane32_swap_b32 v212, v214
  v_permlane32_swap_b32 v213, v215
  v_permlane16_swap_b32 v208, v210
  v_permlane16_swap_b32 v209, v211
  v_permlane16_swap_b32 v212, v214
  v_permlane16_swap_b32 v213, v215
  v_accvgpr_write_b32 a164, v208
  v_accvgpr_write_b32 a165, v209
  v_accvgpr_write_b32 a166, v212
  v_accvgpr_write_b32 a167, v213
  v_accvgpr_write_b32 a180, v210
  v_accvgpr_write_b32 a181, v211
  v_accvgpr_write_b32 a182, v214
  v_accvgpr_write_b32 a183, v215
  v_cvt_pk_bf16_f32 v224, v224, v225
  v_cvt_pk_bf16_f32 v225, v226, v227
  v_cvt_pk_bf16_f32 v226, v228, v229
  v_cvt_pk_bf16_f32 v227, v230, v231
  v_cvt_pk_bf16_f32 v228, v232, v233
  v_cvt_pk_bf16_f32 v229, v234, v235
  v_cvt_pk_bf16_f32 v230, v236, v237
  v_cvt_pk_bf16_f32 v231, v238, v239
  s_nop 1
  v_permlane32_swap_b32 v224, v226
  v_permlane32_swap_b32 v225, v227
  v_permlane32_swap_b32 v228, v230
  v_permlane32_swap_b32 v229, v231
  v_permlane16_swap_b32 v224, v226
  v_permlane16_swap_b32 v225, v227
  v_permlane16_swap_b32 v228, v230
  v_permlane16_swap_b32 v229, v231
  v_accvgpr_write_b32 a168, v224
  v_accvgpr_write_b32 a169, v225
  v_accvgpr_write_b32 a170, v228
  v_accvgpr_write_b32 a171, v229
  v_accvgpr_write_b32 a184, v226
  v_accvgpr_write_b32 a185, v227
  v_accvgpr_write_b32 a186, v230
  v_accvgpr_write_b32 a187, v231
  v_cvt_pk_bf16_f32 v240, v240, v241
  v_cvt_pk_bf16_f32 v241, v242, v243
  v_cvt_pk_bf16_f32 v242, v244, v245
  v_cvt_pk_bf16_f32 v243, v246, v247
  v_cvt_pk_bf16_f32 v244, v248, v249
  v_cvt_pk_bf16_f32 v245, v250, v251
  v_cvt_pk_bf16_f32 v246, v252, v253
  v_cvt_pk_bf16_f32 v247, v254, v255
  s_nop 1
  v_permlane32_swap_b32 v240, v242
  v_permlane32_swap_b32 v241, v243
  v_permlane32_swap_b32 v244, v246
  v_permlane32_swap_b32 v245, v247
  v_permlane16_swap_b32 v240, v242
  v_permlane16_swap_b32 v241, v243
  v_permlane16_swap_b32 v244, v246
  v_permlane16_swap_b32 v245, v247
  v_accvgpr_write_b32 a172, v240
  v_accvgpr_write_b32 a173, v241
  v_accvgpr_write_b32 a174, v244
  v_accvgpr_write_b32 a175, v245
  v_accvgpr_write_b32 a188, v242
  v_accvgpr_write_b32 a189, v243
  v_accvgpr_write_b32 a190, v246
  v_accvgpr_write_b32 a191, v247
  v_mov_b32 v8, 0xff800000
  s_mov_b32 s36, 0x4e800000
  v_mov_b32 v32, 0
  v_mov_b32 v33, 0
  v_mov_b32 v34, 0
  v_mov_b32 v35, 0
  v_mov_b32 v36, 0
  v_mov_b32 v37, 0
  v_mov_b32 v38, 0
  v_mov_b32 v39, 0
  v_mov_b32 v40, 0
  v_mov_b32 v41, 0
  v_mov_b32 v42, 0
  v_mov_b32 v43, 0
  v_mov_b32 v44, 0
  v_mov_b32 v45, 0
  v_mov_b32 v46, 0
  v_mov_b32 v47, 0
  v_mov_b32 v60, 0x3f803f80
  v_mov_b32 v61, 0x3f803f80
  v_mov_b32 v62, 0x3f803f80
  v_mov_b32 v63, 0x3f803f80
  v_and_b32 v6, 15, v1
  v_lshrrev_b32 v56, 4, v1
  v_lshlrev_b32 v56, 2, v56
  v_sub_u32 v6, v6, v56
  s_lshl_b32 s38, s5, 5
  v_add_u32 v6, s38, v6
  v_subrev_u32 v7, 64, v6
  v_add_u32 v9, 16, v6
  v_subrev_u32 v10, 64, v9
  v_mov_b32 v48, 0
  v_mov_b32 v49, 0
  v_mov_b32 v50, 0
  v_mov_b32 v51, 0
  s_nop 1
  v_mfma_f32_32x32x16_bf16 a[0:15], v[48:51], v[48:51], 0
  v_mfma_f32_32x32x16_bf16 a[16:31], v[48:51], v[48:51], 0
  v_mfma_f32_32x32x16_bf16 a[32:47], v[48:51], v[48:51], 0
  v_mfma_f32_32x32x16_bf16 a[48:63], v[48:51], v[48:51], 0
  v_mfma_f32_32x32x16_bf16 a[64:79], v[48:51], v[48:51], 0
  v_mfma_f32_32x32x16_bf16 a[80:95], v[48:51], v[48:51], 0
  v_mfma_f32_32x32x16_bf16 a[96:111], v[48:51], v[48:51], 0
  v_mfma_f32_32x32x16_bf16 a[112:127], v[48:51], v[48:51], 0
  s_waitcnt lgkmcnt(0)
  s_barrier
  v_add_u32 v57, 98304, v2
  v_add_u32 v3, 65536, v2
  ds_read_b128 a[192:195], v3 offset:0
  ds_read_b128 a[196:199], v3 offset:1024
  ds_read_b128 a[200:203], v3 offset:2048
  ds_read_b128 a[204:207], v3 offset:3072
  ds_read_b128 a[224:227], v57 offset:0
  ds_read_b128 a[228:231], v57 offset:1024
  ds_read_b128 a[232:235], v57 offset:2048
  ds_read_b128 a[236:239], v57 offset:3072
  s_add_u32 s16, s48, 0x3000000
  s_addc_u32 s17, s49, 0
  s_mov_b32 s18, 0x1000000
  s_mov_b32 s19, 0x20000
  s_sub_u32 s60, 15, s4
  s_lshl_b32 s60, s60, 16
  s_lshl_b32 s61, s4, 1
  s_sub_u32 s61, s61, 14
  s_lshl_b32 s61, s61, 16
  s_lshl_b32 s28, s4, 16
  s_sub_u32 s29, s28, 65536
  s_cmp_lt_i32 s29, 0
  s_cselect_b32 s62, s60, 0
  s_add_u32 s29, s29, s62
  s_waitcnt vmcnt(0)
  v_cmp_ne_u32 vcc, 1, v15
  s_nop 4
  s_cbranch_vccz F_kf_fast
  v_and_b32 v59, 7, v1
  v_lshlrev_b32 v59, 12, v59
  s_and_b32 s56, s2, 31
  s_lshl_b32 s56, s56, 7
  s_add_u32 s56, s56, 131072
  s_mov_b32 s58, 0
F_kpoll:
  buffer_load_dword v58, v59, s[20:23], s56 offen sc1
  s_waitcnt vmcnt(0)
  v_cmp_ne_u32 vcc, 1, v58
  s_add_u32 s58, s58, 1
  s_nop 3
  s_cbranch_vccz F_kpoll_ok
  s_cmp_ge_u32 s58, 1048576
  s_cbranch_scc1 F_kpoll_ok
  s_sleep 4
  s_branch F_kpoll
F_kpoll_ok:
F_kf_fast:
  s_waitcnt lgkmcnt(0)
  v_mfma_f32_16x16x32_bf16 v[160:163], a[192:195], a[128:131], 0
  v_mfma_f32_16x16x32_bf16 v[160:163], a[196:199], a[132:135], v[160:163]
  v_mfma_f32_16x16x32_bf16 v[160:163], a[200:203], a[136:139], v[160:163]
  v_mfma_f32_16x16x32_bf16 v[160:163], a[204:207], a[140:143], v[160:163]
  v_mfma_f32_16x16x32_bf16 v[164:167], a[192:195], a[144:147], 0
  v_mfma_f32_16x16x32_bf16 v[164:167], a[196:199], a[148:151], v[164:167]
  v_mfma_f32_16x16x32_bf16 v[164:167], a[200:203], a[152:155], v[164:167]
  v_mfma_f32_16x16x32_bf16 v[164:167], a[204:207], a[156:159], v[164:167]
  v_mfma_f32_16x16x32_bf16 v[176:179], a[224:227], a[160:163], 0
  v_mfma_f32_16x16x32_bf16 v[176:179], a[228:231], a[164:167], v[176:179]
  v_mfma_f32_16x16x32_bf16 v[176:179], a[232:235], a[168:171], v[176:179]
  v_mfma_f32_16x16x32_bf16 v[176:179], a[236:239], a[172:175], v[176:179]
  v_mfma_f32_16x16x32_bf16 v[180:183], a[224:227], a[176:179], 0
  v_mfma_f32_16x16x32_bf16 v[180:183], a[228:231], a[180:183], v[180:183]
  v_mfma_f32_16x16x32_bf16 v[180:183], a[232:235], a[184:187], v[180:183]
  v_mfma_f32_16x16x32_bf16 v[180:183], a[236:239], a[188:191], v[180:183]
  s_nop 7
  v_cmp_gt_i32_e64 s[40:41], 0, v6
  v_cmp_gt_i32_e64 s[42:43], 1, v6
  v_cmp_gt_i32_e64 s[44:45], 2, v6
  v_cndmask_b32_e64 v160, v160, v8, s[40:41]
  v_cndmask_b32_e64 v161, v161, v8, s[42:43]
  v_cndmask_b32_e64 v162, v162, v8, s[44:45]
  v_cmp_gt_i32_e64 s[40:41], 3, v6
  s_nop 1
  v_cndmask_b32_e64 v163, v163, v8, s[40:41]
  v_max_f32 v56, v160, v161
  v_max3_f32 v56, v56, v162, v163
  v_mov_b32 v57, v56
  s_nop 1
  v_permlane32_swap_b32 v56, v57
  s_nop 1
  v_max_f32 v56, v56, v57
  v_mov_b32 v57, v56
  s_nop 1
  v_permlane16_swap_b32 v56, v57
  s_nop 1
  v_max_f32 v56, v56, v57
  v_sub_f32 v16, 0, v56
  v_sub_f32 v17, 0, v56
  v_sub_f32 v18, 0, v56
  v_sub_f32 v19, 0, v56
  v_cmp_gt_i32_e64 s[40:41], 0, v9
  v_cmp_gt_i32_e64 s[42:43], 1, v9
  v_cmp_gt_i32_e64 s[44:45], 2, v9
  v_cndmask_b32_e64 v164, v164, v8, s[40:41]
  v_cndmask_b32_e64 v165, v165, v8, s[42:43]
  v_cndmask_b32_e64 v166, v166, v8, s[44:45]
  v_cmp_gt_i32_e64 s[40:41], 3, v9
  s_nop 1
  v_cndmask_b32_e64 v167, v167, v8, s[40:41]
  v_max_f32 v56, v164, v165
  v_max3_f32 v56, v56, v166, v167
  v_mov_b32 v57, v56
  s_nop 1
  v_permlane32_swap_b32 v56, v57
  s_nop 1
  v_max_f32 v56, v56, v57
  v_mov_b32 v57, v56
  s_nop 1
  v_permlane16_swap_b32 v56, v57
  s_nop 1
  v_max_f32 v56, v56, v57
  v_sub_f32 v20, 0, v56
  v_sub_f32 v21, 0, v56
  v_sub_f32 v22, 0, v56
  v_sub_f32 v23, 0, v56
  v_add_u32 v3, 65536, v2
  ds_read_b128 a[192:195], v3 offset:0
  ds_read_b128 a[196:199], v3 offset:1024
  ds_read_b128 a[200:203], v3 offset:2048
  ds_read_b128 a[204:207], v3 offset:3072
  ds_read_b128 a[208:211], v3 offset:4096
  ds_read_b128 a[212:215], v3 offset:5120
  ds_read_b128 a[216:219], v3 offset:6144
  ds_read_b128 a[220:223], v3 offset:7168
  s_mov_b32 s33, 98304
  s_mov_b32 s34, 0
  s_waitcnt lgkmcnt(4)
  v_mfma_f32_16x16x32_bf16 v[64:67], a[192:195], a[128:131], v[16:19]
  ds_read_b128 a[224:227], v3 offset:8192
  s_add_u32 s56, s29, 0
  s_add_u32 m0, s55, 131072
  s_nop 0
  buffer_load_dwordx4 v14, s[8:11], s56 offen offset:0 lds
  v_mfma_f32_16x16x32_bf16 v[96:99], a[192:195], a[144:147], v[20:23]
  buffer_load_dwordx4 v14, s[8:11], s56 offen offset:1024 lds
  v_mfma_f32_16x16x32_bf16 v[64:67], a[196:199], a[132:135], v[64:67]
  ds_read_b128 a[228:231], v3 offset:9216
  buffer_load_dwordx4 v14, s[8:11], s56 offen offset:2048 lds
  v_mfma_f32_16x16x32_bf16 v[96:99], a[196:199], a[148:151], v[96:99]
  buffer_load_dwordx4 v14, s[8:11], s56 offen offset:3072 lds
  v_mfma_f32_16x16x32_bf16 v[64:67], a[200:203], a[136:139], v[64:67]
  ds_read_b128 a[232:235], v3 offset:10240
  s_add_u32 s56, s29, 4096
  s_add_u32 m0, s55, 135168
  s_nop 0
  buffer_load_dwordx4 v14, s[8:11], s56 offen offset:0 lds
  v_mfma_f32_16x16x32_bf16 v[96:99], a[200:203], a[152:155], v[96:99]
  buffer_load_dwordx4 v14, s[8:11], s56 offen offset:1024 lds
  v_mfma_f32_16x16x32_bf16 v[64:67], a[204:207], a[140:143], v[64:67]
  ds_read_b128 a[236:239], v3 offset:11264
  buffer_load_dwordx4 v14, s[8:11], s56 offen offset:2048 lds
  v_mfma_f32_16x16x32_bf16 v[96:99], a[204:207], a[156:159], v[96:99]
  s_waitcnt lgkmcnt(4)
  buffer_load_dwordx4 v14, s[8:11], s56 offen offset:3072 lds
  v_mfma_f32_16x16x32_bf16 v[68:71], a[208:211], a[128:131], v[16:19]
  ds_read_b128 a[240:243], v3 offset:12288
  s_add_u32 s56, s29, 32768
  s_add_u32 m0, s55, 147456
  s_nop 0
  buffer_load_dwordx4 v14, s[8:11], s56 offen offset:0 lds
  v_mfma_f32_16x16x32_bf16 v[100:103], a[208:211], a[144:147], v[20:23]
  buffer_load_dwordx4 v14, s[8:11], s56 offen offset:1024 lds
  v_mfma_f32_16x16x32_bf16 v[68:71], a[212:215], a[132:135], v[68:71]
  ds_read_b128 a[244:247], v3 offset:13312
  buffer_load_dwordx4 v14, s[8:11], s56 offen offset:2048 lds
  v_mfma_f32_16x16x32_bf16 v[100:103], a[212:215], a[148:151], v[100:103]
  buffer_load_dwordx4 v14, s[8:11], s56 offen offset:3072 lds
  v_mfma_f32_16x16x32_bf16 v[68:71], a[216:219], a[136:139], v[68:71]
  ds_read_b128 a[248:251], v3 offset:14336
  s_add_u32 s56, s29, 36864
  s_add_u32 m0, s55, 151552
  s_nop 0
  buffer_load_dwordx4 v14, s[8:11], s56 offen offset:0 lds
  v_mfma_f32_16x16x32_bf16 v[100:103], a[216:219], a[152:155], v[100:103]
  buffer_load_dwordx4 v14, s[8:11], s56 offen offset:1024 lds
  v_mfma_f32_16x16x32_bf16 v[68:71], a[220:223], a[140:143], v[68:71]
  ds_read_b128 a[252:255], v3 offset:15360
  buffer_load_dwordx4 v14, s[8:11], s56 offen offset:2048 lds
  v_mfma_f32_16x16x32_bf16 v[100:103], a[220:223], a[156:159], v[100:103]
  s_waitcnt lgkmcnt(4)
  buffer_load_dwordx4 v14, s[8:11], s56 offen offset:3072 lds
  v_mfma_f32_16x16x32_bf16 v[72:75], a[224:227], a[128:131], v[16:19]
  ds_read_b128 a[192:195], v3 offset:16384
  v_mfma_f32_16x16x32_bf16 v[104:107], a[224:227], a[144:147], v[20:23]
  v_mfma_f32_16x16x32_bf16 v[72:75], a[228:231], a[132:135], v[72:75]
  ds_read_b128 a[196:199], v3 offset:17408
  v_mfma_f32_16x16x32_bf16 v[104:107], a[228:231], a[148:151], v[104:107]
  v_mfma_f32_16x16x32_bf16 v[72:75], a[232:235], a[136:139], v[72:75]
  ds_read_b128 a[200:203], v3 offset:18432
  v_cmp_gt_i32_e64 s[40:41], 0, v6
  v_cmp_gt_i32_e64 s[42:43], 1, v6
  v_cmp_gt_i32_e64 s[44:45], 2, v6
  v_cndmask_b32_e64 v176, v176, v8, s[40:41]
  v_cndmask_b32_e64 v177, v177, v8, s[42:43]
  v_cndmask_b32_e64 v178, v178, v8, s[44:45]
  v_cmp_gt_i32_e64 s[40:41], 3, v6
  s_nop 1
  v_cndmask_b32_e64 v179, v179, v8, s[40:41]
  v_mfma_f32_16x16x32_bf16 v[104:107], a[232:235], a[152:155], v[104:107]
  v_mfma_f32_16x16x32_bf16 v[72:75], a[236:239], a[140:143], v[72:75]
  ds_read_b128 a[204:207], v3 offset:19456
  v_mfma_f32_16x16x32_bf16 v[104:107], a[236:239], a[156:159], v[104:107]
  s_waitcnt lgkmcnt(4)
  v_mfma_f32_16x16x32_bf16 v[76:79], a[240:243], a[128:131], v[16:19]
  ds_read_b128 a[208:211], v3 offset:20480
  v_mfma_f32_16x16x32_bf16 v[108:111], a[240:243], a[144:147], v[20:23]
  v_max_f32 v58, v176, v177
  v_mfma_f32_16x16x32_bf16 v[76:79], a[244:247], a[132:135], v[76:79]
  ds_read_b128 a[212:215], v3 offset:21504
  v_max3_f32 v58, v58, v178, v179
  v_mfma_f32_16x16x32_bf16 v[108:111], a[244:247], a[148:151], v[108:111]
  v_mfma_f32_16x16x32_bf16 v[76:79], a[248:251], a[136:139], v[76:79]
  ds_read_b128 a[216:219], v3 offset:22528
  v_mfma_f32_16x16x32_bf16 v[108:111], a[248:251], a[152:155], v[108:111]
  v_mfma_f32_16x16x32_bf16 v[76:79], a[252:255], a[140:143], v[76:79]
  ds_read_b128 a[220:223], v3 offset:23552
  v_mfma_f32_16x16x32_bf16 v[108:111], a[252:255], a[156:159], v[108:111]
  s_waitcnt lgkmcnt(4)
  v_mfma_f32_16x16x32_bf16 v[80:83], a[192:195], a[128:131], v[16:19]
  ds_read_b128 a[224:227], v3 offset:24576
  v_mov_b32 v59, v58
  s_nop 1
  v_permlane32_swap_b32 v58, v59
  s_nop 1
  v_max_f32 v58, v58, v59
  v_mov_b32 v59, v58
  s_nop 1
  v_permlane16_swap_b32 v58, v59
  s_nop 1
  v_max_f32 v58, v58, v59
  v_mfma_f32_16x16x32_bf16 v[112:115], a[192:195], a[144:147], v[20:23]
  v_mfma_f32_16x16x32_bf16 v[80:83], a[196:199], a[132:135], v[80:83]
  ds_read_b128 a[228:231], v3 offset:25600
  v_mfma_f32_16x16x32_bf16 v[112:115], a[196:199], a[148:151], v[112:115]
  v_mfma_f32_16x16x32_bf16 v[80:83], a[200:203], a[136:139], v[80:83]
  ds_read_b128 a[232:235], v3 offset:26624
  v_mfma_f32_16x16x32_bf16 v[112:115], a[200:203], a[152:155], v[112:115]
  v_mfma_f32_16x16x32_bf16 v[80:83], a[204:207], a[140:143], v[80:83]
  ds_read_b128 a[236:239], v3 offset:27648
  v_sub_f32 v24, 0, v58
  v_mfma_f32_16x16x32_bf16 v[112:115], a[204:207], a[156:159], v[112:115]
  s_waitcnt lgkmcnt(4)
  v_sub_f32 v25, 0, v58
  v_mfma_f32_16x16x32_bf16 v[84:87], a[208:211], a[128:131], v[16:19]
  ds_read_b128 a[240:243], v3 offset:28672
  v_sub_f32 v26, 0, v58
  v_mfma_f32_16x16x32_bf16 v[116:119], a[208:211], a[144:147], v[20:23]
  v_sub_f32 v27, 0, v58
  v_mfma_f32_16x16x32_bf16 v[84:87], a[212:215], a[132:135], v[84:87]
  ds_read_b128 a[244:247], v3 offset:29696
  v_mfma_f32_16x16x32_bf16 v[116:119], a[212:215], a[148:151], v[116:119]
  v_mfma_f32_16x16x32_bf16 v[84:87], a[216:219], a[136:139], v[84:87]
  ds_read_b128 a[248:251], v3 offset:30720
  v_mfma_f32_16x16x32_bf16 v[116:119], a[216:219], a[152:155], v[116:119]
  v_mfma_f32_16x16x32_bf16 v[84:87], a[220:223], a[140:143], v[84:87]
  ds_read_b128 a[252:255], v3 offset:31744
  v_cmp_gt_i32_e64 s[40:41], 0, v9
  v_cmp_gt_i32_e64 s[42:43], 1, v9
  v_cmp_gt_i32_e64 s[44:45], 2, v9
  v_cndmask_b32_e64 v180, v180, v8, s[40:41]
  v_cndmask_b32_e64 v181, v181, v8, s[42:43]
  v_cndmask_b32_e64 v182, v182, v8, s[44:45]
  v_cmp_gt_i32_e64 s[40:41], 3, v9
  s_nop 1
  v_cndmask_b32_e64 v183, v183, v8, s[40:41]
  v_mfma_f32_16x16x32_bf16 v[116:119], a[220:223], a[156:159], v[116:119]
  s_waitcnt lgkmcnt(4)
  v_mfma_f32_16x16x32_bf16 v[88:91], a[224:227], a[128:131], v[16:19]
  v_mfma_f32_16x16x32_bf16 v[120:123], a[224:227], a[144:147], v[20:23]
  v_mfma_f32_16x16x32_bf16 v[88:91], a[228:231], a[132:135], v[88:91]
  v_max_f32 v58, v180, v181
  v_mfma_f32_16x16x32_bf16 v[120:123], a[228:231], a[148:151], v[120:123]
  v_max3_f32 v58, v58, v182, v183
  v_mfma_f32_16x16x32_bf16 v[88:91], a[232:235], a[136:139], v[88:91]
  v_mfma_f32_16x16x32_bf16 v[120:123], a[232:235], a[152:155], v[120:123]
  v_mfma_f32_16x16x32_bf16 v[88:91], a[236:239], a[140:143], v[88:91]
  v_mfma_f32_16x16x32_bf16 v[120:123], a[236:239], a[156:159], v[120:123]
  s_waitcnt lgkmcnt(1)
  v_mov_b32 v59, v58
  s_nop 1
  v_permlane32_swap_b32 v58, v59
  s_nop 1
  v_max_f32 v58, v58, v59
  v_mov_b32 v59, v58
  s_nop 1
  v_permlane16_swap_b32 v58, v59
  s_nop 1
  v_max_f32 v58, v58, v59
  v_mfma_f32_16x16x32_bf16 v[92:95], a[240:243], a[128:131], v[16:19]
  v_mfma_f32_16x16x32_bf16 v[124:127], a[240:243], a[144:147], v[20:23]
  v_mfma_f32_16x16x32_bf16 v[92:95], a[244:247], a[132:135], v[92:95]
  v_mfma_f32_16x16x32_bf16 v[124:127], a[244:247], a[148:151], v[124:127]
  v_mfma_f32_16x16x32_bf16 v[92:95], a[248:251], a[136:139], v[92:95]
  v_sub_f32 v28, 0, v58
  v_mfma_f32_16x16x32_bf16 v[124:127], a[248:251], a[152:155], v[124:127]
  s_waitcnt lgkmcnt(0)
  v_sub_f32 v29, 0, v58
  v_sub_f32 v30, 0, v58
  v_mfma_f32_16x16x32_bf16 v[92:95], a[252:255], a[140:143], v[92:95]
  v_sub_f32 v31, 0, v58
  v_mfma_f32_16x16x32_bf16 v[124:127], a[252:255], a[156:159], v[124:127]
  v_cmp_gt_i32_e64 s[40:41], 0, v6
  v_cmp_gt_i32_e64 s[42:43], 1, v6
  v_cmp_gt_i32_e64 s[44:45], 2, v6
  v_cndmask_b32_e64 v64, v64, v8, s[40:41]
  v_cndmask_b32_e64 v65, v65, v8, s[42:43]
  v_cndmask_b32_e64 v66, v66, v8, s[44:45]
  v_cmp_gt_i32_e64 s[40:41], 3, v6
  v_cmp_gt_i32_e64 s[42:43], 0, v9
  v_cmp_gt_i32_e64 s[44:45], 1, v9
  v_cndmask_b32_e64 v67, v67, v8, s[40:41]
  v_cndmask_b32_e64 v96, v96, v8, s[42:43]
  v_cndmask_b32_e64 v97, v97, v8, s[44:45]
  v_cmp_gt_i32_e64 s[40:41], 2, v9
  v_cmp_gt_i32_e64 s[42:43], 3, v9
  v_cmp_gt_i32_e64 s[44:45], 16, v6
  v_cndmask_b32_e64 v98, v98, v8, s[40:41]
  v_cndmask_b32_e64 v99, v99, v8, s[42:43]
  v_cndmask_b32_e64 v68, v68, v8, s[44:45]
  v_cmp_gt_i32_e64 s[40:41], 17, v6
  v_cmp_gt_i32_e64 s[42:43], 18, v6
  v_cmp_gt_i32_e64 s[44:45], 19, v6
  v_cndmask_b32_e64 v69, v69, v8, s[40:41]
  v_cndmask_b32_e64 v70, v70, v8, s[42:43]
  v_cndmask_b32_e64 v71, v71, v8, s[44:45]
  v_cmp_gt_i32_e64 s[40:41], 16, v9
  v_cmp_gt_i32_e64 s[42:43], 17, v9
  v_cmp_gt_i32_e64 s[44:45], 18, v9
  v_cndmask_b32_e64 v100, v100, v8, s[40:41]
  v_cndmask_b32_e64 v101, v101, v8, s[42:43]
  v_cndmask_b32_e64 v102, v102, v8, s[44:45]
  v_cmp_gt_i32_e64 s[40:41], 19, v9
  v_cmp_gt_i32_e64 s[42:43], 32, v6
  v_cmp_gt_i32_e64 s[44:45], 33, v6
  v_cndmask_b32_e64 v103, v103, v8, s[40:41]
  v_cndmask_b32_e64 v72, v72, v8, s[42:43]
  v_cndmask_b32_e64 v73, v73, v8, s[44:45]
  v_cmp_gt_i32_e64 s[40:41], 34, v6
  v_cmp_gt_i32_e64 s[42:43], 35, v6
  v_cmp_gt_i32_e64 s[44:45], 32, v9
  v_cndmask_b32_e64 v74, v74, v8, s[40:41]
  v_cndmask_b32_e64 v75, v75, v8, s[42:43]
  v_cndmask_b32_e64 v104, v104, v8, s[44:45]
  v_cmp_gt_i32_e64 s[40:41], 33, v9
  v_cmp_gt_i32_e64 s[42:43], 34, v9
  v_cmp_gt_i32_e64 s[44:45], 35, v9
  v_cndmask_b32_e64 v105, v105, v8, s[40:41]
  v_cndmask_b32_e64 v106, v106, v8, s[42:43]
  v_cndmask_b32_e64 v107, v107, v8, s[44:45]
  v_cmp_gt_i32_e64 s[40:41], 48, v6
  v_cmp_gt_i32_e64 s[42:43], 49, v6
  v_cmp_gt_i32_e64 s[44:45], 50, v6
  v_cndmask_b32_e64 v76, v76, v8, s[40:41]
  v_cndmask_b32_e64 v77, v77, v8, s[42:43]
  v_cndmask_b32_e64 v78, v78, v8, s[44:45]
  v_cmp_gt_i32_e64 s[40:41], 51, v6
  v_cmp_gt_i32_e64 s[42:43], 48, v9
  v_cmp_gt_i32_e64 s[44:45], 49, v9
  v_cndmask_b32_e64 v79, v79, v8, s[40:41]
  v_cndmask_b32_e64 v108, v108, v8, s[42:43]
  v_cndmask_b32_e64 v109, v109, v8, s[44:45]
  v_cmp_gt_i32_e64 s[40:41], 50, v9
  v_cmp_gt_i32_e64 s[42:43], 51, v9
  v_cmp_gt_i32_e64 s[44:45], 0, v7
  v_cndmask_b32_e64 v110, v110, v8, s[40:41]
  v_cndmask_b32_e64 v111, v111, v8, s[42:43]
  v_cndmask_b32_e64 v80, v80, v8, s[44:45]
  v_cmp_gt_i32_e64 s[40:41], 1, v7
  v_cmp_gt_i32_e64 s[42:43], 2, v7
  v_cmp_gt_i32_e64 s[44:45], 3, v7
  v_cndmask_b32_e64 v81, v81, v8, s[40:41]
  v_cndmask_b32_e64 v82, v82, v8, s[42:43]
  v_cndmask_b32_e64 v83, v83, v8, s[44:45]
  v_cmp_gt_i32_e64 s[40:41], 0, v10
  v_cmp_gt_i32_e64 s[42:43], 1, v10
  v_cmp_gt_i32_e64 s[44:45], 2, v10
  v_cndmask_b32_e64 v112, v112, v8, s[40:41]
  v_cndmask_b32_e64 v113, v113, v8, s[42:43]
  v_cndmask_b32_e64 v114, v114, v8, s[44:45]
  v_cmp_gt_i32_e64 s[40:41], 3, v10
  v_cmp_gt_i32_e64 s[42:43], 16, v7
  v_cmp_gt_i32_e64 s[44:45], 17, v7
  v_cndmask_b32_e64 v115, v115, v8, s[40:41]
  v_cndmask_b32_e64 v84, v84, v8, s[42:43]
  v_cndmask_b32_e64 v85, v85, v8, s[44:45]
  v_cmp_gt_i32_e64 s[40:41], 18, v7
  v_cmp_gt_i32_e64 s[42:43], 19, v7
  v_cmp_gt_i32_e64 s[44:45], 16, v10
  v_cndmask_b32_e64 v86, v86, v8, s[40:41]
  v_cndmask_b32_e64 v87, v87, v8, s[42:43]
  v_cndmask_b32_e64 v116, v116, v8, s[44:45]
  v_cmp_gt_i32_e64 s[40:41], 17, v10
  v_cmp_gt_i32_e64 s[42:43], 18, v10
  v_cmp_gt_i32_e64 s[44:45], 19, v10
  v_cndmask_b32_e64 v117, v117, v8, s[40:41]
  v_cndmask_b32_e64 v118, v118, v8, s[42:43]
  v_cndmask_b32_e64 v119, v119, v8, s[44:45]
  v_cmp_gt_i32_e64 s[40:41], 32, v7
  v_cmp_gt_i32_e64 s[42:43], 33, v7
  v_cmp_gt_i32_e64 s[44:45], 34, v7
  v_cndmask_b32_e64 v88, v88, v8, s[40:41]
  v_cndmask_b32_e64 v89, v89, v8, s[42:43]
  v_cndmask_b32_e64 v90, v90, v8, s[44:45]
  v_cmp_gt_i32_e64 s[40:41], 35, v7
  v_cmp_gt_i32_e64 s[42:43], 32, v10
  v_cmp_gt_i32_e64 s[44:45], 33, v10
  v_cndmask_b32_e64 v91, v91, v8, s[40:41]
  v_cndmask_b32_e64 v120, v120, v8, s[42:43]
  v_cndmask_b32_e64 v121, v121, v8, s[44:45]
  v_cmp_gt_i32_e64 s[40:41], 34, v10
  v_cmp_gt_i32_e64 s[42:43], 35, v10
  v_cmp_gt_i32_e64 s[44:45], 48, v7
  v_cndmask_b32_e64 v122, v122, v8, s[40:41]
  v_cndmask_b32_e64 v123, v123, v8, s[42:43]
  v_cndmask_b32_e64 v92, v92, v8, s[44:45]
  v_cmp_gt_i32_e64 s[40:41], 49, v7
  v_cmp_gt_i32_e64 s[42:43], 50, v7
  v_cmp_gt_i32_e64 s[44:45], 51, v7
  v_cndmask_b32_e64 v93, v93, v8, s[40:41]
  v_cndmask_b32_e64 v94, v94, v8, s[42:43]
  v_cndmask_b32_e64 v95, v95, v8, s[44:45]
  v_cmp_gt_i32_e64 s[40:41], 48, v10
  v_cmp_gt_i32_e64 s[42:43], 49, v10
  v_cmp_gt_i32_e64 s[44:45], 50, v10
  v_cndmask_b32_e64 v124, v124, v8, s[40:41]
  v_cndmask_b32_e64 v125, v125, v8, s[42:43]
  v_cndmask_b32_e64 v126, v126, v8, s[44:45]
  v_cmp_gt_i32_e64 s[40:41], 51, v10
  s_nop 1
  v_cndmask_b32_e64 v127, v127, v8, s[40:41]
  v_exp_f32 v48, v64
  v_exp_f32 v49, v65
  v_exp_f32 v50, v66
  v_exp_f32 v51, v67
  v_cvt_pk_bf16_f32 v192, v48, v49
  v_exp_f32 v52, v68
  v_exp_f32 v53, v69
  v_cvt_pk_bf16_f32 v193, v50, v51
  v_pk_maximum3_f16 v11, v192, v192, v193
  v_exp_f32 v54, v70
  v_exp_f32 v55, v71
  v_cvt_pk_bf16_f32 v194, v52, v53
  v_exp_f32 v48, v96
  v_exp_f32 v49, v97
  v_cvt_pk_bf16_f32 v195, v54, v55
  v_pk_maximum3_f16 v11, v11, v194, v195
  v_exp_f32 v50, v98
  v_exp_f32 v51, v99
  v_cvt_pk_bf16_f32 v208, v48, v49
  v_exp_f32 v52, v100
  v_exp_f32 v53, v101
  v_cvt_pk_bf16_f32 v209, v50, v51
  v_pk_maximum3_f16 v11, v11, v208, v209
  v_exp_f32 v54, v102
  v_exp_f32 v55, v103
  v_cvt_pk_bf16_f32 v210, v52, v53
  v_exp_f32 v48, v72
  v_exp_f32 v49, v73
  v_cvt_pk_bf16_f32 v211, v54, v55
  v_pk_maximum3_f16 v11, v11, v210, v211
  v_exp_f32 v50, v74
  v_exp_f32 v51, v75
  v_cvt_pk_bf16_f32 v196, v48, v49
  v_exp_f32 v52, v76
  v_exp_f32 v53, v77
  v_cvt_pk_bf16_f32 v197, v50, v51
  v_pk_maximum3_f16 v11, v11, v196, v197
  v_exp_f32 v54, v78
  v_exp_f32 v55, v79
  v_cvt_pk_bf16_f32 v198, v52, v53
  v_exp_f32 v48, v104
  v_exp_f32 v49, v105
  v_cvt_pk_bf16_f32 v199, v54, v55
  v_pk_maximum3_f16 v11, v11, v198, v199
  v_exp_f32 v50, v106
  v_exp_f32 v51, v107
  v_cvt_pk_bf16_f32 v212, v48, v49
  v_exp_f32 v52, v108
  v_exp_f32 v53, v109
  v_cvt_pk_bf16_f32 v213, v50, v51
  v_pk_maximum3_f16 v11, v11, v212, v213
  v_exp_f32 v54, v110
  v_exp_f32 v55, v111
  v_cvt_pk_bf16_f32 v214, v52, v53
  s_nop 0
  v_cvt_pk_bf16_f32 v215, v54, v55
  v_pk_maximum3_f16 v11, v11, v214, v215
  s_waitcnt vmcnt(0)
  s_waitcnt lgkmcnt(0)
  s_barrier
  v_add_u32 v3, s33, v2
  ds_read_b128 a[192:195], v3 offset:0
  ds_read_b128 a[196:199], v3 offset:1024
  ds_read_b128 a[200:203], v3 offset:2048
  ds_read_b128 a[204:207], v3 offset:3072
  ds_read_b128 a[208:211], v3 offset:4096
  ds_read_b128 a[212:215], v3 offset:5120
  ds_read_b128 a[216:219], v3 offset:6144
  ds_read_b128 a[220:223], v3 offset:7168
  v_mov_b32 v13, s64
  v_mov_b32 v14, s65
  s_sub_u32 s29, s28, 131072
  s_lshl_b32 s30, s5, 12
  s_branch F_main
F_V:
  s_cmp_eq_u32 s76, 0
  s_cselect_b32 s64, s34, s36
  s_cselect_b32 s65, s35, s37
  s_mov_b32 s66, 0x400000
  s_mov_b32 s67, 0x20000
  s_add_u32 s56, s48, 128
  s_add_u32 m0, s49, 65536
  s_nop 0
  buffer_load_dwordx4 v6, s[60:63], s56 offen offset:0 lds
  buffer_load_dwordx4 v7, s[60:63], s56 offen offset:1024 lds
  buffer_load_dwordx4 v8, s[60:63], s56 offen offset:2048 lds
  buffer_load_dwordx4 v9, s[60:63], s56 offen offset:3072 lds
  s_add_u32 s56, s48, 32896
  s_add_u32 m0, s49, 69632
  s_nop 0
  buffer_load_dwordx4 v6, s[60:63], s56 offen offset:0 lds
  buffer_load_dwordx4 v7, s[60:63], s56 offen offset:1024 lds
  buffer_load_dwordx4 v8, s[60:63], s56 offen offset:2048 lds
  buffer_load_dwordx4 v9, s[60:63], s56 offen offset:3072 lds
  s_add_u32 s56, s48, 65664
  s_add_u32 m0, s49, 73728
  s_nop 0
  buffer_load_dwordx4 v6, s[60:63], s56 offen offset:0 lds
  buffer_load_dwordx4 v7, s[60:63], s56 offen offset:1024 lds
  buffer_load_dwordx4 v8, s[60:63], s56 offen offset:2048 lds
  buffer_load_dwordx4 v9, s[60:63], s56 offen offset:3072 lds
  s_add_u32 s56, s48, 98432
  s_add_u32 m0, s49, 77824
  s_nop 0
  buffer_load_dwordx4 v6, s[60:63], s56 offen offset:0 lds
  buffer_load_dwordx4 v7, s[60:63], s56 offen offset:1024 lds
  buffer_load_dwordx4 v8, s[60:63], s56 offen offset:2048 lds
  buffer_load_dwordx4 v9, s[60:63], s56 offen offset:3072 lds
  s_add_u32 s56, s50, 524288
  s_add_u32 m0, s51, 65536
  s_nop 0
  buffer_load_dwordx4 v44, s[64:67], s56 offen offset:0 lds
  buffer_load_dwordx4 v45, s[64:67], s56 offen offset:1024 lds
  buffer_load_dwordx4 v46, s[64:67], s56 offen offset:2048 lds
  buffer_load_dwordx4 v47, s[64:67], s56 offen offset:3072 lds
  s_add_u32 s56, s50, 655360
  s_add_u32 m0, s51, 69632
  s_nop 0
  buffer_load_dwordx4 v44, s[64:67], s56 offen offset:0 lds
  buffer_load_dwordx4 v45, s[64:67], s56 offen offset:1024 lds
  buffer_load_dwordx4 v46, s[64:67], s56 offen offset:2048 lds
  buffer_load_dwordx4 v47, s[64:67], s56 offen offset:3072 lds
  s_add_u32 s56, s50, 786432
  s_add_u32 m0, s51, 73728
  s_nop 0
  buffer_load_dwordx4 v44, s[64:67], s56 offen offset:0 lds
  buffer_load_dwordx4 v45, s[64:67], s56 offen offset:1024 lds
  buffer_load_dwordx4 v46, s[64:67], s56 offen offset:2048 lds
  buffer_load_dwordx4 v47, s[64:67], s56 offen offset:3072 lds
  s_add_u32 s56, s50, 917504
  s_add_u32 m0, s51, 77824
  s_nop 0
  buffer_load_dwordx4 v44, s[64:67], s56 offen offset:0 lds
  buffer_load_dwordx4 v45, s[64:67], s56 offen offset:1024 lds
  buffer_load_dwordx4 v46, s[64:67], s56 offen offset:2048 lds
  buffer_load_dwordx4 v47, s[64:67], s56 offen offset:3072 lds
  s_getpc_b64 s[62:63]
F_pc:
  s_sub_u32 s62, s62, F_pc-gated_mix__compressed_kv_cla__moe_arch_mod__prompt_kernel
  s_subb_u32 s63, s63, 0
  s_lshr_b32 s56, s2, 3
  s_lshl_b32 s56, s56, 1
  s_add_u32 s56, s56, s76
  s_lshl_b32 s56, s56, 6
  v_add_u32 v17, s56, v1
  v_lshlrev_b32 v17, 7, v17
  v_min_u32 v17, K2_rare_A-gated_mix__compressed_kv_cla__moe_arch_mod__prompt_kernel-4, v17
  global_load_dword v15, v17, s[62:63]
  s_cmp_eq_u32 s76, 0
  s_cselect_b32 s60, s34, s36
  s_cselect_b32 s61, s35, s37
  s_mov_b32 s62, 0x400000
  s_mov_b32 s63, 0x20000
  s_mov_b32 s24, s40
  s_mov_b32 s25, s41
  s_mov_b32 s26, 0x400
  s_mov_b32 s27, 0x20000
  s_lshl_b32 s56, s2, 13
  s_lshl_b32 s58, s76, 12
  s_add_u32 s56, s56, s58
  buffer_load_dwordx4 v[192:195], v2, s[12:15], s56 offen offset:0
  buffer_load_dwordx4 v[196:199], v2, s[12:15], s56 offen offset:1024
  buffer_load_dwordx4 v[200:203], v2, s[12:15], s56 offen offset:2048
  buffer_load_dwordx4 v[204:207], v2, s[12:15], s56 offen offset:3072
  buffer_load_dwordx4 v[208:211], v2, s[24:27], 0 offen
  s_mov_b32 s24, s42
  s_mov_b32 s25, s43
  s_mov_b32 s26, 0x400
  s_mov_b32 s27, 0x20000
  buffer_load_dwordx4 v[212:215], v2, s[24:27], 0 offen
  s_mov_b32 s24, s38
  s_mov_b32 s25, s39
  s_mov_b32 s26, 0x400000
  s_mov_b32 s27, 0x20000
  s_lshl_b32 s56, s2, 14
  s_lshl_b32 s38, s76, 13
  s_add_u32 s56, s56, s38
  s_add_u32 m0, s38, 0x20000
  s_nop 0
  buffer_load_dwordx4 v2, s[24:27], s56 offen offset:0 lds
  buffer_load_dwordx4 v2, s[24:27], s56 offen offset:1024 lds
  buffer_load_dwordx4 v2, s[24:27], s56 offen offset:2048 lds
  buffer_load_dwordx4 v2, s[24:27], s56 offen offset:3072 lds
  s_add_u32 s56, s56, 4096
  s_add_u32 m0, m0, 4096
  s_nop 0
  buffer_load_dwordx4 v2, s[24:27], s56 offen offset:0 lds
  buffer_load_dwordx4 v2, s[24:27], s56 offen offset:1024 lds
  buffer_load_dwordx4 v2, s[24:27], s56 offen offset:2048 lds
  buffer_load_dwordx4 v2, s[24:27], s56 offen offset:3072 lds
  s_and_b32 s56, s3, 3
  s_cmp_eq_u32 s76, 0
  s_cbranch_scc0 F_tw3
  s_lshl_b32 s56, s56, 5
  s_sub_u32 s38, 15, s4
  s_lshl_b32 s38, s38, 7
  s_add_u32 s38, s38, s56
  s_lshl_b32 s39, s4, 7
  s_add_u32 s39, s39, s56
  v_and_b32 v19, 31, v1
  v_mov_b32 v56, s38
  v_mov_b32 v57, s39
  v_cmp_gt_u32 vcc, 32, v1
  s_nop 1
  v_cndmask_b32 v56, v57, v56, vcc
  v_add_u32 v19, v19, v56
  v_lshlrev_b32 v19, 10, v19
  v_mov_b32 v18, v19
  s_mov_b32 s64, s30
  s_mov_b32 s65, s31
  s_mov_b32 s66, 0x200000
  s_mov_b32 s72, s28
  s_mov_b32 s73, s29
  s_mov_b32 s74, 0x200000
  s_mov_b32 s58, 128
  s_mov_b32 s37, 128
  s_mov_b32 s59, 0
  s_branch F_twd
  F_tw3:
  v_bfe_u32 v18, v1, 1, 3
  s_lshl_b32 s38, s4, 3
  v_add_u32 v18, s38, v18
  v_lshlrev_b32 v18, 13, v18
  v_and_b32 v56, 1, v1
  v_lshl_add_u32 v18, v56, 7, v18
  s_lshl_b32 s38, s3, 8
  v_add_u32 v18, s38, v18
  v_mov_b32 v19, v18
  s_mov_b32 s64, s34
  s_mov_b32 s65, s35
  s_mov_b32 s66, 0x400000
  s_mov_b32 s72, s36
  s_mov_b32 s73, s37
  s_mov_b32 s74, 0x400000
  s_mov_b32 s58, 524288
  s_mov_b32 s37, 524288
  s_mov_b32 s59, 3
  F_twd:
  s_mov_b32 s67, 0x20000
  s_mov_b32 s75, 0x20000
  s_mul_i32 s56, s58, 2
  s_nop 0
  buffer_load_dword v15, v18, s[64:67], s56 offen
  s_add_u32 s56, s59, -1
  s_min_u32 s56, s56, 7
  s_mul_i32 s56, s56, s37
  s_nop 0
  buffer_load_dword v15, v19, s[72:75], s56 offen
  s_mov_b32 s68, s32
  s_mov_b32 s69, s33
  s_mov_b32 s70, 0x400000
  s_mov_b32 s71, 0x20000
  s_lshl_b32 s56, s3, 20
  s_add_u32 s56, s56, 0x1000000
  s_add_u32 s8, s46, s56
  s_addc_u32 s9, s47, 0
  s_mov_b32 s10, 0x100000
  s_mov_b32 s11, 0x20000
  s_add_u32 s20, s46, 0x4400000
  s_addc_u32 s21, s47, 0
  s_mov_b32 s22, 0x100000
  s_mov_b32 s23, 0x20000
  s_mov_b32 s16, s44
  s_mov_b32 s17, s45
  s_mov_b32 s18, 0x100
  s_mov_b32 s19, 0x20000
  s_sub_u32 s52, 15, s4
  s_cmp_eq_u32 s76, 0
  s_cselect_b32 s52, s52, s4
  s_lshl_b32 s52, s52, 17
  s_lshl_b32 s53, s76, 14
  s_lshl_b32 s54, s76, 18
  s_lshl_b32 s56, s3, 8
  s_add_u32 s54, s54, s56
  s_lshl_b32 s55, s76, 13
  s_lshr_b32 s57, s52, 1
  s_add_u32 s57, s57, 16384
  v_add_u32 v14, s55, v2
  v_and_b32 v56, 31, v1
  v_lshlrev_b32 v56, 7, v56
  v_lshrrev_b32 v57, 5, v1
  v_bfe_u32 v58, v1, 1, 3
  v_xor_b32 v57, v57, v58
  v_lshl_add_u32 v3, v57, 4, v56
  s_lshl_b32 s56, s76, 14
  v_add_u32 v56, s56, v3
  v_and_b32 v56, 15, v1
  v_lshlrev_b32 v56, 7, v56
  v_lshrrev_b32 v57, 4, v1
  v_bfe_u32 v58, v1, 1, 3
  v_xor_b32 v57, v57, v58
  v_lshl_add_u32 v56, v57, 4, v56
  v_add_u32 v56, s56, v56
  v_mov_b32 v36, v56
  v_xor_b32 v37, 64, v56
  v_add_u32 v38, 0x10000, v36
  v_add_u32 v39, 0x10000, v37
  v_lshrrev_b32 v56, 5, v1
  v_lshlrev_b32 v56, 3, v56
  v_bfe_u32 v57, v1, 2, 2
  v_add_u32 v56, v56, v57
  v_lshlrev_b32 v56, 8, v56
  v_lshl_add_u32 v56, v57, 6, v56
  v_bfe_u32 v58, v1, 4, 1
  v_lshl_add_u32 v56, v58, 5, v56
  v_and_b32 v58, 3, v1
  v_lshl_add_u32 v4, v58, 3, v56
  v_add_u32 v56, 49152, v4
  v_lshrrev_b32 v56, 4, v1
  v_bfe_u32 v57, v1, 2, 2
  v_lshl_add_u32 v58, v56, 3, v57
  v_lshlrev_b32 v58, 8, v58
  v_and_b32 v56, 1, v56
  v_lshl_add_u32 v56, v56, 2, v57
  v_lshl_add_u32 v58, v56, 5, v58
  v_and_b32 v56, 3, v1
  v_lshl_add_u32 v58, v56, 3, v58
  v_add_u32 v58, 49152, v58
  v_xor_b32 v20, 0, v58
  v_add_u32 v28, 0x10000, v20
  v_xor_b32 v21, 32, v58
  v_add_u32 v29, 0x10000, v21
  v_xor_b32 v22, 64, v58
  v_add_u32 v30, 0x10000, v22
  v_xor_b32 v23, 96, v58
  v_add_u32 v31, 0x10000, v23
  v_xor_b32 v24, 128, v58
  v_add_u32 v32, 0x10000, v24
  v_xor_b32 v25, 160, v58
  v_add_u32 v33, 0x10000, v25
  v_xor_b32 v26, 192, v58
  v_add_u32 v34, 0x10000, v26
  v_xor_b32 v27, 224, v58
  v_add_u32 v35, 0x10000, v27
  v_mov_b32 v48, 0
  v_mov_b32 v49, 0
  v_mov_b32 v50, 0
  v_mov_b32 v51, 0
  s_nop 1
  v_mfma_f32_32x32x16_bf16 a[0:15], v[48:51], v[48:51], 0
  v_mfma_f32_32x32x16_bf16 a[16:31], v[48:51], v[48:51], 0
  v_mfma_f32_32x32x16_bf16 a[32:47], v[48:51], v[48:51], 0
  v_mfma_f32_32x32x16_bf16 a[48:63], v[48:51], v[48:51], 0
  v_mfma_f32_32x32x16_bf16 a[64:79], v[48:51], v[48:51], 0
  v_mfma_f32_32x32x16_bf16 a[80:95], v[48:51], v[48:51], 0
  v_mfma_f32_32x32x16_bf16 a[96:111], v[48:51], v[48:51], 0
  v_mfma_f32_32x32x16_bf16 a[112:127], v[48:51], v[48:51], 0
  v_mfma_f32_32x32x16_bf16 a[128:143], v[48:51], v[48:51], 0
  v_mfma_f32_32x32x16_bf16 a[144:159], v[48:51], v[48:51], 0
  v_mfma_f32_32x32x16_bf16 a[160:175], v[48:51], v[48:51], 0
  v_mfma_f32_32x32x16_bf16 a[176:191], v[48:51], v[48:51], 0
  v_mfma_f32_32x32x16_bf16 a[192:207], v[48:51], v[48:51], 0
  v_mfma_f32_32x32x16_bf16 a[208:223], v[48:51], v[48:51], 0
  v_mfma_f32_32x32x16_bf16 a[224:239], v[48:51], v[48:51], 0
  v_mfma_f32_32x32x16_bf16 a[240:255], v[48:51], v[48:51], 0
  s_barrier
  ds_read_b128 v[64:67], v36 offset:0
  ds_read_b64_tr_b16 v[96:97], v20 offset:0
  ds_read_b64_tr_b16 v[98:99], v20 offset:1024
  ds_read_b128 v[68:71], v36 offset:2048
  ds_read_b64_tr_b16 v[100:101], v21 offset:0
  ds_read_b64_tr_b16 v[102:103], v21 offset:1024
  ds_read_b128 v[72:75], v36 offset:4096
  ds_read_b64_tr_b16 v[104:105], v22 offset:0
  ds_read_b64_tr_b16 v[106:107], v22 offset:1024
  ds_read_b128 v[76:79], v36 offset:6144
  ds_read_b64_tr_b16 v[108:109], v23 offset:0
  ds_read_b64_tr_b16 v[110:111], v23 offset:1024
  ds_read_b128 v[80:83], v36 offset:8192
  ds_read_b64_tr_b16 v[112:113], v24 offset:0
  ds_read_b64_tr_b16 v[114:115], v24 offset:1024
  ds_read_b128 v[84:87], v36 offset:10240
  ds_read_b64_tr_b16 v[116:117], v25 offset:0
  ds_read_b64_tr_b16 v[118:119], v25 offset:1024
  ds_read_b128 v[88:91], v36 offset:12288
  ds_read_b64_tr_b16 v[120:121], v26 offset:0
  ds_read_b64_tr_b16 v[122:123], v26 offset:1024
  ds_read_b128 v[92:95], v36 offset:14336
  ds_read_b64_tr_b16 v[124:125], v27 offset:0
  ds_read_b64_tr_b16 v[126:127], v27 offset:1024
  s_waitcnt lgkmcnt(0)
  v_mfma_f32_16x16x32_bf16 a[0:3], v[64:67], v[96:99], a[0:3]
  ds_read_b128 v[128:131], v37 offset:0
  v_mfma_f32_16x16x32_bf16 a[4:7], v[64:67], v[100:103], a[4:7]
  v_mfma_f32_16x16x32_bf16 a[8:11], v[64:67], v[104:107], a[8:11]
  ds_read_b64_tr_b16 v[160:161], v20 offset:8192
  v_mfma_f32_16x16x32_bf16 a[12:15], v[64:67], v[108:111], a[12:15]
  v_mfma_f32_16x16x32_bf16 a[16:19], v[64:67], v[112:115], a[16:19]
  ds_read_b64_tr_b16 v[162:163], v20 offset:9216
  v_mfma_f32_16x16x32_bf16 a[20:23], v[64:67], v[116:119], a[20:23]
  v_mfma_f32_16x16x32_bf16 a[24:27], v[64:67], v[120:123], a[24:27]
  ds_read_b128 v[132:135], v37 offset:2048
  v_mfma_f32_16x16x32_bf16 a[28:31], v[64:67], v[124:127], a[28:31]
  v_mfma_f32_16x16x32_bf16 a[32:35], v[68:71], v[96:99], a[32:35]
  ds_read_b64_tr_b16 v[164:165], v21 offset:8192
  v_mfma_f32_16x16x32_bf16 a[36:39], v[68:71], v[100:103], a[36:39]
  v_mfma_f32_16x16x32_bf16 a[40:43], v[68:71], v[104:107], a[40:43]
  ds_read_b64_tr_b16 v[166:167], v21 offset:9216
  v_mfma_f32_16x16x32_bf16 a[44:47], v[68:71], v[108:111], a[44:47]
  v_mfma_f32_16x16x32_bf16 a[48:51], v[68:71], v[112:115], a[48:51]
  ds_read_b128 v[136:139], v37 offset:4096
  v_mfma_f32_16x16x32_bf16 a[52:55], v[68:71], v[116:119], a[52:55]
  v_mfma_f32_16x16x32_bf16 a[56:59], v[68:71], v[120:123], a[56:59]
  ds_read_b64_tr_b16 v[168:169], v22 offset:8192
  v_mfma_f32_16x16x32_bf16 a[60:63], v[68:71], v[124:127], a[60:63]
  v_mfma_f32_16x16x32_bf16 a[64:67], v[72:75], v[96:99], a[64:67]
  ds_read_b64_tr_b16 v[170:171], v22 offset:9216
  v_mfma_f32_16x16x32_bf16 a[68:71], v[72:75], v[100:103], a[68:71]
  v_mfma_f32_16x16x32_bf16 a[72:75], v[72:75], v[104:107], a[72:75]
  ds_read_b128 v[140:143], v37 offset:6144
  v_mfma_f32_16x16x32_bf16 a[76:79], v[72:75], v[108:111], a[76:79]
  v_mfma_f32_16x16x32_bf16 a[80:83], v[72:75], v[112:115], a[80:83]
  ds_read_b64_tr_b16 v[172:173], v23 offset:8192
  v_mfma_f32_16x16x32_bf16 a[84:87], v[72:75], v[116:119], a[84:87]
  v_mfma_f32_16x16x32_bf16 a[88:91], v[72:75], v[120:123], a[88:91]
  ds_read_b64_tr_b16 v[174:175], v23 offset:9216
  v_mfma_f32_16x16x32_bf16 a[92:95], v[72:75], v[124:127], a[92:95]
  v_mfma_f32_16x16x32_bf16 a[96:99], v[76:79], v[96:99], a[96:99]
  ds_read_b128 v[144:147], v37 offset:8192
  v_mfma_f32_16x16x32_bf16 a[100:103], v[76:79], v[100:103], a[100:103]
  v_mfma_f32_16x16x32_bf16 a[104:107], v[76:79], v[104:107], a[104:107]
  ds_read_b64_tr_b16 v[176:177], v24 offset:8192
  v_mfma_f32_16x16x32_bf16 a[108:111], v[76:79], v[108:111], a[108:111]
  v_mfma_f32_16x16x32_bf16 a[112:115], v[76:79], v[112:115], a[112:115]
  ds_read_b64_tr_b16 v[178:179], v24 offset:9216
  v_mfma_f32_16x16x32_bf16 a[116:119], v[76:79], v[116:119], a[116:119]
  v_mfma_f32_16x16x32_bf16 a[120:123], v[76:79], v[120:123], a[120:123]
  ds_read_b128 v[148:151], v37 offset:10240
  v_mfma_f32_16x16x32_bf16 a[124:127], v[76:79], v[124:127], a[124:127]
  v_mfma_f32_16x16x32_bf16 a[128:131], v[80:83], v[96:99], a[128:131]
  ds_read_b64_tr_b16 v[180:181], v25 offset:8192
  v_mfma_f32_16x16x32_bf16 a[132:135], v[80:83], v[100:103], a[132:135]
  v_mfma_f32_16x16x32_bf16 a[136:139], v[80:83], v[104:107], a[136:139]
  ds_read_b64_tr_b16 v[182:183], v25 offset:9216
  v_mfma_f32_16x16x32_bf16 a[140:143], v[80:83], v[108:111], a[140:143]
  v_mfma_f32_16x16x32_bf16 a[144:147], v[80:83], v[112:115], a[144:147]
  ds_read_b128 v[152:155], v37 offset:12288
  v_mfma_f32_16x16x32_bf16 a[148:151], v[80:83], v[116:119], a[148:151]
  v_mfma_f32_16x16x32_bf16 a[152:155], v[80:83], v[120:123], a[152:155]
  ds_read_b64_tr_b16 v[184:185], v26 offset:8192
  v_mfma_f32_16x16x32_bf16 a[156:159], v[80:83], v[124:127], a[156:159]
  v_mfma_f32_16x16x32_bf16 a[160:163], v[84:87], v[96:99], a[160:163]
  ds_read_b64_tr_b16 v[186:187], v26 offset:9216
  v_mfma_f32_16x16x32_bf16 a[164:167], v[84:87], v[100:103], a[164:167]
  v_mfma_f32_16x16x32_bf16 a[168:171], v[84:87], v[104:107], a[168:171]
  ds_read_b128 v[156:159], v37 offset:14336
  v_mfma_f32_16x16x32_bf16 a[172:175], v[84:87], v[108:111], a[172:175]
  v_mfma_f32_16x16x32_bf16 a[176:179], v[84:87], v[112:115], a[176:179]
  ds_read_b64_tr_b16 v[188:189], v27 offset:8192
  v_mfma_f32_16x16x32_bf16 a[180:183], v[84:87], v[116:119], a[180:183]
  v_mfma_f32_16x16x32_bf16 a[184:187], v[84:87], v[120:123], a[184:187]
  ds_read_b64_tr_b16 v[190:191], v27 offset:9216
  v_mfma_f32_16x16x32_bf16 a[188:191], v[84:87], v[124:127], a[188:191]
  v_mfma_f32_16x16x32_bf16 a[192:195], v[88:91], v[96:99], a[192:195]
  s_mul_i32 s56, s58, 3
  v_mfma_f32_16x16x32_bf16 a[196:199], v[88:91], v[100:103], a[196:199]
  buffer_load_dword v15, v18, s[64:67], s56 offen
  v_mfma_f32_16x16x32_bf16 a[200:203], v[88:91], v[104:107], a[200:203]
  v_mfma_f32_16x16x32_bf16 a[204:207], v[88:91], v[108:111], a[204:207]
  v_mfma_f32_16x16x32_bf16 a[208:211], v[88:91], v[112:115], a[208:211]
  v_mfma_f32_16x16x32_bf16 a[212:215], v[88:91], v[116:119], a[212:215]
  v_mfma_f32_16x16x32_bf16 a[216:219], v[88:91], v[120:123], a[216:219]
  s_add_u32 s56, s59, 0
  s_min_u32 s56, s56, 7
  s_mul_i32 s56, s56, s37
  v_mfma_f32_16x16x32_bf16 a[220:223], v[88:91], v[124:127], a[220:223]
  buffer_load_dword v15, v19, s[72:75], s56 offen
  v_mfma_f32_16x16x32_bf16 a[224:227], v[92:95], v[96:99], a[224:227]
  v_mfma_f32_16x16x32_bf16 a[228:231], v[92:95], v[100:103], a[228:231]
  v_mfma_f32_16x16x32_bf16 a[232:235], v[92:95], v[104:107], a[232:235]
  v_mfma_f32_16x16x32_bf16 a[236:239], v[92:95], v[108:111], a[236:239]
  v_mfma_f32_16x16x32_bf16 a[240:243], v[92:95], v[112:115], a[240:243]
  v_mfma_f32_16x16x32_bf16 a[244:247], v[92:95], v[116:119], a[244:247]
  v_mfma_f32_16x16x32_bf16 a[248:251], v[92:95], v[120:123], a[248:251]
  v_mfma_f32_16x16x32_bf16 a[252:255], v[92:95], v[124:127], a[252:255]
  s_waitcnt vmcnt(19) lgkmcnt(0)
  s_barrier
  v_mfma_f32_16x16x32_bf16 a[0:3], v[128:131], v[160:163], a[0:3]
  ds_read_b128 v[64:67], v38 offset:0
  s_add_u32 s56, s50, 1048576
  s_add_u32 m0, s51, 0
  v_mfma_f32_16x16x32_bf16 a[4:7], v[128:131], v[164:167], a[4:7]
  buffer_load_dwordx4 v44, s[60:63], s56 offen offset:0 lds
  v_mfma_f32_16x16x32_bf16 a[8:11], v[128:131], v[168:171], a[8:11]
  ds_read_b64_tr_b16 v[96:97], v28 offset:0
  v_mfma_f32_16x16x32_bf16 a[12:15], v[128:131], v[172:175], a[12:15]
  v_mfma_f32_16x16x32_bf16 a[16:19], v[128:131], v[176:179], a[16:19]
  ds_read_b64_tr_b16 v[98:99], v28 offset:1024
  v_mfma_f32_16x16x32_bf16 a[20:23], v[128:131], v[180:183], a[20:23]
  v_mfma_f32_16x16x32_bf16 a[24:27], v[128:131], v[184:187], a[24:27]
  ds_read_b128 v[68:71], v38 offset:2048
  v_mfma_f32_16x16x32_bf16 a[28:31], v[128:131], v[188:191], a[28:31]
  buffer_load_dwordx4 v45, s[60:63], s56 offen offset:1024 lds
  v_mfma_f32_16x16x32_bf16 a[32:35], v[132:135], v[160:163], a[32:35]
  ds_read_b64_tr_b16 v[100:101], v29 offset:0
  v_mfma_f32_16x16x32_bf16 a[36:39], v[132:135], v[164:167], a[36:39]
  v_mfma_f32_16x16x32_bf16 a[40:43], v[132:135], v[168:171], a[40:43]
  ds_read_b64_tr_b16 v[102:103], v29 offset:1024
  v_mfma_f32_16x16x32_bf16 a[44:47], v[132:135], v[172:175], a[44:47]
  buffer_load_dwordx4 v46, s[60:63], s56 offen offset:2048 lds
  v_mfma_f32_16x16x32_bf16 a[48:51], v[132:135], v[176:179], a[48:51]
  ds_read_b128 v[72:75], v38 offset:4096
  v_mfma_f32_16x16x32_bf16 a[52:55], v[132:135], v[180:183], a[52:55]
  v_mfma_f32_16x16x32_bf16 a[56:59], v[132:135], v[184:187], a[56:59]
  ds_read_b64_tr_b16 v[104:105], v30 offset:0
  v_mfma_f32_16x16x32_bf16 a[60:63], v[132:135], v[188:191], a[60:63]
  v_mfma_f32_16x16x32_bf16 a[64:67], v[136:139], v[160:163], a[64:67]
  ds_read_b64_tr_b16 v[106:107], v30 offset:1024
  v_mfma_f32_16x16x32_bf16 a[68:71], v[136:139], v[164:167], a[68:71]
  buffer_load_dwordx4 v47, s[60:63], s56 offen offset:3072 lds
  v_mfma_f32_16x16x32_bf16 a[72:75], v[136:139], v[168:171], a[72:75]
  ds_read_b128 v[76:79], v38 offset:6144
  v_mfma_f32_16x16x32_bf16 a[76:79], v[136:139], v[172:175], a[76:79]
  v_mfma_f32_16x16x32_bf16 a[80:83], v[136:139], v[176:179], a[80:83]
  ds_read_b64_tr_b16 v[108:109], v31 offset:0
  v_mfma_f32_16x16x32_bf16 a[84:87], v[136:139], v[180:183], a[84:87]
  v_mfma_f32_16x16x32_bf16 a[88:91], v[136:139], v[184:187], a[88:91]
  ds_read_b64_tr_b16 v[110:111], v31 offset:1024
  s_add_u32 s56, s50, 1179648
  s_add_u32 m0, s51, 4096
  v_mfma_f32_16x16x32_bf16 a[92:95], v[136:139], v[188:191], a[92:95]
  buffer_load_dwordx4 v44, s[60:63], s56 offen offset:0 lds
  v_mfma_f32_16x16x32_bf16 a[96:99], v[140:143], v[160:163], a[96:99]
  ds_read_b128 v[80:83], v38 offset:8192
  v_mfma_f32_16x16x32_bf16 a[100:103], v[140:143], v[164:167], a[100:103]
  v_mfma_f32_16x16x32_bf16 a[104:107], v[140:143], v[168:171], a[104:107]
  ds_read_b64_tr_b16 v[112:113], v32 offset:0
  v_mfma_f32_16x16x32_bf16 a[108:111], v[140:143], v[172:175], a[108:111]
  buffer_load_dwordx4 v45, s[60:63], s56 offen offset:1024 lds
  v_mfma_f32_16x16x32_bf16 a[112:115], v[140:143], v[176:179], a[112:115]
  ds_read_b64_tr_b16 v[114:115], v32 offset:1024
  v_mfma_f32_16x16x32_bf16 a[116:119], v[140:143], v[180:183], a[116:119]
  v_mfma_f32_16x16x32_bf16 a[120:123], v[140:143], v[184:187], a[120:123]
  ds_read_b128 v[84:87], v38 offset:10240
  v_mfma_f32_16x16x32_bf16 a[124:127], v[140:143], v[188:191], a[124:127]
  v_mfma_f32_16x16x32_bf16 a[128:131], v[144:147], v[160:163], a[128:131]
  ds_read_b64_tr_b16 v[116:117], v33 offset:0
  v_mfma_f32_16x16x32_bf16 a[132:135], v[144:147], v[164:167], a[132:135]
  buffer_load_dwordx4 v46, s[60:63], s56 offen offset:2048 lds
  v_mfma_f32_16x16x32_bf16 a[136:139], v[144:147], v[168:171], a[136:139]
  ds_read_b64_tr_b16 v[118:119], v33 offset:1024
  v_mfma_f32_16x16x32_bf16 a[140:143], v[144:147], v[172:175], a[140:143]
  v_mfma_f32_16x16x32_bf16 a[144:147], v[144:147], v[176:179], a[144:147]
  ds_read_b128 v[88:91], v38 offset:12288
  v_mfma_f32_16x16x32_bf16 a[148:151], v[144:147], v[180:183], a[148:151]
  v_mfma_f32_16x16x32_bf16 a[152:155], v[144:147], v[184:187], a[152:155]
  ds_read_b64_tr_b16 v[120:121], v34 offset:0
  v_mfma_f32_16x16x32_bf16 a[156:159], v[144:147], v[188:191], a[156:159]
  buffer_load_dwordx4 v47, s[60:63], s56 offen offset:3072 lds
  v_mfma_f32_16x16x32_bf16 a[160:163], v[148:151], v[160:163], a[160:163]
  ds_read_b64_tr_b16 v[122:123], v34 offset:1024
  v_mfma_f32_16x16x32_bf16 a[164:167], v[148:151], v[164:167], a[164:167]
  v_mfma_f32_16x16x32_bf16 a[168:171], v[148:151], v[168:171], a[168:171]
  ds_read_b128 v[92:95], v38 offset:14336
  v_mfma_f32_16x16x32_bf16 a[172:175], v[148:151], v[172:175], a[172:175]
  v_mfma_f32_16x16x32_bf16 a[176:179], v[148:151], v[176:179], a[176:179]
  ds_read_b64_tr_b16 v[124:125], v35 offset:0
  s_add_u32 s56, s50, 1310720
  s_add_u32 m0, s51, 8192
  v_mfma_f32_16x16x32_bf16 a[180:183], v[148:151], v[180:183], a[180:183]
  buffer_load_dwordx4 v44, s[60:63], s56 offen offset:0 lds
  v_mfma_f32_16x16x32_bf16 a[184:187], v[148:151], v[184:187], a[184:187]
  ds_read_b64_tr_b16 v[126:127], v35 offset:1024
  v_mfma_f32_16x16x32_bf16 a[188:191], v[148:151], v[188:191], a[188:191]
  v_mfma_f32_16x16x32_bf16 a[192:195], v[152:155], v[160:163], a[192:195]
  v_mfma_f32_16x16x32_bf16 a[196:199], v[152:155], v[164:167], a[196:199]
  buffer_load_dwordx4 v45, s[60:63], s56 offen offset:1024 lds
  v_mfma_f32_16x16x32_bf16 a[200:203], v[152:155], v[168:171], a[200:203]
  v_mfma_f32_16x16x32_bf16 a[204:207], v[152:155], v[172:175], a[204:207]
  v_mfma_f32_16x16x32_bf16 a[208:211], v[152:155], v[176:179], a[208:211]
  v_mfma_f32_16x16x32_bf16 a[212:215], v[152:155], v[180:183], a[212:215]
  v_mfma_f32_16x16x32_bf16 a[216:219], v[152:155], v[184:187], a[216:219]
  buffer_load_dwordx4 v46, s[60:63], s56 offen offset:2048 lds
  v_mfma_f32_16x16x32_bf16 a[220:223], v[152:155], v[188:191], a[220:223]
  v_mfma_f32_16x16x32_bf16 a[224:227], v[156:159], v[160:163], a[224:227]
  v_mfma_f32_16x16x32_bf16 a[228:231], v[156:159], v[164:167], a[228:231]
  v_mfma_f32_16x16x32_bf16 a[232:235], v[156:159], v[168:171], a[232:235]
  v_mfma_f32_16x16x32_bf16 a[236:239], v[156:159], v[172:175], a[236:239]
  v_mfma_f32_16x16x32_bf16 a[240:243], v[156:159], v[176:179], a[240:243]
  buffer_load_dwordx4 v47, s[60:63], s56 offen offset:3072 lds
  v_mfma_f32_16x16x32_bf16 a[244:247], v[156:159], v[180:183], a[244:247]
  v_mfma_f32_16x16x32_bf16 a[248:251], v[156:159], v[184:187], a[248:251]
  v_mfma_f32_16x16x32_bf16 a[252:255], v[156:159], v[188:191], a[252:255]
  s_waitcnt lgkmcnt(0)
  v_mfma_f32_16x16x32_bf16 a[0:3], v[64:67], v[96:99], a[0:3]
  ds_read_b128 v[128:131], v39 offset:0
  s_add_u32 s56, s50, 1441792
  s_add_u32 m0, s51, 12288
  v_mfma_f32_16x16x32_bf16 a[4:7], v[64:67], v[100:103], a[4:7]
  buffer_load_dwordx4 v44, s[60:63], s56 offen offset:0 lds
  v_mfma_f32_16x16x32_bf16 a[8:11], v[64:67], v[104:107], a[8:11]
  ds_read_b64_tr_b16 v[160:161], v28 offset:8192
  v_mfma_f32_16x16x32_bf16 a[12:15], v[64:67], v[108:111], a[12:15]
  v_mfma_f32_16x16x32_bf16 a[16:19], v[64:67], v[112:115], a[16:19]
  ds_read_b64_tr_b16 v[162:163], v28 offset:9216
  v_mfma_f32_16x16x32_bf16 a[20:23], v[64:67], v[116:119], a[20:23]
  v_mfma_f32_16x16x32_bf16 a[24:27], v[64:67], v[120:123], a[24:27]
  ds_read_b128 v[132:135], v39 offset:2048
  v_mfma_f32_16x16x32_bf16 a[28:31], v[64:67], v[124:127], a[28:31]
  buffer_load_dwordx4 v45, s[60:63], s56 offen offset:1024 lds
  v_mfma_f32_16x16x32_bf16 a[32:35], v[68:71], v[96:99], a[32:35]
  ds_read_b64_tr_b16 v[164:165], v29 offset:8192
  v_mfma_f32_16x16x32_bf16 a[36:39], v[68:71], v[100:103], a[36:39]
  v_mfma_f32_16x16x32_bf16 a[40:43], v[68:71], v[104:107], a[40:43]
  ds_read_b64_tr_b16 v[166:167], v29 offset:9216
  v_mfma_f32_16x16x32_bf16 a[44:47], v[68:71], v[108:111], a[44:47]
  v_mfma_f32_16x16x32_bf16 a[48:51], v[68:71], v[112:115], a[48:51]
  ds_read_b128 v[136:139], v39 offset:4096
  v_mfma_f32_16x16x32_bf16 a[52:55], v[68:71], v[116:119], a[52:55]
  buffer_load_dwordx4 v46, s[60:63], s56 offen offset:2048 lds
  v_mfma_f32_16x16x32_bf16 a[56:59], v[68:71], v[120:123], a[56:59]
  ds_read_b64_tr_b16 v[168:169], v30 offset:8192
  v_mfma_f32_16x16x32_bf16 a[60:63], v[68:71], v[124:127], a[60:63]
  v_mfma_f32_16x16x32_bf16 a[64:67], v[72:75], v[96:99], a[64:67]
  ds_read_b64_tr_b16 v[170:171], v30 offset:9216
  v_mfma_f32_16x16x32_bf16 a[68:71], v[72:75], v[100:103], a[68:71]
  buffer_load_dwordx4 v47, s[60:63], s56 offen offset:3072 lds
  v_mfma_f32_16x16x32_bf16 a[72:75], v[72:75], v[104:107], a[72:75]
  ds_read_b128 v[140:143], v39 offset:6144
  v_mfma_f32_16x16x32_bf16 a[76:79], v[72:75], v[108:111], a[76:79]
  v_mfma_f32_16x16x32_bf16 a[80:83], v[72:75], v[112:115], a[80:83]
  ds_read_b64_tr_b16 v[172:173], v31 offset:8192
  v_mfma_f32_16x16x32_bf16 a[84:87], v[72:75], v[116:119], a[84:87]
  v_mfma_f32_16x16x32_bf16 a[88:91], v[72:75], v[120:123], a[88:91]
  ds_read_b64_tr_b16 v[174:175], v31 offset:9216
  v_mfma_f32_16x16x32_bf16 a[92:95], v[72:75], v[124:127], a[92:95]
  v_mfma_f32_16x16x32_bf16 a[96:99], v[76:79], v[96:99], a[96:99]
  ds_read_b128 v[144:147], v39 offset:8192
  v_mfma_f32_16x16x32_bf16 a[100:103], v[76:79], v[100:103], a[100:103]
  v_mfma_f32_16x16x32_bf16 a[104:107], v[76:79], v[104:107], a[104:107]
  ds_read_b64_tr_b16 v[176:177], v32 offset:8192
  v_mfma_f32_16x16x32_bf16 a[108:111], v[76:79], v[108:111], a[108:111]
  v_mfma_f32_16x16x32_bf16 a[112:115], v[76:79], v[112:115], a[112:115]
  ds_read_b64_tr_b16 v[178:179], v32 offset:9216
  v_mfma_f32_16x16x32_bf16 a[116:119], v[76:79], v[116:119], a[116:119]
  v_mfma_f32_16x16x32_bf16 a[120:123], v[76:79], v[120:123], a[120:123]
  ds_read_b128 v[148:151], v39 offset:10240
  v_mfma_f32_16x16x32_bf16 a[124:127], v[76:79], v[124:127], a[124:127]
  v_mfma_f32_16x16x32_bf16 a[128:131], v[80:83], v[96:99], a[128:131]
  ds_read_b64_tr_b16 v[180:181], v33 offset:8192
  v_mfma_f32_16x16x32_bf16 a[132:135], v[80:83], v[100:103], a[132:135]
  v_mfma_f32_16x16x32_bf16 a[136:139], v[80:83], v[104:107], a[136:139]
  ds_read_b64_tr_b16 v[182:183], v33 offset:9216
  v_mfma_f32_16x16x32_bf16 a[140:143], v[80:83], v[108:111], a[140:143]
  v_mfma_f32_16x16x32_bf16 a[144:147], v[80:83], v[112:115], a[144:147]
  ds_read_b128 v[152:155], v39 offset:12288
  v_mfma_f32_16x16x32_bf16 a[148:151], v[80:83], v[116:119], a[148:151]
  v_mfma_f32_16x16x32_bf16 a[152:155], v[80:83], v[120:123], a[152:155]
  ds_read_b64_tr_b16 v[184:185], v34 offset:8192
  v_mfma_f32_16x16x32_bf16 a[156:159], v[80:83], v[124:127], a[156:159]
  v_mfma_f32_16x16x32_bf16 a[160:163], v[84:87], v[96:99], a[160:163]
  ds_read_b64_tr_b16 v[186:187], v34 offset:9216
  v_mfma_f32_16x16x32_bf16 a[164:167], v[84:87], v[100:103], a[164:167]
  v_mfma_f32_16x16x32_bf16 a[168:171], v[84:87], v[104:107], a[168:171]
  ds_read_b128 v[156:159], v39 offset:14336
  v_mfma_f32_16x16x32_bf16 a[172:175], v[84:87], v[108:111], a[172:175]
  v_mfma_f32_16x16x32_bf16 a[176:179], v[84:87], v[112:115], a[176:179]
  ds_read_b64_tr_b16 v[188:189], v35 offset:8192
  v_mfma_f32_16x16x32_bf16 a[180:183], v[84:87], v[116:119], a[180:183]
  v_mfma_f32_16x16x32_bf16 a[184:187], v[84:87], v[120:123], a[184:187]
  ds_read_b64_tr_b16 v[190:191], v35 offset:9216
  v_mfma_f32_16x16x32_bf16 a[188:191], v[84:87], v[124:127], a[188:191]
  v_mfma_f32_16x16x32_bf16 a[192:195], v[88:91], v[96:99], a[192:195]
  s_mul_i32 s56, s58, 4
  v_mfma_f32_16x16x32_bf16 a[196:199], v[88:91], v[100:103], a[196:199]
  buffer_load_dword v15, v18, s[64:67], s56 offen
  v_mfma_f32_16x16x32_bf16 a[200:203], v[88:91], v[104:107], a[200:203]
  v_mfma_f32_16x16x32_bf16 a[204:207], v[88:91], v[108:111], a[204:207]
  v_mfma_f32_16x16x32_bf16 a[208:211], v[88:91], v[112:115], a[208:211]
  v_mfma_f32_16x16x32_bf16 a[212:215], v[88:91], v[116:119], a[212:215]
  v_mfma_f32_16x16x32_bf16 a[216:219], v[88:91], v[120:123], a[216:219]
  s_add_u32 s56, s59, 1
  s_min_u32 s56, s56, 7
  s_mul_i32 s56, s56, s37
  v_mfma_f32_16x16x32_bf16 a[220:223], v[88:91], v[124:127], a[220:223]
  buffer_load_dword v15, v19, s[72:75], s56 offen
  v_mfma_f32_16x16x32_bf16 a[224:227], v[92:95], v[96:99], a[224:227]
  v_mfma_f32_16x16x32_bf16 a[228:231], v[92:95], v[100:103], a[228:231]
  v_mfma_f32_16x16x32_bf16 a[232:235], v[92:95], v[104:107], a[232:235]
  v_mfma_f32_16x16x32_bf16 a[236:239], v[92:95], v[108:111], a[236:239]
  v_mfma_f32_16x16x32_bf16 a[240:243], v[92:95], v[112:115], a[240:243]
  v_mfma_f32_16x16x32_bf16 a[244:247], v[92:95], v[116:119], a[244:247]
  v_mfma_f32_16x16x32_bf16 a[248:251], v[92:95], v[120:123], a[248:251]
  v_mfma_f32_16x16x32_bf16 a[252:255], v[92:95], v[124:127], a[252:255]
  s_load_dwordx4 s[40:43], s[0:1], 64
  s_load_dwordx2 s[44:45], s[0:1], 80
  s_waitcnt lgkmcnt(0)
  s_mul_i32 s56, s2, 7168
  v_min_u32 v17, 55, v1
  v_lshlrev_b32 v17, 7, v17
  s_cmp_eq_u32 s76, 0
  s_cselect_b32 s24, s40, s44
  s_cselect_b32 s25, s41, s45
  s_mov_b32 s26, 0x1c0000
  s_mov_b32 s27, 0x20000
  buffer_load_dword v15, v17, s[24:27], s56 offen
  s_cselect_b32 s24, s42, s44
  s_cselect_b32 s25, s43, s45
  buffer_load_dword v15, v17, s[24:27], s56 offen
  s_waitcnt vmcnt(4) lgkmcnt(0)
  s_barrier
  v_mfma_f32_16x16x32_bf16 a[0:3], v[128:131], v[160:163], a[0:3]
  ds_read_b128 v[64:67], v36 offset:0
  s_add_u32 s56, s50, 1572864
  s_add_u32 m0, s51, 65536
  v_mfma_f32_16x16x32_bf16 a[4:7], v[128:131], v[164:167], a[4:7]
  buffer_load_dwordx4 v44, s[60:63], s56 offen offset:0 lds
  v_mfma_f32_16x16x32_bf16 a[8:11], v[128:131], v[168:171], a[8:11]
  ds_read_b64_tr_b16 v[96:97], v20 offset:0
  v_mfma_f32_16x16x32_bf16 a[12:15], v[128:131], v[172:175], a[12:15]
  v_mfma_f32_16x16x32_bf16 a[16:19], v[128:131], v[176:179], a[16:19]
  ds_read_b64_tr_b16 v[98:99], v20 offset:1024
  v_mfma_f32_16x16x32_bf16 a[20:23], v[128:131], v[180:183], a[20:23]
  v_mfma_f32_16x16x32_bf16 a[24:27], v[128:131], v[184:187], a[24:27]
  ds_read_b128 v[68:71], v36 offset:2048
  v_mfma_f32_16x16x32_bf16 a[28:31], v[128:131], v[188:191], a[28:31]
  buffer_load_dwordx4 v45, s[60:63], s56 offen offset:1024 lds
  v_mfma_f32_16x16x32_bf16 a[32:35], v[132:135], v[160:163], a[32:35]
  ds_read_b64_tr_b16 v[100:101], v21 offset:0
  v_mfma_f32_16x16x32_bf16 a[36:39], v[132:135], v[164:167], a[36:39]
  v_mfma_f32_16x16x32_bf16 a[40:43], v[132:135], v[168:171], a[40:43]
  ds_read_b64_tr_b16 v[102:103], v21 offset:1024
  v_mfma_f32_16x16x32_bf16 a[44:47], v[132:135], v[172:175], a[44:47]
  buffer_load_dwordx4 v46, s[60:63], s56 offen offset:2048 lds
  v_mfma_f32_16x16x32_bf16 a[48:51], v[132:135], v[176:179], a[48:51]
  ds_read_b128 v[72:75], v36 offset:4096
  v_mfma_f32_16x16x32_bf16 a[52:55], v[132:135], v[180:183], a[52:55]
  v_mfma_f32_16x16x32_bf16 a[56:59], v[132:135], v[184:187], a[56:59]
  ds_read_b64_tr_b16 v[104:105], v22 offset:0
  v_mfma_f32_16x16x32_bf16 a[60:63], v[132:135], v[188:191], a[60:63]
  v_mfma_f32_16x16x32_bf16 a[64:67], v[136:139], v[160:163], a[64:67]
  ds_read_b64_tr_b16 v[106:107], v22 offset:1024
  v_mfma_f32_16x16x32_bf16 a[68:71], v[136:139], v[164:167], a[68:71]
  buffer_load_dwordx4 v47, s[60:63], s56 offen offset:3072 lds
  v_mfma_f32_16x16x32_bf16 a[72:75], v[136:139], v[168:171], a[72:75]
  ds_read_b128 v[76:79], v36 offset:6144
  v_mfma_f32_16x16x32_bf16 a[76:79], v[136:139], v[172:175], a[76:79]
  v_mfma_f32_16x16x32_bf16 a[80:83], v[136:139], v[176:179], a[80:83]
  ds_read_b64_tr_b16 v[108:109], v23 offset:0
  v_mfma_f32_16x16x32_bf16 a[84:87], v[136:139], v[180:183], a[84:87]
  v_mfma_f32_16x16x32_bf16 a[88:91], v[136:139], v[184:187], a[88:91]
  ds_read_b64_tr_b16 v[110:111], v23 offset:1024
  s_add_u32 s56, s50, 1703936
  s_add_u32 m0, s51, 69632
  v_mfma_f32_16x16x32_bf16 a[92:95], v[136:139], v[188:191], a[92:95]
  buffer_load_dwordx4 v44, s[60:63], s56 offen offset:0 lds
  v_mfma_f32_16x16x32_bf16 a[96:99], v[140:143], v[160:163], a[96:99]
  ds_read_b128 v[80:83], v36 offset:8192
  v_mfma_f32_16x16x32_bf16 a[100:103], v[140:143], v[164:167], a[100:103]
  v_mfma_f32_16x16x32_bf16 a[104:107], v[140:143], v[168:171], a[104:107]
  ds_read_b64_tr_b16 v[112:113], v24 offset:0
  v_mfma_f32_16x16x32_bf16 a[108:111], v[140:143], v[172:175], a[108:111]
  buffer_load_dwordx4 v45, s[60:63], s56 offen offset:1024 lds
  v_mfma_f32_16x16x32_bf16 a[112:115], v[140:143], v[176:179], a[112:115]
  ds_read_b64_tr_b16 v[114:115], v24 offset:1024
  v_mfma_f32_16x16x32_bf16 a[116:119], v[140:143], v[180:183], a[116:119]
  v_mfma_f32_16x16x32_bf16 a[120:123], v[140:143], v[184:187], a[120:123]
  ds_read_b128 v[84:87], v36 offset:10240
  v_mfma_f32_16x16x32_bf16 a[124:127], v[140:143], v[188:191], a[124:127]
  v_mfma_f32_16x16x32_bf16 a[128:131], v[144:147], v[160:163], a[128:131]
  ds_read_b64_tr_b16 v[116:117], v25 offset:0
  v_mfma_f32_16x16x32_bf16 a[132:135], v[144:147], v[164:167], a[132:135]
  buffer_load_dwordx4 v46, s[60:63], s56 offen offset:2048 lds
  v_mfma_f32_16x16x32_bf16 a[136:139], v[144:147], v[168:171], a[136:139]
  ds_read_b64_tr_b16 v[118:119], v25 offset:1024
  v_mfma_f32_16x16x32_bf16 a[140:143], v[144:147], v[172:175], a[140:143]
  v_mfma_f32_16x16x32_bf16 a[144:147], v[144:147], v[176:179], a[144:147]
  ds_read_b128 v[88:91], v36 offset:12288
  v_mfma_f32_16x16x32_bf16 a[148:151], v[144:147], v[180:183], a[148:151]
  v_mfma_f32_16x16x32_bf16 a[152:155], v[144:147], v[184:187], a[152:155]
  ds_read_b64_tr_b16 v[120:121], v26 offset:0
  v_mfma_f32_16x16x32_bf16 a[156:159], v[144:147], v[188:191], a[156:159]
  buffer_load_dwordx4 v47, s[60:63], s56 offen offset:3072 lds
  v_mfma_f32_16x16x32_bf16 a[160:163], v[148:151], v[160:163], a[160:163]
  ds_read_b64_tr_b16 v[122:123], v26 offset:1024
  v_mfma_f32_16x16x32_bf16 a[164:167], v[148:151], v[164:167], a[164:167]
  v_mfma_f32_16x16x32_bf16 a[168:171], v[148:151], v[168:171], a[168:171]
  ds_read_b128 v[92:95], v36 offset:14336
  v_mfma_f32_16x16x32_bf16 a[172:175], v[148:151], v[172:175], a[172:175]
  v_mfma_f32_16x16x32_bf16 a[176:179], v[148:151], v[176:179], a[176:179]
  ds_read_b64_tr_b16 v[124:125], v27 offset:0
  s_add_u32 s56, s50, 1835008
  s_add_u32 m0, s51, 73728
  v_mfma_f32_16x16x32_bf16 a[180:183], v[148:151], v[180:183], a[180:183]
  buffer_load_dwordx4 v44, s[60:63], s56 offen offset:0 lds
  v_mfma_f32_16x16x32_bf16 a[184:187], v[148:151], v[184:187], a[184:187]
  ds_read_b64_tr_b16 v[126:127], v27 offset:1024
  v_mfma_f32_16x16x32_bf16 a[188:191], v[148:151], v[188:191], a[188:191]
  v_mfma_f32_16x16x32_bf16 a[192:195], v[152:155], v[160:163], a[192:195]
  v_mfma_f32_16x16x32_bf16 a[196:199], v[152:155], v[164:167], a[196:199]
  buffer_load_dwordx4 v45, s[60:63], s56 offen offset:1024 lds
  s_lshl_b32 s39, s4, 6
  v_add_u32 v17, s39, v1
  v_lshlrev_b32 v17, 13, v17
  s_lshl_b32 s39, s3, 8
  s_lshl_b32 s38, s76, 7
  s_add_u32 s39, s39, s38
  buffer_load_dword v15, v17, s[68:71], s39 offen
  v_mfma_f32_16x16x32_bf16 a[200:203], v[152:155], v[168:171], a[200:203]
  v_mfma_f32_16x16x32_bf16 a[204:207], v[152:155], v[172:175], a[204:207]
  v_mfma_f32_16x16x32_bf16 a[208:211], v[152:155], v[176:179], a[208:211]
  v_mfma_f32_16x16x32_bf16 a[212:215], v[152:155], v[180:183], a[212:215]
  v_mfma_f32_16x16x32_bf16 a[216:219], v[152:155], v[184:187], a[216:219]
  buffer_load_dwordx4 v46, s[60:63], s56 offen offset:2048 lds
  v_mfma_f32_16x16x32_bf16 a[220:223], v[152:155], v[188:191], a[220:223]
  v_mfma_f32_16x16x32_bf16 a[224:227], v[156:159], v[160:163], a[224:227]
  v_mfma_f32_16x16x32_bf16 a[228:231], v[156:159], v[164:167], a[228:231]
  v_mfma_f32_16x16x32_bf16 a[232:235], v[156:159], v[168:171], a[232:235]
  v_mfma_f32_16x16x32_bf16 a[236:239], v[156:159], v[172:175], a[236:239]
  v_mfma_f32_16x16x32_bf16 a[240:243], v[156:159], v[176:179], a[240:243]
  buffer_load_dwordx4 v47, s[60:63], s56 offen offset:3072 lds
  v_mfma_f32_16x16x32_bf16 a[244:247], v[156:159], v[180:183], a[244:247]
  v_mfma_f32_16x16x32_bf16 a[248:251], v[156:159], v[184:187], a[248:251]
  v_mfma_f32_16x16x32_bf16 a[252:255], v[156:159], v[188:191], a[252:255]
  s_waitcnt lgkmcnt(0)
  v_mfma_f32_16x16x32_bf16 a[0:3], v[64:67], v[96:99], a[0:3]
  ds_read_b128 v[128:131], v37 offset:0
  s_add_u32 s56, s50, 1966080
  s_add_u32 m0, s51, 77824
  v_mfma_f32_16x16x32_bf16 a[4:7], v[64:67], v[100:103], a[4:7]
  buffer_load_dwordx4 v44, s[60:63], s56 offen offset:0 lds
  v_mfma_f32_16x16x32_bf16 a[8:11], v[64:67], v[104:107], a[8:11]
  ds_read_b64_tr_b16 v[160:161], v20 offset:8192
  v_mov_b32 v216, 0
  v_mfma_f32_16x16x32_bf16 a[12:15], v[64:67], v[108:111], a[12:15]
  v_mov_b32 v220, 0
  v_mfma_f32_16x16x32_bf16 a[16:19], v[64:67], v[112:115], a[16:19]
  ds_read_b64_tr_b16 v[162:163], v20 offset:9216
  v_mov_b32 v217, 0
  v_mfma_f32_16x16x32_bf16 a[20:23], v[64:67], v[116:119], a[20:23]
  v_mov_b32 v221, 0
  v_mfma_f32_16x16x32_bf16 a[24:27], v[64:67], v[120:123], a[24:27]
  ds_read_b128 v[132:135], v37 offset:2048
  v_mov_b32 v218, 0
  v_mfma_f32_16x16x32_bf16 a[28:31], v[64:67], v[124:127], a[28:31]
  buffer_load_dwordx4 v45, s[60:63], s56 offen offset:1024 lds
  v_mfma_f32_16x16x32_bf16 a[32:35], v[68:71], v[96:99], a[32:35]
  ds_read_b64_tr_b16 v[164:165], v21 offset:8192
  v_mov_b32 v222, 0
  v_mfma_f32_16x16x32_bf16 a[36:39], v[68:71], v[100:103], a[36:39]
  v_mov_b32 v219, 0
  v_mfma_f32_16x16x32_bf16 a[40:43], v[68:71], v[104:107], a[40:43]
  ds_read_b64_tr_b16 v[166:167], v21 offset:9216
  v_mov_b32 v223, 0
  v_mfma_f32_16x16x32_bf16 a[44:47], v[68:71], v[108:111], a[44:47]
  v_lshlrev_b32 v224, 16, v208
  v_mfma_f32_16x16x32_bf16 a[48:51], v[68:71], v[112:115], a[48:51]
  ds_read_b128 v[136:139], v37 offset:4096
  v_and_b32 v225, 0xffff0000, v208
  v_mfma_f32_16x16x32_bf16 a[52:55], v[68:71], v[116:119], a[52:55]
  buffer_load_dwordx4 v46, s[60:63], s56 offen offset:2048 lds
  v_mfma_f32_16x16x32_bf16 a[56:59], v[68:71], v[120:123], a[56:59]
  ds_read_b64_tr_b16 v[168:169], v22 offset:8192
  v_lshlrev_b32 v226, 16, v212
  v_mfma_f32_16x16x32_bf16 a[60:63], v[68:71], v[124:127], a[60:63]
  v_and_b32 v227, 0xffff0000, v212
  v_mfma_f32_16x16x32_bf16 a[64:67], v[72:75], v[96:99], a[64:67]
  ds_read_b64_tr_b16 v[170:171], v22 offset:9216
  v_lshlrev_b32 v228, 16, v192
  v_mfma_f32_16x16x32_bf16 a[68:71], v[72:75], v[100:103], a[68:71]
  buffer_load_dwordx4 v47, s[60:63], s56 offen offset:3072 lds
  v_mfma_f32_16x16x32_bf16 a[72:75], v[72:75], v[104:107], a[72:75]
  ds_read_b128 v[140:143], v37 offset:6144
  v_mfma_f32_16x16x32_bf16 a[76:79], v[72:75], v[108:111], a[76:79]
  v_and_b32 v229, 0xffff0000, v192
  v_fmac_f32 v216, v224, v228
  v_mfma_f32_16x16x32_bf16 a[80:83], v[72:75], v[112:115], a[80:83]
  ds_read_b64_tr_b16 v[172:173], v23 offset:8192
  v_mfma_f32_16x16x32_bf16 a[84:87], v[72:75], v[116:119], a[84:87]
  v_fmac_f32 v216, v225, v229
  v_fmac_f32 v220, v226, v228
  v_mfma_f32_16x16x32_bf16 a[88:91], v[72:75], v[120:123], a[88:91]
  ds_read_b64_tr_b16 v[174:175], v23 offset:9216
  v_fmac_f32 v220, v227, v229
  v_mfma_f32_16x16x32_bf16 a[92:95], v[72:75], v[124:127], a[92:95]
  v_lshlrev_b32 v228, 16, v196
  v_mfma_f32_16x16x32_bf16 a[96:99], v[76:79], v[96:99], a[96:99]
  ds_read_b128 v[144:147], v37 offset:8192
  v_and_b32 v229, 0xffff0000, v196
  v_mfma_f32_16x16x32_bf16 a[100:103], v[76:79], v[100:103], a[100:103]
  v_fmac_f32 v217, v224, v228
  v_mfma_f32_16x16x32_bf16 a[104:107], v[76:79], v[104:107], a[104:107]
  ds_read_b64_tr_b16 v[176:177], v24 offset:8192
  v_fmac_f32 v217, v225, v229
  v_mfma_f32_16x16x32_bf16 a[108:111], v[76:79], v[108:111], a[108:111]
  v_fmac_f32 v221, v226, v228
  v_mfma_f32_16x16x32_bf16 a[112:115], v[76:79], v[112:115], a[112:115]
  ds_read_b64_tr_b16 v[178:179], v24 offset:9216
  v_fmac_f32 v221, v227, v229
  v_mfma_f32_16x16x32_bf16 a[116:119], v[76:79], v[116:119], a[116:119]
  v_lshlrev_b32 v228, 16, v200
  v_and_b32 v229, 0xffff0000, v200
  v_mfma_f32_16x16x32_bf16 a[120:123], v[76:79], v[120:123], a[120:123]
  ds_read_b128 v[148:151], v37 offset:10240
  v_mfma_f32_16x16x32_bf16 a[124:127], v[76:79], v[124:127], a[124:127]
  v_fmac_f32 v218, v224, v228
  v_fmac_f32 v218, v225, v229
  v_mfma_f32_16x16x32_bf16 a[128:131], v[80:83], v[96:99], a[128:131]
  ds_read_b64_tr_b16 v[180:181], v25 offset:8192
  v_mfma_f32_16x16x32_bf16 a[132:135], v[80:83], v[100:103], a[132:135]
  v_fmac_f32 v222, v226, v228
  v_fmac_f32 v222, v227, v229
  v_mfma_f32_16x16x32_bf16 a[136:139], v[80:83], v[104:107], a[136:139]
  ds_read_b64_tr_b16 v[182:183], v25 offset:9216
  v_lshlrev_b32 v228, 16, v204
  v_mfma_f32_16x16x32_bf16 a[140:143], v[80:83], v[108:111], a[140:143]
  v_and_b32 v229, 0xffff0000, v204
  v_mfma_f32_16x16x32_bf16 a[144:147], v[80:83], v[112:115], a[144:147]
  ds_read_b128 v[152:155], v37 offset:12288
  v_fmac_f32 v219, v224, v228
  v_mfma_f32_16x16x32_bf16 a[148:151], v[80:83], v[116:119], a[148:151]
  v_fmac_f32 v219, v225, v229
  v_mfma_f32_16x16x32_bf16 a[152:155], v[80:83], v[120:123], a[152:155]
  ds_read_b64_tr_b16 v[184:185], v26 offset:8192
  v_fmac_f32 v223, v226, v228
  v_mfma_f32_16x16x32_bf16 a[156:159], v[80:83], v[124:127], a[156:159]
  v_fmac_f32 v223, v227, v229
  v_mfma_f32_16x16x32_bf16 a[160:163], v[84:87], v[96:99], a[160:163]
  ds_read_b64_tr_b16 v[186:187], v26 offset:9216
  v_lshlrev_b32 v224, 16, v209
  v_mfma_f32_16x16x32_bf16 a[164:167], v[84:87], v[100:103], a[164:167]
  v_and_b32 v225, 0xffff0000, v209
  v_mfma_f32_16x16x32_bf16 a[168:171], v[84:87], v[104:107], a[168:171]
  ds_read_b128 v[156:159], v37 offset:14336
  v_lshlrev_b32 v226, 16, v213
  v_mfma_f32_16x16x32_bf16 a[172:175], v[84:87], v[108:111], a[172:175]
  v_and_b32 v227, 0xffff0000, v213
  v_lshlrev_b32 v228, 16, v193
  v_mfma_f32_16x16x32_bf16 a[176:179], v[84:87], v[112:115], a[176:179]
  ds_read_b64_tr_b16 v[188:189], v27 offset:8192
  v_mfma_f32_16x16x32_bf16 a[180:183], v[84:87], v[116:119], a[180:183]
  v_and_b32 v229, 0xffff0000, v193
  v_fmac_f32 v216, v224, v228
  v_mfma_f32_16x16x32_bf16 a[184:187], v[84:87], v[120:123], a[184:187]
  ds_read_b64_tr_b16 v[190:191], v27 offset:9216
  v_mfma_f32_16x16x32_bf16 a[188:191], v[84:87], v[124:127], a[188:191]
  v_fmac_f32 v216, v225, v229
  v_fmac_f32 v220, v226, v228
  v_mfma_f32_16x16x32_bf16 a[192:195], v[88:91], v[96:99], a[192:195]
  s_mul_i32 s56, s58, 5
  v_fmac_f32 v220, v227, v229
  v_mfma_f32_16x16x32_bf16 a[196:199], v[88:91], v[100:103], a[196:199]
  buffer_load_dword v15, v18, s[64:67], s56 offen
  v_mfma_f32_16x16x32_bf16 a[200:203], v[88:91], v[104:107], a[200:203]
  v_lshlrev_b32 v228, 16, v197
  v_mfma_f32_16x16x32_bf16 a[204:207], v[88:91], v[108:111], a[204:207]
  v_and_b32 v229, 0xffff0000, v197
  v_fmac_f32 v217, v224, v228
  v_mfma_f32_16x16x32_bf16 a[208:211], v[88:91], v[112:115], a[208:211]
  v_fmac_f32 v217, v225, v229
  v_mfma_f32_16x16x32_bf16 a[212:215], v[88:91], v[116:119], a[212:215]
  v_fmac_f32 v221, v226, v228
  v_fmac_f32 v221, v227, v229
  v_mfma_f32_16x16x32_bf16 a[216:219], v[88:91], v[120:123], a[216:219]
  s_add_u32 s56, s59, 2
  s_min_u32 s56, s56, 7
  s_mul_i32 s56, s56, s37
  v_mfma_f32_16x16x32_bf16 a[220:223], v[88:91], v[124:127], a[220:223]
  buffer_load_dword v15, v19, s[72:75], s56 offen
  v_mfma_f32_16x16x32_bf16 a[224:227], v[92:95], v[96:99], a[224:227]
  v_lshlrev_b32 v228, 16, v201
  v_mfma_f32_16x16x32_bf16 a[228:231], v[92:95], v[100:103], a[228:231]
  v_and_b32 v229, 0xffff0000, v201
  v_fmac_f32 v218, v224, v228
  v_mfma_f32_16x16x32_bf16 a[232:235], v[92:95], v[104:107], a[232:235]
  v_fmac_f32 v218, v225, v229
  v_mfma_f32_16x16x32_bf16 a[236:239], v[92:95], v[108:111], a[236:239]
  v_fmac_f32 v222, v226, v228
  v_fmac_f32 v222, v227, v229
  v_mfma_f32_16x16x32_bf16 a[240:243], v[92:95], v[112:115], a[240:243]
  v_lshlrev_b32 v228, 16, v205
  v_mfma_f32_16x16x32_bf16 a[244:247], v[92:95], v[116:119], a[244:247]
  v_and_b32 v229, 0xffff0000, v205
  v_fmac_f32 v219, v224, v228
  v_mfma_f32_16x16x32_bf16 a[248:251], v[92:95], v[120:123], a[248:251]
  v_fmac_f32 v219, v225, v229
  v_mfma_f32_16x16x32_bf16 a[252:255], v[92:95], v[124:127], a[252:255]
  s_waitcnt vmcnt(2) lgkmcnt(0)
  s_barrier
  v_mfma_f32_16x16x32_bf16 a[0:3], v[128:131], v[160:163], a[0:3]
  ds_read_b128 v[64:67], v38 offset:0
  s_add_u32 s56, s50, 2097152
  s_add_u32 m0, s51, 0
  v_mfma_f32_16x16x32_bf16 a[4:7], v[128:131], v[164:167], a[4:7]
  buffer_load_dwordx4 v44, s[60:63], s56 offen offset:0 lds
  v_mfma_f32_16x16x32_bf16 a[8:11], v[128:131], v[168:171], a[8:11]
  ds_read_b64_tr_b16 v[96:97], v28 offset:0
  v_fmac_f32 v223, v226, v228
  v_mfma_f32_16x16x32_bf16 a[12:15], v[128:131], v[172:175], a[12:15]
  v_fmac_f32 v223, v227, v229
  v_mfma_f32_16x16x32_bf16 a[16:19], v[128:131], v[176:179], a[16:19]
  ds_read_b64_tr_b16 v[98:99], v28 offset:1024
  v_lshlrev_b32 v224, 16, v210
  v_mfma_f32_16x16x32_bf16 a[20:23], v[128:131], v[180:183], a[20:23]
  v_and_b32 v225, 0xffff0000, v210
  v_mfma_f32_16x16x32_bf16 a[24:27], v[128:131], v[184:187], a[24:27]
  ds_read_b128 v[68:71], v38 offset:2048
  v_lshlrev_b32 v226, 16, v214
  v_mfma_f32_16x16x32_bf16 a[28:31], v[128:131], v[188:191], a[28:31]
  buffer_load_dwordx4 v45, s[60:63], s56 offen offset:1024 lds
  v_mfma_f32_16x16x32_bf16 a[32:35], v[132:135], v[160:163], a[32:35]
  ds_read_b64_tr_b16 v[100:101], v29 offset:0
  v_and_b32 v227, 0xffff0000, v214
  v_mfma_f32_16x16x32_bf16 a[36:39], v[132:135], v[164:167], a[36:39]
  v_lshlrev_b32 v228, 16, v194
  v_mfma_f32_16x16x32_bf16 a[40:43], v[132:135], v[168:171], a[40:43]
  ds_read_b64_tr_b16 v[102:103], v29 offset:1024
  v_and_b32 v229, 0xffff0000, v194
  v_mfma_f32_16x16x32_bf16 a[44:47], v[132:135], v[172:175], a[44:47]
  buffer_load_dwordx4 v46, s[60:63], s56 offen offset:2048 lds
  v_mfma_f32_16x16x32_bf16 a[48:51], v[132:135], v[176:179], a[48:51]
  ds_read_b128 v[72:75], v38 offset:4096
  v_fmac_f32 v216, v224, v228
  v_mfma_f32_16x16x32_bf16 a[52:55], v[132:135], v[180:183], a[52:55]
  v_fmac_f32 v216, v225, v229
  v_mfma_f32_16x16x32_bf16 a[56:59], v[132:135], v[184:187], a[56:59]
  ds_read_b64_tr_b16 v[104:105], v30 offset:0
  v_fmac_f32 v220, v226, v228
  v_mfma_f32_16x16x32_bf16 a[60:63], v[132:135], v[188:191], a[60:63]
  v_fmac_f32 v220, v227, v229
  v_mfma_f32_16x16x32_bf16 a[64:67], v[136:139], v[160:163], a[64:67]
  ds_read_b64_tr_b16 v[106:107], v30 offset:1024
  v_lshlrev_b32 v228, 16, v198
  v_mfma_f32_16x16x32_bf16 a[68:71], v[136:139], v[164:167], a[68:71]
  buffer_load_dwordx4 v47, s[60:63], s56 offen offset:3072 lds
  v_mfma_f32_16x16x32_bf16 a[72:75], v[136:139], v[168:171], a[72:75]
  ds_read_b128 v[76:79], v38 offset:6144
  v_mfma_f32_16x16x32_bf16 a[76:79], v[136:139], v[172:175], a[76:79]
  v_and_b32 v229, 0xffff0000, v198
  v_fmac_f32 v217, v224, v228
  v_mfma_f32_16x16x32_bf16 a[80:83], v[136:139], v[176:179], a[80:83]
  ds_read_b64_tr_b16 v[108:109], v31 offset:0
  v_fmac_f32 v217, v225, v229
  v_mfma_f32_16x16x32_bf16 a[84:87], v[136:139], v[180:183], a[84:87]
  v_fmac_f32 v221, v226, v228
  v_mfma_f32_16x16x32_bf16 a[88:91], v[136:139], v[184:187], a[88:91]
  ds_read_b64_tr_b16 v[110:111], v31 offset:1024
  s_add_u32 s56, s50, 2228224
  s_add_u32 m0, s51, 4096
  v_mfma_f32_16x16x32_bf16 a[92:95], v[136:139], v[188:191], a[92:95]
  buffer_load_dwordx4 v44, s[60:63], s56 offen offset:0 lds
  v_mfma_f32_16x16x32_bf16 a[96:99], v[140:143], v[160:163], a[96:99]
  ds_read_b128 v[80:83], v38 offset:8192
  v_fmac_f32 v221, v227, v229
  v_mfma_f32_16x16x32_bf16 a[100:103], v[140:143], v[164:167], a[100:103]
  v_lshlrev_b32 v228, 16, v202
  v_mfma_f32_16x16x32_bf16 a[104:107], v[140:143], v[168:171], a[104:107]
  ds_read_b64_tr_b16 v[112:113], v32 offset:0
  v_and_b32 v229, 0xffff0000, v202
  v_mfma_f32_16x16x32_bf16 a[108:111], v[140:143], v[172:175], a[108:111]
  buffer_load_dwordx4 v45, s[60:63], s56 offen offset:1024 lds
  v_mfma_f32_16x16x32_bf16 a[112:115], v[140:143], v[176:179], a[112:115]
  ds_read_b64_tr_b16 v[114:115], v32 offset:1024
  v_fmac_f32 v218, v224, v228
  v_mfma_f32_16x16x32_bf16 a[116:119], v[140:143], v[180:183], a[116:119]
  v_fmac_f32 v218, v225, v229
  v_mfma_f32_16x16x32_bf16 a[120:123], v[140:143], v[184:187], a[120:123]
  ds_read_b128 v[84:87], v38 offset:10240
  v_fmac_f32 v222, v226, v228
  v_mfma_f32_16x16x32_bf16 a[124:127], v[140:143], v[188:191], a[124:127]
  v_fmac_f32 v222, v227, v229
  v_mfma_f32_16x16x32_bf16 a[128:131], v[144:147], v[160:163], a[128:131]
  ds_read_b64_tr_b16 v[116:117], v33 offset:0
  v_lshlrev_b32 v228, 16, v206
  v_mfma_f32_16x16x32_bf16 a[132:135], v[144:147], v[164:167], a[132:135]
  buffer_load_dwordx4 v46, s[60:63], s56 offen offset:2048 lds
  v_mfma_f32_16x16x32_bf16 a[136:139], v[144:147], v[168:171], a[136:139]
  ds_read_b64_tr_b16 v[118:119], v33 offset:1024
  v_and_b32 v229, 0xffff0000, v206
  v_mfma_f32_16x16x32_bf16 a[140:143], v[144:147], v[172:175], a[140:143]
  v_fmac_f32 v219, v224, v228
  v_mfma_f32_16x16x32_bf16 a[144:147], v[144:147], v[176:179], a[144:147]
  ds_read_b128 v[88:91], v38 offset:12288
  v_fmac_f32 v219, v225, v229
  v_mfma_f32_16x16x32_bf16 a[148:151], v[144:147], v[180:183], a[148:151]
  v_fmac_f32 v223, v226, v228
  v_mfma_f32_16x16x32_bf16 a[152:155], v[144:147], v[184:187], a[152:155]
  ds_read_b64_tr_b16 v[120:121], v34 offset:0
  v_fmac_f32 v223, v227, v229
  v_mfma_f32_16x16x32_bf16 a[156:159], v[144:147], v[188:191], a[156:159]
  buffer_load_dwordx4 v47, s[60:63], s56 offen offset:3072 lds
  v_mfma_f32_16x16x32_bf16 a[160:163], v[148:151], v[160:163], a[160:163]
  ds_read_b64_tr_b16 v[122:123], v34 offset:1024
  v_mfma_f32_16x16x32_bf16 a[164:167], v[148:151], v[164:167], a[164:167]
  v_lshlrev_b32 v224, 16, v211
  v_and_b32 v225, 0xffff0000, v211
  v_mfma_f32_16x16x32_bf16 a[168:171], v[148:151], v[168:171], a[168:171]
  ds_read_b128 v[92:95], v38 offset:14336
  v_lshlrev_b32 v226, 16, v215
  v_mfma_f32_16x16x32_bf16 a[172:175], v[148:151], v[172:175], a[172:175]
  v_and_b32 v227, 0xffff0000, v215
  v_mfma_f32_16x16x32_bf16 a[176:179], v[148:151], v[176:179], a[176:179]
  ds_read_b64_tr_b16 v[124:125], v35 offset:0
  s_add_u32 s56, s50, 2359296
  s_add_u32 m0, s51, 8192
  v_mfma_f32_16x16x32_bf16 a[180:183], v[148:151], v[180:183], a[180:183]
  buffer_load_dwordx4 v44, s[60:63], s56 offen offset:0 lds
  v_mfma_f32_16x16x32_bf16 a[184:187], v[148:151], v[184:187], a[184:187]
  ds_read_b64_tr_b16 v[126:127], v35 offset:1024
  v_lshlrev_b32 v228, 16, v195
  v_mfma_f32_16x16x32_bf16 a[188:191], v[148:151], v[188:191], a[188:191]
  v_and_b32 v229, 0xffff0000, v195
  v_mfma_f32_16x16x32_bf16 a[192:195], v[152:155], v[160:163], a[192:195]
  v_fmac_f32 v216, v224, v228
  v_fmac_f32 v216, v225, v229
  v_mfma_f32_16x16x32_bf16 a[196:199], v[152:155], v[164:167], a[196:199]
  buffer_load_dwordx4 v45, s[60:63], s56 offen offset:1024 lds
  v_mfma_f32_16x16x32_bf16 a[200:203], v[152:155], v[168:171], a[200:203]
  v_fmac_f32 v220, v226, v228
  v_mfma_f32_16x16x32_bf16 a[204:207], v[152:155], v[172:175], a[204:207]
  v_fmac_f32 v220, v227, v229
  v_lshlrev_b32 v228, 16, v199
  v_mfma_f32_16x16x32_bf16 a[208:211], v[152:155], v[176:179], a[208:211]
  v_and_b32 v229, 0xffff0000, v199
  v_mfma_f32_16x16x32_bf16 a[212:215], v[152:155], v[180:183], a[212:215]
  v_fmac_f32 v217, v224, v228
  v_fmac_f32 v217, v225, v229
  v_mfma_f32_16x16x32_bf16 a[216:219], v[152:155], v[184:187], a[216:219]
  buffer_load_dwordx4 v46, s[60:63], s56 offen offset:2048 lds
  v_mfma_f32_16x16x32_bf16 a[220:223], v[152:155], v[188:191], a[220:223]
  v_fmac_f32 v221, v226, v228
  v_mfma_f32_16x16x32_bf16 a[224:227], v[156:159], v[160:163], a[224:227]
  v_fmac_f32 v221, v227, v229
  v_lshlrev_b32 v228, 16, v203
  v_mfma_f32_16x16x32_bf16 a[228:231], v[156:159], v[164:167], a[228:231]
  v_and_b32 v229, 0xffff0000, v203
  v_mfma_f32_16x16x32_bf16 a[232:235], v[156:159], v[168:171], a[232:235]
  v_fmac_f32 v218, v224, v228
  v_fmac_f32 v218, v225, v229
  v_mfma_f32_16x16x32_bf16 a[236:239], v[156:159], v[172:175], a[236:239]
  v_fmac_f32 v222, v226, v228
  v_mfma_f32_16x16x32_bf16 a[240:243], v[156:159], v[176:179], a[240:243]
  buffer_load_dwordx4 v47, s[60:63], s56 offen offset:3072 lds
  v_mfma_f32_16x16x32_bf16 a[244:247], v[156:159], v[180:183], a[244:247]
  v_fmac_f32 v222, v227, v229
  v_lshlrev_b32 v228, 16, v207
  v_mfma_f32_16x16x32_bf16 a[248:251], v[156:159], v[184:187], a[248:251]
  v_and_b32 v229, 0xffff0000, v207
  v_mfma_f32_16x16x32_bf16 a[252:255], v[156:159], v[188:191], a[252:255]
  v_fmac_f32 v219, v224, v228
  s_waitcnt lgkmcnt(0)
  v_mfma_f32_16x16x32_bf16 a[0:3], v[64:67], v[96:99], a[0:3]
  ds_read_b128 v[128:131], v39 offset:0
  s_add_u32 s56, s50, 2490368
  s_add_u32 m0, s51, 12288
  v_mfma_f32_16x16x32_bf16 a[4:7], v[64:67], v[100:103], a[4:7]
  buffer_load_dwordx4 v44, s[60:63], s56 offen offset:0 lds
  v_mfma_f32_16x16x32_bf16 a[8:11], v[64:67], v[104:107], a[8:11]
  ds_read_b64_tr_b16 v[160:161], v28 offset:8192
  v_fmac_f32 v219, v225, v229
  v_mfma_f32_16x16x32_bf16 a[12:15], v[64:67], v[108:111], a[12:15]
  v_fmac_f32 v223, v226, v228
  v_mfma_f32_16x16x32_bf16 a[16:19], v[64:67], v[112:115], a[16:19]
  ds_read_b64_tr_b16 v[162:163], v28 offset:9216
  v_fmac_f32 v223, v227, v229
  v_mfma_f32_16x16x32_bf16 a[20:23], v[64:67], v[116:119], a[20:23]
  v_add_f32_dpp v216, v216, v216 row_shr:1 row_mask:0xf bank_mask:0xf bound_ctrl:1
  v_mfma_f32_16x16x32_bf16 a[24:27], v[64:67], v[120:123], a[24:27]
  ds_read_b128 v[132:135], v39 offset:2048
  v_add_f32_dpp v217, v217, v217 row_shr:1 row_mask:0xf bank_mask:0xf bound_ctrl:1
  v_mfma_f32_16x16x32_bf16 a[28:31], v[64:67], v[124:127], a[28:31]
  buffer_load_dwordx4 v45, s[60:63], s56 offen offset:1024 lds
  v_mfma_f32_16x16x32_bf16 a[32:35], v[68:71], v[96:99], a[32:35]
  ds_read_b64_tr_b16 v[164:165], v29 offset:8192
  v_add_f32_dpp v218, v218, v218 row_shr:1 row_mask:0xf bank_mask:0xf bound_ctrl:1
  v_mfma_f32_16x16x32_bf16 a[36:39], v[68:71], v[100:103], a[36:39]
  v_add_f32_dpp v219, v219, v219 row_shr:1 row_mask:0xf bank_mask:0xf bound_ctrl:1
  v_mfma_f32_16x16x32_bf16 a[40:43], v[68:71], v[104:107], a[40:43]
  ds_read_b64_tr_b16 v[166:167], v29 offset:9216
  v_add_f32_dpp v220, v220, v220 row_shr:1 row_mask:0xf bank_mask:0xf bound_ctrl:1
  v_mfma_f32_16x16x32_bf16 a[44:47], v[68:71], v[108:111], a[44:47]
  v_add_f32_dpp v221, v221, v221 row_shr:1 row_mask:0xf bank_mask:0xf bound_ctrl:1
  v_mfma_f32_16x16x32_bf16 a[48:51], v[68:71], v[112:115], a[48:51]
  ds_read_b128 v[136:139], v39 offset:4096
  v_add_f32_dpp v222, v222, v222 row_shr:1 row_mask:0xf bank_mask:0xf bound_ctrl:1
  v_mfma_f32_16x16x32_bf16 a[52:55], v[68:71], v[116:119], a[52:55]
  buffer_load_dwordx4 v46, s[60:63], s56 offen offset:2048 lds
  v_mfma_f32_16x16x32_bf16 a[56:59], v[68:71], v[120:123], a[56:59]
  ds_read_b64_tr_b16 v[168:169], v30 offset:8192
  v_add_f32_dpp v223, v223, v223 row_shr:1 row_mask:0xf bank_mask:0xf bound_ctrl:1
  v_mfma_f32_16x16x32_bf16 a[60:63], v[68:71], v[124:127], a[60:63]
  v_add_f32_dpp v216, v216, v216 row_shr:2 row_mask:0xf bank_mask:0xf bound_ctrl:1
  v_mfma_f32_16x16x32_bf16 a[64:67], v[72:75], v[96:99], a[64:67]
  ds_read_b64_tr_b16 v[170:171], v30 offset:9216
  v_add_f32_dpp v217, v217, v217 row_shr:2 row_mask:0xf bank_mask:0xf bound_ctrl:1
  v_mfma_f32_16x16x32_bf16 a[68:71], v[72:75], v[100:103], a[68:71]
  buffer_load_dwordx4 v47, s[60:63], s56 offen offset:3072 lds
  v_mfma_f32_16x16x32_bf16 a[72:75], v[72:75], v[104:107], a[72:75]
  ds_read_b128 v[140:143], v39 offset:6144
  v_mfma_f32_16x16x32_bf16 a[76:79], v[72:75], v[108:111], a[76:79]
  v_add_f32_dpp v218, v218, v218 row_shr:2 row_mask:0xf bank_mask:0xf bound_ctrl:1
  v_add_f32_dpp v219, v219, v219 row_shr:2 row_mask:0xf bank_mask:0xf bound_ctrl:1
  v_mfma_f32_16x16x32_bf16 a[80:83], v[72:75], v[112:115], a[80:83]
  ds_read_b64_tr_b16 v[172:173], v31 offset:8192
  v_mfma_f32_16x16x32_bf16 a[84:87], v[72:75], v[116:119], a[84:87]
  v_add_f32_dpp v220, v220, v220 row_shr:2 row_mask:0xf bank_mask:0xf bound_ctrl:1
  v_add_f32_dpp v221, v221, v221 row_shr:2 row_mask:0xf bank_mask:0xf bound_ctrl:1
  v_mfma_f32_16x16x32_bf16 a[88:91], v[72:75], v[120:123], a[88:91]
  ds_read_b64_tr_b16 v[174:175], v31 offset:9216
  v_add_f32_dpp v222, v222, v222 row_shr:2 row_mask:0xf bank_mask:0xf bound_ctrl:1
  v_mfma_f32_16x16x32_bf16 a[92:95], v[72:75], v[124:127], a[92:95]
  v_add_f32_dpp v223, v223, v223 row_shr:2 row_mask:0xf bank_mask:0xf bound_ctrl:1
  v_mfma_f32_16x16x32_bf16 a[96:99], v[76:79], v[96:99], a[96:99]
  ds_read_b128 v[144:147], v39 offset:8192
  v_add_f32_dpp v216, v216, v216 row_shr:4 row_mask:0xf bank_mask:0xf bound_ctrl:1
  v_mfma_f32_16x16x32_bf16 a[100:103], v[76:79], v[100:103], a[100:103]
  v_add_f32_dpp v217, v217, v217 row_shr:4 row_mask:0xf bank_mask:0xf bound_ctrl:1
  v_mfma_f32_16x16x32_bf16 a[104:107], v[76:79], v[104:107], a[104:107]
  ds_read_b64_tr_b16 v[176:177], v32 offset:8192
  v_add_f32_dpp v218, v218, v218 row_shr:4 row_mask:0xf bank_mask:0xf bound_ctrl:1
  v_mfma_f32_16x16x32_bf16 a[108:111], v[76:79], v[108:111], a[108:111]
  v_add_f32_dpp v219, v219, v219 row_shr:4 row_mask:0xf bank_mask:0xf bound_ctrl:1
  v_mfma_f32_16x16x32_bf16 a[112:115], v[76:79], v[112:115], a[112:115]
  ds_read_b64_tr_b16 v[178:179], v32 offset:9216
  v_add_f32_dpp v220, v220, v220 row_shr:4 row_mask:0xf bank_mask:0xf bound_ctrl:1
  v_mfma_f32_16x16x32_bf16 a[116:119], v[76:79], v[116:119], a[116:119]
  v_add_f32_dpp v221, v221, v221 row_shr:4 row_mask:0xf bank_mask:0xf bound_ctrl:1
  v_add_f32_dpp v222, v222, v222 row_shr:4 row_mask:0xf bank_mask:0xf bound_ctrl:1
  v_mfma_f32_16x16x32_bf16 a[120:123], v[76:79], v[120:123], a[120:123]
  ds_read_b128 v[148:151], v39 offset:10240
  v_mfma_f32_16x16x32_bf16 a[124:127], v[76:79], v[124:127], a[124:127]
  v_add_f32_dpp v223, v223, v223 row_shr:4 row_mask:0xf bank_mask:0xf bound_ctrl:1
  v_add_f32_dpp v216, v216, v216 row_shr:8 row_mask:0xf bank_mask:0xf bound_ctrl:1
  v_mfma_f32_16x16x32_bf16 a[128:131], v[80:83], v[96:99], a[128:131]
  ds_read_b64_tr_b16 v[180:181], v33 offset:8192
  v_mfma_f32_16x16x32_bf16 a[132:135], v[80:83], v[100:103], a[132:135]
  v_add_f32_dpp v217, v217, v217 row_shr:8 row_mask:0xf bank_mask:0xf bound_ctrl:1
  v_add_f32_dpp v218, v218, v218 row_shr:8 row_mask:0xf bank_mask:0xf bound_ctrl:1
  v_mfma_f32_16x16x32_bf16 a[136:139], v[80:83], v[104:107], a[136:139]
  ds_read_b64_tr_b16 v[182:183], v33 offset:9216
  v_add_f32_dpp v219, v219, v219 row_shr:8 row_mask:0xf bank_mask:0xf bound_ctrl:1
  v_mfma_f32_16x16x32_bf16 a[140:143], v[80:83], v[108:111], a[140:143]
  v_add_f32_dpp v220, v220, v220 row_shr:8 row_mask:0xf bank_mask:0xf bound_ctrl:1
  v_mfma_f32_16x16x32_bf16 a[144:147], v[80:83], v[112:115], a[144:147]
  ds_read_b128 v[152:155], v39 offset:12288
  v_add_f32_dpp v221, v221, v221 row_shr:8 row_mask:0xf bank_mask:0xf bound_ctrl:1
  v_mfma_f32_16x16x32_bf16 a[148:151], v[80:83], v[116:119], a[148:151]
  v_add_f32_dpp v222, v222, v222 row_shr:8 row_mask:0xf bank_mask:0xf bound_ctrl:1
  v_mfma_f32_16x16x32_bf16 a[152:155], v[80:83], v[120:123], a[152:155]
  ds_read_b64_tr_b16 v[184:185], v34 offset:8192
  v_add_f32_dpp v223, v223, v223 row_shr:8 row_mask:0xf bank_mask:0xf bound_ctrl:1
  v_mfma_f32_16x16x32_bf16 a[156:159], v[80:83], v[124:127], a[156:159]
  v_add_f32_dpp v216, v216, v216 row_bcast:15 row_mask:0xa bank_mask:0xf
  v_mfma_f32_16x16x32_bf16 a[160:163], v[84:87], v[96:99], a[160:163]
  ds_read_b64_tr_b16 v[186:187], v34 offset:9216
  v_add_f32_dpp v217, v217, v217 row_bcast:15 row_mask:0xa bank_mask:0xf
  v_mfma_f32_16x16x32_bf16 a[164:167], v[84:87], v[100:103], a[164:167]
  v_add_f32_dpp v218, v218, v218 row_bcast:15 row_mask:0xa bank_mask:0xf
  v_mfma_f32_16x16x32_bf16 a[168:171], v[84:87], v[104:107], a[168:171]
  ds_read_b128 v[156:159], v39 offset:14336
  v_add_f32_dpp v219, v219, v219 row_bcast:15 row_mask:0xa bank_mask:0xf
  v_mfma_f32_16x16x32_bf16 a[172:175], v[84:87], v[108:111], a[172:175]
  v_add_f32_dpp v220, v220, v220 row_bcast:15 row_mask:0xa bank_mask:0xf
  v_add_f32_dpp v221, v221, v221 row_bcast:15 row_mask:0xa bank_mask:0xf
  v_mfma_f32_16x16x32_bf16 a[176:179], v[84:87], v[112:115], a[176:179]
  ds_read_b64_tr_b16 v[188:189], v35 offset:8192
  v_mfma_f32_16x16x32_bf16 a[180:183], v[84:87], v[116:119], a[180:183]
  v_add_f32_dpp v222, v222, v222 row_bcast:15 row_mask:0xa bank_mask:0xf
  v_add_f32_dpp v223, v223, v223 row_bcast:15 row_mask:0xa bank_mask:0xf
  v_mfma_f32_16x16x32_bf16 a[184:187], v[84:87], v[120:123], a[184:187]
  ds_read_b64_tr_b16 v[190:191], v35 offset:9216
  v_mfma_f32_16x16x32_bf16 a[188:191], v[84:87], v[124:127], a[188:191]
  v_add_f32_dpp v216, v216, v216 row_bcast:31 row_mask:0xc bank_mask:0xf
  v_add_f32_dpp v217, v217, v217 row_bcast:31 row_mask:0xc bank_mask:0xf
  v_mfma_f32_16x16x32_bf16 a[192:195], v[88:91], v[96:99], a[192:195]
  s_mul_i32 s56, s58, 6
  v_add_f32_dpp v218, v218, v218 row_bcast:31 row_mask:0xc bank_mask:0xf
  v_mfma_f32_16x16x32_bf16 a[196:199], v[88:91], v[100:103], a[196:199]
  buffer_load_dword v15, v18, s[64:67], s56 offen
  v_mfma_f32_16x16x32_bf16 a[200:203], v[88:91], v[104:107], a[200:203]
  v_add_f32_dpp v219, v219, v219 row_bcast:31 row_mask:0xc bank_mask:0xf
  v_mfma_f32_16x16x32_bf16 a[204:207], v[88:91], v[108:111], a[204:207]
  v_add_f32_dpp v220, v220, v220 row_bcast:31 row_mask:0xc bank_mask:0xf
  v_add_f32_dpp v221, v221, v221 row_bcast:31 row_mask:0xc bank_mask:0xf
  v_mfma_f32_16x16x32_bf16 a[208:211], v[88:91], v[112:115], a[208:211]
  v_add_f32_dpp v222, v222, v222 row_bcast:31 row_mask:0xc bank_mask:0xf
  v_mfma_f32_16x16x32_bf16 a[212:215], v[88:91], v[116:119], a[212:215]
  v_add_f32_dpp v223, v223, v223 row_bcast:31 row_mask:0xc bank_mask:0xf
  v_mul_f32 v220, 0xbfb8aa3b, v220
  v_mfma_f32_16x16x32_bf16 a[216:219], v[88:91], v[120:123], a[216:219]
  s_add_u32 s56, s59, 3
  s_min_u32 s56, s56, 7
  s_mul_i32 s56, s56, s37
  v_mfma_f32_16x16x32_bf16 a[220:223], v[88:91], v[124:127], a[220:223]
  buffer_load_dword v15, v19, s[72:75], s56 offen
  v_mfma_f32_16x16x32_bf16 a[224:227], v[92:95], v[96:99], a[224:227]
  v_mul_f32 v221, 0xbfb8aa3b, v221
  v_mfma_f32_16x16x32_bf16 a[228:231], v[92:95], v[100:103], a[228:231]
  v_mul_f32 v222, 0xbfb8aa3b, v222
  v_mul_f32 v223, 0xbfb8aa3b, v223
  v_mfma_f32_16x16x32_bf16 a[232:235], v[92:95], v[104:107], a[232:235]
  v_exp_f32 v220, v220
  v_mfma_f32_16x16x32_bf16 a[236:239], v[92:95], v[108:111], a[236:239]
  v_mfma_f32_16x16x32_bf16 a[240:243], v[92:95], v[112:115], a[240:243]
  v_exp_f32 v221, v221
  v_mfma_f32_16x16x32_bf16 a[244:247], v[92:95], v[116:119], a[244:247]
  v_exp_f32 v222, v222
  v_mfma_f32_16x16x32_bf16 a[248:251], v[92:95], v[120:123], a[248:251]
  v_exp_f32 v223, v223
  v_mfma_f32_16x16x32_bf16 a[252:255], v[92:95], v[124:127], a[252:255]
  s_waitcnt vmcnt(2) lgkmcnt(0)
  s_barrier
  v_mfma_f32_16x16x32_bf16 a[0:3], v[128:131], v[160:163], a[0:3]
  ds_read_b128 v[64:67], v36 offset:0
  s_add_u32 s56, s50, 2621440
  s_add_u32 m0, s51, 65536
  v_mfma_f32_16x16x32_bf16 a[4:7], v[128:131], v[164:167], a[4:7]
  buffer_load_dwordx4 v44, s[60:63], s56 offen offset:0 lds
  v_mfma_f32_16x16x32_bf16 a[8:11], v[128:131], v[168:171], a[8:11]
  ds_read_b64_tr_b16 v[96:97], v20 offset:0
  v_mfma_f32_16x16x32_bf16 a[12:15], v[128:131], v[172:175], a[12:15]
  v_add_f32 v220, 1.0, v220
  v_mfma_f32_16x16x32_bf16 a[16:19], v[128:131], v[176:179], a[16:19]
  ds_read_b64_tr_b16 v[98:99], v20 offset:1024
  v_add_f32 v221, 1.0, v221
  v_mfma_f32_16x16x32_bf16 a[20:23], v[128:131], v[180:183], a[20:23]
  v_add_f32 v222, 1.0, v222
  v_mfma_f32_16x16x32_bf16 a[24:27], v[128:131], v[184:187], a[24:27]
  ds_read_b128 v[68:71], v36 offset:2048
  v_add_f32 v223, 1.0, v223
  v_mfma_f32_16x16x32_bf16 a[28:31], v[128:131], v[188:191], a[28:31]
  buffer_load_dwordx4 v45, s[60:63], s56 offen offset:1024 lds
  v_mfma_f32_16x16x32_bf16 a[32:35], v[132:135], v[160:163], a[32:35]
  ds_read_b64_tr_b16 v[100:101], v21 offset:0
  v_mfma_f32_16x16x32_bf16 a[36:39], v[132:135], v[164:167], a[36:39]
  v_rcp_f32 v220, v220
  v_mfma_f32_16x16x32_bf16 a[40:43], v[132:135], v[168:171], a[40:43]
  ds_read_b64_tr_b16 v[102:103], v21 offset:1024
  v_mfma_f32_16x16x32_bf16 a[44:47], v[132:135], v[172:175], a[44:47]
  buffer_load_dwordx4 v46, s[60:63], s56 offen offset:2048 lds
  v_mfma_f32_16x16x32_bf16 a[48:51], v[132:135], v[176:179], a[48:51]
  ds_read_b128 v[72:75], v36 offset:4096
  v_rcp_f32 v221, v221
  v_mfma_f32_16x16x32_bf16 a[52:55], v[132:135], v[180:183], a[52:55]
  v_rcp_f32 v222, v222
  v_mfma_f32_16x16x32_bf16 a[56:59], v[132:135], v[184:187], a[56:59]
  ds_read_b64_tr_b16 v[104:105], v22 offset:0
  v_mfma_f32_16x16x32_bf16 a[60:63], v[132:135], v[188:191], a[60:63]
  v_rcp_f32 v223, v223
  v_mfma_f32_16x16x32_bf16 a[64:67], v[136:139], v[160:163], a[64:67]
  ds_read_b64_tr_b16 v[106:107], v22 offset:1024
  v_mfma_f32_16x16x32_bf16 a[68:71], v[136:139], v[164:167], a[68:71]
  buffer_load_dwordx4 v47, s[60:63], s56 offen offset:3072 lds
  v_mfma_f32_16x16x32_bf16 a[72:75], v[136:139], v[168:171], a[72:75]
  ds_read_b128 v[76:79], v36 offset:6144
  v_mfma_f32_16x16x32_bf16 a[76:79], v[136:139], v[172:175], a[76:79]
  s_lshl_b32 s38, s2, 5
  s_lshl_b32 s39, s76, 4
  v_mfma_f32_16x16x32_bf16 a[80:83], v[136:139], v[176:179], a[80:83]
  ds_read_b64_tr_b16 v[108:109], v23 offset:0
  s_add_u32 s38, s38, s39
  v_mfma_f32_16x16x32_bf16 a[84:87], v[136:139], v[180:183], a[84:87]
  s_mul_i32 s39, s2, 96
  v_mfma_f32_16x16x32_bf16 a[88:91], v[136:139], v[184:187], a[88:91]
  ds_read_b64_tr_b16 v[110:111], v23 offset:1024
  s_add_u32 s56, s50, 2752512
  s_add_u32 m0, s51, 69632
  v_mfma_f32_16x16x32_bf16 a[92:95], v[136:139], v[188:191], a[92:95]
  buffer_load_dwordx4 v44, s[60:63], s56 offen offset:0 lds
  v_mfma_f32_16x16x32_bf16 a[96:99], v[140:143], v[160:163], a[96:99]
  ds_read_b128 v[80:83], v36 offset:8192
  s_add_u32 s39, s39, 65536
  v_mfma_f32_16x16x32_bf16 a[100:103], v[140:143], v[164:167], a[100:103]
  v_mov_b32 v224, s39
  v_mfma_f32_16x16x32_bf16 a[104:107], v[140:143], v[168:171], a[104:107]
  ds_read_b64_tr_b16 v[112:113], v24 offset:0
  v_mov_b32 v225, 8192
  v_mfma_f32_16x16x32_bf16 a[108:111], v[140:143], v[172:175], a[108:111]
  buffer_load_dwordx4 v45, s[60:63], s56 offen offset:1024 lds
  v_mfma_f32_16x16x32_bf16 a[112:115], v[140:143], v[176:179], a[112:115]
  ds_read_b64_tr_b16 v[114:115], v24 offset:1024
  v_mfma_f32_16x16x32_bf16 a[116:119], v[140:143], v[180:183], a[116:119]
  v_mfma_f32_16x16x32_bf16 a[120:123], v[140:143], v[184:187], a[120:123]
  ds_read_b128 v[84:87], v36 offset:10240
  v_mfma_f32_16x16x32_bf16 a[124:127], v[140:143], v[188:191], a[124:127]
  v_mfma_f32_16x16x32_bf16 a[128:131], v[144:147], v[160:163], a[128:131]
  ds_read_b64_tr_b16 v[116:117], v25 offset:0
  v_mfma_f32_16x16x32_bf16 a[132:135], v[144:147], v[164:167], a[132:135]
  buffer_load_dwordx4 v46, s[60:63], s56 offen offset:2048 lds
  v_mfma_f32_16x16x32_bf16 a[136:139], v[144:147], v[168:171], a[136:139]
  ds_read_b64_tr_b16 v[118:119], v25 offset:1024
  v_cmp_eq_u32 vcc, 63, v1
  s_and_saveexec_b64 s[40:41], vcc
  buffer_store_dwordx4 v[216:219], v224, s[20:23], s38 offen sc1
  buffer_store_dwordx4 v[220:223], v225, s[20:23], s38 offen sc1
  s_mov_b64 exec, s[40:41]
  v_mfma_f32_16x16x32_bf16 a[140:143], v[144:147], v[172:175], a[140:143]
  v_mfma_f32_16x16x32_bf16 a[144:147], v[144:147], v[176:179], a[144:147]
  ds_read_b128 v[88:91], v36 offset:12288
  v_mfma_f32_16x16x32_bf16 a[148:151], v[144:147], v[180:183], a[148:151]
  v_mfma_f32_16x16x32_bf16 a[152:155], v[144:147], v[184:187], a[152:155]
  ds_read_b64_tr_b16 v[120:121], v26 offset:0
  v_mfma_f32_16x16x32_bf16 a[156:159], v[144:147], v[188:191], a[156:159]
  buffer_load_dwordx4 v47, s[60:63], s56 offen offset:3072 lds
  v_mfma_f32_16x16x32_bf16 a[160:163], v[148:151], v[160:163], a[160:163]
  ds_read_b64_tr_b16 v[122:123], v26 offset:1024
  v_mfma_f32_16x16x32_bf16 a[164:167], v[148:151], v[164:167], a[164:167]
  v_mov_b32 v226, 0
  v_mov_b32 v227, 0
  v_mfma_f32_16x16x32_bf16 a[168:171], v[148:151], v[168:171], a[168:171]
  ds_read_b128 v[92:95], v36 offset:14336
  v_mov_b32 v228, 0
  v_mfma_f32_16x16x32_bf16 a[172:175], v[148:151], v[172:175], a[172:175]
  v_mov_b32 v229, 0
  v_mfma_f32_16x16x32_bf16 a[176:179], v[148:151], v[176:179], a[176:179]
  ds_read_b64_tr_b16 v[124:125], v27 offset:0
  s_add_u32 s56, s50, 2883584
  s_add_u32 m0, s51, 73728
  v_mfma_f32_16x16x32_bf16 a[180:183], v[148:151], v[180:183], a[180:183]
  buffer_load_dwordx4 v44, s[60:63], s56 offen offset:0 lds
  v_mfma_f32_16x16x32_bf16 a[184:187], v[148:151], v[184:187], a[184:187]
  ds_read_b64_tr_b16 v[126:127], v27 offset:1024
  s_lshl_b32 s38, s2, 11
  v_mfma_f32_16x16x32_bf16 a[188:191], v[148:151], v[188:191], a[188:191]
  s_lshl_b32 s39, s76, 10
  v_mfma_f32_16x16x32_bf16 a[192:195], v[152:155], v[160:163], a[192:195]
  s_add_u32 s38, s38, s39
  s_add_u32 s38, s38, 32768
  v_mfma_f32_16x16x32_bf16 a[196:199], v[152:155], v[164:167], a[196:199]
  buffer_load_dwordx4 v45, s[60:63], s56 offen offset:1024 lds
  v_mfma_f32_16x16x32_bf16 a[200:203], v[152:155], v[168:171], a[200:203]
  v_mfma_f32_16x16x32_bf16 a[204:207], v[152:155], v[172:175], a[204:207]
  v_mfma_f32_16x16x32_bf16 a[208:211], v[152:155], v[176:179], a[208:211]
  s_cmp_lt_u32 s2, 8
  s_cselect_b32 s22, 0x100000, 0
  buffer_store_dwordx4 v[226:229], v2, s[20:23], s38 offen sc1
  s_mov_b32 s22, 0x100000
  v_mfma_f32_16x16x32_bf16 a[212:215], v[152:155], v[180:183], a[212:215]
  v_mfma_f32_16x16x32_bf16 a[216:219], v[152:155], v[184:187], a[216:219]
  buffer_load_dwordx4 v46, s[60:63], s56 offen offset:2048 lds
  v_mfma_f32_16x16x32_bf16 a[220:223], v[152:155], v[188:191], a[220:223]
  s_lshl_b32 s38, s2, 7
  v_mfma_f32_16x16x32_bf16 a[224:227], v[156:159], v[160:163], a[224:227]
  s_lshl_b32 s39, s76, 4
  s_add_u32 s38, s38, s39
  v_mfma_f32_16x16x32_bf16 a[228:231], v[156:159], v[164:167], a[228:231]
  s_add_u32 s38, s38, 131072
  v_mfma_f32_16x16x32_bf16 a[232:235], v[156:159], v[168:171], a[232:235]
  v_mov_b32 v224, 0
  v_mfma_f32_16x16x32_bf16 a[236:239], v[156:159], v[172:175], a[236:239]
  v_mfma_f32_16x16x32_bf16 a[240:243], v[156:159], v[176:179], a[240:243]
  buffer_load_dwordx4 v47, s[60:63], s56 offen offset:3072 lds
  v_mfma_f32_16x16x32_bf16 a[244:247], v[156:159], v[180:183], a[244:247]
  v_cmp_eq_u32 vcc, 0, v1
  s_and_saveexec_b64 s[40:41], vcc
  buffer_store_dwordx4 v[226:229], v224, s[20:23], s38 offen sc1
  s_mov_b64 exec, s[40:41]
  v_mfma_f32_16x16x32_bf16 a[248:251], v[156:159], v[184:187], a[248:251]
  v_mfma_f32_16x16x32_bf16 a[252:255], v[156:159], v[188:191], a[252:255]
  s_waitcnt lgkmcnt(0)
  v_mfma_f32_16x16x32_bf16 a[0:3], v[64:67], v[96:99], a[0:3]
  ds_read_b128 v[128:131], v37 offset:0
  s_add_u32 s56, s50, 3014656
  s_add_u32 m0, s51, 77824
  v_mfma_f32_16x16x32_bf16 a[4:7], v[64:67], v[100:103], a[4:7]
  buffer_load_dwordx4 v44, s[60:63], s56 offen offset:0 lds
  v_mfma_f32_16x16x32_bf16 a[8:11], v[64:67], v[104:107], a[8:11]
  ds_read_b64_tr_b16 v[160:161], v20 offset:8192
  v_mfma_f32_16x16x32_bf16 a[12:15], v[64:67], v[108:111], a[12:15]
  v_lshrrev_b32 v230, 5, v1
  v_mfma_f32_16x16x32_bf16 a[16:19], v[64:67], v[112:115], a[16:19]
  ds_read_b64_tr_b16 v[162:163], v20 offset:9216
  v_mfma_f32_16x16x32_bf16 a[20:23], v[64:67], v[116:119], a[20:23]
  v_mfma_f32_16x16x32_bf16 a[24:27], v[64:67], v[120:123], a[24:27]
  ds_read_b128 v[132:135], v37 offset:2048
  v_lshlrev_b32 v230, 2, v230
  v_mfma_f32_16x16x32_bf16 a[28:31], v[64:67], v[124:127], a[28:31]
  buffer_load_dwordx4 v45, s[60:63], s56 offen offset:1024 lds
  v_mfma_f32_16x16x32_bf16 a[32:35], v[68:71], v[96:99], a[32:35]
  ds_read_b64_tr_b16 v[164:165], v21 offset:8192
  v_mfma_f32_16x16x32_bf16 a[36:39], v[68:71], v[100:103], a[36:39]
  v_mfma_f32_16x16x32_bf16 a[40:43], v[68:71], v[104:107], a[40:43]
  ds_read_b64_tr_b16 v[166:167], v21 offset:9216
  v_bfe_u32 v231, v1, 2, 2
  v_mfma_f32_16x16x32_bf16 a[44:47], v[68:71], v[108:111], a[44:47]
  v_mfma_f32_16x16x32_bf16 a[48:51], v[68:71], v[112:115], a[48:51]
  ds_read_b128 v[136:139], v37 offset:4096
  v_mfma_f32_16x16x32_bf16 a[52:55], v[68:71], v[116:119], a[52:55]
  buffer_load_dwordx4 v46, s[60:63], s56 offen offset:2048 lds
  v_mfma_f32_16x16x32_bf16 a[56:59], v[68:71], v[120:123], a[56:59]
  ds_read_b64_tr_b16 v[168:169], v22 offset:8192
  v_mfma_f32_16x16x32_bf16 a[60:63], v[68:71], v[124:127], a[60:63]
  v_add_u32 v230, v230, v231
  v_mfma_f32_16x16x32_bf16 a[64:67], v[72:75], v[96:99], a[64:67]
  ds_read_b64_tr_b16 v[170:171], v22 offset:9216
  v_mfma_f32_16x16x32_bf16 a[68:71], v[72:75], v[100:103], a[68:71]
  buffer_load_dwordx4 v47, s[60:63], s56 offen offset:3072 lds
  v_mfma_f32_16x16x32_bf16 a[72:75], v[72:75], v[104:107], a[72:75]
  ds_read_b128 v[140:143], v37 offset:6144
  v_mfma_f32_16x16x32_bf16 a[76:79], v[72:75], v[108:111], a[76:79]
  v_lshlrev_b32 v230, 10, v230
  v_mfma_f32_16x16x32_bf16 a[80:83], v[72:75], v[112:115], a[80:83]
  ds_read_b64_tr_b16 v[172:173], v23 offset:8192
  v_mfma_f32_16x16x32_bf16 a[84:87], v[72:75], v[116:119], a[84:87]
  v_bfe_u32 v231, v1, 4, 1
  v_mfma_f32_16x16x32_bf16 a[88:91], v[72:75], v[120:123], a[88:91]
  ds_read_b64_tr_b16 v[174:175], v23 offset:9216
  v_mfma_f32_16x16x32_bf16 a[92:95], v[72:75], v[124:127], a[92:95]
  v_mfma_f32_16x16x32_bf16 a[96:99], v[76:79], v[96:99], a[96:99]
  ds_read_b128 v[144:147], v37 offset:8192
  v_lshl_add_u32 v230, v231, 5, v230
  v_mfma_f32_16x16x32_bf16 a[100:103], v[76:79], v[100:103], a[100:103]
  v_mfma_f32_16x16x32_bf16 a[104:107], v[76:79], v[104:107], a[104:107]
  ds_read_b64_tr_b16 v[176:177], v24 offset:8192
  v_mfma_f32_16x16x32_bf16 a[108:111], v[76:79], v[108:111], a[108:111]
  v_and_b32 v231, 3, v1
  v_mfma_f32_16x16x32_bf16 a[112:115], v[76:79], v[112:115], a[112:115]
  ds_read_b64_tr_b16 v[178:179], v24 offset:9216
  v_mfma_f32_16x16x32_bf16 a[116:119], v[76:79], v[116:119], a[116:119]
  v_mfma_f32_16x16x32_bf16 a[120:123], v[76:79], v[120:123], a[120:123]
  ds_read_b128 v[148:151], v37 offset:10240
  v_lshl_add_u32 v230, v231, 3, v230
  v_mfma_f32_16x16x32_bf16 a[124:127], v[76:79], v[124:127], a[124:127]
  v_mfma_f32_16x16x32_bf16 a[128:131], v[80:83], v[96:99], a[128:131]
  ds_read_b64_tr_b16 v[180:181], v25 offset:8192
  v_mfma_f32_16x16x32_bf16 a[132:135], v[80:83], v[100:103], a[132:135]
  s_lshl_b32 s38, s76, 9
  v_mfma_f32_16x16x32_bf16 a[136:139], v[80:83], v[104:107], a[136:139]
  ds_read_b64_tr_b16 v[182:183], v25 offset:9216
  v_mfma_f32_16x16x32_bf16 a[140:143], v[80:83], v[108:111], a[140:143]
  s_add_u32 s38, s38, 0x20000
  v_mfma_f32_16x16x32_bf16 a[144:147], v[80:83], v[112:115], a[144:147]
  ds_read_b128 v[152:155], v37 offset:12288
  v_mfma_f32_16x16x32_bf16 a[148:151], v[80:83], v[116:119], a[148:151]
  v_mfma_f32_16x16x32_bf16 a[152:155], v[80:83], v[120:123], a[152:155]
  ds_read_b64_tr_b16 v[184:185], v26 offset:8192
  v_add_u32 v230, s38, v230
  v_mfma_f32_16x16x32_bf16 a[156:159], v[80:83], v[124:127], a[156:159]
  v_mfma_f32_16x16x32_bf16 a[160:163], v[84:87], v[96:99], a[160:163]
  ds_read_b64_tr_b16 v[186:187], v26 offset:9216
  v_mfma_f32_16x16x32_bf16 a[164:167], v[84:87], v[100:103], a[164:167]
  v_mfma_f32_16x16x32_bf16 a[168:171], v[84:87], v[104:107], a[168:171]
  ds_read_b128 v[156:159], v37 offset:14336
  v_mfma_f32_16x16x32_bf16 a[172:175], v[84:87], v[108:111], a[172:175]
  v_mfma_f32_16x16x32_bf16 a[176:179], v[84:87], v[112:115], a[176:179]
  ds_read_b64_tr_b16 v[188:189], v27 offset:8192
  v_mfma_f32_16x16x32_bf16 a[180:183], v[84:87], v[116:119], a[180:183]
  v_mfma_f32_16x16x32_bf16 a[184:187], v[84:87], v[120:123], a[184:187]
  ds_read_b64_tr_b16 v[190:191], v27 offset:9216
  ds_read_b64_tr_b16 v[192:193], v230 offset:0
  v_mfma_f32_16x16x32_bf16 a[188:191], v[84:87], v[124:127], a[188:191]
  ds_read_b64_tr_b16 v[194:195], v230 offset:8192
  v_mfma_f32_16x16x32_bf16 a[192:195], v[88:91], v[96:99], a[192:195]
  s_mul_i32 s56, s58, 7
  ds_read_b64_tr_b16 v[196:197], v230 offset:64
  v_mfma_f32_16x16x32_bf16 a[196:199], v[88:91], v[100:103], a[196:199]
  buffer_load_dword v15, v18, s[64:67], s56 offen
  ds_read_b64_tr_b16 v[198:199], v230 offset:8256
  v_mfma_f32_16x16x32_bf16 a[200:203], v[88:91], v[104:107], a[200:203]
  ds_read_b64_tr_b16 v[200:201], v230 offset:128
  v_mfma_f32_16x16x32_bf16 a[204:207], v[88:91], v[108:111], a[204:207]
  ds_read_b64_tr_b16 v[202:203], v230 offset:8320
  v_mfma_f32_16x16x32_bf16 a[208:211], v[88:91], v[112:115], a[208:211]
  ds_read_b64_tr_b16 v[204:205], v230 offset:192
  v_mfma_f32_16x16x32_bf16 a[212:215], v[88:91], v[116:119], a[212:215]
  ds_read_b64_tr_b16 v[206:207], v230 offset:8384
  v_mfma_f32_16x16x32_bf16 a[216:219], v[88:91], v[120:123], a[216:219]
  s_add_u32 s56, s59, 4
  s_min_u32 s56, s56, 7
  s_mul_i32 s56, s56, s37
  ds_read_b64_tr_b16 v[208:209], v230 offset:256
  v_mfma_f32_16x16x32_bf16 a[220:223], v[88:91], v[124:127], a[220:223]
  buffer_load_dword v15, v19, s[72:75], s56 offen
  ds_read_b64_tr_b16 v[210:211], v230 offset:8448
  v_mfma_f32_16x16x32_bf16 a[224:227], v[92:95], v[96:99], a[224:227]
  ds_read_b64_tr_b16 v[212:213], v230 offset:320
  v_mfma_f32_16x16x32_bf16 a[228:231], v[92:95], v[100:103], a[228:231]
  ds_read_b64_tr_b16 v[214:215], v230 offset:8512
  v_mfma_f32_16x16x32_bf16 a[232:235], v[92:95], v[104:107], a[232:235]
  ds_read_b64_tr_b16 v[216:217], v230 offset:384
  v_mfma_f32_16x16x32_bf16 a[236:239], v[92:95], v[108:111], a[236:239]
  ds_read_b64_tr_b16 v[218:219], v230 offset:8576
  v_mfma_f32_16x16x32_bf16 a[240:243], v[92:95], v[112:115], a[240:243]
  ds_read_b64_tr_b16 v[220:221], v230 offset:448
  v_mfma_f32_16x16x32_bf16 a[244:247], v[92:95], v[116:119], a[244:247]
  ds_read_b64_tr_b16 v[222:223], v230 offset:8640
  v_mfma_f32_16x16x32_bf16 a[248:251], v[92:95], v[120:123], a[248:251]
  v_mfma_f32_16x16x32_bf16 a[252:255], v[92:95], v[124:127], a[252:255]
  s_waitcnt vmcnt(2) lgkmcnt(0)
  s_barrier
  v_mfma_f32_16x16x32_bf16 a[0:3], v[128:131], v[160:163], a[0:3]
  ds_read_b128 v[64:67], v38 offset:0
  s_add_u32 s56, s50, 3145728
  s_add_u32 m0, s51, 0
  v_mfma_f32_16x16x32_bf16 a[4:7], v[128:131], v[164:167], a[4:7]
  buffer_load_dwordx4 v44, s[60:63], s56 offen offset:0 lds
  v_mfma_f32_16x16x32_bf16 a[8:11], v[128:131], v[168:171], a[8:11]
  ds_read_b64_tr_b16 v[96:97], v28 offset:0
  v_mfma_f32_16x16x32_bf16 a[12:15], v[128:131], v[172:175], a[12:15]
  s_add_u32 s24, s46, 0x4000000
  v_mfma_f32_16x16x32_bf16 a[16:19], v[128:131], v[176:179], a[16:19]
  ds_read_b64_tr_b16 v[98:99], v28 offset:1024
  v_mfma_f32_16x16x32_bf16 a[20:23], v[128:131], v[180:183], a[20:23]
  s_addc_u32 s25, s47, 0
  v_mfma_f32_16x16x32_bf16 a[24:27], v[128:131], v[184:187], a[24:27]
  ds_read_b128 v[68:71], v38 offset:2048
  v_mfma_f32_16x16x32_bf16 a[28:31], v[128:131], v[188:191], a[28:31]
  buffer_load_dwordx4 v45, s[60:63], s56 offen offset:1024 lds
  v_mfma_f32_16x16x32_bf16 a[32:35], v[132:135], v[160:163], a[32:35]
  ds_read_b64_tr_b16 v[100:101], v29 offset:0
  v_mfma_f32_16x16x32_bf16 a[36:39], v[132:135], v[164:167], a[36:39]
  s_mov_b32 s26, 0x400000
  v_mfma_f32_16x16x32_bf16 a[40:43], v[132:135], v[168:171], a[40:43]
  ds_read_b64_tr_b16 v[102:103], v29 offset:1024
  v_mfma_f32_16x16x32_bf16 a[44:47], v[132:135], v[172:175], a[44:47]
  buffer_load_dwordx4 v46, s[60:63], s56 offen offset:2048 lds
  v_mfma_f32_16x16x32_bf16 a[48:51], v[132:135], v[176:179], a[48:51]
  ds_read_b128 v[72:75], v38 offset:4096
  v_mfma_f32_16x16x32_bf16 a[52:55], v[132:135], v[180:183], a[52:55]
  s_lshl_b32 s38, s76, 21
  v_mfma_f32_16x16x32_bf16 a[56:59], v[132:135], v[184:187], a[56:59]
  ds_read_b64_tr_b16 v[104:105], v30 offset:0
  v_mfma_f32_16x16x32_bf16 a[60:63], v[132:135], v[188:191], a[60:63]
  s_lshl_b32 s39, s2, 10
  v_mfma_f32_16x16x32_bf16 a[64:67], v[136:139], v[160:163], a[64:67]
  ds_read_b64_tr_b16 v[106:107], v30 offset:1024
  v_mfma_f32_16x16x32_bf16 a[68:71], v[136:139], v[164:167], a[68:71]
  buffer_load_dwordx4 v47, s[60:63], s56 offen offset:3072 lds
  v_mfma_f32_16x16x32_bf16 a[72:75], v[136:139], v[168:171], a[72:75]
  ds_read_b128 v[76:79], v38 offset:6144
  s_add_u32 s38, s38, s39
  v_mfma_f32_16x16x32_bf16 a[76:79], v[136:139], v[172:175], a[76:79]
  v_mfma_f32_16x16x32_bf16 a[80:83], v[136:139], v[176:179], a[80:83]
  ds_read_b64_tr_b16 v[108:109], v31 offset:0
  v_mfma_f32_16x16x32_bf16 a[84:87], v[136:139], v[180:183], a[84:87]
  v_mfma_f32_16x16x32_bf16 a[88:91], v[136:139], v[184:187], a[88:91]
  ds_read_b64_tr_b16 v[110:111], v31 offset:1024
  s_add_u32 s56, s50, 3276800
  s_add_u32 m0, s51, 4096
  v_mfma_f32_16x16x32_bf16 a[92:95], v[136:139], v[188:191], a[92:95]
  buffer_load_dwordx4 v44, s[60:63], s56 offen offset:0 lds
  v_mfma_f32_16x16x32_bf16 a[96:99], v[140:143], v[160:163], a[96:99]
  ds_read_b128 v[80:83], v38 offset:8192
  v_mfma_f32_16x16x32_bf16 a[100:103], v[140:143], v[164:167], a[100:103]
  buffer_store_dwordx4 v[192:195], v2, s[24:27], s38 offen sc1
  v_mfma_f32_16x16x32_bf16 a[104:107], v[140:143], v[168:171], a[104:107]
  ds_read_b64_tr_b16 v[112:113], v32 offset:0
  v_mfma_f32_16x16x32_bf16 a[108:111], v[140:143], v[172:175], a[108:111]
  buffer_load_dwordx4 v45, s[60:63], s56 offen offset:1024 lds
  v_mfma_f32_16x16x32_bf16 a[112:115], v[140:143], v[176:179], a[112:115]
  ds_read_b64_tr_b16 v[114:115], v32 offset:1024
  v_mfma_f32_16x16x32_bf16 a[116:119], v[140:143], v[180:183], a[116:119]
  v_mfma_f32_16x16x32_bf16 a[120:123], v[140:143], v[184:187], a[120:123]
  ds_read_b128 v[84:87], v38 offset:10240
  v_mfma_f32_16x16x32_bf16 a[124:127], v[140:143], v[188:191], a[124:127]
  s_add_u32 s38, s38, 262144
  v_mfma_f32_16x16x32_bf16 a[128:131], v[144:147], v[160:163], a[128:131]
  ds_read_b64_tr_b16 v[116:117], v33 offset:0
  v_mfma_f32_16x16x32_bf16 a[132:135], v[144:147], v[164:167], a[132:135]
  buffer_load_dwordx4 v46, s[60:63], s56 offen offset:2048 lds
  v_mfma_f32_16x16x32_bf16 a[136:139], v[144:147], v[168:171], a[136:139]
  ds_read_b64_tr_b16 v[118:119], v33 offset:1024
  v_mfma_f32_16x16x32_bf16 a[140:143], v[144:147], v[172:175], a[140:143]
  v_mfma_f32_16x16x32_bf16 a[144:147], v[144:147], v[176:179], a[144:147]
  ds_read_b128 v[88:91], v38 offset:12288
  v_mfma_f32_16x16x32_bf16 a[148:151], v[144:147], v[180:183], a[148:151]
  buffer_store_dwordx4 v[196:199], v2, s[24:27], s38 offen sc1
  v_mfma_f32_16x16x32_bf16 a[152:155], v[144:147], v[184:187], a[152:155]
  ds_read_b64_tr_b16 v[120:121], v34 offset:0
  v_mfma_f32_16x16x32_bf16 a[156:159], v[144:147], v[188:191], a[156:159]
  buffer_load_dwordx4 v47, s[60:63], s56 offen offset:3072 lds
  v_mfma_f32_16x16x32_bf16 a[160:163], v[148:151], v[160:163], a[160:163]
  ds_read_b64_tr_b16 v[122:123], v34 offset:1024
  v_mfma_f32_16x16x32_bf16 a[164:167], v[148:151], v[164:167], a[164:167]
  v_mfma_f32_16x16x32_bf16 a[168:171], v[148:151], v[168:171], a[168:171]
  ds_read_b128 v[92:95], v38 offset:14336
  s_add_u32 s38, s38, 262144
  v_mfma_f32_16x16x32_bf16 a[172:175], v[148:151], v[172:175], a[172:175]
  v_mfma_f32_16x16x32_bf16 a[176:179], v[148:151], v[176:179], a[176:179]
  ds_read_b64_tr_b16 v[124:125], v35 offset:0
  s_add_u32 s56, s50, 3407872
  s_add_u32 m0, s51, 8192
  v_mfma_f32_16x16x32_bf16 a[180:183], v[148:151], v[180:183], a[180:183]
  buffer_load_dwordx4 v44, s[60:63], s56 offen offset:0 lds
  v_mfma_f32_16x16x32_bf16 a[184:187], v[148:151], v[184:187], a[184:187]
  ds_read_b64_tr_b16 v[126:127], v35 offset:1024
  v_mfma_f32_16x16x32_bf16 a[188:191], v[148:151], v[188:191], a[188:191]
  v_mfma_f32_16x16x32_bf16 a[192:195], v[152:155], v[160:163], a[192:195]
  buffer_store_dwordx4 v[200:203], v2, s[24:27], s38 offen sc1
  v_mfma_f32_16x16x32_bf16 a[196:199], v[152:155], v[164:167], a[196:199]
  buffer_load_dwordx4 v45, s[60:63], s56 offen offset:1024 lds
  v_mfma_f32_16x16x32_bf16 a[200:203], v[152:155], v[168:171], a[200:203]
  v_mfma_f32_16x16x32_bf16 a[204:207], v[152:155], v[172:175], a[204:207]
  v_mfma_f32_16x16x32_bf16 a[208:211], v[152:155], v[176:179], a[208:211]
  s_add_u32 s38, s38, 262144
  v_mfma_f32_16x16x32_bf16 a[212:215], v[152:155], v[180:183], a[212:215]
  v_mfma_f32_16x16x32_bf16 a[216:219], v[152:155], v[184:187], a[216:219]
  buffer_load_dwordx4 v46, s[60:63], s56 offen offset:2048 lds
  v_mfma_f32_16x16x32_bf16 a[220:223], v[152:155], v[188:191], a[220:223]
  v_mfma_f32_16x16x32_bf16 a[224:227], v[156:159], v[160:163], a[224:227]
  v_mfma_f32_16x16x32_bf16 a[228:231], v[156:159], v[164:167], a[228:231]
  buffer_store_dwordx4 v[204:207], v2, s[24:27], s38 offen sc1
  v_mfma_f32_16x16x32_bf16 a[232:235], v[156:159], v[168:171], a[232:235]
  v_mfma_f32_16x16x32_bf16 a[236:239], v[156:159], v[172:175], a[236:239]
  v_mfma_f32_16x16x32_bf16 a[240:243], v[156:159], v[176:179], a[240:243]
  buffer_load_dwordx4 v47, s[60:63], s56 offen offset:3072 lds
  v_mfma_f32_16x16x32_bf16 a[244:247], v[156:159], v[180:183], a[244:247]
  s_add_u32 s38, s38, 262144
  v_mfma_f32_16x16x32_bf16 a[248:251], v[156:159], v[184:187], a[248:251]
  v_mfma_f32_16x16x32_bf16 a[252:255], v[156:159], v[188:191], a[252:255]
  s_waitcnt lgkmcnt(0)
  v_mfma_f32_16x16x32_bf16 a[0:3], v[64:67], v[96:99], a[0:3]
  ds_read_b128 v[128:131], v39 offset:0
  s_add_u32 s56, s50, 3538944
  s_add_u32 m0, s51, 12288
  v_mfma_f32_16x16x32_bf16 a[4:7], v[64:67], v[100:103], a[4:7]
  buffer_load_dwordx4 v44, s[60:63], s56 offen offset:0 lds
  v_mfma_f32_16x16x32_bf16 a[8:11], v[64:67], v[104:107], a[8:11]
  ds_read_b64_tr_b16 v[160:161], v28 offset:8192
  v_mfma_f32_16x16x32_bf16 a[12:15], v[64:67], v[108:111], a[12:15]
  buffer_store_dwordx4 v[208:211], v2, s[24:27], s38 offen sc1
  v_mfma_f32_16x16x32_bf16 a[16:19], v[64:67], v[112:115], a[16:19]
  ds_read_b64_tr_b16 v[162:163], v28 offset:9216
  v_mfma_f32_16x16x32_bf16 a[20:23], v[64:67], v[116:119], a[20:23]
  v_mfma_f32_16x16x32_bf16 a[24:27], v[64:67], v[120:123], a[24:27]
  ds_read_b128 v[132:135], v39 offset:2048
  v_mfma_f32_16x16x32_bf16 a[28:31], v[64:67], v[124:127], a[28:31]
  buffer_load_dwordx4 v45, s[60:63], s56 offen offset:1024 lds
  v_mfma_f32_16x16x32_bf16 a[32:35], v[68:71], v[96:99], a[32:35]
  ds_read_b64_tr_b16 v[164:165], v29 offset:8192
  v_mfma_f32_16x16x32_bf16 a[36:39], v[68:71], v[100:103], a[36:39]
  s_add_u32 s38, s38, 262144
  v_mfma_f32_16x16x32_bf16 a[40:43], v[68:71], v[104:107], a[40:43]
  ds_read_b64_tr_b16 v[166:167], v29 offset:9216
  v_mfma_f32_16x16x32_bf16 a[44:47], v[68:71], v[108:111], a[44:47]
  v_mfma_f32_16x16x32_bf16 a[48:51], v[68:71], v[112:115], a[48:51]
  ds_read_b128 v[136:139], v39 offset:4096
  v_mfma_f32_16x16x32_bf16 a[52:55], v[68:71], v[116:119], a[52:55]
  buffer_load_dwordx4 v46, s[60:63], s56 offen offset:2048 lds
  v_mfma_f32_16x16x32_bf16 a[56:59], v[68:71], v[120:123], a[56:59]
  ds_read_b64_tr_b16 v[168:169], v30 offset:8192
  v_mfma_f32_16x16x32_bf16 a[60:63], v[68:71], v[124:127], a[60:63]
  buffer_store_dwordx4 v[212:215], v2, s[24:27], s38 offen sc1
  v_mfma_f32_16x16x32_bf16 a[64:67], v[72:75], v[96:99], a[64:67]
  ds_read_b64_tr_b16 v[170:171], v30 offset:9216
  v_mfma_f32_16x16x32_bf16 a[68:71], v[72:75], v[100:103], a[68:71]
  buffer_load_dwordx4 v47, s[60:63], s56 offen offset:3072 lds
  v_mfma_f32_16x16x32_bf16 a[72:75], v[72:75], v[104:107], a[72:75]
  ds_read_b128 v[140:143], v39 offset:6144
  v_mfma_f32_16x16x32_bf16 a[76:79], v[72:75], v[108:111], a[76:79]
  v_mfma_f32_16x16x32_bf16 a[80:83], v[72:75], v[112:115], a[80:83]
  ds_read_b64_tr_b16 v[172:173], v31 offset:8192
  v_mfma_f32_16x16x32_bf16 a[84:87], v[72:75], v[116:119], a[84:87]
  s_add_u32 s38, s38, 262144
  v_mfma_f32_16x16x32_bf16 a[88:91], v[72:75], v[120:123], a[88:91]
  ds_read_b64_tr_b16 v[174:175], v31 offset:9216
  v_mfma_f32_16x16x32_bf16 a[92:95], v[72:75], v[124:127], a[92:95]
  v_mfma_f32_16x16x32_bf16 a[96:99], v[76:79], v[96:99], a[96:99]
  ds_read_b128 v[144:147], v39 offset:8192
  v_mfma_f32_16x16x32_bf16 a[100:103], v[76:79], v[100:103], a[100:103]
  buffer_store_dwordx4 v[216:219], v2, s[24:27], s38 offen sc1
  v_mfma_f32_16x16x32_bf16 a[104:107], v[76:79], v[104:107], a[104:107]
  ds_read_b64_tr_b16 v[176:177], v32 offset:8192
  v_mfma_f32_16x16x32_bf16 a[108:111], v[76:79], v[108:111], a[108:111]
  v_mfma_f32_16x16x32_bf16 a[112:115], v[76:79], v[112:115], a[112:115]
  ds_read_b64_tr_b16 v[178:179], v32 offset:9216
  v_mfma_f32_16x16x32_bf16 a[116:119], v[76:79], v[116:119], a[116:119]
  s_add_u32 s38, s38, 262144
  v_mfma_f32_16x16x32_bf16 a[120:123], v[76:79], v[120:123], a[120:123]
  ds_read_b128 v[148:151], v39 offset:10240
  v_mfma_f32_16x16x32_bf16 a[124:127], v[76:79], v[124:127], a[124:127]
  v_mfma_f32_16x16x32_bf16 a[128:131], v[80:83], v[96:99], a[128:131]
  ds_read_b64_tr_b16 v[180:181], v33 offset:8192
  v_mfma_f32_16x16x32_bf16 a[132:135], v[80:83], v[100:103], a[132:135]
  v_mfma_f32_16x16x32_bf16 a[136:139], v[80:83], v[104:107], a[136:139]
  ds_read_b64_tr_b16 v[182:183], v33 offset:9216
  buffer_store_dwordx4 v[220:223], v2, s[24:27], s38 offen sc1
  v_mfma_f32_16x16x32_bf16 a[140:143], v[80:83], v[108:111], a[140:143]
  v_mfma_f32_16x16x32_bf16 a[144:147], v[80:83], v[112:115], a[144:147]
  ds_read_b128 v[152:155], v39 offset:12288
  v_mfma_f32_16x16x32_bf16 a[148:151], v[80:83], v[116:119], a[148:151]
  v_mfma_f32_16x16x32_bf16 a[152:155], v[80:83], v[120:123], a[152:155]
  ds_read_b64_tr_b16 v[184:185], v34 offset:8192
  v_mfma_f32_16x16x32_bf16 a[156:159], v[80:83], v[124:127], a[156:159]
  s_add_u32 s38, s38, 262144
  v_mfma_f32_16x16x32_bf16 a[160:163], v[84:87], v[96:99], a[160:163]
  ds_read_b64_tr_b16 v[186:187], v34 offset:9216
  v_mfma_f32_16x16x32_bf16 a[164:167], v[84:87], v[100:103], a[164:167]
  v_mfma_f32_16x16x32_bf16 a[168:171], v[84:87], v[104:107], a[168:171]
  ds_read_b128 v[156:159], v39 offset:14336
  v_mfma_f32_16x16x32_bf16 a[172:175], v[84:87], v[108:111], a[172:175]
  v_mfma_f32_16x16x32_bf16 a[176:179], v[84:87], v[112:115], a[176:179]
  ds_read_b64_tr_b16 v[188:189], v35 offset:8192
  v_mfma_f32_16x16x32_bf16 a[180:183], v[84:87], v[116:119], a[180:183]
  v_mfma_f32_16x16x32_bf16 a[184:187], v[84:87], v[120:123], a[184:187]
  ds_read_b64_tr_b16 v[190:191], v35 offset:9216
  v_mfma_f32_16x16x32_bf16 a[188:191], v[84:87], v[124:127], a[188:191]
  v_mfma_f32_16x16x32_bf16 a[192:195], v[88:91], v[96:99], a[192:195]
  s_mul_i32 s56, s58, 7
  v_mfma_f32_16x16x32_bf16 a[196:199], v[88:91], v[100:103], a[196:199]
  buffer_load_dword v15, v18, s[64:67], s56 offen
  v_mfma_f32_16x16x32_bf16 a[200:203], v[88:91], v[104:107], a[200:203]
  v_mfma_f32_16x16x32_bf16 a[204:207], v[88:91], v[108:111], a[204:207]
  v_mfma_f32_16x16x32_bf16 a[208:211], v[88:91], v[112:115], a[208:211]
  v_mfma_f32_16x16x32_bf16 a[212:215], v[88:91], v[116:119], a[212:215]
  v_mfma_f32_16x16x32_bf16 a[216:219], v[88:91], v[120:123], a[216:219]
  s_add_u32 s56, s59, 5
  s_min_u32 s56, s56, 7
  s_mul_i32 s56, s56, s37
  v_mfma_f32_16x16x32_bf16 a[220:223], v[88:91], v[124:127], a[220:223]
  buffer_load_dword v15, v19, s[72:75], s56 offen
  v_mfma_f32_16x16x32_bf16 a[224:227], v[92:95], v[96:99], a[224:227]
  v_mfma_f32_16x16x32_bf16 a[228:231], v[92:95], v[100:103], a[228:231]
  v_mfma_f32_16x16x32_bf16 a[232:235], v[92:95], v[104:107], a[232:235]
  v_mfma_f32_16x16x32_bf16 a[236:239], v[92:95], v[108:111], a[236:239]
  v_mfma_f32_16x16x32_bf16 a[240:243], v[92:95], v[112:115], a[240:243]
  v_mfma_f32_16x16x32_bf16 a[244:247], v[92:95], v[116:119], a[244:247]
  v_mfma_f32_16x16x32_bf16 a[248:251], v[92:95], v[120:123], a[248:251]
  v_mfma_f32_16x16x32_bf16 a[252:255], v[92:95], v[124:127], a[252:255]
  s_waitcnt vmcnt(4) lgkmcnt(0)
  s_barrier
  v_mfma_f32_16x16x32_bf16 a[0:3], v[128:131], v[160:163], a[0:3]
  ds_read_b128 v[64:67], v36 offset:0
  s_add_u32 s56, s50, 3670016
  s_add_u32 m0, s51, 65536
  v_mfma_f32_16x16x32_bf16 a[4:7], v[128:131], v[164:167], a[4:7]
  buffer_load_dwordx4 v44, s[60:63], s56 offen offset:0 lds
  v_mfma_f32_16x16x32_bf16 a[8:11], v[128:131], v[168:171], a[8:11]
  ds_read_b64_tr_b16 v[96:97], v20 offset:0
  v_mfma_f32_16x16x32_bf16 a[12:15], v[128:131], v[172:175], a[12:15]
  v_mfma_f32_16x16x32_bf16 a[16:19], v[128:131], v[176:179], a[16:19]
  ds_read_b64_tr_b16 v[98:99], v20 offset:1024
  v_mfma_f32_16x16x32_bf16 a[20:23], v[128:131], v[180:183], a[20:23]
  v_mfma_f32_16x16x32_bf16 a[24:27], v[128:131], v[184:187], a[24:27]
  ds_read_b128 v[68:71], v36 offset:2048
  v_mfma_f32_16x16x32_bf16 a[28:31], v[128:131], v[188:191], a[28:31]
  buffer_load_dwordx4 v45, s[60:63], s56 offen offset:1024 lds
  v_mfma_f32_16x16x32_bf16 a[32:35], v[132:135], v[160:163], a[32:35]
  ds_read_b64_tr_b16 v[100:101], v21 offset:0
  v_mfma_f32_16x16x32_bf16 a[36:39], v[132:135], v[164:167], a[36:39]
  v_mfma_f32_16x16x32_bf16 a[40:43], v[132:135], v[168:171], a[40:43]
  ds_read_b64_tr_b16 v[102:103], v21 offset:1024
  v_mfma_f32_16x16x32_bf16 a[44:47], v[132:135], v[172:175], a[44:47]
  buffer_load_dwordx4 v46, s[60:63], s56 offen offset:2048 lds
  v_mfma_f32_16x16x32_bf16 a[48:51], v[132:135], v[176:179], a[48:51]
  ds_read_b128 v[72:75], v36 offset:4096
  v_mfma_f32_16x16x32_bf16 a[52:55], v[132:135], v[180:183], a[52:55]
  v_mfma_f32_16x16x32_bf16 a[56:59], v[132:135], v[184:187], a[56:59]
  ds_read_b64_tr_b16 v[104:105], v22 offset:0
  v_mfma_f32_16x16x32_bf16 a[60:63], v[132:135], v[188:191], a[60:63]
  v_mfma_f32_16x16x32_bf16 a[64:67], v[136:139], v[160:163], a[64:67]
  ds_read_b64_tr_b16 v[106:107], v22 offset:1024
  v_mfma_f32_16x16x32_bf16 a[68:71], v[136:139], v[164:167], a[68:71]
  buffer_load_dwordx4 v47, s[60:63], s56 offen offset:3072 lds
  v_mfma_f32_16x16x32_bf16 a[72:75], v[136:139], v[168:171], a[72:75]
  ds_read_b128 v[76:79], v36 offset:6144
  v_mfma_f32_16x16x32_bf16 a[76:79], v[136:139], v[172:175], a[76:79]
  v_mfma_f32_16x16x32_bf16 a[80:83], v[136:139], v[176:179], a[80:83]
  ds_read_b64_tr_b16 v[108:109], v23 offset:0
  v_mfma_f32_16x16x32_bf16 a[84:87], v[136:139], v[180:183], a[84:87]
  v_mfma_f32_16x16x32_bf16 a[88:91], v[136:139], v[184:187], a[88:91]
  ds_read_b64_tr_b16 v[110:111], v23 offset:1024
  s_add_u32 s56, s50, 3801088
  s_add_u32 m0, s51, 69632
  v_mfma_f32_16x16x32_bf16 a[92:95], v[136:139], v[188:191], a[92:95]
  buffer_load_dwordx4 v44, s[60:63], s56 offen offset:0 lds
  v_mfma_f32_16x16x32_bf16 a[96:99], v[140:143], v[160:163], a[96:99]
  ds_read_b128 v[80:83], v36 offset:8192
  v_mfma_f32_16x16x32_bf16 a[100:103], v[140:143], v[164:167], a[100:103]
  v_mfma_f32_16x16x32_bf16 a[104:107], v[140:143], v[168:171], a[104:107]
  ds_read_b64_tr_b16 v[112:113], v24 offset:0
  v_mfma_f32_16x16x32_bf16 a[108:111], v[140:143], v[172:175], a[108:111]
  buffer_load_dwordx4 v45, s[60:63], s56 offen offset:1024 lds
  v_mfma_f32_16x16x32_bf16 a[112:115], v[140:143], v[176:179], a[112:115]
  ds_read_b64_tr_b16 v[114:115], v24 offset:1024
  v_mfma_f32_16x16x32_bf16 a[116:119], v[140:143], v[180:183], a[116:119]
  v_mfma_f32_16x16x32_bf16 a[120:123], v[140:143], v[184:187], a[120:123]
  ds_read_b128 v[84:87], v36 offset:10240
  v_mfma_f32_16x16x32_bf16 a[124:127], v[140:143], v[188:191], a[124:127]
  v_mfma_f32_16x16x32_bf16 a[128:131], v[144:147], v[160:163], a[128:131]
  ds_read_b64_tr_b16 v[116:117], v25 offset:0
  v_mfma_f32_16x16x32_bf16 a[132:135], v[144:147], v[164:167], a[132:135]
  buffer_load_dwordx4 v46, s[60:63], s56 offen offset:2048 lds
  v_mfma_f32_16x16x32_bf16 a[136:139], v[144:147], v[168:171], a[136:139]
  ds_read_b64_tr_b16 v[118:119], v25 offset:1024
  v_mfma_f32_16x16x32_bf16 a[140:143], v[144:147], v[172:175], a[140:143]
  v_mfma_f32_16x16x32_bf16 a[144:147], v[144:147], v[176:179], a[144:147]
  ds_read_b128 v[88:91], v36 offset:12288
  v_mfma_f32_16x16x32_bf16 a[148:151], v[144:147], v[180:183], a[148:151]
  v_mfma_f32_16x16x32_bf16 a[152:155], v[144:147], v[184:187], a[152:155]
  ds_read_b64_tr_b16 v[120:121], v26 offset:0
  v_mfma_f32_16x16x32_bf16 a[156:159], v[144:147], v[188:191], a[156:159]
  buffer_load_dwordx4 v47, s[60:63], s56 offen offset:3072 lds
  v_mfma_f32_16x16x32_bf16 a[160:163], v[148:151], v[160:163], a[160:163]
  ds_read_b64_tr_b16 v[122:123], v26 offset:1024
  v_mfma_f32_16x16x32_bf16 a[164:167], v[148:151], v[164:167], a[164:167]
  v_mfma_f32_16x16x32_bf16 a[168:171], v[148:151], v[168:171], a[168:171]
  ds_read_b128 v[92:95], v36 offset:14336
  v_mfma_f32_16x16x32_bf16 a[172:175], v[148:151], v[172:175], a[172:175]
  v_mfma_f32_16x16x32_bf16 a[176:179], v[148:151], v[176:179], a[176:179]
  ds_read_b64_tr_b16 v[124:125], v27 offset:0
  s_add_u32 s56, s50, 3932160
  s_add_u32 m0, s51, 73728
  v_mfma_f32_16x16x32_bf16 a[180:183], v[148:151], v[180:183], a[180:183]
  buffer_load_dwordx4 v44, s[60:63], s56 offen offset:0 lds
  v_mfma_f32_16x16x32_bf16 a[184:187], v[148:151], v[184:187], a[184:187]
  ds_read_b64_tr_b16 v[126:127], v27 offset:1024
  v_mfma_f32_16x16x32_bf16 a[188:191], v[148:151], v[188:191], a[188:191]
  v_mfma_f32_16x16x32_bf16 a[192:195], v[152:155], v[160:163], a[192:195]
  v_mfma_f32_16x16x32_bf16 a[196:199], v[152:155], v[164:167], a[196:199]
  buffer_load_dwordx4 v45, s[60:63], s56 offen offset:1024 lds
  v_mfma_f32_16x16x32_bf16 a[200:203], v[152:155], v[168:171], a[200:203]
  v_mfma_f32_16x16x32_bf16 a[204:207], v[152:155], v[172:175], a[204:207]
  v_mfma_f32_16x16x32_bf16 a[208:211], v[152:155], v[176:179], a[208:211]
  v_mfma_f32_16x16x32_bf16 a[212:215], v[152:155], v[180:183], a[212:215]
  v_mfma_f32_16x16x32_bf16 a[216:219], v[152:155], v[184:187], a[216:219]
  buffer_load_dwordx4 v46, s[60:63], s56 offen offset:2048 lds
  v_mfma_f32_16x16x32_bf16 a[220:223], v[152:155], v[188:191], a[220:223]
  v_mfma_f32_16x16x32_bf16 a[224:227], v[156:159], v[160:163], a[224:227]
  v_mfma_f32_16x16x32_bf16 a[228:231], v[156:159], v[164:167], a[228:231]
  v_mfma_f32_16x16x32_bf16 a[232:235], v[156:159], v[168:171], a[232:235]
  v_mfma_f32_16x16x32_bf16 a[236:239], v[156:159], v[172:175], a[236:239]
  v_mfma_f32_16x16x32_bf16 a[240:243], v[156:159], v[176:179], a[240:243]
  buffer_load_dwordx4 v47, s[60:63], s56 offen offset:3072 lds
  v_mfma_f32_16x16x32_bf16 a[244:247], v[156:159], v[180:183], a[244:247]
  v_mfma_f32_16x16x32_bf16 a[248:251], v[156:159], v[184:187], a[248:251]
  v_mfma_f32_16x16x32_bf16 a[252:255], v[156:159], v[188:191], a[252:255]
  s_waitcnt lgkmcnt(0)
  v_mfma_f32_16x16x32_bf16 a[0:3], v[64:67], v[96:99], a[0:3]
  ds_read_b128 v[128:131], v37 offset:0
  s_add_u32 s56, s50, 4063232
  s_add_u32 m0, s51, 77824
  v_mfma_f32_16x16x32_bf16 a[4:7], v[64:67], v[100:103], a[4:7]
  buffer_load_dwordx4 v44, s[60:63], s56 offen offset:0 lds
  v_mfma_f32_16x16x32_bf16 a[8:11], v[64:67], v[104:107], a[8:11]
  ds_read_b64_tr_b16 v[160:161], v20 offset:8192
  v_mfma_f32_16x16x32_bf16 a[12:15], v[64:67], v[108:111], a[12:15]
  v_mfma_f32_16x16x32_bf16 a[16:19], v[64:67], v[112:115], a[16:19]
  ds_read_b64_tr_b16 v[162:163], v20 offset:9216
  v_mfma_f32_16x16x32_bf16 a[20:23], v[64:67], v[116:119], a[20:23]
  v_mfma_f32_16x16x32_bf16 a[24:27], v[64:67], v[120:123], a[24:27]
  ds_read_b128 v[132:135], v37 offset:2048
  v_mfma_f32_16x16x32_bf16 a[28:31], v[64:67], v[124:127], a[28:31]
  buffer_load_dwordx4 v45, s[60:63], s56 offen offset:1024 lds
  v_mfma_f32_16x16x32_bf16 a[32:35], v[68:71], v[96:99], a[32:35]
  ds_read_b64_tr_b16 v[164:165], v21 offset:8192
  v_mfma_f32_16x16x32_bf16 a[36:39], v[68:71], v[100:103], a[36:39]
  v_mfma_f32_16x16x32_bf16 a[40:43], v[68:71], v[104:107], a[40:43]
  ds_read_b64_tr_b16 v[166:167], v21 offset:9216
  v_mfma_f32_16x16x32_bf16 a[44:47], v[68:71], v[108:111], a[44:47]
  v_mfma_f32_16x16x32_bf16 a[48:51], v[68:71], v[112:115], a[48:51]
  ds_read_b128 v[136:139], v37 offset:4096
  v_mfma_f32_16x16x32_bf16 a[52:55], v[68:71], v[116:119], a[52:55]
  buffer_load_dwordx4 v46, s[60:63], s56 offen offset:2048 lds
  v_mfma_f32_16x16x32_bf16 a[56:59], v[68:71], v[120:123], a[56:59]
  ds_read_b64_tr_b16 v[168:169], v22 offset:8192
  v_mfma_f32_16x16x32_bf16 a[60:63], v[68:71], v[124:127], a[60:63]
  v_mfma_f32_16x16x32_bf16 a[64:67], v[72:75], v[96:99], a[64:67]
  ds_read_b64_tr_b16 v[170:171], v22 offset:9216
  v_mfma_f32_16x16x32_bf16 a[68:71], v[72:75], v[100:103], a[68:71]
  buffer_load_dwordx4 v47, s[60:63], s56 offen offset:3072 lds
  v_mfma_f32_16x16x32_bf16 a[72:75], v[72:75], v[104:107], a[72:75]
  ds_read_b128 v[140:143], v37 offset:6144
  v_mfma_f32_16x16x32_bf16 a[76:79], v[72:75], v[108:111], a[76:79]
  v_mfma_f32_16x16x32_bf16 a[80:83], v[72:75], v[112:115], a[80:83]
  ds_read_b64_tr_b16 v[172:173], v23 offset:8192
  v_mfma_f32_16x16x32_bf16 a[84:87], v[72:75], v[116:119], a[84:87]
  v_mfma_f32_16x16x32_bf16 a[88:91], v[72:75], v[120:123], a[88:91]
  ds_read_b64_tr_b16 v[174:175], v23 offset:9216
  v_mfma_f32_16x16x32_bf16 a[92:95], v[72:75], v[124:127], a[92:95]
  v_mfma_f32_16x16x32_bf16 a[96:99], v[76:79], v[96:99], a[96:99]
  ds_read_b128 v[144:147], v37 offset:8192
  v_mfma_f32_16x16x32_bf16 a[100:103], v[76:79], v[100:103], a[100:103]
  v_mfma_f32_16x16x32_bf16 a[104:107], v[76:79], v[104:107], a[104:107]
  ds_read_b64_tr_b16 v[176:177], v24 offset:8192
  v_mfma_f32_16x16x32_bf16 a[108:111], v[76:79], v[108:111], a[108:111]
  v_mfma_f32_16x16x32_bf16 a[112:115], v[76:79], v[112:115], a[112:115]
  ds_read_b64_tr_b16 v[178:179], v24 offset:9216
  v_mfma_f32_16x16x32_bf16 a[116:119], v[76:79], v[116:119], a[116:119]
  v_mfma_f32_16x16x32_bf16 a[120:123], v[76:79], v[120:123], a[120:123]
  ds_read_b128 v[148:151], v37 offset:10240
  v_mfma_f32_16x16x32_bf16 a[124:127], v[76:79], v[124:127], a[124:127]
  v_mfma_f32_16x16x32_bf16 a[128:131], v[80:83], v[96:99], a[128:131]
  ds_read_b64_tr_b16 v[180:181], v25 offset:8192
  v_mfma_f32_16x16x32_bf16 a[132:135], v[80:83], v[100:103], a[132:135]
  v_mfma_f32_16x16x32_bf16 a[136:139], v[80:83], v[104:107], a[136:139]
  ds_read_b64_tr_b16 v[182:183], v25 offset:9216
  v_mfma_f32_16x16x32_bf16 a[140:143], v[80:83], v[108:111], a[140:143]
  v_mfma_f32_16x16x32_bf16 a[144:147], v[80:83], v[112:115], a[144:147]
  ds_read_b128 v[152:155], v37 offset:12288
  v_mfma_f32_16x16x32_bf16 a[148:151], v[80:83], v[116:119], a[148:151]
  v_mfma_f32_16x16x32_bf16 a[152:155], v[80:83], v[120:123], a[152:155]
  ds_read_b64_tr_b16 v[184:185], v26 offset:8192
  v_mfma_f32_16x16x32_bf16 a[156:159], v[80:83], v[124:127], a[156:159]
  v_mfma_f32_16x16x32_bf16 a[160:163], v[84:87], v[96:99], a[160:163]
  ds_read_b64_tr_b16 v[186:187], v26 offset:9216
  v_mfma_f32_16x16x32_bf16 a[164:167], v[84:87], v[100:103], a[164:167]
  v_mfma_f32_16x16x32_bf16 a[168:171], v[84:87], v[104:107], a[168:171]
  ds_read_b128 v[156:159], v37 offset:14336
  v_mfma_f32_16x16x32_bf16 a[172:175], v[84:87], v[108:111], a[172:175]
  v_mfma_f32_16x16x32_bf16 a[176:179], v[84:87], v[112:115], a[176:179]
  ds_read_b64_tr_b16 v[188:189], v27 offset:8192
  v_mfma_f32_16x16x32_bf16 a[180:183], v[84:87], v[116:119], a[180:183]
  v_mfma_f32_16x16x32_bf16 a[184:187], v[84:87], v[120:123], a[184:187]
  ds_read_b64_tr_b16 v[190:191], v27 offset:9216
  v_mfma_f32_16x16x32_bf16 a[188:191], v[84:87], v[124:127], a[188:191]
  v_mfma_f32_16x16x32_bf16 a[192:195], v[88:91], v[96:99], a[192:195]
  s_mul_i32 s56, s58, 7
  v_mfma_f32_16x16x32_bf16 a[196:199], v[88:91], v[100:103], a[196:199]
  buffer_load_dword v15, v18, s[64:67], s56 offen
  v_mfma_f32_16x16x32_bf16 a[200:203], v[88:91], v[104:107], a[200:203]
  v_mfma_f32_16x16x32_bf16 a[204:207], v[88:91], v[108:111], a[204:207]
  v_mfma_f32_16x16x32_bf16 a[208:211], v[88:91], v[112:115], a[208:211]
  v_mfma_f32_16x16x32_bf16 a[212:215], v[88:91], v[116:119], a[212:215]
  v_mfma_f32_16x16x32_bf16 a[216:219], v[88:91], v[120:123], a[216:219]
  s_add_u32 s56, s59, 6
  s_min_u32 s56, s56, 7
  s_mul_i32 s56, s56, s37
  v_mfma_f32_16x16x32_bf16 a[220:223], v[88:91], v[124:127], a[220:223]
  buffer_load_dword v15, v19, s[72:75], s56 offen
  v_mfma_f32_16x16x32_bf16 a[224:227], v[92:95], v[96:99], a[224:227]
  v_mfma_f32_16x16x32_bf16 a[228:231], v[92:95], v[100:103], a[228:231]
  v_mfma_f32_16x16x32_bf16 a[232:235], v[92:95], v[104:107], a[232:235]
  v_mfma_f32_16x16x32_bf16 a[236:239], v[92:95], v[108:111], a[236:239]
  v_mfma_f32_16x16x32_bf16 a[240:243], v[92:95], v[112:115], a[240:243]
  v_mfma_f32_16x16x32_bf16 a[244:247], v[92:95], v[116:119], a[244:247]
  v_mfma_f32_16x16x32_bf16 a[248:251], v[92:95], v[120:123], a[248:251]
  v_mfma_f32_16x16x32_bf16 a[252:255], v[92:95], v[124:127], a[252:255]
  s_waitcnt vmcnt(2) lgkmcnt(0)
  s_barrier
  v_mfma_f32_16x16x32_bf16 a[0:3], v[128:131], v[160:163], a[0:3]
  ds_read_b128 v[64:67], v38 offset:0
  v_mfma_f32_16x16x32_bf16 a[4:7], v[128:131], v[164:167], a[4:7]
  v_mfma_f32_16x16x32_bf16 a[8:11], v[128:131], v[168:171], a[8:11]
  ds_read_b64_tr_b16 v[96:97], v28 offset:0
  v_mfma_f32_16x16x32_bf16 a[12:15], v[128:131], v[172:175], a[12:15]
  v_mfma_f32_16x16x32_bf16 a[16:19], v[128:131], v[176:179], a[16:19]
  ds_read_b64_tr_b16 v[98:99], v28 offset:1024
  v_mfma_f32_16x16x32_bf16 a[20:23], v[128:131], v[180:183], a[20:23]
  v_mfma_f32_16x16x32_bf16 a[24:27], v[128:131], v[184:187], a[24:27]
  ds_read_b128 v[68:71], v38 offset:2048
  v_mfma_f32_16x16x32_bf16 a[28:31], v[128:131], v[188:191], a[28:31]
  v_mfma_f32_16x16x32_bf16 a[32:35], v[132:135], v[160:163], a[32:35]
  ds_read_b64_tr_b16 v[100:101], v29 offset:0
  v_mfma_f32_16x16x32_bf16 a[36:39], v[132:135], v[164:167], a[36:39]
  v_mfma_f32_16x16x32_bf16 a[40:43], v[132:135], v[168:171], a[40:43]
  ds_read_b64_tr_b16 v[102:103], v29 offset:1024
  v_mfma_f32_16x16x32_bf16 a[44:47], v[132:135], v[172:175], a[44:47]
  v_mfma_f32_16x16x32_bf16 a[48:51], v[132:135], v[176:179], a[48:51]
  ds_read_b128 v[72:75], v38 offset:4096
  v_mfma_f32_16x16x32_bf16 a[52:55], v[132:135], v[180:183], a[52:55]
  v_mfma_f32_16x16x32_bf16 a[56:59], v[132:135], v[184:187], a[56:59]
  ds_read_b64_tr_b16 v[104:105], v30 offset:0
  v_mfma_f32_16x16x32_bf16 a[60:63], v[132:135], v[188:191], a[60:63]
  v_mfma_f32_16x16x32_bf16 a[64:67], v[136:139], v[160:163], a[64:67]
  ds_read_b64_tr_b16 v[106:107], v30 offset:1024
  v_mfma_f32_16x16x32_bf16 a[68:71], v[136:139], v[164:167], a[68:71]
  v_mfma_f32_16x16x32_bf16 a[72:75], v[136:139], v[168:171], a[72:75]
  ds_read_b128 v[76:79], v38 offset:6144
  v_mfma_f32_16x16x32_bf16 a[76:79], v[136:139], v[172:175], a[76:79]
  v_mfma_f32_16x16x32_bf16 a[80:83], v[136:139], v[176:179], a[80:83]
  ds_read_b64_tr_b16 v[108:109], v31 offset:0
  v_mfma_f32_16x16x32_bf16 a[84:87], v[136:139], v[180:183], a[84:87]
  v_mfma_f32_16x16x32_bf16 a[88:91], v[136:139], v[184:187], a[88:91]
  ds_read_b64_tr_b16 v[110:111], v31 offset:1024
  v_mfma_f32_16x16x32_bf16 a[92:95], v[136:139], v[188:191], a[92:95]
  v_mfma_f32_16x16x32_bf16 a[96:99], v[140:143], v[160:163], a[96:99]
  ds_read_b128 v[80:83], v38 offset:8192
  v_mfma_f32_16x16x32_bf16 a[100:103], v[140:143], v[164:167], a[100:103]
  v_mfma_f32_16x16x32_bf16 a[104:107], v[140:143], v[168:171], a[104:107]
  ds_read_b64_tr_b16 v[112:113], v32 offset:0
  v_mfma_f32_16x16x32_bf16 a[108:111], v[140:143], v[172:175], a[108:111]
  v_mfma_f32_16x16x32_bf16 a[112:115], v[140:143], v[176:179], a[112:115]
  ds_read_b64_tr_b16 v[114:115], v32 offset:1024
  v_mfma_f32_16x16x32_bf16 a[116:119], v[140:143], v[180:183], a[116:119]
  v_mfma_f32_16x16x32_bf16 a[120:123], v[140:143], v[184:187], a[120:123]
  ds_read_b128 v[84:87], v38 offset:10240
  v_mfma_f32_16x16x32_bf16 a[124:127], v[140:143], v[188:191], a[124:127]
  v_mfma_f32_16x16x32_bf16 a[128:131], v[144:147], v[160:163], a[128:131]
  ds_read_b64_tr_b16 v[116:117], v33 offset:0
  v_mfma_f32_16x16x32_bf16 a[132:135], v[144:147], v[164:167], a[132:135]
  v_mfma_f32_16x16x32_bf16 a[136:139], v[144:147], v[168:171], a[136:139]
  ds_read_b64_tr_b16 v[118:119], v33 offset:1024
  v_mfma_f32_16x16x32_bf16 a[140:143], v[144:147], v[172:175], a[140:143]
  v_mfma_f32_16x16x32_bf16 a[144:147], v[144:147], v[176:179], a[144:147]
  ds_read_b128 v[88:91], v38 offset:12288
  v_mfma_f32_16x16x32_bf16 a[148:151], v[144:147], v[180:183], a[148:151]
  v_mfma_f32_16x16x32_bf16 a[152:155], v[144:147], v[184:187], a[152:155]
  ds_read_b64_tr_b16 v[120:121], v34 offset:0
  v_mfma_f32_16x16x32_bf16 a[156:159], v[144:147], v[188:191], a[156:159]
  v_mfma_f32_16x16x32_bf16 a[160:163], v[148:151], v[160:163], a[160:163]
  ds_read_b64_tr_b16 v[122:123], v34 offset:1024
  v_mfma_f32_16x16x32_bf16 a[164:167], v[148:151], v[164:167], a[164:167]
  v_mfma_f32_16x16x32_bf16 a[168:171], v[148:151], v[168:171], a[168:171]
  ds_read_b128 v[92:95], v38 offset:14336
  v_mfma_f32_16x16x32_bf16 a[172:175], v[148:151], v[172:175], a[172:175]
  v_mfma_f32_16x16x32_bf16 a[176:179], v[148:151], v[176:179], a[176:179]
  ds_read_b64_tr_b16 v[124:125], v35 offset:0
  v_mfma_f32_16x16x32_bf16 a[180:183], v[148:151], v[180:183], a[180:183]
  v_mfma_f32_16x16x32_bf16 a[184:187], v[148:151], v[184:187], a[184:187]
  ds_read_b64_tr_b16 v[126:127], v35 offset:1024
  v_mfma_f32_16x16x32_bf16 a[188:191], v[148:151], v[188:191], a[188:191]
  v_mfma_f32_16x16x32_bf16 a[192:195], v[152:155], v[160:163], a[192:195]
  v_mfma_f32_16x16x32_bf16 a[196:199], v[152:155], v[164:167], a[196:199]
  v_mfma_f32_16x16x32_bf16 a[200:203], v[152:155], v[168:171], a[200:203]
  v_mfma_f32_16x16x32_bf16 a[204:207], v[152:155], v[172:175], a[204:207]
  s_cmp_lg_u32 s76, 0
  s_cbranch_scc1 F_nors
  s_and_b32 s56, s2, 7
  s_lshl_b32 s56, s56, 2
  v_mov_b32 v232, 1
  v_mov_b32 v233, s56
  v_cmp_eq_u32 vcc, 0, v1
  s_and_saveexec_b64 s[40:41], vcc
  buffer_atomic_add v232, v233, s[16:19], 0 offen sc1
  s_mov_b64 exec, s[40:41]
F_nors:
  v_mfma_f32_16x16x32_bf16 a[208:211], v[152:155], v[176:179], a[208:211]
  v_mfma_f32_16x16x32_bf16 a[212:215], v[152:155], v[180:183], a[212:215]
  v_mfma_f32_16x16x32_bf16 a[216:219], v[152:155], v[184:187], a[216:219]
  v_mfma_f32_16x16x32_bf16 a[220:223], v[152:155], v[188:191], a[220:223]
  v_mfma_f32_16x16x32_bf16 a[224:227], v[156:159], v[160:163], a[224:227]
  v_mfma_f32_16x16x32_bf16 a[228:231], v[156:159], v[164:167], a[228:231]
  v_mfma_f32_16x16x32_bf16 a[232:235], v[156:159], v[168:171], a[232:235]
  v_mfma_f32_16x16x32_bf16 a[236:239], v[156:159], v[172:175], a[236:239]
  v_mfma_f32_16x16x32_bf16 a[240:243], v[156:159], v[176:179], a[240:243]
  v_mfma_f32_16x16x32_bf16 a[244:247], v[156:159], v[180:183], a[244:247]
  v_mfma_f32_16x16x32_bf16 a[248:251], v[156:159], v[184:187], a[248:251]
  v_mfma_f32_16x16x32_bf16 a[252:255], v[156:159], v[188:191], a[252:255]
  s_waitcnt lgkmcnt(0)
  v_mfma_f32_16x16x32_bf16 a[0:3], v[64:67], v[96:99], a[0:3]
  ds_read_b128 v[128:131], v39 offset:0
  v_mfma_f32_16x16x32_bf16 a[4:7], v[64:67], v[100:103], a[4:7]
  v_mfma_f32_16x16x32_bf16 a[8:11], v[64:67], v[104:107], a[8:11]
  ds_read_b64_tr_b16 v[160:161], v28 offset:8192
  v_mfma_f32_16x16x32_bf16 a[12:15], v[64:67], v[108:111], a[12:15]
  v_mfma_f32_16x16x32_bf16 a[16:19], v[64:67], v[112:115], a[16:19]
  ds_read_b64_tr_b16 v[162:163], v28 offset:9216
  v_mfma_f32_16x16x32_bf16 a[20:23], v[64:67], v[116:119], a[20:23]
  v_mfma_f32_16x16x32_bf16 a[24:27], v[64:67], v[120:123], a[24:27]
  ds_read_b128 v[132:135], v39 offset:2048
  v_mfma_f32_16x16x32_bf16 a[28:31], v[64:67], v[124:127], a[28:31]
  v_mfma_f32_16x16x32_bf16 a[32:35], v[68:71], v[96:99], a[32:35]
  ds_read_b64_tr_b16 v[164:165], v29 offset:8192
  v_mfma_f32_16x16x32_bf16 a[36:39], v[68:71], v[100:103], a[36:39]
  v_mfma_f32_16x16x32_bf16 a[40:43], v[68:71], v[104:107], a[40:43]
  ds_read_b64_tr_b16 v[166:167], v29 offset:9216
  v_mfma_f32_16x16x32_bf16 a[44:47], v[68:71], v[108:111], a[44:47]
  v_mfma_f32_16x16x32_bf16 a[48:51], v[68:71], v[112:115], a[48:51]
  ds_read_b128 v[136:139], v39 offset:4096
  v_mfma_f32_16x16x32_bf16 a[52:55], v[68:71], v[116:119], a[52:55]
  v_mfma_f32_16x16x32_bf16 a[56:59], v[68:71], v[120:123], a[56:59]
  ds_read_b64_tr_b16 v[168:169], v30 offset:8192
  v_mfma_f32_16x16x32_bf16 a[60:63], v[68:71], v[124:127], a[60:63]
  v_mfma_f32_16x16x32_bf16 a[64:67], v[72:75], v[96:99], a[64:67]
  ds_read_b64_tr_b16 v[170:171], v30 offset:9216
  v_mfma_f32_16x16x32_bf16 a[68:71], v[72:75], v[100:103], a[68:71]
  v_mfma_f32_16x16x32_bf16 a[72:75], v[72:75], v[104:107], a[72:75]
  ds_read_b128 v[140:143], v39 offset:6144
  v_mfma_f32_16x16x32_bf16 a[76:79], v[72:75], v[108:111], a[76:79]
  v_mfma_f32_16x16x32_bf16 a[80:83], v[72:75], v[112:115], a[80:83]
  ds_read_b64_tr_b16 v[172:173], v31 offset:8192
  v_mfma_f32_16x16x32_bf16 a[84:87], v[72:75], v[116:119], a[84:87]
  v_mfma_f32_16x16x32_bf16 a[88:91], v[72:75], v[120:123], a[88:91]
  ds_read_b64_tr_b16 v[174:175], v31 offset:9216
  v_mfma_f32_16x16x32_bf16 a[92:95], v[72:75], v[124:127], a[92:95]
  v_mfma_f32_16x16x32_bf16 a[96:99], v[76:79], v[96:99], a[96:99]
  ds_read_b128 v[144:147], v39 offset:8192
  v_mfma_f32_16x16x32_bf16 a[100:103], v[76:79], v[100:103], a[100:103]
  v_mfma_f32_16x16x32_bf16 a[104:107], v[76:79], v[104:107], a[104:107]
  ds_read_b64_tr_b16 v[176:177], v32 offset:8192
  v_mfma_f32_16x16x32_bf16 a[108:111], v[76:79], v[108:111], a[108:111]
  v_mfma_f32_16x16x32_bf16 a[112:115], v[76:79], v[112:115], a[112:115]
  ds_read_b64_tr_b16 v[178:179], v32 offset:9216
  v_mfma_f32_16x16x32_bf16 a[116:119], v[76:79], v[116:119], a[116:119]
  v_mfma_f32_16x16x32_bf16 a[120:123], v[76:79], v[120:123], a[120:123]
  ds_read_b128 v[148:151], v39 offset:10240
  v_mfma_f32_16x16x32_bf16 a[124:127], v[76:79], v[124:127], a[124:127]
  v_mfma_f32_16x16x32_bf16 a[128:131], v[80:83], v[96:99], a[128:131]
  ds_read_b64_tr_b16 v[180:181], v33 offset:8192
  v_mfma_f32_16x16x32_bf16 a[132:135], v[80:83], v[100:103], a[132:135]
  v_mfma_f32_16x16x32_bf16 a[136:139], v[80:83], v[104:107], a[136:139]
  ds_read_b64_tr_b16 v[182:183], v33 offset:9216
  v_mfma_f32_16x16x32_bf16 a[140:143], v[80:83], v[108:111], a[140:143]
  v_mfma_f32_16x16x32_bf16 a[144:147], v[80:83], v[112:115], a[144:147]
  ds_read_b128 v[152:155], v39 offset:12288
  v_mfma_f32_16x16x32_bf16 a[148:151], v[80:83], v[116:119], a[148:151]
  v_mfma_f32_16x16x32_bf16 a[152:155], v[80:83], v[120:123], a[152:155]
  ds_read_b64_tr_b16 v[184:185], v34 offset:8192
  v_mfma_f32_16x16x32_bf16 a[156:159], v[80:83], v[124:127], a[156:159]
  v_mfma_f32_16x16x32_bf16 a[160:163], v[84:87], v[96:99], a[160:163]
  ds_read_b64_tr_b16 v[186:187], v34 offset:9216
  v_mfma_f32_16x16x32_bf16 a[164:167], v[84:87], v[100:103], a[164:167]
  v_mfma_f32_16x16x32_bf16 a[168:171], v[84:87], v[104:107], a[168:171]
  ds_read_b128 v[156:159], v39 offset:14336
  v_mfma_f32_16x16x32_bf16 a[172:175], v[84:87], v[108:111], a[172:175]
  v_mfma_f32_16x16x32_bf16 a[176:179], v[84:87], v[112:115], a[176:179]
  ds_read_b64_tr_b16 v[188:189], v35 offset:8192
  v_mfma_f32_16x16x32_bf16 a[180:183], v[84:87], v[116:119], a[180:183]
  v_mfma_f32_16x16x32_bf16 a[184:187], v[84:87], v[120:123], a[184:187]
  ds_read_b64_tr_b16 v[190:191], v35 offset:9216
  v_mfma_f32_16x16x32_bf16 a[188:191], v[84:87], v[124:127], a[188:191]
  v_mfma_f32_16x16x32_bf16 a[192:195], v[88:91], v[96:99], a[192:195]
  s_mul_i32 s56, s58, 7
  v_mfma_f32_16x16x32_bf16 a[196:199], v[88:91], v[100:103], a[196:199]
  buffer_load_dword v15, v18, s[64:67], s56 offen
  v_mfma_f32_16x16x32_bf16 a[200:203], v[88:91], v[104:107], a[200:203]
  v_mfma_f32_16x16x32_bf16 a[204:207], v[88:91], v[108:111], a[204:207]
  v_mfma_f32_16x16x32_bf16 a[208:211], v[88:91], v[112:115], a[208:211]
  v_mfma_f32_16x16x32_bf16 a[212:215], v[88:91], v[116:119], a[212:215]
  v_mfma_f32_16x16x32_bf16 a[216:219], v[88:91], v[120:123], a[216:219]
  s_add_u32 s56, s59, 7
  s_min_u32 s56, s56, 7
  s_mul_i32 s56, s56, s37
  v_mfma_f32_16x16x32_bf16 a[220:223], v[88:91], v[124:127], a[220:223]
  buffer_load_dword v15, v19, s[72:75], s56 offen
  v_mfma_f32_16x16x32_bf16 a[224:227], v[92:95], v[96:99], a[224:227]
  v_mfma_f32_16x16x32_bf16 a[228:231], v[92:95], v[100:103], a[228:231]
  v_mfma_f32_16x16x32_bf16 a[232:235], v[92:95], v[104:107], a[232:235]
  v_mfma_f32_16x16x32_bf16 a[236:239], v[92:95], v[108:111], a[236:239]
  v_mfma_f32_16x16x32_bf16 a[240:243], v[92:95], v[112:115], a[240:243]
  v_mfma_f32_16x16x32_bf16 a[244:247], v[92:95], v[116:119], a[244:247]
  v_mfma_f32_16x16x32_bf16 a[248:251], v[92:95], v[120:123], a[248:251]
  v_mfma_f32_16x16x32_bf16 a[252:255], v[92:95], v[124:127], a[252:255]
  s_waitcnt lgkmcnt(0)
  s_barrier
  v_mfma_f32_16x16x32_bf16 a[0:3], v[128:131], v[160:163], a[0:3]
  v_mfma_f32_16x16x32_bf16 a[4:7], v[128:131], v[164:167], a[4:7]
  v_mfma_f32_16x16x32_bf16 a[8:11], v[128:131], v[168:171], a[8:11]
  v_mfma_f32_16x16x32_bf16 a[12:15], v[128:131], v[172:175], a[12:15]
  v_mfma_f32_16x16x32_bf16 a[16:19], v[128:131], v[176:179], a[16:19]
  v_mfma_f32_16x16x32_bf16 a[20:23], v[128:131], v[180:183], a[20:23]
  v_mfma_f32_16x16x32_bf16 a[24:27], v[128:131], v[184:187], a[24:27]
  v_mfma_f32_16x16x32_bf16 a[28:31], v[128:131], v[188:191], a[28:31]
  v_mfma_f32_16x16x32_bf16 a[32:35], v[132:135], v[160:163], a[32:35]
  v_mfma_f32_16x16x32_bf16 a[36:39], v[132:135], v[164:167], a[36:39]
  v_mfma_f32_16x16x32_bf16 a[40:43], v[132:135], v[168:171], a[40:43]
  v_mfma_f32_16x16x32_bf16 a[44:47], v[132:135], v[172:175], a[44:47]
  v_mfma_f32_16x16x32_bf16 a[48:51], v[132:135], v[176:179], a[48:51]
  v_mfma_f32_16x16x32_bf16 a[52:55], v[132:135], v[180:183], a[52:55]
  v_mfma_f32_16x16x32_bf16 a[56:59], v[132:135], v[184:187], a[56:59]
  v_mfma_f32_16x16x32_bf16 a[60:63], v[132:135], v[188:191], a[60:63]
  v_mfma_f32_16x16x32_bf16 a[64:67], v[136:139], v[160:163], a[64:67]
  v_mfma_f32_16x16x32_bf16 a[68:71], v[136:139], v[164:167], a[68:71]
  v_mfma_f32_16x16x32_bf16 a[72:75], v[136:139], v[168:171], a[72:75]
  v_mfma_f32_16x16x32_bf16 a[76:79], v[136:139], v[172:175], a[76:79]
  v_mfma_f32_16x16x32_bf16 a[80:83], v[136:139], v[176:179], a[80:83]
  v_mfma_f32_16x16x32_bf16 a[84:87], v[136:139], v[180:183], a[84:87]
  v_mfma_f32_16x16x32_bf16 a[88:91], v[136:139], v[184:187], a[88:91]
  v_mfma_f32_16x16x32_bf16 a[92:95], v[136:139], v[188:191], a[92:95]
  v_mfma_f32_16x16x32_bf16 a[96:99], v[140:143], v[160:163], a[96:99]
  v_mfma_f32_16x16x32_bf16 a[100:103], v[140:143], v[164:167], a[100:103]
  v_mfma_f32_16x16x32_bf16 a[104:107], v[140:143], v[168:171], a[104:107]
  v_mfma_f32_16x16x32_bf16 a[108:111], v[140:143], v[172:175], a[108:111]
  v_mfma_f32_16x16x32_bf16 a[112:115], v[140:143], v[176:179], a[112:115]
  v_mfma_f32_16x16x32_bf16 a[116:119], v[140:143], v[180:183], a[116:119]
  v_mfma_f32_16x16x32_bf16 a[120:123], v[140:143], v[184:187], a[120:123]
  v_mfma_f32_16x16x32_bf16 a[124:127], v[140:143], v[188:191], a[124:127]
  v_mfma_f32_16x16x32_bf16 a[128:131], v[144:147], v[160:163], a[128:131]
  v_mfma_f32_16x16x32_bf16 a[132:135], v[144:147], v[164:167], a[132:135]
  v_mfma_f32_16x16x32_bf16 a[136:139], v[144:147], v[168:171], a[136:139]
  v_mfma_f32_16x16x32_bf16 a[140:143], v[144:147], v[172:175], a[140:143]
  v_mfma_f32_16x16x32_bf16 a[144:147], v[144:147], v[176:179], a[144:147]
  v_mfma_f32_16x16x32_bf16 a[148:151], v[144:147], v[180:183], a[148:151]
  v_mfma_f32_16x16x32_bf16 a[152:155], v[144:147], v[184:187], a[152:155]
  v_mfma_f32_16x16x32_bf16 a[156:159], v[144:147], v[188:191], a[156:159]
  v_mfma_f32_16x16x32_bf16 a[160:163], v[148:151], v[160:163], a[160:163]
  v_mfma_f32_16x16x32_bf16 a[164:167], v[148:151], v[164:167], a[164:167]
  v_mfma_f32_16x16x32_bf16 a[168:171], v[148:151], v[168:171], a[168:171]
  v_mfma_f32_16x16x32_bf16 a[172:175], v[148:151], v[172:175], a[172:175]
  v_mfma_f32_16x16x32_bf16 a[176:179], v[148:151], v[176:179], a[176:179]
  v_mfma_f32_16x16x32_bf16 a[180:183], v[148:151], v[180:183], a[180:183]
  v_mfma_f32_16x16x32_bf16 a[184:187], v[148:151], v[184:187], a[184:187]
  v_mfma_f32_16x16x32_bf16 a[188:191], v[148:151], v[188:191], a[188:191]
  v_mfma_f32_16x16x32_bf16 a[192:195], v[152:155], v[160:163], a[192:195]
  v_mfma_f32_16x16x32_bf16 a[196:199], v[152:155], v[164:167], a[196:199]
  v_mfma_f32_16x16x32_bf16 a[200:203], v[152:155], v[168:171], a[200:203]
  v_mfma_f32_16x16x32_bf16 a[204:207], v[152:155], v[172:175], a[204:207]
  v_mfma_f32_16x16x32_bf16 a[208:211], v[152:155], v[176:179], a[208:211]
  v_mfma_f32_16x16x32_bf16 a[212:215], v[152:155], v[180:183], a[212:215]
  v_mfma_f32_16x16x32_bf16 a[216:219], v[152:155], v[184:187], a[216:219]
  v_mfma_f32_16x16x32_bf16 a[220:223], v[152:155], v[188:191], a[220:223]
  v_mfma_f32_16x16x32_bf16 a[224:227], v[156:159], v[160:163], a[224:227]
  v_mfma_f32_16x16x32_bf16 a[228:231], v[156:159], v[164:167], a[228:231]
  v_mfma_f32_16x16x32_bf16 a[232:235], v[156:159], v[168:171], a[232:235]
  v_mfma_f32_16x16x32_bf16 a[236:239], v[156:159], v[172:175], a[236:239]
  v_mfma_f32_16x16x32_bf16 a[240:243], v[156:159], v[176:179], a[240:243]
  v_mfma_f32_16x16x32_bf16 a[244:247], v[156:159], v[180:183], a[244:247]
  v_mfma_f32_16x16x32_bf16 a[248:251], v[156:159], v[184:187], a[248:251]
  v_mfma_f32_16x16x32_bf16 a[252:255], v[156:159], v[188:191], a[252:255]
  s_lshl_b32 s39, s5, 12
  v_add_u32 v56, s39, v3
  v_xor_b32 v20, 0, v56
  v_xor_b32 v21, 32, v56
  v_xor_b32 v22, 64, v56
  v_xor_b32 v23, 96, v56
  v_xor_b32 v24, 0, v56
  v_add_u32 v24, 131072, v24
  v_xor_b32 v25, 32, v56
  v_add_u32 v25, 131072, v25
  v_xor_b32 v26, 64, v56
  v_add_u32 v26, 131072, v26
  v_xor_b32 v27, 96, v56
  v_add_u32 v27, 131072, v27
  v_xor_b32 v28, 0, v56
  v_add_u32 v28, 65536, v28
  v_xor_b32 v29, 32, v56
  v_add_u32 v29, 65536, v29
  v_xor_b32 v30, 64, v56
  v_add_u32 v30, 65536, v30
  v_xor_b32 v31, 96, v56
  v_add_u32 v31, 65536, v31
  v_xor_b32 v32, 0, v4
  v_add_u32 v32, 32768, v32
  v_xor_b32 v33, 64, v4
  v_add_u32 v33, 32768, v33
  v_xor_b32 v34, 128, v4
  v_add_u32 v34, 32768, v34
  v_xor_b32 v35, 192, v4
  v_add_u32 v35, 32768, v35
  v_xor_b32 v36, 0, v4
  v_add_u32 v36, 49152, v36
  v_xor_b32 v37, 64, v4
  v_add_u32 v37, 49152, v37
  v_xor_b32 v38, 128, v4
  v_add_u32 v38, 49152, v38
  v_xor_b32 v39, 192, v4
  v_add_u32 v39, 49152, v39
  v_xor_b32 v40, 0, v4
  v_add_u32 v40, 98304, v40
  v_xor_b32 v41, 64, v4
  v_add_u32 v41, 98304, v41
  v_xor_b32 v42, 128, v4
  v_add_u32 v42, 98304, v42
  v_xor_b32 v43, 192, v4
  v_add_u32 v43, 98304, v43
  ds_read_b64_tr_b16 v[64:65], v32 offset:0
  ds_read_b64_tr_b16 v[66:67], v32 offset:1024
  ds_read_b64_tr_b16 v[68:69], v33 offset:0
  ds_read_b64_tr_b16 v[70:71], v33 offset:1024
  ds_read_b64_tr_b16 v[72:73], v34 offset:0
  ds_read_b64_tr_b16 v[74:75], v34 offset:1024
  ds_read_b64_tr_b16 v[76:77], v35 offset:0
  ds_read_b64_tr_b16 v[78:79], v35 offset:1024
  ds_read_b128 v[80:83], v20 offset:0
  ds_read_b128 v[84:87], v20 offset:16384
  s_mov_b32 s36, 0x3e0293ee
  s_waitcnt lgkmcnt(0)
  v_mfma_f32_32x32x16_bf16 v[128:143], v[64:67], v[80:83], 0
  ds_read_b64_tr_b16 v[88:89], v32 offset:4096
  ds_read_b64_tr_b16 v[90:91], v32 offset:5120
  s_add_u32 s56, s52, 256
  s_add_u32 m0, s53, 65536
  v_mfma_f32_32x32x16_bf16 v[192:207], v[64:67], v[84:87], 0
  ds_read_b64_tr_b16 v[92:93], v33 offset:4096
  buffer_load_dwordx4 v6, s[12:15], s56 offen offset:0 lds
  buffer_load_dwordx4 v7, s[12:15], s56 offen offset:1024 lds
  v_mfma_f32_32x32x16_bf16 v[144:159], v[68:71], v[80:83], 0
  ds_read_b64_tr_b16 v[94:95], v33 offset:5120
  buffer_load_dwordx4 v8, s[12:15], s56 offen offset:2048 lds
  v_accvgpr_read_b32 v44, a0
  v_accvgpr_read_b32 v45, a1
  v_accvgpr_read_b32 v46, a2
  v_accvgpr_read_b32 v47, a3
  v_mfma_f32_32x32x16_bf16 v[208:223], v[68:71], v[84:87], 0
  ds_read_b64_tr_b16 v[96:97], v34 offset:4096
  buffer_load_dwordx4 v9, s[12:15], s56 offen offset:3072 lds
  s_add_u32 s56, s52, 33024
  s_add_u32 m0, s53, 69632
  v_accvgpr_read_b32 v48, a32
  v_accvgpr_read_b32 v49, a33
  v_mfma_f32_32x32x16_bf16 v[160:175], v[72:75], v[80:83], 0
  ds_read_b64_tr_b16 v[98:99], v34 offset:5120
  ds_read_b64_tr_b16 v[100:101], v35 offset:4096
  buffer_load_dwordx4 v6, s[12:15], s56 offen offset:0 lds
  v_accvgpr_read_b32 v50, a34
  v_accvgpr_read_b32 v51, a35
  v_cvt_pk_bf16_f32 v52, v44, v45
  v_mfma_f32_32x32x16_bf16 v[224:239], v[72:75], v[84:87], 0
  ds_read_b64_tr_b16 v[102:103], v35 offset:5120
  buffer_load_dwordx4 v7, s[12:15], s56 offen offset:1024 lds
  v_cvt_pk_bf16_f32 v53, v46, v47
  v_cvt_pk_bf16_f32 v54, v48, v49
  v_cvt_pk_bf16_f32 v55, v50, v51
  v_mfma_f32_32x32x16_bf16 v[176:191], v[76:79], v[80:83], 0
  ds_read_b128 v[104:107], v21 offset:0
  buffer_load_dwordx4 v8, s[12:15], s56 offen offset:2048 lds
  v_accvgpr_write_b32 a0, v52
  v_accvgpr_write_b32 a1, v53
  v_accvgpr_write_b32 a2, v54
  v_accvgpr_write_b32 a3, v55
  v_mfma_f32_32x32x16_bf16 v[240:255], v[76:79], v[84:87], 0
  ds_read_b128 v[108:111], v21 offset:16384
  buffer_load_dwordx4 v9, s[12:15], s56 offen offset:3072 lds
  s_add_u32 s56, s52, 65792
  s_add_u32 m0, s53, 73728
  v_accvgpr_read_b32 v112, a4
  v_accvgpr_read_b32 v113, a5
  s_waitcnt lgkmcnt(0)
  v_mfma_f32_32x32x16_bf16 v[128:143], v[88:91], v[104:107], v[128:143]
  ds_read_b64_tr_b16 v[64:65], v32 offset:8192
  ds_read_b64_tr_b16 v[66:67], v32 offset:9216
  buffer_load_dwordx4 v6, s[12:15], s56 offen offset:0 lds
  v_accvgpr_read_b32 v114, a6
  v_accvgpr_read_b32 v115, a7
  v_accvgpr_read_b32 v116, a36
  v_mfma_f32_32x32x16_bf16 v[192:207], v[88:91], v[108:111], v[192:207]
  ds_read_b64_tr_b16 v[68:69], v33 offset:8192
  buffer_load_dwordx4 v7, s[12:15], s56 offen offset:1024 lds
  v_accvgpr_read_b32 v117, a37
  v_accvgpr_read_b32 v118, a38
  v_accvgpr_read_b32 v119, a39
  v_mfma_f32_32x32x16_bf16 v[144:159], v[92:95], v[104:107], v[144:159]
  ds_read_b64_tr_b16 v[70:71], v33 offset:9216
  buffer_load_dwordx4 v8, s[12:15], s56 offen offset:2048 lds
  v_cvt_pk_bf16_f32 v120, v112, v113
  v_cvt_pk_bf16_f32 v121, v114, v115
  v_cvt_pk_bf16_f32 v122, v116, v117
  v_cvt_pk_bf16_f32 v123, v118, v119
  v_mfma_f32_32x32x16_bf16 v[208:223], v[92:95], v[108:111], v[208:223]
  ds_read_b64_tr_b16 v[72:73], v34 offset:8192
  buffer_load_dwordx4 v9, s[12:15], s56 offen offset:3072 lds
  s_add_u32 s56, s52, 98560
  s_add_u32 m0, s53, 77824
  v_accvgpr_write_b32 a4, v120
  v_accvgpr_write_b32 a5, v121
  v_mfma_f32_32x32x16_bf16 v[160:175], v[96:99], v[104:107], v[160:175]
  ds_read_b64_tr_b16 v[74:75], v34 offset:9216
  ds_read_b64_tr_b16 v[76:77], v35 offset:8192
  buffer_load_dwordx4 v6, s[12:15], s56 offen offset:0 lds
  buffer_load_dwordx4 v7, s[12:15], s56 offen offset:1024 lds
  v_accvgpr_write_b32 a6, v122
  v_accvgpr_write_b32 a7, v123
  v_mfma_f32_32x32x16_bf16 v[224:239], v[96:99], v[108:111], v[224:239]
  ds_read_b64_tr_b16 v[78:79], v35 offset:9216
  buffer_load_dwordx4 v8, s[12:15], s56 offen offset:2048 lds
  v_accvgpr_read_b32 v44, a8
  v_accvgpr_read_b32 v45, a9
  v_accvgpr_read_b32 v46, a10
  v_accvgpr_read_b32 v47, a11
  v_mfma_f32_32x32x16_bf16 v[176:191], v[100:103], v[104:107], v[176:191]
  ds_read_b128 v[80:83], v22 offset:0
  buffer_load_dwordx4 v9, s[12:15], s56 offen offset:3072 lds
  s_add_u32 s56, s54, 1048576
  s_add_u32 m0, s55, 98304
  v_accvgpr_read_b32 v48, a40
  v_accvgpr_read_b32 v49, a41
  v_mfma_f32_32x32x16_bf16 v[240:255], v[100:103], v[108:111], v[240:255]
  ds_read_b128 v[84:87], v22 offset:16384
  buffer_load_dwordx4 v10, s[68:71], s56 offen offset:0 lds
  v_accvgpr_read_b32 v50, a42
  v_accvgpr_read_b32 v51, a43
  v_cvt_pk_bf16_f32 v52, v44, v45
  s_waitcnt lgkmcnt(0)
  v_mfma_f32_32x32x16_bf16 v[128:143], v[64:67], v[80:83], v[128:143]
  ds_read_b64_tr_b16 v[88:89], v32 offset:12288
  ds_read_b64_tr_b16 v[90:91], v32 offset:13312
  buffer_load_dwordx4 v11, s[68:71], s56 offen offset:1024 lds
  v_cvt_pk_bf16_f32 v53, v46, v47
  v_cvt_pk_bf16_f32 v54, v48, v49
  v_mfma_f32_32x32x16_bf16 v[192:207], v[64:67], v[84:87], v[192:207]
  ds_read_b64_tr_b16 v[92:93], v33 offset:12288
  buffer_load_dwordx4 v12, s[68:71], s56 offen offset:2048 lds
  v_cvt_pk_bf16_f32 v55, v50, v51
  v_accvgpr_write_b32 a8, v52
  v_accvgpr_write_b32 a9, v53
  v_accvgpr_write_b32 a10, v54
  v_mfma_f32_32x32x16_bf16 v[144:159], v[68:71], v[80:83], v[144:159]
  ds_read_b64_tr_b16 v[94:95], v33 offset:13312
  buffer_load_dwordx4 v13, s[68:71], s56 offen offset:3072 lds
  s_add_u32 s56, s54, 1179648
  s_add_u32 m0, s55, 102400
  v_accvgpr_write_b32 a11, v55
  v_accvgpr_read_b32 v112, a12
  v_mfma_f32_32x32x16_bf16 v[208:223], v[68:71], v[84:87], v[208:223]
  ds_read_b64_tr_b16 v[96:97], v34 offset:12288
  buffer_load_dwordx4 v10, s[68:71], s56 offen offset:0 lds
  v_accvgpr_read_b32 v113, a13
  v_accvgpr_read_b32 v114, a14
  v_accvgpr_read_b32 v115, a15
  v_accvgpr_read_b32 v116, a44
  v_mfma_f32_32x32x16_bf16 v[160:175], v[72:75], v[80:83], v[160:175]
  ds_read_b64_tr_b16 v[98:99], v34 offset:13312
  ds_read_b64_tr_b16 v[100:101], v35 offset:12288
  buffer_load_dwordx4 v11, s[68:71], s56 offen offset:1024 lds
  v_accvgpr_read_b32 v117, a45
  v_accvgpr_read_b32 v118, a46
  v_mfma_f32_32x32x16_bf16 v[224:239], v[72:75], v[84:87], v[224:239]
  ds_read_b64_tr_b16 v[102:103], v35 offset:13312
  buffer_load_dwordx4 v12, s[68:71], s56 offen offset:2048 lds
  v_accvgpr_read_b32 v119, a47
  v_cvt_pk_bf16_f32 v120, v112, v113
  v_cvt_pk_bf16_f32 v121, v114, v115
  v_cvt_pk_bf16_f32 v122, v116, v117
  v_mfma_f32_32x32x16_bf16 v[176:191], v[76:79], v[80:83], v[176:191]
  ds_read_b128 v[104:107], v23 offset:0
  buffer_load_dwordx4 v13, s[68:71], s56 offen offset:3072 lds
  v_cvt_pk_bf16_f32 v123, v118, v119
  v_accvgpr_write_b32 a12, v120
  v_accvgpr_write_b32 a13, v121
  v_mfma_f32_32x32x16_bf16 v[240:255], v[76:79], v[84:87], v[240:255]
  ds_read_b128 v[108:111], v23 offset:16384
  v_accvgpr_write_b32 a14, v122
  v_accvgpr_write_b32 a15, v123
  v_accvgpr_read_b32 v44, a16
  v_accvgpr_read_b32 v45, a17
  v_accvgpr_read_b32 v46, a18
  s_waitcnt lgkmcnt(0)
  s_barrier
  v_mfma_f32_32x32x16_bf16 v[128:143], v[88:91], v[104:107], v[128:143]
  ds_read_b64_tr_b16 v[64:65], v36 offset:0
  ds_read_b64_tr_b16 v[66:67], v36 offset:1024
  s_add_u32 s56, s52, 384
  s_add_u32 m0, s53, 0
  v_accvgpr_read_b32 v47, a19
  v_accvgpr_read_b32 v48, a48
  v_accvgpr_read_b32 v49, a49
  v_mfma_f32_32x32x16_bf16 v[192:207], v[88:91], v[108:111], v[192:207]
  ds_read_b64_tr_b16 v[68:69], v37 offset:0
  buffer_load_dwordx4 v6, s[12:15], s56 offen offset:0 lds
  v_accvgpr_read_b32 v50, a50
  v_accvgpr_read_b32 v51, a51
  v_cvt_pk_bf16_f32 v52, v44, v45
  v_cvt_pk_bf16_f32 v53, v46, v47
  v_mfma_f32_32x32x16_bf16 v[144:159], v[92:95], v[104:107], v[144:159]
  ds_read_b64_tr_b16 v[70:71], v37 offset:1024
  buffer_load_dwordx4 v7, s[12:15], s56 offen offset:1024 lds
  v_cvt_pk_bf16_f32 v54, v48, v49
  v_cvt_pk_bf16_f32 v55, v50, v51
  v_accvgpr_write_b32 a16, v52
  v_mfma_f32_32x32x16_bf16 v[208:223], v[92:95], v[108:111], v[208:223]
  ds_read_b64_tr_b16 v[72:73], v38 offset:0
  buffer_load_dwordx4 v8, s[12:15], s56 offen offset:2048 lds
  v_accvgpr_write_b32 a17, v53
  v_accvgpr_write_b32 a18, v54
  v_accvgpr_write_b32 a19, v55
  v_accvgpr_read_b32 v112, a20
  v_mfma_f32_32x32x16_bf16 v[160:175], v[96:99], v[104:107], v[160:175]
  ds_read_b64_tr_b16 v[74:75], v38 offset:1024
  ds_read_b64_tr_b16 v[76:77], v39 offset:0
  buffer_load_dwordx4 v9, s[12:15], s56 offen offset:3072 lds
  v_accvgpr_read_b32 v113, a21
  v_accvgpr_read_b32 v114, a22
  v_mfma_f32_32x32x16_bf16 v[224:239], v[96:99], v[108:111], v[224:239]
  ds_read_b64_tr_b16 v[78:79], v39 offset:1024
  s_add_u32 s56, s52, 33152
  s_add_u32 m0, s53, 4096
  v_accvgpr_read_b32 v115, a23
  v_accvgpr_read_b32 v116, a52
  v_accvgpr_read_b32 v117, a53
  v_accvgpr_read_b32 v118, a54
  v_accvgpr_read_b32 v119, a55
  v_mfma_f32_32x32x16_bf16 v[176:191], v[100:103], v[104:107], v[176:191]
  ds_read_b128 v[80:83], v24 offset:0
  buffer_load_dwordx4 v6, s[12:15], s56 offen offset:0 lds
  v_cvt_pk_bf16_f32 v120, v112, v113
  v_cvt_pk_bf16_f32 v121, v114, v115
  v_cvt_pk_bf16_f32 v122, v116, v117
  v_mfma_f32_32x32x16_bf16 v[240:255], v[100:103], v[108:111], v[240:255]
  ds_read_b128 v[84:87], v24 offset:16384
  buffer_load_dwordx4 v7, s[12:15], s56 offen offset:1024 lds
  v_cvt_pk_bf16_f32 v123, v118, v119
  v_accvgpr_write_b32 a20, v120
  v_accvgpr_write_b32 a21, v121
  s_waitcnt lgkmcnt(0)
  v_mfma_f32_32x32x16_bf16 v[128:143], v[64:67], v[80:83], v[128:143]
  ds_read_b64_tr_b16 v[88:89], v36 offset:4096
  ds_read_b64_tr_b16 v[90:91], v36 offset:5120
  buffer_load_dwordx4 v8, s[12:15], s56 offen offset:2048 lds
  v_accvgpr_write_b32 a22, v122
  v_accvgpr_write_b32 a23, v123
  v_accvgpr_read_b32 v44, a24
  v_mfma_f32_32x32x16_bf16 v[192:207], v[64:67], v[84:87], v[192:207]
  ds_read_b64_tr_b16 v[92:93], v37 offset:4096
  buffer_load_dwordx4 v9, s[12:15], s56 offen offset:3072 lds
  v_accvgpr_read_b32 v45, a25
  v_accvgpr_read_b32 v46, a26
  v_accvgpr_read_b32 v47, a27
  v_mfma_f32_32x32x16_bf16 v[144:159], v[68:71], v[80:83], v[144:159]
  ds_read_b64_tr_b16 v[94:95], v37 offset:5120
  s_add_u32 s56, s52, 65920
  s_add_u32 m0, s53, 8192
  v_accvgpr_read_b32 v48, a56
  v_accvgpr_read_b32 v49, a57
  v_accvgpr_read_b32 v50, a58
  v_accvgpr_read_b32 v51, a59
  v_mfma_f32_32x32x16_bf16 v[208:223], v[68:71], v[84:87], v[208:223]
  ds_read_b64_tr_b16 v[96:97], v38 offset:4096
  buffer_load_dwordx4 v6, s[12:15], s56 offen offset:0 lds
  v_cvt_pk_bf16_f32 v52, v44, v45
  v_cvt_pk_bf16_f32 v53, v46, v47
  v_cvt_pk_bf16_f32 v54, v48, v49
  v_cvt_pk_bf16_f32 v55, v50, v51
  v_mfma_f32_32x32x16_bf16 v[160:175], v[72:75], v[80:83], v[160:175]
  ds_read_b64_tr_b16 v[98:99], v38 offset:5120
  ds_read_b64_tr_b16 v[100:101], v39 offset:4096
  buffer_load_dwordx4 v7, s[12:15], s56 offen offset:1024 lds
  v_accvgpr_write_b32 a24, v52
  v_accvgpr_write_b32 a25, v53
  v_accvgpr_write_b32 a26, v54
  v_mfma_f32_32x32x16_bf16 v[224:239], v[72:75], v[84:87], v[224:239]
  ds_read_b64_tr_b16 v[102:103], v39 offset:5120
  buffer_load_dwordx4 v8, s[12:15], s56 offen offset:2048 lds
  v_accvgpr_write_b32 a27, v55
  v_accvgpr_read_b32 v112, a28
  v_accvgpr_read_b32 v113, a29
  v_mfma_f32_32x32x16_bf16 v[176:191], v[76:79], v[80:83], v[176:191]
  ds_read_b128 v[104:107], v25 offset:0
  buffer_load_dwordx4 v9, s[12:15], s56 offen offset:3072 lds
  v_accvgpr_read_b32 v114, a30
  v_accvgpr_read_b32 v115, a31
  v_accvgpr_read_b32 v116, a60
  v_accvgpr_read_b32 v117, a61
  v_mfma_f32_32x32x16_bf16 v[240:255], v[76:79], v[84:87], v[240:255]
  ds_read_b128 v[108:111], v25 offset:16384
  s_add_u32 s56, s52, 98688
  s_add_u32 m0, s53, 12288
  v_accvgpr_read_b32 v118, a62
  v_accvgpr_read_b32 v119, a63
  v_cvt_pk_bf16_f32 v120, v112, v113
  s_waitcnt lgkmcnt(0)
  v_mfma_f32_32x32x16_bf16 v[128:143], v[88:91], v[104:107], v[128:143]
  ds_read_b64_tr_b16 v[64:65], v36 offset:8192
  ds_read_b64_tr_b16 v[66:67], v36 offset:9216
  buffer_load_dwordx4 v6, s[12:15], s56 offen offset:0 lds
  v_cvt_pk_bf16_f32 v121, v114, v115
  v_cvt_pk_bf16_f32 v122, v116, v117
  v_cvt_pk_bf16_f32 v123, v118, v119
  v_mfma_f32_32x32x16_bf16 v[192:207], v[88:91], v[108:111], v[192:207]
  ds_read_b64_tr_b16 v[68:69], v37 offset:8192
  buffer_load_dwordx4 v7, s[12:15], s56 offen offset:1024 lds
  v_accvgpr_write_b32 a28, v120
  v_accvgpr_write_b32 a29, v121
  v_accvgpr_write_b32 a30, v122
  v_mfma_f32_32x32x16_bf16 v[144:159], v[92:95], v[104:107], v[144:159]
  ds_read_b64_tr_b16 v[70:71], v37 offset:9216
  buffer_load_dwordx4 v8, s[12:15], s56 offen offset:2048 lds
  v_accvgpr_write_b32 a31, v123
  v_accvgpr_read_b32 v44, a64
  v_accvgpr_read_b32 v45, a65
  v_accvgpr_read_b32 v46, a66
  v_mfma_f32_32x32x16_bf16 v[208:223], v[92:95], v[108:111], v[208:223]
  ds_read_b64_tr_b16 v[72:73], v38 offset:8192
  buffer_load_dwordx4 v9, s[12:15], s56 offen offset:3072 lds
  v_accvgpr_read_b32 v47, a67
  v_accvgpr_read_b32 v48, a96
  v_accvgpr_read_b32 v49, a97
  v_mfma_f32_32x32x16_bf16 v[160:175], v[96:99], v[104:107], v[160:175]
  ds_read_b64_tr_b16 v[74:75], v38 offset:9216
  ds_read_b64_tr_b16 v[76:77], v39 offset:8192
  s_add_u32 s56, s54, 1572864
  s_add_u32 m0, s55, 32768
  v_accvgpr_read_b32 v50, a98
  v_accvgpr_read_b32 v51, a99
  v_cvt_pk_bf16_f32 v52, v44, v45
  v_cvt_pk_bf16_f32 v53, v46, v47
  v_mfma_f32_32x32x16_bf16 v[224:239], v[96:99], v[108:111], v[224:239]
  ds_read_b64_tr_b16 v[78:79], v39 offset:9216
  buffer_load_dwordx4 v10, s[68:71], s56 offen offset:0 lds
  v_cvt_pk_bf16_f32 v54, v48, v49
  v_cvt_pk_bf16_f32 v55, v50, v51
  v_accvgpr_write_b32 a64, v52
  v_mfma_f32_32x32x16_bf16 v[176:191], v[100:103], v[104:107], v[176:191]
  ds_read_b128 v[80:83], v26 offset:0
  buffer_load_dwordx4 v11, s[68:71], s56 offen offset:1024 lds
  v_accvgpr_write_b32 a65, v53
  v_accvgpr_write_b32 a66, v54
  v_accvgpr_write_b32 a67, v55
  v_accvgpr_read_b32 v112, a68
  v_mfma_f32_32x32x16_bf16 v[240:255], v[100:103], v[108:111], v[240:255]
  ds_read_b128 v[84:87], v26 offset:16384
  buffer_load_dwordx4 v12, s[68:71], s56 offen offset:2048 lds
  v_accvgpr_read_b32 v113, a69
  v_accvgpr_read_b32 v114, a70
  v_accvgpr_read_b32 v115, a71
  s_waitcnt lgkmcnt(0)
  v_mfma_f32_32x32x16_bf16 v[128:143], v[64:67], v[80:83], v[128:143]
  ds_read_b64_tr_b16 v[88:89], v36 offset:12288
  ds_read_b64_tr_b16 v[90:91], v36 offset:13312
  buffer_load_dwordx4 v13, s[68:71], s56 offen offset:3072 lds
  v_accvgpr_read_b32 v116, a100
  v_accvgpr_read_b32 v117, a101
  v_mfma_f32_32x32x16_bf16 v[192:207], v[64:67], v[84:87], v[192:207]
  ds_read_b64_tr_b16 v[92:93], v37 offset:12288
  s_add_u32 s56, s54, 1703936
  s_add_u32 m0, s55, 36864
  v_accvgpr_read_b32 v118, a102
  v_accvgpr_read_b32 v119, a103
  v_cvt_pk_bf16_f32 v120, v112, v113
  v_cvt_pk_bf16_f32 v121, v114, v115
  v_cvt_pk_bf16_f32 v122, v116, v117
  v_mfma_f32_32x32x16_bf16 v[144:159], v[68:71], v[80:83], v[144:159]
  ds_read_b64_tr_b16 v[94:95], v37 offset:13312
  buffer_load_dwordx4 v10, s[68:71], s56 offen offset:0 lds
  v_cvt_pk_bf16_f32 v123, v118, v119
  v_accvgpr_write_b32 a68, v120
  v_accvgpr_write_b32 a69, v121
  v_mfma_f32_32x32x16_bf16 v[208:223], v[68:71], v[84:87], v[208:223]
  ds_read_b64_tr_b16 v[96:97], v38 offset:12288
  buffer_load_dwordx4 v11, s[68:71], s56 offen offset:1024 lds
  v_accvgpr_write_b32 a70, v122
  v_accvgpr_write_b32 a71, v123
  v_accvgpr_read_b32 v44, a72
  v_accvgpr_read_b32 v45, a73
  v_mfma_f32_32x32x16_bf16 v[160:175], v[72:75], v[80:83], v[160:175]
  ds_read_b64_tr_b16 v[98:99], v38 offset:13312
  ds_read_b64_tr_b16 v[100:101], v39 offset:12288
  buffer_load_dwordx4 v12, s[68:71], s56 offen offset:2048 lds
  v_accvgpr_read_b32 v46, a74
  v_accvgpr_read_b32 v47, a75
  v_mfma_f32_32x32x16_bf16 v[224:239], v[72:75], v[84:87], v[224:239]
  ds_read_b64_tr_b16 v[102:103], v39 offset:13312
  buffer_load_dwordx4 v13, s[68:71], s56 offen offset:3072 lds
  v_accvgpr_read_b32 v48, a104
  v_accvgpr_read_b32 v49, a105
  v_accvgpr_read_b32 v50, a106
  v_accvgpr_read_b32 v51, a107
  v_mfma_f32_32x32x16_bf16 v[176:191], v[76:79], v[80:83], v[176:191]
  ds_read_b128 v[104:107], v27 offset:0
  v_cvt_pk_bf16_f32 v52, v44, v45
  v_cvt_pk_bf16_f32 v53, v46, v47
  v_cvt_pk_bf16_f32 v54, v48, v49
  v_cvt_pk_bf16_f32 v55, v50, v51
  v_accvgpr_write_b32 a72, v52
  v_accvgpr_write_b32 a73, v53
  v_mfma_f32_32x32x16_bf16 v[240:255], v[76:79], v[84:87], v[240:255]
  ds_read_b128 v[108:111], v27 offset:16384
  v_accvgpr_write_b32 a74, v54
  v_accvgpr_write_b32 a75, v55
  v_accvgpr_read_b32 v112, a76
  v_accvgpr_read_b32 v113, a77
  s_waitcnt vmcnt(24) lgkmcnt(0)
  s_barrier
  v_mfma_f32_32x32x16_bf16 v[128:143], v[88:91], v[104:107], v[128:143]
  ds_read_b64_tr_b16 v[64:65], v40 offset:0
  ds_read_b64_tr_b16 v[66:67], v40 offset:1024
  s_add_u32 s56, s52, 512
  s_add_u32 m0, s53, 131072
  v_accvgpr_read_b32 v114, a78
  v_accvgpr_read_b32 v115, a79
  v_accvgpr_read_b32 v116, a108
  v_accvgpr_read_b32 v117, a109
  v_mfma_f32_32x32x16_bf16 v[192:207], v[88:91], v[108:111], v[192:207]
  ds_read_b64_tr_b16 v[68:69], v41 offset:0
  buffer_load_dwordx4 v6, s[12:15], s56 offen offset:0 lds
  v_accvgpr_read_b32 v118, a110
  v_accvgpr_read_b32 v119, a111
  v_cvt_pk_bf16_f32 v120, v112, v113
  v_mfma_f32_32x32x16_bf16 v[144:159], v[92:95], v[104:107], v[144:159]
  ds_read_b64_tr_b16 v[70:71], v41 offset:1024
  buffer_load_dwordx4 v7, s[12:15], s56 offen offset:1024 lds
  v_cvt_pk_bf16_f32 v121, v114, v115
  v_cvt_pk_bf16_f32 v122, v116, v117
  v_cvt_pk_bf16_f32 v123, v118, v119
  v_accvgpr_write_b32 a76, v120
  v_mfma_f32_32x32x16_bf16 v[208:223], v[92:95], v[108:111], v[208:223]
  ds_read_b64_tr_b16 v[72:73], v42 offset:0
  buffer_load_dwordx4 v8, s[12:15], s56 offen offset:2048 lds
  v_accvgpr_write_b32 a77, v121
  v_accvgpr_write_b32 a78, v122
  v_accvgpr_write_b32 a79, v123
  v_mfma_f32_32x32x16_bf16 v[160:175], v[96:99], v[104:107], v[160:175]
  ds_read_b64_tr_b16 v[74:75], v42 offset:1024
  ds_read_b64_tr_b16 v[76:77], v43 offset:0
  buffer_load_dwordx4 v9, s[12:15], s56 offen offset:3072 lds
  v_accvgpr_read_b32 v44, a80
  v_accvgpr_read_b32 v45, a81
  v_accvgpr_read_b32 v46, a82
  v_mfma_f32_32x32x16_bf16 v[224:239], v[96:99], v[108:111], v[224:239]
  ds_read_b64_tr_b16 v[78:79], v43 offset:1024
  s_add_u32 s56, s52, 33280
  s_add_u32 m0, s53, 135168
  v_accvgpr_read_b32 v47, a83
  v_accvgpr_read_b32 v48, a112
  v_accvgpr_read_b32 v49, a113
  v_accvgpr_read_b32 v50, a114
  v_mfma_f32_32x32x16_bf16 v[176:191], v[100:103], v[104:107], v[176:191]
  ds_read_b128 v[80:83], v28 offset:0
  buffer_load_dwordx4 v6, s[12:15], s56 offen offset:0 lds
  v_accvgpr_read_b32 v51, a115
  v_cvt_pk_bf16_f32 v52, v44, v45
  v_cvt_pk_bf16_f32 v53, v46, v47
  v_cvt_pk_bf16_f32 v54, v48, v49
  v_mfma_f32_32x32x16_bf16 v[240:255], v[100:103], v[108:111], v[240:255]
  ds_read_b128 v[84:87], v28 offset:16384
  buffer_load_dwordx4 v7, s[12:15], s56 offen offset:1024 lds
  v_cvt_pk_bf16_f32 v55, v50, v51
  v_accvgpr_write_b32 a80, v52
  s_waitcnt lgkmcnt(0)
  v_mfma_f32_32x32x16_bf16 v[128:143], v[64:67], v[80:83], v[128:143]
  ds_read_b64_tr_b16 v[88:89], v40 offset:4096
  ds_read_b64_tr_b16 v[90:91], v40 offset:5120
  buffer_load_dwordx4 v8, s[12:15], s56 offen offset:2048 lds
  v_accvgpr_write_b32 a81, v53
  v_accvgpr_write_b32 a82, v54
  v_accvgpr_write_b32 a83, v55
  v_mfma_f32_32x32x16_bf16 v[192:207], v[64:67], v[84:87], v[192:207]
  ds_read_b64_tr_b16 v[92:93], v41 offset:4096
  buffer_load_dwordx4 v9, s[12:15], s56 offen offset:3072 lds
  v_accvgpr_read_b32 v112, a84
  v_accvgpr_read_b32 v113, a85
  v_accvgpr_read_b32 v114, a86
  v_mfma_f32_32x32x16_bf16 v[144:159], v[68:71], v[80:83], v[144:159]
  ds_read_b64_tr_b16 v[94:95], v41 offset:5120
  s_add_u32 s56, s52, 66048
  s_add_u32 m0, s53, 139264
  v_accvgpr_read_b32 v115, a87
  v_accvgpr_read_b32 v116, a116
  v_accvgpr_read_b32 v117, a117
  v_accvgpr_read_b32 v118, a118
  v_accvgpr_read_b32 v119, a119
  v_mfma_f32_32x32x16_bf16 v[208:223], v[68:71], v[84:87], v[208:223]
  ds_read_b64_tr_b16 v[96:97], v42 offset:4096
  buffer_load_dwordx4 v6, s[12:15], s56 offen offset:0 lds
  v_cvt_pk_bf16_f32 v120, v112, v113
  v_cvt_pk_bf16_f32 v121, v114, v115
  v_cvt_pk_bf16_f32 v122, v116, v117
  v_mfma_f32_32x32x16_bf16 v[160:175], v[72:75], v[80:83], v[160:175]
  ds_read_b64_tr_b16 v[98:99], v42 offset:5120
  ds_read_b64_tr_b16 v[100:101], v43 offset:4096
  buffer_load_dwordx4 v7, s[12:15], s56 offen offset:1024 lds
  v_cvt_pk_bf16_f32 v123, v118, v119
  v_accvgpr_write_b32 a84, v120
  v_accvgpr_write_b32 a85, v121
  v_mfma_f32_32x32x16_bf16 v[224:239], v[72:75], v[84:87], v[224:239]
  ds_read_b64_tr_b16 v[102:103], v43 offset:5120
  buffer_load_dwordx4 v8, s[12:15], s56 offen offset:2048 lds
  v_accvgpr_write_b32 a86, v122
  v_accvgpr_write_b32 a87, v123
  v_accvgpr_read_b32 v44, a88
  v_mfma_f32_32x32x16_bf16 v[176:191], v[76:79], v[80:83], v[176:191]
  ds_read_b128 v[104:107], v29 offset:0
  buffer_load_dwordx4 v9, s[12:15], s56 offen offset:3072 lds
  v_accvgpr_read_b32 v45, a89
  v_accvgpr_read_b32 v46, a90
  v_accvgpr_read_b32 v47, a91
  v_accvgpr_read_b32 v48, a120
  v_mfma_f32_32x32x16_bf16 v[240:255], v[76:79], v[84:87], v[240:255]
  ds_read_b128 v[108:111], v29 offset:16384
  s_add_u32 s56, s52, 98816
  s_add_u32 m0, s53, 143360
  v_accvgpr_read_b32 v49, a121
  v_accvgpr_read_b32 v50, a122
  v_accvgpr_read_b32 v51, a123
  s_waitcnt lgkmcnt(0)
  v_mfma_f32_32x32x16_bf16 v[128:143], v[88:91], v[104:107], v[128:143]
  ds_read_b64_tr_b16 v[64:65], v40 offset:8192
  ds_read_b64_tr_b16 v[66:67], v40 offset:9216
  buffer_load_dwordx4 v6, s[12:15], s56 offen offset:0 lds
  v_cvt_pk_bf16_f32 v52, v44, v45
  v_cvt_pk_bf16_f32 v53, v46, v47
  v_cvt_pk_bf16_f32 v54, v48, v49
  v_mfma_f32_32x32x16_bf16 v[192:207], v[88:91], v[108:111], v[192:207]
  ds_read_b64_tr_b16 v[68:69], v41 offset:8192
  buffer_load_dwordx4 v7, s[12:15], s56 offen offset:1024 lds
  v_cvt_pk_bf16_f32 v55, v50, v51
  v_accvgpr_write_b32 a88, v52
  v_accvgpr_write_b32 a89, v53
  v_accvgpr_write_b32 a90, v54
  v_mfma_f32_32x32x16_bf16 v[144:159], v[92:95], v[104:107], v[144:159]
  ds_read_b64_tr_b16 v[70:71], v41 offset:9216
  buffer_load_dwordx4 v8, s[12:15], s56 offen offset:2048 lds
  v_accvgpr_write_b32 a91, v55
  v_accvgpr_read_b32 v112, a92
  v_accvgpr_read_b32 v113, a93
  v_mfma_f32_32x32x16_bf16 v[208:223], v[92:95], v[108:111], v[208:223]
  ds_read_b64_tr_b16 v[72:73], v42 offset:8192
  buffer_load_dwordx4 v9, s[12:15], s56 offen offset:3072 lds
  v_accvgpr_read_b32 v114, a94
  v_accvgpr_read_b32 v115, a95
  v_accvgpr_read_b32 v116, a124
  v_accvgpr_read_b32 v117, a125
  v_mfma_f32_32x32x16_bf16 v[160:175], v[96:99], v[104:107], v[160:175]
  ds_read_b64_tr_b16 v[74:75], v42 offset:9216
  ds_read_b64_tr_b16 v[76:77], v43 offset:8192
  s_add_u32 s56, s54, 2097152
  s_add_u32 m0, s55, 49152
  v_accvgpr_read_b32 v118, a126
  v_accvgpr_read_b32 v119, a127
  v_cvt_pk_bf16_f32 v120, v112, v113
  v_mfma_f32_32x32x16_bf16 v[224:239], v[96:99], v[108:111], v[224:239]
  ds_read_b64_tr_b16 v[78:79], v43 offset:9216
  buffer_load_dwordx4 v10, s[68:71], s56 offen offset:0 lds
  v_cvt_pk_bf16_f32 v121, v114, v115
  v_cvt_pk_bf16_f32 v122, v116, v117
  v_cvt_pk_bf16_f32 v123, v118, v119
  v_accvgpr_write_b32 a92, v120
  v_mfma_f32_32x32x16_bf16 v[176:191], v[100:103], v[104:107], v[176:191]
  ds_read_b128 v[80:83], v30 offset:0
  buffer_load_dwordx4 v11, s[68:71], s56 offen offset:1024 lds
  v_accvgpr_write_b32 a93, v121
  v_accvgpr_write_b32 a94, v122
  v_accvgpr_write_b32 a95, v123
  v_mfma_f32_32x32x16_bf16 v[240:255], v[100:103], v[108:111], v[240:255]
  ds_read_b128 v[84:87], v30 offset:16384
  buffer_load_dwordx4 v12, s[68:71], s56 offen offset:2048 lds
  v_accvgpr_read_b32 v44, a128
  v_accvgpr_read_b32 v45, a129
  v_accvgpr_read_b32 v46, a130
  s_waitcnt lgkmcnt(0)
  v_mfma_f32_32x32x16_bf16 v[128:143], v[64:67], v[80:83], v[128:143]
  ds_read_b64_tr_b16 v[88:89], v40 offset:12288
  ds_read_b64_tr_b16 v[90:91], v40 offset:13312
  buffer_load_dwordx4 v13, s[68:71], s56 offen offset:3072 lds
  v_accvgpr_read_b32 v47, a131
  v_accvgpr_read_b32 v48, a160
  v_accvgpr_read_b32 v49, a161
  v_mfma_f32_32x32x16_bf16 v[192:207], v[64:67], v[84:87], v[192:207]
  ds_read_b64_tr_b16 v[92:93], v41 offset:12288
  s_add_u32 s56, s54, 2228224
  s_add_u32 m0, s55, 53248
  v_accvgpr_read_b32 v50, a162
  v_accvgpr_read_b32 v51, a163
  v_cvt_pk_bf16_f32 v52, v44, v45
  v_cvt_pk_bf16_f32 v53, v46, v47
  v_mfma_f32_32x32x16_bf16 v[144:159], v[68:71], v[80:83], v[144:159]
  ds_read_b64_tr_b16 v[94:95], v41 offset:13312
  buffer_load_dwordx4 v10, s[68:71], s56 offen offset:0 lds
  v_cvt_pk_bf16_f32 v54, v48, v49
  v_cvt_pk_bf16_f32 v55, v50, v51
  v_accvgpr_write_b32 a128, v52
  v_mfma_f32_32x32x16_bf16 v[208:223], v[68:71], v[84:87], v[208:223]
  ds_read_b64_tr_b16 v[96:97], v42 offset:12288
  buffer_load_dwordx4 v11, s[68:71], s56 offen offset:1024 lds
  v_accvgpr_write_b32 a129, v53
  v_accvgpr_write_b32 a130, v54
  v_accvgpr_write_b32 a131, v55
  v_accvgpr_read_b32 v112, a132
  v_mfma_f32_32x32x16_bf16 v[160:175], v[72:75], v[80:83], v[160:175]
  ds_read_b64_tr_b16 v[98:99], v42 offset:13312
  ds_read_b64_tr_b16 v[100:101], v43 offset:12288
  buffer_load_dwordx4 v12, s[68:71], s56 offen offset:2048 lds
  v_accvgpr_read_b32 v113, a133
  v_accvgpr_read_b32 v114, a134
  v_accvgpr_read_b32 v115, a135
  v_mfma_f32_32x32x16_bf16 v[224:239], v[72:75], v[84:87], v[224:239]
  ds_read_b64_tr_b16 v[102:103], v43 offset:13312
  buffer_load_dwordx4 v13, s[68:71], s56 offen offset:3072 lds
  v_accvgpr_read_b32 v116, a164
  v_accvgpr_read_b32 v117, a165
  v_accvgpr_read_b32 v118, a166
  v_mfma_f32_32x32x16_bf16 v[176:191], v[76:79], v[80:83], v[176:191]
  ds_read_b128 v[104:107], v31 offset:0
  v_accvgpr_read_b32 v119, a167
  v_cvt_pk_bf16_f32 v120, v112, v113
  v_cvt_pk_bf16_f32 v121, v114, v115
  v_cvt_pk_bf16_f32 v122, v116, v117
  v_cvt_pk_bf16_f32 v123, v118, v119
  v_accvgpr_write_b32 a132, v120
  v_mfma_f32_32x32x16_bf16 v[240:255], v[76:79], v[84:87], v[240:255]
  ds_read_b128 v[108:111], v31 offset:16384
  v_accvgpr_write_b32 a133, v121
  v_accvgpr_write_b32 a134, v122
  v_accvgpr_write_b32 a135, v123
  v_accvgpr_read_b32 v44, a136
  s_waitcnt vmcnt(24) lgkmcnt(0)
  s_barrier
  v_mfma_f32_32x32x16_bf16 v[128:143], v[88:91], v[104:107], v[128:143]
  ds_read_b64_tr_b16 v[64:65], v32 offset:0
  ds_read_b64_tr_b16 v[66:67], v32 offset:1024
  s_add_u32 s56, s52, 640
  s_add_u32 m0, s53, 65536
  v_accvgpr_read_b32 v45, a137
  v_accvgpr_read_b32 v46, a138
  v_accvgpr_read_b32 v47, a139
  v_accvgpr_read_b32 v48, a168
  v_mfma_f32_32x32x16_bf16 v[192:207], v[88:91], v[108:111], v[192:207]
  ds_read_b64_tr_b16 v[68:69], v33 offset:0
  buffer_load_dwordx4 v6, s[12:15], s56 offen offset:0 lds
  v_accvgpr_read_b32 v49, a169
  v_accvgpr_read_b32 v50, a170
  v_accvgpr_read_b32 v51, a171
  v_mfma_f32_32x32x16_bf16 v[144:159], v[92:95], v[104:107], v[144:159]
  ds_read_b64_tr_b16 v[70:71], v33 offset:1024
  buffer_load_dwordx4 v7, s[12:15], s56 offen offset:1024 lds
  v_cvt_pk_bf16_f32 v52, v44, v45
  v_cvt_pk_bf16_f32 v53, v46, v47
  v_cvt_pk_bf16_f32 v54, v48, v49
  v_cvt_pk_bf16_f32 v55, v50, v51
  v_mfma_f32_32x32x16_bf16 v[208:223], v[92:95], v[108:111], v[208:223]
  ds_read_b64_tr_b16 v[72:73], v34 offset:0
  buffer_load_dwordx4 v8, s[12:15], s56 offen offset:2048 lds
  v_accvgpr_write_b32 a136, v52
  v_accvgpr_write_b32 a137, v53
  v_accvgpr_write_b32 a138, v54
  v_mfma_f32_32x32x16_bf16 v[160:175], v[96:99], v[104:107], v[160:175]
  ds_read_b64_tr_b16 v[74:75], v34 offset:1024
  ds_read_b64_tr_b16 v[76:77], v35 offset:0
  buffer_load_dwordx4 v9, s[12:15], s56 offen offset:3072 lds
  v_accvgpr_write_b32 a139, v55
  v_accvgpr_read_b32 v112, a140
  v_accvgpr_read_b32 v113, a141
  v_mfma_f32_32x32x16_bf16 v[224:239], v[96:99], v[108:111], v[224:239]
  ds_read_b64_tr_b16 v[78:79], v35 offset:1024
  s_add_u32 s56, s52, 33408
  s_add_u32 m0, s53, 69632
  v_accvgpr_read_b32 v114, a142
  v_accvgpr_read_b32 v115, a143
  v_accvgpr_read_b32 v116, a172
  v_accvgpr_read_b32 v117, a173
  v_mfma_f32_32x32x16_bf16 v[176:191], v[100:103], v[104:107], v[176:191]
  ds_read_b128 v[80:83], v20 offset:0
  buffer_load_dwordx4 v6, s[12:15], s56 offen offset:0 lds
  v_accvgpr_read_b32 v118, a174
  v_accvgpr_read_b32 v119, a175
  v_cvt_pk_bf16_f32 v120, v112, v113
  v_cvt_pk_bf16_f32 v121, v114, v115
  v_mfma_f32_32x32x16_bf16 v[240:255], v[100:103], v[108:111], v[240:255]
  ds_read_b128 v[84:87], v20 offset:16384
  buffer_load_dwordx4 v7, s[12:15], s56 offen offset:1024 lds
  v_cvt_pk_bf16_f32 v122, v116, v117
  v_cvt_pk_bf16_f32 v123, v118, v119
  v_accvgpr_write_b32 a140, v120
  s_waitcnt lgkmcnt(0)
  v_mfma_f32_32x32x16_bf16 v[128:143], v[64:67], v[80:83], v[128:143]
  ds_read_b64_tr_b16 v[88:89], v32 offset:4096
  ds_read_b64_tr_b16 v[90:91], v32 offset:5120
  buffer_load_dwordx4 v8, s[12:15], s56 offen offset:2048 lds
  v_accvgpr_write_b32 a141, v121
  v_accvgpr_write_b32 a142, v122
  v_mfma_f32_32x32x16_bf16 v[192:207], v[64:67], v[84:87], v[192:207]
  ds_read_b64_tr_b16 v[92:93], v33 offset:4096
  buffer_load_dwordx4 v9, s[12:15], s56 offen offset:3072 lds
  v_accvgpr_write_b32 a143, v123
  v_accvgpr_read_b32 v44, a144
  v_accvgpr_read_b32 v45, a145
  v_accvgpr_read_b32 v46, a146
  v_mfma_f32_32x32x16_bf16 v[144:159], v[68:71], v[80:83], v[144:159]
  ds_read_b64_tr_b16 v[94:95], v33 offset:5120
  s_add_u32 s56, s52, 66176
  s_add_u32 m0, s53, 73728
  v_accvgpr_read_b32 v47, a147
  v_accvgpr_read_b32 v48, a176
  v_accvgpr_read_b32 v49, a177
  v_accvgpr_read_b32 v50, a178
  v_mfma_f32_32x32x16_bf16 v[208:223], v[68:71], v[84:87], v[208:223]
  ds_read_b64_tr_b16 v[96:97], v34 offset:4096
  buffer_load_dwordx4 v6, s[12:15], s56 offen offset:0 lds
  v_accvgpr_read_b32 v51, a179
  v_cvt_pk_bf16_f32 v52, v44, v45
  v_cvt_pk_bf16_f32 v53, v46, v47
  v_cvt_pk_bf16_f32 v54, v48, v49
  v_mfma_f32_32x32x16_bf16 v[160:175], v[72:75], v[80:83], v[160:175]
  ds_read_b64_tr_b16 v[98:99], v34 offset:5120
  ds_read_b64_tr_b16 v[100:101], v35 offset:4096
  buffer_load_dwordx4 v7, s[12:15], s56 offen offset:1024 lds
  v_cvt_pk_bf16_f32 v55, v50, v51
  v_accvgpr_write_b32 a144, v52
  v_mfma_f32_32x32x16_bf16 v[224:239], v[72:75], v[84:87], v[224:239]
  ds_read_b64_tr_b16 v[102:103], v35 offset:5120
  buffer_load_dwordx4 v8, s[12:15], s56 offen offset:2048 lds
  v_accvgpr_write_b32 a145, v53
  v_accvgpr_write_b32 a146, v54
  v_accvgpr_write_b32 a147, v55
  v_accvgpr_read_b32 v112, a148
  v_mfma_f32_32x32x16_bf16 v[176:191], v[76:79], v[80:83], v[176:191]
  ds_read_b128 v[104:107], v21 offset:0
  buffer_load_dwordx4 v9, s[12:15], s56 offen offset:3072 lds
  v_accvgpr_read_b32 v113, a149
  v_accvgpr_read_b32 v114, a150
  v_accvgpr_read_b32 v115, a151
  v_mfma_f32_32x32x16_bf16 v[240:255], v[76:79], v[84:87], v[240:255]
  ds_read_b128 v[108:111], v21 offset:16384
  s_add_u32 s56, s52, 98944
  s_add_u32 m0, s53, 77824
  v_accvgpr_read_b32 v116, a180
  v_accvgpr_read_b32 v117, a181
  v_accvgpr_read_b32 v118, a182
  v_accvgpr_read_b32 v119, a183
  s_waitcnt lgkmcnt(0)
  v_mfma_f32_32x32x16_bf16 v[128:143], v[88:91], v[104:107], v[128:143]
  ds_read_b64_tr_b16 v[64:65], v32 offset:8192
  ds_read_b64_tr_b16 v[66:67], v32 offset:9216
  buffer_load_dwordx4 v6, s[12:15], s56 offen offset:0 lds
  v_cvt_pk_bf16_f32 v120, v112, v113
  v_cvt_pk_bf16_f32 v121, v114, v115
  v_cvt_pk_bf16_f32 v122, v116, v117
  v_mfma_f32_32x32x16_bf16 v[192:207], v[88:91], v[108:111], v[192:207]
  ds_read_b64_tr_b16 v[68:69], v33 offset:8192
  buffer_load_dwordx4 v7, s[12:15], s56 offen offset:1024 lds
  v_cvt_pk_bf16_f32 v123, v118, v119
  v_accvgpr_write_b32 a148, v120
  v_accvgpr_write_b32 a149, v121
  v_mfma_f32_32x32x16_bf16 v[144:159], v[92:95], v[104:107], v[144:159]
  ds_read_b64_tr_b16 v[70:71], v33 offset:9216
  buffer_load_dwordx4 v8, s[12:15], s56 offen offset:2048 lds
  v_accvgpr_write_b32 a150, v122
  v_accvgpr_write_b32 a151, v123
  v_accvgpr_read_b32 v44, a152
  v_accvgpr_read_b32 v45, a153
  v_mfma_f32_32x32x16_bf16 v[208:223], v[92:95], v[108:111], v[208:223]
  ds_read_b64_tr_b16 v[72:73], v34 offset:8192
  buffer_load_dwordx4 v9, s[12:15], s56 offen offset:3072 lds
  v_accvgpr_read_b32 v46, a154
  v_accvgpr_read_b32 v47, a155
  v_accvgpr_read_b32 v48, a184
  v_mfma_f32_32x32x16_bf16 v[160:175], v[96:99], v[104:107], v[160:175]
  ds_read_b64_tr_b16 v[74:75], v34 offset:9216
  ds_read_b64_tr_b16 v[76:77], v35 offset:8192
  s_add_u32 s56, s54, 2621440
  s_add_u32 m0, s55, 98304
  v_accvgpr_read_b32 v49, a185
  v_accvgpr_read_b32 v50, a186
  v_accvgpr_read_b32 v51, a187
  v_cvt_pk_bf16_f32 v52, v44, v45
  v_mfma_f32_32x32x16_bf16 v[224:239], v[96:99], v[108:111], v[224:239]
  ds_read_b64_tr_b16 v[78:79], v35 offset:9216
  buffer_load_dwordx4 v10, s[68:71], s56 offen offset:0 lds
  v_cvt_pk_bf16_f32 v53, v46, v47
  v_cvt_pk_bf16_f32 v54, v48, v49
  v_cvt_pk_bf16_f32 v55, v50, v51
  v_mfma_f32_32x32x16_bf16 v[176:191], v[100:103], v[104:107], v[176:191]
  ds_read_b128 v[80:83], v22 offset:0
  buffer_load_dwordx4 v11, s[68:71], s56 offen offset:1024 lds
  v_accvgpr_write_b32 a152, v52
  v_accvgpr_write_b32 a153, v53
  v_accvgpr_write_b32 a154, v54
  v_accvgpr_write_b32 a155, v55
  v_mfma_f32_32x32x16_bf16 v[240:255], v[100:103], v[108:111], v[240:255]
  ds_read_b128 v[84:87], v22 offset:16384
  buffer_load_dwordx4 v12, s[68:71], s56 offen offset:2048 lds
  v_accvgpr_read_b32 v112, a156
  v_accvgpr_read_b32 v113, a157
  s_waitcnt lgkmcnt(0)
  v_mfma_f32_32x32x16_bf16 v[128:143], v[64:67], v[80:83], v[128:143]
  ds_read_b64_tr_b16 v[88:89], v32 offset:12288
  ds_read_b64_tr_b16 v[90:91], v32 offset:13312
  buffer_load_dwordx4 v13, s[68:71], s56 offen offset:3072 lds
  v_accvgpr_read_b32 v114, a158
  v_accvgpr_read_b32 v115, a159
  v_accvgpr_read_b32 v116, a188
  v_mfma_f32_32x32x16_bf16 v[192:207], v[64:67], v[84:87], v[192:207]
  ds_read_b64_tr_b16 v[92:93], v33 offset:12288
  s_add_u32 s56, s54, 2752512
  s_add_u32 m0, s55, 102400
  v_accvgpr_read_b32 v117, a189
  v_accvgpr_read_b32 v118, a190
  v_accvgpr_read_b32 v119, a191
  v_cvt_pk_bf16_f32 v120, v112, v113
  v_mfma_f32_32x32x16_bf16 v[144:159], v[68:71], v[80:83], v[144:159]
  ds_read_b64_tr_b16 v[94:95], v33 offset:13312
  buffer_load_dwordx4 v10, s[68:71], s56 offen offset:0 lds
  v_cvt_pk_bf16_f32 v121, v114, v115
  v_cvt_pk_bf16_f32 v122, v116, v117
  v_cvt_pk_bf16_f32 v123, v118, v119
  v_accvgpr_write_b32 a156, v120
  v_mfma_f32_32x32x16_bf16 v[208:223], v[68:71], v[84:87], v[208:223]
  ds_read_b64_tr_b16 v[96:97], v34 offset:12288
  buffer_load_dwordx4 v11, s[68:71], s56 offen offset:1024 lds
  v_accvgpr_write_b32 a157, v121
  v_accvgpr_write_b32 a158, v122
  v_accvgpr_write_b32 a159, v123
  v_mfma_f32_32x32x16_bf16 v[160:175], v[72:75], v[80:83], v[160:175]
  ds_read_b64_tr_b16 v[98:99], v34 offset:13312
  ds_read_b64_tr_b16 v[100:101], v35 offset:12288
  buffer_load_dwordx4 v12, s[68:71], s56 offen offset:2048 lds
  v_accvgpr_read_b32 v44, a192
  v_accvgpr_read_b32 v45, a193
  v_accvgpr_read_b32 v46, a194
  v_mfma_f32_32x32x16_bf16 v[224:239], v[72:75], v[84:87], v[224:239]
  ds_read_b64_tr_b16 v[102:103], v35 offset:13312
  buffer_load_dwordx4 v13, s[68:71], s56 offen offset:3072 lds
  v_accvgpr_read_b32 v47, a195
  v_accvgpr_read_b32 v48, a224
  v_accvgpr_read_b32 v49, a225
  v_mfma_f32_32x32x16_bf16 v[176:191], v[76:79], v[80:83], v[176:191]
  ds_read_b128 v[104:107], v23 offset:0
  v_accvgpr_read_b32 v50, a226
  v_accvgpr_read_b32 v51, a227
  v_cvt_pk_bf16_f32 v52, v44, v45
  v_cvt_pk_bf16_f32 v53, v46, v47
  v_cvt_pk_bf16_f32 v54, v48, v49
  v_cvt_pk_bf16_f32 v55, v50, v51
  v_mfma_f32_32x32x16_bf16 v[240:255], v[76:79], v[84:87], v[240:255]
  ds_read_b128 v[108:111], v23 offset:16384
  v_accvgpr_write_b32 a192, v52
  v_accvgpr_write_b32 a193, v53
  v_accvgpr_write_b32 a194, v54
  v_accvgpr_write_b32 a195, v55
  v_accvgpr_read_b32 v112, a196
  s_waitcnt vmcnt(24) lgkmcnt(0)
  s_barrier
  v_mfma_f32_32x32x16_bf16 v[128:143], v[88:91], v[104:107], v[128:143]
  ds_read_b64_tr_b16 v[64:65], v36 offset:0
  ds_read_b64_tr_b16 v[66:67], v36 offset:1024
  s_add_u32 s56, s52, 768
  s_add_u32 m0, s53, 0
  v_accvgpr_read_b32 v113, a197
  v_accvgpr_read_b32 v114, a198
  v_accvgpr_read_b32 v115, a199
  v_mfma_f32_32x32x16_bf16 v[192:207], v[88:91], v[108:111], v[192:207]
  ds_read_b64_tr_b16 v[68:69], v37 offset:0
  buffer_load_dwordx4 v6, s[12:15], s56 offen offset:0 lds
  v_accvgpr_read_b32 v116, a228
  v_accvgpr_read_b32 v117, a229
  v_accvgpr_read_b32 v118, a230
  v_accvgpr_read_b32 v119, a231
  v_mfma_f32_32x32x16_bf16 v[144:159], v[92:95], v[104:107], v[144:159]
  ds_read_b64_tr_b16 v[70:71], v37 offset:1024
  buffer_load_dwordx4 v7, s[12:15], s56 offen offset:1024 lds
  v_cvt_pk_bf16_f32 v120, v112, v113
  v_cvt_pk_bf16_f32 v121, v114, v115
  v_cvt_pk_bf16_f32 v122, v116, v117
  v_mfma_f32_32x32x16_bf16 v[208:223], v[92:95], v[108:111], v[208:223]
  ds_read_b64_tr_b16 v[72:73], v38 offset:0
  buffer_load_dwordx4 v8, s[12:15], s56 offen offset:2048 lds
  v_cvt_pk_bf16_f32 v123, v118, v119
  v_accvgpr_write_b32 a196, v120
  v_accvgpr_write_b32 a197, v121
  v_accvgpr_write_b32 a198, v122
  v_mfma_f32_32x32x16_bf16 v[160:175], v[96:99], v[104:107], v[160:175]
  ds_read_b64_tr_b16 v[74:75], v38 offset:1024
  ds_read_b64_tr_b16 v[76:77], v39 offset:0
  buffer_load_dwordx4 v9, s[12:15], s56 offen offset:3072 lds
  v_accvgpr_write_b32 a199, v123
  v_accvgpr_read_b32 v44, a200
  v_mfma_f32_32x32x16_bf16 v[224:239], v[96:99], v[108:111], v[224:239]
  ds_read_b64_tr_b16 v[78:79], v39 offset:1024
  s_add_u32 s56, s52, 33536
  s_add_u32 m0, s53, 4096
  v_accvgpr_read_b32 v45, a201
  v_accvgpr_read_b32 v46, a202
  v_accvgpr_read_b32 v47, a203
  v_accvgpr_read_b32 v48, a232
  v_accvgpr_read_b32 v49, a233
  v_mfma_f32_32x32x16_bf16 v[176:191], v[100:103], v[104:107], v[176:191]
  ds_read_b128 v[80:83], v24 offset:0
  buffer_load_dwordx4 v6, s[12:15], s56 offen offset:0 lds
  v_accvgpr_read_b32 v50, a234
  v_accvgpr_read_b32 v51, a235
  v_cvt_pk_bf16_f32 v52, v44, v45
  v_mfma_f32_32x32x16_bf16 v[240:255], v[100:103], v[108:111], v[240:255]
  ds_read_b128 v[84:87], v24 offset:16384
  buffer_load_dwordx4 v7, s[12:15], s56 offen offset:1024 lds
  v_cvt_pk_bf16_f32 v53, v46, v47
  v_cvt_pk_bf16_f32 v54, v48, v49
  v_cvt_pk_bf16_f32 v55, v50, v51
  s_waitcnt lgkmcnt(0)
  v_mfma_f32_32x32x16_bf16 v[128:143], v[64:67], v[80:83], v[128:143]
  ds_read_b64_tr_b16 v[88:89], v36 offset:4096
  ds_read_b64_tr_b16 v[90:91], v36 offset:5120
  buffer_load_dwordx4 v8, s[12:15], s56 offen offset:2048 lds
  v_accvgpr_write_b32 a200, v52
  v_accvgpr_write_b32 a201, v53
  v_accvgpr_write_b32 a202, v54
  v_mfma_f32_32x32x16_bf16 v[192:207], v[64:67], v[84:87], v[192:207]
  ds_read_b64_tr_b16 v[92:93], v37 offset:4096
  buffer_load_dwordx4 v9, s[12:15], s56 offen offset:3072 lds
  v_accvgpr_write_b32 a203, v55
  v_accvgpr_read_b32 v112, a204
  v_accvgpr_read_b32 v113, a205
  v_mfma_f32_32x32x16_bf16 v[144:159], v[68:71], v[80:83], v[144:159]
  ds_read_b64_tr_b16 v[94:95], v37 offset:5120
  s_add_u32 s56, s52, 66304
  s_add_u32 m0, s53, 8192
  v_accvgpr_read_b32 v114, a206
  v_accvgpr_read_b32 v115, a207
  v_accvgpr_read_b32 v116, a236
  v_accvgpr_read_b32 v117, a237
  v_mfma_f32_32x32x16_bf16 v[208:223], v[68:71], v[84:87], v[208:223]
  ds_read_b64_tr_b16 v[96:97], v38 offset:4096
  buffer_load_dwordx4 v6, s[12:15], s56 offen offset:0 lds
  v_accvgpr_read_b32 v118, a238
  v_accvgpr_read_b32 v119, a239
  v_cvt_pk_bf16_f32 v120, v112, v113
  v_cvt_pk_bf16_f32 v121, v114, v115
  v_mfma_f32_32x32x16_bf16 v[160:175], v[72:75], v[80:83], v[160:175]
  ds_read_b64_tr_b16 v[98:99], v38 offset:5120
  ds_read_b64_tr_b16 v[100:101], v39 offset:4096
  buffer_load_dwordx4 v7, s[12:15], s56 offen offset:1024 lds
  v_cvt_pk_bf16_f32 v122, v116, v117
  v_cvt_pk_bf16_f32 v123, v118, v119
  v_accvgpr_write_b32 a204, v120
  v_mfma_f32_32x32x16_bf16 v[224:239], v[72:75], v[84:87], v[224:239]
  ds_read_b64_tr_b16 v[102:103], v39 offset:5120
  buffer_load_dwordx4 v8, s[12:15], s56 offen offset:2048 lds
  v_accvgpr_write_b32 a205, v121
  v_accvgpr_write_b32 a206, v122
  v_accvgpr_write_b32 a207, v123
  v_mfma_f32_32x32x16_bf16 v[176:191], v[76:79], v[80:83], v[176:191]
  ds_read_b128 v[104:107], v25 offset:0
  buffer_load_dwordx4 v9, s[12:15], s56 offen offset:3072 lds
  v_accvgpr_read_b32 v44, a208
  v_accvgpr_read_b32 v45, a209
  v_accvgpr_read_b32 v46, a210
  v_accvgpr_read_b32 v47, a211
  v_mfma_f32_32x32x16_bf16 v[240:255], v[76:79], v[84:87], v[240:255]
  ds_read_b128 v[108:111], v25 offset:16384
  s_add_u32 s56, s52, 99072
  s_add_u32 m0, s53, 12288
  v_accvgpr_read_b32 v48, a240
  v_accvgpr_read_b32 v49, a241
  v_accvgpr_read_b32 v50, a242
  s_waitcnt lgkmcnt(0)
  v_mfma_f32_32x32x16_bf16 v[128:143], v[88:91], v[104:107], v[128:143]
  ds_read_b64_tr_b16 v[64:65], v36 offset:8192
  ds_read_b64_tr_b16 v[66:67], v36 offset:9216
  buffer_load_dwordx4 v6, s[12:15], s56 offen offset:0 lds
  v_accvgpr_read_b32 v51, a243
  v_cvt_pk_bf16_f32 v52, v44, v45
  v_cvt_pk_bf16_f32 v53, v46, v47
  v_mfma_f32_32x32x16_bf16 v[192:207], v[88:91], v[108:111], v[192:207]
  ds_read_b64_tr_b16 v[68:69], v37 offset:8192
  buffer_load_dwordx4 v7, s[12:15], s56 offen offset:1024 lds
  v_cvt_pk_bf16_f32 v54, v48, v49
  v_cvt_pk_bf16_f32 v55, v50, v51
  v_accvgpr_write_b32 a208, v52
  v_mfma_f32_32x32x16_bf16 v[144:159], v[92:95], v[104:107], v[144:159]
  ds_read_b64_tr_b16 v[70:71], v37 offset:9216
  buffer_load_dwordx4 v8, s[12:15], s56 offen offset:2048 lds
  v_accvgpr_write_b32 a209, v53
  v_accvgpr_write_b32 a210, v54
  v_accvgpr_write_b32 a211, v55
  v_accvgpr_read_b32 v112, a212
  v_mfma_f32_32x32x16_bf16 v[208:223], v[92:95], v[108:111], v[208:223]
  ds_read_b64_tr_b16 v[72:73], v38 offset:8192
  buffer_load_dwordx4 v9, s[12:15], s56 offen offset:3072 lds
  v_accvgpr_read_b32 v113, a213
  v_accvgpr_read_b32 v114, a214
  v_accvgpr_read_b32 v115, a215
  v_mfma_f32_32x32x16_bf16 v[160:175], v[96:99], v[104:107], v[160:175]
  ds_read_b64_tr_b16 v[74:75], v38 offset:9216
  ds_read_b64_tr_b16 v[76:77], v39 offset:8192
  s_add_u32 s56, s54, 3145728
  s_add_u32 m0, s55, 32768
  v_accvgpr_read_b32 v116, a244
  v_accvgpr_read_b32 v117, a245
  v_accvgpr_read_b32 v118, a246
  v_accvgpr_read_b32 v119, a247
  v_mfma_f32_32x32x16_bf16 v[224:239], v[96:99], v[108:111], v[224:239]
  ds_read_b64_tr_b16 v[78:79], v39 offset:9216
  buffer_load_dwordx4 v10, s[68:71], s56 offen offset:0 lds
  v_cvt_pk_bf16_f32 v120, v112, v113
  v_cvt_pk_bf16_f32 v121, v114, v115
  v_cvt_pk_bf16_f32 v122, v116, v117
  v_mfma_f32_32x32x16_bf16 v[176:191], v[100:103], v[104:107], v[176:191]
  ds_read_b128 v[80:83], v26 offset:0
  buffer_load_dwordx4 v11, s[68:71], s56 offen offset:1024 lds
  v_cvt_pk_bf16_f32 v123, v118, v119
  v_accvgpr_write_b32 a212, v120
  v_accvgpr_write_b32 a213, v121
  v_accvgpr_write_b32 a214, v122
  v_mfma_f32_32x32x16_bf16 v[240:255], v[100:103], v[108:111], v[240:255]
  ds_read_b128 v[84:87], v26 offset:16384
  buffer_load_dwordx4 v12, s[68:71], s56 offen offset:2048 lds
  v_accvgpr_write_b32 a215, v123
  v_accvgpr_read_b32 v44, a216
  v_accvgpr_read_b32 v45, a217
  s_waitcnt lgkmcnt(0)
  v_mfma_f32_32x32x16_bf16 v[128:143], v[64:67], v[80:83], v[128:143]
  ds_read_b64_tr_b16 v[88:89], v36 offset:12288
  ds_read_b64_tr_b16 v[90:91], v36 offset:13312
  buffer_load_dwordx4 v13, s[68:71], s56 offen offset:3072 lds
  v_accvgpr_read_b32 v46, a218
  v_accvgpr_read_b32 v47, a219
  v_mfma_f32_32x32x16_bf16 v[192:207], v[64:67], v[84:87], v[192:207]
  ds_read_b64_tr_b16 v[92:93], v37 offset:12288
  s_add_u32 s56, s54, 3276800
  s_add_u32 m0, s55, 36864
  v_accvgpr_read_b32 v48, a248
  v_accvgpr_read_b32 v49, a249
  v_accvgpr_read_b32 v50, a250
  v_accvgpr_read_b32 v51, a251
  v_cvt_pk_bf16_f32 v52, v44, v45
  v_mfma_f32_32x32x16_bf16 v[144:159], v[68:71], v[80:83], v[144:159]
  ds_read_b64_tr_b16 v[94:95], v37 offset:13312
  buffer_load_dwordx4 v10, s[68:71], s56 offen offset:0 lds
  v_cvt_pk_bf16_f32 v53, v46, v47
  v_cvt_pk_bf16_f32 v54, v48, v49
  v_cvt_pk_bf16_f32 v55, v50, v51
  v_mfma_f32_32x32x16_bf16 v[208:223], v[68:71], v[84:87], v[208:223]
  ds_read_b64_tr_b16 v[96:97], v38 offset:12288
  buffer_load_dwordx4 v11, s[68:71], s56 offen offset:1024 lds
  v_accvgpr_write_b32 a216, v52
  v_accvgpr_write_b32 a217, v53
  v_accvgpr_write_b32 a218, v54
  v_accvgpr_write_b32 a219, v55
  v_mfma_f32_32x32x16_bf16 v[160:175], v[72:75], v[80:83], v[160:175]
  ds_read_b64_tr_b16 v[98:99], v38 offset:13312
  ds_read_b64_tr_b16 v[100:101], v39 offset:12288
  buffer_load_dwordx4 v12, s[68:71], s56 offen offset:2048 lds
  v_accvgpr_read_b32 v112, a220
  v_accvgpr_read_b32 v113, a221
  v_mfma_f32_32x32x16_bf16 v[224:239], v[72:75], v[84:87], v[224:239]
  ds_read_b64_tr_b16 v[102:103], v39 offset:13312
  buffer_load_dwordx4 v13, s[68:71], s56 offen offset:3072 lds
  v_accvgpr_read_b32 v114, a222
  v_accvgpr_read_b32 v115, a223
  v_accvgpr_read_b32 v116, a252
  v_accvgpr_read_b32 v117, a253
  v_mfma_f32_32x32x16_bf16 v[176:191], v[76:79], v[80:83], v[176:191]
  ds_read_b128 v[104:107], v27 offset:0
  v_accvgpr_read_b32 v118, a254
  v_accvgpr_read_b32 v119, a255
  v_cvt_pk_bf16_f32 v120, v112, v113
  v_cvt_pk_bf16_f32 v121, v114, v115
  v_cvt_pk_bf16_f32 v122, v116, v117
  v_cvt_pk_bf16_f32 v123, v118, v119
  v_mfma_f32_32x32x16_bf16 v[240:255], v[76:79], v[84:87], v[240:255]
  ds_read_b128 v[108:111], v27 offset:16384
  v_accvgpr_write_b32 a220, v120
  v_accvgpr_write_b32 a221, v121
  v_accvgpr_write_b32 a222, v122
  v_accvgpr_write_b32 a223, v123
  s_waitcnt vmcnt(24) lgkmcnt(0)
  s_barrier
  v_mfma_f32_32x32x16_bf16 v[128:143], v[88:91], v[104:107], v[128:143]
  ds_read_b64_tr_b16 v[64:65], v40 offset:0
  ds_read_b64_tr_b16 v[66:67], v40 offset:1024
  s_add_u32 s56, s52, 896
  s_add_u32 m0, s53, 131072
  v_mfma_f32_32x32x16_bf16 v[192:207], v[88:91], v[108:111], v[192:207]
  ds_read_b64_tr_b16 v[68:69], v41 offset:0
  buffer_load_dwordx4 v6, s[12:15], s56 offen offset:0 lds
  v_mfma_f32_32x32x16_bf16 v[144:159], v[92:95], v[104:107], v[144:159]
  ds_read_b64_tr_b16 v[70:71], v41 offset:1024
  buffer_load_dwordx4 v7, s[12:15], s56 offen offset:1024 lds
  v_mfma_f32_32x32x16_bf16 v[208:223], v[92:95], v[108:111], v[208:223]
  ds_read_b64_tr_b16 v[72:73], v42 offset:0
  buffer_load_dwordx4 v8, s[12:15], s56 offen offset:2048 lds
  v_mfma_f32_32x32x16_bf16 v[160:175], v[96:99], v[104:107], v[160:175]
  ds_read_b64_tr_b16 v[74:75], v42 offset:1024
  ds_read_b64_tr_b16 v[76:77], v43 offset:0
  buffer_load_dwordx4 v9, s[12:15], s56 offen offset:3072 lds
  v_mfma_f32_32x32x16_bf16 v[224:239], v[96:99], v[108:111], v[224:239]
  ds_read_b64_tr_b16 v[78:79], v43 offset:1024
  s_add_u32 s56, s52, 33664
  s_add_u32 m0, s53, 135168
  v_mfma_f32_32x32x16_bf16 v[176:191], v[100:103], v[104:107], v[176:191]
  ds_read_b128 v[80:83], v28 offset:0
  buffer_load_dwordx4 v6, s[12:15], s56 offen offset:0 lds
  v_mfma_f32_32x32x16_bf16 v[240:255], v[100:103], v[108:111], v[240:255]
  ds_read_b128 v[84:87], v28 offset:16384
  buffer_load_dwordx4 v7, s[12:15], s56 offen offset:1024 lds
  s_waitcnt lgkmcnt(0)
  v_mfma_f32_32x32x16_bf16 v[128:143], v[64:67], v[80:83], v[128:143]
  ds_read_b64_tr_b16 v[88:89], v40 offset:4096
  ds_read_b64_tr_b16 v[90:91], v40 offset:5120
  buffer_load_dwordx4 v8, s[12:15], s56 offen offset:2048 lds
  v_mfma_f32_32x32x16_bf16 v[192:207], v[64:67], v[84:87], v[192:207]
  ds_read_b64_tr_b16 v[92:93], v41 offset:4096
  buffer_load_dwordx4 v9, s[12:15], s56 offen offset:3072 lds
  v_mfma_f32_32x32x16_bf16 v[144:159], v[68:71], v[80:83], v[144:159]
  ds_read_b64_tr_b16 v[94:95], v41 offset:5120
  s_add_u32 s56, s52, 66432
  s_add_u32 m0, s53, 139264
  v_mfma_f32_32x32x16_bf16 v[208:223], v[68:71], v[84:87], v[208:223]
  ds_read_b64_tr_b16 v[96:97], v42 offset:4096
  buffer_load_dwordx4 v6, s[12:15], s56 offen offset:0 lds
  v_mfma_f32_32x32x16_bf16 v[160:175], v[72:75], v[80:83], v[160:175]
  ds_read_b64_tr_b16 v[98:99], v42 offset:5120
  ds_read_b64_tr_b16 v[100:101], v43 offset:4096
  buffer_load_dwordx4 v7, s[12:15], s56 offen offset:1024 lds
  v_mfma_f32_32x32x16_bf16 v[224:239], v[72:75], v[84:87], v[224:239]
  ds_read_b64_tr_b16 v[102:103], v43 offset:5120
  buffer_load_dwordx4 v8, s[12:15], s56 offen offset:2048 lds
  v_mfma_f32_32x32x16_bf16 v[176:191], v[76:79], v[80:83], v[176:191]
  ds_read_b128 v[104:107], v29 offset:0
  buffer_load_dwordx4 v9, s[12:15], s56 offen offset:3072 lds
  v_mfma_f32_32x32x16_bf16 v[240:255], v[76:79], v[84:87], v[240:255]
  ds_read_b128 v[108:111], v29 offset:16384
  s_add_u32 s56, s52, 99200
  s_add_u32 m0, s53, 143360
  s_waitcnt lgkmcnt(0)
  v_mfma_f32_32x32x16_bf16 v[128:143], v[88:91], v[104:107], v[128:143]
  ds_read_b64_tr_b16 v[64:65], v40 offset:8192
  ds_read_b64_tr_b16 v[66:67], v40 offset:9216
  buffer_load_dwordx4 v6, s[12:15], s56 offen offset:0 lds
  v_mfma_f32_32x32x16_bf16 v[192:207], v[88:91], v[108:111], v[192:207]
  ds_read_b64_tr_b16 v[68:69], v41 offset:8192
  buffer_load_dwordx4 v7, s[12:15], s56 offen offset:1024 lds
  v_mfma_f32_32x32x16_bf16 v[144:159], v[92:95], v[104:107], v[144:159]
  ds_read_b64_tr_b16 v[70:71], v41 offset:9216
  buffer_load_dwordx4 v8, s[12:15], s56 offen offset:2048 lds
  v_mfma_f32_32x32x16_bf16 v[208:223], v[92:95], v[108:111], v[208:223]
  ds_read_b64_tr_b16 v[72:73], v42 offset:8192
  buffer_load_dwordx4 v9, s[12:15], s56 offen offset:3072 lds
  v_mfma_f32_32x32x16_bf16 v[160:175], v[96:99], v[104:107], v[160:175]
  ds_read_b64_tr_b16 v[74:75], v42 offset:9216
  ds_read_b64_tr_b16 v[76:77], v43 offset:8192
  s_add_u32 s56, s54, 3670016
  s_add_u32 m0, s55, 49152
  v_mfma_f32_32x32x16_bf16 v[224:239], v[96:99], v[108:111], v[224:239]
  ds_read_b64_tr_b16 v[78:79], v43 offset:9216
  buffer_load_dwordx4 v10, s[68:71], s56 offen offset:0 lds
  v_mfma_f32_32x32x16_bf16 v[176:191], v[100:103], v[104:107], v[176:191]
  ds_read_b128 v[80:83], v30 offset:0
  buffer_load_dwordx4 v11, s[68:71], s56 offen offset:1024 lds
  v_mfma_f32_32x32x16_bf16 v[240:255], v[100:103], v[108:111], v[240:255]
  ds_read_b128 v[84:87], v30 offset:16384
  buffer_load_dwordx4 v12, s[68:71], s56 offen offset:2048 lds
  s_waitcnt lgkmcnt(0)
  v_mfma_f32_32x32x16_bf16 v[128:143], v[64:67], v[80:83], v[128:143]
  ds_read_b64_tr_b16 v[88:89], v40 offset:12288
  ds_read_b64_tr_b16 v[90:91], v40 offset:13312
  buffer_load_dwordx4 v13, s[68:71], s56 offen offset:3072 lds
  v_mfma_f32_32x32x16_bf16 v[192:207], v[64:67], v[84:87], v[192:207]
  ds_read_b64_tr_b16 v[92:93], v41 offset:12288
  s_add_u32 s56, s54, 3801088
  s_add_u32 m0, s55, 53248
  v_mfma_f32_32x32x16_bf16 v[144:159], v[68:71], v[80:83], v[144:159]
  ds_read_b64_tr_b16 v[94:95], v41 offset:13312
  buffer_load_dwordx4 v10, s[68:71], s56 offen offset:0 lds
  v_mfma_f32_32x32x16_bf16 v[208:223], v[68:71], v[84:87], v[208:223]
  ds_read_b64_tr_b16 v[96:97], v42 offset:12288
  buffer_load_dwordx4 v11, s[68:71], s56 offen offset:1024 lds
  v_mfma_f32_32x32x16_bf16 v[160:175], v[72:75], v[80:83], v[160:175]
  ds_read_b64_tr_b16 v[98:99], v42 offset:13312
  ds_read_b64_tr_b16 v[100:101], v43 offset:12288
  buffer_load_dwordx4 v12, s[68:71], s56 offen offset:2048 lds
  v_mfma_f32_32x32x16_bf16 v[224:239], v[72:75], v[84:87], v[224:239]
  ds_read_b64_tr_b16 v[102:103], v43 offset:13312
  buffer_load_dwordx4 v13, s[68:71], s56 offen offset:3072 lds
  v_mfma_f32_32x32x16_bf16 v[176:191], v[76:79], v[80:83], v[176:191]
  ds_read_b128 v[104:107], v31 offset:0
  v_mfma_f32_32x32x16_bf16 v[240:255], v[76:79], v[84:87], v[240:255]
  ds_read_b128 v[108:111], v31 offset:16384
  s_waitcnt vmcnt(24) lgkmcnt(0)
  s_barrier
  v_mfma_f32_32x32x16_bf16 v[128:143], v[88:91], v[104:107], v[128:143]
  ds_read_b64_tr_b16 v[64:65], v32 offset:0
  ds_read_b64_tr_b16 v[66:67], v32 offset:1024
  s_add_u32 s38, s57, 0
  v_mfma_f32_32x32x16_bf16 v[192:207], v[88:91], v[108:111], v[192:207]
  ds_read_b64_tr_b16 v[68:69], v33 offset:0
  buffer_store_dwordx4 a[0:3], v2, s[8:11], s38 offen sc1
  v_mfma_f32_32x32x16_bf16 v[144:159], v[92:95], v[104:107], v[144:159]
  ds_read_b64_tr_b16 v[70:71], v33 offset:1024
  s_add_u32 s38, s57, 1024
  v_mfma_f32_32x32x16_bf16 v[208:223], v[92:95], v[108:111], v[208:223]
  ds_read_b64_tr_b16 v[72:73], v34 offset:0
  buffer_store_dwordx4 a[4:7], v2, s[8:11], s38 offen sc1
  v_mfma_f32_32x32x16_bf16 v[160:175], v[96:99], v[104:107], v[160:175]
  ds_read_b64_tr_b16 v[74:75], v34 offset:1024
  ds_read_b64_tr_b16 v[76:77], v35 offset:0
  s_add_u32 s38, s57, 2048
  v_mfma_f32_32x32x16_bf16 v[224:239], v[96:99], v[108:111], v[224:239]
  ds_read_b64_tr_b16 v[78:79], v35 offset:1024
  buffer_store_dwordx4 a[8:11], v2, s[8:11], s38 offen sc1
  v_mfma_f32_32x32x16_bf16 v[176:191], v[100:103], v[104:107], v[176:191]
  ds_read_b128 v[80:83], v20 offset:0
  s_add_u32 s38, s57, 3072
  v_mfma_f32_32x32x16_bf16 v[240:255], v[100:103], v[108:111], v[240:255]
  ds_read_b128 v[84:87], v20 offset:16384
  buffer_store_dwordx4 a[12:15], v2, s[8:11], s38 offen sc1
  s_waitcnt lgkmcnt(0)
  v_mfma_f32_32x32x16_bf16 v[128:143], v[64:67], v[80:83], v[128:143]
  ds_read_b64_tr_b16 v[88:89], v32 offset:4096
  ds_read_b64_tr_b16 v[90:91], v32 offset:5120
  s_add_u32 s38, s57, 4096
  v_mfma_f32_32x32x16_bf16 v[192:207], v[64:67], v[84:87], v[192:207]
  ds_read_b64_tr_b16 v[92:93], v33 offset:4096
  buffer_store_dwordx4 a[16:19], v2, s[8:11], s38 offen sc1
  v_mfma_f32_32x32x16_bf16 v[144:159], v[68:71], v[80:83], v[144:159]
  ds_read_b64_tr_b16 v[94:95], v33 offset:5120
  s_add_u32 s38, s57, 5120
  v_mfma_f32_32x32x16_bf16 v[208:223], v[68:71], v[84:87], v[208:223]
  ds_read_b64_tr_b16 v[96:97], v34 offset:4096
  buffer_store_dwordx4 a[20:23], v2, s[8:11], s38 offen sc1
  v_mfma_f32_32x32x16_bf16 v[160:175], v[72:75], v[80:83], v[160:175]
  ds_read_b64_tr_b16 v[98:99], v34 offset:5120
  ds_read_b64_tr_b16 v[100:101], v35 offset:4096
  v_mfma_f32_32x32x16_bf16 v[224:239], v[72:75], v[84:87], v[224:239]
  ds_read_b64_tr_b16 v[102:103], v35 offset:5120
  s_add_u32 s38, s57, 6144
  v_mfma_f32_32x32x16_bf16 v[176:191], v[76:79], v[80:83], v[176:191]
  ds_read_b128 v[104:107], v21 offset:0
  buffer_store_dwordx4 a[24:27], v2, s[8:11], s38 offen sc1
  v_mfma_f32_32x32x16_bf16 v[240:255], v[76:79], v[84:87], v[240:255]
  ds_read_b128 v[108:111], v21 offset:16384
  s_add_u32 s38, s57, 7168
  s_waitcnt lgkmcnt(0)
  v_mfma_f32_32x32x16_bf16 v[128:143], v[88:91], v[104:107], v[128:143]
  ds_read_b64_tr_b16 v[64:65], v32 offset:8192
  ds_read_b64_tr_b16 v[66:67], v32 offset:9216
  s_mov_b32 s35, 0x100000
  s_lshl_b32 s39, s5, 12
  s_add_u32 s47, s39, 65536
  s_add_u32 s32, s39, 163840
  s_add_u32 s31, s39, 65536
  s_add_u32 s30, s39, 32768
  s_sub_u32 s28, 15, s4
  s_lshl_b32 s29, s28, 16
  v_add_u32 v5, s39, v2
  buffer_store_dwordx4 a[28:31], v2, s[8:11], s38 offen sc1
  v_mfma_f32_32x32x16_bf16 v[192:207], v[88:91], v[108:111], v[192:207]
  ds_read_b64_tr_b16 v[68:69], v33 offset:8192
  s_add_u32 s38, s57, 8192
  v_mfma_f32_32x32x16_bf16 v[144:159], v[92:95], v[104:107], v[144:159]
  ds_read_b64_tr_b16 v[70:71], v33 offset:9216
  buffer_store_dwordx4 a[64:67], v2, s[8:11], s38 offen sc1
  v_mfma_f32_32x32x16_bf16 v[208:223], v[92:95], v[108:111], v[208:223]
  ds_read_b64_tr_b16 v[72:73], v34 offset:8192
  s_add_u32 s38, s57, 9216
  v_mfma_f32_32x32x16_bf16 v[160:175], v[96:99], v[104:107], v[160:175]
  ds_read_b64_tr_b16 v[74:75], v34 offset:9216
  ds_read_b64_tr_b16 v[76:77], v35 offset:8192
  buffer_store_dwordx4 a[68:71], v2, s[8:11], s38 offen sc1
  v_mfma_f32_32x32x16_bf16 v[224:239], v[96:99], v[108:111], v[224:239]
  ds_read_b64_tr_b16 v[78:79], v35 offset:9216
  s_add_u32 s38, s57, 10240
  v_mfma_f32_32x32x16_bf16 v[176:191], v[100:103], v[104:107], v[176:191]
  ds_read_b128 v[80:83], v22 offset:0
  buffer_store_dwordx4 a[72:75], v2, s[8:11], s38 offen sc1
  v_mfma_f32_32x32x16_bf16 v[240:255], v[100:103], v[108:111], v[240:255]
  ds_read_b128 v[84:87], v22 offset:16384
  s_waitcnt lgkmcnt(0)
  v_mfma_f32_32x32x16_bf16 v[128:143], v[64:67], v[80:83], v[128:143]
  ds_read_b64_tr_b16 v[88:89], v32 offset:12288
  ds_read_b64_tr_b16 v[90:91], v32 offset:13312
  s_add_u32 s38, s57, 11264
  v_mfma_f32_32x32x16_bf16 v[192:207], v[64:67], v[84:87], v[192:207]
  ds_read_b64_tr_b16 v[92:93], v33 offset:12288
  buffer_store_dwordx4 a[76:79], v2, s[8:11], s38 offen sc1
  v_mfma_f32_32x32x16_bf16 v[144:159], v[68:71], v[80:83], v[144:159]
  ds_read_b64_tr_b16 v[94:95], v33 offset:13312
  s_add_u32 s38, s57, 12288
  v_mfma_f32_32x32x16_bf16 v[208:223], v[68:71], v[84:87], v[208:223]
  ds_read_b64_tr_b16 v[96:97], v34 offset:12288
  buffer_store_dwordx4 a[80:83], v2, s[8:11], s38 offen sc1
  v_mfma_f32_32x32x16_bf16 v[160:175], v[72:75], v[80:83], v[160:175]
  ds_read_b64_tr_b16 v[98:99], v34 offset:13312
  ds_read_b64_tr_b16 v[100:101], v35 offset:12288
  s_add_u32 s38, s57, 13312
  v_mfma_f32_32x32x16_bf16 v[224:239], v[72:75], v[84:87], v[224:239]
  ds_read_b64_tr_b16 v[102:103], v35 offset:13312
  buffer_store_dwordx4 a[84:87], v2, s[8:11], s38 offen sc1
  v_mfma_f32_32x32x16_bf16 v[176:191], v[76:79], v[80:83], v[176:191]
  ds_read_b128 v[104:107], v23 offset:0
  s_add_u32 s38, s57, 14336
  v_mfma_f32_32x32x16_bf16 v[240:255], v[76:79], v[84:87], v[240:255]
  ds_read_b128 v[108:111], v23 offset:16384
  buffer_store_dwordx4 a[88:91], v2, s[8:11], s38 offen sc1
  s_waitcnt vmcnt(15) lgkmcnt(0)
  s_barrier
  v_mfma_f32_32x32x16_bf16 v[128:143], v[88:91], v[104:107], v[128:143]
  ds_read_b64_tr_b16 v[64:65], v36 offset:0
  ds_read_b64_tr_b16 v[66:67], v36 offset:1024
  s_add_u32 s38, s57, 15360
  v_mfma_f32_32x32x16_bf16 v[192:207], v[88:91], v[108:111], v[192:207]
  ds_read_b64_tr_b16 v[68:69], v37 offset:0
  buffer_store_dwordx4 a[92:95], v2, s[8:11], s38 offen sc1
  v_mfma_f32_32x32x16_bf16 v[144:159], v[92:95], v[104:107], v[144:159]
  ds_read_b64_tr_b16 v[70:71], v37 offset:1024
  v_mfma_f32_32x32x16_bf16 v[208:223], v[92:95], v[108:111], v[208:223]
  ds_read_b64_tr_b16 v[72:73], v38 offset:0
  s_add_u32 s38, s57, 32768
  v_mfma_f32_32x32x16_bf16 v[160:175], v[96:99], v[104:107], v[160:175]
  ds_read_b64_tr_b16 v[74:75], v38 offset:1024
  ds_read_b64_tr_b16 v[76:77], v39 offset:0
  buffer_store_dwordx4 a[128:131], v2, s[8:11], s38 offen sc1
  v_mfma_f32_32x32x16_bf16 v[224:239], v[96:99], v[108:111], v[224:239]
  ds_read_b64_tr_b16 v[78:79], v39 offset:1024
  s_add_u32 s38, s57, 33792
  v_mfma_f32_32x32x16_bf16 v[176:191], v[100:103], v[104:107], v[176:191]
  ds_read_b128 v[80:83], v24 offset:0
  buffer_store_dwordx4 a[132:135], v2, s[8:11], s38 offen sc1
  v_mfma_f32_32x32x16_bf16 v[240:255], v[100:103], v[108:111], v[240:255]
  ds_read_b128 v[84:87], v24 offset:16384
  s_add_u32 s38, s57, 34816
  s_waitcnt lgkmcnt(0)
  v_mfma_f32_32x32x16_bf16 v[128:143], v[64:67], v[80:83], v[128:143]
  ds_read_b64_tr_b16 v[88:89], v36 offset:4096
  ds_read_b64_tr_b16 v[90:91], v36 offset:5120
  buffer_store_dwordx4 a[136:139], v2, s[8:11], s38 offen sc1
  s_lshl_b32 s39, s76, 15
  v_add_u32 v56, s39, v2
  ds_write_b128 v56, a[0:3] offset:0
  ds_write_b128 v56, a[4:7] offset:1024
  ds_write_b128 v56, a[8:11] offset:2048
  ds_write_b128 v56, a[12:15] offset:3072
  ds_write_b128 v56, a[16:19] offset:4096
  ds_write_b128 v56, a[20:23] offset:5120
  ds_write_b128 v56, a[24:27] offset:6144
  ds_write_b128 v56, a[28:31] offset:7168
  v_mfma_f32_32x32x16_bf16 v[192:207], v[64:67], v[84:87], v[192:207]
  ds_read_b64_tr_b16 v[92:93], v37 offset:4096
  s_add_u32 s38, s57, 35840
  v_mfma_f32_32x32x16_bf16 v[144:159], v[68:71], v[80:83], v[144:159]
  ds_read_b64_tr_b16 v[94:95], v37 offset:5120
  buffer_store_dwordx4 a[140:143], v2, s[8:11], s38 offen sc1
  v_mfma_f32_32x32x16_bf16 v[208:223], v[68:71], v[84:87], v[208:223]
  ds_read_b64_tr_b16 v[96:97], v38 offset:4096
  s_add_u32 s38, s57, 36864
  v_mfma_f32_32x32x16_bf16 v[160:175], v[72:75], v[80:83], v[160:175]
  ds_read_b64_tr_b16 v[98:99], v38 offset:5120
  ds_read_b64_tr_b16 v[100:101], v39 offset:4096
  buffer_store_dwordx4 a[144:147], v2, s[8:11], s38 offen sc1
  v_mfma_f32_32x32x16_bf16 v[224:239], v[72:75], v[84:87], v[224:239]
  ds_read_b64_tr_b16 v[102:103], v39 offset:5120
  s_add_u32 s38, s57, 37888
  v_mfma_f32_32x32x16_bf16 v[176:191], v[76:79], v[80:83], v[176:191]
  ds_read_b128 v[104:107], v25 offset:0
  buffer_store_dwordx4 a[148:151], v2, s[8:11], s38 offen sc1
  v_mfma_f32_32x32x16_bf16 v[240:255], v[76:79], v[84:87], v[240:255]
  ds_read_b128 v[108:111], v25 offset:16384
  s_waitcnt lgkmcnt(0)
  v_mfma_f32_32x32x16_bf16 v[128:143], v[88:91], v[104:107], v[128:143]
  ds_read_b64_tr_b16 v[64:65], v36 offset:8192
  ds_read_b64_tr_b16 v[66:67], v36 offset:9216
  s_add_u32 s38, s57, 38912
  v_mfma_f32_32x32x16_bf16 v[192:207], v[88:91], v[108:111], v[192:207]
  ds_read_b64_tr_b16 v[68:69], v37 offset:8192
  buffer_store_dwordx4 a[152:155], v2, s[8:11], s38 offen sc1
  v_mfma_f32_32x32x16_bf16 v[144:159], v[92:95], v[104:107], v[144:159]
  ds_read_b64_tr_b16 v[70:71], v37 offset:9216
  s_add_u32 s38, s57, 39936
  v_mfma_f32_32x32x16_bf16 v[208:223], v[92:95], v[108:111], v[208:223]
  ds_read_b64_tr_b16 v[72:73], v38 offset:8192
  buffer_store_dwordx4 a[156:159], v2, s[8:11], s38 offen sc1
  v_mfma_f32_32x32x16_bf16 v[160:175], v[96:99], v[104:107], v[160:175]
  ds_read_b64_tr_b16 v[74:75], v38 offset:9216
  ds_read_b64_tr_b16 v[76:77], v39 offset:8192
  s_add_u32 s38, s57, 40960
  v_mfma_f32_32x32x16_bf16 v[224:239], v[96:99], v[108:111], v[224:239]
  ds_read_b64_tr_b16 v[78:79], v39 offset:9216
  buffer_store_dwordx4 a[192:195], v2, s[8:11], s38 offen sc1
  v_mfma_f32_32x32x16_bf16 v[176:191], v[100:103], v[104:107], v[176:191]
  ds_read_b128 v[80:83], v26 offset:0
  s_add_u32 s38, s57, 41984
  v_mfma_f32_32x32x16_bf16 v[240:255], v[100:103], v[108:111], v[240:255]
  ds_read_b128 v[84:87], v26 offset:16384
  buffer_store_dwordx4 a[196:199], v2, s[8:11], s38 offen sc1
  s_waitcnt lgkmcnt(0)
  v_mfma_f32_32x32x16_bf16 v[128:143], v[64:67], v[80:83], v[128:143]
  ds_read_b64_tr_b16 v[88:89], v36 offset:12288
  ds_read_b64_tr_b16 v[90:91], v36 offset:13312
  s_add_u32 s38, s57, 43008
  ds_write_b128 v56, a[64:67] offset:8192
  ds_write_b128 v56, a[68:71] offset:9216
  ds_write_b128 v56, a[72:75] offset:10240
  ds_write_b128 v56, a[76:79] offset:11264
  ds_write_b128 v56, a[80:83] offset:12288
  ds_write_b128 v56, a[84:87] offset:13312
  ds_write_b128 v56, a[88:91] offset:14336
  ds_write_b128 v56, a[92:95] offset:15360
  v_mfma_f32_32x32x16_bf16 v[192:207], v[64:67], v[84:87], v[192:207]
  ds_read_b64_tr_b16 v[92:93], v37 offset:12288
  buffer_store_dwordx4 a[200:203], v2, s[8:11], s38 offen sc1
  v_mfma_f32_32x32x16_bf16 v[144:159], v[68:71], v[80:83], v[144:159]
  ds_read_b64_tr_b16 v[94:95], v37 offset:13312
  v_mfma_f32_32x32x16_bf16 v[208:223], v[68:71], v[84:87], v[208:223]
  ds_read_b64_tr_b16 v[96:97], v38 offset:12288
  s_add_u32 s38, s57, 44032
  v_mfma_f32_32x32x16_bf16 v[160:175], v[72:75], v[80:83], v[160:175]
  ds_read_b64_tr_b16 v[98:99], v38 offset:13312
  ds_read_b64_tr_b16 v[100:101], v39 offset:12288
  buffer_store_dwordx4 a[204:207], v2, s[8:11], s38 offen sc1
  v_mfma_f32_32x32x16_bf16 v[224:239], v[72:75], v[84:87], v[224:239]
  ds_read_b64_tr_b16 v[102:103], v39 offset:13312
  s_add_u32 s38, s57, 45056
  v_mfma_f32_32x32x16_bf16 v[176:191], v[76:79], v[80:83], v[176:191]
  ds_read_b128 v[104:107], v27 offset:0
  buffer_store_dwordx4 a[208:211], v2, s[8:11], s38 offen sc1
  v_mfma_f32_32x32x16_bf16 v[240:255], v[76:79], v[84:87], v[240:255]
  ds_read_b128 v[108:111], v27 offset:16384
  s_add_u32 s38, s57, 46080
  s_waitcnt lgkmcnt(0)
  s_barrier
  v_mfma_f32_32x32x16_bf16 v[128:143], v[88:91], v[104:107], v[128:143]
  buffer_store_dwordx4 a[212:215], v2, s[8:11], s38 offen sc1
  v_mfma_f32_32x32x16_bf16 v[192:207], v[88:91], v[108:111], v[192:207]
  s_add_u32 s38, s57, 47104
  ds_write_b128 v56, a[128:131] offset:16384
  ds_write_b128 v56, a[132:135] offset:17408
  ds_write_b128 v56, a[136:139] offset:18432
  ds_write_b128 v56, a[140:143] offset:19456
  ds_write_b128 v56, a[144:147] offset:20480
  ds_write_b128 v56, a[148:151] offset:21504
  ds_write_b128 v56, a[152:155] offset:22528
  ds_write_b128 v56, a[156:159] offset:23552
  v_mfma_f32_32x32x16_bf16 v[144:159], v[92:95], v[104:107], v[144:159]
  buffer_store_dwordx4 a[216:219], v2, s[8:11], s38 offen sc1
  v_mfma_f32_32x32x16_bf16 v[208:223], v[92:95], v[108:111], v[208:223]
  s_add_u32 s38, s57, 48128
  v_mfma_f32_32x32x16_bf16 v[160:175], v[96:99], v[104:107], v[160:175]
  buffer_store_dwordx4 a[220:223], v2, s[8:11], s38 offen sc1
  v_mfma_f32_32x32x16_bf16 v[224:239], v[96:99], v[108:111], v[224:239]
  ds_write_b128 v56, a[192:195] offset:24576
  ds_write_b128 v56, a[196:199] offset:25600
  ds_write_b128 v56, a[200:203] offset:26624
  ds_write_b128 v56, a[204:207] offset:27648
  ds_write_b128 v56, a[208:211] offset:28672
  ds_write_b128 v56, a[212:215] offset:29696
  ds_write_b128 v56, a[216:219] offset:30720
  ds_write_b128 v56, a[220:223] offset:31744
  v_mfma_f32_32x32x16_bf16 v[176:191], v[100:103], v[104:107], v[176:191]
  v_mfma_f32_32x32x16_bf16 v[240:255], v[100:103], v[108:111], v[240:255]
  s_load_dwordx2 s[48:49], s[0:1], 112
  s_load_dwordx2 s[66:67], s[0:1], 0
  s_load_dwordx4 s[68:71], s[0:1], 64
  s_load_dwordx2 s[72:73], s[0:1], 80
  s_waitcnt lgkmcnt(0)
  s_mov_b32 s38, 0x3e0293ee
  v_mov_b32 v56, s38
  s_nop 7
  v_cvt_pk_bf16_f32 v128, v128, v129
  v_cvt_pk_bf16_f32 v129, v130, v131
  v_cvt_pk_bf16_f32 v130, v132, v133
  v_cvt_pk_bf16_f32 v131, v134, v135
  v_cvt_pk_bf16_f32 v132, v136, v137
  v_cvt_pk_bf16_f32 v133, v138, v139
  v_cvt_pk_bf16_f32 v134, v140, v141
  v_cvt_pk_bf16_f32 v135, v142, v143
  s_nop 1
  v_permlane32_swap_b32 v128, v130
  v_permlane32_swap_b32 v129, v131
  v_permlane32_swap_b32 v132, v134
  v_permlane32_swap_b32 v133, v135
  v_permlane16_swap_b32 v128, v130
  v_permlane16_swap_b32 v129, v131
  v_permlane16_swap_b32 v132, v134
  v_permlane16_swap_b32 v133, v135
  v_accvgpr_write_b32 a128, v128
  v_accvgpr_write_b32 a129, v129
  v_accvgpr_write_b32 a130, v132
  v_accvgpr_write_b32 a131, v133
  v_accvgpr_write_b32 a144, v130
  v_accvgpr_write_b32 a145, v131
  v_accvgpr_write_b32 a146, v134
  v_accvgpr_write_b32 a147, v135
  v_cvt_pk_bf16_f32 v144, v144, v145
  v_cvt_pk_bf16_f32 v145, v146, v147
  v_cvt_pk_bf16_f32 v146, v148, v149
  v_cvt_pk_bf16_f32 v147, v150, v151
  v_cvt_pk_bf16_f32 v148, v152, v153
  v_cvt_pk_bf16_f32 v149, v154, v155
  v_cvt_pk_bf16_f32 v150, v156, v157
  v_cvt_pk_bf16_f32 v151, v158, v159
  s_nop 1
  v_permlane32_swap_b32 v144, v146
  v_permlane32_swap_b32 v145, v147
  v_permlane32_swap_b32 v148, v150
  v_permlane32_swap_b32 v149, v151
  v_permlane16_swap_b32 v144, v146
  v_permlane16_swap_b32 v145, v147
  v_permlane16_swap_b32 v148, v150
  v_permlane16_swap_b32 v149, v151
  v_accvgpr_write_b32 a132, v144
  v_accvgpr_write_b32 a133, v145
  v_accvgpr_write_b32 a134, v148
  v_accvgpr_write_b32 a135, v149
  v_accvgpr_write_b32 a148, v146
  v_accvgpr_write_b32 a149, v147
  v_accvgpr_write_b32 a150, v150
  v_accvgpr_write_b32 a151, v151
  v_cvt_pk_bf16_f32 v160, v160, v161
  v_cvt_pk_bf16_f32 v161, v162, v163
  v_cvt_pk_bf16_f32 v162, v164, v165
  v_cvt_pk_bf16_f32 v163, v166, v167
  v_cvt_pk_bf16_f32 v164, v168, v169
  v_cvt_pk_bf16_f32 v165, v170, v171
  v_cvt_pk_bf16_f32 v166, v172, v173
  v_cvt_pk_bf16_f32 v167, v174, v175
  s_nop 1
  v_permlane32_swap_b32 v160, v162
  v_permlane32_swap_b32 v161, v163
  v_permlane32_swap_b32 v164, v166
  v_permlane32_swap_b32 v165, v167
  v_permlane16_swap_b32 v160, v162
  v_permlane16_swap_b32 v161, v163
  v_permlane16_swap_b32 v164, v166
  v_permlane16_swap_b32 v165, v167
  v_accvgpr_write_b32 a136, v160
  v_accvgpr_write_b32 a137, v161
  v_accvgpr_write_b32 a138, v164
  v_accvgpr_write_b32 a139, v165
  v_accvgpr_write_b32 a152, v162
  v_accvgpr_write_b32 a153, v163
  v_accvgpr_write_b32 a154, v166
  v_accvgpr_write_b32 a155, v167
  v_cvt_pk_bf16_f32 v176, v176, v177
  v_cvt_pk_bf16_f32 v177, v178, v179
  v_cvt_pk_bf16_f32 v178, v180, v181
  v_cvt_pk_bf16_f32 v179, v182, v183
  v_cvt_pk_bf16_f32 v180, v184, v185
  v_cvt_pk_bf16_f32 v181, v186, v187
  v_cvt_pk_bf16_f32 v182, v188, v189
  v_cvt_pk_bf16_f32 v183, v190, v191
  s_nop 1
  v_permlane32_swap_b32 v176, v178
  v_permlane32_swap_b32 v177, v179
  v_permlane32_swap_b32 v180, v182
  v_permlane32_swap_b32 v181, v183
  v_permlane16_swap_b32 v176, v178
  v_permlane16_swap_b32 v177, v179
  v_permlane16_swap_b32 v180, v182
  v_permlane16_swap_b32 v181, v183
  v_accvgpr_write_b32 a140, v176
  v_accvgpr_write_b32 a141, v177
  v_accvgpr_write_b32 a142, v180
  v_accvgpr_write_b32 a143, v181
  v_accvgpr_write_b32 a156, v178
  v_accvgpr_write_b32 a157, v179
  v_accvgpr_write_b32 a158, v182
  v_accvgpr_write_b32 a159, v183
  v_cvt_pk_bf16_f32 v192, v192, v193
  v_cvt_pk_bf16_f32 v193, v194, v195
  v_cvt_pk_bf16_f32 v194, v196, v197
  v_cvt_pk_bf16_f32 v195, v198, v199
  v_cvt_pk_bf16_f32 v196, v200, v201
  v_cvt_pk_bf16_f32 v197, v202, v203
  v_cvt_pk_bf16_f32 v198, v204, v205
  v_cvt_pk_bf16_f32 v199, v206, v207
  s_nop 1
  v_permlane32_swap_b32 v192, v194
  v_permlane32_swap_b32 v193, v195
  v_permlane32_swap_b32 v196, v198
  v_permlane32_swap_b32 v197, v199
  v_permlane16_swap_b32 v192, v194
  v_permlane16_swap_b32 v193, v195
  v_permlane16_swap_b32 v196, v198
  v_permlane16_swap_b32 v197, v199
  v_accvgpr_write_b32 a160, v192
  v_accvgpr_write_b32 a161, v193
  v_accvgpr_write_b32 a162, v196
  v_accvgpr_write_b32 a163, v197
  v_accvgpr_write_b32 a176, v194
  v_accvgpr_write_b32 a177, v195
  v_accvgpr_write_b32 a178, v198
  v_accvgpr_write_b32 a179, v199
  v_cvt_pk_bf16_f32 v208, v208, v209
  v_cvt_pk_bf16_f32 v209, v210, v211
  v_cvt_pk_bf16_f32 v210, v212, v213
  v_cvt_pk_bf16_f32 v211, v214, v215
  v_cvt_pk_bf16_f32 v212, v216, v217
  v_cvt_pk_bf16_f32 v213, v218, v219
  v_cvt_pk_bf16_f32 v214, v220, v221
  v_cvt_pk_bf16_f32 v215, v222, v223
  s_nop 1
  v_permlane32_swap_b32 v208, v210
  v_permlane32_swap_b32 v209, v211
  v_permlane32_swap_b32 v212, v214
  v_permlane32_swap_b32 v213, v215
  v_permlane16_swap_b32 v208, v210
  v_permlane16_swap_b32 v209, v211
  v_permlane16_swap_b32 v212, v214
  v_permlane16_swap_b32 v213, v215
  v_accvgpr_write_b32 a164, v208
  v_accvgpr_write_b32 a165, v209
  v_accvgpr_write_b32 a166, v212
  v_accvgpr_write_b32 a167, v213
  v_accvgpr_write_b32 a180, v210
  v_accvgpr_write_b32 a181, v211
  v_accvgpr_write_b32 a182, v214
  v_accvgpr_write_b32 a183, v215
  v_cvt_pk_bf16_f32 v224, v224, v225
  v_cvt_pk_bf16_f32 v225, v226, v227
  v_cvt_pk_bf16_f32 v226, v228, v229
  v_cvt_pk_bf16_f32 v227, v230, v231
  v_cvt_pk_bf16_f32 v228, v232, v233
  v_cvt_pk_bf16_f32 v229, v234, v235
  v_cvt_pk_bf16_f32 v230, v236, v237
  v_cvt_pk_bf16_f32 v231, v238, v239
  s_nop 1
  v_permlane32_swap_b32 v224, v226
  v_permlane32_swap_b32 v225, v227
  v_permlane32_swap_b32 v228, v230
  v_permlane32_swap_b32 v229, v231
  v_permlane16_swap_b32 v224, v226
  v_permlane16_swap_b32 v225, v227
  v_permlane16_swap_b32 v228, v230
  v_permlane16_swap_b32 v229, v231
  v_accvgpr_write_b32 a168, v224
  v_accvgpr_write_b32 a169, v225
  v_accvgpr_write_b32 a170, v228
  v_accvgpr_write_b32 a171, v229
  v_accvgpr_write_b32 a184, v226
  v_accvgpr_write_b32 a185, v227
  v_accvgpr_write_b32 a186, v230
  v_accvgpr_write_b32 a187, v231
  v_cvt_pk_bf16_f32 v240, v240, v241
  v_cvt_pk_bf16_f32 v241, v242, v243
  v_cvt_pk_bf16_f32 v242, v244, v245
  v_cvt_pk_bf16_f32 v243, v246, v247
  v_cvt_pk_bf16_f32 v244, v248, v249
  v_cvt_pk_bf16_f32 v245, v250, v251
  v_cvt_pk_bf16_f32 v246, v252, v253
  v_cvt_pk_bf16_f32 v247, v254, v255
  s_nop 1
  v_permlane32_swap_b32 v240, v242
  v_permlane32_swap_b32 v241, v243
  v_permlane32_swap_b32 v244, v246
  v_permlane32_swap_b32 v245, v247
  v_permlane16_swap_b32 v240, v242
  v_permlane16_swap_b32 v241, v243
  v_permlane16_swap_b32 v244, v246
  v_permlane16_swap_b32 v245, v247
  v_accvgpr_write_b32 a172, v240
  v_accvgpr_write_b32 a173, v241
  v_accvgpr_write_b32 a174, v244
  v_accvgpr_write_b32 a175, v245
  v_accvgpr_write_b32 a188, v242
  v_accvgpr_write_b32 a189, v243
  v_accvgpr_write_b32 a190, v246
  v_accvgpr_write_b32 a191, v247
  v_mov_b32 v8, 0xff800000
  s_mov_b32 s36, 0x4e800000
  v_mov_b32 v32, 0
  v_mov_b32 v33, 0
  v_mov_b32 v34, 0
  v_mov_b32 v35, 0
  v_mov_b32 v36, 0
  v_mov_b32 v37, 0
  v_mov_b32 v38, 0
  v_mov_b32 v39, 0
  v_mov_b32 v40, 0
  v_mov_b32 v41, 0
  v_mov_b32 v42, 0
  v_mov_b32 v43, 0
  v_mov_b32 v44, 0
  v_mov_b32 v45, 0
  v_mov_b32 v46, 0
  v_mov_b32 v47, 0
  v_mov_b32 v60, 0x3f803f80
  v_mov_b32 v61, 0x3f803f80
  v_mov_b32 v62, 0x3f803f80
  v_mov_b32 v63, 0x3f803f80
  v_and_b32 v6, 15, v1
  v_lshrrev_b32 v56, 4, v1
  v_lshlrev_b32 v56, 2, v56
  v_sub_u32 v6, v6, v56
  s_lshl_b32 s38, s5, 5
  v_add_u32 v6, s38, v6
  v_subrev_u32 v7, 64, v6
  v_add_u32 v9, 16, v6
  v_subrev_u32 v10, 64, v9
  v_mov_b32 v48, 0
  v_mov_b32 v49, 0
  v_mov_b32 v50, 0
  v_mov_b32 v51, 0
  s_nop 1
  v_mfma_f32_32x32x16_bf16 a[0:15], v[48:51], v[48:51], 0
  v_mfma_f32_32x32x16_bf16 a[16:31], v[48:51], v[48:51], 0
  v_mfma_f32_32x32x16_bf16 a[32:47], v[48:51], v[48:51], 0
  v_mfma_f32_32x32x16_bf16 a[48:63], v[48:51], v[48:51], 0
  v_mfma_f32_32x32x16_bf16 a[64:79], v[48:51], v[48:51], 0
  v_mfma_f32_32x32x16_bf16 a[80:95], v[48:51], v[48:51], 0
  v_mfma_f32_32x32x16_bf16 a[96:111], v[48:51], v[48:51], 0
  v_mfma_f32_32x32x16_bf16 a[112:127], v[48:51], v[48:51], 0
  s_waitcnt lgkmcnt(0)
  s_barrier
  v_add_u32 v57, 98304, v2
  v_add_u32 v3, 65536, v2
  ds_read_b128 a[192:195], v3 offset:0
  ds_read_b128 a[196:199], v3 offset:1024
  ds_read_b128 a[200:203], v3 offset:2048
  ds_read_b128 a[204:207], v3 offset:3072
  ds_read_b128 a[224:227], v57 offset:0
  ds_read_b128 a[228:231], v57 offset:1024
  ds_read_b128 a[232:235], v57 offset:2048
  ds_read_b128 a[236:239], v57 offset:3072
  s_add_u32 s16, s48, 0x3000000
  s_addc_u32 s17, s49, 0
  s_mov_b32 s18, 0x1000000
  s_mov_b32 s19, 0x20000
  s_sub_u32 s60, 15, s4
  s_lshl_b32 s60, s60, 16
  s_lshl_b32 s61, s4, 1
  s_sub_u32 s61, s61, 14
  s_lshl_b32 s61, s61, 16
  s_lshl_b32 s28, s4, 16
  s_sub_u32 s29, s28, 65536
  s_cmp_lt_i32 s29, 0
  s_cselect_b32 s62, s60, 0
  s_add_u32 s29, s29, s62
  s_waitcnt vmcnt(0)
  s_lshl_b32 s56, s2, 7
  s_add_u32 s56, s56, 131072
  s_lshl_b32 s58, s76, 2
  s_add_u32 s56, s56, s58
  s_add_u32 s56, s56, 4
  v_mov_b32 v56, 1
  v_mov_b32 v57, 0
  v_cmp_eq_u32 vcc, 0, v1
  s_and_saveexec_b64 s[40:41], vcc
  buffer_store_dword v56, v57, s[20:23], s56 offen sc1
  s_mov_b64 exec, s[40:41]
  s_waitcnt lgkmcnt(0)
  v_mfma_f32_16x16x32_bf16 v[160:163], a[192:195], a[128:131], 0
  v_mfma_f32_16x16x32_bf16 v[160:163], a[196:199], a[132:135], v[160:163]
  v_mfma_f32_16x16x32_bf16 v[160:163], a[200:203], a[136:139], v[160:163]
  v_mfma_f32_16x16x32_bf16 v[160:163], a[204:207], a[140:143], v[160:163]
  v_mfma_f32_16x16x32_bf16 v[164:167], a[192:195], a[144:147], 0
  v_mfma_f32_16x16x32_bf16 v[164:167], a[196:199], a[148:151], v[164:167]
  v_mfma_f32_16x16x32_bf16 v[164:167], a[200:203], a[152:155], v[164:167]
  v_mfma_f32_16x16x32_bf16 v[164:167], a[204:207], a[156:159], v[164:167]
  v_mfma_f32_16x16x32_bf16 v[176:179], a[224:227], a[160:163], 0
  v_mfma_f32_16x16x32_bf16 v[176:179], a[228:231], a[164:167], v[176:179]
  v_mfma_f32_16x16x32_bf16 v[176:179], a[232:235], a[168:171], v[176:179]
  v_mfma_f32_16x16x32_bf16 v[176:179], a[236:239], a[172:175], v[176:179]
  v_mfma_f32_16x16x32_bf16 v[180:183], a[224:227], a[176:179], 0
  v_mfma_f32_16x16x32_bf16 v[180:183], a[228:231], a[180:183], v[180:183]
  v_mfma_f32_16x16x32_bf16 v[180:183], a[232:235], a[184:187], v[180:183]
  v_mfma_f32_16x16x32_bf16 v[180:183], a[236:239], a[188:191], v[180:183]
  s_nop 7
  v_cmp_gt_i32_e64 s[40:41], 0, v6
  v_cmp_gt_i32_e64 s[42:43], 1, v6
  v_cmp_gt_i32_e64 s[44:45], 2, v6
  v_cndmask_b32_e64 v160, v160, v8, s[40:41]
  v_cndmask_b32_e64 v161, v161, v8, s[42:43]
  v_cndmask_b32_e64 v162, v162, v8, s[44:45]
  v_cmp_gt_i32_e64 s[40:41], 3, v6
  s_nop 1
  v_cndmask_b32_e64 v163, v163, v8, s[40:41]
  v_max_f32 v56, v160, v161
  v_max3_f32 v56, v56, v162, v163
  v_mov_b32 v57, v56
  s_nop 1
  v_permlane32_swap_b32 v56, v57
  s_nop 1
  v_max_f32 v56, v56, v57
  v_mov_b32 v57, v56
  s_nop 1
  v_permlane16_swap_b32 v56, v57
  s_nop 1
  v_max_f32 v56, v56, v57
  v_sub_f32 v16, 0, v56
  v_sub_f32 v17, 0, v56
  v_sub_f32 v18, 0, v56
  v_sub_f32 v19, 0, v56
  v_cmp_gt_i32_e64 s[40:41], 0, v9
  v_cmp_gt_i32_e64 s[42:43], 1, v9
  v_cmp_gt_i32_e64 s[44:45], 2, v9
  v_cndmask_b32_e64 v164, v164, v8, s[40:41]
  v_cndmask_b32_e64 v165, v165, v8, s[42:43]
  v_cndmask_b32_e64 v166, v166, v8, s[44:45]
  v_cmp_gt_i32_e64 s[40:41], 3, v9
  s_nop 1
  v_cndmask_b32_e64 v167, v167, v8, s[40:41]
  v_max_f32 v56, v164, v165
  v_max3_f32 v56, v56, v166, v167
  v_mov_b32 v57, v56
  s_nop 1
  v_permlane32_swap_b32 v56, v57
  s_nop 1
  v_max_f32 v56, v56, v57
  v_mov_b32 v57, v56
  s_nop 1
  v_permlane16_swap_b32 v56, v57
  s_nop 1
  v_max_f32 v56, v56, v57
  v_sub_f32 v20, 0, v56
  v_sub_f32 v21, 0, v56
  v_sub_f32 v22, 0, v56
  v_sub_f32 v23, 0, v56
  v_add_u32 v3, 65536, v2
  ds_read_b128 a[192:195], v3 offset:0
  ds_read_b128 a[196:199], v3 offset:1024
  ds_read_b128 a[200:203], v3 offset:2048
  ds_read_b128 a[204:207], v3 offset:3072
  ds_read_b128 a[208:211], v3 offset:4096
  ds_read_b128 a[212:215], v3 offset:5120
  ds_read_b128 a[216:219], v3 offset:6144
  ds_read_b128 a[220:223], v3 offset:7168
  s_mov_b32 s33, 98304
  s_mov_b32 s34, 0
  s_waitcnt lgkmcnt(4)
  v_mfma_f32_16x16x32_bf16 v[64:67], a[192:195], a[128:131], v[16:19]
  ds_read_b128 a[224:227], v3 offset:8192
  v_mfma_f32_16x16x32_bf16 v[96:99], a[192:195], a[144:147], v[20:23]
  v_mfma_f32_16x16x32_bf16 v[64:67], a[196:199], a[132:135], v[64:67]
  ds_read_b128 a[228:231], v3 offset:9216
  v_mfma_f32_16x16x32_bf16 v[96:99], a[196:199], a[148:151], v[96:99]
  v_mfma_f32_16x16x32_bf16 v[64:67], a[200:203], a[136:139], v[64:67]
  ds_read_b128 a[232:235], v3 offset:10240
  v_mfma_f32_16x16x32_bf16 v[96:99], a[200:203], a[152:155], v[96:99]
  v_mfma_f32_16x16x32_bf16 v[64:67], a[204:207], a[140:143], v[64:67]
  ds_read_b128 a[236:239], v3 offset:11264
  v_cmp_gt_i32_e64 s[40:41], 0, v6
  v_cmp_gt_i32_e64 s[42:43], 1, v6
  v_cmp_gt_i32_e64 s[44:45], 2, v6
  v_cndmask_b32_e64 v176, v176, v8, s[40:41]
  v_cndmask_b32_e64 v177, v177, v8, s[42:43]
  v_cndmask_b32_e64 v178, v178, v8, s[44:45]
  v_cmp_gt_i32_e64 s[40:41], 3, v6
  s_nop 1
  v_cndmask_b32_e64 v179, v179, v8, s[40:41]
  v_mfma_f32_16x16x32_bf16 v[96:99], a[204:207], a[156:159], v[96:99]
  s_waitcnt lgkmcnt(4)
  v_mfma_f32_16x16x32_bf16 v[68:71], a[208:211], a[128:131], v[16:19]
  ds_read_b128 a[240:243], v3 offset:12288
  v_mfma_f32_16x16x32_bf16 v[100:103], a[208:211], a[144:147], v[20:23]
  v_mfma_f32_16x16x32_bf16 v[68:71], a[212:215], a[132:135], v[68:71]
  ds_read_b128 a[244:247], v3 offset:13312
  v_mfma_f32_16x16x32_bf16 v[100:103], a[212:215], a[148:151], v[100:103]
  v_mfma_f32_16x16x32_bf16 v[68:71], a[216:219], a[136:139], v[68:71]
  ds_read_b128 a[248:251], v3 offset:14336
  v_max_f32 v58, v176, v177
  v_mfma_f32_16x16x32_bf16 v[100:103], a[216:219], a[152:155], v[100:103]
  v_max3_f32 v58, v58, v178, v179
  v_mfma_f32_16x16x32_bf16 v[68:71], a[220:223], a[140:143], v[68:71]
  ds_read_b128 a[252:255], v3 offset:15360
  v_mfma_f32_16x16x32_bf16 v[100:103], a[220:223], a[156:159], v[100:103]
  s_waitcnt lgkmcnt(4)
  v_mfma_f32_16x16x32_bf16 v[72:75], a[224:227], a[128:131], v[16:19]
  ds_read_b128 a[192:195], v3 offset:16384
  v_mfma_f32_16x16x32_bf16 v[104:107], a[224:227], a[144:147], v[20:23]
  v_mfma_f32_16x16x32_bf16 v[72:75], a[228:231], a[132:135], v[72:75]
  ds_read_b128 a[196:199], v3 offset:17408
  v_mfma_f32_16x16x32_bf16 v[104:107], a[228:231], a[148:151], v[104:107]
  v_mfma_f32_16x16x32_bf16 v[72:75], a[232:235], a[136:139], v[72:75]
  ds_read_b128 a[200:203], v3 offset:18432
  v_mfma_f32_16x16x32_bf16 v[104:107], a[232:235], a[152:155], v[104:107]
  v_mov_b32 v59, v58
  s_nop 1
  v_permlane32_swap_b32 v58, v59
  s_nop 1
  v_max_f32 v58, v58, v59
  v_mov_b32 v59, v58
  s_nop 1
  v_permlane16_swap_b32 v58, v59
  s_nop 1
  v_max_f32 v58, v58, v59
  v_mfma_f32_16x16x32_bf16 v[72:75], a[236:239], a[140:143], v[72:75]
  ds_read_b128 a[204:207], v3 offset:19456
  v_mfma_f32_16x16x32_bf16 v[104:107], a[236:239], a[156:159], v[104:107]
  s_waitcnt lgkmcnt(4)
  v_mfma_f32_16x16x32_bf16 v[76:79], a[240:243], a[128:131], v[16:19]
  ds_read_b128 a[208:211], v3 offset:20480
  v_mfma_f32_16x16x32_bf16 v[108:111], a[240:243], a[144:147], v[20:23]
  v_mfma_f32_16x16x32_bf16 v[76:79], a[244:247], a[132:135], v[76:79]
  ds_read_b128 a[212:215], v3 offset:21504
  v_mfma_f32_16x16x32_bf16 v[108:111], a[244:247], a[148:151], v[108:111]
  v_mfma_f32_16x16x32_bf16 v[76:79], a[248:251], a[136:139], v[76:79]
  ds_read_b128 a[216:219], v3 offset:22528
  v_mfma_f32_16x16x32_bf16 v[108:111], a[248:251], a[152:155], v[108:111]
  v_sub_f32 v24, 0, v58
  v_mfma_f32_16x16x32_bf16 v[76:79], a[252:255], a[140:143], v[76:79]
  ds_read_b128 a[220:223], v3 offset:23552
  v_mfma_f32_16x16x32_bf16 v[108:111], a[252:255], a[156:159], v[108:111]
  s_waitcnt lgkmcnt(4)
  v_sub_f32 v25, 0, v58
  v_mfma_f32_16x16x32_bf16 v[80:83], a[192:195], a[128:131], v[16:19]
  ds_read_b128 a[224:227], v3 offset:24576
  v_sub_f32 v26, 0, v58
  v_mfma_f32_16x16x32_bf16 v[112:115], a[192:195], a[144:147], v[20:23]
  v_sub_f32 v27, 0, v58
  v_mfma_f32_16x16x32_bf16 v[80:83], a[196:199], a[132:135], v[80:83]
  ds_read_b128 a[228:231], v3 offset:25600
  v_mfma_f32_16x16x32_bf16 v[112:115], a[196:199], a[148:151], v[112:115]
  v_mfma_f32_16x16x32_bf16 v[80:83], a[200:203], a[136:139], v[80:83]
  ds_read_b128 a[232:235], v3 offset:26624
  v_mfma_f32_16x16x32_bf16 v[112:115], a[200:203], a[152:155], v[112:115]
  v_mfma_f32_16x16x32_bf16 v[80:83], a[204:207], a[140:143], v[80:83]
  ds_read_b128 a[236:239], v3 offset:27648
  v_mfma_f32_16x16x32_bf16 v[112:115], a[204:207], a[156:159], v[112:115]
  s_waitcnt lgkmcnt(4)
  v_cmp_gt_i32_e64 s[40:41], 0, v9
  v_cmp_gt_i32_e64 s[42:43], 1, v9
  v_cmp_gt_i32_e64 s[44:45], 2, v9
  v_cndmask_b32_e64 v180, v180, v8, s[40:41]
  v_cndmask_b32_e64 v181, v181, v8, s[42:43]
  v_cndmask_b32_e64 v182, v182, v8, s[44:45]
  v_cmp_gt_i32_e64 s[40:41], 3, v9
  s_nop 1
  v_cndmask_b32_e64 v183, v183, v8, s[40:41]
  v_mfma_f32_16x16x32_bf16 v[84:87], a[208:211], a[128:131], v[16:19]
  ds_read_b128 a[240:243], v3 offset:28672
  v_mfma_f32_16x16x32_bf16 v[116:119], a[208:211], a[144:147], v[20:23]
  v_mfma_f32_16x16x32_bf16 v[84:87], a[212:215], a[132:135], v[84:87]
  ds_read_b128 a[244:247], v3 offset:29696
  v_mfma_f32_16x16x32_bf16 v[116:119], a[212:215], a[148:151], v[116:119]
  v_mfma_f32_16x16x32_bf16 v[84:87], a[216:219], a[136:139], v[84:87]
  ds_read_b128 a[248:251], v3 offset:30720
  v_mfma_f32_16x16x32_bf16 v[116:119], a[216:219], a[152:155], v[116:119]
  v_mfma_f32_16x16x32_bf16 v[84:87], a[220:223], a[140:143], v[84:87]
  ds_read_b128 a[252:255], v3 offset:31744
  v_max_f32 v58, v180, v181
  v_mfma_f32_16x16x32_bf16 v[116:119], a[220:223], a[156:159], v[116:119]
  s_waitcnt lgkmcnt(4)
  v_max3_f32 v58, v58, v182, v183
  v_mfma_f32_16x16x32_bf16 v[88:91], a[224:227], a[128:131], v[16:19]
  v_mfma_f32_16x16x32_bf16 v[120:123], a[224:227], a[144:147], v[20:23]
  v_mfma_f32_16x16x32_bf16 v[88:91], a[228:231], a[132:135], v[88:91]
  v_mfma_f32_16x16x32_bf16 v[120:123], a[228:231], a[148:151], v[120:123]
  v_mfma_f32_16x16x32_bf16 v[88:91], a[232:235], a[136:139], v[88:91]
  v_mfma_f32_16x16x32_bf16 v[120:123], a[232:235], a[152:155], v[120:123]
  v_mov_b32 v59, v58
  s_nop 1
  v_permlane32_swap_b32 v58, v59
  s_nop 1
  v_max_f32 v58, v58, v59
  v_mov_b32 v59, v58
  s_nop 1
  v_permlane16_swap_b32 v58, v59
  s_nop 1
  v_max_f32 v58, v58, v59
  v_mfma_f32_16x16x32_bf16 v[88:91], a[236:239], a[140:143], v[88:91]
  v_mfma_f32_16x16x32_bf16 v[120:123], a[236:239], a[156:159], v[120:123]
  s_waitcnt lgkmcnt(1)
  v_mfma_f32_16x16x32_bf16 v[92:95], a[240:243], a[128:131], v[16:19]
  v_mfma_f32_16x16x32_bf16 v[124:127], a[240:243], a[144:147], v[20:23]
  v_mfma_f32_16x16x32_bf16 v[92:95], a[244:247], a[132:135], v[92:95]
  v_mfma_f32_16x16x32_bf16 v[124:127], a[244:247], a[148:151], v[124:127]
  v_sub_f32 v28, 0, v58
  v_mfma_f32_16x16x32_bf16 v[92:95], a[248:251], a[136:139], v[92:95]
  v_sub_f32 v29, 0, v58
  v_mfma_f32_16x16x32_bf16 v[124:127], a[248:251], a[152:155], v[124:127]
  s_waitcnt lgkmcnt(0)
  v_sub_f32 v30, 0, v58
  v_mfma_f32_16x16x32_bf16 v[92:95], a[252:255], a[140:143], v[92:95]
  v_sub_f32 v31, 0, v58
  v_mfma_f32_16x16x32_bf16 v[124:127], a[252:255], a[156:159], v[124:127]
  v_cmp_gt_i32_e64 s[40:41], 0, v6
  v_cmp_gt_i32_e64 s[42:43], 1, v6
  v_cmp_gt_i32_e64 s[44:45], 2, v6
  v_cndmask_b32_e64 v64, v64, v8, s[40:41]
  v_cndmask_b32_e64 v65, v65, v8, s[42:43]
  v_cndmask_b32_e64 v66, v66, v8, s[44:45]
  v_cmp_gt_i32_e64 s[40:41], 3, v6
  v_cmp_gt_i32_e64 s[42:43], 0, v9
  v_cmp_gt_i32_e64 s[44:45], 1, v9
  v_cndmask_b32_e64 v67, v67, v8, s[40:41]
  v_cndmask_b32_e64 v96, v96, v8, s[42:43]
  v_cndmask_b32_e64 v97, v97, v8, s[44:45]
  v_cmp_gt_i32_e64 s[40:41], 2, v9
  v_cmp_gt_i32_e64 s[42:43], 3, v9
  v_cmp_gt_i32_e64 s[44:45], 16, v6
  v_cndmask_b32_e64 v98, v98, v8, s[40:41]
  v_cndmask_b32_e64 v99, v99, v8, s[42:43]
  v_cndmask_b32_e64 v68, v68, v8, s[44:45]
  v_cmp_gt_i32_e64 s[40:41], 17, v6
  v_cmp_gt_i32_e64 s[42:43], 18, v6
  v_cmp_gt_i32_e64 s[44:45], 19, v6
  v_cndmask_b32_e64 v69, v69, v8, s[40:41]
  v_cndmask_b32_e64 v70, v70, v8, s[42:43]
  v_cndmask_b32_e64 v71, v71, v8, s[44:45]
  v_cmp_gt_i32_e64 s[40:41], 16, v9
  v_cmp_gt_i32_e64 s[42:43], 17, v9
  v_cmp_gt_i32_e64 s[44:45], 18, v9
  v_cndmask_b32_e64 v100, v100, v8, s[40:41]
  v_cndmask_b32_e64 v101, v101, v8, s[42:43]
  v_cndmask_b32_e64 v102, v102, v8, s[44:45]
  v_cmp_gt_i32_e64 s[40:41], 19, v9
  v_cmp_gt_i32_e64 s[42:43], 32, v6
  v_cmp_gt_i32_e64 s[44:45], 33, v6
  v_cndmask_b32_e64 v103, v103, v8, s[40:41]
  v_cndmask_b32_e64 v72, v72, v8, s[42:43]
  v_cndmask_b32_e64 v73, v73, v8, s[44:45]
  v_cmp_gt_i32_e64 s[40:41], 34, v6
  v_cmp_gt_i32_e64 s[42:43], 35, v6
  v_cmp_gt_i32_e64 s[44:45], 32, v9
  v_cndmask_b32_e64 v74, v74, v8, s[40:41]
  v_cndmask_b32_e64 v75, v75, v8, s[42:43]
  v_cndmask_b32_e64 v104, v104, v8, s[44:45]
  v_cmp_gt_i32_e64 s[40:41], 33, v9
  v_cmp_gt_i32_e64 s[42:43], 34, v9
  v_cmp_gt_i32_e64 s[44:45], 35, v9
  v_cndmask_b32_e64 v105, v105, v8, s[40:41]
  v_cndmask_b32_e64 v106, v106, v8, s[42:43]
  v_cndmask_b32_e64 v107, v107, v8, s[44:45]
  v_cmp_gt_i32_e64 s[40:41], 48, v6
  v_cmp_gt_i32_e64 s[42:43], 49, v6
  v_cmp_gt_i32_e64 s[44:45], 50, v6
  v_cndmask_b32_e64 v76, v76, v8, s[40:41]
  v_cndmask_b32_e64 v77, v77, v8, s[42:43]
  v_cndmask_b32_e64 v78, v78, v8, s[44:45]
  v_cmp_gt_i32_e64 s[40:41], 51, v6
  v_cmp_gt_i32_e64 s[42:43], 48, v9
  v_cmp_gt_i32_e64 s[44:45], 49, v9
  v_cndmask_b32_e64 v79, v79, v8, s[40:41]
  v_cndmask_b32_e64 v108, v108, v8, s[42:43]
  v_cndmask_b32_e64 v109, v109, v8, s[44:45]
  v_cmp_gt_i32_e64 s[40:41], 50, v9
  v_cmp_gt_i32_e64 s[42:43], 51, v9
  v_cmp_gt_i32_e64 s[44:45], 0, v7
  v_cndmask_b32_e64 v110, v110, v8, s[40:41]
  v_cndmask_b32_e64 v111, v111, v8, s[42:43]
  v_cndmask_b32_e64 v80, v80, v8, s[44:45]
  v_cmp_gt_i32_e64 s[40:41], 1, v7
  v_cmp_gt_i32_e64 s[42:43], 2, v7
  v_cmp_gt_i32_e64 s[44:45], 3, v7
  v_cndmask_b32_e64 v81, v81, v8, s[40:41]
  v_cndmask_b32_e64 v82, v82, v8, s[42:43]
  v_cndmask_b32_e64 v83, v83, v8, s[44:45]
  v_cmp_gt_i32_e64 s[40:41], 0, v10
  v_cmp_gt_i32_e64 s[42:43], 1, v10
  v_cmp_gt_i32_e64 s[44:45], 2, v10
  v_cndmask_b32_e64 v112, v112, v8, s[40:41]
  v_cndmask_b32_e64 v113, v113, v8, s[42:43]
  v_cndmask_b32_e64 v114, v114, v8, s[44:45]
  v_cmp_gt_i32_e64 s[40:41], 3, v10
  v_cmp_gt_i32_e64 s[42:43], 16, v7
  v_cmp_gt_i32_e64 s[44:45], 17, v7
  v_cndmask_b32_e64 v115, v115, v8, s[40:41]
  v_cndmask_b32_e64 v84, v84, v8, s[42:43]
  v_cndmask_b32_e64 v85, v85, v8, s[44:45]
  v_cmp_gt_i32_e64 s[40:41], 18, v7
  v_cmp_gt_i32_e64 s[42:43], 19, v7
  v_cmp_gt_i32_e64 s[44:45], 16, v10
  v_cndmask_b32_e64 v86, v86, v8, s[40:41]
  v_cndmask_b32_e64 v87, v87, v8, s[42:43]
  v_cndmask_b32_e64 v116, v116, v8, s[44:45]
  v_cmp_gt_i32_e64 s[40:41], 17, v10
  v_cmp_gt_i32_e64 s[42:43], 18, v10
  v_cmp_gt_i32_e64 s[44:45], 19, v10
  v_cndmask_b32_e64 v117, v117, v8, s[40:41]
  v_cndmask_b32_e64 v118, v118, v8, s[42:43]
  v_cndmask_b32_e64 v119, v119, v8, s[44:45]
  v_cmp_gt_i32_e64 s[40:41], 32, v7
  v_cmp_gt_i32_e64 s[42:43], 33, v7
  v_cmp_gt_i32_e64 s[44:45], 34, v7
  v_cndmask_b32_e64 v88, v88, v8, s[40:41]
  v_cndmask_b32_e64 v89, v89, v8, s[42:43]
  v_cndmask_b32_e64 v90, v90, v8, s[44:45]
  v_cmp_gt_i32_e64 s[40:41], 35, v7
  v_cmp_gt_i32_e64 s[42:43], 32, v10
  v_cmp_gt_i32_e64 s[44:45], 33, v10
  v_cndmask_b32_e64 v91, v91, v8, s[40:41]
  v_cndmask_b32_e64 v120, v120, v8, s[42:43]
  v_cndmask_b32_e64 v121, v121, v8, s[44:45]
  v_cmp_gt_i32_e64 s[40:41], 34, v10
  v_cmp_gt_i32_e64 s[42:43], 35, v10
  v_cmp_gt_i32_e64 s[44:45], 48, v7
  v_cndmask_b32_e64 v122, v122, v8, s[40:41]
  v_cndmask_b32_e64 v123, v123, v8, s[42:43]
  v_cndmask_b32_e64 v92, v92, v8, s[44:45]
  v_cmp_gt_i32_e64 s[40:41], 49, v7
  v_cmp_gt_i32_e64 s[42:43], 50, v7
  v_cmp_gt_i32_e64 s[44:45], 51, v7
  v_cndmask_b32_e64 v93, v93, v8, s[40:41]
  v_cndmask_b32_e64 v94, v94, v8, s[42:43]
  v_cndmask_b32_e64 v95, v95, v8, s[44:45]
  v_cmp_gt_i32_e64 s[40:41], 48, v10
  v_cmp_gt_i32_e64 s[42:43], 49, v10
  v_cmp_gt_i32_e64 s[44:45], 50, v10
  v_cndmask_b32_e64 v124, v124, v8, s[40:41]
  v_cndmask_b32_e64 v125, v125, v8, s[42:43]
  v_cndmask_b32_e64 v126, v126, v8, s[44:45]
  v_cmp_gt_i32_e64 s[40:41], 51, v10
  s_nop 1
  v_cndmask_b32_e64 v127, v127, v8, s[40:41]
  v_exp_f32 v48, v64
  v_exp_f32 v49, v65
  v_exp_f32 v50, v66
  v_exp_f32 v51, v67
  v_cvt_pk_bf16_f32 v192, v48, v49
  v_exp_f32 v52, v68
  v_exp_f32 v53, v69
  v_cvt_pk_bf16_f32 v193, v50, v51
  v_pk_maximum3_f16 v11, v192, v192, v193
  v_exp_f32 v54, v70
  v_exp_f32 v55, v71
  v_cvt_pk_bf16_f32 v194, v52, v53
  v_exp_f32 v48, v96
  v_exp_f32 v49, v97
  v_cvt_pk_bf16_f32 v195, v54, v55
  v_pk_maximum3_f16 v11, v11, v194, v195
  v_exp_f32 v50, v98
  v_exp_f32 v51, v99
  v_cvt_pk_bf16_f32 v208, v48, v49
  v_exp_f32 v52, v100
  v_exp_f32 v53, v101
  v_cvt_pk_bf16_f32 v209, v50, v51
  v_pk_maximum3_f16 v11, v11, v208, v209
  v_exp_f32 v54, v102
  v_exp_f32 v55, v103
  v_cvt_pk_bf16_f32 v210, v52, v53
  v_exp_f32 v48, v72
  v_exp_f32 v49, v73
  v_cvt_pk_bf16_f32 v211, v54, v55
  v_pk_maximum3_f16 v11, v11, v210, v211
  v_exp_f32 v50, v74
  v_exp_f32 v51, v75
  v_cvt_pk_bf16_f32 v196, v48, v49
  v_exp_f32 v52, v76
  v_exp_f32 v53, v77
  v_cvt_pk_bf16_f32 v197, v50, v51
  v_pk_maximum3_f16 v11, v11, v196, v197
  v_exp_f32 v54, v78
  v_exp_f32 v55, v79
  v_cvt_pk_bf16_f32 v198, v52, v53
  v_exp_f32 v48, v104
  v_exp_f32 v49, v105
  v_cvt_pk_bf16_f32 v199, v54, v55
  v_pk_maximum3_f16 v11, v11, v198, v199
  v_exp_f32 v50, v106
  v_exp_f32 v51, v107
  v_cvt_pk_bf16_f32 v212, v48, v49
  v_exp_f32 v52, v108
  v_exp_f32 v53, v109
  v_cvt_pk_bf16_f32 v213, v50, v51
  v_pk_maximum3_f16 v11, v11, v212, v213
  v_exp_f32 v54, v110
  v_exp_f32 v55, v111
  v_cvt_pk_bf16_f32 v214, v52, v53
  s_nop 0
  v_cvt_pk_bf16_f32 v215, v54, v55
  v_pk_maximum3_f16 v11, v11, v214, v215
  v_bfe_u32 v57, v1, 1, 3
  v_lshlrev_b32 v57, 12, v57
  v_and_b32 v56, 1, v1
  v_lshl_add_u32 v57, v56, 2, v57
  v_add_u32 v57, 4, v57
  s_and_b32 s56, s2, 31
  s_lshl_b32 s56, s56, 7
  s_add_u32 s56, s56, 131072
  s_mov_b32 s58, 0
F_vpoll:
  buffer_load_dword v56, v57, s[20:23], s56 offen sc1
  s_waitcnt vmcnt(0)
  v_cmp_ne_u32 vcc, 1, v56
  s_add_u32 s58, s58, 1
  s_nop 3
  s_cbranch_vccz F_vpoll_ok
  s_cmp_ge_u32 s58, 1048576
  s_cbranch_scc1 F_vpoll_ok
  s_sleep 4
  s_branch F_vpoll
F_vpoll_ok:
  s_waitcnt lgkmcnt(0)
  s_barrier
  v_add_u32 v3, s33, v2
  ds_read_b128 a[192:195], v3 offset:0
  ds_read_b128 a[196:199], v3 offset:1024
  ds_read_b128 a[200:203], v3 offset:2048
  ds_read_b128 a[204:207], v3 offset:3072
  ds_read_b128 a[208:211], v3 offset:4096
  ds_read_b128 a[212:215], v3 offset:5120
  ds_read_b128 a[216:219], v3 offset:6144
  ds_read_b128 a[220:223], v3 offset:7168
  v_mov_b32 v13, s64
  v_mov_b32 v14, s65
  s_sub_u32 s29, s28, 131072
  s_lshl_b32 s30, s5, 12
F_main:
  s_waitcnt lgkmcnt(4)
  v_mfma_f32_16x16x32_bf16 v[128:131], a[192:195], a[128:131], v[16:19]
  ds_read_b128 a[224:227], v3 offset:8192
  v_mfma_f32_16x16x32_bf16 v[144:147], a[192:195], a[144:147], v[20:23]
  v_exp_f32 v48, v80
  v_mfma_f32_16x16x32_bf16 v[160:163], a[192:195], a[160:163], v[24:27]
  v_exp_f32 v49, v81
  v_mfma_f32_16x16x32_bf16 v[176:179], a[192:195], a[176:179], v[28:31]
  v_exp_f32 v50, v82
  v_mfma_f32_16x16x32_bf16 v[128:131], a[196:199], a[132:135], v[128:131]
  ds_read_b128 a[228:231], v3 offset:9216
  v_cvt_pk_bf16_f32 v200, v48, v49
  v_mfma_f32_16x16x32_bf16 v[144:147], a[196:199], a[148:151], v[144:147]
  v_exp_f32 v51, v83
  v_mfma_f32_16x16x32_bf16 v[160:163], a[196:199], a[164:167], v[160:163]
  v_exp_f32 v52, v84
  v_mfma_f32_16x16x32_bf16 v[176:179], a[196:199], a[180:183], v[176:179]
  v_exp_f32 v53, v85
  v_mfma_f32_16x16x32_bf16 v[128:131], a[200:203], a[136:139], v[128:131]
  ds_read_b128 a[232:235], v3 offset:10240
  v_cvt_pk_bf16_f32 v201, v50, v51
  v_mfma_f32_16x16x32_bf16 v[144:147], a[200:203], a[152:155], v[144:147]
  v_pk_maximum3_f16 v11, v11, v200, v201
  v_cvt_pk_bf16_f32 v202, v52, v53
  v_mfma_f32_16x16x32_bf16 v[160:163], a[200:203], a[168:171], v[160:163]
  v_exp_f32 v54, v86
  v_mfma_f32_16x16x32_bf16 v[176:179], a[200:203], a[184:187], v[176:179]
  v_exp_f32 v55, v87
  v_mfma_f32_16x16x32_bf16 v[128:131], a[204:207], a[140:143], v[128:131]
  ds_read_b128 a[236:239], v3 offset:11264
  v_cvt_pk_bf16_f32 v203, v54, v55
  v_mfma_f32_16x16x32_bf16 v[144:147], a[204:207], a[156:159], v[144:147]
  v_exp_f32 v48, v112
  v_mfma_f32_16x16x32_bf16 v[160:163], a[204:207], a[172:175], v[160:163]
  v_exp_f32 v49, v113
  v_mfma_f32_16x16x32_bf16 v[176:179], a[204:207], a[188:191], v[176:179]
  s_waitcnt lgkmcnt(4)
  v_pk_maximum3_f16 v11, v11, v202, v203
  v_mfma_f32_16x16x32_bf16 v[132:135], a[208:211], a[128:131], v[16:19]
  ds_read_b128 a[240:243], v3 offset:12288
  v_cvt_pk_bf16_f32 v216, v48, v49
  v_mfma_f32_16x16x32_bf16 v[148:151], a[208:211], a[144:147], v[20:23]
  v_exp_f32 v50, v114
  v_mfma_f32_16x16x32_bf16 v[164:167], a[208:211], a[160:163], v[24:27]
  v_exp_f32 v51, v115
  v_mfma_f32_16x16x32_bf16 v[180:183], a[208:211], a[176:179], v[28:31]
  v_exp_f32 v52, v116
  v_mfma_f32_16x16x32_bf16 v[132:135], a[212:215], a[132:135], v[132:135]
  ds_read_b128 a[244:247], v3 offset:13312
  v_mfma_f32_16x16x32_bf16 v[148:151], a[212:215], a[148:151], v[148:151]
  v_exp_f32 v53, v117
  v_mfma_f32_16x16x32_bf16 v[164:167], a[212:215], a[164:167], v[164:167]
  v_cvt_pk_bf16_f32 v217, v50, v51
  v_mfma_f32_16x16x32_bf16 v[180:183], a[212:215], a[180:183], v[180:183]
  v_pk_maximum3_f16 v11, v11, v216, v217
  v_mfma_f32_16x16x32_bf16 v[132:135], a[216:219], a[136:139], v[132:135]
  ds_read_b128 a[248:251], v3 offset:14336
  v_cvt_pk_bf16_f32 v218, v52, v53
  v_mfma_f32_16x16x32_bf16 v[148:151], a[216:219], a[152:155], v[148:151]
  v_exp_f32 v54, v118
  v_mfma_f32_16x16x32_bf16 v[164:167], a[216:219], a[168:171], v[164:167]
  v_exp_f32 v55, v119
  v_mfma_f32_16x16x32_bf16 v[180:183], a[216:219], a[184:187], v[180:183]
  v_exp_f32 v48, v88
  v_mfma_f32_16x16x32_bf16 v[132:135], a[220:223], a[140:143], v[132:135]
  ds_read_b128 a[252:255], v3 offset:15360
  v_mfma_f32_16x16x32_bf16 v[148:151], a[220:223], a[156:159], v[148:151]
  v_exp_f32 v49, v89
  v_mfma_f32_16x16x32_bf16 v[164:167], a[220:223], a[172:175], v[164:167]
  v_add_u32 v4, s34, v2
  v_cvt_pk_bf16_f32 v219, v54, v55
  v_mfma_f32_16x16x32_bf16 v[180:183], a[220:223], a[188:191], v[180:183]
  s_add_u32 s34, s34, 32768
  s_and_b32 s34, s34, 0xffff
  s_waitcnt vmcnt(0)
  s_barrier
  s_waitcnt lgkmcnt(4)
  v_mfma_f32_16x16x32_bf16 v[136:139], a[224:227], a[128:131], v[16:19]
  ds_read_b128 a[192:195], v4 offset:0
  v_pk_maximum3_f16 v11, v11, v218, v219
  v_mfma_f32_16x16x32_bf16 v[152:155], a[224:227], a[144:147], v[20:23]
  s_cmp_lt_i32 s29, 0
  s_cselect_b32 s62, s60, 0
  v_cvt_pk_bf16_f32 v204, v48, v49
  v_mfma_f32_16x16x32_bf16 v[168:171], a[224:227], a[160:163], v[24:27]
  s_add_u32 s62, s62, s29
  v_exp_f32 v50, v90
  v_mfma_f32_16x16x32_bf16 v[184:187], a[224:227], a[176:179], v[28:31]
  s_cmp_ge_i32 s29, s61
  s_cselect_b32 s10, s35, 0
  v_mfma_f32_16x16x32_bf16 v[136:139], a[228:231], a[132:135], v[136:139]
  ds_read_b128 a[196:199], v4 offset:1024
  s_mov_b32 m0, s31
  v_mfma_f32_16x16x32_bf16 v[152:155], a[228:231], a[148:151], v[152:155]
  buffer_load_dwordx4 v5, s[8:11], s62 offen offset:0 lds
  v_mfma_f32_16x16x32_bf16 v[168:171], a[228:231], a[164:167], v[168:171]
  v_exp_f32 v51, v91
  v_mfma_f32_16x16x32_bf16 v[184:187], a[228:231], a[180:183], v[184:187]
  v_exp_f32 v52, v92
  v_mfma_f32_16x16x32_bf16 v[136:139], a[232:235], a[136:139], v[136:139]
  ds_read_b128 a[200:203], v4 offset:2048
  v_cvt_pk_bf16_f32 v205, v50, v51
  v_mfma_f32_16x16x32_bf16 v[152:155], a[232:235], a[152:155], v[152:155]
  v_exp_f32 v53, v93
  v_mfma_f32_16x16x32_bf16 v[168:171], a[232:235], a[168:171], v[168:171]
  v_pk_maximum3_f16 v11, v11, v204, v205
  v_cvt_pk_bf16_f32 v206, v52, v53
  v_mfma_f32_16x16x32_bf16 v[184:187], a[232:235], a[184:187], v[184:187]
  v_exp_f32 v54, v94
  v_mfma_f32_16x16x32_bf16 v[136:139], a[236:239], a[140:143], v[136:139]
  ds_read_b128 a[204:207], v4 offset:3072
  v_mfma_f32_16x16x32_bf16 v[152:155], a[236:239], a[156:159], v[152:155]
  v_exp_f32 v55, v95
  v_mfma_f32_16x16x32_bf16 v[168:171], a[236:239], a[172:175], v[168:171]
  v_exp_f32 v48, v120
  v_mfma_f32_16x16x32_bf16 v[184:187], a[236:239], a[188:191], v[184:187]
  s_waitcnt lgkmcnt(4)
  v_exp_f32 v49, v121
  v_mfma_f32_16x16x32_bf16 v[140:143], a[240:243], a[128:131], v[16:19]
  ds_read_b128 a[208:211], v4 offset:4096
  v_cvt_pk_bf16_f32 v207, v54, v55
  v_mfma_f32_16x16x32_bf16 v[156:159], a[240:243], a[144:147], v[20:23]
  buffer_load_dwordx4 v5, s[8:11], s62 offen offset:1024 lds
  v_mfma_f32_16x16x32_bf16 v[172:175], a[240:243], a[160:163], v[24:27]
  v_pk_maximum3_f16 v11, v11, v206, v207
  v_cvt_pk_bf16_f32 v220, v48, v49
  v_mfma_f32_16x16x32_bf16 v[188:191], a[240:243], a[176:179], v[28:31]
  v_exp_f32 v50, v122
  v_mfma_f32_16x16x32_bf16 v[140:143], a[244:247], a[132:135], v[140:143]
  ds_read_b128 a[212:215], v4 offset:5120
  v_mfma_f32_16x16x32_bf16 v[156:159], a[244:247], a[148:151], v[156:159]
  v_exp_f32 v51, v123
  v_mfma_f32_16x16x32_bf16 v[172:175], a[244:247], a[164:167], v[172:175]
  v_exp_f32 v52, v124
  v_mfma_f32_16x16x32_bf16 v[188:191], a[244:247], a[180:183], v[188:191]
  v_exp_f32 v53, v125
  v_mfma_f32_16x16x32_bf16 v[140:143], a[248:251], a[136:139], v[140:143]
  ds_read_b128 a[216:219], v4 offset:6144
  v_cvt_pk_bf16_f32 v221, v50, v51
  v_mfma_f32_16x16x32_bf16 v[156:159], a[248:251], a[152:155], v[156:159]
  v_pk_maximum3_f16 v11, v11, v220, v221
  v_cvt_pk_bf16_f32 v222, v52, v53
  v_mfma_f32_16x16x32_bf16 v[172:175], a[248:251], a[168:171], v[172:175]
  v_exp_f32 v54, v126
  v_mfma_f32_16x16x32_bf16 v[188:191], a[248:251], a[184:187], v[188:191]
  v_exp_f32 v55, v127
  v_mfma_f32_16x16x32_bf16 v[140:143], a[252:255], a[140:143], v[140:143]
  ds_read_b128 a[220:223], v4 offset:7168
  s_nop 0
  v_mfma_f32_16x16x32_bf16 v[156:159], a[252:255], a[156:159], v[156:159]
  buffer_load_dwordx4 v5, s[8:11], s62 offen offset:2048 lds
  v_mfma_f32_16x16x32_bf16 v[172:175], a[252:255], a[172:175], v[172:175]
  v_cvt_pk_bf16_f32 v223, v54, v55
  v_pk_maximum3_f16 v11, v11, v222, v223
  v_mfma_f32_16x16x32_bf16 v[188:191], a[252:255], a[188:191], v[188:191]
  s_waitcnt lgkmcnt(4)
  v_lshrrev_b32 v56, 16, v11
  v_and_b32 v57, 0xffff, v11
  v_max_u32 v56, v56, v57
  v_cmp_lt_u32 vcc, 0x4e80, v56
  s_nop 1
  s_cbranch_vccnz K2_rare_C
K2_ret_C:
  v_mfma_f32_16x16x32_bf16 a[0:3], a[192:195], v[192:195], a[0:3]
  ds_read_b128 a[224:227], v4 offset:8192
  v_cmp_gt_i32_e64 s[40:41], 0, v6
  v_mfma_f32_16x16x32_bf16 a[32:35], a[192:195], v[208:211], a[32:35]
  v_cmp_gt_i32_e64 s[42:43], 1, v6
  v_cmp_gt_i32_e64 s[44:45], 2, v6
  v_mfma_f32_16x16x32_bf16 v[32:35], v[60:63], v[192:195], v[32:35]
  ds_read_b128 a[228:231], v4 offset:9216
  v_cndmask_b32_e64 v160, v160, v8, s[40:41]
  v_cndmask_b32_e64 v161, v161, v8, s[42:43]
  v_mfma_f32_16x16x32_bf16 a[4:7], a[196:199], v[192:195], a[4:7]
  v_cndmask_b32_e64 v162, v162, v8, s[44:45]
  v_cmp_gt_i32_e64 s[40:41], 3, v6
  v_mfma_f32_16x16x32_bf16 a[36:39], a[196:199], v[208:211], a[36:39]
  v_cmp_gt_i32_e64 s[42:43], 0, v9
  v_cmp_gt_i32_e64 s[44:45], 1, v9
  v_mfma_f32_16x16x32_bf16 a[8:11], a[200:203], v[192:195], a[8:11]
  ds_read_b128 a[232:235], v4 offset:10240
  v_cndmask_b32_e64 v163, v163, v8, s[40:41]
  v_cndmask_b32_e64 v176, v176, v8, s[42:43]
  v_mfma_f32_16x16x32_bf16 a[40:43], a[200:203], v[208:211], a[40:43]
  v_cndmask_b32_e64 v177, v177, v8, s[44:45]
  v_cmp_gt_i32_e64 s[40:41], 2, v9
  v_mfma_f32_16x16x32_bf16 v[36:39], v[60:63], v[208:211], v[36:39]
  ds_read_b128 a[236:239], v4 offset:11264
  v_cmp_gt_i32_e64 s[42:43], 3, v9
  v_cmp_gt_i32_e64 s[44:45], 16, v6
  v_mfma_f32_16x16x32_bf16 a[12:15], a[204:207], v[192:195], a[12:15]
  buffer_load_dwordx4 v5, s[8:11], s62 offen offset:3072 lds
  v_cndmask_b32_e64 v178, v178, v8, s[40:41]
  v_mfma_f32_16x16x32_bf16 a[44:47], a[204:207], v[208:211], a[44:47]
  s_waitcnt lgkmcnt(4)
  v_cndmask_b32_e64 v179, v179, v8, s[42:43]
  v_cndmask_b32_e64 v164, v164, v8, s[44:45]
  v_cmp_gt_i32_e64 s[40:41], 17, v6
  v_mfma_f32_16x16x32_bf16 a[16:19], a[208:211], v[192:195], a[16:19]
  ds_read_b128 a[240:243], v4 offset:12288
  v_cmp_gt_i32_e64 s[42:43], 18, v6
  v_cmp_gt_i32_e64 s[44:45], 19, v6
  v_mfma_f32_16x16x32_bf16 a[48:51], a[208:211], v[208:211], a[48:51]
  s_add_u32 s31, s31, 16384
  v_cndmask_b32_e64 v165, v165, v8, s[40:41]
  v_cndmask_b32_e64 v166, v166, v8, s[42:43]
  v_cndmask_b32_e64 v167, v167, v8, s[44:45]
  v_mfma_f32_16x16x32_bf16 a[20:23], a[212:215], v[192:195], a[20:23]
  ds_read_b128 a[244:247], v4 offset:13312
  v_cmp_gt_i32_e64 s[40:41], 16, v9
  v_cmp_gt_i32_e64 s[42:43], 17, v9
  v_mfma_f32_16x16x32_bf16 a[52:55], a[212:215], v[208:211], a[52:55]
  s_cmp_eq_u32 s31, s32
  s_cselect_b32 s31, s47, s31
  v_cmp_gt_i32_e64 s[44:45], 18, v9
  v_cndmask_b32_e64 v180, v180, v8, s[40:41]
  v_mfma_f32_16x16x32_bf16 a[24:27], a[216:219], v[192:195], a[24:27]
  ds_read_b128 a[248:251], v4 offset:14336
  v_cndmask_b32_e64 v181, v181, v8, s[42:43]
  v_cndmask_b32_e64 v182, v182, v8, s[44:45]
  v_mfma_f32_16x16x32_bf16 a[56:59], a[216:219], v[208:211], a[56:59]
  s_add_u32 s28, s28, 0x8000
  v_cmp_gt_i32_e64 s[40:41], 19, v9
  v_cmp_gt_i32_e64 s[42:43], 32, v6
  v_cmp_gt_i32_e64 s[44:45], 33, v6
  v_mfma_f32_16x16x32_bf16 a[28:31], a[220:223], v[192:195], a[28:31]
  ds_read_b128 a[252:255], v4 offset:15360
  v_cndmask_b32_e64 v183, v183, v8, s[40:41]
  v_cndmask_b32_e64 v168, v168, v8, s[42:43]
  v_mfma_f32_16x16x32_bf16 a[60:63], a[220:223], v[208:211], a[60:63]
  s_waitcnt lgkmcnt(4)
  v_cndmask_b32_e64 v169, v169, v8, s[44:45]
  v_cmp_gt_i32_e64 s[40:41], 34, v6
  v_mfma_f32_16x16x32_bf16 a[0:3], a[224:227], v[196:199], a[0:3]
  ds_read_b128 a[192:195], v4 offset:16384
  v_cmp_gt_i32_e64 s[42:43], 35, v6
  v_cmp_gt_i32_e64 s[44:45], 32, v9
  v_mfma_f32_16x16x32_bf16 a[32:35], a[224:227], v[212:215], a[32:35]
  s_sub_u32 s29, s28, 131072
  v_cndmask_b32_e64 v170, v170, v8, s[40:41]
  v_cndmask_b32_e64 v171, v171, v8, s[42:43]
  v_mfma_f32_16x16x32_bf16 v[32:35], v[60:63], v[196:199], v[32:35]
  ds_read_b128 a[196:199], v4 offset:17408
  s_cmp_lt_i32 s29, 0
  s_cselect_b32 s62, s60, 0
  s_add_u32 s62, s62, s29
  s_cmp_ge_i32 s29, s61
  s_cselect_b32 s10, s35, 0
  s_mov_b32 m0, s31
  v_mfma_f32_16x16x32_bf16 a[4:7], a[228:231], v[196:199], a[4:7]
  buffer_load_dwordx4 v5, s[8:11], s62 offen offset:0 lds
  v_cndmask_b32_e64 v184, v184, v8, s[44:45]
  v_mfma_f32_16x16x32_bf16 a[36:39], a[228:231], v[212:215], a[36:39]
  v_cmp_gt_i32_e64 s[40:41], 33, v9
  v_cmp_gt_i32_e64 s[42:43], 34, v9
  v_cmp_gt_i32_e64 s[44:45], 35, v9
  v_mfma_f32_16x16x32_bf16 a[8:11], a[232:235], v[196:199], a[8:11]
  ds_read_b128 a[200:203], v4 offset:18432
  v_cndmask_b32_e64 v185, v185, v8, s[40:41]
  v_cndmask_b32_e64 v186, v186, v8, s[42:43]
  v_mfma_f32_16x16x32_bf16 a[40:43], a[232:235], v[212:215], a[40:43]
  v_cndmask_b32_e64 v187, v187, v8, s[44:45]
  v_cmp_gt_i32_e64 s[40:41], 48, v6
  v_cmp_gt_i32_e64 s[42:43], 49, v6
  v_mfma_f32_16x16x32_bf16 v[36:39], v[60:63], v[212:215], v[36:39]
  ds_read_b128 a[204:207], v4 offset:19456
  v_cmp_gt_i32_e64 s[44:45], 50, v6
  v_cndmask_b32_e64 v172, v172, v8, s[40:41]
  v_mfma_f32_16x16x32_bf16 a[12:15], a[236:239], v[196:199], a[12:15]
  v_cndmask_b32_e64 v173, v173, v8, s[42:43]
  v_cndmask_b32_e64 v174, v174, v8, s[44:45]
  v_cmp_gt_i32_e64 s[40:41], 51, v6
  v_mfma_f32_16x16x32_bf16 a[44:47], a[236:239], v[212:215], a[44:47]
  s_waitcnt lgkmcnt(4)
  v_cmp_gt_i32_e64 s[42:43], 48, v9
  v_cmp_gt_i32_e64 s[44:45], 49, v9
  v_cndmask_b32_e64 v175, v175, v8, s[40:41]
  v_mfma_f32_16x16x32_bf16 a[16:19], a[240:243], v[196:199], a[16:19]
  ds_read_b128 a[208:211], v4 offset:20480
  v_cndmask_b32_e64 v188, v188, v8, s[42:43]
  v_cndmask_b32_e64 v189, v189, v8, s[44:45]
  v_mfma_f32_16x16x32_bf16 a[48:51], a[240:243], v[212:215], a[48:51]
  v_cmp_gt_i32_e64 s[40:41], 50, v9
  v_cmp_gt_i32_e64 s[42:43], 51, v9
  s_nop 0
  v_mfma_f32_16x16x32_bf16 a[20:23], a[244:247], v[196:199], a[20:23]
  ds_read_b128 a[212:215], v4 offset:21504
  v_cndmask_b32_e64 v190, v190, v8, s[40:41]
  v_cndmask_b32_e64 v191, v191, v8, s[42:43]
  v_mfma_f32_16x16x32_bf16 a[52:55], a[244:247], v[212:215], a[52:55]
  v_exp_f32 v48, v128
  v_mfma_f32_16x16x32_bf16 a[24:27], a[248:251], v[196:199], a[24:27]
  ds_read_b128 a[216:219], v4 offset:22528
  v_exp_f32 v49, v129
  v_mfma_f32_16x16x32_bf16 a[56:59], a[248:251], v[212:215], a[56:59]
  buffer_load_dwordx4 v5, s[8:11], s62 offen offset:1024 lds
  v_cvt_pk_bf16_f32 v224, v48, v49
  v_mfma_f32_16x16x32_bf16 a[28:31], a[252:255], v[196:199], a[28:31]
  ds_read_b128 a[220:223], v4 offset:23552
  v_exp_f32 v50, v130
  v_mfma_f32_16x16x32_bf16 a[60:63], a[252:255], v[212:215], a[60:63]
  s_waitcnt lgkmcnt(4)
  v_exp_f32 v51, v131
  v_mfma_f32_16x16x32_bf16 a[0:3], a[192:195], v[200:203], a[0:3]
  ds_read_b128 a[224:227], v4 offset:24576
  v_exp_f32 v52, v132
  v_mfma_f32_16x16x32_bf16 a[32:35], a[192:195], v[216:219], a[32:35]
  v_exp_f32 v53, v133
  v_cvt_pk_bf16_f32 v225, v50, v51
  v_mfma_f32_16x16x32_bf16 v[32:35], v[60:63], v[200:203], v[32:35]
  ds_read_b128 a[228:231], v4 offset:25600
  v_pk_maximum3_f16 v11, v224, v224, v225
  v_cvt_pk_bf16_f32 v226, v52, v53
  v_mfma_f32_16x16x32_bf16 a[4:7], a[196:199], v[200:203], a[4:7]
  v_exp_f32 v54, v134
  v_mfma_f32_16x16x32_bf16 a[36:39], a[196:199], v[216:219], a[36:39]
  v_exp_f32 v55, v135
  v_mfma_f32_16x16x32_bf16 a[8:11], a[200:203], v[200:203], a[8:11]
  ds_read_b128 a[232:235], v4 offset:26624
  v_exp_f32 v48, v144
  v_mfma_f32_16x16x32_bf16 a[40:43], a[200:203], v[216:219], a[40:43]
  v_exp_f32 v49, v145
  v_cvt_pk_bf16_f32 v227, v54, v55
  v_mfma_f32_16x16x32_bf16 v[36:39], v[60:63], v[216:219], v[36:39]
  ds_read_b128 a[236:239], v4 offset:27648
  v_pk_maximum3_f16 v11, v11, v226, v227
  v_cvt_pk_bf16_f32 v232, v48, v49
  v_mfma_f32_16x16x32_bf16 a[12:15], a[204:207], v[200:203], a[12:15]
  buffer_load_dwordx4 v5, s[8:11], s62 offen offset:2048 lds
  v_exp_f32 v50, v146
  v_mfma_f32_16x16x32_bf16 a[44:47], a[204:207], v[216:219], a[44:47]
  s_waitcnt lgkmcnt(4)
  v_exp_f32 v51, v147
  v_mfma_f32_16x16x32_bf16 a[16:19], a[208:211], v[200:203], a[16:19]
  ds_read_b128 a[240:243], v4 offset:28672
  v_exp_f32 v52, v148
  v_mfma_f32_16x16x32_bf16 a[48:51], a[208:211], v[216:219], a[48:51]
  v_exp_f32 v53, v149
  v_cvt_pk_bf16_f32 v233, v50, v51
  v_mfma_f32_16x16x32_bf16 a[20:23], a[212:215], v[200:203], a[20:23]
  ds_read_b128 a[244:247], v4 offset:29696
  v_pk_maximum3_f16 v11, v11, v232, v233
  v_cvt_pk_bf16_f32 v234, v52, v53
  v_mfma_f32_16x16x32_bf16 a[52:55], a[212:215], v[216:219], a[52:55]
  v_exp_f32 v54, v150
  v_mfma_f32_16x16x32_bf16 a[24:27], a[216:219], v[200:203], a[24:27]
  ds_read_b128 a[248:251], v4 offset:30720
  s_add_u32 s33, s33, 16384
  s_cmp_eq_u32 s33, 163840
  s_cselect_b32 s33, 65536, s33
  v_mfma_f32_16x16x32_bf16 a[56:59], a[216:219], v[216:219], a[56:59]
  v_exp_f32 v55, v151
  v_exp_f32 v48, v160
  v_mfma_f32_16x16x32_bf16 a[28:31], a[220:223], v[200:203], a[28:31]
  ds_read_b128 a[252:255], v4 offset:31744
  v_exp_f32 v49, v161
  v_mfma_f32_16x16x32_bf16 a[60:63], a[220:223], v[216:219], a[60:63]
  v_cvt_pk_bf16_f32 v235, v54, v55
  v_add_u32 v3, s33, v2
  s_waitcnt lgkmcnt(4)
  v_mfma_f32_16x16x32_bf16 a[0:3], a[224:227], v[204:207], a[0:3]
  ds_read_b128 a[192:195], v3 offset:0
  v_pk_maximum3_f16 v11, v11, v234, v235
  v_exp_f32 v50, v162
  v_mfma_f32_16x16x32_bf16 a[32:35], a[224:227], v[220:223], a[32:35]
  v_exp_f32 v51, v163
  v_cvt_pk_bf16_f32 v240, v48, v49
  v_mfma_f32_16x16x32_bf16 v[32:35], v[60:63], v[204:207], v[32:35]
  ds_read_b128 a[196:199], v3 offset:1024
  v_exp_f32 v52, v164
  v_mfma_f32_16x16x32_bf16 a[4:7], a[228:231], v[204:207], a[4:7]
  buffer_load_dwordx4 v5, s[8:11], s62 offen offset:3072 lds
  v_exp_f32 v53, v165
  v_mfma_f32_16x16x32_bf16 a[36:39], a[228:231], v[220:223], a[36:39]
  s_add_u32 s31, s31, 16384
  s_cmp_eq_u32 s31, s32
  s_cselect_b32 s31, s47, s31
  s_add_u32 s28, s28, 0xfffe8000
  s_sub_u32 s29, s28, 131072
  v_mfma_f32_16x16x32_bf16 a[8:11], a[232:235], v[204:207], a[8:11]
  ds_read_b128 a[200:203], v3 offset:2048
  v_cvt_pk_bf16_f32 v241, v50, v51
  v_pk_maximum3_f16 v11, v11, v240, v241
  v_mfma_f32_16x16x32_bf16 a[40:43], a[232:235], v[220:223], a[40:43]
  v_exp_f32 v54, v166
  v_exp_f32 v55, v167
  v_mfma_f32_16x16x32_bf16 v[36:39], v[60:63], v[220:223], v[36:39]
  ds_read_b128 a[204:207], v3 offset:3072
  v_cvt_pk_bf16_f32 v242, v52, v53
  v_cvt_pk_bf16_f32 v243, v54, v55
  v_mfma_f32_16x16x32_bf16 a[12:15], a[236:239], v[204:207], a[12:15]
  v_exp_f32 v48, v176
  v_pk_maximum3_f16 v11, v11, v242, v243
  v_mfma_f32_16x16x32_bf16 a[44:47], a[236:239], v[220:223], a[44:47]
  s_waitcnt lgkmcnt(4)
  v_exp_f32 v49, v177
  v_mfma_f32_16x16x32_bf16 a[16:19], a[240:243], v[204:207], a[16:19]
  ds_read_b128 a[208:211], v3 offset:4096
  v_exp_f32 v50, v178
  v_mfma_f32_16x16x32_bf16 a[48:51], a[240:243], v[220:223], a[48:51]
  v_exp_f32 v51, v179
  v_cvt_pk_bf16_f32 v248, v48, v49
  v_mfma_f32_16x16x32_bf16 a[20:23], a[244:247], v[204:207], a[20:23]
  ds_read_b128 a[212:215], v3 offset:5120
  v_exp_f32 v52, v180
  v_mfma_f32_16x16x32_bf16 a[52:55], a[244:247], v[220:223], a[52:55]
  v_exp_f32 v53, v181
  v_mfma_f32_16x16x32_bf16 a[24:27], a[248:251], v[204:207], a[24:27]
  ds_read_b128 a[216:219], v3 offset:6144
  v_cvt_pk_bf16_f32 v249, v50, v51
  v_pk_maximum3_f16 v11, v11, v248, v249
  v_mfma_f32_16x16x32_bf16 a[56:59], a[248:251], v[220:223], a[56:59]
  v_exp_f32 v54, v182
  v_mfma_f32_16x16x32_bf16 a[28:31], a[252:255], v[204:207], a[28:31]
  ds_read_b128 a[220:223], v3 offset:7168
  v_exp_f32 v55, v183
  v_mfma_f32_16x16x32_bf16 a[60:63], a[252:255], v[220:223], a[60:63]
  v_cvt_pk_bf16_f32 v250, v52, v53
  s_nop 0
  v_cvt_pk_bf16_f32 v251, v54, v55
  v_pk_maximum3_f16 v11, v11, v250, v251
  s_waitcnt lgkmcnt(4)
  v_mfma_f32_16x16x32_bf16 v[64:67], a[192:195], a[128:131], v[16:19]
  ds_read_b128 a[224:227], v3 offset:8192
  v_mfma_f32_16x16x32_bf16 v[80:83], a[192:195], a[144:147], v[20:23]
  v_exp_f32 v48, v136
  v_mfma_f32_16x16x32_bf16 v[96:99], a[192:195], a[160:163], v[24:27]
  v_exp_f32 v49, v137
  v_mfma_f32_16x16x32_bf16 v[112:115], a[192:195], a[176:179], v[28:31]
  v_exp_f32 v50, v138
  v_mfma_f32_16x16x32_bf16 v[64:67], a[196:199], a[132:135], v[64:67]
  ds_read_b128 a[228:231], v3 offset:9216
  v_cvt_pk_bf16_f32 v228, v48, v49
  v_mfma_f32_16x16x32_bf16 v[80:83], a[196:199], a[148:151], v[80:83]
  v_exp_f32 v51, v139
  v_mfma_f32_16x16x32_bf16 v[96:99], a[196:199], a[164:167], v[96:99]
  v_exp_f32 v52, v140
  v_mfma_f32_16x16x32_bf16 v[112:115], a[196:199], a[180:183], v[112:115]
  v_exp_f32 v53, v141
  v_mfma_f32_16x16x32_bf16 v[64:67], a[200:203], a[136:139], v[64:67]
  ds_read_b128 a[232:235], v3 offset:10240
  v_cvt_pk_bf16_f32 v229, v50, v51
  v_mfma_f32_16x16x32_bf16 v[80:83], a[200:203], a[152:155], v[80:83]
  v_pk_maximum3_f16 v11, v11, v228, v229
  v_cvt_pk_bf16_f32 v230, v52, v53
  v_mfma_f32_16x16x32_bf16 v[96:99], a[200:203], a[168:171], v[96:99]
  v_exp_f32 v54, v142
  v_mfma_f32_16x16x32_bf16 v[112:115], a[200:203], a[184:187], v[112:115]
  v_exp_f32 v55, v143
  v_mfma_f32_16x16x32_bf16 v[64:67], a[204:207], a[140:143], v[64:67]
  ds_read_b128 a[236:239], v3 offset:11264
  v_cvt_pk_bf16_f32 v231, v54, v55
  v_mfma_f32_16x16x32_bf16 v[80:83], a[204:207], a[156:159], v[80:83]
  v_exp_f32 v48, v152
  v_mfma_f32_16x16x32_bf16 v[96:99], a[204:207], a[172:175], v[96:99]
  v_exp_f32 v49, v153
  v_mfma_f32_16x16x32_bf16 v[112:115], a[204:207], a[188:191], v[112:115]
  s_waitcnt lgkmcnt(4)
  v_pk_maximum3_f16 v11, v11, v230, v231
  v_mfma_f32_16x16x32_bf16 v[68:71], a[208:211], a[128:131], v[16:19]
  ds_read_b128 a[240:243], v3 offset:12288
  v_cvt_pk_bf16_f32 v236, v48, v49
  v_mfma_f32_16x16x32_bf16 v[84:87], a[208:211], a[144:147], v[20:23]
  v_exp_f32 v50, v154
  v_mfma_f32_16x16x32_bf16 v[100:103], a[208:211], a[160:163], v[24:27]
  v_exp_f32 v51, v155
  v_mfma_f32_16x16x32_bf16 v[116:119], a[208:211], a[176:179], v[28:31]
  v_exp_f32 v52, v156
  v_mfma_f32_16x16x32_bf16 v[68:71], a[212:215], a[132:135], v[68:71]
  ds_read_b128 a[244:247], v3 offset:13312
  v_mfma_f32_16x16x32_bf16 v[84:87], a[212:215], a[148:151], v[84:87]
  v_exp_f32 v53, v157
  v_mfma_f32_16x16x32_bf16 v[100:103], a[212:215], a[164:167], v[100:103]
  v_cvt_pk_bf16_f32 v237, v50, v51
  v_mfma_f32_16x16x32_bf16 v[116:119], a[212:215], a[180:183], v[116:119]
  v_pk_maximum3_f16 v11, v11, v236, v237
  v_mfma_f32_16x16x32_bf16 v[68:71], a[216:219], a[136:139], v[68:71]
  ds_read_b128 a[248:251], v3 offset:14336
  v_cvt_pk_bf16_f32 v238, v52, v53
  v_mfma_f32_16x16x32_bf16 v[84:87], a[216:219], a[152:155], v[84:87]
  v_exp_f32 v54, v158
  v_mfma_f32_16x16x32_bf16 v[100:103], a[216:219], a[168:171], v[100:103]
  v_exp_f32 v55, v159
  v_mfma_f32_16x16x32_bf16 v[116:119], a[216:219], a[184:187], v[116:119]
  v_exp_f32 v48, v168
  v_mfma_f32_16x16x32_bf16 v[68:71], a[220:223], a[140:143], v[68:71]
  ds_read_b128 a[252:255], v3 offset:15360
  v_mfma_f32_16x16x32_bf16 v[84:87], a[220:223], a[156:159], v[84:87]
  v_exp_f32 v49, v169
  v_mfma_f32_16x16x32_bf16 v[100:103], a[220:223], a[172:175], v[100:103]
  v_add_u32 v4, s34, v2
  v_cvt_pk_bf16_f32 v239, v54, v55
  v_mfma_f32_16x16x32_bf16 v[116:119], a[220:223], a[188:191], v[116:119]
  s_add_u32 s34, s34, 16384
  s_and_b32 s34, s34, 0xffff
  s_waitcnt vmcnt(0)
  s_barrier
  s_waitcnt lgkmcnt(4)
  v_mfma_f32_16x16x32_bf16 v[72:75], a[224:227], a[128:131], v[16:19]
  ds_read_b128 a[192:195], v4 offset:0
  v_pk_maximum3_f16 v11, v11, v238, v239
  v_mfma_f32_16x16x32_bf16 v[88:91], a[224:227], a[144:147], v[20:23]
  s_cmp_lt_i32 s28, 0
  s_cselect_b32 s63, s60, 0
  v_cvt_pk_bf16_f32 v244, v48, v49
  v_mfma_f32_16x16x32_bf16 v[104:107], a[224:227], a[160:163], v[24:27]
  s_add_u32 s63, s63, s28
  v_exp_f32 v50, v170
  v_mfma_f32_16x16x32_bf16 v[120:123], a[224:227], a[176:179], v[28:31]
  s_add_u32 s63, s63, 16384
  v_exp_f32 v51, v171
  v_mfma_f32_16x16x32_bf16 v[72:75], a[228:231], a[132:135], v[72:75]
  ds_read_b128 a[196:199], v4 offset:1024
  s_cmp_ge_i32 s28, s61
  s_cselect_b32 s10, s35, 0
  s_mov_b32 m0, s30
  v_mfma_f32_16x16x32_bf16 v[88:91], a[228:231], a[148:151], v[88:91]
  buffer_load_dwordx4 v5, s[8:11], s63 offen offset:0 lds
  v_mfma_f32_16x16x32_bf16 v[104:107], a[228:231], a[164:167], v[104:107]
  v_exp_f32 v52, v172
  v_mfma_f32_16x16x32_bf16 v[120:123], a[228:231], a[180:183], v[120:123]
  v_exp_f32 v53, v173
  v_mfma_f32_16x16x32_bf16 v[72:75], a[232:235], a[136:139], v[72:75]
  ds_read_b128 a[200:203], v4 offset:2048
  v_cvt_pk_bf16_f32 v245, v50, v51
  v_mfma_f32_16x16x32_bf16 v[88:91], a[232:235], a[152:155], v[88:91]
  v_pk_maximum3_f16 v11, v11, v244, v245
  v_cvt_pk_bf16_f32 v246, v52, v53
  v_mfma_f32_16x16x32_bf16 v[104:107], a[232:235], a[168:171], v[104:107]
  v_exp_f32 v54, v174
  v_mfma_f32_16x16x32_bf16 v[120:123], a[232:235], a[184:187], v[120:123]
  v_exp_f32 v55, v175
  v_mfma_f32_16x16x32_bf16 v[72:75], a[236:239], a[140:143], v[72:75]
  ds_read_b128 a[204:207], v4 offset:3072
  v_cvt_pk_bf16_f32 v247, v54, v55
  v_mfma_f32_16x16x32_bf16 v[88:91], a[236:239], a[156:159], v[88:91]
  v_exp_f32 v48, v184
  v_mfma_f32_16x16x32_bf16 v[104:107], a[236:239], a[172:175], v[104:107]
  v_exp_f32 v49, v185
  v_mfma_f32_16x16x32_bf16 v[120:123], a[236:239], a[188:191], v[120:123]
  s_waitcnt lgkmcnt(4)
  v_pk_maximum3_f16 v11, v11, v246, v247
  v_cvt_pk_bf16_f32 v252, v48, v49
  v_mfma_f32_16x16x32_bf16 v[76:79], a[240:243], a[128:131], v[16:19]
  ds_read_b128 a[208:211], v4 offset:4096
  v_mfma_f32_16x16x32_bf16 v[92:95], a[240:243], a[144:147], v[20:23]
  buffer_load_dwordx4 v5, s[8:11], s63 offen offset:1024 lds
  v_mfma_f32_16x16x32_bf16 v[108:111], a[240:243], a[160:163], v[24:27]
  v_exp_f32 v50, v186
  v_mfma_f32_16x16x32_bf16 v[124:127], a[240:243], a[176:179], v[28:31]
  v_exp_f32 v51, v187
  v_mfma_f32_16x16x32_bf16 v[76:79], a[244:247], a[132:135], v[76:79]
  ds_read_b128 a[212:215], v4 offset:5120
  v_cvt_pk_bf16_f32 v253, v50, v51
  v_mfma_f32_16x16x32_bf16 v[92:95], a[244:247], a[148:151], v[92:95]
  v_exp_f32 v52, v188
  v_mfma_f32_16x16x32_bf16 v[108:111], a[244:247], a[164:167], v[108:111]
  v_exp_f32 v53, v189
  v_mfma_f32_16x16x32_bf16 v[124:127], a[244:247], a[180:183], v[124:127]
  v_pk_maximum3_f16 v11, v11, v252, v253
  v_cvt_pk_bf16_f32 v254, v52, v53
  v_mfma_f32_16x16x32_bf16 v[76:79], a[248:251], a[136:139], v[76:79]
  ds_read_b128 a[216:219], v4 offset:6144
  v_mfma_f32_16x16x32_bf16 v[92:95], a[248:251], a[152:155], v[92:95]
  v_exp_f32 v54, v190
  v_mfma_f32_16x16x32_bf16 v[108:111], a[248:251], a[168:171], v[108:111]
  v_exp_f32 v55, v191
  v_mfma_f32_16x16x32_bf16 v[124:127], a[248:251], a[184:187], v[124:127]
  s_nop 0
  v_cvt_pk_bf16_f32 v255, v54, v55
  v_mfma_f32_16x16x32_bf16 v[76:79], a[252:255], a[140:143], v[76:79]
  ds_read_b128 a[220:223], v4 offset:7168
  v_pk_maximum3_f16 v11, v11, v254, v255
  v_mfma_f32_16x16x32_bf16 v[92:95], a[252:255], a[156:159], v[92:95]
  buffer_load_dwordx4 v5, s[8:11], s63 offen offset:2048 lds
  v_mfma_f32_16x16x32_bf16 v[108:111], a[252:255], a[172:175], v[108:111]
  v_mfma_f32_16x16x32_bf16 v[124:127], a[252:255], a[188:191], v[124:127]
  s_waitcnt lgkmcnt(4)
  v_lshrrev_b32 v56, 16, v11
  v_and_b32 v57, 0xffff, v11
  v_max_u32 v56, v56, v57
  v_cmp_lt_u32 vcc, 0x4e80, v56
  s_nop 1
  s_cbranch_vccnz K2_rare_D
K2_ret_D:
  v_mfma_f32_16x16x32_bf16 a[0:3], a[192:195], v[224:227], a[0:3]
  ds_read_b128 a[224:227], v4 offset:8192
  v_cmp_gt_i32_e64 s[40:41], 0, v7
  v_mfma_f32_16x16x32_bf16 a[32:35], a[192:195], v[232:235], a[32:35]
  v_cmp_gt_i32_e64 s[42:43], 1, v7
  v_cmp_gt_i32_e64 s[44:45], 2, v7
  v_mfma_f32_16x16x32_bf16 a[64:67], a[192:195], v[240:243], a[64:67]
  v_cndmask_b32_e64 v96, v96, v8, s[40:41]
  v_cndmask_b32_e64 v97, v97, v8, s[42:43]
  v_mfma_f32_16x16x32_bf16 a[96:99], a[192:195], v[248:251], a[96:99]
  v_cndmask_b32_e64 v98, v98, v8, s[44:45]
  v_cmp_gt_i32_e64 s[40:41], 3, v7
  v_mfma_f32_16x16x32_bf16 v[32:35], v[60:63], v[224:227], v[32:35]
  ds_read_b128 a[228:231], v4 offset:9216
  v_cmp_gt_i32_e64 s[42:43], 0, v10
  v_cmp_gt_i32_e64 s[44:45], 1, v10
  v_mfma_f32_16x16x32_bf16 a[4:7], a[196:199], v[224:227], a[4:7]
  v_cndmask_b32_e64 v99, v99, v8, s[40:41]
  v_cndmask_b32_e64 v112, v112, v8, s[42:43]
  v_mfma_f32_16x16x32_bf16 a[36:39], a[196:199], v[232:235], a[36:39]
  v_cndmask_b32_e64 v113, v113, v8, s[44:45]
  v_cmp_gt_i32_e64 s[40:41], 2, v10
  v_mfma_f32_16x16x32_bf16 a[68:71], a[196:199], v[240:243], a[68:71]
  v_cmp_gt_i32_e64 s[42:43], 3, v10
  v_cmp_gt_i32_e64 s[44:45], 16, v7
  v_cndmask_b32_e64 v114, v114, v8, s[40:41]
  v_mfma_f32_16x16x32_bf16 a[100:103], a[196:199], v[248:251], a[100:103]
  v_cndmask_b32_e64 v115, v115, v8, s[42:43]
  v_cndmask_b32_e64 v100, v100, v8, s[44:45]
  v_mfma_f32_16x16x32_bf16 a[8:11], a[200:203], v[224:227], a[8:11]
  ds_read_b128 a[232:235], v4 offset:10240
  v_cmp_gt_i32_e64 s[40:41], 17, v7
  v_cmp_gt_i32_e64 s[42:43], 18, v7
  v_mfma_f32_16x16x32_bf16 a[40:43], a[200:203], v[232:235], a[40:43]
  buffer_load_dwordx4 v5, s[8:11], s63 offen offset:3072 lds
  v_cmp_gt_i32_e64 s[44:45], 19, v7
  v_mfma_f32_16x16x32_bf16 a[72:75], a[200:203], v[240:243], a[72:75]
  s_add_u32 s30, s30, 16384
  v_cndmask_b32_e64 v101, v101, v8, s[40:41]
  v_cndmask_b32_e64 v102, v102, v8, s[42:43]
  v_cndmask_b32_e64 v103, v103, v8, s[44:45]
  v_mfma_f32_16x16x32_bf16 a[104:107], a[200:203], v[248:251], a[104:107]
  s_and_b32 s30, s30, 0xffff
  v_cmp_gt_i32_e64 s[40:41], 16, v10
  v_cmp_gt_i32_e64 s[42:43], 17, v10
  v_mfma_f32_16x16x32_bf16 v[36:39], v[60:63], v[232:235], v[36:39]
  ds_read_b128 a[236:239], v4 offset:11264
  v_cmp_gt_i32_e64 s[44:45], 18, v10
  v_cndmask_b32_e64 v116, v116, v8, s[40:41]
  v_mfma_f32_16x16x32_bf16 a[12:15], a[204:207], v[224:227], a[12:15]
  s_cmp_lt_i32 s29, 0
  s_cselect_b32 s62, s60, 0
  v_cndmask_b32_e64 v117, v117, v8, s[42:43]
  v_cndmask_b32_e64 v118, v118, v8, s[44:45]
  v_mfma_f32_16x16x32_bf16 a[44:47], a[204:207], v[232:235], a[44:47]
  s_add_u32 s62, s62, s29
  v_cmp_gt_i32_e64 s[40:41], 19, v10
  v_cmp_gt_i32_e64 s[42:43], 32, v7
  v_cmp_gt_i32_e64 s[44:45], 33, v7
  v_mfma_f32_16x16x32_bf16 a[76:79], a[204:207], v[240:243], a[76:79]
  s_cmp_ge_i32 s29, s61
  s_cselect_b32 s10, s35, 0
  v_cndmask_b32_e64 v119, v119, v8, s[40:41]
  v_cndmask_b32_e64 v104, v104, v8, s[42:43]
  v_mfma_f32_16x16x32_bf16 a[108:111], a[204:207], v[248:251], a[108:111]
  s_waitcnt lgkmcnt(4)
  v_cndmask_b32_e64 v105, v105, v8, s[44:45]
  v_cmp_gt_i32_e64 s[40:41], 34, v7
  v_mfma_f32_16x16x32_bf16 a[16:19], a[208:211], v[224:227], a[16:19]
  ds_read_b128 a[240:243], v4 offset:12288
  v_cmp_gt_i32_e64 s[42:43], 35, v7
  v_cmp_gt_i32_e64 s[44:45], 32, v10
  v_mfma_f32_16x16x32_bf16 a[48:51], a[208:211], v[232:235], a[48:51]
  s_mov_b32 m0, s31
  v_cndmask_b32_e64 v106, v106, v8, s[40:41]
  v_cndmask_b32_e64 v107, v107, v8, s[42:43]
  v_mfma_f32_16x16x32_bf16 a[80:83], a[208:211], v[240:243], a[80:83]
  v_cndmask_b32_e64 v120, v120, v8, s[44:45]
  v_cmp_gt_i32_e64 s[40:41], 33, v10
  v_mfma_f32_16x16x32_bf16 a[112:115], a[208:211], v[248:251], a[112:115]
  buffer_load_dwordx4 v5, s[8:11], s62 offen offset:0 lds
  v_cmp_gt_i32_e64 s[42:43], 34, v10
  v_mfma_f32_16x16x32_bf16 v[40:43], v[60:63], v[240:243], v[40:43]
  ds_read_b128 a[244:247], v4 offset:13312
  v_cmp_gt_i32_e64 s[44:45], 35, v10
  v_cndmask_b32_e64 v121, v121, v8, s[40:41]
  v_mfma_f32_16x16x32_bf16 a[20:23], a[212:215], v[224:227], a[20:23]
  v_cndmask_b32_e64 v122, v122, v8, s[42:43]
  v_cndmask_b32_e64 v123, v123, v8, s[44:45]
  v_cmp_gt_i32_e64 s[40:41], 48, v7
  v_mfma_f32_16x16x32_bf16 a[52:55], a[212:215], v[232:235], a[52:55]
  v_cmp_gt_i32_e64 s[42:43], 49, v7
  v_cmp_gt_i32_e64 s[44:45], 50, v7
  v_cndmask_b32_e64 v108, v108, v8, s[40:41]
  v_mfma_f32_16x16x32_bf16 a[84:87], a[212:215], v[240:243], a[84:87]
  v_cndmask_b32_e64 v109, v109, v8, s[42:43]
  v_cndmask_b32_e64 v110, v110, v8, s[44:45]
  v_mfma_f32_16x16x32_bf16 a[116:119], a[212:215], v[248:251], a[116:119]
  v_cmp_gt_i32_e64 s[40:41], 51, v7
  v_cmp_gt_i32_e64 s[42:43], 48, v10
  v_mfma_f32_16x16x32_bf16 a[24:27], a[216:219], v[224:227], a[24:27]
  ds_read_b128 a[248:251], v4 offset:14336
  v_cmp_gt_i32_e64 s[44:45], 49, v10
  v_cndmask_b32_e64 v111, v111, v8, s[40:41]
  v_mfma_f32_16x16x32_bf16 a[56:59], a[216:219], v[232:235], a[56:59]
  v_cndmask_b32_e64 v124, v124, v8, s[42:43]
  v_cndmask_b32_e64 v125, v125, v8, s[44:45]
  v_cmp_gt_i32_e64 s[40:41], 50, v10
  v_mfma_f32_16x16x32_bf16 a[88:91], a[216:219], v[240:243], a[88:91]
  v_cmp_gt_i32_e64 s[42:43], 51, v10
  s_nop 0
  v_mfma_f32_16x16x32_bf16 a[120:123], a[216:219], v[248:251], a[120:123]
  v_cndmask_b32_e64 v126, v126, v8, s[40:41]
  v_cndmask_b32_e64 v127, v127, v8, s[42:43]
  v_mfma_f32_16x16x32_bf16 v[44:47], v[60:63], v[248:251], v[44:47]
  ds_read_b128 a[252:255], v4 offset:15360
  v_exp_f32 v48, v64
  v_mfma_f32_16x16x32_bf16 a[28:31], a[220:223], v[224:227], a[28:31]
  s_add_u32 s33, s33, 16384
  s_cmp_eq_u32 s33, 163840
  s_cselect_b32 s33, 65536, s33
  v_mfma_f32_16x16x32_bf16 a[60:63], a[220:223], v[232:235], a[60:63]
  buffer_load_dwordx4 v5, s[8:11], s62 offen offset:1024 lds
  v_exp_f32 v49, v65
  v_mfma_f32_16x16x32_bf16 a[92:95], a[220:223], v[240:243], a[92:95]
  v_exp_f32 v50, v66
  v_cvt_pk_bf16_f32 v192, v48, v49
  v_mfma_f32_16x16x32_bf16 a[124:127], a[220:223], v[248:251], a[124:127]
  v_exp_f32 v51, v67
  v_add_u32 v3, s33, v2
  s_waitcnt lgkmcnt(4)
  v_mfma_f32_16x16x32_bf16 a[0:3], a[224:227], v[228:231], a[0:3]
  ds_read_b128 a[192:195], v3 offset:0
  v_exp_f32 v52, v68
  v_mfma_f32_16x16x32_bf16 a[32:35], a[224:227], v[236:239], a[32:35]
  v_exp_f32 v53, v69
  v_cvt_pk_bf16_f32 v193, v50, v51
  v_mfma_f32_16x16x32_bf16 a[64:67], a[224:227], v[244:247], a[64:67]
  v_pk_maximum3_f16 v11, v192, v192, v193
  v_exp_f32 v54, v70
  v_mfma_f32_16x16x32_bf16 a[96:99], a[224:227], v[252:255], a[96:99]
  v_exp_f32 v55, v71
  v_mfma_f32_16x16x32_bf16 v[32:35], v[60:63], v[228:231], v[32:35]
  ds_read_b128 a[196:199], v3 offset:1024
  v_cvt_pk_bf16_f32 v194, v52, v53
  v_cvt_pk_bf16_f32 v195, v54, v55
  v_mfma_f32_16x16x32_bf16 a[4:7], a[228:231], v[228:231], a[4:7]
  v_exp_f32 v48, v80
  v_mfma_f32_16x16x32_bf16 a[36:39], a[228:231], v[236:239], a[36:39]
  v_exp_f32 v49, v81
  v_mfma_f32_16x16x32_bf16 a[68:71], a[228:231], v[244:247], a[68:71]
  v_pk_maximum3_f16 v11, v11, v194, v195
  v_exp_f32 v50, v82
  v_mfma_f32_16x16x32_bf16 a[100:103], a[228:231], v[252:255], a[100:103]
  v_exp_f32 v51, v83
  v_mfma_f32_16x16x32_bf16 a[8:11], a[232:235], v[228:231], a[8:11]
  ds_read_b128 a[200:203], v3 offset:2048
  v_cvt_pk_bf16_f32 v200, v48, v49
  v_cvt_pk_bf16_f32 v201, v50, v51
  v_mfma_f32_16x16x32_bf16 a[40:43], a[232:235], v[236:239], a[40:43]
  buffer_load_dwordx4 v5, s[8:11], s62 offen offset:2048 lds
  v_pk_maximum3_f16 v11, v11, v200, v201
  v_mfma_f32_16x16x32_bf16 a[72:75], a[232:235], v[244:247], a[72:75]
  v_exp_f32 v52, v84
  v_mfma_f32_16x16x32_bf16 a[104:107], a[232:235], v[252:255], a[104:107]
  v_exp_f32 v53, v85
  v_mfma_f32_16x16x32_bf16 v[36:39], v[60:63], v[236:239], v[36:39]
  ds_read_b128 a[204:207], v3 offset:3072
  v_exp_f32 v54, v86
  v_mfma_f32_16x16x32_bf16 a[12:15], a[236:239], v[228:231], a[12:15]
  v_exp_f32 v55, v87
  v_cvt_pk_bf16_f32 v202, v52, v53
  v_mfma_f32_16x16x32_bf16 a[44:47], a[236:239], v[236:239], a[44:47]
  v_exp_f32 v48, v96
  v_cvt_pk_bf16_f32 v203, v54, v55
  v_mfma_f32_16x16x32_bf16 a[76:79], a[236:239], v[244:247], a[76:79]
  v_exp_f32 v49, v97
  v_mfma_f32_16x16x32_bf16 a[108:111], a[236:239], v[252:255], a[108:111]
  s_waitcnt lgkmcnt(4)
  v_pk_maximum3_f16 v11, v11, v202, v203
  v_cvt_pk_bf16_f32 v208, v48, v49
  v_mfma_f32_16x16x32_bf16 a[16:19], a[240:243], v[228:231], a[16:19]
  ds_read_b128 a[208:211], v3 offset:4096
  v_exp_f32 v50, v98
  v_mfma_f32_16x16x32_bf16 a[48:51], a[240:243], v[236:239], a[48:51]
  v_exp_f32 v51, v99
  v_mfma_f32_16x16x32_bf16 a[80:83], a[240:243], v[244:247], a[80:83]
  v_exp_f32 v52, v100
  v_mfma_f32_16x16x32_bf16 a[112:115], a[240:243], v[252:255], a[112:115]
  buffer_load_dwordx4 v5, s[8:11], s62 offen offset:3072 lds
  v_exp_f32 v53, v101
  v_mfma_f32_16x16x32_bf16 v[40:43], v[60:63], v[244:247], v[40:43]
  ds_read_b128 a[212:215], v3 offset:5120
  s_add_u32 s31, s31, 16384
  s_cmp_eq_u32 s31, s32
  s_cselect_b32 s31, s47, s31
  s_add_u32 s28, s28, 0x8000
  s_sub_u32 s29, s28, 131072
  v_mfma_f32_16x16x32_bf16 a[20:23], a[244:247], v[228:231], a[20:23]
  v_cvt_pk_bf16_f32 v209, v50, v51
  v_pk_maximum3_f16 v11, v11, v208, v209
  v_exp_f32 v54, v102
  v_mfma_f32_16x16x32_bf16 a[52:55], a[244:247], v[236:239], a[52:55]
  v_exp_f32 v55, v103
  v_cvt_pk_bf16_f32 v210, v52, v53
  v_mfma_f32_16x16x32_bf16 a[84:87], a[244:247], v[244:247], a[84:87]
  v_exp_f32 v48, v112
  v_mfma_f32_16x16x32_bf16 a[116:119], a[244:247], v[252:255], a[116:119]
  v_exp_f32 v49, v113
  v_mfma_f32_16x16x32_bf16 a[24:27], a[248:251], v[228:231], a[24:27]
  ds_read_b128 a[216:219], v3 offset:6144
  v_cvt_pk_bf16_f32 v211, v54, v55
  v_pk_maximum3_f16 v11, v11, v210, v211
  v_mfma_f32_16x16x32_bf16 a[56:59], a[248:251], v[236:239], a[56:59]
  v_exp_f32 v50, v114
  v_cvt_pk_bf16_f32 v216, v48, v49
  v_mfma_f32_16x16x32_bf16 a[88:91], a[248:251], v[244:247], a[88:91]
  v_exp_f32 v51, v115
  v_mfma_f32_16x16x32_bf16 a[120:123], a[248:251], v[252:255], a[120:123]
  v_exp_f32 v52, v116
  v_mfma_f32_16x16x32_bf16 v[44:47], v[60:63], v[252:255], v[44:47]
  ds_read_b128 a[220:223], v3 offset:7168
  v_exp_f32 v53, v117
  v_mfma_f32_16x16x32_bf16 a[28:31], a[252:255], v[228:231], a[28:31]
  v_cvt_pk_bf16_f32 v217, v50, v51
  v_pk_maximum3_f16 v11, v11, v216, v217
  v_mfma_f32_16x16x32_bf16 a[60:63], a[252:255], v[236:239], a[60:63]
  v_exp_f32 v54, v118
  v_mfma_f32_16x16x32_bf16 a[92:95], a[252:255], v[244:247], a[92:95]
  v_exp_f32 v55, v119
  v_mfma_f32_16x16x32_bf16 a[124:127], a[252:255], v[252:255], a[124:127]
  v_cvt_pk_bf16_f32 v218, v52, v53
  s_nop 0
  v_cvt_pk_bf16_f32 v219, v54, v55
  v_pk_maximum3_f16 v11, v11, v218, v219
  s_mov_b32 s37, s4
  s_cmp_eq_u32 s37, 0
  s_cbranch_scc1 K2_H
K2_loop2:
  s_waitcnt lgkmcnt(4)
  v_mfma_f32_16x16x32_bf16 v[128:131], a[192:195], a[128:131], v[16:19]
  ds_read_b128 a[224:227], v3 offset:8192
  v_mfma_f32_16x16x32_bf16 v[144:147], a[192:195], a[144:147], v[20:23]
  v_exp_f32 v48, v72
  v_mfma_f32_16x16x32_bf16 v[160:163], a[192:195], a[160:163], v[24:27]
  v_exp_f32 v49, v73
  v_mfma_f32_16x16x32_bf16 v[176:179], a[192:195], a[176:179], v[28:31]
  v_exp_f32 v50, v74
  v_mfma_f32_16x16x32_bf16 v[128:131], a[196:199], a[132:135], v[128:131]
  ds_read_b128 a[228:231], v3 offset:9216
  v_cvt_pk_bf16_f32 v196, v48, v49
  v_mfma_f32_16x16x32_bf16 v[144:147], a[196:199], a[148:151], v[144:147]
  v_exp_f32 v51, v75
  v_mfma_f32_16x16x32_bf16 v[160:163], a[196:199], a[164:167], v[160:163]
  v_exp_f32 v52, v76
  v_mfma_f32_16x16x32_bf16 v[176:179], a[196:199], a[180:183], v[176:179]
  v_exp_f32 v53, v77
  v_mfma_f32_16x16x32_bf16 v[128:131], a[200:203], a[136:139], v[128:131]
  ds_read_b128 a[232:235], v3 offset:10240
  v_cvt_pk_bf16_f32 v197, v50, v51
  v_mfma_f32_16x16x32_bf16 v[144:147], a[200:203], a[152:155], v[144:147]
  v_pk_maximum3_f16 v11, v11, v196, v197
  v_cvt_pk_bf16_f32 v198, v52, v53
  v_mfma_f32_16x16x32_bf16 v[160:163], a[200:203], a[168:171], v[160:163]
  v_exp_f32 v54, v78
  v_mfma_f32_16x16x32_bf16 v[176:179], a[200:203], a[184:187], v[176:179]
  v_exp_f32 v55, v79
  v_mfma_f32_16x16x32_bf16 v[128:131], a[204:207], a[140:143], v[128:131]
  ds_read_b128 a[236:239], v3 offset:11264
  v_cvt_pk_bf16_f32 v199, v54, v55
  v_mfma_f32_16x16x32_bf16 v[144:147], a[204:207], a[156:159], v[144:147]
  v_exp_f32 v48, v88
  v_mfma_f32_16x16x32_bf16 v[160:163], a[204:207], a[172:175], v[160:163]
  v_exp_f32 v49, v89
  v_mfma_f32_16x16x32_bf16 v[176:179], a[204:207], a[188:191], v[176:179]
  s_waitcnt lgkmcnt(4)
  v_pk_maximum3_f16 v11, v11, v198, v199
  v_mfma_f32_16x16x32_bf16 v[132:135], a[208:211], a[128:131], v[16:19]
  ds_read_b128 a[240:243], v3 offset:12288
  v_cvt_pk_bf16_f32 v204, v48, v49
  v_mfma_f32_16x16x32_bf16 v[148:151], a[208:211], a[144:147], v[20:23]
  v_exp_f32 v50, v90
  v_mfma_f32_16x16x32_bf16 v[164:167], a[208:211], a[160:163], v[24:27]
  v_exp_f32 v51, v91
  v_mfma_f32_16x16x32_bf16 v[180:183], a[208:211], a[176:179], v[28:31]
  v_exp_f32 v52, v92
  v_mfma_f32_16x16x32_bf16 v[132:135], a[212:215], a[132:135], v[132:135]
  ds_read_b128 a[244:247], v3 offset:13312
  v_mfma_f32_16x16x32_bf16 v[148:151], a[212:215], a[148:151], v[148:151]
  v_exp_f32 v53, v93
  v_mfma_f32_16x16x32_bf16 v[164:167], a[212:215], a[164:167], v[164:167]
  v_cvt_pk_bf16_f32 v205, v50, v51
  v_mfma_f32_16x16x32_bf16 v[180:183], a[212:215], a[180:183], v[180:183]
  v_pk_maximum3_f16 v11, v11, v204, v205
  v_mfma_f32_16x16x32_bf16 v[132:135], a[216:219], a[136:139], v[132:135]
  ds_read_b128 a[248:251], v3 offset:14336
  v_cvt_pk_bf16_f32 v206, v52, v53
  v_mfma_f32_16x16x32_bf16 v[148:151], a[216:219], a[152:155], v[148:151]
  v_exp_f32 v54, v94
  v_mfma_f32_16x16x32_bf16 v[164:167], a[216:219], a[168:171], v[164:167]
  v_exp_f32 v55, v95
  v_mfma_f32_16x16x32_bf16 v[180:183], a[216:219], a[184:187], v[180:183]
  v_exp_f32 v48, v104
  v_mfma_f32_16x16x32_bf16 v[132:135], a[220:223], a[140:143], v[132:135]
  ds_read_b128 a[252:255], v3 offset:15360
  v_mfma_f32_16x16x32_bf16 v[148:151], a[220:223], a[156:159], v[148:151]
  v_exp_f32 v49, v105
  v_mfma_f32_16x16x32_bf16 v[164:167], a[220:223], a[172:175], v[164:167]
  v_add_u32 v4, s34, v2
  v_cvt_pk_bf16_f32 v207, v54, v55
  v_mfma_f32_16x16x32_bf16 v[180:183], a[220:223], a[188:191], v[180:183]
  s_add_u32 s34, s34, 16384
  s_and_b32 s34, s34, 0xffff
  s_waitcnt vmcnt(0)
  s_barrier
  s_waitcnt lgkmcnt(4)
  v_mfma_f32_16x16x32_bf16 v[136:139], a[224:227], a[128:131], v[16:19]
  ds_read_b128 a[192:195], v4 offset:0
  v_pk_maximum3_f16 v11, v11, v206, v207
  v_mfma_f32_16x16x32_bf16 v[152:155], a[224:227], a[144:147], v[20:23]
  s_cmp_lt_i32 s28, 0
  s_cselect_b32 s63, s60, 0
  v_cvt_pk_bf16_f32 v212, v48, v49
  v_mfma_f32_16x16x32_bf16 v[168:171], a[224:227], a[160:163], v[24:27]
  s_add_u32 s63, s63, s28
  v_exp_f32 v50, v106
  v_mfma_f32_16x16x32_bf16 v[184:187], a[224:227], a[176:179], v[28:31]
  s_add_u32 s63, s63, 16384
  v_exp_f32 v51, v107
  v_mfma_f32_16x16x32_bf16 v[136:139], a[228:231], a[132:135], v[136:139]
  ds_read_b128 a[196:199], v4 offset:1024
  s_cmp_ge_i32 s28, s61
  s_cselect_b32 s10, s35, 0
  s_mov_b32 m0, s30
  v_mfma_f32_16x16x32_bf16 v[152:155], a[228:231], a[148:151], v[152:155]
  buffer_load_dwordx4 v5, s[8:11], s63 offen offset:0 lds
  v_mfma_f32_16x16x32_bf16 v[168:171], a[228:231], a[164:167], v[168:171]
  v_exp_f32 v52, v108
  v_mfma_f32_16x16x32_bf16 v[184:187], a[228:231], a[180:183], v[184:187]
  v_exp_f32 v53, v109
  v_mfma_f32_16x16x32_bf16 v[136:139], a[232:235], a[136:139], v[136:139]
  ds_read_b128 a[200:203], v4 offset:2048
  v_cvt_pk_bf16_f32 v213, v50, v51
  v_mfma_f32_16x16x32_bf16 v[152:155], a[232:235], a[152:155], v[152:155]
  v_pk_maximum3_f16 v11, v11, v212, v213
  v_cvt_pk_bf16_f32 v214, v52, v53
  v_mfma_f32_16x16x32_bf16 v[168:171], a[232:235], a[168:171], v[168:171]
  v_exp_f32 v54, v110
  v_mfma_f32_16x16x32_bf16 v[184:187], a[232:235], a[184:187], v[184:187]
  v_exp_f32 v55, v111
  v_mfma_f32_16x16x32_bf16 v[136:139], a[236:239], a[140:143], v[136:139]
  ds_read_b128 a[204:207], v4 offset:3072
  v_cvt_pk_bf16_f32 v215, v54, v55
  v_mfma_f32_16x16x32_bf16 v[152:155], a[236:239], a[156:159], v[152:155]
  v_exp_f32 v48, v120
  v_mfma_f32_16x16x32_bf16 v[168:171], a[236:239], a[172:175], v[168:171]
  v_exp_f32 v49, v121
  v_mfma_f32_16x16x32_bf16 v[184:187], a[236:239], a[188:191], v[184:187]
  s_waitcnt lgkmcnt(4)
  v_pk_maximum3_f16 v11, v11, v214, v215
  v_cvt_pk_bf16_f32 v220, v48, v49
  v_mfma_f32_16x16x32_bf16 v[140:143], a[240:243], a[128:131], v[16:19]
  ds_read_b128 a[208:211], v4 offset:4096
  v_mfma_f32_16x16x32_bf16 v[156:159], a[240:243], a[144:147], v[20:23]
  buffer_load_dwordx4 v5, s[8:11], s63 offen offset:1024 lds
  v_mfma_f32_16x16x32_bf16 v[172:175], a[240:243], a[160:163], v[24:27]
  v_exp_f32 v50, v122
  v_mfma_f32_16x16x32_bf16 v[188:191], a[240:243], a[176:179], v[28:31]
  v_exp_f32 v51, v123
  v_mfma_f32_16x16x32_bf16 v[140:143], a[244:247], a[132:135], v[140:143]
  ds_read_b128 a[212:215], v4 offset:5120
  v_cvt_pk_bf16_f32 v221, v50, v51
  v_mfma_f32_16x16x32_bf16 v[156:159], a[244:247], a[148:151], v[156:159]
  v_exp_f32 v52, v124
  v_mfma_f32_16x16x32_bf16 v[172:175], a[244:247], a[164:167], v[172:175]
  v_exp_f32 v53, v125
  v_mfma_f32_16x16x32_bf16 v[188:191], a[244:247], a[180:183], v[188:191]
  v_pk_maximum3_f16 v11, v11, v220, v221
  v_cvt_pk_bf16_f32 v222, v52, v53
  v_mfma_f32_16x16x32_bf16 v[140:143], a[248:251], a[136:139], v[140:143]
  ds_read_b128 a[216:219], v4 offset:6144
  v_mfma_f32_16x16x32_bf16 v[156:159], a[248:251], a[152:155], v[156:159]
  v_exp_f32 v54, v126
  v_mfma_f32_16x16x32_bf16 v[172:175], a[248:251], a[168:171], v[172:175]
  v_exp_f32 v55, v127
  v_mfma_f32_16x16x32_bf16 v[188:191], a[248:251], a[184:187], v[188:191]
  s_nop 0
  v_cvt_pk_bf16_f32 v223, v54, v55
  v_mfma_f32_16x16x32_bf16 v[140:143], a[252:255], a[140:143], v[140:143]
  ds_read_b128 a[220:223], v4 offset:7168
  v_pk_maximum3_f16 v11, v11, v222, v223
  v_mfma_f32_16x16x32_bf16 v[156:159], a[252:255], a[156:159], v[156:159]
  buffer_load_dwordx4 v5, s[8:11], s63 offen offset:2048 lds
  v_mfma_f32_16x16x32_bf16 v[172:175], a[252:255], a[172:175], v[172:175]
  v_mfma_f32_16x16x32_bf16 v[188:191], a[252:255], a[188:191], v[188:191]
  s_waitcnt lgkmcnt(4)
  v_lshrrev_b32 v56, 16, v11
  v_and_b32 v57, 0xffff, v11
  v_max_u32 v56, v56, v57
  v_cmp_lt_u32 vcc, 0x4e80, v56
  s_nop 1
  s_cbranch_vccnz K2_rare_E
K2_ret_E:
  v_mfma_f32_16x16x32_bf16 a[0:3], a[192:195], v[192:195], a[0:3]
  ds_read_b128 a[224:227], v4 offset:8192
  v_mfma_f32_16x16x32_bf16 a[32:35], a[192:195], v[200:203], a[32:35]
  v_exp_f32 v48, v128
  v_mfma_f32_16x16x32_bf16 a[64:67], a[192:195], v[208:211], a[64:67]
  v_exp_f32 v49, v129
  v_mfma_f32_16x16x32_bf16 a[96:99], a[192:195], v[216:219], a[96:99]
  v_exp_f32 v50, v130
  v_mfma_f32_16x16x32_bf16 v[32:35], v[60:63], v[192:195], v[32:35]
  ds_read_b128 a[228:231], v4 offset:9216
  v_cvt_pk_bf16_f32 v224, v48, v49
  v_mfma_f32_16x16x32_bf16 a[4:7], a[196:199], v[192:195], a[4:7]
  v_exp_f32 v51, v131
  v_mfma_f32_16x16x32_bf16 a[36:39], a[196:199], v[200:203], a[36:39]
  v_exp_f32 v52, v132
  v_mfma_f32_16x16x32_bf16 a[68:71], a[196:199], v[208:211], a[68:71]
  v_exp_f32 v53, v133
  v_mfma_f32_16x16x32_bf16 a[100:103], a[196:199], v[216:219], a[100:103]
  v_cvt_pk_bf16_f32 v225, v50, v51
  v_pk_maximum3_f16 v11, v224, v224, v225
  v_mfma_f32_16x16x32_bf16 a[8:11], a[200:203], v[192:195], a[8:11]
  ds_read_b128 a[232:235], v4 offset:10240
  v_cvt_pk_bf16_f32 v226, v52, v53
  v_mfma_f32_16x16x32_bf16 a[40:43], a[200:203], v[200:203], a[40:43]
  buffer_load_dwordx4 v5, s[8:11], s63 offen offset:3072 lds
  v_mfma_f32_16x16x32_bf16 a[72:75], a[200:203], v[208:211], a[72:75]
  s_add_u32 s30, s30, 16384
  v_exp_f32 v54, v134
  v_mfma_f32_16x16x32_bf16 a[104:107], a[200:203], v[216:219], a[104:107]
  s_and_b32 s30, s30, 0xffff
  v_exp_f32 v55, v135
  v_mfma_f32_16x16x32_bf16 v[36:39], v[60:63], v[200:203], v[36:39]
  ds_read_b128 a[236:239], v4 offset:11264
  v_cvt_pk_bf16_f32 v227, v54, v55
  v_mfma_f32_16x16x32_bf16 a[12:15], a[204:207], v[192:195], a[12:15]
  s_cmp_lt_i32 s29, 0
  s_cselect_b32 s62, s60, 0
  v_pk_maximum3_f16 v11, v11, v226, v227
  v_mfma_f32_16x16x32_bf16 a[44:47], a[204:207], v[200:203], a[44:47]
  s_add_u32 s62, s62, s29
  v_exp_f32 v48, v144
  v_mfma_f32_16x16x32_bf16 a[76:79], a[204:207], v[208:211], a[76:79]
  s_cmp_ge_i32 s29, s61
  s_cselect_b32 s10, s35, 0
  v_mfma_f32_16x16x32_bf16 a[108:111], a[204:207], v[216:219], a[108:111]
  s_waitcnt lgkmcnt(4)
  v_exp_f32 v49, v145
  v_mfma_f32_16x16x32_bf16 a[16:19], a[208:211], v[192:195], a[16:19]
  ds_read_b128 a[240:243], v4 offset:12288
  v_cvt_pk_bf16_f32 v232, v48, v49
  v_mfma_f32_16x16x32_bf16 a[48:51], a[208:211], v[200:203], a[48:51]
  s_mov_b32 m0, s31
  v_exp_f32 v50, v146
  v_mfma_f32_16x16x32_bf16 a[80:83], a[208:211], v[208:211], a[80:83]
  v_mfma_f32_16x16x32_bf16 a[112:115], a[208:211], v[216:219], a[112:115]
  buffer_load_dwordx4 v5, s[8:11], s62 offen offset:0 lds
  v_mfma_f32_16x16x32_bf16 v[40:43], v[60:63], v[208:211], v[40:43]
  ds_read_b128 a[244:247], v4 offset:13312
  v_mfma_f32_16x16x32_bf16 a[20:23], a[212:215], v[192:195], a[20:23]
  v_exp_f32 v51, v147
  v_mfma_f32_16x16x32_bf16 a[52:55], a[212:215], v[200:203], a[52:55]
  v_exp_f32 v52, v148
  v_mfma_f32_16x16x32_bf16 a[84:87], a[212:215], v[208:211], a[84:87]
  v_exp_f32 v53, v149
  v_mfma_f32_16x16x32_bf16 a[116:119], a[212:215], v[216:219], a[116:119]
  v_cvt_pk_bf16_f32 v233, v50, v51
  v_pk_maximum3_f16 v11, v11, v232, v233
  v_mfma_f32_16x16x32_bf16 a[24:27], a[216:219], v[192:195], a[24:27]
  ds_read_b128 a[248:251], v4 offset:14336
  v_cvt_pk_bf16_f32 v234, v52, v53
  v_mfma_f32_16x16x32_bf16 a[56:59], a[216:219], v[200:203], a[56:59]
  v_exp_f32 v54, v150
  v_mfma_f32_16x16x32_bf16 a[88:91], a[216:219], v[208:211], a[88:91]
  v_exp_f32 v55, v151
  v_mfma_f32_16x16x32_bf16 a[120:123], a[216:219], v[216:219], a[120:123]
  v_mfma_f32_16x16x32_bf16 v[44:47], v[60:63], v[216:219], v[44:47]
  ds_read_b128 a[252:255], v4 offset:15360
  v_cvt_pk_bf16_f32 v235, v54, v55
  v_mfma_f32_16x16x32_bf16 a[28:31], a[220:223], v[192:195], a[28:31]
  s_add_u32 s33, s33, 16384
  s_cmp_eq_u32 s33, 163840
  s_cselect_b32 s33, 65536, s33
  v_mfma_f32_16x16x32_bf16 a[60:63], a[220:223], v[200:203], a[60:63]
  buffer_load_dwordx4 v5, s[8:11], s62 offen offset:1024 lds
  v_mfma_f32_16x16x32_bf16 a[92:95], a[220:223], v[208:211], a[92:95]
  v_exp_f32 v48, v160
  v_mfma_f32_16x16x32_bf16 a[124:127], a[220:223], v[216:219], a[124:127]
  v_add_u32 v3, s33, v2
  s_waitcnt lgkmcnt(4)
  v_mfma_f32_16x16x32_bf16 a[0:3], a[224:227], v[196:199], a[0:3]
  ds_read_b128 a[192:195], v3 offset:0
  v_pk_maximum3_f16 v11, v11, v234, v235
  v_mfma_f32_16x16x32_bf16 a[32:35], a[224:227], v[204:207], a[32:35]
  v_exp_f32 v49, v161
  v_mfma_f32_16x16x32_bf16 a[64:67], a[224:227], v[212:215], a[64:67]
  v_exp_f32 v50, v162
  v_mfma_f32_16x16x32_bf16 a[96:99], a[224:227], v[220:223], a[96:99]
  v_exp_f32 v51, v163
  v_mfma_f32_16x16x32_bf16 v[32:35], v[60:63], v[196:199], v[32:35]
  ds_read_b128 a[196:199], v3 offset:1024
  v_cvt_pk_bf16_f32 v240, v48, v49
  v_mfma_f32_16x16x32_bf16 a[4:7], a[228:231], v[196:199], a[4:7]
  v_exp_f32 v52, v164
  v_mfma_f32_16x16x32_bf16 a[36:39], a[228:231], v[204:207], a[36:39]
  v_exp_f32 v53, v165
  v_mfma_f32_16x16x32_bf16 a[68:71], a[228:231], v[212:215], a[68:71]
  v_cvt_pk_bf16_f32 v241, v50, v51
  v_mfma_f32_16x16x32_bf16 a[100:103], a[228:231], v[220:223], a[100:103]
  v_pk_maximum3_f16 v11, v11, v240, v241
  v_mfma_f32_16x16x32_bf16 a[8:11], a[232:235], v[196:199], a[8:11]
  ds_read_b128 a[200:203], v3 offset:2048
  v_cvt_pk_bf16_f32 v242, v52, v53
  v_mfma_f32_16x16x32_bf16 a[40:43], a[232:235], v[204:207], a[40:43]
  buffer_load_dwordx4 v5, s[8:11], s62 offen offset:2048 lds
  v_mfma_f32_16x16x32_bf16 a[72:75], a[232:235], v[212:215], a[72:75]
  v_exp_f32 v54, v166
  v_mfma_f32_16x16x32_bf16 a[104:107], a[232:235], v[220:223], a[104:107]
  v_exp_f32 v55, v167
  v_mfma_f32_16x16x32_bf16 v[36:39], v[60:63], v[204:207], v[36:39]
  ds_read_b128 a[204:207], v3 offset:3072
  v_cvt_pk_bf16_f32 v243, v54, v55
  v_mfma_f32_16x16x32_bf16 a[12:15], a[236:239], v[196:199], a[12:15]
  v_exp_f32 v48, v176
  v_mfma_f32_16x16x32_bf16 a[44:47], a[236:239], v[204:207], a[44:47]
  v_exp_f32 v49, v177
  v_mfma_f32_16x16x32_bf16 a[76:79], a[236:239], v[212:215], a[76:79]
  v_mfma_f32_16x16x32_bf16 a[108:111], a[236:239], v[220:223], a[108:111]
  s_waitcnt lgkmcnt(4)
  v_pk_maximum3_f16 v11, v11, v242, v243
  v_mfma_f32_16x16x32_bf16 a[16:19], a[240:243], v[196:199], a[16:19]
  ds_read_b128 a[208:211], v3 offset:4096
  v_cvt_pk_bf16_f32 v248, v48, v49
  v_mfma_f32_16x16x32_bf16 a[48:51], a[240:243], v[204:207], a[48:51]
  v_exp_f32 v50, v178
  v_mfma_f32_16x16x32_bf16 a[80:83], a[240:243], v[212:215], a[80:83]
  v_exp_f32 v51, v179
  v_mfma_f32_16x16x32_bf16 a[112:115], a[240:243], v[220:223], a[112:115]
  buffer_load_dwordx4 v5, s[8:11], s62 offen offset:3072 lds
  v_mfma_f32_16x16x32_bf16 v[40:43], v[60:63], v[212:215], v[40:43]
  ds_read_b128 a[212:215], v3 offset:5120
  s_add_u32 s31, s31, 16384
  s_cmp_eq_u32 s31, s32
  s_cselect_b32 s31, s47, s31
  s_add_u32 s28, s28, 0xfffe8000
  s_sub_u32 s29, s28, 131072
  v_mfma_f32_16x16x32_bf16 a[20:23], a[244:247], v[196:199], a[20:23]
  v_exp_f32 v52, v180
  v_mfma_f32_16x16x32_bf16 a[52:55], a[244:247], v[204:207], a[52:55]
  v_exp_f32 v53, v181
  v_mfma_f32_16x16x32_bf16 a[84:87], a[244:247], v[212:215], a[84:87]
  v_cvt_pk_bf16_f32 v249, v50, v51
  v_mfma_f32_16x16x32_bf16 a[116:119], a[244:247], v[220:223], a[116:119]
  v_pk_maximum3_f16 v11, v11, v248, v249
  v_mfma_f32_16x16x32_bf16 a[24:27], a[248:251], v[196:199], a[24:27]
  ds_read_b128 a[216:219], v3 offset:6144
  v_cvt_pk_bf16_f32 v250, v52, v53
  v_mfma_f32_16x16x32_bf16 a[56:59], a[248:251], v[204:207], a[56:59]
  v_exp_f32 v54, v182
  v_mfma_f32_16x16x32_bf16 a[88:91], a[248:251], v[212:215], a[88:91]
  v_exp_f32 v55, v183
  v_mfma_f32_16x16x32_bf16 a[120:123], a[248:251], v[220:223], a[120:123]
  v_mfma_f32_16x16x32_bf16 v[44:47], v[60:63], v[220:223], v[44:47]
  ds_read_b128 a[220:223], v3 offset:7168
  s_nop 0
  v_mfma_f32_16x16x32_bf16 a[28:31], a[252:255], v[196:199], a[28:31]
  v_cvt_pk_bf16_f32 v251, v54, v55
  v_pk_maximum3_f16 v11, v11, v250, v251
  v_mfma_f32_16x16x32_bf16 a[60:63], a[252:255], v[204:207], a[60:63]
  v_mfma_f32_16x16x32_bf16 a[92:95], a[252:255], v[212:215], a[92:95]
  v_mfma_f32_16x16x32_bf16 a[124:127], a[252:255], v[220:223], a[124:127]
  s_waitcnt lgkmcnt(4)
  v_mfma_f32_16x16x32_bf16 v[64:67], a[192:195], a[128:131], v[16:19]
  ds_read_b128 a[224:227], v3 offset:8192
  v_mfma_f32_16x16x32_bf16 v[80:83], a[192:195], a[144:147], v[20:23]
  v_exp_f32 v48, v136
  v_mfma_f32_16x16x32_bf16 v[96:99], a[192:195], a[160:163], v[24:27]
  v_exp_f32 v49, v137
  v_mfma_f32_16x16x32_bf16 v[112:115], a[192:195], a[176:179], v[28:31]
  v_exp_f32 v50, v138
  v_mfma_f32_16x16x32_bf16 v[64:67], a[196:199], a[132:135], v[64:67]
  ds_read_b128 a[228:231], v3 offset:9216
  v_cvt_pk_bf16_f32 v228, v48, v49
  v_mfma_f32_16x16x32_bf16 v[80:83], a[196:199], a[148:151], v[80:83]
  v_exp_f32 v51, v139
  v_mfma_f32_16x16x32_bf16 v[96:99], a[196:199], a[164:167], v[96:99]
  v_exp_f32 v52, v140
  v_mfma_f32_16x16x32_bf16 v[112:115], a[196:199], a[180:183], v[112:115]
  v_exp_f32 v53, v141
  v_mfma_f32_16x16x32_bf16 v[64:67], a[200:203], a[136:139], v[64:67]
  ds_read_b128 a[232:235], v3 offset:10240
  v_cvt_pk_bf16_f32 v229, v50, v51
  v_mfma_f32_16x16x32_bf16 v[80:83], a[200:203], a[152:155], v[80:83]
  v_pk_maximum3_f16 v11, v11, v228, v229
  v_cvt_pk_bf16_f32 v230, v52, v53
  v_mfma_f32_16x16x32_bf16 v[96:99], a[200:203], a[168:171], v[96:99]
  v_exp_f32 v54, v142
  v_mfma_f32_16x16x32_bf16 v[112:115], a[200:203], a[184:187], v[112:115]
  v_exp_f32 v55, v143
  v_mfma_f32_16x16x32_bf16 v[64:67], a[204:207], a[140:143], v[64:67]
  ds_read_b128 a[236:239], v3 offset:11264
  v_cvt_pk_bf16_f32 v231, v54, v55
  v_mfma_f32_16x16x32_bf16 v[80:83], a[204:207], a[156:159], v[80:83]
  v_exp_f32 v48, v152
  v_mfma_f32_16x16x32_bf16 v[96:99], a[204:207], a[172:175], v[96:99]
  v_exp_f32 v49, v153
  v_mfma_f32_16x16x32_bf16 v[112:115], a[204:207], a[188:191], v[112:115]
  s_waitcnt lgkmcnt(4)
  v_pk_maximum3_f16 v11, v11, v230, v231
  v_mfma_f32_16x16x32_bf16 v[68:71], a[208:211], a[128:131], v[16:19]
  ds_read_b128 a[240:243], v3 offset:12288
  v_cvt_pk_bf16_f32 v236, v48, v49
  v_mfma_f32_16x16x32_bf16 v[84:87], a[208:211], a[144:147], v[20:23]
  v_exp_f32 v50, v154
  v_mfma_f32_16x16x32_bf16 v[100:103], a[208:211], a[160:163], v[24:27]
  v_exp_f32 v51, v155
  v_mfma_f32_16x16x32_bf16 v[116:119], a[208:211], a[176:179], v[28:31]
  v_exp_f32 v52, v156
  v_mfma_f32_16x16x32_bf16 v[68:71], a[212:215], a[132:135], v[68:71]
  ds_read_b128 a[244:247], v3 offset:13312
  v_mfma_f32_16x16x32_bf16 v[84:87], a[212:215], a[148:151], v[84:87]
  v_exp_f32 v53, v157
  v_mfma_f32_16x16x32_bf16 v[100:103], a[212:215], a[164:167], v[100:103]
  v_cvt_pk_bf16_f32 v237, v50, v51
  v_mfma_f32_16x16x32_bf16 v[116:119], a[212:215], a[180:183], v[116:119]
  v_pk_maximum3_f16 v11, v11, v236, v237
  v_mfma_f32_16x16x32_bf16 v[68:71], a[216:219], a[136:139], v[68:71]
  ds_read_b128 a[248:251], v3 offset:14336
  v_cvt_pk_bf16_f32 v238, v52, v53
  v_mfma_f32_16x16x32_bf16 v[84:87], a[216:219], a[152:155], v[84:87]
  v_exp_f32 v54, v158
  v_mfma_f32_16x16x32_bf16 v[100:103], a[216:219], a[168:171], v[100:103]
  v_exp_f32 v55, v159
  v_mfma_f32_16x16x32_bf16 v[116:119], a[216:219], a[184:187], v[116:119]
  v_exp_f32 v48, v168
  v_mfma_f32_16x16x32_bf16 v[68:71], a[220:223], a[140:143], v[68:71]
  ds_read_b128 a[252:255], v3 offset:15360
  v_mfma_f32_16x16x32_bf16 v[84:87], a[220:223], a[156:159], v[84:87]
  v_exp_f32 v49, v169
  v_mfma_f32_16x16x32_bf16 v[100:103], a[220:223], a[172:175], v[100:103]
  v_add_u32 v4, s34, v2
  v_cvt_pk_bf16_f32 v239, v54, v55
  v_mfma_f32_16x16x32_bf16 v[116:119], a[220:223], a[188:191], v[116:119]
  s_add_u32 s34, s34, 16384
  s_and_b32 s34, s34, 0xffff
  s_waitcnt vmcnt(0)
  s_barrier
  s_waitcnt lgkmcnt(4)
  v_mfma_f32_16x16x32_bf16 v[72:75], a[224:227], a[128:131], v[16:19]
  ds_read_b128 a[192:195], v4 offset:0
  v_pk_maximum3_f16 v11, v11, v238, v239
  v_mfma_f32_16x16x32_bf16 v[88:91], a[224:227], a[144:147], v[20:23]
  s_cmp_lt_i32 s28, 0
  s_cselect_b32 s63, s60, 0
  v_cvt_pk_bf16_f32 v244, v48, v49
  v_mfma_f32_16x16x32_bf16 v[104:107], a[224:227], a[160:163], v[24:27]
  s_add_u32 s63, s63, s28
  v_exp_f32 v50, v170
  v_mfma_f32_16x16x32_bf16 v[120:123], a[224:227], a[176:179], v[28:31]
  s_add_u32 s63, s63, 16384
  v_exp_f32 v51, v171
  v_mfma_f32_16x16x32_bf16 v[72:75], a[228:231], a[132:135], v[72:75]
  ds_read_b128 a[196:199], v4 offset:1024
  s_cmp_ge_i32 s28, s61
  s_cselect_b32 s10, s35, 0
  s_mov_b32 m0, s30
  v_mfma_f32_16x16x32_bf16 v[88:91], a[228:231], a[148:151], v[88:91]
  buffer_load_dwordx4 v5, s[8:11], s63 offen offset:0 lds
  v_mfma_f32_16x16x32_bf16 v[104:107], a[228:231], a[164:167], v[104:107]
  v_exp_f32 v52, v172
  v_mfma_f32_16x16x32_bf16 v[120:123], a[228:231], a[180:183], v[120:123]
  v_exp_f32 v53, v173
  v_mfma_f32_16x16x32_bf16 v[72:75], a[232:235], a[136:139], v[72:75]
  ds_read_b128 a[200:203], v4 offset:2048
  v_cvt_pk_bf16_f32 v245, v50, v51
  v_mfma_f32_16x16x32_bf16 v[88:91], a[232:235], a[152:155], v[88:91]
  v_pk_maximum3_f16 v11, v11, v244, v245
  v_cvt_pk_bf16_f32 v246, v52, v53
  v_mfma_f32_16x16x32_bf16 v[104:107], a[232:235], a[168:171], v[104:107]
  v_exp_f32 v54, v174
  v_mfma_f32_16x16x32_bf16 v[120:123], a[232:235], a[184:187], v[120:123]
  v_exp_f32 v55, v175
  v_mfma_f32_16x16x32_bf16 v[72:75], a[236:239], a[140:143], v[72:75]
  ds_read_b128 a[204:207], v4 offset:3072
  v_cvt_pk_bf16_f32 v247, v54, v55
  v_mfma_f32_16x16x32_bf16 v[88:91], a[236:239], a[156:159], v[88:91]
  v_exp_f32 v48, v184
  v_mfma_f32_16x16x32_bf16 v[104:107], a[236:239], a[172:175], v[104:107]
  v_exp_f32 v49, v185
  v_mfma_f32_16x16x32_bf16 v[120:123], a[236:239], a[188:191], v[120:123]
  s_waitcnt lgkmcnt(4)
  v_pk_maximum3_f16 v11, v11, v246, v247
  v_cvt_pk_bf16_f32 v252, v48, v49
  v_mfma_f32_16x16x32_bf16 v[76:79], a[240:243], a[128:131], v[16:19]
  ds_read_b128 a[208:211], v4 offset:4096
  v_mfma_f32_16x16x32_bf16 v[92:95], a[240:243], a[144:147], v[20:23]
  buffer_load_dwordx4 v5, s[8:11], s63 offen offset:1024 lds
  v_mfma_f32_16x16x32_bf16 v[108:111], a[240:243], a[160:163], v[24:27]
  v_exp_f32 v50, v186
  v_mfma_f32_16x16x32_bf16 v[124:127], a[240:243], a[176:179], v[28:31]
  v_exp_f32 v51, v187
  v_mfma_f32_16x16x32_bf16 v[76:79], a[244:247], a[132:135], v[76:79]
  ds_read_b128 a[212:215], v4 offset:5120
  v_cvt_pk_bf16_f32 v253, v50, v51
  v_mfma_f32_16x16x32_bf16 v[92:95], a[244:247], a[148:151], v[92:95]
  v_exp_f32 v52, v188
  v_mfma_f32_16x16x32_bf16 v[108:111], a[244:247], a[164:167], v[108:111]
  v_exp_f32 v53, v189
  v_mfma_f32_16x16x32_bf16 v[124:127], a[244:247], a[180:183], v[124:127]
  v_pk_maximum3_f16 v11, v11, v252, v253
  v_cvt_pk_bf16_f32 v254, v52, v53
  v_mfma_f32_16x16x32_bf16 v[76:79], a[248:251], a[136:139], v[76:79]
  ds_read_b128 a[216:219], v4 offset:6144
  v_mfma_f32_16x16x32_bf16 v[92:95], a[248:251], a[152:155], v[92:95]
  v_exp_f32 v54, v190
  v_mfma_f32_16x16x32_bf16 v[108:111], a[248:251], a[168:171], v[108:111]
  v_exp_f32 v55, v191
  v_mfma_f32_16x16x32_bf16 v[124:127], a[248:251], a[184:187], v[124:127]
  s_nop 0
  v_cvt_pk_bf16_f32 v255, v54, v55
  v_mfma_f32_16x16x32_bf16 v[76:79], a[252:255], a[140:143], v[76:79]
  ds_read_b128 a[220:223], v4 offset:7168
  v_pk_maximum3_f16 v11, v11, v254, v255
  v_mfma_f32_16x16x32_bf16 v[92:95], a[252:255], a[156:159], v[92:95]
  buffer_load_dwordx4 v5, s[8:11], s63 offen offset:2048 lds
  v_mfma_f32_16x16x32_bf16 v[108:111], a[252:255], a[172:175], v[108:111]
  v_mfma_f32_16x16x32_bf16 v[124:127], a[252:255], a[188:191], v[124:127]
  s_waitcnt lgkmcnt(4)
  v_lshrrev_b32 v56, 16, v11
  v_and_b32 v57, 0xffff, v11
  v_max_u32 v56, v56, v57
  v_cmp_lt_u32 vcc, 0x4e80, v56
  s_nop 1
  s_cbranch_vccnz K2_rare_F
K2_ret_F:
  v_mfma_f32_16x16x32_bf16 a[0:3], a[192:195], v[224:227], a[0:3]
  ds_read_b128 a[224:227], v4 offset:8192
  v_mfma_f32_16x16x32_bf16 a[32:35], a[192:195], v[232:235], a[32:35]
  v_exp_f32 v48, v64
  v_mfma_f32_16x16x32_bf16 a[64:67], a[192:195], v[240:243], a[64:67]
  v_exp_f32 v49, v65
  v_mfma_f32_16x16x32_bf16 a[96:99], a[192:195], v[248:251], a[96:99]
  v_exp_f32 v50, v66
  v_mfma_f32_16x16x32_bf16 v[32:35], v[60:63], v[224:227], v[32:35]
  ds_read_b128 a[228:231], v4 offset:9216
  v_cvt_pk_bf16_f32 v192, v48, v49
  v_mfma_f32_16x16x32_bf16 a[4:7], a[196:199], v[224:227], a[4:7]
  v_exp_f32 v51, v67
  v_mfma_f32_16x16x32_bf16 a[36:39], a[196:199], v[232:235], a[36:39]
  v_exp_f32 v52, v68
  v_mfma_f32_16x16x32_bf16 a[68:71], a[196:199], v[240:243], a[68:71]
  v_exp_f32 v53, v69
  v_mfma_f32_16x16x32_bf16 a[100:103], a[196:199], v[248:251], a[100:103]
  v_cvt_pk_bf16_f32 v193, v50, v51
  v_pk_maximum3_f16 v11, v192, v192, v193
  v_mfma_f32_16x16x32_bf16 a[8:11], a[200:203], v[224:227], a[8:11]
  ds_read_b128 a[232:235], v4 offset:10240
  v_cvt_pk_bf16_f32 v194, v52, v53
  v_mfma_f32_16x16x32_bf16 a[40:43], a[200:203], v[232:235], a[40:43]
  buffer_load_dwordx4 v5, s[8:11], s63 offen offset:3072 lds
  v_mfma_f32_16x16x32_bf16 a[72:75], a[200:203], v[240:243], a[72:75]
  s_add_u32 s30, s30, 16384
  v_exp_f32 v54, v70
  v_mfma_f32_16x16x32_bf16 a[104:107], a[200:203], v[248:251], a[104:107]
  s_and_b32 s30, s30, 0xffff
  v_exp_f32 v55, v71
  v_mfma_f32_16x16x32_bf16 v[36:39], v[60:63], v[232:235], v[36:39]
  ds_read_b128 a[236:239], v4 offset:11264
  v_cvt_pk_bf16_f32 v195, v54, v55
  v_mfma_f32_16x16x32_bf16 a[12:15], a[204:207], v[224:227], a[12:15]
  s_cmp_lt_i32 s29, 0
  s_cselect_b32 s62, s60, 0
  v_pk_maximum3_f16 v11, v11, v194, v195
  v_mfma_f32_16x16x32_bf16 a[44:47], a[204:207], v[232:235], a[44:47]
  s_add_u32 s62, s62, s29
  v_exp_f32 v48, v80
  v_mfma_f32_16x16x32_bf16 a[76:79], a[204:207], v[240:243], a[76:79]
  s_cmp_ge_i32 s29, s61
  s_cselect_b32 s10, s35, 0
  v_mfma_f32_16x16x32_bf16 a[108:111], a[204:207], v[248:251], a[108:111]
  s_waitcnt lgkmcnt(4)
  v_exp_f32 v49, v81
  v_mfma_f32_16x16x32_bf16 a[16:19], a[208:211], v[224:227], a[16:19]
  ds_read_b128 a[240:243], v4 offset:12288
  v_cvt_pk_bf16_f32 v200, v48, v49
  v_mfma_f32_16x16x32_bf16 a[48:51], a[208:211], v[232:235], a[48:51]
  s_mov_b32 m0, s31
  v_exp_f32 v50, v82
  v_mfma_f32_16x16x32_bf16 a[80:83], a[208:211], v[240:243], a[80:83]
  v_mfma_f32_16x16x32_bf16 a[112:115], a[208:211], v[248:251], a[112:115]
  buffer_load_dwordx4 v5, s[8:11], s62 offen offset:0 lds
  v_mfma_f32_16x16x32_bf16 v[40:43], v[60:63], v[240:243], v[40:43]
  ds_read_b128 a[244:247], v4 offset:13312
  v_mfma_f32_16x16x32_bf16 a[20:23], a[212:215], v[224:227], a[20:23]
  v_exp_f32 v51, v83
  v_mfma_f32_16x16x32_bf16 a[52:55], a[212:215], v[232:235], a[52:55]
  v_exp_f32 v52, v84
  v_mfma_f32_16x16x32_bf16 a[84:87], a[212:215], v[240:243], a[84:87]
  v_exp_f32 v53, v85
  v_mfma_f32_16x16x32_bf16 a[116:119], a[212:215], v[248:251], a[116:119]
  v_cvt_pk_bf16_f32 v201, v50, v51
  v_pk_maximum3_f16 v11, v11, v200, v201
  v_mfma_f32_16x16x32_bf16 a[24:27], a[216:219], v[224:227], a[24:27]
  ds_read_b128 a[248:251], v4 offset:14336
  v_cvt_pk_bf16_f32 v202, v52, v53
  v_mfma_f32_16x16x32_bf16 a[56:59], a[216:219], v[232:235], a[56:59]
  v_exp_f32 v54, v86
  v_mfma_f32_16x16x32_bf16 a[88:91], a[216:219], v[240:243], a[88:91]
  v_exp_f32 v55, v87
  v_mfma_f32_16x16x32_bf16 a[120:123], a[216:219], v[248:251], a[120:123]
  v_mfma_f32_16x16x32_bf16 v[44:47], v[60:63], v[248:251], v[44:47]
  ds_read_b128 a[252:255], v4 offset:15360
  v_cvt_pk_bf16_f32 v203, v54, v55
  v_mfma_f32_16x16x32_bf16 a[28:31], a[220:223], v[224:227], a[28:31]
  s_add_u32 s33, s33, 16384
  s_cmp_eq_u32 s33, 163840
  s_cselect_b32 s33, 65536, s33
  v_mfma_f32_16x16x32_bf16 a[60:63], a[220:223], v[232:235], a[60:63]
  buffer_load_dwordx4 v5, s[8:11], s62 offen offset:1024 lds
  v_mfma_f32_16x16x32_bf16 a[92:95], a[220:223], v[240:243], a[92:95]
  v_exp_f32 v48, v96
  v_mfma_f32_16x16x32_bf16 a[124:127], a[220:223], v[248:251], a[124:127]
  v_add_u32 v3, s33, v2
  s_waitcnt lgkmcnt(4)
  v_mfma_f32_16x16x32_bf16 a[0:3], a[224:227], v[228:231], a[0:3]
  ds_read_b128 a[192:195], v3 offset:0
  v_pk_maximum3_f16 v11, v11, v202, v203
  v_mfma_f32_16x16x32_bf16 a[32:35], a[224:227], v[236:239], a[32:35]
  v_exp_f32 v49, v97
  v_mfma_f32_16x16x32_bf16 a[64:67], a[224:227], v[244:247], a[64:67]
  v_exp_f32 v50, v98
  v_mfma_f32_16x16x32_bf16 a[96:99], a[224:227], v[252:255], a[96:99]
  v_exp_f32 v51, v99
  v_mfma_f32_16x16x32_bf16 v[32:35], v[60:63], v[228:231], v[32:35]
  ds_read_b128 a[196:199], v3 offset:1024
  v_cvt_pk_bf16_f32 v208, v48, v49
  v_mfma_f32_16x16x32_bf16 a[4:7], a[228:231], v[228:231], a[4:7]
  v_exp_f32 v52, v100
  v_mfma_f32_16x16x32_bf16 a[36:39], a[228:231], v[236:239], a[36:39]
  v_exp_f32 v53, v101
  v_mfma_f32_16x16x32_bf16 a[68:71], a[228:231], v[244:247], a[68:71]
  v_cvt_pk_bf16_f32 v209, v50, v51
  v_mfma_f32_16x16x32_bf16 a[100:103], a[228:231], v[252:255], a[100:103]
  v_pk_maximum3_f16 v11, v11, v208, v209
  v_mfma_f32_16x16x32_bf16 a[8:11], a[232:235], v[228:231], a[8:11]
  ds_read_b128 a[200:203], v3 offset:2048
  v_cvt_pk_bf16_f32 v210, v52, v53
  v_mfma_f32_16x16x32_bf16 a[40:43], a[232:235], v[236:239], a[40:43]
  buffer_load_dwordx4 v5, s[8:11], s62 offen offset:2048 lds
  v_mfma_f32_16x16x32_bf16 a[72:75], a[232:235], v[244:247], a[72:75]
  v_exp_f32 v54, v102
  v_mfma_f32_16x16x32_bf16 a[104:107], a[232:235], v[252:255], a[104:107]
  v_exp_f32 v55, v103
  v_mfma_f32_16x16x32_bf16 v[36:39], v[60:63], v[236:239], v[36:39]
  ds_read_b128 a[204:207], v3 offset:3072
  v_cvt_pk_bf16_f32 v211, v54, v55
  v_mfma_f32_16x16x32_bf16 a[12:15], a[236:239], v[228:231], a[12:15]
  v_exp_f32 v48, v112
  v_mfma_f32_16x16x32_bf16 a[44:47], a[236:239], v[236:239], a[44:47]
  v_exp_f32 v49, v113
  v_mfma_f32_16x16x32_bf16 a[76:79], a[236:239], v[244:247], a[76:79]
  v_mfma_f32_16x16x32_bf16 a[108:111], a[236:239], v[252:255], a[108:111]
  s_waitcnt lgkmcnt(4)
  v_pk_maximum3_f16 v11, v11, v210, v211
  v_mfma_f32_16x16x32_bf16 a[16:19], a[240:243], v[228:231], a[16:19]
  ds_read_b128 a[208:211], v3 offset:4096
  v_cvt_pk_bf16_f32 v216, v48, v49
  v_mfma_f32_16x16x32_bf16 a[48:51], a[240:243], v[236:239], a[48:51]
  v_exp_f32 v50, v114
  v_mfma_f32_16x16x32_bf16 a[80:83], a[240:243], v[244:247], a[80:83]
  v_exp_f32 v51, v115
  v_mfma_f32_16x16x32_bf16 a[112:115], a[240:243], v[252:255], a[112:115]
  buffer_load_dwordx4 v5, s[8:11], s62 offen offset:3072 lds
  v_mfma_f32_16x16x32_bf16 v[40:43], v[60:63], v[244:247], v[40:43]
  ds_read_b128 a[212:215], v3 offset:5120
  s_add_u32 s31, s31, 16384
  s_cmp_eq_u32 s31, s32
  s_cselect_b32 s31, s47, s31
  s_add_u32 s28, s28, 0x8000
  s_sub_u32 s29, s28, 131072
  v_mfma_f32_16x16x32_bf16 a[20:23], a[244:247], v[228:231], a[20:23]
  v_exp_f32 v52, v116
  v_mfma_f32_16x16x32_bf16 a[52:55], a[244:247], v[236:239], a[52:55]
  v_exp_f32 v53, v117
  v_mfma_f32_16x16x32_bf16 a[84:87], a[244:247], v[244:247], a[84:87]
  v_cvt_pk_bf16_f32 v217, v50, v51
  v_mfma_f32_16x16x32_bf16 a[116:119], a[244:247], v[252:255], a[116:119]
  v_pk_maximum3_f16 v11, v11, v216, v217
  v_mfma_f32_16x16x32_bf16 a[24:27], a[248:251], v[228:231], a[24:27]
  ds_read_b128 a[216:219], v3 offset:6144
  v_cvt_pk_bf16_f32 v218, v52, v53
  v_mfma_f32_16x16x32_bf16 a[56:59], a[248:251], v[236:239], a[56:59]
  v_exp_f32 v54, v118
  v_mfma_f32_16x16x32_bf16 a[88:91], a[248:251], v[244:247], a[88:91]
  v_exp_f32 v55, v119
  v_mfma_f32_16x16x32_bf16 a[120:123], a[248:251], v[252:255], a[120:123]
  v_mfma_f32_16x16x32_bf16 v[44:47], v[60:63], v[252:255], v[44:47]
  ds_read_b128 a[220:223], v3 offset:7168
  s_nop 0
  v_mfma_f32_16x16x32_bf16 a[28:31], a[252:255], v[228:231], a[28:31]
  v_cvt_pk_bf16_f32 v219, v54, v55
  v_pk_maximum3_f16 v11, v11, v218, v219
  v_mfma_f32_16x16x32_bf16 a[60:63], a[252:255], v[236:239], a[60:63]
  v_mfma_f32_16x16x32_bf16 a[92:95], a[252:255], v[244:247], a[92:95]
  v_mfma_f32_16x16x32_bf16 a[124:127], a[252:255], v[252:255], a[124:127]
  s_sub_u32 s37, s37, 1
  s_cmp_lg_u32 s37, 0
  s_cbranch_scc1 K2_loop2
K2_H:
  s_cmp_eq_u32 s4, 7
  s_cbranch_scc1 K2_G
  s_waitcnt lgkmcnt(4)
  v_mfma_f32_16x16x32_bf16 v[128:131], a[192:195], a[128:131], v[16:19]
  ds_read_b128 a[224:227], v3 offset:8192
  v_mfma_f32_16x16x32_bf16 v[160:163], a[192:195], a[144:147], v[20:23]
  v_exp_f32 v48, v72
  v_mfma_f32_16x16x32_bf16 v[128:131], a[196:199], a[132:135], v[128:131]
  ds_read_b128 a[228:231], v3 offset:9216
  v_mfma_f32_16x16x32_bf16 v[160:163], a[196:199], a[148:151], v[160:163]
  v_exp_f32 v49, v73
  v_mfma_f32_16x16x32_bf16 v[128:131], a[200:203], a[136:139], v[128:131]
  ds_read_b128 a[232:235], v3 offset:10240
  v_exp_f32 v50, v74
  v_mfma_f32_16x16x32_bf16 v[160:163], a[200:203], a[152:155], v[160:163]
  v_exp_f32 v51, v75
  v_mfma_f32_16x16x32_bf16 v[128:131], a[204:207], a[140:143], v[128:131]
  ds_read_b128 a[236:239], v3 offset:11264
  v_cvt_pk_bf16_f32 v196, v48, v49
  v_mfma_f32_16x16x32_bf16 v[160:163], a[204:207], a[156:159], v[160:163]
  s_waitcnt lgkmcnt(4)
  v_exp_f32 v52, v76
  v_mfma_f32_16x16x32_bf16 v[132:135], a[208:211], a[128:131], v[16:19]
  ds_read_b128 a[240:243], v3 offset:12288
  v_cvt_pk_bf16_f32 v197, v50, v51
  v_mfma_f32_16x16x32_bf16 v[164:167], a[208:211], a[144:147], v[20:23]
  v_exp_f32 v53, v77
  v_mfma_f32_16x16x32_bf16 v[132:135], a[212:215], a[132:135], v[132:135]
  ds_read_b128 a[244:247], v3 offset:13312
  v_pk_maximum3_f16 v11, v11, v196, v197
  v_mfma_f32_16x16x32_bf16 v[164:167], a[212:215], a[148:151], v[164:167]
  v_exp_f32 v54, v78
  v_mfma_f32_16x16x32_bf16 v[132:135], a[216:219], a[136:139], v[132:135]
  ds_read_b128 a[248:251], v3 offset:14336
  v_cvt_pk_bf16_f32 v198, v52, v53
  v_mfma_f32_16x16x32_bf16 v[164:167], a[216:219], a[152:155], v[164:167]
  v_exp_f32 v55, v79
  v_mfma_f32_16x16x32_bf16 v[132:135], a[220:223], a[140:143], v[132:135]
  ds_read_b128 a[252:255], v3 offset:15360
  v_cvt_pk_bf16_f32 v199, v54, v55
  v_mfma_f32_16x16x32_bf16 v[164:167], a[220:223], a[156:159], v[164:167]
  s_waitcnt lgkmcnt(4)
  v_exp_f32 v48, v88
  v_mfma_f32_16x16x32_bf16 v[136:139], a[224:227], a[128:131], v[16:19]
  ds_read_b128 a[192:195], v3 offset:16384
  v_pk_maximum3_f16 v11, v11, v198, v199
  v_mfma_f32_16x16x32_bf16 v[168:171], a[224:227], a[144:147], v[20:23]
  v_exp_f32 v49, v89
  v_mfma_f32_16x16x32_bf16 v[136:139], a[228:231], a[132:135], v[136:139]
  ds_read_b128 a[196:199], v3 offset:17408
  v_cvt_pk_bf16_f32 v204, v48, v49
  v_mfma_f32_16x16x32_bf16 v[168:171], a[228:231], a[148:151], v[168:171]
  v_exp_f32 v50, v90
  v_mfma_f32_16x16x32_bf16 v[136:139], a[232:235], a[136:139], v[136:139]
  ds_read_b128 a[200:203], v3 offset:18432
  v_mfma_f32_16x16x32_bf16 v[168:171], a[232:235], a[152:155], v[168:171]
  v_exp_f32 v51, v91
  v_mfma_f32_16x16x32_bf16 v[136:139], a[236:239], a[140:143], v[136:139]
  ds_read_b128 a[204:207], v3 offset:19456
  v_cvt_pk_bf16_f32 v205, v50, v51
  v_mfma_f32_16x16x32_bf16 v[168:171], a[236:239], a[156:159], v[168:171]
  s_waitcnt lgkmcnt(4)
  v_exp_f32 v52, v92
  v_mfma_f32_16x16x32_bf16 v[140:143], a[240:243], a[128:131], v[16:19]
  ds_read_b128 a[208:211], v3 offset:20480
  v_pk_maximum3_f16 v11, v11, v204, v205
  v_mfma_f32_16x16x32_bf16 v[172:175], a[240:243], a[144:147], v[20:23]
  v_exp_f32 v53, v93
  v_mfma_f32_16x16x32_bf16 v[140:143], a[244:247], a[132:135], v[140:143]
  ds_read_b128 a[212:215], v3 offset:21504
  v_cvt_pk_bf16_f32 v206, v52, v53
  v_mfma_f32_16x16x32_bf16 v[172:175], a[244:247], a[148:151], v[172:175]
  v_exp_f32 v54, v94
  v_mfma_f32_16x16x32_bf16 v[140:143], a[248:251], a[136:139], v[140:143]
  ds_read_b128 a[216:219], v3 offset:22528
  v_mfma_f32_16x16x32_bf16 v[172:175], a[248:251], a[152:155], v[172:175]
  v_exp_f32 v55, v95
  v_mfma_f32_16x16x32_bf16 v[140:143], a[252:255], a[140:143], v[140:143]
  ds_read_b128 a[220:223], v3 offset:23552
  v_cvt_pk_bf16_f32 v207, v54, v55
  v_mfma_f32_16x16x32_bf16 v[172:175], a[252:255], a[156:159], v[172:175]
  s_waitcnt lgkmcnt(4)
  v_exp_f32 v48, v104
  v_mfma_f32_16x16x32_bf16 v[144:147], a[192:195], a[128:131], v[16:19]
  ds_read_b128 a[224:227], v3 offset:24576
  v_pk_maximum3_f16 v11, v11, v206, v207
  v_mfma_f32_16x16x32_bf16 v[176:179], a[192:195], a[144:147], v[20:23]
  v_exp_f32 v49, v105
  v_mfma_f32_16x16x32_bf16 v[144:147], a[196:199], a[132:135], v[144:147]
  ds_read_b128 a[228:231], v3 offset:25600
  v_cvt_pk_bf16_f32 v212, v48, v49
  v_mfma_f32_16x16x32_bf16 v[176:179], a[196:199], a[148:151], v[176:179]
  v_exp_f32 v50, v106
  v_mfma_f32_16x16x32_bf16 v[144:147], a[200:203], a[136:139], v[144:147]
  ds_read_b128 a[232:235], v3 offset:26624
  v_mfma_f32_16x16x32_bf16 v[176:179], a[200:203], a[152:155], v[176:179]
  v_exp_f32 v51, v107
  v_mfma_f32_16x16x32_bf16 v[144:147], a[204:207], a[140:143], v[144:147]
  ds_read_b128 a[236:239], v3 offset:27648
  v_cvt_pk_bf16_f32 v213, v50, v51
  v_mfma_f32_16x16x32_bf16 v[176:179], a[204:207], a[156:159], v[176:179]
  s_waitcnt lgkmcnt(4)
  v_exp_f32 v52, v108
  v_mfma_f32_16x16x32_bf16 v[148:151], a[208:211], a[128:131], v[16:19]
  ds_read_b128 a[240:243], v3 offset:28672
  v_pk_maximum3_f16 v11, v11, v212, v213
  v_mfma_f32_16x16x32_bf16 v[180:183], a[208:211], a[144:147], v[20:23]
  v_exp_f32 v53, v109
  v_mfma_f32_16x16x32_bf16 v[148:151], a[212:215], a[132:135], v[148:151]
  ds_read_b128 a[244:247], v3 offset:29696
  v_cvt_pk_bf16_f32 v214, v52, v53
  v_mfma_f32_16x16x32_bf16 v[180:183], a[212:215], a[148:151], v[180:183]
  v_exp_f32 v54, v110
  v_mfma_f32_16x16x32_bf16 v[148:151], a[216:219], a[136:139], v[148:151]
  ds_read_b128 a[248:251], v3 offset:30720
  v_mfma_f32_16x16x32_bf16 v[180:183], a[216:219], a[152:155], v[180:183]
  v_exp_f32 v55, v111
  v_mfma_f32_16x16x32_bf16 v[148:151], a[220:223], a[140:143], v[148:151]
  ds_read_b128 a[252:255], v3 offset:31744
  v_add_u32 v4, s34, v2
  v_cvt_pk_bf16_f32 v215, v54, v55
  v_mfma_f32_16x16x32_bf16 v[180:183], a[220:223], a[156:159], v[180:183]
  s_add_u32 s34, s34, 16384
  s_and_b32 s34, s34, 0xffff
  s_waitcnt vmcnt(0)
  s_barrier
  s_waitcnt lgkmcnt(4)
  v_mfma_f32_16x16x32_bf16 v[152:155], a[224:227], a[128:131], v[16:19]
  ds_read_b128 a[192:195], v4 offset:0
  v_exp_f32 v48, v120
  v_mfma_f32_16x16x32_bf16 v[184:187], a[224:227], a[144:147], v[20:23]
  s_cmp_lt_i32 s28, 0
  s_cselect_b32 s63, s60, 0
  v_exp_f32 v49, v121
  v_mfma_f32_16x16x32_bf16 v[152:155], a[228:231], a[132:135], v[152:155]
  ds_read_b128 a[196:199], v4 offset:1024
  v_pk_maximum3_f16 v11, v11, v214, v215
  v_cvt_pk_bf16_f32 v220, v48, v49
  v_mfma_f32_16x16x32_bf16 v[184:187], a[228:231], a[148:151], v[184:187]
  s_add_u32 s63, s63, s28
  v_exp_f32 v50, v122
  v_mfma_f32_16x16x32_bf16 v[152:155], a[232:235], a[136:139], v[152:155]
  ds_read_b128 a[200:203], v4 offset:2048
  s_add_u32 s63, s63, 16384
  s_cmp_ge_i32 s28, s61
  s_cselect_b32 s10, s35, 0
  s_mov_b32 m0, s30
  v_mfma_f32_16x16x32_bf16 v[184:187], a[232:235], a[152:155], v[184:187]
  buffer_load_dwordx4 v5, s[8:11], s63 offen offset:0 lds
  v_mfma_f32_16x16x32_bf16 v[152:155], a[236:239], a[140:143], v[152:155]
  ds_read_b128 a[204:207], v4 offset:3072
  v_exp_f32 v51, v123
  v_mfma_f32_16x16x32_bf16 v[184:187], a[236:239], a[156:159], v[184:187]
  s_waitcnt lgkmcnt(4)
  v_exp_f32 v52, v124
  v_cvt_pk_bf16_f32 v221, v50, v51
  v_mfma_f32_16x16x32_bf16 v[156:159], a[240:243], a[128:131], v[16:19]
  ds_read_b128 a[208:211], v4 offset:4096
  v_pk_maximum3_f16 v11, v11, v220, v221
  v_mfma_f32_16x16x32_bf16 v[188:191], a[240:243], a[144:147], v[20:23]
  v_exp_f32 v53, v125
  v_mfma_f32_16x16x32_bf16 v[156:159], a[244:247], a[132:135], v[156:159]
  ds_read_b128 a[212:215], v4 offset:5120
  v_cvt_pk_bf16_f32 v222, v52, v53
  v_mfma_f32_16x16x32_bf16 v[188:191], a[244:247], a[148:151], v[188:191]
  v_exp_f32 v54, v126
  v_mfma_f32_16x16x32_bf16 v[156:159], a[248:251], a[136:139], v[156:159]
  ds_read_b128 a[216:219], v4 offset:6144
  v_mfma_f32_16x16x32_bf16 v[188:191], a[248:251], a[152:155], v[188:191]
  v_exp_f32 v55, v127
  v_mfma_f32_16x16x32_bf16 v[156:159], a[252:255], a[140:143], v[156:159]
  ds_read_b128 a[220:223], v4 offset:7168
  s_nop 0
  v_cvt_pk_bf16_f32 v223, v54, v55
  v_pk_maximum3_f16 v11, v11, v222, v223
  v_mfma_f32_16x16x32_bf16 v[188:191], a[252:255], a[156:159], v[188:191]
  s_waitcnt lgkmcnt(4)
  v_lshrrev_b32 v56, 16, v11
  v_and_b32 v57, 0xffff, v11
  v_max_u32 v56, v56, v57
  v_cmp_lt_u32 vcc, 0x4e80, v56
  s_nop 1
  s_cbranch_vccnz K2_rare_H
K2_ret_H:
  v_mfma_f32_16x16x32_bf16 a[0:3], a[192:195], v[192:195], a[0:3]
  ds_read_b128 a[224:227], v4 offset:8192
  v_mfma_f32_16x16x32_bf16 a[32:35], a[192:195], v[200:203], a[32:35]
  buffer_load_dwordx4 v5, s[8:11], s63 offen offset:1024 lds
  v_mfma_f32_16x16x32_bf16 a[64:67], a[192:195], v[208:211], a[64:67]
  v_exp_f32 v48, v128
  v_mfma_f32_16x16x32_bf16 a[96:99], a[192:195], v[216:219], a[96:99]
  v_exp_f32 v49, v129
  v_mfma_f32_16x16x32_bf16 v[32:35], v[60:63], v[192:195], v[32:35]
  ds_read_b128 a[228:231], v4 offset:9216
  v_cvt_pk_bf16_f32 v224, v48, v49
  v_mfma_f32_16x16x32_bf16 a[4:7], a[196:199], v[192:195], a[4:7]
  v_exp_f32 v50, v130
  v_mfma_f32_16x16x32_bf16 a[36:39], a[196:199], v[200:203], a[36:39]
  v_exp_f32 v51, v131
  v_mfma_f32_16x16x32_bf16 a[68:71], a[196:199], v[208:211], a[68:71]
  v_exp_f32 v52, v132
  v_mfma_f32_16x16x32_bf16 a[100:103], a[196:199], v[216:219], a[100:103]
  v_exp_f32 v53, v133
  v_mfma_f32_16x16x32_bf16 a[8:11], a[200:203], v[192:195], a[8:11]
  ds_read_b128 a[232:235], v4 offset:10240
  v_cvt_pk_bf16_f32 v225, v50, v51
  v_mfma_f32_16x16x32_bf16 a[40:43], a[200:203], v[200:203], a[40:43]
  buffer_load_dwordx4 v5, s[8:11], s63 offen offset:2048 lds
  v_mfma_f32_16x16x32_bf16 a[72:75], a[200:203], v[208:211], a[72:75]
  v_pk_maximum3_f16 v11, v224, v224, v225
  v_cvt_pk_bf16_f32 v226, v52, v53
  v_mfma_f32_16x16x32_bf16 a[104:107], a[200:203], v[216:219], a[104:107]
  v_exp_f32 v54, v134
  v_mfma_f32_16x16x32_bf16 v[36:39], v[60:63], v[200:203], v[36:39]
  ds_read_b128 a[236:239], v4 offset:11264
  v_mfma_f32_16x16x32_bf16 a[12:15], a[204:207], v[192:195], a[12:15]
  v_exp_f32 v55, v135
  v_mfma_f32_16x16x32_bf16 a[44:47], a[204:207], v[200:203], a[44:47]
  v_exp_f32 v48, v160
  v_mfma_f32_16x16x32_bf16 a[76:79], a[204:207], v[208:211], a[76:79]
  v_exp_f32 v49, v161
  v_mfma_f32_16x16x32_bf16 a[108:111], a[204:207], v[216:219], a[108:111]
  s_waitcnt lgkmcnt(4)
  v_cvt_pk_bf16_f32 v227, v54, v55
  v_pk_maximum3_f16 v11, v11, v226, v227
  v_mfma_f32_16x16x32_bf16 a[16:19], a[208:211], v[192:195], a[16:19]
  ds_read_b128 a[240:243], v4 offset:12288
  v_cvt_pk_bf16_f32 v240, v48, v49
  v_mfma_f32_16x16x32_bf16 a[48:51], a[208:211], v[200:203], a[48:51]
  buffer_load_dwordx4 v5, s[8:11], s63 offen offset:3072 lds
  v_mfma_f32_16x16x32_bf16 a[80:83], a[208:211], v[208:211], a[80:83]
  s_add_u32 s30, s30, 16384
  v_exp_f32 v50, v162
  v_mfma_f32_16x16x32_bf16 a[112:115], a[208:211], v[216:219], a[112:115]
  s_and_b32 s30, s30, 0xffff
  v_exp_f32 v51, v163
  v_mfma_f32_16x16x32_bf16 v[40:43], v[60:63], v[208:211], v[40:43]
  ds_read_b128 a[244:247], v4 offset:13312
  v_cvt_pk_bf16_f32 v241, v50, v51
  v_mfma_f32_16x16x32_bf16 a[20:23], a[212:215], v[192:195], a[20:23]
  s_cmp_lt_i32 s29, 0
  s_cselect_b32 s62, s60, 0
  v_pk_maximum3_f16 v11, v11, v240, v241
  v_mfma_f32_16x16x32_bf16 a[52:55], a[212:215], v[200:203], a[52:55]
  s_add_u32 s62, s62, s29
  v_exp_f32 v52, v164
  v_mfma_f32_16x16x32_bf16 a[84:87], a[212:215], v[208:211], a[84:87]
  s_cmp_ge_i32 s29, s61
  s_cselect_b32 s10, s35, 0
  v_mfma_f32_16x16x32_bf16 a[116:119], a[212:215], v[216:219], a[116:119]
  s_mov_b32 m0, s31
  v_exp_f32 v53, v165
  v_mfma_f32_16x16x32_bf16 a[24:27], a[216:219], v[192:195], a[24:27]
  ds_read_b128 a[248:251], v4 offset:14336
  v_cvt_pk_bf16_f32 v242, v52, v53
  v_mfma_f32_16x16x32_bf16 a[56:59], a[216:219], v[200:203], a[56:59]
  v_exp_f32 v54, v166
  v_mfma_f32_16x16x32_bf16 a[88:91], a[216:219], v[208:211], a[88:91]
  buffer_load_dwordx4 v5, s[8:11], s62 offen offset:0 lds
  v_mfma_f32_16x16x32_bf16 a[120:123], a[216:219], v[216:219], a[120:123]
  v_exp_f32 v55, v167
  v_mfma_f32_16x16x32_bf16 v[44:47], v[60:63], v[216:219], v[44:47]
  ds_read_b128 a[252:255], v4 offset:15360
  v_cvt_pk_bf16_f32 v243, v54, v55
  v_mfma_f32_16x16x32_bf16 a[28:31], a[220:223], v[192:195], a[28:31]
  s_add_u32 s33, s33, 32768
  s_cmp_eq_u32 s33, 163840
  s_cselect_b32 s33, 65536, s33
  v_mfma_f32_16x16x32_bf16 a[60:63], a[220:223], v[200:203], a[60:63]
  v_exp_f32 v48, v136
  v_mfma_f32_16x16x32_bf16 a[92:95], a[220:223], v[208:211], a[92:95]
  v_exp_f32 v49, v137
  v_mfma_f32_16x16x32_bf16 a[124:127], a[220:223], v[216:219], a[124:127]
  v_add_u32 v3, s33, v2
  s_waitcnt lgkmcnt(4)
  v_mfma_f32_16x16x32_bf16 a[0:3], a[224:227], v[196:199], a[0:3]
  ds_read_b128 a[192:195], v3 offset:0
  v_pk_maximum3_f16 v11, v11, v242, v243
  v_mfma_f32_16x16x32_bf16 a[32:35], a[224:227], v[204:207], a[32:35]
  v_exp_f32 v50, v138
  v_mfma_f32_16x16x32_bf16 a[64:67], a[224:227], v[212:215], a[64:67]
  v_exp_f32 v51, v139
  v_mfma_f32_16x16x32_bf16 a[96:99], a[224:227], v[220:223], a[96:99]
  buffer_load_dwordx4 v5, s[8:11], s62 offen offset:1024 lds
  v_mfma_f32_16x16x32_bf16 v[32:35], v[60:63], v[196:199], v[32:35]
  ds_read_b128 a[196:199], v3 offset:1024
  v_cvt_pk_bf16_f32 v228, v48, v49
  v_mfma_f32_16x16x32_bf16 a[4:7], a[228:231], v[196:199], a[4:7]
  v_exp_f32 v52, v140
  v_mfma_f32_16x16x32_bf16 a[36:39], a[228:231], v[204:207], a[36:39]
  v_exp_f32 v53, v141
  v_mfma_f32_16x16x32_bf16 a[68:71], a[228:231], v[212:215], a[68:71]
  v_cvt_pk_bf16_f32 v229, v50, v51
  v_mfma_f32_16x16x32_bf16 a[100:103], a[228:231], v[220:223], a[100:103]
  v_pk_maximum3_f16 v11, v11, v228, v229
  v_mfma_f32_16x16x32_bf16 a[8:11], a[232:235], v[196:199], a[8:11]
  ds_read_b128 a[200:203], v3 offset:2048
  v_cvt_pk_bf16_f32 v230, v52, v53
  v_mfma_f32_16x16x32_bf16 a[40:43], a[232:235], v[204:207], a[40:43]
  v_exp_f32 v54, v142
  v_mfma_f32_16x16x32_bf16 a[72:75], a[232:235], v[212:215], a[72:75]
  v_exp_f32 v55, v143
  v_mfma_f32_16x16x32_bf16 a[104:107], a[232:235], v[220:223], a[104:107]
  v_mfma_f32_16x16x32_bf16 v[36:39], v[60:63], v[204:207], v[36:39]
  ds_read_b128 a[204:207], v3 offset:3072
  v_cvt_pk_bf16_f32 v231, v54, v55
  v_mfma_f32_16x16x32_bf16 a[12:15], a[236:239], v[196:199], a[12:15]
  buffer_load_dwordx4 v5, s[8:11], s62 offen offset:2048 lds
  v_mfma_f32_16x16x32_bf16 a[44:47], a[236:239], v[204:207], a[44:47]
  v_exp_f32 v48, v168
  v_mfma_f32_16x16x32_bf16 a[76:79], a[236:239], v[212:215], a[76:79]
  v_exp_f32 v49, v169
  v_mfma_f32_16x16x32_bf16 a[108:111], a[236:239], v[220:223], a[108:111]
  s_waitcnt lgkmcnt(4)
  v_pk_maximum3_f16 v11, v11, v230, v231
  v_mfma_f32_16x16x32_bf16 a[16:19], a[240:243], v[196:199], a[16:19]
  ds_read_b128 a[208:211], v3 offset:4096
  v_cvt_pk_bf16_f32 v244, v48, v49
  v_mfma_f32_16x16x32_bf16 a[48:51], a[240:243], v[204:207], a[48:51]
  v_exp_f32 v50, v170
  v_mfma_f32_16x16x32_bf16 a[80:83], a[240:243], v[212:215], a[80:83]
  v_exp_f32 v51, v171
  v_mfma_f32_16x16x32_bf16 a[112:115], a[240:243], v[220:223], a[112:115]
  v_mfma_f32_16x16x32_bf16 v[40:43], v[60:63], v[212:215], v[40:43]
  ds_read_b128 a[212:215], v3 offset:5120
  v_cvt_pk_bf16_f32 v245, v50, v51
  v_mfma_f32_16x16x32_bf16 a[20:23], a[244:247], v[196:199], a[20:23]
  buffer_load_dwordx4 v5, s[8:11], s62 offen offset:3072 lds
  v_mfma_f32_16x16x32_bf16 a[52:55], a[244:247], v[204:207], a[52:55]
  s_add_u32 s31, s31, 16384
  s_cmp_eq_u32 s31, s32
  s_cselect_b32 s31, s47, s31
  s_add_u32 s28, s28, 0xfffe8000
  s_sub_u32 s29, s28, 131072
  v_mfma_f32_16x16x32_bf16 a[84:87], a[244:247], v[212:215], a[84:87]
  v_exp_f32 v52, v172
  v_mfma_f32_16x16x32_bf16 a[116:119], a[244:247], v[220:223], a[116:119]
  v_exp_f32 v53, v173
  v_mfma_f32_16x16x32_bf16 a[24:27], a[248:251], v[196:199], a[24:27]
  ds_read_b128 a[216:219], v3 offset:6144
  v_pk_maximum3_f16 v11, v11, v244, v245
  v_mfma_f32_16x16x32_bf16 a[56:59], a[248:251], v[204:207], a[56:59]
  v_exp_f32 v54, v174
  v_mfma_f32_16x16x32_bf16 a[88:91], a[248:251], v[212:215], a[88:91]
  v_exp_f32 v55, v175
  v_mfma_f32_16x16x32_bf16 a[120:123], a[248:251], v[220:223], a[120:123]
  v_cvt_pk_bf16_f32 v246, v52, v53
  v_mfma_f32_16x16x32_bf16 v[44:47], v[60:63], v[220:223], v[44:47]
  ds_read_b128 a[220:223], v3 offset:7168
  s_nop 0
  v_mfma_f32_16x16x32_bf16 a[28:31], a[252:255], v[196:199], a[28:31]
  v_cvt_pk_bf16_f32 v247, v54, v55
  v_pk_maximum3_f16 v11, v11, v246, v247
  v_mfma_f32_16x16x32_bf16 a[60:63], a[252:255], v[204:207], a[60:63]
  v_mfma_f32_16x16x32_bf16 a[92:95], a[252:255], v[212:215], a[92:95]
  v_mfma_f32_16x16x32_bf16 a[124:127], a[252:255], v[220:223], a[124:127]
  s_nop 15
  v_mov_b32 v56, v40
  v_rcp_f32 v56, v56
  v_mov_b32 v58, v44
  v_rcp_f32 v58, v58
  s_mov_b32 s38, s4
  s_lshl_b32 s38, s38, 2
  s_add_u32 s38, s38, s5
  s_lshl_b32 s38, s38, 18
  s_lshl_b32 s39, s3, 13
  s_add_u32 s38, s38, s39
  v_accvgpr_read_b32 v24, a64
  v_accvgpr_read_b32 v25, a65
  v_accvgpr_read_b32 v26, a66
  v_accvgpr_read_b32 v27, a67
  v_accvgpr_read_b32 v28, a96
  v_accvgpr_read_b32 v29, a97
  v_accvgpr_read_b32 v30, a98
  v_accvgpr_read_b32 v31, a99
  v_pk_mul_f32 v[24:25], v[24:25], v[56:57] op_sel_hi:[1,0]
  v_pk_mul_f32 v[26:27], v[26:27], v[56:57] op_sel_hi:[1,0]
  v_pk_mul_f32 v[28:29], v[28:29], v[58:59] op_sel_hi:[1,0]
  v_pk_mul_f32 v[30:31], v[30:31], v[58:59] op_sel_hi:[1,0]
  v_cvt_pk_bf16_f32 v48, v24, v25
  v_cvt_pk_bf16_f32 v49, v26, v27
  v_cvt_pk_bf16_f32 v50, v28, v29
  v_cvt_pk_bf16_f32 v51, v30, v31
  s_nop 1
  v_permlane16_swap_b32 v48, v50
  v_permlane16_swap_b32 v49, v51
  s_nop 0
  v_permlane32_swap_b32 v48, v50
  v_permlane32_swap_b32 v49, v51
  buffer_store_dwordx4 v[48:51], v2, s[16:19], s38 offen offset:0 sc1
  s_nop 1
  v_accvgpr_read_b32 v24, a68
  v_accvgpr_read_b32 v25, a69
  v_accvgpr_read_b32 v26, a70
  v_accvgpr_read_b32 v27, a71
  v_accvgpr_read_b32 v28, a100
  v_accvgpr_read_b32 v29, a101
  v_accvgpr_read_b32 v30, a102
  v_accvgpr_read_b32 v31, a103
  v_pk_mul_f32 v[24:25], v[24:25], v[56:57] op_sel_hi:[1,0]
  v_pk_mul_f32 v[26:27], v[26:27], v[56:57] op_sel_hi:[1,0]
  v_pk_mul_f32 v[28:29], v[28:29], v[58:59] op_sel_hi:[1,0]
  v_pk_mul_f32 v[30:31], v[30:31], v[58:59] op_sel_hi:[1,0]
  v_cvt_pk_bf16_f32 v48, v24, v25
  v_cvt_pk_bf16_f32 v49, v26, v27
  v_cvt_pk_bf16_f32 v50, v28, v29
  v_cvt_pk_bf16_f32 v51, v30, v31
  s_nop 1
  v_permlane16_swap_b32 v48, v50
  v_permlane16_swap_b32 v49, v51
  s_nop 0
  v_permlane32_swap_b32 v48, v50
  v_permlane32_swap_b32 v49, v51
  buffer_store_dwordx4 v[48:51], v2, s[16:19], s38 offen offset:1024 sc1
  s_nop 1
  v_accvgpr_read_b32 v24, a72
  v_accvgpr_read_b32 v25, a73
  v_accvgpr_read_b32 v26, a74
  v_accvgpr_read_b32 v27, a75
  v_accvgpr_read_b32 v28, a104
  v_accvgpr_read_b32 v29, a105
  v_accvgpr_read_b32 v30, a106
  v_accvgpr_read_b32 v31, a107
  v_pk_mul_f32 v[24:25], v[24:25], v[56:57] op_sel_hi:[1,0]
  v_pk_mul_f32 v[26:27], v[26:27], v[56:57] op_sel_hi:[1,0]
  v_pk_mul_f32 v[28:29], v[28:29], v[58:59] op_sel_hi:[1,0]
  v_pk_mul_f32 v[30:31], v[30:31], v[58:59] op_sel_hi:[1,0]
  v_cvt_pk_bf16_f32 v48, v24, v25
  v_cvt_pk_bf16_f32 v49, v26, v27
  v_cvt_pk_bf16_f32 v50, v28, v29
  v_cvt_pk_bf16_f32 v51, v30, v31
  s_nop 1
  v_permlane16_swap_b32 v48, v50
  v_permlane16_swap_b32 v49, v51
  s_nop 0
  v_permlane32_swap_b32 v48, v50
  v_permlane32_swap_b32 v49, v51
  buffer_store_dwordx4 v[48:51], v2, s[16:19], s38 offen offset:2048 sc1
  s_nop 1
  v_accvgpr_read_b32 v24, a76
  v_accvgpr_read_b32 v25, a77
  v_accvgpr_read_b32 v26, a78
  v_accvgpr_read_b32 v27, a79
  v_accvgpr_read_b32 v28, a108
  v_accvgpr_read_b32 v29, a109
  v_accvgpr_read_b32 v30, a110
  v_accvgpr_read_b32 v31, a111
  v_pk_mul_f32 v[24:25], v[24:25], v[56:57] op_sel_hi:[1,0]
  v_pk_mul_f32 v[26:27], v[26:27], v[56:57] op_sel_hi:[1,0]
  v_pk_mul_f32 v[28:29], v[28:29], v[58:59] op_sel_hi:[1,0]
  v_pk_mul_f32 v[30:31], v[30:31], v[58:59] op_sel_hi:[1,0]
  v_cvt_pk_bf16_f32 v48, v24, v25
  v_cvt_pk_bf16_f32 v49, v26, v27
  v_cvt_pk_bf16_f32 v50, v28, v29
  v_cvt_pk_bf16_f32 v51, v30, v31
  s_nop 1
  v_permlane16_swap_b32 v48, v50
  v_permlane16_swap_b32 v49, v51
  s_nop 0
  v_permlane32_swap_b32 v48, v50
  v_permlane32_swap_b32 v49, v51
  buffer_store_dwordx4 v[48:51], v2, s[16:19], s38 offen offset:3072 sc1
  s_nop 1
  v_accvgpr_read_b32 v24, a80
  v_accvgpr_read_b32 v25, a81
  v_accvgpr_read_b32 v26, a82
  v_accvgpr_read_b32 v27, a83
  v_accvgpr_read_b32 v28, a112
  v_accvgpr_read_b32 v29, a113
  v_accvgpr_read_b32 v30, a114
  v_accvgpr_read_b32 v31, a115
  v_pk_mul_f32 v[24:25], v[24:25], v[56:57] op_sel_hi:[1,0]
  v_pk_mul_f32 v[26:27], v[26:27], v[56:57] op_sel_hi:[1,0]
  v_pk_mul_f32 v[28:29], v[28:29], v[58:59] op_sel_hi:[1,0]
  v_pk_mul_f32 v[30:31], v[30:31], v[58:59] op_sel_hi:[1,0]
  v_cvt_pk_bf16_f32 v48, v24, v25
  v_cvt_pk_bf16_f32 v49, v26, v27
  v_cvt_pk_bf16_f32 v50, v28, v29
  v_cvt_pk_bf16_f32 v51, v30, v31
  s_nop 1
  v_permlane16_swap_b32 v48, v50
  v_permlane16_swap_b32 v49, v51
  s_nop 0
  v_permlane32_swap_b32 v48, v50
  v_permlane32_swap_b32 v49, v51
  s_add_u32 s38, s38, 4096
  buffer_store_dwordx4 v[48:51], v2, s[16:19], s38 offen offset:0 sc1
  s_nop 1
  v_accvgpr_read_b32 v24, a84
  v_accvgpr_read_b32 v25, a85
  v_accvgpr_read_b32 v26, a86
  v_accvgpr_read_b32 v27, a87
  v_accvgpr_read_b32 v28, a116
  v_accvgpr_read_b32 v29, a117
  v_accvgpr_read_b32 v30, a118
  v_accvgpr_read_b32 v31, a119
  v_pk_mul_f32 v[24:25], v[24:25], v[56:57] op_sel_hi:[1,0]
  v_pk_mul_f32 v[26:27], v[26:27], v[56:57] op_sel_hi:[1,0]
  v_pk_mul_f32 v[28:29], v[28:29], v[58:59] op_sel_hi:[1,0]
  v_pk_mul_f32 v[30:31], v[30:31], v[58:59] op_sel_hi:[1,0]
  v_cvt_pk_bf16_f32 v48, v24, v25
  v_cvt_pk_bf16_f32 v49, v26, v27
  v_cvt_pk_bf16_f32 v50, v28, v29
  v_cvt_pk_bf16_f32 v51, v30, v31
  s_nop 1
  v_permlane16_swap_b32 v48, v50
  v_permlane16_swap_b32 v49, v51
  s_nop 0
  v_permlane32_swap_b32 v48, v50
  v_permlane32_swap_b32 v49, v51
  buffer_store_dwordx4 v[48:51], v2, s[16:19], s38 offen offset:1024 sc1
  s_nop 1
  v_accvgpr_read_b32 v24, a88
  v_accvgpr_read_b32 v25, a89
  v_accvgpr_read_b32 v26, a90
  v_accvgpr_read_b32 v27, a91
  v_accvgpr_read_b32 v28, a120
  v_accvgpr_read_b32 v29, a121
  v_accvgpr_read_b32 v30, a122
  v_accvgpr_read_b32 v31, a123
  v_pk_mul_f32 v[24:25], v[24:25], v[56:57] op_sel_hi:[1,0]
  v_pk_mul_f32 v[26:27], v[26:27], v[56:57] op_sel_hi:[1,0]
  v_pk_mul_f32 v[28:29], v[28:29], v[58:59] op_sel_hi:[1,0]
  v_pk_mul_f32 v[30:31], v[30:31], v[58:59] op_sel_hi:[1,0]
  v_cvt_pk_bf16_f32 v48, v24, v25
  v_cvt_pk_bf16_f32 v49, v26, v27
  v_cvt_pk_bf16_f32 v50, v28, v29
  v_cvt_pk_bf16_f32 v51, v30, v31
  s_nop 1
  v_permlane16_swap_b32 v48, v50
  v_permlane16_swap_b32 v49, v51
  s_nop 0
  v_permlane32_swap_b32 v48, v50
  v_permlane32_swap_b32 v49, v51
  buffer_store_dwordx4 v[48:51], v2, s[16:19], s38 offen offset:2048 sc1
  s_nop 1
  v_accvgpr_read_b32 v24, a92
  v_accvgpr_read_b32 v25, a93
  v_accvgpr_read_b32 v26, a94
  v_accvgpr_read_b32 v27, a95
  v_accvgpr_read_b32 v28, a124
  v_accvgpr_read_b32 v29, a125
  v_accvgpr_read_b32 v30, a126
  v_accvgpr_read_b32 v31, a127
  v_pk_mul_f32 v[24:25], v[24:25], v[56:57] op_sel_hi:[1,0]
  v_pk_mul_f32 v[26:27], v[26:27], v[56:57] op_sel_hi:[1,0]
  v_pk_mul_f32 v[28:29], v[28:29], v[58:59] op_sel_hi:[1,0]
  v_pk_mul_f32 v[30:31], v[30:31], v[58:59] op_sel_hi:[1,0]
  v_cvt_pk_bf16_f32 v48, v24, v25
  v_cvt_pk_bf16_f32 v49, v26, v27
  v_cvt_pk_bf16_f32 v50, v28, v29
  v_cvt_pk_bf16_f32 v51, v30, v31
  s_nop 1
  v_permlane16_swap_b32 v48, v50
  v_permlane16_swap_b32 v49, v51
  s_nop 0
  v_permlane32_swap_b32 v48, v50
  v_permlane32_swap_b32 v49, v51
  buffer_store_dwordx4 v[48:51], v2, s[16:19], s38 offen offset:3072 sc1
  s_nop 1
  s_waitcnt lgkmcnt(4)
  v_mfma_f32_16x16x32_bf16 v[64:67], a[192:195], a[128:131], v[16:19]
  ds_read_b128 a[224:227], v3 offset:8192
  v_mfma_f32_16x16x32_bf16 v[96:99], a[192:195], a[144:147], v[20:23]
  v_exp_f32 v48, v144
  v_mfma_f32_16x16x32_bf16 v[64:67], a[196:199], a[132:135], v[64:67]
  ds_read_b128 a[228:231], v3 offset:9216
  v_mfma_f32_16x16x32_bf16 v[96:99], a[196:199], a[148:151], v[96:99]
  v_exp_f32 v49, v145
  v_mfma_f32_16x16x32_bf16 v[64:67], a[200:203], a[136:139], v[64:67]
  ds_read_b128 a[232:235], v3 offset:10240
  v_exp_f32 v50, v146
  v_mfma_f32_16x16x32_bf16 v[96:99], a[200:203], a[152:155], v[96:99]
  v_exp_f32 v51, v147
  v_mfma_f32_16x16x32_bf16 v[64:67], a[204:207], a[140:143], v[64:67]
  ds_read_b128 a[236:239], v3 offset:11264
  v_cvt_pk_bf16_f32 v232, v48, v49
  v_mfma_f32_16x16x32_bf16 v[96:99], a[204:207], a[156:159], v[96:99]
  s_waitcnt lgkmcnt(4)
  v_exp_f32 v52, v148
  v_mfma_f32_16x16x32_bf16 v[68:71], a[208:211], a[128:131], v[16:19]
  ds_read_b128 a[240:243], v3 offset:12288
  v_cvt_pk_bf16_f32 v233, v50, v51
  v_mfma_f32_16x16x32_bf16 v[100:103], a[208:211], a[144:147], v[20:23]
  v_exp_f32 v53, v149
  v_mfma_f32_16x16x32_bf16 v[68:71], a[212:215], a[132:135], v[68:71]
  ds_read_b128 a[244:247], v3 offset:13312
  v_pk_maximum3_f16 v11, v11, v232, v233
  v_mfma_f32_16x16x32_bf16 v[100:103], a[212:215], a[148:151], v[100:103]
  v_exp_f32 v54, v150
  v_mfma_f32_16x16x32_bf16 v[68:71], a[216:219], a[136:139], v[68:71]
  ds_read_b128 a[248:251], v3 offset:14336
  v_cvt_pk_bf16_f32 v234, v52, v53
  v_mfma_f32_16x16x32_bf16 v[100:103], a[216:219], a[152:155], v[100:103]
  v_exp_f32 v55, v151
  v_mfma_f32_16x16x32_bf16 v[68:71], a[220:223], a[140:143], v[68:71]
  ds_read_b128 a[252:255], v3 offset:15360
  v_cvt_pk_bf16_f32 v235, v54, v55
  v_mfma_f32_16x16x32_bf16 v[100:103], a[220:223], a[156:159], v[100:103]
  s_waitcnt lgkmcnt(4)
  v_exp_f32 v48, v176
  v_mfma_f32_16x16x32_bf16 v[72:75], a[224:227], a[128:131], v[16:19]
  ds_read_b128 a[192:195], v3 offset:16384
  v_pk_maximum3_f16 v11, v11, v234, v235
  v_mfma_f32_16x16x32_bf16 v[104:107], a[224:227], a[144:147], v[20:23]
  v_exp_f32 v49, v177
  v_mfma_f32_16x16x32_bf16 v[72:75], a[228:231], a[132:135], v[72:75]
  ds_read_b128 a[196:199], v3 offset:17408
  v_cvt_pk_bf16_f32 v248, v48, v49
  v_mfma_f32_16x16x32_bf16 v[104:107], a[228:231], a[148:151], v[104:107]
  v_exp_f32 v50, v178
  v_mfma_f32_16x16x32_bf16 v[72:75], a[232:235], a[136:139], v[72:75]
  ds_read_b128 a[200:203], v3 offset:18432
  v_mfma_f32_16x16x32_bf16 v[104:107], a[232:235], a[152:155], v[104:107]
  v_exp_f32 v51, v179
  v_mfma_f32_16x16x32_bf16 v[72:75], a[236:239], a[140:143], v[72:75]
  ds_read_b128 a[204:207], v3 offset:19456
  v_cvt_pk_bf16_f32 v249, v50, v51
  v_mfma_f32_16x16x32_bf16 v[104:107], a[236:239], a[156:159], v[104:107]
  s_waitcnt lgkmcnt(4)
  v_exp_f32 v52, v180
  v_mfma_f32_16x16x32_bf16 v[76:79], a[240:243], a[128:131], v[16:19]
  ds_read_b128 a[208:211], v3 offset:20480
  v_pk_maximum3_f16 v11, v11, v248, v249
  v_mfma_f32_16x16x32_bf16 v[108:111], a[240:243], a[144:147], v[20:23]
  v_exp_f32 v53, v181
  v_mfma_f32_16x16x32_bf16 v[76:79], a[244:247], a[132:135], v[76:79]
  ds_read_b128 a[212:215], v3 offset:21504
  v_cvt_pk_bf16_f32 v250, v52, v53
  v_mfma_f32_16x16x32_bf16 v[108:111], a[244:247], a[148:151], v[108:111]
  v_exp_f32 v54, v182
  v_mfma_f32_16x16x32_bf16 v[76:79], a[248:251], a[136:139], v[76:79]
  ds_read_b128 a[216:219], v3 offset:22528
  v_mfma_f32_16x16x32_bf16 v[108:111], a[248:251], a[152:155], v[108:111]
  v_exp_f32 v55, v183
  v_mfma_f32_16x16x32_bf16 v[76:79], a[252:255], a[140:143], v[76:79]
  ds_read_b128 a[220:223], v3 offset:23552
  v_cvt_pk_bf16_f32 v251, v54, v55
  v_mfma_f32_16x16x32_bf16 v[108:111], a[252:255], a[156:159], v[108:111]
  s_waitcnt lgkmcnt(4)
  v_exp_f32 v48, v152
  v_mfma_f32_16x16x32_bf16 v[80:83], a[192:195], a[128:131], v[16:19]
  ds_read_b128 a[224:227], v3 offset:24576
  v_pk_maximum3_f16 v11, v11, v250, v251
  v_mfma_f32_16x16x32_bf16 v[112:115], a[192:195], a[144:147], v[20:23]
  v_exp_f32 v49, v153
  v_mfma_f32_16x16x32_bf16 v[80:83], a[196:199], a[132:135], v[80:83]
  ds_read_b128 a[228:231], v3 offset:25600
  v_cvt_pk_bf16_f32 v236, v48, v49
  v_mfma_f32_16x16x32_bf16 v[112:115], a[196:199], a[148:151], v[112:115]
  v_exp_f32 v50, v154
  v_mfma_f32_16x16x32_bf16 v[80:83], a[200:203], a[136:139], v[80:83]
  ds_read_b128 a[232:235], v3 offset:26624
  v_mfma_f32_16x16x32_bf16 v[112:115], a[200:203], a[152:155], v[112:115]
  v_exp_f32 v51, v155
  v_mfma_f32_16x16x32_bf16 v[80:83], a[204:207], a[140:143], v[80:83]
  ds_read_b128 a[236:239], v3 offset:27648
  v_cvt_pk_bf16_f32 v237, v50, v51
  v_mfma_f32_16x16x32_bf16 v[112:115], a[204:207], a[156:159], v[112:115]
  s_waitcnt lgkmcnt(4)
  v_exp_f32 v52, v156
  v_mfma_f32_16x16x32_bf16 v[84:87], a[208:211], a[128:131], v[16:19]
  ds_read_b128 a[240:243], v3 offset:28672
  v_pk_maximum3_f16 v11, v11, v236, v237
  v_mfma_f32_16x16x32_bf16 v[116:119], a[208:211], a[144:147], v[20:23]
  v_exp_f32 v53, v157
  v_mfma_f32_16x16x32_bf16 v[84:87], a[212:215], a[132:135], v[84:87]
  ds_read_b128 a[244:247], v3 offset:29696
  v_cvt_pk_bf16_f32 v238, v52, v53
  v_mfma_f32_16x16x32_bf16 v[116:119], a[212:215], a[148:151], v[116:119]
  v_exp_f32 v54, v158
  v_mfma_f32_16x16x32_bf16 v[84:87], a[216:219], a[136:139], v[84:87]
  ds_read_b128 a[248:251], v3 offset:30720
  v_mfma_f32_16x16x32_bf16 v[116:119], a[216:219], a[152:155], v[116:119]
  v_exp_f32 v55, v159
  v_mfma_f32_16x16x32_bf16 v[84:87], a[220:223], a[140:143], v[84:87]
  ds_read_b128 a[252:255], v3 offset:31744
  v_add_u32 v4, s34, v2
  v_cvt_pk_bf16_f32 v239, v54, v55
  v_mfma_f32_16x16x32_bf16 v[116:119], a[220:223], a[156:159], v[116:119]
  s_add_u32 s34, s34, 32768
  s_and_b32 s34, s34, 0xffff
  s_waitcnt vmcnt(8)
  s_barrier
  s_waitcnt lgkmcnt(4)
  v_mfma_f32_16x16x32_bf16 v[88:91], a[224:227], a[128:131], v[16:19]
  ds_read_b128 a[192:195], v4 offset:0
  v_exp_f32 v48, v184
  v_mfma_f32_16x16x32_bf16 v[120:123], a[224:227], a[144:147], v[20:23]
  s_cmp_lt_i32 s28, 0
  s_cselect_b32 s63, s60, 0
  v_exp_f32 v49, v185
  v_mfma_f32_16x16x32_bf16 v[88:91], a[228:231], a[132:135], v[88:91]
  ds_read_b128 a[196:199], v4 offset:1024
  v_pk_maximum3_f16 v11, v11, v238, v239
  v_cvt_pk_bf16_f32 v252, v48, v49
  v_mfma_f32_16x16x32_bf16 v[120:123], a[228:231], a[148:151], v[120:123]
  s_add_u32 s63, s63, s28
  v_exp_f32 v50, v186
  v_mfma_f32_16x16x32_bf16 v[88:91], a[232:235], a[136:139], v[88:91]
  ds_read_b128 a[200:203], v4 offset:2048
  s_add_u32 s63, s63, 16384
  s_cmp_ge_i32 s28, s61
  s_cselect_b32 s10, s35, 0
  s_mov_b32 m0, s30
  v_mfma_f32_16x16x32_bf16 v[120:123], a[232:235], a[152:155], v[120:123]
  buffer_load_dwordx4 v5, s[8:11], s63 offen offset:0 lds
  v_mfma_f32_16x16x32_bf16 v[88:91], a[236:239], a[140:143], v[88:91]
  ds_read_b128 a[204:207], v4 offset:3072
  v_exp_f32 v51, v187
  v_mfma_f32_16x16x32_bf16 v[120:123], a[236:239], a[156:159], v[120:123]
  s_waitcnt lgkmcnt(4)
  v_exp_f32 v52, v188
  v_cvt_pk_bf16_f32 v253, v50, v51
  v_mfma_f32_16x16x32_bf16 v[92:95], a[240:243], a[128:131], v[16:19]
  ds_read_b128 a[208:211], v4 offset:4096
  v_pk_maximum3_f16 v11, v11, v252, v253
  v_mfma_f32_16x16x32_bf16 v[124:127], a[240:243], a[144:147], v[20:23]
  v_exp_f32 v53, v189
  v_mfma_f32_16x16x32_bf16 v[92:95], a[244:247], a[132:135], v[92:95]
  ds_read_b128 a[212:215], v4 offset:5120
  v_cvt_pk_bf16_f32 v254, v52, v53
  v_mfma_f32_16x16x32_bf16 v[124:127], a[244:247], a[148:151], v[124:127]
  buffer_load_dwordx4 v5, s[8:11], s63 offen offset:1024 lds
  v_mfma_f32_16x16x32_bf16 v[92:95], a[248:251], a[136:139], v[92:95]
  ds_read_b128 a[216:219], v4 offset:6144
  v_exp_f32 v54, v190
  v_mfma_f32_16x16x32_bf16 v[124:127], a[248:251], a[152:155], v[124:127]
  v_exp_f32 v55, v191
  v_mfma_f32_16x16x32_bf16 v[92:95], a[252:255], a[140:143], v[92:95]
  ds_read_b128 a[220:223], v4 offset:7168
  s_nop 0
  v_cvt_pk_bf16_f32 v255, v54, v55
  v_pk_maximum3_f16 v11, v11, v254, v255
  v_mfma_f32_16x16x32_bf16 v[124:127], a[252:255], a[156:159], v[124:127]
  s_waitcnt lgkmcnt(4)
  v_lshrrev_b32 v56, 16, v11
  v_and_b32 v57, 0xffff, v11
  v_max_u32 v56, v56, v57
  v_cmp_lt_u32 vcc, 0x4e80, v56
  s_nop 1
  s_cbranch_vccnz K2_rare_B1
K2_ret_B1:
  v_mfma_f32_16x16x32_bf16 a[0:3], a[192:195], v[224:227], a[0:3]
  ds_read_b128 a[224:227], v4 offset:8192
  v_mfma_f32_16x16x32_bf16 a[32:35], a[192:195], v[240:243], a[32:35]
  buffer_load_dwordx4 v5, s[8:11], s63 offen offset:2048 lds
  v_mfma_f32_16x16x32_bf16 v[32:35], v[60:63], v[224:227], v[32:35]
  ds_read_b128 a[228:231], v4 offset:9216
  v_exp_f32 v48, v64
  v_mfma_f32_16x16x32_bf16 a[4:7], a[196:199], v[224:227], a[4:7]
  v_exp_f32 v49, v65
  v_mfma_f32_16x16x32_bf16 a[36:39], a[196:199], v[240:243], a[36:39]
  buffer_load_dwordx4 v5, s[8:11], s63 offen offset:3072 lds
  v_cvt_pk_bf16_f32 v192, v48, v49
  v_mfma_f32_16x16x32_bf16 a[8:11], a[200:203], v[224:227], a[8:11]
  ds_read_b128 a[232:235], v4 offset:10240
  v_mfma_f32_16x16x32_bf16 a[40:43], a[200:203], v[240:243], a[40:43]
  s_add_u32 s30, s30, 16384
  v_exp_f32 v50, v66
  v_mfma_f32_16x16x32_bf16 v[36:39], v[60:63], v[240:243], v[36:39]
  ds_read_b128 a[236:239], v4 offset:11264
  s_and_b32 s30, s30, 0xffff
  s_cmp_lt_i32 s29, 0
  s_cselect_b32 s62, s60, 0
  s_add_u32 s62, s62, s29
  s_cmp_ge_i32 s29, s61
  s_cselect_b32 s10, s35, 0
  s_mov_b32 m0, s31
  v_mfma_f32_16x16x32_bf16 a[12:15], a[204:207], v[224:227], a[12:15]
  buffer_load_dwordx4 v5, s[8:11], s62 offen offset:0 lds
  v_exp_f32 v51, v67
  v_mfma_f32_16x16x32_bf16 a[44:47], a[204:207], v[240:243], a[44:47]
  s_waitcnt lgkmcnt(4)
  v_exp_f32 v52, v68
  v_mfma_f32_16x16x32_bf16 a[16:19], a[208:211], v[224:227], a[16:19]
  ds_read_b128 a[240:243], v4 offset:12288
  v_cvt_pk_bf16_f32 v193, v50, v51
  v_mfma_f32_16x16x32_bf16 a[48:51], a[208:211], v[240:243], a[48:51]
  v_exp_f32 v53, v69
  v_mfma_f32_16x16x32_bf16 a[20:23], a[212:215], v[224:227], a[20:23]
  ds_read_b128 a[244:247], v4 offset:13312
  v_pk_maximum3_f16 v11, v192, v192, v193
  v_mfma_f32_16x16x32_bf16 a[52:55], a[212:215], v[240:243], a[52:55]
  v_exp_f32 v54, v70
  v_mfma_f32_16x16x32_bf16 a[24:27], a[216:219], v[224:227], a[24:27]
  ds_read_b128 a[248:251], v4 offset:14336
  v_cvt_pk_bf16_f32 v194, v52, v53
  v_mfma_f32_16x16x32_bf16 a[56:59], a[216:219], v[240:243], a[56:59]
  buffer_load_dwordx4 v5, s[8:11], s62 offen offset:1024 lds
  v_mfma_f32_16x16x32_bf16 a[28:31], a[220:223], v[224:227], a[28:31]
  ds_read_b128 a[252:255], v4 offset:15360
  v_exp_f32 v55, v71
  v_mfma_f32_16x16x32_bf16 a[60:63], a[220:223], v[240:243], a[60:63]
  s_waitcnt lgkmcnt(4)
  v_exp_f32 v48, v96
  v_mfma_f32_16x16x32_bf16 a[0:3], a[224:227], v[228:231], a[0:3]
  ds_read_b128 a[192:195], v4 offset:16384
  v_cvt_pk_bf16_f32 v195, v54, v55
  v_mfma_f32_16x16x32_bf16 a[32:35], a[224:227], v[244:247], a[32:35]
  buffer_load_dwordx4 v5, s[8:11], s62 offen offset:2048 lds
  v_mfma_f32_16x16x32_bf16 v[32:35], v[60:63], v[228:231], v[32:35]
  ds_read_b128 a[196:199], v4 offset:17408
  v_pk_maximum3_f16 v11, v11, v194, v195
  v_mfma_f32_16x16x32_bf16 a[4:7], a[228:231], v[228:231], a[4:7]
  v_exp_f32 v49, v97
  v_mfma_f32_16x16x32_bf16 a[36:39], a[228:231], v[244:247], a[36:39]
  v_exp_f32 v50, v98
  v_mfma_f32_16x16x32_bf16 a[8:11], a[232:235], v[228:231], a[8:11]
  ds_read_b128 a[200:203], v4 offset:18432
  v_cvt_pk_bf16_f32 v208, v48, v49
  v_mfma_f32_16x16x32_bf16 a[40:43], a[232:235], v[244:247], a[40:43]
  buffer_load_dwordx4 v5, s[8:11], s62 offen offset:3072 lds
  v_mfma_f32_16x16x32_bf16 v[36:39], v[60:63], v[244:247], v[36:39]
  ds_read_b128 a[204:207], v4 offset:19456
  v_exp_f32 v51, v99
  v_mfma_f32_16x16x32_bf16 a[12:15], a[236:239], v[228:231], a[12:15]
  s_add_u32 s31, s31, 16384
  v_exp_f32 v52, v100
  v_mfma_f32_16x16x32_bf16 a[44:47], a[236:239], v[244:247], a[44:47]
  s_waitcnt lgkmcnt(4)
  v_exp_f32 v53, v101
  v_mfma_f32_16x16x32_bf16 a[16:19], a[240:243], v[228:231], a[16:19]
  ds_read_b128 a[208:211], v4 offset:20480
  s_cmp_eq_u32 s31, s32
  s_cselect_b32 s31, s47, s31
  s_add_u32 s28, s28, 0x8000
  s_sub_u32 s29, s28, 131072
  s_cmp_lt_i32 s28, 0
  s_cselect_b32 s63, s60, 0
  s_add_u32 s63, s63, s28
  s_add_u32 s63, s63, 16384
  s_cmp_ge_i32 s28, s61
  s_cselect_b32 s10, s35, 0
  s_mov_b32 m0, s30
  v_mfma_f32_16x16x32_bf16 a[48:51], a[240:243], v[244:247], a[48:51]
  buffer_load_dwordx4 v5, s[8:11], s63 offen offset:0 lds
  v_cvt_pk_bf16_f32 v209, v50, v51
  v_mfma_f32_16x16x32_bf16 a[20:23], a[244:247], v[228:231], a[20:23]
  ds_read_b128 a[212:215], v4 offset:21504
  v_pk_maximum3_f16 v11, v11, v208, v209
  v_mfma_f32_16x16x32_bf16 a[52:55], a[244:247], v[244:247], a[52:55]
  v_exp_f32 v54, v102
  v_mfma_f32_16x16x32_bf16 a[24:27], a[248:251], v[228:231], a[24:27]
  ds_read_b128 a[216:219], v4 offset:22528
  v_cvt_pk_bf16_f32 v210, v52, v53
  v_mfma_f32_16x16x32_bf16 a[56:59], a[248:251], v[244:247], a[56:59]
  buffer_load_dwordx4 v5, s[8:11], s63 offen offset:1024 lds
  v_mfma_f32_16x16x32_bf16 a[28:31], a[252:255], v[228:231], a[28:31]
  ds_read_b128 a[220:223], v4 offset:23552
  v_exp_f32 v55, v103
  v_mfma_f32_16x16x32_bf16 a[60:63], a[252:255], v[244:247], a[60:63]
  s_waitcnt lgkmcnt(4)
  v_exp_f32 v48, v72
  v_mfma_f32_16x16x32_bf16 a[0:3], a[192:195], v[232:235], a[0:3]
  ds_read_b128 a[224:227], v4 offset:24576
  v_cvt_pk_bf16_f32 v211, v54, v55
  v_mfma_f32_16x16x32_bf16 a[32:35], a[192:195], v[248:251], a[32:35]
  v_exp_f32 v49, v73
  v_mfma_f32_16x16x32_bf16 v[32:35], v[60:63], v[232:235], v[32:35]
  ds_read_b128 a[228:231], v4 offset:25600
  v_pk_maximum3_f16 v11, v11, v210, v211
  v_mfma_f32_16x16x32_bf16 a[4:7], a[196:199], v[232:235], a[4:7]
  buffer_load_dwordx4 v5, s[8:11], s63 offen offset:2048 lds
  v_mfma_f32_16x16x32_bf16 a[36:39], a[196:199], v[248:251], a[36:39]
  v_exp_f32 v50, v74
  v_mfma_f32_16x16x32_bf16 a[8:11], a[200:203], v[232:235], a[8:11]
  ds_read_b128 a[232:235], v4 offset:26624
  v_cvt_pk_bf16_f32 v196, v48, v49
  v_mfma_f32_16x16x32_bf16 a[40:43], a[200:203], v[248:251], a[40:43]
  v_exp_f32 v51, v75
  v_mfma_f32_16x16x32_bf16 v[36:39], v[60:63], v[248:251], v[36:39]
  ds_read_b128 a[236:239], v4 offset:27648
  v_cvt_pk_bf16_f32 v197, v50, v51
  v_mfma_f32_16x16x32_bf16 a[12:15], a[204:207], v[232:235], a[12:15]
  buffer_load_dwordx4 v5, s[8:11], s63 offen offset:3072 lds
  v_mfma_f32_16x16x32_bf16 a[44:47], a[204:207], v[248:251], a[44:47]
  s_waitcnt lgkmcnt(4)
  v_exp_f32 v52, v76
  v_mfma_f32_16x16x32_bf16 a[16:19], a[208:211], v[232:235], a[16:19]
  ds_read_b128 a[240:243], v4 offset:28672
  v_pk_maximum3_f16 v11, v11, v196, v197
  v_mfma_f32_16x16x32_bf16 a[48:51], a[208:211], v[248:251], a[48:51]
  s_add_u32 s30, s30, 16384
  v_exp_f32 v53, v77
  v_mfma_f32_16x16x32_bf16 a[20:23], a[212:215], v[232:235], a[20:23]
  ds_read_b128 a[244:247], v4 offset:29696
  s_and_b32 s30, s30, 0xffff
  s_cmp_lt_i32 s29, 0
  s_cselect_b32 s62, s60, 0
  s_add_u32 s62, s62, s29
  s_cmp_ge_i32 s29, s61
  s_cselect_b32 s10, s35, 0
  s_mov_b32 m0, s31
  v_mfma_f32_16x16x32_bf16 a[52:55], a[212:215], v[248:251], a[52:55]
  buffer_load_dwordx4 v5, s[8:11], s62 offen offset:0 lds
  v_cvt_pk_bf16_f32 v198, v52, v53
  v_mfma_f32_16x16x32_bf16 a[24:27], a[216:219], v[232:235], a[24:27]
  ds_read_b128 a[248:251], v4 offset:30720
  s_add_u32 s33, s33, 32768
  s_cmp_eq_u32 s33, 163840
  s_cselect_b32 s33, 65536, s33
  v_mfma_f32_16x16x32_bf16 a[56:59], a[216:219], v[248:251], a[56:59]
  v_exp_f32 v54, v78
  v_mfma_f32_16x16x32_bf16 a[28:31], a[220:223], v[232:235], a[28:31]
  ds_read_b128 a[252:255], v4 offset:31744
  v_exp_f32 v55, v79
  v_mfma_f32_16x16x32_bf16 a[60:63], a[220:223], v[248:251], a[60:63]
  v_cvt_pk_bf16_f32 v199, v54, v55
  v_add_u32 v3, s33, v2
  s_waitcnt lgkmcnt(4)
  v_mfma_f32_16x16x32_bf16 a[0:3], a[224:227], v[236:239], a[0:3]
  ds_read_b128 a[192:195], v3 offset:0
  v_pk_maximum3_f16 v11, v11, v198, v199
  v_mfma_f32_16x16x32_bf16 a[32:35], a[224:227], v[252:255], a[32:35]
  buffer_load_dwordx4 v5, s[8:11], s62 offen offset:1024 lds
  v_mfma_f32_16x16x32_bf16 v[32:35], v[60:63], v[236:239], v[32:35]
  ds_read_b128 a[196:199], v3 offset:1024
  v_exp_f32 v48, v104
  v_mfma_f32_16x16x32_bf16 a[4:7], a[228:231], v[236:239], a[4:7]
  v_exp_f32 v49, v105
  v_mfma_f32_16x16x32_bf16 a[36:39], a[228:231], v[252:255], a[36:39]
  v_exp_f32 v50, v106
  v_mfma_f32_16x16x32_bf16 a[8:11], a[232:235], v[236:239], a[8:11]
  ds_read_b128 a[200:203], v3 offset:2048
  v_cvt_pk_bf16_f32 v212, v48, v49
  v_mfma_f32_16x16x32_bf16 a[40:43], a[232:235], v[252:255], a[40:43]
  buffer_load_dwordx4 v5, s[8:11], s62 offen offset:2048 lds
  v_mfma_f32_16x16x32_bf16 v[36:39], v[60:63], v[252:255], v[36:39]
  ds_read_b128 a[204:207], v3 offset:3072
  v_exp_f32 v51, v107
  v_mfma_f32_16x16x32_bf16 a[12:15], a[236:239], v[236:239], a[12:15]
  v_exp_f32 v52, v108
  v_mfma_f32_16x16x32_bf16 a[44:47], a[236:239], v[252:255], a[44:47]
  s_waitcnt lgkmcnt(4)
  v_exp_f32 v53, v109
  v_mfma_f32_16x16x32_bf16 a[16:19], a[240:243], v[236:239], a[16:19]
  ds_read_b128 a[208:211], v3 offset:4096
  v_cvt_pk_bf16_f32 v213, v50, v51
  v_mfma_f32_16x16x32_bf16 a[48:51], a[240:243], v[252:255], a[48:51]
  buffer_load_dwordx4 v5, s[8:11], s62 offen offset:3072 lds
  v_mfma_f32_16x16x32_bf16 a[20:23], a[244:247], v[236:239], a[20:23]
  ds_read_b128 a[212:215], v3 offset:5120
  s_add_u32 s31, s31, 16384
  s_cmp_eq_u32 s31, s32
  s_cselect_b32 s31, s47, s31
  s_add_u32 s28, s28, 0xfffe8000
  s_sub_u32 s29, s28, 131072
  v_mfma_f32_16x16x32_bf16 a[52:55], a[244:247], v[252:255], a[52:55]
  v_pk_maximum3_f16 v11, v11, v212, v213
  v_exp_f32 v54, v110
  v_mfma_f32_16x16x32_bf16 a[24:27], a[248:251], v[236:239], a[24:27]
  ds_read_b128 a[216:219], v3 offset:6144
  v_cvt_pk_bf16_f32 v214, v52, v53
  v_mfma_f32_16x16x32_bf16 a[56:59], a[248:251], v[252:255], a[56:59]
  v_exp_f32 v55, v111
  v_mfma_f32_16x16x32_bf16 a[28:31], a[252:255], v[236:239], a[28:31]
  ds_read_b128 a[220:223], v3 offset:7168
  s_nop 0
  v_mfma_f32_16x16x32_bf16 a[60:63], a[252:255], v[252:255], a[60:63]
  v_cvt_pk_bf16_f32 v215, v54, v55
  v_pk_maximum3_f16 v11, v11, v214, v215
  s_sub_u32 s37, 6, s4
  s_cmp_eq_u32 s37, 0
  s_cbranch_scc1 K2_fin
K2_loop1:
  s_waitcnt lgkmcnt(4)
  v_mfma_f32_16x16x32_bf16 v[128:131], a[192:195], a[128:131], v[16:19]
  ds_read_b128 a[224:227], v3 offset:8192
  v_mfma_f32_16x16x32_bf16 v[160:163], a[192:195], a[144:147], v[20:23]
  v_exp_f32 v48, v80
  v_mfma_f32_16x16x32_bf16 v[128:131], a[196:199], a[132:135], v[128:131]
  ds_read_b128 a[228:231], v3 offset:9216
  v_mfma_f32_16x16x32_bf16 v[160:163], a[196:199], a[148:151], v[160:163]
  v_exp_f32 v49, v81
  v_mfma_f32_16x16x32_bf16 v[128:131], a[200:203], a[136:139], v[128:131]
  ds_read_b128 a[232:235], v3 offset:10240
  v_exp_f32 v50, v82
  v_mfma_f32_16x16x32_bf16 v[160:163], a[200:203], a[152:155], v[160:163]
  v_exp_f32 v51, v83
  v_mfma_f32_16x16x32_bf16 v[128:131], a[204:207], a[140:143], v[128:131]
  ds_read_b128 a[236:239], v3 offset:11264
  v_cvt_pk_bf16_f32 v200, v48, v49
  v_mfma_f32_16x16x32_bf16 v[160:163], a[204:207], a[156:159], v[160:163]
  s_waitcnt lgkmcnt(4)
  v_exp_f32 v52, v84
  v_mfma_f32_16x16x32_bf16 v[132:135], a[208:211], a[128:131], v[16:19]
  ds_read_b128 a[240:243], v3 offset:12288
  v_cvt_pk_bf16_f32 v201, v50, v51
  v_mfma_f32_16x16x32_bf16 v[164:167], a[208:211], a[144:147], v[20:23]
  v_exp_f32 v53, v85
  v_mfma_f32_16x16x32_bf16 v[132:135], a[212:215], a[132:135], v[132:135]
  ds_read_b128 a[244:247], v3 offset:13312
  v_pk_maximum3_f16 v11, v11, v200, v201
  v_mfma_f32_16x16x32_bf16 v[164:167], a[212:215], a[148:151], v[164:167]
  v_exp_f32 v54, v86
  v_mfma_f32_16x16x32_bf16 v[132:135], a[216:219], a[136:139], v[132:135]
  ds_read_b128 a[248:251], v3 offset:14336
  v_cvt_pk_bf16_f32 v202, v52, v53
  v_mfma_f32_16x16x32_bf16 v[164:167], a[216:219], a[152:155], v[164:167]
  v_exp_f32 v55, v87
  v_mfma_f32_16x16x32_bf16 v[132:135], a[220:223], a[140:143], v[132:135]
  ds_read_b128 a[252:255], v3 offset:15360
  v_cvt_pk_bf16_f32 v203, v54, v55
  v_mfma_f32_16x16x32_bf16 v[164:167], a[220:223], a[156:159], v[164:167]
  s_waitcnt lgkmcnt(4)
  v_exp_f32 v48, v112
  v_mfma_f32_16x16x32_bf16 v[136:139], a[224:227], a[128:131], v[16:19]
  ds_read_b128 a[192:195], v3 offset:16384
  v_pk_maximum3_f16 v11, v11, v202, v203
  v_mfma_f32_16x16x32_bf16 v[168:171], a[224:227], a[144:147], v[20:23]
  v_exp_f32 v49, v113
  v_mfma_f32_16x16x32_bf16 v[136:139], a[228:231], a[132:135], v[136:139]
  ds_read_b128 a[196:199], v3 offset:17408
  v_cvt_pk_bf16_f32 v216, v48, v49
  v_mfma_f32_16x16x32_bf16 v[168:171], a[228:231], a[148:151], v[168:171]
  v_exp_f32 v50, v114
  v_mfma_f32_16x16x32_bf16 v[136:139], a[232:235], a[136:139], v[136:139]
  ds_read_b128 a[200:203], v3 offset:18432
  v_mfma_f32_16x16x32_bf16 v[168:171], a[232:235], a[152:155], v[168:171]
  v_exp_f32 v51, v115
  v_mfma_f32_16x16x32_bf16 v[136:139], a[236:239], a[140:143], v[136:139]
  ds_read_b128 a[204:207], v3 offset:19456
  v_cvt_pk_bf16_f32 v217, v50, v51
  v_mfma_f32_16x16x32_bf16 v[168:171], a[236:239], a[156:159], v[168:171]
  s_waitcnt lgkmcnt(4)
  v_exp_f32 v52, v116
  v_mfma_f32_16x16x32_bf16 v[140:143], a[240:243], a[128:131], v[16:19]
  ds_read_b128 a[208:211], v3 offset:20480
  v_pk_maximum3_f16 v11, v11, v216, v217
  v_mfma_f32_16x16x32_bf16 v[172:175], a[240:243], a[144:147], v[20:23]
  v_exp_f32 v53, v117
  v_mfma_f32_16x16x32_bf16 v[140:143], a[244:247], a[132:135], v[140:143]
  ds_read_b128 a[212:215], v3 offset:21504
  v_cvt_pk_bf16_f32 v218, v52, v53
  v_mfma_f32_16x16x32_bf16 v[172:175], a[244:247], a[148:151], v[172:175]
  v_exp_f32 v54, v118
  v_mfma_f32_16x16x32_bf16 v[140:143], a[248:251], a[136:139], v[140:143]
  ds_read_b128 a[216:219], v3 offset:22528
  v_mfma_f32_16x16x32_bf16 v[172:175], a[248:251], a[152:155], v[172:175]
  v_exp_f32 v55, v119
  v_mfma_f32_16x16x32_bf16 v[140:143], a[252:255], a[140:143], v[140:143]
  ds_read_b128 a[220:223], v3 offset:23552
  v_cvt_pk_bf16_f32 v219, v54, v55
  v_mfma_f32_16x16x32_bf16 v[172:175], a[252:255], a[156:159], v[172:175]
  s_waitcnt lgkmcnt(4)
  v_exp_f32 v48, v88
  v_mfma_f32_16x16x32_bf16 v[144:147], a[192:195], a[128:131], v[16:19]
  ds_read_b128 a[224:227], v3 offset:24576
  v_pk_maximum3_f16 v11, v11, v218, v219
  v_mfma_f32_16x16x32_bf16 v[176:179], a[192:195], a[144:147], v[20:23]
  v_exp_f32 v49, v89
  v_mfma_f32_16x16x32_bf16 v[144:147], a[196:199], a[132:135], v[144:147]
  ds_read_b128 a[228:231], v3 offset:25600
  v_cvt_pk_bf16_f32 v204, v48, v49
  v_mfma_f32_16x16x32_bf16 v[176:179], a[196:199], a[148:151], v[176:179]
  v_exp_f32 v50, v90
  v_mfma_f32_16x16x32_bf16 v[144:147], a[200:203], a[136:139], v[144:147]
  ds_read_b128 a[232:235], v3 offset:26624
  v_mfma_f32_16x16x32_bf16 v[176:179], a[200:203], a[152:155], v[176:179]
  v_exp_f32 v51, v91
  v_mfma_f32_16x16x32_bf16 v[144:147], a[204:207], a[140:143], v[144:147]
  ds_read_b128 a[236:239], v3 offset:27648
  v_cvt_pk_bf16_f32 v205, v50, v51
  v_mfma_f32_16x16x32_bf16 v[176:179], a[204:207], a[156:159], v[176:179]
  s_waitcnt lgkmcnt(4)
  v_exp_f32 v52, v92
  v_mfma_f32_16x16x32_bf16 v[148:151], a[208:211], a[128:131], v[16:19]
  ds_read_b128 a[240:243], v3 offset:28672
  v_pk_maximum3_f16 v11, v11, v204, v205
  v_mfma_f32_16x16x32_bf16 v[180:183], a[208:211], a[144:147], v[20:23]
  v_exp_f32 v53, v93
  v_mfma_f32_16x16x32_bf16 v[148:151], a[212:215], a[132:135], v[148:151]
  ds_read_b128 a[244:247], v3 offset:29696
  v_cvt_pk_bf16_f32 v206, v52, v53
  v_mfma_f32_16x16x32_bf16 v[180:183], a[212:215], a[148:151], v[180:183]
  v_exp_f32 v54, v94
  v_mfma_f32_16x16x32_bf16 v[148:151], a[216:219], a[136:139], v[148:151]
  ds_read_b128 a[248:251], v3 offset:30720
  v_mfma_f32_16x16x32_bf16 v[180:183], a[216:219], a[152:155], v[180:183]
  v_exp_f32 v55, v95
  v_mfma_f32_16x16x32_bf16 v[148:151], a[220:223], a[140:143], v[148:151]
  ds_read_b128 a[252:255], v3 offset:31744
  v_add_u32 v4, s34, v2
  v_cvt_pk_bf16_f32 v207, v54, v55
  v_mfma_f32_16x16x32_bf16 v[180:183], a[220:223], a[156:159], v[180:183]
  s_add_u32 s34, s34, 32768
  s_and_b32 s34, s34, 0xffff
  s_waitcnt vmcnt(0)
  s_barrier
  s_waitcnt lgkmcnt(4)
  v_mfma_f32_16x16x32_bf16 v[152:155], a[224:227], a[128:131], v[16:19]
  ds_read_b128 a[192:195], v4 offset:0
  v_exp_f32 v48, v120
  v_mfma_f32_16x16x32_bf16 v[184:187], a[224:227], a[144:147], v[20:23]
  s_cmp_lt_i32 s28, 0
  s_cselect_b32 s63, s60, 0
  v_exp_f32 v49, v121
  v_mfma_f32_16x16x32_bf16 v[152:155], a[228:231], a[132:135], v[152:155]
  ds_read_b128 a[196:199], v4 offset:1024
  v_pk_maximum3_f16 v11, v11, v206, v207
  v_cvt_pk_bf16_f32 v220, v48, v49
  v_mfma_f32_16x16x32_bf16 v[184:187], a[228:231], a[148:151], v[184:187]
  s_add_u32 s63, s63, s28
  v_exp_f32 v50, v122
  v_mfma_f32_16x16x32_bf16 v[152:155], a[232:235], a[136:139], v[152:155]
  ds_read_b128 a[200:203], v4 offset:2048
  s_add_u32 s63, s63, 16384
  s_cmp_ge_i32 s28, s61
  s_cselect_b32 s10, s35, 0
  s_mov_b32 m0, s30
  v_mfma_f32_16x16x32_bf16 v[184:187], a[232:235], a[152:155], v[184:187]
  buffer_load_dwordx4 v5, s[8:11], s63 offen offset:0 lds
  v_mfma_f32_16x16x32_bf16 v[152:155], a[236:239], a[140:143], v[152:155]
  ds_read_b128 a[204:207], v4 offset:3072
  v_exp_f32 v51, v123
  v_mfma_f32_16x16x32_bf16 v[184:187], a[236:239], a[156:159], v[184:187]
  s_waitcnt lgkmcnt(4)
  v_exp_f32 v52, v124
  v_cvt_pk_bf16_f32 v221, v50, v51
  v_mfma_f32_16x16x32_bf16 v[156:159], a[240:243], a[128:131], v[16:19]
  ds_read_b128 a[208:211], v4 offset:4096
  v_pk_maximum3_f16 v11, v11, v220, v221
  v_mfma_f32_16x16x32_bf16 v[188:191], a[240:243], a[144:147], v[20:23]
  v_exp_f32 v53, v125
  v_mfma_f32_16x16x32_bf16 v[156:159], a[244:247], a[132:135], v[156:159]
  ds_read_b128 a[212:215], v4 offset:5120
  v_cvt_pk_bf16_f32 v222, v52, v53
  v_mfma_f32_16x16x32_bf16 v[188:191], a[244:247], a[148:151], v[188:191]
  buffer_load_dwordx4 v5, s[8:11], s63 offen offset:1024 lds
  v_mfma_f32_16x16x32_bf16 v[156:159], a[248:251], a[136:139], v[156:159]
  ds_read_b128 a[216:219], v4 offset:6144
  v_exp_f32 v54, v126
  v_mfma_f32_16x16x32_bf16 v[188:191], a[248:251], a[152:155], v[188:191]
  v_exp_f32 v55, v127
  v_mfma_f32_16x16x32_bf16 v[156:159], a[252:255], a[140:143], v[156:159]
  ds_read_b128 a[220:223], v4 offset:7168
  s_nop 0
  v_cvt_pk_bf16_f32 v223, v54, v55
  v_pk_maximum3_f16 v11, v11, v222, v223
  v_mfma_f32_16x16x32_bf16 v[188:191], a[252:255], a[156:159], v[188:191]
  s_waitcnt lgkmcnt(4)
  v_lshrrev_b32 v56, 16, v11
  v_and_b32 v57, 0xffff, v11
  v_max_u32 v56, v56, v57
  v_cmp_lt_u32 vcc, 0x4e80, v56
  s_nop 1
  s_cbranch_vccnz K2_rare_A
K2_ret_A:
  v_mfma_f32_16x16x32_bf16 a[0:3], a[192:195], v[192:195], a[0:3]
  ds_read_b128 a[224:227], v4 offset:8192
  v_mfma_f32_16x16x32_bf16 a[32:35], a[192:195], v[208:211], a[32:35]
  buffer_load_dwordx4 v5, s[8:11], s63 offen offset:2048 lds
  v_mfma_f32_16x16x32_bf16 v[32:35], v[60:63], v[192:195], v[32:35]
  ds_read_b128 a[228:231], v4 offset:9216
  v_exp_f32 v48, v128
  v_mfma_f32_16x16x32_bf16 a[4:7], a[196:199], v[192:195], a[4:7]
  v_exp_f32 v49, v129
  v_mfma_f32_16x16x32_bf16 a[36:39], a[196:199], v[208:211], a[36:39]
  buffer_load_dwordx4 v5, s[8:11], s63 offen offset:3072 lds
  v_cvt_pk_bf16_f32 v224, v48, v49
  v_mfma_f32_16x16x32_bf16 a[8:11], a[200:203], v[192:195], a[8:11]
  ds_read_b128 a[232:235], v4 offset:10240
  v_mfma_f32_16x16x32_bf16 a[40:43], a[200:203], v[208:211], a[40:43]
  s_add_u32 s30, s30, 16384
  v_exp_f32 v50, v130
  v_mfma_f32_16x16x32_bf16 v[36:39], v[60:63], v[208:211], v[36:39]
  ds_read_b128 a[236:239], v4 offset:11264
  s_and_b32 s30, s30, 0xffff
  s_cmp_lt_i32 s29, 0
  s_cselect_b32 s62, s60, 0
  s_add_u32 s62, s62, s29
  s_cmp_ge_i32 s29, s61
  s_cselect_b32 s10, s35, 0
  s_mov_b32 m0, s31
  v_mfma_f32_16x16x32_bf16 a[12:15], a[204:207], v[192:195], a[12:15]
  buffer_load_dwordx4 v5, s[8:11], s62 offen offset:0 lds
  v_exp_f32 v51, v131
  v_mfma_f32_16x16x32_bf16 a[44:47], a[204:207], v[208:211], a[44:47]
  s_waitcnt lgkmcnt(4)
  v_exp_f32 v52, v132
  v_mfma_f32_16x16x32_bf16 a[16:19], a[208:211], v[192:195], a[16:19]
  ds_read_b128 a[240:243], v4 offset:12288
  v_cvt_pk_bf16_f32 v225, v50, v51
  v_mfma_f32_16x16x32_bf16 a[48:51], a[208:211], v[208:211], a[48:51]
  v_exp_f32 v53, v133
  v_mfma_f32_16x16x32_bf16 a[20:23], a[212:215], v[192:195], a[20:23]
  ds_read_b128 a[244:247], v4 offset:13312
  v_pk_maximum3_f16 v11, v224, v224, v225
  v_mfma_f32_16x16x32_bf16 a[52:55], a[212:215], v[208:211], a[52:55]
  v_exp_f32 v54, v134
  v_mfma_f32_16x16x32_bf16 a[24:27], a[216:219], v[192:195], a[24:27]
  ds_read_b128 a[248:251], v4 offset:14336
  v_cvt_pk_bf16_f32 v226, v52, v53
  v_mfma_f32_16x16x32_bf16 a[56:59], a[216:219], v[208:211], a[56:59]
  buffer_load_dwordx4 v5, s[8:11], s62 offen offset:1024 lds
  v_mfma_f32_16x16x32_bf16 a[28:31], a[220:223], v[192:195], a[28:31]
  ds_read_b128 a[252:255], v4 offset:15360
  v_exp_f32 v55, v135
  v_mfma_f32_16x16x32_bf16 a[60:63], a[220:223], v[208:211], a[60:63]
  s_waitcnt lgkmcnt(4)
  v_exp_f32 v48, v160
  v_mfma_f32_16x16x32_bf16 a[0:3], a[224:227], v[196:199], a[0:3]
  ds_read_b128 a[192:195], v4 offset:16384
  v_cvt_pk_bf16_f32 v227, v54, v55
  v_mfma_f32_16x16x32_bf16 a[32:35], a[224:227], v[212:215], a[32:35]
  buffer_load_dwordx4 v5, s[8:11], s62 offen offset:2048 lds
  v_mfma_f32_16x16x32_bf16 v[32:35], v[60:63], v[196:199], v[32:35]
  ds_read_b128 a[196:199], v4 offset:17408
  v_pk_maximum3_f16 v11, v11, v226, v227
  v_mfma_f32_16x16x32_bf16 a[4:7], a[228:231], v[196:199], a[4:7]
  v_exp_f32 v49, v161
  v_mfma_f32_16x16x32_bf16 a[36:39], a[228:231], v[212:215], a[36:39]
  v_exp_f32 v50, v162
  v_mfma_f32_16x16x32_bf16 a[8:11], a[232:235], v[196:199], a[8:11]
  ds_read_b128 a[200:203], v4 offset:18432
  v_cvt_pk_bf16_f32 v240, v48, v49
  v_mfma_f32_16x16x32_bf16 a[40:43], a[232:235], v[212:215], a[40:43]
  buffer_load_dwordx4 v5, s[8:11], s62 offen offset:3072 lds
  v_mfma_f32_16x16x32_bf16 v[36:39], v[60:63], v[212:215], v[36:39]
  ds_read_b128 a[204:207], v4 offset:19456
  v_exp_f32 v51, v163
  v_mfma_f32_16x16x32_bf16 a[12:15], a[236:239], v[196:199], a[12:15]
  s_add_u32 s31, s31, 16384
  v_exp_f32 v52, v164
  v_mfma_f32_16x16x32_bf16 a[44:47], a[236:239], v[212:215], a[44:47]
  s_waitcnt lgkmcnt(4)
  v_exp_f32 v53, v165
  v_mfma_f32_16x16x32_bf16 a[16:19], a[240:243], v[196:199], a[16:19]
  ds_read_b128 a[208:211], v4 offset:20480
  s_cmp_eq_u32 s31, s32
  s_cselect_b32 s31, s47, s31
  s_add_u32 s28, s28, 0x8000
  s_sub_u32 s29, s28, 131072
  s_cmp_lt_i32 s28, 0
  s_cselect_b32 s63, s60, 0
  s_add_u32 s63, s63, s28
  s_add_u32 s63, s63, 16384
  s_cmp_ge_i32 s28, s61
  s_cselect_b32 s10, s35, 0
  s_mov_b32 m0, s30
  v_mfma_f32_16x16x32_bf16 a[48:51], a[240:243], v[212:215], a[48:51]
  buffer_load_dwordx4 v5, s[8:11], s63 offen offset:0 lds
  v_cvt_pk_bf16_f32 v241, v50, v51
  v_mfma_f32_16x16x32_bf16 a[20:23], a[244:247], v[196:199], a[20:23]
  ds_read_b128 a[212:215], v4 offset:21504
  v_pk_maximum3_f16 v11, v11, v240, v241
  v_mfma_f32_16x16x32_bf16 a[52:55], a[244:247], v[212:215], a[52:55]
  v_exp_f32 v54, v166
  v_mfma_f32_16x16x32_bf16 a[24:27], a[248:251], v[196:199], a[24:27]
  ds_read_b128 a[216:219], v4 offset:22528
  v_cvt_pk_bf16_f32 v242, v52, v53
  v_mfma_f32_16x16x32_bf16 a[56:59], a[248:251], v[212:215], a[56:59]
  buffer_load_dwordx4 v5, s[8:11], s63 offen offset:1024 lds
  v_mfma_f32_16x16x32_bf16 a[28:31], a[252:255], v[196:199], a[28:31]
  ds_read_b128 a[220:223], v4 offset:23552
  v_exp_f32 v55, v167
  v_mfma_f32_16x16x32_bf16 a[60:63], a[252:255], v[212:215], a[60:63]
  s_waitcnt lgkmcnt(4)
  v_exp_f32 v48, v136
  v_mfma_f32_16x16x32_bf16 a[0:3], a[192:195], v[200:203], a[0:3]
  ds_read_b128 a[224:227], v4 offset:24576
  v_cvt_pk_bf16_f32 v243, v54, v55
  v_mfma_f32_16x16x32_bf16 a[32:35], a[192:195], v[216:219], a[32:35]
  v_exp_f32 v49, v137
  v_mfma_f32_16x16x32_bf16 v[32:35], v[60:63], v[200:203], v[32:35]
  ds_read_b128 a[228:231], v4 offset:25600
  v_pk_maximum3_f16 v11, v11, v242, v243
  v_mfma_f32_16x16x32_bf16 a[4:7], a[196:199], v[200:203], a[4:7]
  buffer_load_dwordx4 v5, s[8:11], s63 offen offset:2048 lds
  v_mfma_f32_16x16x32_bf16 a[36:39], a[196:199], v[216:219], a[36:39]
  v_exp_f32 v50, v138
  v_mfma_f32_16x16x32_bf16 a[8:11], a[200:203], v[200:203], a[8:11]
  ds_read_b128 a[232:235], v4 offset:26624
  v_cvt_pk_bf16_f32 v228, v48, v49
  v_mfma_f32_16x16x32_bf16 a[40:43], a[200:203], v[216:219], a[40:43]
  v_exp_f32 v51, v139
  v_mfma_f32_16x16x32_bf16 v[36:39], v[60:63], v[216:219], v[36:39]
  ds_read_b128 a[236:239], v4 offset:27648
  v_cvt_pk_bf16_f32 v229, v50, v51
  v_mfma_f32_16x16x32_bf16 a[12:15], a[204:207], v[200:203], a[12:15]
  buffer_load_dwordx4 v5, s[8:11], s63 offen offset:3072 lds
  v_mfma_f32_16x16x32_bf16 a[44:47], a[204:207], v[216:219], a[44:47]
  s_waitcnt lgkmcnt(4)
  v_exp_f32 v52, v140
  v_mfma_f32_16x16x32_bf16 a[16:19], a[208:211], v[200:203], a[16:19]
  ds_read_b128 a[240:243], v4 offset:28672
  v_pk_maximum3_f16 v11, v11, v228, v229
  v_mfma_f32_16x16x32_bf16 a[48:51], a[208:211], v[216:219], a[48:51]
  s_add_u32 s30, s30, 16384
  v_exp_f32 v53, v141
  v_mfma_f32_16x16x32_bf16 a[20:23], a[212:215], v[200:203], a[20:23]
  ds_read_b128 a[244:247], v4 offset:29696
  s_and_b32 s30, s30, 0xffff
  s_cmp_lt_i32 s29, 0
  s_cselect_b32 s62, s60, 0
  s_add_u32 s62, s62, s29
  s_cmp_ge_i32 s29, s61
  s_cselect_b32 s10, s35, 0
  s_mov_b32 m0, s31
  v_mfma_f32_16x16x32_bf16 a[52:55], a[212:215], v[216:219], a[52:55]
  buffer_load_dwordx4 v5, s[8:11], s62 offen offset:0 lds
  v_cvt_pk_bf16_f32 v230, v52, v53
  v_mfma_f32_16x16x32_bf16 a[24:27], a[216:219], v[200:203], a[24:27]
  ds_read_b128 a[248:251], v4 offset:30720
  s_add_u32 s33, s33, 32768
  s_cmp_eq_u32 s33, 163840
  s_cselect_b32 s33, 65536, s33
  v_mfma_f32_16x16x32_bf16 a[56:59], a[216:219], v[216:219], a[56:59]
  v_exp_f32 v54, v142
  v_mfma_f32_16x16x32_bf16 a[28:31], a[220:223], v[200:203], a[28:31]
  ds_read_b128 a[252:255], v4 offset:31744
  v_exp_f32 v55, v143
  v_mfma_f32_16x16x32_bf16 a[60:63], a[220:223], v[216:219], a[60:63]
  v_cvt_pk_bf16_f32 v231, v54, v55
  v_add_u32 v3, s33, v2
  s_waitcnt lgkmcnt(4)
  v_mfma_f32_16x16x32_bf16 a[0:3], a[224:227], v[204:207], a[0:3]
  ds_read_b128 a[192:195], v3 offset:0
  v_pk_maximum3_f16 v11, v11, v230, v231
  v_mfma_f32_16x16x32_bf16 a[32:35], a[224:227], v[220:223], a[32:35]
  buffer_load_dwordx4 v5, s[8:11], s62 offen offset:1024 lds
  v_mfma_f32_16x16x32_bf16 v[32:35], v[60:63], v[204:207], v[32:35]
  ds_read_b128 a[196:199], v3 offset:1024
  v_exp_f32 v48, v168
  v_mfma_f32_16x16x32_bf16 a[4:7], a[228:231], v[204:207], a[4:7]
  v_exp_f32 v49, v169
  v_mfma_f32_16x16x32_bf16 a[36:39], a[228:231], v[220:223], a[36:39]
  v_exp_f32 v50, v170
  v_mfma_f32_16x16x32_bf16 a[8:11], a[232:235], v[204:207], a[8:11]
  ds_read_b128 a[200:203], v3 offset:2048
  v_cvt_pk_bf16_f32 v244, v48, v49
  v_mfma_f32_16x16x32_bf16 a[40:43], a[232:235], v[220:223], a[40:43]
  buffer_load_dwordx4 v5, s[8:11], s62 offen offset:2048 lds
  v_mfma_f32_16x16x32_bf16 v[36:39], v[60:63], v[220:223], v[36:39]
  ds_read_b128 a[204:207], v3 offset:3072
  v_exp_f32 v51, v171
  v_mfma_f32_16x16x32_bf16 a[12:15], a[236:239], v[204:207], a[12:15]
  v_exp_f32 v52, v172
  v_mfma_f32_16x16x32_bf16 a[44:47], a[236:239], v[220:223], a[44:47]
  s_waitcnt lgkmcnt(4)
  v_exp_f32 v53, v173
  v_mfma_f32_16x16x32_bf16 a[16:19], a[240:243], v[204:207], a[16:19]
  ds_read_b128 a[208:211], v3 offset:4096
  v_cvt_pk_bf16_f32 v245, v50, v51
  v_mfma_f32_16x16x32_bf16 a[48:51], a[240:243], v[220:223], a[48:51]
  buffer_load_dwordx4 v5, s[8:11], s62 offen offset:3072 lds
  v_mfma_f32_16x16x32_bf16 a[20:23], a[244:247], v[204:207], a[20:23]
  ds_read_b128 a[212:215], v3 offset:5120
  s_add_u32 s31, s31, 16384
  s_cmp_eq_u32 s31, s32
  s_cselect_b32 s31, s47, s31
  s_add_u32 s28, s28, 0xfffe8000
  s_sub_u32 s29, s28, 131072
  v_mfma_f32_16x16x32_bf16 a[52:55], a[244:247], v[220:223], a[52:55]
  v_pk_maximum3_f16 v11, v11, v244, v245
  v_exp_f32 v54, v174
  v_mfma_f32_16x16x32_bf16 a[24:27], a[248:251], v[204:207], a[24:27]
  ds_read_b128 a[216:219], v3 offset:6144
  v_cvt_pk_bf16_f32 v246, v52, v53
  v_mfma_f32_16x16x32_bf16 a[56:59], a[248:251], v[220:223], a[56:59]
  v_exp_f32 v55, v175
  v_mfma_f32_16x16x32_bf16 a[28:31], a[252:255], v[204:207], a[28:31]
  ds_read_b128 a[220:223], v3 offset:7168
  s_nop 0
  v_mfma_f32_16x16x32_bf16 a[60:63], a[252:255], v[220:223], a[60:63]
  v_cvt_pk_bf16_f32 v247, v54, v55
  v_pk_maximum3_f16 v11, v11, v246, v247
  s_waitcnt lgkmcnt(4)
  v_mfma_f32_16x16x32_bf16 v[64:67], a[192:195], a[128:131], v[16:19]
  ds_read_b128 a[224:227], v3 offset:8192
  v_mfma_f32_16x16x32_bf16 v[96:99], a[192:195], a[144:147], v[20:23]
  v_exp_f32 v48, v144
  v_mfma_f32_16x16x32_bf16 v[64:67], a[196:199], a[132:135], v[64:67]
  ds_read_b128 a[228:231], v3 offset:9216
  v_mfma_f32_16x16x32_bf16 v[96:99], a[196:199], a[148:151], v[96:99]
  v_exp_f32 v49, v145
  v_mfma_f32_16x16x32_bf16 v[64:67], a[200:203], a[136:139], v[64:67]
  ds_read_b128 a[232:235], v3 offset:10240
  v_exp_f32 v50, v146
  v_mfma_f32_16x16x32_bf16 v[96:99], a[200:203], a[152:155], v[96:99]
  v_exp_f32 v51, v147
  v_mfma_f32_16x16x32_bf16 v[64:67], a[204:207], a[140:143], v[64:67]
  ds_read_b128 a[236:239], v3 offset:11264
  v_cvt_pk_bf16_f32 v232, v48, v49
  v_mfma_f32_16x16x32_bf16 v[96:99], a[204:207], a[156:159], v[96:99]
  s_waitcnt lgkmcnt(4)
  v_exp_f32 v52, v148
  v_mfma_f32_16x16x32_bf16 v[68:71], a[208:211], a[128:131], v[16:19]
  ds_read_b128 a[240:243], v3 offset:12288
  v_cvt_pk_bf16_f32 v233, v50, v51
  v_mfma_f32_16x16x32_bf16 v[100:103], a[208:211], a[144:147], v[20:23]
  v_exp_f32 v53, v149
  v_mfma_f32_16x16x32_bf16 v[68:71], a[212:215], a[132:135], v[68:71]
  ds_read_b128 a[244:247], v3 offset:13312
  v_pk_maximum3_f16 v11, v11, v232, v233
  v_mfma_f32_16x16x32_bf16 v[100:103], a[212:215], a[148:151], v[100:103]
  v_exp_f32 v54, v150
  v_mfma_f32_16x16x32_bf16 v[68:71], a[216:219], a[136:139], v[68:71]
  ds_read_b128 a[248:251], v3 offset:14336
  v_cvt_pk_bf16_f32 v234, v52, v53
  v_mfma_f32_16x16x32_bf16 v[100:103], a[216:219], a[152:155], v[100:103]
  v_exp_f32 v55, v151
  v_mfma_f32_16x16x32_bf16 v[68:71], a[220:223], a[140:143], v[68:71]
  ds_read_b128 a[252:255], v3 offset:15360
  v_cvt_pk_bf16_f32 v235, v54, v55
  v_mfma_f32_16x16x32_bf16 v[100:103], a[220:223], a[156:159], v[100:103]
  s_waitcnt lgkmcnt(4)
  v_exp_f32 v48, v176
  v_mfma_f32_16x16x32_bf16 v[72:75], a[224:227], a[128:131], v[16:19]
  ds_read_b128 a[192:195], v3 offset:16384
  v_pk_maximum3_f16 v11, v11, v234, v235
  v_mfma_f32_16x16x32_bf16 v[104:107], a[224:227], a[144:147], v[20:23]
  v_exp_f32 v49, v177
  v_mfma_f32_16x16x32_bf16 v[72:75], a[228:231], a[132:135], v[72:75]
  ds_read_b128 a[196:199], v3 offset:17408
  v_cvt_pk_bf16_f32 v248, v48, v49
  v_mfma_f32_16x16x32_bf16 v[104:107], a[228:231], a[148:151], v[104:107]
  v_exp_f32 v50, v178
  v_mfma_f32_16x16x32_bf16 v[72:75], a[232:235], a[136:139], v[72:75]
  ds_read_b128 a[200:203], v3 offset:18432
  v_mfma_f32_16x16x32_bf16 v[104:107], a[232:235], a[152:155], v[104:107]
  v_exp_f32 v51, v179
  v_mfma_f32_16x16x32_bf16 v[72:75], a[236:239], a[140:143], v[72:75]
  ds_read_b128 a[204:207], v3 offset:19456
  v_cvt_pk_bf16_f32 v249, v50, v51
  v_mfma_f32_16x16x32_bf16 v[104:107], a[236:239], a[156:159], v[104:107]
  s_waitcnt lgkmcnt(4)
  v_exp_f32 v52, v180
  v_mfma_f32_16x16x32_bf16 v[76:79], a[240:243], a[128:131], v[16:19]
  ds_read_b128 a[208:211], v3 offset:20480
  v_pk_maximum3_f16 v11, v11, v248, v249
  v_mfma_f32_16x16x32_bf16 v[108:111], a[240:243], a[144:147], v[20:23]
  v_exp_f32 v53, v181
  v_mfma_f32_16x16x32_bf16 v[76:79], a[244:247], a[132:135], v[76:79]
  ds_read_b128 a[212:215], v3 offset:21504
  v_cvt_pk_bf16_f32 v250, v52, v53
  v_mfma_f32_16x16x32_bf16 v[108:111], a[244:247], a[148:151], v[108:111]
  v_exp_f32 v54, v182
  v_mfma_f32_16x16x32_bf16 v[76:79], a[248:251], a[136:139], v[76:79]
  ds_read_b128 a[216:219], v3 offset:22528
  v_mfma_f32_16x16x32_bf16 v[108:111], a[248:251], a[152:155], v[108:111]
  v_exp_f32 v55, v183
  v_mfma_f32_16x16x32_bf16 v[76:79], a[252:255], a[140:143], v[76:79]
  ds_read_b128 a[220:223], v3 offset:23552
  v_cvt_pk_bf16_f32 v251, v54, v55
  v_mfma_f32_16x16x32_bf16 v[108:111], a[252:255], a[156:159], v[108:111]
  s_waitcnt lgkmcnt(4)
  v_exp_f32 v48, v152
  v_mfma_f32_16x16x32_bf16 v[80:83], a[192:195], a[128:131], v[16:19]
  ds_read_b128 a[224:227], v3 offset:24576
  v_pk_maximum3_f16 v11, v11, v250, v251
  v_mfma_f32_16x16x32_bf16 v[112:115], a[192:195], a[144:147], v[20:23]
  v_exp_f32 v49, v153
  v_mfma_f32_16x16x32_bf16 v[80:83], a[196:199], a[132:135], v[80:83]
  ds_read_b128 a[228:231], v3 offset:25600
  v_cvt_pk_bf16_f32 v236, v48, v49
  v_mfma_f32_16x16x32_bf16 v[112:115], a[196:199], a[148:151], v[112:115]
  v_exp_f32 v50, v154
  v_mfma_f32_16x16x32_bf16 v[80:83], a[200:203], a[136:139], v[80:83]
  ds_read_b128 a[232:235], v3 offset:26624
  v_mfma_f32_16x16x32_bf16 v[112:115], a[200:203], a[152:155], v[112:115]
  v_exp_f32 v51, v155
  v_mfma_f32_16x16x32_bf16 v[80:83], a[204:207], a[140:143], v[80:83]
  ds_read_b128 a[236:239], v3 offset:27648
  v_cvt_pk_bf16_f32 v237, v50, v51
  v_mfma_f32_16x16x32_bf16 v[112:115], a[204:207], a[156:159], v[112:115]
  s_waitcnt lgkmcnt(4)
  v_exp_f32 v52, v156
  v_mfma_f32_16x16x32_bf16 v[84:87], a[208:211], a[128:131], v[16:19]
  ds_read_b128 a[240:243], v3 offset:28672
  v_pk_maximum3_f16 v11, v11, v236, v237
  v_mfma_f32_16x16x32_bf16 v[116:119], a[208:211], a[144:147], v[20:23]
  v_exp_f32 v53, v157
  v_mfma_f32_16x16x32_bf16 v[84:87], a[212:215], a[132:135], v[84:87]
  ds_read_b128 a[244:247], v3 offset:29696
  v_cvt_pk_bf16_f32 v238, v52, v53
  v_mfma_f32_16x16x32_bf16 v[116:119], a[212:215], a[148:151], v[116:119]
  v_exp_f32 v54, v158
  v_mfma_f32_16x16x32_bf16 v[84:87], a[216:219], a[136:139], v[84:87]
  ds_read_b128 a[248:251], v3 offset:30720
  v_mfma_f32_16x16x32_bf16 v[116:119], a[216:219], a[152:155], v[116:119]
  v_exp_f32 v55, v159
  v_mfma_f32_16x16x32_bf16 v[84:87], a[220:223], a[140:143], v[84:87]
  ds_read_b128 a[252:255], v3 offset:31744
  v_add_u32 v4, s34, v2
  v_cvt_pk_bf16_f32 v239, v54, v55
  v_mfma_f32_16x16x32_bf16 v[116:119], a[220:223], a[156:159], v[116:119]
  s_add_u32 s34, s34, 32768
  s_and_b32 s34, s34, 0xffff
  s_waitcnt vmcnt(0)
  s_barrier
  s_waitcnt lgkmcnt(4)
  v_mfma_f32_16x16x32_bf16 v[88:91], a[224:227], a[128:131], v[16:19]
  ds_read_b128 a[192:195], v4 offset:0
  v_exp_f32 v48, v184
  v_mfma_f32_16x16x32_bf16 v[120:123], a[224:227], a[144:147], v[20:23]
  s_cmp_lt_i32 s28, 0
  s_cselect_b32 s63, s60, 0
  v_exp_f32 v49, v185
  v_mfma_f32_16x16x32_bf16 v[88:91], a[228:231], a[132:135], v[88:91]
  ds_read_b128 a[196:199], v4 offset:1024
  v_pk_maximum3_f16 v11, v11, v238, v239
  v_cvt_pk_bf16_f32 v252, v48, v49
  v_mfma_f32_16x16x32_bf16 v[120:123], a[228:231], a[148:151], v[120:123]
  s_add_u32 s63, s63, s28
  v_exp_f32 v50, v186
  v_mfma_f32_16x16x32_bf16 v[88:91], a[232:235], a[136:139], v[88:91]
  ds_read_b128 a[200:203], v4 offset:2048
  s_add_u32 s63, s63, 16384
  s_cmp_ge_i32 s28, s61
  s_cselect_b32 s10, s35, 0
  s_mov_b32 m0, s30
  v_mfma_f32_16x16x32_bf16 v[120:123], a[232:235], a[152:155], v[120:123]
  buffer_load_dwordx4 v5, s[8:11], s63 offen offset:0 lds
  v_mfma_f32_16x16x32_bf16 v[88:91], a[236:239], a[140:143], v[88:91]
  ds_read_b128 a[204:207], v4 offset:3072
  v_exp_f32 v51, v187
  v_mfma_f32_16x16x32_bf16 v[120:123], a[236:239], a[156:159], v[120:123]
  s_waitcnt lgkmcnt(4)
  v_exp_f32 v52, v188
  v_cvt_pk_bf16_f32 v253, v50, v51
  v_mfma_f32_16x16x32_bf16 v[92:95], a[240:243], a[128:131], v[16:19]
  ds_read_b128 a[208:211], v4 offset:4096
  v_pk_maximum3_f16 v11, v11, v252, v253
  v_mfma_f32_16x16x32_bf16 v[124:127], a[240:243], a[144:147], v[20:23]
  v_exp_f32 v53, v189
  v_mfma_f32_16x16x32_bf16 v[92:95], a[244:247], a[132:135], v[92:95]
  ds_read_b128 a[212:215], v4 offset:5120
  v_cvt_pk_bf16_f32 v254, v52, v53
  v_mfma_f32_16x16x32_bf16 v[124:127], a[244:247], a[148:151], v[124:127]
  buffer_load_dwordx4 v5, s[8:11], s63 offen offset:1024 lds
  v_mfma_f32_16x16x32_bf16 v[92:95], a[248:251], a[136:139], v[92:95]
  ds_read_b128 a[216:219], v4 offset:6144
  v_exp_f32 v54, v190
  v_mfma_f32_16x16x32_bf16 v[124:127], a[248:251], a[152:155], v[124:127]
  v_exp_f32 v55, v191
  v_mfma_f32_16x16x32_bf16 v[92:95], a[252:255], a[140:143], v[92:95]
  ds_read_b128 a[220:223], v4 offset:7168
  s_nop 0
  v_cvt_pk_bf16_f32 v255, v54, v55
  v_pk_maximum3_f16 v11, v11, v254, v255
  v_mfma_f32_16x16x32_bf16 v[124:127], a[252:255], a[156:159], v[124:127]
  s_waitcnt lgkmcnt(4)
  v_lshrrev_b32 v56, 16, v11
  v_and_b32 v57, 0xffff, v11
  v_max_u32 v56, v56, v57
  v_cmp_lt_u32 vcc, 0x4e80, v56
  s_nop 1
  s_cbranch_vccnz K2_rare_B
K2_ret_B:
  v_mfma_f32_16x16x32_bf16 a[0:3], a[192:195], v[224:227], a[0:3]
  ds_read_b128 a[224:227], v4 offset:8192
  v_mfma_f32_16x16x32_bf16 a[32:35], a[192:195], v[240:243], a[32:35]
  buffer_load_dwordx4 v5, s[8:11], s63 offen offset:2048 lds
  v_mfma_f32_16x16x32_bf16 v[32:35], v[60:63], v[224:227], v[32:35]
  ds_read_b128 a[228:231], v4 offset:9216
  v_exp_f32 v48, v64
  v_mfma_f32_16x16x32_bf16 a[4:7], a[196:199], v[224:227], a[4:7]
  v_exp_f32 v49, v65
  v_mfma_f32_16x16x32_bf16 a[36:39], a[196:199], v[240:243], a[36:39]
  buffer_load_dwordx4 v5, s[8:11], s63 offen offset:3072 lds
  v_cvt_pk_bf16_f32 v192, v48, v49
  v_mfma_f32_16x16x32_bf16 a[8:11], a[200:203], v[224:227], a[8:11]
  ds_read_b128 a[232:235], v4 offset:10240
  v_mfma_f32_16x16x32_bf16 a[40:43], a[200:203], v[240:243], a[40:43]
  s_add_u32 s30, s30, 16384
  v_exp_f32 v50, v66
  v_mfma_f32_16x16x32_bf16 v[36:39], v[60:63], v[240:243], v[36:39]
  ds_read_b128 a[236:239], v4 offset:11264
  s_and_b32 s30, s30, 0xffff
  s_cmp_lt_i32 s29, 0
  s_cselect_b32 s62, s60, 0
  s_add_u32 s62, s62, s29
  s_cmp_ge_i32 s29, s61
  s_cselect_b32 s10, s35, 0
  s_mov_b32 m0, s31
  v_mfma_f32_16x16x32_bf16 a[12:15], a[204:207], v[224:227], a[12:15]
  buffer_load_dwordx4 v5, s[8:11], s62 offen offset:0 lds
  v_exp_f32 v51, v67
  v_mfma_f32_16x16x32_bf16 a[44:47], a[204:207], v[240:243], a[44:47]
  s_waitcnt lgkmcnt(4)
  v_exp_f32 v52, v68
  v_mfma_f32_16x16x32_bf16 a[16:19], a[208:211], v[224:227], a[16:19]
  ds_read_b128 a[240:243], v4 offset:12288
  v_cvt_pk_bf16_f32 v193, v50, v51
  v_mfma_f32_16x16x32_bf16 a[48:51], a[208:211], v[240:243], a[48:51]
  v_exp_f32 v53, v69
  v_mfma_f32_16x16x32_bf16 a[20:23], a[212:215], v[224:227], a[20:23]
  ds_read_b128 a[244:247], v4 offset:13312
  v_pk_maximum3_f16 v11, v192, v192, v193
  v_mfma_f32_16x16x32_bf16 a[52:55], a[212:215], v[240:243], a[52:55]
  v_exp_f32 v54, v70
  v_mfma_f32_16x16x32_bf16 a[24:27], a[216:219], v[224:227], a[24:27]
  ds_read_b128 a[248:251], v4 offset:14336
  v_cvt_pk_bf16_f32 v194, v52, v53
  v_mfma_f32_16x16x32_bf16 a[56:59], a[216:219], v[240:243], a[56:59]
  buffer_load_dwordx4 v5, s[8:11], s62 offen offset:1024 lds
  v_mfma_f32_16x16x32_bf16 a[28:31], a[220:223], v[224:227], a[28:31]
  ds_read_b128 a[252:255], v4 offset:15360
  v_exp_f32 v55, v71
  v_mfma_f32_16x16x32_bf16 a[60:63], a[220:223], v[240:243], a[60:63]
  s_waitcnt lgkmcnt(4)
  v_exp_f32 v48, v96
  v_mfma_f32_16x16x32_bf16 a[0:3], a[224:227], v[228:231], a[0:3]
  ds_read_b128 a[192:195], v4 offset:16384
  v_cvt_pk_bf16_f32 v195, v54, v55
  v_mfma_f32_16x16x32_bf16 a[32:35], a[224:227], v[244:247], a[32:35]
  buffer_load_dwordx4 v5, s[8:11], s62 offen offset:2048 lds
  v_mfma_f32_16x16x32_bf16 v[32:35], v[60:63], v[228:231], v[32:35]
  ds_read_b128 a[196:199], v4 offset:17408
  v_pk_maximum3_f16 v11, v11, v194, v195
  v_mfma_f32_16x16x32_bf16 a[4:7], a[228:231], v[228:231], a[4:7]
  v_exp_f32 v49, v97
  v_mfma_f32_16x16x32_bf16 a[36:39], a[228:231], v[244:247], a[36:39]
  v_exp_f32 v50, v98
  v_mfma_f32_16x16x32_bf16 a[8:11], a[232:235], v[228:231], a[8:11]
  ds_read_b128 a[200:203], v4 offset:18432
  v_cvt_pk_bf16_f32 v208, v48, v49
  v_mfma_f32_16x16x32_bf16 a[40:43], a[232:235], v[244:247], a[40:43]
  buffer_load_dwordx4 v5, s[8:11], s62 offen offset:3072 lds
  v_mfma_f32_16x16x32_bf16 v[36:39], v[60:63], v[244:247], v[36:39]
  ds_read_b128 a[204:207], v4 offset:19456
  v_exp_f32 v51, v99
  v_mfma_f32_16x16x32_bf16 a[12:15], a[236:239], v[228:231], a[12:15]
  s_add_u32 s31, s31, 16384
  v_exp_f32 v52, v100
  v_mfma_f32_16x16x32_bf16 a[44:47], a[236:239], v[244:247], a[44:47]
  s_waitcnt lgkmcnt(4)
  v_exp_f32 v53, v101
  v_mfma_f32_16x16x32_bf16 a[16:19], a[240:243], v[228:231], a[16:19]
  ds_read_b128 a[208:211], v4 offset:20480
  s_cmp_eq_u32 s31, s32
  s_cselect_b32 s31, s47, s31
  s_add_u32 s28, s28, 0x8000
  s_sub_u32 s29, s28, 131072
  s_cmp_lt_i32 s28, 0
  s_cselect_b32 s63, s60, 0
  s_add_u32 s63, s63, s28
  s_add_u32 s63, s63, 16384
  s_cmp_ge_i32 s28, s61
  s_cselect_b32 s10, s35, 0
  s_mov_b32 m0, s30
  v_mfma_f32_16x16x32_bf16 a[48:51], a[240:243], v[244:247], a[48:51]
  buffer_load_dwordx4 v5, s[8:11], s63 offen offset:0 lds
  v_cvt_pk_bf16_f32 v209, v50, v51
  v_mfma_f32_16x16x32_bf16 a[20:23], a[244:247], v[228:231], a[20:23]
  ds_read_b128 a[212:215], v4 offset:21504
  v_pk_maximum3_f16 v11, v11, v208, v209
  v_mfma_f32_16x16x32_bf16 a[52:55], a[244:247], v[244:247], a[52:55]
  v_exp_f32 v54, v102
  v_mfma_f32_16x16x32_bf16 a[24:27], a[248:251], v[228:231], a[24:27]
  ds_read_b128 a[216:219], v4 offset:22528
  v_cvt_pk_bf16_f32 v210, v52, v53
  v_mfma_f32_16x16x32_bf16 a[56:59], a[248:251], v[244:247], a[56:59]
  buffer_load_dwordx4 v5, s[8:11], s63 offen offset:1024 lds
  v_mfma_f32_16x16x32_bf16 a[28:31], a[252:255], v[228:231], a[28:31]
  ds_read_b128 a[220:223], v4 offset:23552
  v_exp_f32 v55, v103
  v_mfma_f32_16x16x32_bf16 a[60:63], a[252:255], v[244:247], a[60:63]
  s_waitcnt lgkmcnt(4)
  v_exp_f32 v48, v72
  v_mfma_f32_16x16x32_bf16 a[0:3], a[192:195], v[232:235], a[0:3]
  ds_read_b128 a[224:227], v4 offset:24576
  v_cvt_pk_bf16_f32 v211, v54, v55
  v_mfma_f32_16x16x32_bf16 a[32:35], a[192:195], v[248:251], a[32:35]
  v_exp_f32 v49, v73
  v_mfma_f32_16x16x32_bf16 v[32:35], v[60:63], v[232:235], v[32:35]
  ds_read_b128 a[228:231], v4 offset:25600
  v_pk_maximum3_f16 v11, v11, v210, v211
  v_mfma_f32_16x16x32_bf16 a[4:7], a[196:199], v[232:235], a[4:7]
  buffer_load_dwordx4 v5, s[8:11], s63 offen offset:2048 lds
  v_mfma_f32_16x16x32_bf16 a[36:39], a[196:199], v[248:251], a[36:39]
  v_exp_f32 v50, v74
  v_mfma_f32_16x16x32_bf16 a[8:11], a[200:203], v[232:235], a[8:11]
  ds_read_b128 a[232:235], v4 offset:26624
  v_cvt_pk_bf16_f32 v196, v48, v49
  v_mfma_f32_16x16x32_bf16 a[40:43], a[200:203], v[248:251], a[40:43]
  v_exp_f32 v51, v75
  v_mfma_f32_16x16x32_bf16 v[36:39], v[60:63], v[248:251], v[36:39]
  ds_read_b128 a[236:239], v4 offset:27648
  v_cvt_pk_bf16_f32 v197, v50, v51
  v_mfma_f32_16x16x32_bf16 a[12:15], a[204:207], v[232:235], a[12:15]
  buffer_load_dwordx4 v5, s[8:11], s63 offen offset:3072 lds
  v_mfma_f32_16x16x32_bf16 a[44:47], a[204:207], v[248:251], a[44:47]
  s_waitcnt lgkmcnt(4)
  v_exp_f32 v52, v76
  v_mfma_f32_16x16x32_bf16 a[16:19], a[208:211], v[232:235], a[16:19]
  ds_read_b128 a[240:243], v4 offset:28672
  v_pk_maximum3_f16 v11, v11, v196, v197
  v_mfma_f32_16x16x32_bf16 a[48:51], a[208:211], v[248:251], a[48:51]
  s_add_u32 s30, s30, 16384
  v_exp_f32 v53, v77
  v_mfma_f32_16x16x32_bf16 a[20:23], a[212:215], v[232:235], a[20:23]
  ds_read_b128 a[244:247], v4 offset:29696
  s_and_b32 s30, s30, 0xffff
  s_cmp_lt_i32 s29, 0
  s_cselect_b32 s62, s60, 0
  s_add_u32 s62, s62, s29
  s_cmp_ge_i32 s29, s61
  s_cselect_b32 s10, s35, 0
  s_mov_b32 m0, s31
  v_mfma_f32_16x16x32_bf16 a[52:55], a[212:215], v[248:251], a[52:55]
  buffer_load_dwordx4 v5, s[8:11], s62 offen offset:0 lds
  v_cvt_pk_bf16_f32 v198, v52, v53
  v_mfma_f32_16x16x32_bf16 a[24:27], a[216:219], v[232:235], a[24:27]
  ds_read_b128 a[248:251], v4 offset:30720
  s_add_u32 s33, s33, 32768
  s_cmp_eq_u32 s33, 163840
  s_cselect_b32 s33, 65536, s33
  v_mfma_f32_16x16x32_bf16 a[56:59], a[216:219], v[248:251], a[56:59]
  v_exp_f32 v54, v78
  v_mfma_f32_16x16x32_bf16 a[28:31], a[220:223], v[232:235], a[28:31]
  ds_read_b128 a[252:255], v4 offset:31744
  v_exp_f32 v55, v79
  v_mfma_f32_16x16x32_bf16 a[60:63], a[220:223], v[248:251], a[60:63]
  v_cvt_pk_bf16_f32 v199, v54, v55
  v_add_u32 v3, s33, v2
  s_waitcnt lgkmcnt(4)
  v_mfma_f32_16x16x32_bf16 a[0:3], a[224:227], v[236:239], a[0:3]
  ds_read_b128 a[192:195], v3 offset:0
  v_pk_maximum3_f16 v11, v11, v198, v199
  v_mfma_f32_16x16x32_bf16 a[32:35], a[224:227], v[252:255], a[32:35]
  buffer_load_dwordx4 v5, s[8:11], s62 offen offset:1024 lds
  v_mfma_f32_16x16x32_bf16 v[32:35], v[60:63], v[236:239], v[32:35]
  ds_read_b128 a[196:199], v3 offset:1024
  v_exp_f32 v48, v104
  v_mfma_f32_16x16x32_bf16 a[4:7], a[228:231], v[236:239], a[4:7]
  v_exp_f32 v49, v105
  v_mfma_f32_16x16x32_bf16 a[36:39], a[228:231], v[252:255], a[36:39]
  v_exp_f32 v50, v106
  v_mfma_f32_16x16x32_bf16 a[8:11], a[232:235], v[236:239], a[8:11]
  ds_read_b128 a[200:203], v3 offset:2048
  v_cvt_pk_bf16_f32 v212, v48, v49
  v_mfma_f32_16x16x32_bf16 a[40:43], a[232:235], v[252:255], a[40:43]
  buffer_load_dwordx4 v5, s[8:11], s62 offen offset:2048 lds
  v_mfma_f32_16x16x32_bf16 v[36:39], v[60:63], v[252:255], v[36:39]
  ds_read_b128 a[204:207], v3 offset:3072
  v_exp_f32 v51, v107
  v_mfma_f32_16x16x32_bf16 a[12:15], a[236:239], v[236:239], a[12:15]
  v_exp_f32 v52, v108
  v_mfma_f32_16x16x32_bf16 a[44:47], a[236:239], v[252:255], a[44:47]
  s_waitcnt lgkmcnt(4)
  v_exp_f32 v53, v109
  v_mfma_f32_16x16x32_bf16 a[16:19], a[240:243], v[236:239], a[16:19]
  ds_read_b128 a[208:211], v3 offset:4096
  v_cvt_pk_bf16_f32 v213, v50, v51
  v_mfma_f32_16x16x32_bf16 a[48:51], a[240:243], v[252:255], a[48:51]
  buffer_load_dwordx4 v5, s[8:11], s62 offen offset:3072 lds
  v_mfma_f32_16x16x32_bf16 a[20:23], a[244:247], v[236:239], a[20:23]
  ds_read_b128 a[212:215], v3 offset:5120
  s_add_u32 s31, s31, 16384
  s_cmp_eq_u32 s31, s32
  s_cselect_b32 s31, s47, s31
  s_add_u32 s28, s28, 0xfffe8000
  s_sub_u32 s29, s28, 131072
  v_mfma_f32_16x16x32_bf16 a[52:55], a[244:247], v[252:255], a[52:55]
  v_pk_maximum3_f16 v11, v11, v212, v213
  v_exp_f32 v54, v110
  v_mfma_f32_16x16x32_bf16 a[24:27], a[248:251], v[236:239], a[24:27]
  ds_read_b128 a[216:219], v3 offset:6144
  v_cvt_pk_bf16_f32 v214, v52, v53
  v_mfma_f32_16x16x32_bf16 a[56:59], a[248:251], v[252:255], a[56:59]
  v_exp_f32 v55, v111
  v_mfma_f32_16x16x32_bf16 a[28:31], a[252:255], v[236:239], a[28:31]
  ds_read_b128 a[220:223], v3 offset:7168
  s_nop 0
  v_mfma_f32_16x16x32_bf16 a[60:63], a[252:255], v[252:255], a[60:63]
  v_cvt_pk_bf16_f32 v215, v54, v55
  v_pk_maximum3_f16 v11, v11, v214, v215
  s_sub_u32 s37, s37, 1
  s_cmp_lg_u32 s37, 0
  s_cbranch_scc1 K2_loop1
K2_fin:
  s_mov_b32 s50, s66
  s_mov_b32 s51, s67
  s_mov_b32 s52, s68
  s_mov_b32 s53, s69
  s_mov_b32 s54, s70
  s_mov_b32 s55, s71
  s_mov_b32 s56, s72
  s_mov_b32 s57, s73
  s_waitcnt vmcnt(0) lgkmcnt(0)
  s_barrier
  s_getpc_b64 s[58:59]
K2_pcT_S:
  s_add_u32 s58, s58, K2_Lepi-K2_pcT_S
  s_addc_u32 s59, s59, 0
  s_lshl_b32 s38, s5, 6
  v_add_u32 v59, s38, v1
  v_lshlrev_b32 v59, 7, v59
  v_min_u32 v59, K2_rare_C-K2_Lepi-4, v59
  global_load_dword v15, v59, s[58:59]
  s_lshl_b32 s38, s5, 3
  s_add_u32 s38, s38, 65536
  v_mov_b32 v56, s38
  v_mov_b32 v58, v13
  v_mov_b32 v59, v14
  ds_write_b64 v56, v[58:59]
  v_add_u32 v4, s34, v2
  s_waitcnt lgkmcnt(0)
  s_barrier
  v_mov_b32 v56, 65536
  ds_read_b128 v[52:55], v56
  ds_read_b128 a[192:195], v4 offset:0
  ds_read_b128 a[196:199], v4 offset:1024
  ds_read_b128 a[200:203], v4 offset:2048
  ds_read_b128 a[204:207], v4 offset:3072
  ds_read_b128 a[208:211], v4 offset:4096
  ds_read_b128 a[212:215], v4 offset:5120
  ds_read_b128 a[216:219], v4 offset:6144
  ds_read_b128 a[220:223], v4 offset:7168
  s_waitcnt lgkmcnt(8)
  v_cmp_gt_f32 vcc, v54, v52
  s_nop 1
  v_cndmask_b32 v13, v52, v54, vcc
  v_cndmask_b32 v14, v53, v55, vcc
  v_exp_f32 v48, v80
  v_exp_f32 v49, v81
  v_exp_f32 v50, v82
  v_exp_f32 v51, v83
  v_cvt_pk_bf16_f32 v200, v48, v49
  v_exp_f32 v52, v84
  v_exp_f32 v53, v85
  v_cvt_pk_bf16_f32 v201, v50, v51
  v_pk_maximum3_f16 v11, v11, v200, v201
  v_exp_f32 v54, v86
  v_exp_f32 v55, v87
  v_cvt_pk_bf16_f32 v202, v52, v53
  v_exp_f32 v48, v112
  v_exp_f32 v49, v113
  v_cvt_pk_bf16_f32 v203, v54, v55
  v_pk_maximum3_f16 v11, v11, v202, v203
  v_exp_f32 v50, v114
  v_exp_f32 v51, v115
  v_cvt_pk_bf16_f32 v216, v48, v49
  v_exp_f32 v52, v116
  v_exp_f32 v53, v117
  v_cvt_pk_bf16_f32 v217, v50, v51
  v_pk_maximum3_f16 v11, v11, v216, v217
  v_exp_f32 v54, v118
  v_exp_f32 v55, v119
  v_cvt_pk_bf16_f32 v218, v52, v53
  v_exp_f32 v48, v88
  v_exp_f32 v49, v89
  v_cvt_pk_bf16_f32 v219, v54, v55
  v_pk_maximum3_f16 v11, v11, v218, v219
  v_exp_f32 v50, v90
  v_exp_f32 v51, v91
  v_cvt_pk_bf16_f32 v204, v48, v49
  v_exp_f32 v52, v92
  v_exp_f32 v53, v93
  v_cvt_pk_bf16_f32 v205, v50, v51
  v_pk_maximum3_f16 v11, v11, v204, v205
  v_exp_f32 v54, v94
  v_exp_f32 v55, v95
  v_cvt_pk_bf16_f32 v206, v52, v53
  v_exp_f32 v48, v120
  v_exp_f32 v49, v121
  v_cvt_pk_bf16_f32 v207, v54, v55
  v_pk_maximum3_f16 v11, v11, v206, v207
  v_exp_f32 v50, v122
  v_exp_f32 v51, v123
  v_cvt_pk_bf16_f32 v220, v48, v49
  v_exp_f32 v52, v124
  v_exp_f32 v53, v125
  v_cvt_pk_bf16_f32 v221, v50, v51
  v_pk_maximum3_f16 v11, v11, v220, v221
  v_exp_f32 v54, v126
  v_exp_f32 v55, v127
  v_cvt_pk_bf16_f32 v222, v52, v53
  s_nop 0
  v_cvt_pk_bf16_f32 v223, v54, v55
  v_pk_maximum3_f16 v11, v11, v222, v223
  v_lshrrev_b32 v56, 16, v11
  v_and_b32 v57, 0xffff, v11
  v_max_u32 v56, v56, v57
  v_cmp_lt_u32 vcc, 0x4e80, v56
  s_nop 1
  s_cbranch_vccnz K2_rare_G2
  K2_ret_G2:
  s_waitcnt lgkmcnt(4)
  v_mfma_f32_16x16x32_bf16 a[0:3], a[192:195], v[192:195], a[0:3]
  ds_read_b128 a[224:227], v4 offset:8192
  s_mov_b32 s24, s50
  s_mov_b32 s25, s51
  s_mov_b32 s26, 0x200000
  s_mov_b32 s27, 0x20000
  v_lshlrev_b32 v57, 10, v14
  v_lshl_add_u32 v57, v0, 1, v57
  buffer_load_ushort v128, v57, s[24:27], 0 offen
  buffer_load_ushort v129, v57, s[24:27], 0 offen offset:512
  v_mfma_f32_16x16x32_bf16 a[32:35], a[192:195], v[208:211], a[32:35]
  v_mfma_f32_16x16x32_bf16 v[32:35], v[60:63], v[192:195], v[32:35]
  ds_read_b128 a[228:231], v4 offset:9216
  s_mov_b32 s24, s52
  s_mov_b32 s25, s53
  s_mov_b32 s26, 0x1c0000
  s_and_b32 s38, s2, 7
  s_mul_i32 s38, s38, 28
  s_lshr_b32 s39, s2, 3
  s_max_u32 s39, s39, 4
  s_sub_u32 s39, s39, 4
  s_add_u32 s58, s38, s39
  s_lshl_b32 s38, s58, 4
  s_add_u32 s39, s38, 917504
  v_mul_u32_u24 v56, 3584, v0
  buffer_load_dwordx4 v[132:135], v56, s[24:27], s38 offen
  v_mfma_f32_16x16x32_bf16 a[4:7], a[196:199], v[192:195], a[4:7]
  v_mfma_f32_16x16x32_bf16 a[36:39], a[196:199], v[208:211], a[36:39]
  buffer_load_dwordx4 v[136:139], v56, s[24:27], s39 offen
  v_mfma_f32_16x16x32_bf16 a[8:11], a[200:203], v[192:195], a[8:11]
  ds_read_b128 a[232:235], v4 offset:10240
  v_mfma_f32_16x16x32_bf16 a[40:43], a[200:203], v[208:211], a[40:43]
  s_mov_b32 s24, s54
  s_mov_b32 s25, s55
  buffer_load_dwordx4 v[140:143], v56, s[24:27], s38 offen
  v_mfma_f32_16x16x32_bf16 v[36:39], v[60:63], v[208:211], v[36:39]
  ds_read_b128 a[236:239], v4 offset:11264
  v_mfma_f32_16x16x32_bf16 a[12:15], a[204:207], v[192:195], a[12:15]
  buffer_load_dwordx4 v[144:147], v56, s[24:27], s39 offen
  v_mfma_f32_16x16x32_bf16 a[44:47], a[204:207], v[208:211], a[44:47]
  s_waitcnt lgkmcnt(4)
  v_mfma_f32_16x16x32_bf16 a[16:19], a[208:211], v[192:195], a[16:19]
  ds_read_b128 a[240:243], v4 offset:12288
  s_mov_b32 s24, s56
  s_mov_b32 s25, s57
  s_mov_b32 s26, 0x1c0000
  s_lshl_b32 s38, s58, 13
  v_lshlrev_b32 v58, 2, v0
  buffer_load_dword v148, v58, s[24:27], s38 offen offset:0
  v_mfma_f32_16x16x32_bf16 a[48:51], a[208:211], v[208:211], a[48:51]
  v_mfma_f32_16x16x32_bf16 a[20:23], a[212:215], v[192:195], a[20:23]
  ds_read_b128 a[244:247], v4 offset:13312
  buffer_load_dword v149, v58, s[24:27], s38 offen offset:1024
  v_mfma_f32_16x16x32_bf16 a[52:55], a[212:215], v[208:211], a[52:55]
  v_mfma_f32_16x16x32_bf16 a[24:27], a[216:219], v[192:195], a[24:27]
  ds_read_b128 a[248:251], v4 offset:14336
  buffer_load_dword v150, v58, s[24:27], s38 offen offset:2048
  v_mfma_f32_16x16x32_bf16 a[56:59], a[216:219], v[208:211], a[56:59]
  v_mfma_f32_16x16x32_bf16 a[28:31], a[220:223], v[192:195], a[28:31]
  ds_read_b128 a[252:255], v4 offset:15360
  buffer_load_dword v151, v58, s[24:27], s38 offen offset:3072
  v_mfma_f32_16x16x32_bf16 a[60:63], a[220:223], v[208:211], a[60:63]
  s_waitcnt lgkmcnt(4)
  v_mfma_f32_16x16x32_bf16 a[0:3], a[224:227], v[196:199], a[0:3]
  ds_read_b128 a[192:195], v4 offset:16384
  s_add_u32 s38, s38, 4096
  buffer_load_dword v152, v58, s[24:27], s38 offen offset:0
  v_mfma_f32_16x16x32_bf16 a[32:35], a[224:227], v[212:215], a[32:35]
  v_mfma_f32_16x16x32_bf16 v[32:35], v[60:63], v[196:199], v[32:35]
  ds_read_b128 a[196:199], v4 offset:17408
  buffer_load_dword v153, v58, s[24:27], s38 offen offset:1024
  v_mfma_f32_16x16x32_bf16 a[4:7], a[228:231], v[196:199], a[4:7]
  v_mfma_f32_16x16x32_bf16 a[36:39], a[228:231], v[212:215], a[36:39]
  buffer_load_dword v154, v58, s[24:27], s38 offen offset:2048
  v_mfma_f32_16x16x32_bf16 a[8:11], a[232:235], v[196:199], a[8:11]
  ds_read_b128 a[200:203], v4 offset:18432
  v_mfma_f32_16x16x32_bf16 a[40:43], a[232:235], v[212:215], a[40:43]
  buffer_load_dword v155, v58, s[24:27], s38 offen offset:3072
  v_mfma_f32_16x16x32_bf16 v[36:39], v[60:63], v[212:215], v[36:39]
  ds_read_b128 a[204:207], v4 offset:19456
  v_mfma_f32_16x16x32_bf16 a[12:15], a[236:239], v[196:199], a[12:15]
  v_mfma_f32_16x16x32_bf16 a[44:47], a[236:239], v[212:215], a[44:47]
  s_waitcnt lgkmcnt(4)
  v_mfma_f32_16x16x32_bf16 a[16:19], a[240:243], v[196:199], a[16:19]
  ds_read_b128 a[208:211], v4 offset:20480
  v_mfma_f32_16x16x32_bf16 a[48:51], a[240:243], v[212:215], a[48:51]
  v_mfma_f32_16x16x32_bf16 a[20:23], a[244:247], v[196:199], a[20:23]
  ds_read_b128 a[212:215], v4 offset:21504
  v_mfma_f32_16x16x32_bf16 a[52:55], a[244:247], v[212:215], a[52:55]
  v_mfma_f32_16x16x32_bf16 a[24:27], a[248:251], v[196:199], a[24:27]
  ds_read_b128 a[216:219], v4 offset:22528
  v_mfma_f32_16x16x32_bf16 a[56:59], a[248:251], v[212:215], a[56:59]
  v_mfma_f32_16x16x32_bf16 a[28:31], a[252:255], v[196:199], a[28:31]
  ds_read_b128 a[220:223], v4 offset:23552
  v_mfma_f32_16x16x32_bf16 a[60:63], a[252:255], v[212:215], a[60:63]
  s_waitcnt lgkmcnt(4)
  v_mfma_f32_16x16x32_bf16 a[0:3], a[192:195], v[200:203], a[0:3]
  ds_read_b128 a[224:227], v4 offset:24576
  v_mfma_f32_16x16x32_bf16 a[32:35], a[192:195], v[216:219], a[32:35]
  v_mfma_f32_16x16x32_bf16 v[32:35], v[60:63], v[200:203], v[32:35]
  ds_read_b128 a[228:231], v4 offset:25600
  v_mfma_f32_16x16x32_bf16 a[4:7], a[196:199], v[200:203], a[4:7]
  v_mfma_f32_16x16x32_bf16 a[36:39], a[196:199], v[216:219], a[36:39]
  v_mfma_f32_16x16x32_bf16 a[8:11], a[200:203], v[200:203], a[8:11]
  ds_read_b128 a[232:235], v4 offset:26624
  v_mfma_f32_16x16x32_bf16 a[40:43], a[200:203], v[216:219], a[40:43]
  v_mfma_f32_16x16x32_bf16 v[36:39], v[60:63], v[216:219], v[36:39]
  ds_read_b128 a[236:239], v4 offset:27648
  v_mfma_f32_16x16x32_bf16 a[12:15], a[204:207], v[200:203], a[12:15]
  v_mfma_f32_16x16x32_bf16 a[44:47], a[204:207], v[216:219], a[44:47]
  s_waitcnt lgkmcnt(4)
  v_mfma_f32_16x16x32_bf16 a[16:19], a[208:211], v[200:203], a[16:19]
  ds_read_b128 a[240:243], v4 offset:28672
  v_mfma_f32_16x16x32_bf16 a[48:51], a[208:211], v[216:219], a[48:51]
  v_mfma_f32_16x16x32_bf16 a[20:23], a[212:215], v[200:203], a[20:23]
  ds_read_b128 a[244:247], v4 offset:29696
  v_mfma_f32_16x16x32_bf16 a[52:55], a[212:215], v[216:219], a[52:55]
  v_mfma_f32_16x16x32_bf16 a[24:27], a[216:219], v[200:203], a[24:27]
  ds_read_b128 a[248:251], v4 offset:30720
  v_mfma_f32_16x16x32_bf16 a[56:59], a[216:219], v[216:219], a[56:59]
  v_mfma_f32_16x16x32_bf16 a[28:31], a[220:223], v[200:203], a[28:31]
  ds_read_b128 a[252:255], v4 offset:31744
  v_mfma_f32_16x16x32_bf16 a[60:63], a[220:223], v[216:219], a[60:63]
  s_waitcnt lgkmcnt(4)
  v_mfma_f32_16x16x32_bf16 a[0:3], a[224:227], v[204:207], a[0:3]
  v_mfma_f32_16x16x32_bf16 a[32:35], a[224:227], v[220:223], a[32:35]
  v_mfma_f32_16x16x32_bf16 v[32:35], v[60:63], v[204:207], v[32:35]
  v_mfma_f32_16x16x32_bf16 a[4:7], a[228:231], v[204:207], a[4:7]
  v_mfma_f32_16x16x32_bf16 a[36:39], a[228:231], v[220:223], a[36:39]
  v_mfma_f32_16x16x32_bf16 a[8:11], a[232:235], v[204:207], a[8:11]
  v_mfma_f32_16x16x32_bf16 a[40:43], a[232:235], v[220:223], a[40:43]
  v_mfma_f32_16x16x32_bf16 v[36:39], v[60:63], v[220:223], v[36:39]
  v_mfma_f32_16x16x32_bf16 a[12:15], a[236:239], v[204:207], a[12:15]
  v_mfma_f32_16x16x32_bf16 a[44:47], a[236:239], v[220:223], a[44:47]
  s_waitcnt lgkmcnt(1)
  v_mfma_f32_16x16x32_bf16 a[16:19], a[240:243], v[204:207], a[16:19]
  v_mfma_f32_16x16x32_bf16 a[48:51], a[240:243], v[220:223], a[48:51]
  v_mfma_f32_16x16x32_bf16 a[20:23], a[244:247], v[204:207], a[20:23]
  v_mfma_f32_16x16x32_bf16 a[52:55], a[244:247], v[220:223], a[52:55]
  v_mfma_f32_16x16x32_bf16 a[24:27], a[248:251], v[204:207], a[24:27]
  v_mfma_f32_16x16x32_bf16 a[56:59], a[248:251], v[220:223], a[56:59]
  s_waitcnt lgkmcnt(0)
  v_mfma_f32_16x16x32_bf16 a[28:31], a[252:255], v[204:207], a[28:31]
  v_mfma_f32_16x16x32_bf16 a[60:63], a[252:255], v[220:223], a[60:63]
  s_branch K2_Lepi
K2_G:
  s_mov_b32 s50, s66
  s_mov_b32 s51, s67
  s_mov_b32 s52, s68
  s_mov_b32 s53, s69
  s_mov_b32 s54, s70
  s_mov_b32 s55, s71
  s_mov_b32 s56, s72
  s_mov_b32 s57, s73
  s_waitcnt vmcnt(0) lgkmcnt(0)
  s_barrier
  s_getpc_b64 s[58:59]
K2_pcT_H:
  s_add_u32 s58, s58, K2_Lepi-K2_pcT_H
  s_addc_u32 s59, s59, 0
  s_lshl_b32 s38, s5, 6
  v_add_u32 v59, s38, v1
  v_lshlrev_b32 v59, 7, v59
  v_min_u32 v59, K2_rare_C-K2_Lepi-4, v59
  global_load_dword v15, v59, s[58:59]
  s_lshl_b32 s38, s5, 3
  s_add_u32 s38, s38, 65536
  v_mov_b32 v56, s38
  v_mov_b32 v58, v13
  v_mov_b32 v59, v14
  ds_write_b64 v56, v[58:59]
  v_add_u32 v4, s34, v2
  s_waitcnt lgkmcnt(0)
  s_barrier
  v_mov_b32 v56, 65536
  ds_read_b128 v[52:55], v56
  ds_read_b128 a[192:195], v4 offset:0
  ds_read_b128 a[196:199], v4 offset:1024
  ds_read_b128 a[200:203], v4 offset:2048
  ds_read_b128 a[204:207], v4 offset:3072
  ds_read_b128 a[208:211], v4 offset:4096
  ds_read_b128 a[212:215], v4 offset:5120
  ds_read_b128 a[216:219], v4 offset:6144
  ds_read_b128 a[220:223], v4 offset:7168
  s_waitcnt lgkmcnt(8)
  v_cmp_gt_f32 vcc, v54, v52
  s_nop 1
  v_cndmask_b32 v13, v52, v54, vcc
  v_cndmask_b32 v14, v53, v55, vcc
  v_exp_f32 v48, v72
  v_exp_f32 v49, v73
  v_exp_f32 v50, v74
  v_exp_f32 v51, v75
  v_cvt_pk_bf16_f32 v196, v48, v49
  v_exp_f32 v52, v76
  v_exp_f32 v53, v77
  v_cvt_pk_bf16_f32 v197, v50, v51
  v_pk_maximum3_f16 v11, v11, v196, v197
  v_exp_f32 v54, v78
  v_exp_f32 v55, v79
  v_cvt_pk_bf16_f32 v198, v52, v53
  v_exp_f32 v48, v88
  v_exp_f32 v49, v89
  v_cvt_pk_bf16_f32 v199, v54, v55
  v_pk_maximum3_f16 v11, v11, v198, v199
  v_exp_f32 v50, v90
  v_exp_f32 v51, v91
  v_cvt_pk_bf16_f32 v204, v48, v49
  v_exp_f32 v52, v92
  v_exp_f32 v53, v93
  v_cvt_pk_bf16_f32 v205, v50, v51
  v_pk_maximum3_f16 v11, v11, v204, v205
  v_exp_f32 v54, v94
  v_exp_f32 v55, v95
  v_cvt_pk_bf16_f32 v206, v52, v53
  v_exp_f32 v48, v104
  v_exp_f32 v49, v105
  v_cvt_pk_bf16_f32 v207, v54, v55
  v_pk_maximum3_f16 v11, v11, v206, v207
  v_exp_f32 v50, v106
  v_exp_f32 v51, v107
  v_cvt_pk_bf16_f32 v212, v48, v49
  v_exp_f32 v52, v108
  v_exp_f32 v53, v109
  v_cvt_pk_bf16_f32 v213, v50, v51
  v_pk_maximum3_f16 v11, v11, v212, v213
  v_exp_f32 v54, v110
  v_exp_f32 v55, v111
  v_cvt_pk_bf16_f32 v214, v52, v53
  v_exp_f32 v48, v120
  v_exp_f32 v49, v121
  v_cvt_pk_bf16_f32 v215, v54, v55
  v_pk_maximum3_f16 v11, v11, v214, v215
  v_exp_f32 v50, v122
  v_exp_f32 v51, v123
  v_cvt_pk_bf16_f32 v220, v48, v49
  v_exp_f32 v52, v124
  v_exp_f32 v53, v125
  v_cvt_pk_bf16_f32 v221, v50, v51
  v_pk_maximum3_f16 v11, v11, v220, v221
  v_exp_f32 v54, v126
  v_exp_f32 v55, v127
  v_cvt_pk_bf16_f32 v222, v52, v53
  s_nop 0
  v_cvt_pk_bf16_f32 v223, v54, v55
  v_pk_maximum3_f16 v11, v11, v222, v223
  v_lshrrev_b32 v56, 16, v11
  v_and_b32 v57, 0xffff, v11
  v_max_u32 v56, v56, v57
  v_cmp_lt_u32 vcc, 0x4e80, v56
  s_nop 1
  s_cbranch_vccnz K2_rare_G
  K2_ret_G:
  s_waitcnt lgkmcnt(4)
  v_mfma_f32_16x16x32_bf16 a[0:3], a[192:195], v[192:195], a[0:3]
  ds_read_b128 a[224:227], v4 offset:8192
  s_mov_b32 s24, s50
  s_mov_b32 s25, s51
  s_mov_b32 s26, 0x200000
  s_mov_b32 s27, 0x20000
  v_lshlrev_b32 v57, 10, v14
  v_lshl_add_u32 v57, v0, 1, v57
  buffer_load_ushort v128, v57, s[24:27], 0 offen
  buffer_load_ushort v129, v57, s[24:27], 0 offen offset:512
  v_mfma_f32_16x16x32_bf16 a[32:35], a[192:195], v[200:203], a[32:35]
  v_mfma_f32_16x16x32_bf16 a[64:67], a[192:195], v[208:211], a[64:67]
  s_mov_b32 s24, s52
  s_mov_b32 s25, s53
  s_mov_b32 s26, 0x1c0000
  s_and_b32 s38, s2, 7
  s_mul_i32 s38, s38, 28
  s_lshr_b32 s39, s2, 3
  s_max_u32 s39, s39, 4
  s_sub_u32 s39, s39, 4
  s_add_u32 s58, s38, s39
  s_lshl_b32 s38, s58, 4
  s_add_u32 s39, s38, 917504
  v_mul_u32_u24 v56, 3584, v0
  buffer_load_dwordx4 v[132:135], v56, s[24:27], s38 offen
  v_mfma_f32_16x16x32_bf16 a[96:99], a[192:195], v[216:219], a[96:99]
  v_mfma_f32_16x16x32_bf16 v[32:35], v[60:63], v[192:195], v[32:35]
  ds_read_b128 a[228:231], v4 offset:9216
  buffer_load_dwordx4 v[136:139], v56, s[24:27], s39 offen
  v_mfma_f32_16x16x32_bf16 a[4:7], a[196:199], v[192:195], a[4:7]
  v_mfma_f32_16x16x32_bf16 a[36:39], a[196:199], v[200:203], a[36:39]
  s_mov_b32 s24, s54
  s_mov_b32 s25, s55
  buffer_load_dwordx4 v[140:143], v56, s[24:27], s38 offen
  v_mfma_f32_16x16x32_bf16 a[68:71], a[196:199], v[208:211], a[68:71]
  v_mfma_f32_16x16x32_bf16 a[100:103], a[196:199], v[216:219], a[100:103]
  buffer_load_dwordx4 v[144:147], v56, s[24:27], s39 offen
  v_mfma_f32_16x16x32_bf16 a[8:11], a[200:203], v[192:195], a[8:11]
  ds_read_b128 a[232:235], v4 offset:10240
  v_mfma_f32_16x16x32_bf16 a[40:43], a[200:203], v[200:203], a[40:43]
  s_mov_b32 s24, s56
  s_mov_b32 s25, s57
  s_mov_b32 s26, 0x1c0000
  s_lshl_b32 s38, s58, 13
  v_lshlrev_b32 v58, 2, v0
  buffer_load_dword v148, v58, s[24:27], s38 offen offset:0
  v_mfma_f32_16x16x32_bf16 a[72:75], a[200:203], v[208:211], a[72:75]
  v_mfma_f32_16x16x32_bf16 a[104:107], a[200:203], v[216:219], a[104:107]
  buffer_load_dword v149, v58, s[24:27], s38 offen offset:1024
  v_mfma_f32_16x16x32_bf16 v[36:39], v[60:63], v[200:203], v[36:39]
  ds_read_b128 a[236:239], v4 offset:11264
  v_mfma_f32_16x16x32_bf16 a[12:15], a[204:207], v[192:195], a[12:15]
  buffer_load_dword v150, v58, s[24:27], s38 offen offset:2048
  v_mfma_f32_16x16x32_bf16 a[44:47], a[204:207], v[200:203], a[44:47]
  v_mfma_f32_16x16x32_bf16 a[76:79], a[204:207], v[208:211], a[76:79]
  buffer_load_dword v151, v58, s[24:27], s38 offen offset:3072
  v_mfma_f32_16x16x32_bf16 a[108:111], a[204:207], v[216:219], a[108:111]
  s_waitcnt lgkmcnt(4)
  v_mfma_f32_16x16x32_bf16 a[16:19], a[208:211], v[192:195], a[16:19]
  ds_read_b128 a[240:243], v4 offset:12288
  s_add_u32 s38, s38, 4096
  buffer_load_dword v152, v58, s[24:27], s38 offen offset:0
  v_mfma_f32_16x16x32_bf16 a[48:51], a[208:211], v[200:203], a[48:51]
  v_mfma_f32_16x16x32_bf16 a[80:83], a[208:211], v[208:211], a[80:83]
  buffer_load_dword v153, v58, s[24:27], s38 offen offset:1024
  v_mfma_f32_16x16x32_bf16 a[112:115], a[208:211], v[216:219], a[112:115]
  v_mfma_f32_16x16x32_bf16 v[40:43], v[60:63], v[208:211], v[40:43]
  ds_read_b128 a[244:247], v4 offset:13312
  buffer_load_dword v154, v58, s[24:27], s38 offen offset:2048
  v_mfma_f32_16x16x32_bf16 a[20:23], a[212:215], v[192:195], a[20:23]
  v_mfma_f32_16x16x32_bf16 a[52:55], a[212:215], v[200:203], a[52:55]
  buffer_load_dword v155, v58, s[24:27], s38 offen offset:3072
  v_mfma_f32_16x16x32_bf16 a[84:87], a[212:215], v[208:211], a[84:87]
  v_mfma_f32_16x16x32_bf16 a[116:119], a[212:215], v[216:219], a[116:119]
  v_mfma_f32_16x16x32_bf16 a[24:27], a[216:219], v[192:195], a[24:27]
  ds_read_b128 a[248:251], v4 offset:14336
  v_mfma_f32_16x16x32_bf16 a[56:59], a[216:219], v[200:203], a[56:59]
  v_mfma_f32_16x16x32_bf16 a[88:91], a[216:219], v[208:211], a[88:91]
  v_mfma_f32_16x16x32_bf16 a[120:123], a[216:219], v[216:219], a[120:123]
  v_mfma_f32_16x16x32_bf16 v[44:47], v[60:63], v[216:219], v[44:47]
  ds_read_b128 a[252:255], v4 offset:15360
  v_mfma_f32_16x16x32_bf16 a[28:31], a[220:223], v[192:195], a[28:31]
  v_mfma_f32_16x16x32_bf16 a[60:63], a[220:223], v[200:203], a[60:63]
  v_mfma_f32_16x16x32_bf16 a[92:95], a[220:223], v[208:211], a[92:95]
  v_mfma_f32_16x16x32_bf16 a[124:127], a[220:223], v[216:219], a[124:127]
  s_waitcnt lgkmcnt(4)
  v_mfma_f32_16x16x32_bf16 a[0:3], a[224:227], v[196:199], a[0:3]
  v_mfma_f32_16x16x32_bf16 a[32:35], a[224:227], v[204:207], a[32:35]
  v_mfma_f32_16x16x32_bf16 a[64:67], a[224:227], v[212:215], a[64:67]
  v_mfma_f32_16x16x32_bf16 a[96:99], a[224:227], v[220:223], a[96:99]
  v_mfma_f32_16x16x32_bf16 v[32:35], v[60:63], v[196:199], v[32:35]
  v_mfma_f32_16x16x32_bf16 a[4:7], a[228:231], v[196:199], a[4:7]
  v_mfma_f32_16x16x32_bf16 a[36:39], a[228:231], v[204:207], a[36:39]
  v_mfma_f32_16x16x32_bf16 a[68:71], a[228:231], v[212:215], a[68:71]
  v_mfma_f32_16x16x32_bf16 a[100:103], a[228:231], v[220:223], a[100:103]
  v_mfma_f32_16x16x32_bf16 a[8:11], a[232:235], v[196:199], a[8:11]
  v_mfma_f32_16x16x32_bf16 a[40:43], a[232:235], v[204:207], a[40:43]
  v_mfma_f32_16x16x32_bf16 a[72:75], a[232:235], v[212:215], a[72:75]
  v_mfma_f32_16x16x32_bf16 a[104:107], a[232:235], v[220:223], a[104:107]
  v_mfma_f32_16x16x32_bf16 v[36:39], v[60:63], v[204:207], v[36:39]
  v_mfma_f32_16x16x32_bf16 a[12:15], a[236:239], v[196:199], a[12:15]
  v_mfma_f32_16x16x32_bf16 a[44:47], a[236:239], v[204:207], a[44:47]
  v_mfma_f32_16x16x32_bf16 a[76:79], a[236:239], v[212:215], a[76:79]
  v_mfma_f32_16x16x32_bf16 a[108:111], a[236:239], v[220:223], a[108:111]
  s_waitcnt lgkmcnt(1)
  v_mfma_f32_16x16x32_bf16 a[16:19], a[240:243], v[196:199], a[16:19]
  v_mfma_f32_16x16x32_bf16 a[48:51], a[240:243], v[204:207], a[48:51]
  v_mfma_f32_16x16x32_bf16 a[80:83], a[240:243], v[212:215], a[80:83]
  v_mfma_f32_16x16x32_bf16 a[112:115], a[240:243], v[220:223], a[112:115]
  v_mfma_f32_16x16x32_bf16 v[40:43], v[60:63], v[212:215], v[40:43]
  v_mfma_f32_16x16x32_bf16 a[20:23], a[244:247], v[196:199], a[20:23]
  v_mfma_f32_16x16x32_bf16 a[52:55], a[244:247], v[204:207], a[52:55]
  v_mfma_f32_16x16x32_bf16 a[84:87], a[244:247], v[212:215], a[84:87]
  v_mfma_f32_16x16x32_bf16 a[116:119], a[244:247], v[220:223], a[116:119]
  v_mfma_f32_16x16x32_bf16 a[24:27], a[248:251], v[196:199], a[24:27]
  v_mfma_f32_16x16x32_bf16 a[56:59], a[248:251], v[204:207], a[56:59]
  v_mfma_f32_16x16x32_bf16 a[88:91], a[248:251], v[212:215], a[88:91]
  v_mfma_f32_16x16x32_bf16 a[120:123], a[248:251], v[220:223], a[120:123]
  s_waitcnt lgkmcnt(0)
  v_mfma_f32_16x16x32_bf16 v[44:47], v[60:63], v[220:223], v[44:47]
  v_mfma_f32_16x16x32_bf16 a[28:31], a[252:255], v[196:199], a[28:31]
  v_mfma_f32_16x16x32_bf16 a[60:63], a[252:255], v[204:207], a[60:63]
  v_mfma_f32_16x16x32_bf16 a[92:95], a[252:255], v[212:215], a[92:95]
  v_mfma_f32_16x16x32_bf16 a[124:127], a[252:255], v[220:223], a[124:127]
  s_nop 15
  v_mov_b32 v56, v40
  v_rcp_f32 v56, v56
  v_mov_b32 v58, v44
  v_rcp_f32 v58, v58
  s_mov_b32 s38, s4
  s_lshl_b32 s38, s38, 2
  s_add_u32 s38, s38, s5
  s_lshl_b32 s38, s38, 18
  s_lshl_b32 s39, s3, 13
  s_add_u32 s38, s38, s39
  v_accvgpr_read_b32 v64, a64
  v_accvgpr_read_b32 v65, a65
  v_accvgpr_read_b32 v66, a66
  v_accvgpr_read_b32 v67, a67
  v_accvgpr_read_b32 v68, a96
  v_accvgpr_read_b32 v69, a97
  v_accvgpr_read_b32 v70, a98
  v_accvgpr_read_b32 v71, a99
  v_pk_mul_f32 v[64:65], v[64:65], v[56:57] op_sel_hi:[1,0]
  v_pk_mul_f32 v[66:67], v[66:67], v[56:57] op_sel_hi:[1,0]
  v_pk_mul_f32 v[68:69], v[68:69], v[58:59] op_sel_hi:[1,0]
  v_pk_mul_f32 v[70:71], v[70:71], v[58:59] op_sel_hi:[1,0]
  v_cvt_pk_bf16_f32 v72, v64, v65
  v_cvt_pk_bf16_f32 v73, v66, v67
  v_cvt_pk_bf16_f32 v74, v68, v69
  v_cvt_pk_bf16_f32 v75, v70, v71
  s_nop 1
  v_permlane16_swap_b32 v72, v74
  v_permlane16_swap_b32 v73, v75
  s_nop 0
  v_permlane32_swap_b32 v72, v74
  v_permlane32_swap_b32 v73, v75
  buffer_store_dwordx4 v[72:75], v2, s[16:19], s38 offen offset:0 sc1
  v_accvgpr_read_b32 v80, a68
  v_accvgpr_read_b32 v81, a69
  v_accvgpr_read_b32 v82, a70
  v_accvgpr_read_b32 v83, a71
  v_accvgpr_read_b32 v84, a100
  v_accvgpr_read_b32 v85, a101
  v_accvgpr_read_b32 v86, a102
  v_accvgpr_read_b32 v87, a103
  v_pk_mul_f32 v[80:81], v[80:81], v[56:57] op_sel_hi:[1,0]
  v_pk_mul_f32 v[82:83], v[82:83], v[56:57] op_sel_hi:[1,0]
  v_pk_mul_f32 v[84:85], v[84:85], v[58:59] op_sel_hi:[1,0]
  v_pk_mul_f32 v[86:87], v[86:87], v[58:59] op_sel_hi:[1,0]
  v_cvt_pk_bf16_f32 v88, v80, v81
  v_cvt_pk_bf16_f32 v89, v82, v83
  v_cvt_pk_bf16_f32 v90, v84, v85
  v_cvt_pk_bf16_f32 v91, v86, v87
  s_nop 1
  v_permlane16_swap_b32 v88, v90
  v_permlane16_swap_b32 v89, v91
  s_nop 0
  v_permlane32_swap_b32 v88, v90
  v_permlane32_swap_b32 v89, v91
  buffer_store_dwordx4 v[88:91], v2, s[16:19], s38 offen offset:1024 sc1
  v_accvgpr_read_b32 v64, a72
  v_accvgpr_read_b32 v65, a73
  v_accvgpr_read_b32 v66, a74
  v_accvgpr_read_b32 v67, a75
  v_accvgpr_read_b32 v68, a104
  v_accvgpr_read_b32 v69, a105
  v_accvgpr_read_b32 v70, a106
  v_accvgpr_read_b32 v71, a107
  v_pk_mul_f32 v[64:65], v[64:65], v[56:57] op_sel_hi:[1,0]
  v_pk_mul_f32 v[66:67], v[66:67], v[56:57] op_sel_hi:[1,0]
  v_pk_mul_f32 v[68:69], v[68:69], v[58:59] op_sel_hi:[1,0]
  v_pk_mul_f32 v[70:71], v[70:71], v[58:59] op_sel_hi:[1,0]
  v_cvt_pk_bf16_f32 v72, v64, v65
  v_cvt_pk_bf16_f32 v73, v66, v67
  v_cvt_pk_bf16_f32 v74, v68, v69
  v_cvt_pk_bf16_f32 v75, v70, v71
  s_nop 1
  v_permlane16_swap_b32 v72, v74
  v_permlane16_swap_b32 v73, v75
  s_nop 0
  v_permlane32_swap_b32 v72, v74
  v_permlane32_swap_b32 v73, v75
  buffer_store_dwordx4 v[72:75], v2, s[16:19], s38 offen offset:2048 sc1
  v_accvgpr_read_b32 v80, a76
  v_accvgpr_read_b32 v81, a77
  v_accvgpr_read_b32 v82, a78
  v_accvgpr_read_b32 v83, a79
  v_accvgpr_read_b32 v84, a108
  v_accvgpr_read_b32 v85, a109
  v_accvgpr_read_b32 v86, a110
  v_accvgpr_read_b32 v87, a111
  v_pk_mul_f32 v[80:81], v[80:81], v[56:57] op_sel_hi:[1,0]
  v_pk_mul_f32 v[82:83], v[82:83], v[56:57] op_sel_hi:[1,0]
  v_pk_mul_f32 v[84:85], v[84:85], v[58:59] op_sel_hi:[1,0]
  v_pk_mul_f32 v[86:87], v[86:87], v[58:59] op_sel_hi:[1,0]
  v_cvt_pk_bf16_f32 v88, v80, v81
  v_cvt_pk_bf16_f32 v89, v82, v83
  v_cvt_pk_bf16_f32 v90, v84, v85
  v_cvt_pk_bf16_f32 v91, v86, v87
  s_nop 1
  v_permlane16_swap_b32 v88, v90
  v_permlane16_swap_b32 v89, v91
  s_nop 0
  v_permlane32_swap_b32 v88, v90
  v_permlane32_swap_b32 v89, v91
  buffer_store_dwordx4 v[88:91], v2, s[16:19], s38 offen offset:3072 sc1
  v_accvgpr_read_b32 v64, a80
  v_accvgpr_read_b32 v65, a81
  v_accvgpr_read_b32 v66, a82
  v_accvgpr_read_b32 v67, a83
  v_accvgpr_read_b32 v68, a112
  v_accvgpr_read_b32 v69, a113
  v_accvgpr_read_b32 v70, a114
  v_accvgpr_read_b32 v71, a115
  v_pk_mul_f32 v[64:65], v[64:65], v[56:57] op_sel_hi:[1,0]
  v_pk_mul_f32 v[66:67], v[66:67], v[56:57] op_sel_hi:[1,0]
  v_pk_mul_f32 v[68:69], v[68:69], v[58:59] op_sel_hi:[1,0]
  v_pk_mul_f32 v[70:71], v[70:71], v[58:59] op_sel_hi:[1,0]
  v_cvt_pk_bf16_f32 v72, v64, v65
  v_cvt_pk_bf16_f32 v73, v66, v67
  v_cvt_pk_bf16_f32 v74, v68, v69
  v_cvt_pk_bf16_f32 v75, v70, v71
  s_nop 1
  v_permlane16_swap_b32 v72, v74
  v_permlane16_swap_b32 v73, v75
  s_nop 0
  v_permlane32_swap_b32 v72, v74
  v_permlane32_swap_b32 v73, v75
  s_add_u32 s38, s38, 4096
  buffer_store_dwordx4 v[72:75], v2, s[16:19], s38 offen offset:0 sc1
  v_accvgpr_read_b32 v80, a84
  v_accvgpr_read_b32 v81, a85
  v_accvgpr_read_b32 v82, a86
  v_accvgpr_read_b32 v83, a87
  v_accvgpr_read_b32 v84, a116
  v_accvgpr_read_b32 v85, a117
  v_accvgpr_read_b32 v86, a118
  v_accvgpr_read_b32 v87, a119
  v_pk_mul_f32 v[80:81], v[80:81], v[56:57] op_sel_hi:[1,0]
  v_pk_mul_f32 v[82:83], v[82:83], v[56:57] op_sel_hi:[1,0]
  v_pk_mul_f32 v[84:85], v[84:85], v[58:59] op_sel_hi:[1,0]
  v_pk_mul_f32 v[86:87], v[86:87], v[58:59] op_sel_hi:[1,0]
  v_cvt_pk_bf16_f32 v88, v80, v81
  v_cvt_pk_bf16_f32 v89, v82, v83
  v_cvt_pk_bf16_f32 v90, v84, v85
  v_cvt_pk_bf16_f32 v91, v86, v87
  s_nop 1
  v_permlane16_swap_b32 v88, v90
  v_permlane16_swap_b32 v89, v91
  s_nop 0
  v_permlane32_swap_b32 v88, v90
  v_permlane32_swap_b32 v89, v91
  buffer_store_dwordx4 v[88:91], v2, s[16:19], s38 offen offset:1024 sc1
  v_accvgpr_read_b32 v64, a88
  v_accvgpr_read_b32 v65, a89
  v_accvgpr_read_b32 v66, a90
  v_accvgpr_read_b32 v67, a91
  v_accvgpr_read_b32 v68, a120
  v_accvgpr_read_b32 v69, a121
  v_accvgpr_read_b32 v70, a122
  v_accvgpr_read_b32 v71, a123
  v_pk_mul_f32 v[64:65], v[64:65], v[56:57] op_sel_hi:[1,0]
  v_pk_mul_f32 v[66:67], v[66:67], v[56:57] op_sel_hi:[1,0]
  v_pk_mul_f32 v[68:69], v[68:69], v[58:59] op_sel_hi:[1,0]
  v_pk_mul_f32 v[70:71], v[70:71], v[58:59] op_sel_hi:[1,0]
  v_cvt_pk_bf16_f32 v72, v64, v65
  v_cvt_pk_bf16_f32 v73, v66, v67
  v_cvt_pk_bf16_f32 v74, v68, v69
  v_cvt_pk_bf16_f32 v75, v70, v71
  s_nop 1
  v_permlane16_swap_b32 v72, v74
  v_permlane16_swap_b32 v73, v75
  s_nop 0
  v_permlane32_swap_b32 v72, v74
  v_permlane32_swap_b32 v73, v75
  buffer_store_dwordx4 v[72:75], v2, s[16:19], s38 offen offset:2048 sc1
  v_accvgpr_read_b32 v80, a92
  v_accvgpr_read_b32 v81, a93
  v_accvgpr_read_b32 v82, a94
  v_accvgpr_read_b32 v83, a95
  v_accvgpr_read_b32 v84, a124
  v_accvgpr_read_b32 v85, a125
  v_accvgpr_read_b32 v86, a126
  v_accvgpr_read_b32 v87, a127
  v_pk_mul_f32 v[80:81], v[80:81], v[56:57] op_sel_hi:[1,0]
  v_pk_mul_f32 v[82:83], v[82:83], v[56:57] op_sel_hi:[1,0]
  v_pk_mul_f32 v[84:85], v[84:85], v[58:59] op_sel_hi:[1,0]
  v_pk_mul_f32 v[86:87], v[86:87], v[58:59] op_sel_hi:[1,0]
  v_cvt_pk_bf16_f32 v88, v80, v81
  v_cvt_pk_bf16_f32 v89, v82, v83
  v_cvt_pk_bf16_f32 v90, v84, v85
  v_cvt_pk_bf16_f32 v91, v86, v87
  s_nop 1
  v_permlane16_swap_b32 v88, v90
  v_permlane16_swap_b32 v89, v91
  s_nop 0
  v_permlane32_swap_b32 v88, v90
  v_permlane32_swap_b32 v89, v91
  buffer_store_dwordx4 v[88:91], v2, s[16:19], s38 offen offset:3072 sc1
K2_Lepi:
  s_nop 15
  v_mov_b32 v56, v32
  v_rcp_f32 v56, v56
  v_mov_b32 v58, v36
  v_rcp_f32 v58, v58
  s_sub_u32 s38, 15, s4
  s_lshl_b32 s38, s38, 2
  s_add_u32 s38, s38, s5
  s_lshl_b32 s38, s38, 18
  s_lshl_b32 s39, s3, 13
  s_add_u32 s38, s38, s39
  v_accvgpr_read_b32 v64, a0
  v_accvgpr_read_b32 v65, a1
  v_accvgpr_read_b32 v66, a2
  v_accvgpr_read_b32 v67, a3
  v_accvgpr_read_b32 v68, a32
  v_accvgpr_read_b32 v69, a33
  v_accvgpr_read_b32 v70, a34
  v_accvgpr_read_b32 v71, a35
  v_pk_mul_f32 v[64:65], v[64:65], v[56:57] op_sel_hi:[1,0]
  v_pk_mul_f32 v[66:67], v[66:67], v[56:57] op_sel_hi:[1,0]
  v_pk_mul_f32 v[68:69], v[68:69], v[58:59] op_sel_hi:[1,0]
  v_pk_mul_f32 v[70:71], v[70:71], v[58:59] op_sel_hi:[1,0]
  v_cvt_pk_bf16_f32 v72, v64, v65
  v_cvt_pk_bf16_f32 v73, v66, v67
  v_cvt_pk_bf16_f32 v74, v68, v69
  v_cvt_pk_bf16_f32 v75, v70, v71
  s_nop 1
  v_permlane16_swap_b32 v72, v74
  v_permlane16_swap_b32 v73, v75
  s_nop 0
  v_permlane32_swap_b32 v72, v74
  v_permlane32_swap_b32 v73, v75
  buffer_store_dwordx4 v[72:75], v2, s[16:19], s38 offen offset:0 sc1
  v_accvgpr_read_b32 v80, a4
  v_accvgpr_read_b32 v81, a5
  v_accvgpr_read_b32 v82, a6
  v_accvgpr_read_b32 v83, a7
  v_accvgpr_read_b32 v84, a36
  v_accvgpr_read_b32 v85, a37
  v_accvgpr_read_b32 v86, a38
  v_accvgpr_read_b32 v87, a39
  v_pk_mul_f32 v[80:81], v[80:81], v[56:57] op_sel_hi:[1,0]
  v_pk_mul_f32 v[82:83], v[82:83], v[56:57] op_sel_hi:[1,0]
  v_pk_mul_f32 v[84:85], v[84:85], v[58:59] op_sel_hi:[1,0]
  v_pk_mul_f32 v[86:87], v[86:87], v[58:59] op_sel_hi:[1,0]
  v_cvt_pk_bf16_f32 v88, v80, v81
  v_cvt_pk_bf16_f32 v89, v82, v83
  v_cvt_pk_bf16_f32 v90, v84, v85
  v_cvt_pk_bf16_f32 v91, v86, v87
  s_nop 1
  v_permlane16_swap_b32 v88, v90
  v_permlane16_swap_b32 v89, v91
  s_nop 0
  v_permlane32_swap_b32 v88, v90
  v_permlane32_swap_b32 v89, v91
  buffer_store_dwordx4 v[88:91], v2, s[16:19], s38 offen offset:1024 sc1
  v_accvgpr_read_b32 v64, a8
  v_accvgpr_read_b32 v65, a9
  v_accvgpr_read_b32 v66, a10
  v_accvgpr_read_b32 v67, a11
  v_accvgpr_read_b32 v68, a40
  v_accvgpr_read_b32 v69, a41
  v_accvgpr_read_b32 v70, a42
  v_accvgpr_read_b32 v71, a43
  v_pk_mul_f32 v[64:65], v[64:65], v[56:57] op_sel_hi:[1,0]
  v_pk_mul_f32 v[66:67], v[66:67], v[56:57] op_sel_hi:[1,0]
  v_pk_mul_f32 v[68:69], v[68:69], v[58:59] op_sel_hi:[1,0]
  v_pk_mul_f32 v[70:71], v[70:71], v[58:59] op_sel_hi:[1,0]
  v_cvt_pk_bf16_f32 v72, v64, v65
  v_cvt_pk_bf16_f32 v73, v66, v67
  v_cvt_pk_bf16_f32 v74, v68, v69
  v_cvt_pk_bf16_f32 v75, v70, v71
  s_nop 1
  v_permlane16_swap_b32 v72, v74
  v_permlane16_swap_b32 v73, v75
  s_nop 0
  v_permlane32_swap_b32 v72, v74
  v_permlane32_swap_b32 v73, v75
  buffer_store_dwordx4 v[72:75], v2, s[16:19], s38 offen offset:2048 sc1
  v_accvgpr_read_b32 v80, a12
  v_accvgpr_read_b32 v81, a13
  v_accvgpr_read_b32 v82, a14
  v_accvgpr_read_b32 v83, a15
  v_accvgpr_read_b32 v84, a44
  v_accvgpr_read_b32 v85, a45
  v_accvgpr_read_b32 v86, a46
  v_accvgpr_read_b32 v87, a47
  v_pk_mul_f32 v[80:81], v[80:81], v[56:57] op_sel_hi:[1,0]
  v_pk_mul_f32 v[82:83], v[82:83], v[56:57] op_sel_hi:[1,0]
  v_pk_mul_f32 v[84:85], v[84:85], v[58:59] op_sel_hi:[1,0]
  v_pk_mul_f32 v[86:87], v[86:87], v[58:59] op_sel_hi:[1,0]
  v_cvt_pk_bf16_f32 v88, v80, v81
  v_cvt_pk_bf16_f32 v89, v82, v83
  v_cvt_pk_bf16_f32 v90, v84, v85
  v_cvt_pk_bf16_f32 v91, v86, v87
  s_nop 1
  v_permlane16_swap_b32 v88, v90
  v_permlane16_swap_b32 v89, v91
  s_nop 0
  v_permlane32_swap_b32 v88, v90
  v_permlane32_swap_b32 v89, v91
  buffer_store_dwordx4 v[88:91], v2, s[16:19], s38 offen offset:3072 sc1
  v_accvgpr_read_b32 v64, a16
  v_accvgpr_read_b32 v65, a17
  v_accvgpr_read_b32 v66, a18
  v_accvgpr_read_b32 v67, a19
  v_accvgpr_read_b32 v68, a48
  v_accvgpr_read_b32 v69, a49
  v_accvgpr_read_b32 v70, a50
  v_accvgpr_read_b32 v71, a51
  v_pk_mul_f32 v[64:65], v[64:65], v[56:57] op_sel_hi:[1,0]
  v_pk_mul_f32 v[66:67], v[66:67], v[56:57] op_sel_hi:[1,0]
  v_pk_mul_f32 v[68:69], v[68:69], v[58:59] op_sel_hi:[1,0]
  v_pk_mul_f32 v[70:71], v[70:71], v[58:59] op_sel_hi:[1,0]
  v_cvt_pk_bf16_f32 v72, v64, v65
  v_cvt_pk_bf16_f32 v73, v66, v67
  v_cvt_pk_bf16_f32 v74, v68, v69
  v_cvt_pk_bf16_f32 v75, v70, v71
  s_nop 1
  v_permlane16_swap_b32 v72, v74
  v_permlane16_swap_b32 v73, v75
  s_nop 0
  v_permlane32_swap_b32 v72, v74
  v_permlane32_swap_b32 v73, v75
  s_add_u32 s38, s38, 4096
  buffer_store_dwordx4 v[72:75], v2, s[16:19], s38 offen offset:0 sc1
  v_accvgpr_read_b32 v80, a20
  v_accvgpr_read_b32 v81, a21
  v_accvgpr_read_b32 v82, a22
  v_accvgpr_read_b32 v83, a23
  v_accvgpr_read_b32 v84, a52
  v_accvgpr_read_b32 v85, a53
  v_accvgpr_read_b32 v86, a54
  v_accvgpr_read_b32 v87, a55
  v_pk_mul_f32 v[80:81], v[80:81], v[56:57] op_sel_hi:[1,0]
  v_pk_mul_f32 v[82:83], v[82:83], v[56:57] op_sel_hi:[1,0]
  v_pk_mul_f32 v[84:85], v[84:85], v[58:59] op_sel_hi:[1,0]
  v_pk_mul_f32 v[86:87], v[86:87], v[58:59] op_sel_hi:[1,0]
  v_cvt_pk_bf16_f32 v88, v80, v81
  v_cvt_pk_bf16_f32 v89, v82, v83
  v_cvt_pk_bf16_f32 v90, v84, v85
  v_cvt_pk_bf16_f32 v91, v86, v87
  s_nop 1
  v_permlane16_swap_b32 v88, v90
  v_permlane16_swap_b32 v89, v91
  s_nop 0
  v_permlane32_swap_b32 v88, v90
  v_permlane32_swap_b32 v89, v91
  buffer_store_dwordx4 v[88:91], v2, s[16:19], s38 offen offset:1024 sc1
  v_accvgpr_read_b32 v64, a24
  v_accvgpr_read_b32 v65, a25
  v_accvgpr_read_b32 v66, a26
  v_accvgpr_read_b32 v67, a27
  v_accvgpr_read_b32 v68, a56
  v_accvgpr_read_b32 v69, a57
  v_accvgpr_read_b32 v70, a58
  v_accvgpr_read_b32 v71, a59
  v_pk_mul_f32 v[64:65], v[64:65], v[56:57] op_sel_hi:[1,0]
  v_pk_mul_f32 v[66:67], v[66:67], v[56:57] op_sel_hi:[1,0]
  v_pk_mul_f32 v[68:69], v[68:69], v[58:59] op_sel_hi:[1,0]
  v_pk_mul_f32 v[70:71], v[70:71], v[58:59] op_sel_hi:[1,0]
  v_cvt_pk_bf16_f32 v72, v64, v65
  v_cvt_pk_bf16_f32 v73, v66, v67
  v_cvt_pk_bf16_f32 v74, v68, v69
  v_cvt_pk_bf16_f32 v75, v70, v71
  s_nop 1
  v_permlane16_swap_b32 v72, v74
  v_permlane16_swap_b32 v73, v75
  s_nop 0
  v_permlane32_swap_b32 v72, v74
  v_permlane32_swap_b32 v73, v75
  buffer_store_dwordx4 v[72:75], v2, s[16:19], s38 offen offset:2048 sc1
  v_accvgpr_read_b32 v80, a28
  v_accvgpr_read_b32 v81, a29
  v_accvgpr_read_b32 v82, a30
  v_accvgpr_read_b32 v83, a31
  v_accvgpr_read_b32 v84, a60
  v_accvgpr_read_b32 v85, a61
  v_accvgpr_read_b32 v86, a62
  v_accvgpr_read_b32 v87, a63
  v_pk_mul_f32 v[80:81], v[80:81], v[56:57] op_sel_hi:[1,0]
  v_pk_mul_f32 v[82:83], v[82:83], v[56:57] op_sel_hi:[1,0]
  v_pk_mul_f32 v[84:85], v[84:85], v[58:59] op_sel_hi:[1,0]
  v_pk_mul_f32 v[86:87], v[86:87], v[58:59] op_sel_hi:[1,0]
  v_cvt_pk_bf16_f32 v88, v80, v81
  v_cvt_pk_bf16_f32 v89, v82, v83
  v_cvt_pk_bf16_f32 v90, v84, v85
  v_cvt_pk_bf16_f32 v91, v86, v87
  s_nop 1
  v_permlane16_swap_b32 v88, v90
  v_permlane16_swap_b32 v89, v91
  s_nop 0
  v_permlane32_swap_b32 v88, v90
  v_permlane32_swap_b32 v89, v91
  buffer_store_dwordx4 v[88:91], v2, s[16:19], s38 offen offset:3072 sc1
  s_cmp_lg_u32 s2, 0
  s_cbranch_scc1 K2_noidx
  v_mov_b32 v56, 16384
  buffer_store_dword v14, v56, s[20:23], 0 offen
K2_noidx:
  s_cmp_eq_u32 s4, 0
  s_cbranch_scc1 K2_noy
  s_waitcnt vmcnt(8)
  v_lshlrev_b32 v128, 16, v128
  v_lshlrev_b32 v129, 16, v129
  v_lshlrev_b32 v56, 16, v132
  v_mul_f32 v160, v56, v128
  v_lshlrev_b32 v56, 16, v136
  v_fmac_f32 v160, v56, v129
  v_and_b32 v56, 0xffff0000, v132
  v_mul_f32 v161, v56, v128
  v_and_b32 v56, 0xffff0000, v136
  v_fmac_f32 v161, v56, v129
  v_lshlrev_b32 v56, 16, v133
  v_mul_f32 v162, v56, v128
  v_lshlrev_b32 v56, 16, v137
  v_fmac_f32 v162, v56, v129
  v_and_b32 v56, 0xffff0000, v133
  v_mul_f32 v163, v56, v128
  v_and_b32 v56, 0xffff0000, v137
  v_fmac_f32 v163, v56, v129
  v_lshlrev_b32 v56, 16, v134
  v_mul_f32 v164, v56, v128
  v_lshlrev_b32 v56, 16, v138
  v_fmac_f32 v164, v56, v129
  v_and_b32 v56, 0xffff0000, v134
  v_mul_f32 v165, v56, v128
  v_and_b32 v56, 0xffff0000, v138
  v_fmac_f32 v165, v56, v129
  v_lshlrev_b32 v56, 16, v135
  v_mul_f32 v166, v56, v128
  v_lshlrev_b32 v56, 16, v139
  v_fmac_f32 v166, v56, v129
  v_and_b32 v56, 0xffff0000, v135
  v_mul_f32 v167, v56, v128
  v_and_b32 v56, 0xffff0000, v139
  v_fmac_f32 v167, v56, v129
  v_lshlrev_b32 v56, 16, v140
  v_mul_f32 v168, v56, v128
  v_lshlrev_b32 v56, 16, v144
  v_fmac_f32 v168, v56, v129
  v_and_b32 v56, 0xffff0000, v140
  v_mul_f32 v169, v56, v128
  v_and_b32 v56, 0xffff0000, v144
  v_fmac_f32 v169, v56, v129
  v_lshlrev_b32 v56, 16, v141
  v_mul_f32 v170, v56, v128
  v_lshlrev_b32 v56, 16, v145
  v_fmac_f32 v170, v56, v129
  v_and_b32 v56, 0xffff0000, v141
  v_mul_f32 v171, v56, v128
  v_and_b32 v56, 0xffff0000, v145
  v_fmac_f32 v171, v56, v129
  v_lshlrev_b32 v56, 16, v142
  v_mul_f32 v172, v56, v128
  v_lshlrev_b32 v56, 16, v146
  v_fmac_f32 v172, v56, v129
  v_and_b32 v56, 0xffff0000, v142
  v_mul_f32 v173, v56, v128
  v_and_b32 v56, 0xffff0000, v146
  v_fmac_f32 v173, v56, v129
  v_lshlrev_b32 v56, 16, v143
  v_mul_f32 v174, v56, v128
  v_lshlrev_b32 v56, 16, v147
  v_fmac_f32 v174, v56, v129
  v_and_b32 v56, 0xffff0000, v143
  v_mul_f32 v175, v56, v128
  v_and_b32 v56, 0xffff0000, v147
  v_fmac_f32 v175, v56, v129
  s_nop 1
  v_permlane32_swap_b32 v160, v168
  v_permlane32_swap_b32 v161, v169
  v_permlane32_swap_b32 v162, v170
  v_permlane32_swap_b32 v163, v171
  v_permlane32_swap_b32 v164, v172
  v_permlane32_swap_b32 v165, v173
  v_permlane32_swap_b32 v166, v174
  v_permlane32_swap_b32 v167, v175
  s_nop 1
  v_add_f32 v160, v160, v168
  v_add_f32 v161, v161, v169
  v_add_f32 v162, v162, v170
  v_add_f32 v163, v163, v171
  v_add_f32 v164, v164, v172
  v_add_f32 v165, v165, v173
  v_add_f32 v166, v166, v174
  v_add_f32 v167, v167, v175
  s_nop 1
  v_permlane16_swap_b32 v160, v164
  v_permlane16_swap_b32 v161, v165
  v_permlane16_swap_b32 v162, v166
  v_permlane16_swap_b32 v163, v167
  s_nop 1
  v_add_f32 v160, v160, v164
  v_add_f32 v161, v161, v165
  v_add_f32 v162, v162, v166
  v_add_f32 v163, v163, v167
  s_nop 1
  v_add_f32_dpp v160, v160, v160 row_shr:1 row_mask:0xf bank_mask:0xf
  v_add_f32_dpp v161, v161, v161 row_shr:1 row_mask:0xf bank_mask:0xf
  v_add_f32_dpp v162, v162, v162 row_shr:1 row_mask:0xf bank_mask:0xf
  v_add_f32_dpp v163, v163, v163 row_shr:1 row_mask:0xf bank_mask:0xf
  s_nop 1
  v_add_f32_dpp v160, v160, v160 row_shr:2 row_mask:0xf bank_mask:0xf
  v_add_f32_dpp v161, v161, v161 row_shr:2 row_mask:0xf bank_mask:0xf
  v_add_f32_dpp v162, v162, v162 row_shr:2 row_mask:0xf bank_mask:0xf
  v_add_f32_dpp v163, v163, v163 row_shr:2 row_mask:0xf bank_mask:0xf
  s_nop 1
  v_add_f32_dpp v160, v160, v160 row_shr:4 row_mask:0xf bank_mask:0xf
  v_add_f32_dpp v161, v161, v161 row_shr:4 row_mask:0xf bank_mask:0xf
  v_add_f32_dpp v162, v162, v162 row_shr:4 row_mask:0xf bank_mask:0xf
  v_add_f32_dpp v163, v163, v163 row_shr:4 row_mask:0xf bank_mask:0xf
  s_nop 1
  v_add_f32_dpp v160, v160, v160 row_shr:8 row_mask:0xf bank_mask:0xf
  v_add_f32_dpp v161, v161, v161 row_shr:8 row_mask:0xf bank_mask:0xf
  v_add_f32_dpp v162, v162, v162 row_shr:8 row_mask:0xf bank_mask:0xf
  v_add_f32_dpp v163, v163, v163 row_shr:8 row_mask:0xf bank_mask:0xf
  v_lshrrev_b32 v56, 4, v1
  v_and_b32 v57, 1, v56
  v_lshlrev_b32 v57, 4, v57
  v_lshrrev_b32 v56, 1, v56
  v_lshl_add_u32 v57, v56, 5, v57
  s_lshl_b32 s38, s5, 6
  s_add_u32 s38, s38, 1024
  v_add_u32 v57, s38, v57
  v_and_b32 v56, 15, v1
  v_cmp_eq_u32 vcc, 15, v56
  s_barrier
  s_and_saveexec_b64 s[40:41], vcc
  ds_write_b128 v57, v[160:163]
  s_mov_b64 exec, s[40:41]
  s_waitcnt lgkmcnt(0)
  s_barrier
  v_lshlrev_b32 v56, 2, v56
  v_add_u32 v56, 1024, v56
  ds_read_b32 v160, v56 offset:0
  ds_read_b32 v161, v56 offset:64
  ds_read_b32 v162, v56 offset:128
  ds_read_b32 v163, v56 offset:192
  s_waitcnt lgkmcnt(0)
  v_add_f32 v160, v160, v161
  v_add_f32 v162, v162, v163
  v_add_f32 v160, v160, v162
  v_mul_f32 v57, 0xbfb8aa3b, v160
  v_exp_f32 v57, v57
  s_nop 0
  v_add_f32 v57, 1.0, v57
  v_rcp_f32 v57, v57
  s_nop 0
  v_mul_f32 v57, v57, v160
  v_mov_b32_dpp v58, v160 row_shl:8 row_mask:0xf bank_mask:0xf
  s_nop 1
  v_mul_f32 v57, v57, v58
  v_mul_f32 v56, 0xbfb8aa3b, v13
  v_exp_f32 v56, v56
  s_nop 0
  v_add_f32 v56, 1.0, v56
  v_rcp_f32 v56, v56
  s_nop 0
  v_mul_f32 v57, v57, v56
  s_nop 0
  v_readlane_b32 s60, v57, 0
  v_readlane_b32 s61, v57, 1
  v_readlane_b32 s62, v57, 2
  v_readlane_b32 s63, v57, 3
  v_readlane_b32 s64, v57, 4
  v_readlane_b32 s65, v57, 5
  v_readlane_b32 s66, v57, 6
  v_readlane_b32 s67, v57, 7
  s_nop 1
  v_lshlrev_b32 v57, 16, v148
  v_and_b32 v58, 0xffff0000, v148
  v_mul_f32 v164, s60, v57
  v_mul_f32 v165, s60, v58
  v_lshlrev_b32 v57, 16, v149
  v_and_b32 v58, 0xffff0000, v149
  v_fmac_f32 v164, s61, v57
  v_fmac_f32 v165, s61, v58
  v_lshlrev_b32 v57, 16, v150
  v_and_b32 v58, 0xffff0000, v150
  v_fmac_f32 v164, s62, v57
  v_fmac_f32 v165, s62, v58
  v_lshlrev_b32 v57, 16, v151
  v_and_b32 v58, 0xffff0000, v151
  v_fmac_f32 v164, s63, v57
  v_fmac_f32 v165, s63, v58
  v_lshlrev_b32 v57, 16, v152
  v_and_b32 v58, 0xffff0000, v152
  v_fmac_f32 v164, s64, v57
  v_fmac_f32 v165, s64, v58
  v_lshlrev_b32 v57, 16, v153
  v_and_b32 v58, 0xffff0000, v153
  v_fmac_f32 v164, s65, v57
  v_fmac_f32 v165, s65, v58
  v_lshlrev_b32 v57, 16, v154
  v_and_b32 v58, 0xffff0000, v154
  v_fmac_f32 v164, s66, v57
  v_fmac_f32 v165, s66, v58
  v_lshlrev_b32 v57, 16, v155
  v_and_b32 v58, 0xffff0000, v155
  v_fmac_f32 v164, s67, v57
  v_fmac_f32 v165, s67, v58
  v_lshlrev_b32 v56, 3, v0
  v_add_u32 v56, 4096, v56
  ds_write_b64 v56, v[164:165]
  s_lshl_b32 s38, s5, 9
  s_add_u32 s38, s38, 4096
  v_lshlrev_b32 v56, 2, v1
  v_add_u32 v57, s38, v56
  s_waitcnt lgkmcnt(0)
  ds_read_b32 v164, v57
  ds_read_b32 v165, v57 offset:256
  s_and_b32 s39, s2, 7
  s_lshl_b32 s39, s39, 11
  s_lshl_b32 s38, s5, 9
  s_add_u32 s38, s38, s39
  s_add_u32 s38, s38, 32768
  s_waitcnt lgkmcnt(0)
  buffer_atomic_add_f32 v164, v56, s[20:23], s38 offen
  buffer_atomic_add_f32 v165, v56, s[20:23], s38 offen offset:256
K2_noy:
  s_load_dwordx2 s[36:37], s[0:1], 96
  v_mov_b32 v17, v14
  s_and_b32 s28, s2, 7
  s_lshl_b32 s28, s28, 2
  s_lshr_b32 s34, s2, 3
  s_and_b32 s34, s34, 3
  s_add_u32 s28, s28, s34
  s_lshr_b32 s29, s2, 5
  s_add_u32 s8, s48, 0x3000000
  s_addc_u32 s9, s49, 0
  s_mov_b32 s10, 0x1000000
  s_mov_b32 s11, 0x20000
  s_add_u32 s12, s48, 0x4000000
  s_addc_u32 s13, s49, 0
  s_mov_b32 s14, 0x400000
  s_mov_b32 s15, 0x20000
  s_mov_b32 s24, s50
  s_mov_b32 s25, s51
  s_mov_b32 s26, 0x200000
  s_mov_b32 s27, 0x20000
  s_lshl_b32 s34, s5, 16
  s_lshl_b32 s30, s28, 19
  s_add_u32 s30, s30, s34
  s_add_u32 s31, s30, 0x40000
  s_lshl_b32 s32, s29, 19
  s_add_u32 s32, s32, s34
  s_add_u32 s33, s32, 0x40000
  s_and_b32 s34, s5, 1
  s_lshl_b32 s34, s34, 5
  s_lshl_b32 s35, s28, 6
  s_add_u32 s34, s34, s35
  v_and_b32 v248, 31, v1
  v_add_u32 v248, s34, v248
  v_mov_b32 v251, v248
  v_lshlrev_b32 v3, 10, v248
  v_lshrrev_b32 v249, 5, v1
  v_lshlrev_b32 v249, 3, v249
  s_lshr_b32 s34, s5, 1
  s_lshl_b32 s34, s34, 6
  s_lshl_b32 s35, s29, 7
  s_add_u32 s34, s34, s35
  v_add_u32 v249, s34, v249
  v_add_u32 v3, v3, v249
  v_lshlrev_b32 v250, 2, v248
  v_add_u32 v250, 8192, v250
  s_waitcnt vmcnt(0) lgkmcnt(0)
  s_barrier
  s_mov_b32 s16, s36
  s_mov_b32 s17, s37
  s_mov_b32 s18, 0x200000
  s_mov_b32 s19, 0x20000
  s_cmp_lg_u32 s5, 0
  s_cbranch_scc1 D_noflag
  s_lshl_b32 s34, s2, 7
  s_add_u32 s34, s34, 131084
  v_mov_b32 v252, 1
  v_mov_b32 v253, 0
  v_cmp_eq_u32 vcc, 0, v1
  s_and_saveexec_b64 s[40:41], vcc
  buffer_store_dword v252, v253, s[20:23], s34 offen sc1
  s_mov_b64 exec, s[40:41]
D_noflag:
  buffer_load_dwordx2 v[8:9], v3, s[24:27], 0 offen offset:0
  buffer_load_dwordx2 v[10:11], v3, s[24:27], 0 offen offset:16
  buffer_load_dwordx2 v[12:13], v3, s[24:27], 0 offen offset:32
  buffer_load_dwordx2 v[14:15], v3, s[24:27], 0 offen offset:48
  buffer_load_dword v16, v250, s[20:23], 0 offen sc1
  buffer_load_dwordx4 v[40:43], v2, s[12:15], s32 offen offset:0
  buffer_load_dwordx4 v[44:47], v2, s[12:15], s33 offen offset:0
  buffer_load_dwordx4 v[56:59], v2, s[12:15], s32 offen offset:1024
  buffer_load_dwordx4 v[60:63], v2, s[12:15], s33 offen offset:1024
  buffer_load_dwordx4 v[72:75], v2, s[12:15], s32 offen offset:2048
  buffer_load_dwordx4 v[76:79], v2, s[12:15], s33 offen offset:2048
  buffer_load_dwordx4 v[88:91], v2, s[12:15], s32 offen offset:3072
  buffer_load_dwordx4 v[92:95], v2, s[12:15], s33 offen offset:3072
  s_add_u32 s32, s32, 4096
  s_add_u32 s33, s33, 4096
  buffer_load_dwordx4 v[104:107], v2, s[12:15], s32 offen offset:0
  buffer_load_dwordx4 v[108:111], v2, s[12:15], s33 offen offset:0
  buffer_load_dwordx4 v[120:123], v2, s[12:15], s32 offen offset:1024
  buffer_load_dwordx4 v[124:127], v2, s[12:15], s33 offen offset:1024
  buffer_load_dwordx4 v[136:139], v2, s[12:15], s32 offen offset:2048
  buffer_load_dwordx4 v[140:143], v2, s[12:15], s33 offen offset:2048
  buffer_load_dwordx4 v[152:155], v2, s[12:15], s32 offen offset:3072
  buffer_load_dwordx4 v[156:159], v2, s[12:15], s33 offen offset:3072
  s_add_u32 s32, s32, 4096
  s_add_u32 s33, s33, 4096
  buffer_load_dwordx4 v[168:171], v2, s[12:15], s32 offen offset:0
  buffer_load_dwordx4 v[172:175], v2, s[12:15], s33 offen offset:0
  buffer_load_dwordx4 v[184:187], v2, s[12:15], s32 offen offset:1024
  buffer_load_dwordx4 v[188:191], v2, s[12:15], s33 offen offset:1024
  buffer_load_dwordx4 v[200:203], v2, s[12:15], s32 offen offset:2048
  buffer_load_dwordx4 v[204:207], v2, s[12:15], s33 offen offset:2048
  buffer_load_dwordx4 v[216:219], v2, s[12:15], s32 offen offset:3072
  buffer_load_dwordx4 v[220:223], v2, s[12:15], s33 offen offset:3072
  s_add_u32 s32, s32, 4096
  s_add_u32 s33, s33, 4096
  buffer_load_dwordx4 v[232:235], v2, s[12:15], s32 offen offset:0
  buffer_load_dwordx4 v[236:239], v2, s[12:15], s33 offen offset:0
  s_lshr_b32 s34, s28, 1
  s_sub_u32 s35, 15, s34
  s_min_u32 s34, s34, s35
  s_lshl_b32 s34, s34, 12
  s_add_u32 s34, s34, 131084
  v_and_b32 v252, 7, v1
  s_lshl_b32 s35, s5, 3
  v_add_u32 v252, s35, v252
  v_and_b32 v253, 3, v252
  v_lshlrev_b32 v253, 3, v253
  v_lshrrev_b32 v252, 2, v252
  v_or_b32 v253, v253, v252
  v_lshlrev_b32 v253, 7, v253
  s_mov_b32 s35, 0
D_poll:
  buffer_load_dword v252, v253, s[20:23], s34 offen sc1
  s_waitcnt vmcnt(0)
  v_cmp_ne_u32 vcc, 1, v252
  s_add_u32 s35, s35, 1
  s_nop 3
  s_cbranch_vccz D_poll_ok
  s_cmp_ge_u32 s35, 1048576
  s_cbranch_scc1 D_poll_ok
  s_sleep 2
  s_branch D_poll
D_poll_ok:
  buffer_load_dwordx4 v[48:51], v2, s[8:11], s30 offen offset:0
  buffer_load_dwordx4 v[52:55], v2, s[8:11], s31 offen offset:0
  buffer_load_dwordx4 v[64:67], v2, s[8:11], s30 offen offset:1024
  buffer_load_dwordx4 v[68:71], v2, s[8:11], s31 offen offset:1024
  buffer_load_dwordx4 v[80:83], v2, s[8:11], s30 offen offset:2048
  buffer_load_dwordx4 v[84:87], v2, s[8:11], s31 offen offset:2048
  buffer_load_dwordx4 v[96:99], v2, s[8:11], s30 offen offset:3072
  buffer_load_dwordx4 v[100:103], v2, s[8:11], s31 offen offset:3072
  s_add_u32 s30, s30, 4096
  s_add_u32 s31, s31, 4096
  buffer_load_dwordx4 v[112:115], v2, s[8:11], s30 offen offset:0
  buffer_load_dwordx4 v[116:119], v2, s[8:11], s31 offen offset:0
  buffer_load_dwordx4 v[128:131], v2, s[8:11], s30 offen offset:1024
  buffer_load_dwordx4 v[132:135], v2, s[8:11], s31 offen offset:1024
  buffer_load_dwordx4 v[144:147], v2, s[8:11], s30 offen offset:2048
  buffer_load_dwordx4 v[148:151], v2, s[8:11], s31 offen offset:2048
  buffer_load_dwordx4 v[160:163], v2, s[8:11], s30 offen offset:3072
  buffer_load_dwordx4 v[164:167], v2, s[8:11], s31 offen offset:3072
  s_add_u32 s30, s30, 4096
  s_add_u32 s31, s31, 4096
  buffer_load_dwordx4 v[176:179], v2, s[8:11], s30 offen offset:0
  buffer_load_dwordx4 v[180:183], v2, s[8:11], s31 offen offset:0
  buffer_load_dwordx4 v[192:195], v2, s[8:11], s30 offen offset:1024
  buffer_load_dwordx4 v[196:199], v2, s[8:11], s31 offen offset:1024
  buffer_load_dwordx4 v[208:211], v2, s[8:11], s30 offen offset:2048
  buffer_load_dwordx4 v[212:215], v2, s[8:11], s31 offen offset:2048
  buffer_load_dwordx4 v[224:227], v2, s[8:11], s30 offen offset:3072
  buffer_load_dwordx4 v[228:231], v2, s[8:11], s31 offen offset:3072
  s_add_u32 s30, s30, 4096
  s_add_u32 s31, s31, 4096
  buffer_load_dwordx4 v[240:243], v2, s[8:11], s30 offen offset:0
  buffer_load_dwordx4 v[244:247], v2, s[8:11], s31 offen offset:0
  s_waitcnt vmcnt(24)
  v_mfma_f32_32x32x16_bf16 a[0:15], v[40:43], v[48:51], 0
  v_mfma_f32_32x32x16_bf16 a[16:31], v[40:43], v[52:55], 0
  v_mfma_f32_32x32x16_bf16 a[32:47], v[44:47], v[48:51], 0
  v_mfma_f32_32x32x16_bf16 a[48:63], v[44:47], v[52:55], 0
  buffer_load_dwordx4 v[40:43], v2, s[12:15], s32 offen offset:1024
  buffer_load_dwordx4 v[44:47], v2, s[12:15], s33 offen offset:1024
  buffer_load_dwordx4 v[48:51], v2, s[8:11], s30 offen offset:1024
  buffer_load_dwordx4 v[52:55], v2, s[8:11], s31 offen offset:1024
  s_waitcnt vmcnt(26)
  v_mfma_f32_32x32x16_bf16 a[0:15], v[56:59], v[64:67], a[0:15]
  v_mfma_f32_32x32x16_bf16 a[16:31], v[56:59], v[68:71], a[16:31]
  v_mfma_f32_32x32x16_bf16 a[32:47], v[60:63], v[64:67], a[32:47]
  v_mfma_f32_32x32x16_bf16 a[48:63], v[60:63], v[68:71], a[48:63]
  buffer_load_dwordx4 v[56:59], v2, s[12:15], s32 offen offset:2048
  buffer_load_dwordx4 v[60:63], v2, s[12:15], s33 offen offset:2048
  buffer_load_dwordx4 v[64:67], v2, s[8:11], s30 offen offset:2048
  buffer_load_dwordx4 v[68:71], v2, s[8:11], s31 offen offset:2048
  s_waitcnt vmcnt(28)
  v_mfma_f32_32x32x16_bf16 a[0:15], v[72:75], v[80:83], a[0:15]
  v_mfma_f32_32x32x16_bf16 a[16:31], v[72:75], v[84:87], a[16:31]
  v_mfma_f32_32x32x16_bf16 a[32:47], v[76:79], v[80:83], a[32:47]
  v_mfma_f32_32x32x16_bf16 a[48:63], v[76:79], v[84:87], a[48:63]
  buffer_load_dwordx4 v[72:75], v2, s[12:15], s32 offen offset:3072
  buffer_load_dwordx4 v[76:79], v2, s[12:15], s33 offen offset:3072
  buffer_load_dwordx4 v[80:83], v2, s[8:11], s30 offen offset:3072
  buffer_load_dwordx4 v[84:87], v2, s[8:11], s31 offen offset:3072
  s_waitcnt vmcnt(30)
  v_mfma_f32_32x32x16_bf16 a[0:15], v[88:91], v[96:99], a[0:15]
  v_mfma_f32_32x32x16_bf16 a[16:31], v[88:91], v[100:103], a[16:31]
  v_mfma_f32_32x32x16_bf16 a[32:47], v[92:95], v[96:99], a[32:47]
  v_mfma_f32_32x32x16_bf16 a[48:63], v[92:95], v[100:103], a[48:63]
  s_add_u32 s32, s32, 4096
  s_add_u32 s33, s33, 4096
  buffer_load_dwordx4 v[88:91], v2, s[12:15], s32 offen offset:0
  buffer_load_dwordx4 v[92:95], v2, s[12:15], s33 offen offset:0
  s_add_u32 s30, s30, 4096
  s_add_u32 s31, s31, 4096
  buffer_load_dwordx4 v[96:99], v2, s[8:11], s30 offen offset:0
  buffer_load_dwordx4 v[100:103], v2, s[8:11], s31 offen offset:0
  s_waitcnt vmcnt(32)
  v_mfma_f32_32x32x16_bf16 a[0:15], v[104:107], v[112:115], a[0:15]
  v_mfma_f32_32x32x16_bf16 a[16:31], v[104:107], v[116:119], a[16:31]
  v_mfma_f32_32x32x16_bf16 a[32:47], v[108:111], v[112:115], a[32:47]
  v_mfma_f32_32x32x16_bf16 a[48:63], v[108:111], v[116:119], a[48:63]
  buffer_load_dwordx4 v[104:107], v2, s[12:15], s32 offen offset:1024
  buffer_load_dwordx4 v[108:111], v2, s[12:15], s33 offen offset:1024
  buffer_load_dwordx4 v[112:115], v2, s[8:11], s30 offen offset:1024
  buffer_load_dwordx4 v[116:119], v2, s[8:11], s31 offen offset:1024
  s_waitcnt vmcnt(34)
  v_mfma_f32_32x32x16_bf16 a[0:15], v[120:123], v[128:131], a[0:15]
  v_mfma_f32_32x32x16_bf16 a[16:31], v[120:123], v[132:135], a[16:31]
  v_mfma_f32_32x32x16_bf16 a[32:47], v[124:127], v[128:131], a[32:47]
  v_mfma_f32_32x32x16_bf16 a[48:63], v[124:127], v[132:135], a[48:63]
  buffer_load_dwordx4 v[120:123], v2, s[12:15], s32 offen offset:2048
  buffer_load_dwordx4 v[124:127], v2, s[12:15], s33 offen offset:2048
  buffer_load_dwordx4 v[128:131], v2, s[8:11], s30 offen offset:2048
  buffer_load_dwordx4 v[132:135], v2, s[8:11], s31 offen offset:2048
  s_waitcnt vmcnt(36)
  v_mfma_f32_32x32x16_bf16 a[0:15], v[136:139], v[144:147], a[0:15]
  v_mfma_f32_32x32x16_bf16 a[16:31], v[136:139], v[148:151], a[16:31]
  v_mfma_f32_32x32x16_bf16 a[32:47], v[140:143], v[144:147], a[32:47]
  v_mfma_f32_32x32x16_bf16 a[48:63], v[140:143], v[148:151], a[48:63]
  buffer_load_dwordx4 v[136:139], v2, s[12:15], s32 offen offset:3072
  buffer_load_dwordx4 v[140:143], v2, s[12:15], s33 offen offset:3072
  buffer_load_dwordx4 v[144:147], v2, s[8:11], s30 offen offset:3072
  buffer_load_dwordx4 v[148:151], v2, s[8:11], s31 offen offset:3072
  s_waitcnt vmcnt(38)
  v_mfma_f32_32x32x16_bf16 a[0:15], v[152:155], v[160:163], a[0:15]
  v_mfma_f32_32x32x16_bf16 a[16:31], v[152:155], v[164:167], a[16:31]
  v_mfma_f32_32x32x16_bf16 a[32:47], v[156:159], v[160:163], a[32:47]
  v_mfma_f32_32x32x16_bf16 a[48:63], v[156:159], v[164:167], a[48:63]
  s_add_u32 s32, s32, 4096
  s_add_u32 s33, s33, 4096
  buffer_load_dwordx4 v[152:155], v2, s[12:15], s32 offen offset:0
  buffer_load_dwordx4 v[156:159], v2, s[12:15], s33 offen offset:0
  s_add_u32 s30, s30, 4096
  s_add_u32 s31, s31, 4096
  buffer_load_dwordx4 v[160:163], v2, s[8:11], s30 offen offset:0
  buffer_load_dwordx4 v[164:167], v2, s[8:11], s31 offen offset:0
  s_waitcnt vmcnt(40)
  v_mfma_f32_32x32x16_bf16 a[0:15], v[168:171], v[176:179], a[0:15]
  v_mfma_f32_32x32x16_bf16 a[16:31], v[168:171], v[180:183], a[16:31]
  v_mfma_f32_32x32x16_bf16 a[32:47], v[172:175], v[176:179], a[32:47]
  v_mfma_f32_32x32x16_bf16 a[48:63], v[172:175], v[180:183], a[48:63]
  buffer_load_dwordx4 v[168:171], v2, s[12:15], s32 offen offset:1024
  buffer_load_dwordx4 v[172:175], v2, s[12:15], s33 offen offset:1024
  buffer_load_dwordx4 v[176:179], v2, s[8:11], s30 offen offset:1024
  buffer_load_dwordx4 v[180:183], v2, s[8:11], s31 offen offset:1024
  s_waitcnt vmcnt(42)
  v_mfma_f32_32x32x16_bf16 a[0:15], v[184:187], v[192:195], a[0:15]
  v_mfma_f32_32x32x16_bf16 a[16:31], v[184:187], v[196:199], a[16:31]
  v_mfma_f32_32x32x16_bf16 a[32:47], v[188:191], v[192:195], a[32:47]
  v_mfma_f32_32x32x16_bf16 a[48:63], v[188:191], v[196:199], a[48:63]
  buffer_load_dwordx4 v[184:187], v2, s[12:15], s32 offen offset:2048
  buffer_load_dwordx4 v[188:191], v2, s[12:15], s33 offen offset:2048
  buffer_load_dwordx4 v[192:195], v2, s[8:11], s30 offen offset:2048
  buffer_load_dwordx4 v[196:199], v2, s[8:11], s31 offen offset:2048
  s_waitcnt vmcnt(44)
  v_mfma_f32_32x32x16_bf16 a[0:15], v[200:203], v[208:211], a[0:15]
  v_mfma_f32_32x32x16_bf16 a[16:31], v[200:203], v[212:215], a[16:31]
  v_mfma_f32_32x32x16_bf16 a[32:47], v[204:207], v[208:211], a[32:47]
  v_mfma_f32_32x32x16_bf16 a[48:63], v[204:207], v[212:215], a[48:63]
  buffer_load_dwordx4 v[200:203], v2, s[12:15], s32 offen offset:3072
  buffer_load_dwordx4 v[204:207], v2, s[12:15], s33 offen offset:3072
  buffer_load_dwordx4 v[208:211], v2, s[8:11], s30 offen offset:3072
  buffer_load_dwordx4 v[212:215], v2, s[8:11], s31 offen offset:3072
  s_waitcnt vmcnt(46)
  v_mfma_f32_32x32x16_bf16 a[0:15], v[216:219], v[224:227], a[0:15]
  v_mfma_f32_32x32x16_bf16 a[16:31], v[216:219], v[228:231], a[16:31]
  v_mfma_f32_32x32x16_bf16 a[32:47], v[220:223], v[224:227], a[32:47]
  v_mfma_f32_32x32x16_bf16 a[48:63], v[220:223], v[228:231], a[48:63]
  s_add_u32 s32, s32, 4096
  s_add_u32 s33, s33, 4096
  buffer_load_dwordx4 v[216:219], v2, s[12:15], s32 offen offset:0
  buffer_load_dwordx4 v[220:223], v2, s[12:15], s33 offen offset:0
  s_add_u32 s30, s30, 4096
  s_add_u32 s31, s31, 4096
  buffer_load_dwordx4 v[224:227], v2, s[8:11], s30 offen offset:0
  buffer_load_dwordx4 v[228:231], v2, s[8:11], s31 offen offset:0
  s_waitcnt vmcnt(48)
  v_mfma_f32_32x32x16_bf16 a[0:15], v[232:235], v[240:243], a[0:15]
  v_mfma_f32_32x32x16_bf16 a[16:31], v[232:235], v[244:247], a[16:31]
  v_mfma_f32_32x32x16_bf16 a[32:47], v[236:239], v[240:243], a[32:47]
  v_mfma_f32_32x32x16_bf16 a[48:63], v[236:239], v[244:247], a[48:63]
  buffer_load_dwordx4 v[232:235], v2, s[12:15], s32 offen offset:1024
  buffer_load_dwordx4 v[236:239], v2, s[12:15], s33 offen offset:1024
  buffer_load_dwordx4 v[240:243], v2, s[8:11], s30 offen offset:1024
  buffer_load_dwordx4 v[244:247], v2, s[8:11], s31 offen offset:1024
  s_waitcnt vmcnt(48)
  v_mfma_f32_32x32x16_bf16 a[0:15], v[40:43], v[48:51], a[0:15]
  v_mfma_f32_32x32x16_bf16 a[16:31], v[40:43], v[52:55], a[16:31]
  v_mfma_f32_32x32x16_bf16 a[32:47], v[44:47], v[48:51], a[32:47]
  v_mfma_f32_32x32x16_bf16 a[48:63], v[44:47], v[52:55], a[48:63]
  buffer_load_dwordx4 v[40:43], v2, s[12:15], s32 offen offset:2048
  buffer_load_dwordx4 v[44:47], v2, s[12:15], s33 offen offset:2048
  buffer_load_dwordx4 v[48:51], v2, s[8:11], s30 offen offset:2048
  buffer_load_dwordx4 v[52:55], v2, s[8:11], s31 offen offset:2048
  s_waitcnt vmcnt(48)
  v_mfma_f32_32x32x16_bf16 a[0:15], v[56:59], v[64:67], a[0:15]
  v_mfma_f32_32x32x16_bf16 a[16:31], v[56:59], v[68:71], a[16:31]
  v_mfma_f32_32x32x16_bf16 a[32:47], v[60:63], v[64:67], a[32:47]
  v_mfma_f32_32x32x16_bf16 a[48:63], v[60:63], v[68:71], a[48:63]
  buffer_load_dwordx4 v[56:59], v2, s[12:15], s32 offen offset:3072
  buffer_load_dwordx4 v[60:63], v2, s[12:15], s33 offen offset:3072
  buffer_load_dwordx4 v[64:67], v2, s[8:11], s30 offen offset:3072
  buffer_load_dwordx4 v[68:71], v2, s[8:11], s31 offen offset:3072
  s_waitcnt vmcnt(48)
  v_mfma_f32_32x32x16_bf16 a[0:15], v[72:75], v[80:83], a[0:15]
  v_mfma_f32_32x32x16_bf16 a[16:31], v[72:75], v[84:87], a[16:31]
  v_mfma_f32_32x32x16_bf16 a[32:47], v[76:79], v[80:83], a[32:47]
  v_mfma_f32_32x32x16_bf16 a[48:63], v[76:79], v[84:87], a[48:63]
  s_add_u32 s32, s32, 4096
  s_add_u32 s33, s33, 4096
  buffer_load_dwordx4 v[72:75], v2, s[12:15], s32 offen offset:0
  buffer_load_dwordx4 v[76:79], v2, s[12:15], s33 offen offset:0
  s_add_u32 s30, s30, 4096
  s_add_u32 s31, s31, 4096
  buffer_load_dwordx4 v[80:83], v2, s[8:11], s30 offen offset:0
  buffer_load_dwordx4 v[84:87], v2, s[8:11], s31 offen offset:0
  s_waitcnt vmcnt(48)
  v_mfma_f32_32x32x16_bf16 a[0:15], v[88:91], v[96:99], a[0:15]
  v_mfma_f32_32x32x16_bf16 a[16:31], v[88:91], v[100:103], a[16:31]
  v_mfma_f32_32x32x16_bf16 a[32:47], v[92:95], v[96:99], a[32:47]
  v_mfma_f32_32x32x16_bf16 a[48:63], v[92:95], v[100:103], a[48:63]
  buffer_load_dwordx4 v[88:91], v2, s[12:15], s32 offen offset:1024
  buffer_load_dwordx4 v[92:95], v2, s[12:15], s33 offen offset:1024
  buffer_load_dwordx4 v[96:99], v2, s[8:11], s30 offen offset:1024
  buffer_load_dwordx4 v[100:103], v2, s[8:11], s31 offen offset:1024
  s_waitcnt vmcnt(48)
  v_mfma_f32_32x32x16_bf16 a[0:15], v[104:107], v[112:115], a[0:15]
  v_mfma_f32_32x32x16_bf16 a[16:31], v[104:107], v[116:119], a[16:31]
  v_mfma_f32_32x32x16_bf16 a[32:47], v[108:111], v[112:115], a[32:47]
  v_mfma_f32_32x32x16_bf16 a[48:63], v[108:111], v[116:119], a[48:63]
  buffer_load_dwordx4 v[104:107], v2, s[12:15], s32 offen offset:2048
  buffer_load_dwordx4 v[108:111], v2, s[12:15], s33 offen offset:2048
  buffer_load_dwordx4 v[112:115], v2, s[8:11], s30 offen offset:2048
  buffer_load_dwordx4 v[116:119], v2, s[8:11], s31 offen offset:2048
  s_waitcnt vmcnt(48)
  v_mfma_f32_32x32x16_bf16 a[0:15], v[120:123], v[128:131], a[0:15]
  v_mfma_f32_32x32x16_bf16 a[16:31], v[120:123], v[132:135], a[16:31]
  v_mfma_f32_32x32x16_bf16 a[32:47], v[124:127], v[128:131], a[32:47]
  v_mfma_f32_32x32x16_bf16 a[48:63], v[124:127], v[132:135], a[48:63]
  buffer_load_dwordx4 v[120:123], v2, s[12:15], s32 offen offset:3072
  buffer_load_dwordx4 v[124:127], v2, s[12:15], s33 offen offset:3072
  buffer_load_dwordx4 v[128:131], v2, s[8:11], s30 offen offset:3072
  buffer_load_dwordx4 v[132:135], v2, s[8:11], s31 offen offset:3072
  s_waitcnt vmcnt(48)
  v_mfma_f32_32x32x16_bf16 a[0:15], v[136:139], v[144:147], a[0:15]
  v_mfma_f32_32x32x16_bf16 a[16:31], v[136:139], v[148:151], a[16:31]
  v_mfma_f32_32x32x16_bf16 a[32:47], v[140:143], v[144:147], a[32:47]
  v_mfma_f32_32x32x16_bf16 a[48:63], v[140:143], v[148:151], a[48:63]
  s_add_u32 s32, s32, 4096
  s_add_u32 s33, s33, 4096
  buffer_load_dwordx4 v[136:139], v2, s[12:15], s32 offen offset:0
  buffer_load_dwordx4 v[140:143], v2, s[12:15], s33 offen offset:0
  s_add_u32 s30, s30, 4096
  s_add_u32 s31, s31, 4096
  buffer_load_dwordx4 v[144:147], v2, s[8:11], s30 offen offset:0
  buffer_load_dwordx4 v[148:151], v2, s[8:11], s31 offen offset:0
  s_waitcnt vmcnt(48)
  v_mfma_f32_32x32x16_bf16 a[0:15], v[152:155], v[160:163], a[0:15]
  v_mfma_f32_32x32x16_bf16 a[16:31], v[152:155], v[164:167], a[16:31]
  v_mfma_f32_32x32x16_bf16 a[32:47], v[156:159], v[160:163], a[32:47]
  v_mfma_f32_32x32x16_bf16 a[48:63], v[156:159], v[164:167], a[48:63]
  buffer_load_dwordx4 v[152:155], v2, s[12:15], s32 offen offset:1024
  buffer_load_dwordx4 v[156:159], v2, s[12:15], s33 offen offset:1024
  buffer_load_dwordx4 v[160:163], v2, s[8:11], s30 offen offset:1024
  buffer_load_dwordx4 v[164:167], v2, s[8:11], s31 offen offset:1024
  s_waitcnt vmcnt(48)
  v_mfma_f32_32x32x16_bf16 a[0:15], v[168:171], v[176:179], a[0:15]
  v_mfma_f32_32x32x16_bf16 a[16:31], v[168:171], v[180:183], a[16:31]
  v_mfma_f32_32x32x16_bf16 a[32:47], v[172:175], v[176:179], a[32:47]
  v_mfma_f32_32x32x16_bf16 a[48:63], v[172:175], v[180:183], a[48:63]
  buffer_load_dwordx4 v[168:171], v2, s[12:15], s32 offen offset:2048
  buffer_load_dwordx4 v[172:175], v2, s[12:15], s33 offen offset:2048
  buffer_load_dwordx4 v[176:179], v2, s[8:11], s30 offen offset:2048
  buffer_load_dwordx4 v[180:183], v2, s[8:11], s31 offen offset:2048
  s_waitcnt vmcnt(48)
  v_mfma_f32_32x32x16_bf16 a[0:15], v[184:187], v[192:195], a[0:15]
  v_mfma_f32_32x32x16_bf16 a[16:31], v[184:187], v[196:199], a[16:31]
  v_mfma_f32_32x32x16_bf16 a[32:47], v[188:191], v[192:195], a[32:47]
  v_mfma_f32_32x32x16_bf16 a[48:63], v[188:191], v[196:199], a[48:63]
  buffer_load_dwordx4 v[184:187], v2, s[12:15], s32 offen offset:3072
  buffer_load_dwordx4 v[188:191], v2, s[12:15], s33 offen offset:3072
  buffer_load_dwordx4 v[192:195], v2, s[8:11], s30 offen offset:3072
  buffer_load_dwordx4 v[196:199], v2, s[8:11], s31 offen offset:3072
  s_waitcnt vmcnt(48)
  v_mfma_f32_32x32x16_bf16 a[0:15], v[200:203], v[208:211], a[0:15]
  v_mfma_f32_32x32x16_bf16 a[16:31], v[200:203], v[212:215], a[16:31]
  v_mfma_f32_32x32x16_bf16 a[32:47], v[204:207], v[208:211], a[32:47]
  v_mfma_f32_32x32x16_bf16 a[48:63], v[204:207], v[212:215], a[48:63]
  s_add_u32 s32, s32, 4096
  s_add_u32 s33, s33, 4096
  buffer_load_dwordx4 v[200:203], v2, s[12:15], s32 offen offset:0
  buffer_load_dwordx4 v[204:207], v2, s[12:15], s33 offen offset:0
  s_add_u32 s30, s30, 4096
  s_add_u32 s31, s31, 4096
  buffer_load_dwordx4 v[208:211], v2, s[8:11], s30 offen offset:0
  buffer_load_dwordx4 v[212:215], v2, s[8:11], s31 offen offset:0
  s_waitcnt vmcnt(48)
  v_mfma_f32_32x32x16_bf16 a[0:15], v[216:219], v[224:227], a[0:15]
  v_mfma_f32_32x32x16_bf16 a[16:31], v[216:219], v[228:231], a[16:31]
  v_mfma_f32_32x32x16_bf16 a[32:47], v[220:223], v[224:227], a[32:47]
  v_mfma_f32_32x32x16_bf16 a[48:63], v[220:223], v[228:231], a[48:63]
  buffer_load_dwordx4 v[216:219], v2, s[12:15], s32 offen offset:1024
  buffer_load_dwordx4 v[220:223], v2, s[12:15], s33 offen offset:1024
  buffer_load_dwordx4 v[224:227], v2, s[8:11], s30 offen offset:1024
  buffer_load_dwordx4 v[228:231], v2, s[8:11], s31 offen offset:1024
  s_waitcnt vmcnt(48)
  v_mfma_f32_32x32x16_bf16 a[0:15], v[232:235], v[240:243], a[0:15]
  v_mfma_f32_32x32x16_bf16 a[16:31], v[232:235], v[244:247], a[16:31]
  v_mfma_f32_32x32x16_bf16 a[32:47], v[236:239], v[240:243], a[32:47]
  v_mfma_f32_32x32x16_bf16 a[48:63], v[236:239], v[244:247], a[48:63]
  buffer_load_dwordx4 v[232:235], v2, s[12:15], s32 offen offset:2048
  buffer_load_dwordx4 v[236:239], v2, s[12:15], s33 offen offset:2048
  buffer_load_dwordx4 v[240:243], v2, s[8:11], s30 offen offset:2048
  buffer_load_dwordx4 v[244:247], v2, s[8:11], s31 offen offset:2048
  s_waitcnt vmcnt(48)
  v_mfma_f32_32x32x16_bf16 a[0:15], v[40:43], v[48:51], a[0:15]
  v_mfma_f32_32x32x16_bf16 a[16:31], v[40:43], v[52:55], a[16:31]
  v_mfma_f32_32x32x16_bf16 a[32:47], v[44:47], v[48:51], a[32:47]
  v_mfma_f32_32x32x16_bf16 a[48:63], v[44:47], v[52:55], a[48:63]
  buffer_load_dwordx4 v[40:43], v2, s[12:15], s32 offen offset:3072
  buffer_load_dwordx4 v[44:47], v2, s[12:15], s33 offen offset:3072
  buffer_load_dwordx4 v[48:51], v2, s[8:11], s30 offen offset:3072
  buffer_load_dwordx4 v[52:55], v2, s[8:11], s31 offen offset:3072
  s_waitcnt vmcnt(48)
  v_mfma_f32_32x32x16_bf16 a[0:15], v[56:59], v[64:67], a[0:15]
  v_mfma_f32_32x32x16_bf16 a[16:31], v[56:59], v[68:71], a[16:31]
  v_mfma_f32_32x32x16_bf16 a[32:47], v[60:63], v[64:67], a[32:47]
  v_mfma_f32_32x32x16_bf16 a[48:63], v[60:63], v[68:71], a[48:63]
  s_add_u32 s32, s32, 4096
  s_add_u32 s33, s33, 4096
  buffer_load_dwordx4 v[56:59], v2, s[12:15], s32 offen offset:0
  buffer_load_dwordx4 v[60:63], v2, s[12:15], s33 offen offset:0
  s_add_u32 s30, s30, 4096
  s_add_u32 s31, s31, 4096
  buffer_load_dwordx4 v[64:67], v2, s[8:11], s30 offen offset:0
  buffer_load_dwordx4 v[68:71], v2, s[8:11], s31 offen offset:0
  v_lshlrev_b32 v38, 7, v1
  s_mov_b32 s39, 131084
  s_add_u32 s38, s39, 0
  buffer_load_dword v34, v38, s[20:23], s38 offen sc1
  s_add_u32 s38, s39, 8192
  buffer_load_dword v35, v38, s[20:23], s38 offen sc1
  s_add_u32 s38, s39, 16384
  buffer_load_dword v36, v38, s[20:23], s38 offen sc1
  s_add_u32 s38, s39, 24576
  buffer_load_dword v37, v38, s[20:23], s38 offen sc1
  s_waitcnt vmcnt(52)
  v_mfma_f32_32x32x16_bf16 a[0:15], v[72:75], v[80:83], a[0:15]
  v_mfma_f32_32x32x16_bf16 a[16:31], v[72:75], v[84:87], a[16:31]
  v_mfma_f32_32x32x16_bf16 a[32:47], v[76:79], v[80:83], a[32:47]
  v_mfma_f32_32x32x16_bf16 a[48:63], v[76:79], v[84:87], a[48:63]
  buffer_load_dwordx4 v[72:75], v2, s[12:15], s32 offen offset:1024
  buffer_load_dwordx4 v[76:79], v2, s[12:15], s33 offen offset:1024
  buffer_load_dwordx4 v[80:83], v2, s[8:11], s30 offen offset:1024
  buffer_load_dwordx4 v[84:87], v2, s[8:11], s31 offen offset:1024
  s_waitcnt vmcnt(52)
  v_mfma_f32_32x32x16_bf16 a[0:15], v[88:91], v[96:99], a[0:15]
  v_mfma_f32_32x32x16_bf16 a[16:31], v[88:91], v[100:103], a[16:31]
  v_mfma_f32_32x32x16_bf16 a[32:47], v[92:95], v[96:99], a[32:47]
  v_mfma_f32_32x32x16_bf16 a[48:63], v[92:95], v[100:103], a[48:63]
  buffer_load_dwordx4 v[88:91], v2, s[12:15], s32 offen offset:2048
  buffer_load_dwordx4 v[92:95], v2, s[12:15], s33 offen offset:2048
  buffer_load_dwordx4 v[96:99], v2, s[8:11], s30 offen offset:2048
  buffer_load_dwordx4 v[100:103], v2, s[8:11], s31 offen offset:2048
  s_waitcnt vmcnt(52)
  v_mfma_f32_32x32x16_bf16 a[0:15], v[104:107], v[112:115], a[0:15]
  v_mfma_f32_32x32x16_bf16 a[16:31], v[104:107], v[116:119], a[16:31]
  v_mfma_f32_32x32x16_bf16 a[32:47], v[108:111], v[112:115], a[32:47]
  v_mfma_f32_32x32x16_bf16 a[48:63], v[108:111], v[116:119], a[48:63]
  buffer_load_dwordx4 v[104:107], v2, s[12:15], s32 offen offset:3072
  buffer_load_dwordx4 v[108:111], v2, s[12:15], s33 offen offset:3072
  buffer_load_dwordx4 v[112:115], v2, s[8:11], s30 offen offset:3072
  buffer_load_dwordx4 v[116:119], v2, s[8:11], s31 offen offset:3072
  s_waitcnt vmcnt(52)
  v_mfma_f32_32x32x16_bf16 a[0:15], v[120:123], v[128:131], a[0:15]
  v_mfma_f32_32x32x16_bf16 a[16:31], v[120:123], v[132:135], a[16:31]
  v_mfma_f32_32x32x16_bf16 a[32:47], v[124:127], v[128:131], a[32:47]
  v_mfma_f32_32x32x16_bf16 a[48:63], v[124:127], v[132:135], a[48:63]
  s_add_u32 s32, s32, 4096
  s_add_u32 s33, s33, 4096
  buffer_load_dwordx4 v[120:123], v2, s[12:15], s32 offen offset:0
  buffer_load_dwordx4 v[124:127], v2, s[12:15], s33 offen offset:0
  s_add_u32 s30, s30, 4096
  s_add_u32 s31, s31, 4096
  buffer_load_dwordx4 v[128:131], v2, s[8:11], s30 offen offset:0
  buffer_load_dwordx4 v[132:135], v2, s[8:11], s31 offen offset:0
  s_waitcnt vmcnt(52)
  v_mfma_f32_32x32x16_bf16 a[0:15], v[136:139], v[144:147], a[0:15]
  v_mfma_f32_32x32x16_bf16 a[16:31], v[136:139], v[148:151], a[16:31]
  v_mfma_f32_32x32x16_bf16 a[32:47], v[140:143], v[144:147], a[32:47]
  v_mfma_f32_32x32x16_bf16 a[48:63], v[140:143], v[148:151], a[48:63]
  buffer_load_dwordx4 v[136:139], v2, s[12:15], s32 offen offset:1024
  buffer_load_dwordx4 v[140:143], v2, s[12:15], s33 offen offset:1024
  buffer_load_dwordx4 v[144:147], v2, s[8:11], s30 offen offset:1024
  buffer_load_dwordx4 v[148:151], v2, s[8:11], s31 offen offset:1024
  s_waitcnt vmcnt(52)
  v_mfma_f32_32x32x16_bf16 a[0:15], v[152:155], v[160:163], a[0:15]
  v_mfma_f32_32x32x16_bf16 a[16:31], v[152:155], v[164:167], a[16:31]
  v_mfma_f32_32x32x16_bf16 a[32:47], v[156:159], v[160:163], a[32:47]
  v_mfma_f32_32x32x16_bf16 a[48:63], v[156:159], v[164:167], a[48:63]
  buffer_load_dwordx4 v[152:155], v2, s[12:15], s32 offen offset:2048
  buffer_load_dwordx4 v[156:159], v2, s[12:15], s33 offen offset:2048
  buffer_load_dwordx4 v[160:163], v2, s[8:11], s30 offen offset:2048
  buffer_load_dwordx4 v[164:167], v2, s[8:11], s31 offen offset:2048
  s_waitcnt vmcnt(52)
  v_mfma_f32_32x32x16_bf16 a[0:15], v[168:171], v[176:179], a[0:15]
  v_mfma_f32_32x32x16_bf16 a[16:31], v[168:171], v[180:183], a[16:31]
  v_mfma_f32_32x32x16_bf16 a[32:47], v[172:175], v[176:179], a[32:47]
  v_mfma_f32_32x32x16_bf16 a[48:63], v[172:175], v[180:183], a[48:63]
  buffer_load_dwordx4 v[168:171], v2, s[12:15], s32 offen offset:3072
  buffer_load_dwordx4 v[172:175], v2, s[12:15], s33 offen offset:3072
  buffer_load_dwordx4 v[176:179], v2, s[8:11], s30 offen offset:3072
  buffer_load_dwordx4 v[180:183], v2, s[8:11], s31 offen offset:3072
  s_waitcnt vmcnt(52)
  v_mfma_f32_32x32x16_bf16 a[0:15], v[184:187], v[192:195], a[0:15]
  v_mfma_f32_32x32x16_bf16 a[16:31], v[184:187], v[196:199], a[16:31]
  v_mfma_f32_32x32x16_bf16 a[32:47], v[188:191], v[192:195], a[32:47]
  v_mfma_f32_32x32x16_bf16 a[48:63], v[188:191], v[196:199], a[48:63]
  s_add_u32 s32, s32, 4096
  s_add_u32 s33, s33, 4096
  buffer_load_dwordx4 v[184:187], v2, s[12:15], s32 offen offset:0
  buffer_load_dwordx4 v[188:191], v2, s[12:15], s33 offen offset:0
  s_add_u32 s30, s30, 4096
  s_add_u32 s31, s31, 4096
  buffer_load_dwordx4 v[192:195], v2, s[8:11], s30 offen offset:0
  buffer_load_dwordx4 v[196:199], v2, s[8:11], s31 offen offset:0
  s_waitcnt vmcnt(52)
  v_mfma_f32_32x32x16_bf16 a[0:15], v[200:203], v[208:211], a[0:15]
  v_mfma_f32_32x32x16_bf16 a[16:31], v[200:203], v[212:215], a[16:31]
  v_mfma_f32_32x32x16_bf16 a[32:47], v[204:207], v[208:211], a[32:47]
  v_mfma_f32_32x32x16_bf16 a[48:63], v[204:207], v[212:215], a[48:63]
  buffer_load_dwordx4 v[200:203], v2, s[12:15], s32 offen offset:1024
  buffer_load_dwordx4 v[204:207], v2, s[12:15], s33 offen offset:1024
  buffer_load_dwordx4 v[208:211], v2, s[8:11], s30 offen offset:1024
  buffer_load_dwordx4 v[212:215], v2, s[8:11], s31 offen offset:1024
  s_waitcnt vmcnt(52)
  v_mfma_f32_32x32x16_bf16 a[0:15], v[216:219], v[224:227], a[0:15]
  v_mfma_f32_32x32x16_bf16 a[16:31], v[216:219], v[228:231], a[16:31]
  v_mfma_f32_32x32x16_bf16 a[32:47], v[220:223], v[224:227], a[32:47]
  v_mfma_f32_32x32x16_bf16 a[48:63], v[220:223], v[228:231], a[48:63]
  buffer_load_dwordx4 v[216:219], v2, s[12:15], s32 offen offset:2048
  buffer_load_dwordx4 v[220:223], v2, s[12:15], s33 offen offset:2048
  buffer_load_dwordx4 v[224:227], v2, s[8:11], s30 offen offset:2048
  buffer_load_dwordx4 v[228:231], v2, s[8:11], s31 offen offset:2048
  s_waitcnt vmcnt(52)
  v_mfma_f32_32x32x16_bf16 a[0:15], v[232:235], v[240:243], a[0:15]
  v_mfma_f32_32x32x16_bf16 a[16:31], v[232:235], v[244:247], a[16:31]
  v_mfma_f32_32x32x16_bf16 a[32:47], v[236:239], v[240:243], a[32:47]
  v_mfma_f32_32x32x16_bf16 a[48:63], v[236:239], v[244:247], a[48:63]
  buffer_load_dwordx4 v[232:235], v2, s[12:15], s32 offen offset:3072
  buffer_load_dwordx4 v[236:239], v2, s[12:15], s33 offen offset:3072
  buffer_load_dwordx4 v[240:243], v2, s[8:11], s30 offen offset:3072
  buffer_load_dwordx4 v[244:247], v2, s[8:11], s31 offen offset:3072
  s_waitcnt vmcnt(52)
  v_mfma_f32_32x32x16_bf16 a[0:15], v[40:43], v[48:51], a[0:15]
  v_mfma_f32_32x32x16_bf16 a[16:31], v[40:43], v[52:55], a[16:31]
  v_mfma_f32_32x32x16_bf16 a[32:47], v[44:47], v[48:51], a[32:47]
  v_mfma_f32_32x32x16_bf16 a[48:63], v[44:47], v[52:55], a[48:63]
  s_add_u32 s32, s32, 4096
  s_add_u32 s33, s33, 4096
  buffer_load_dwordx4 v[40:43], v2, s[12:15], s32 offen offset:0
  buffer_load_dwordx4 v[44:47], v2, s[12:15], s33 offen offset:0
  s_add_u32 s30, s30, 4096
  s_add_u32 s31, s31, 4096
  buffer_load_dwordx4 v[48:51], v2, s[8:11], s30 offen offset:0
  buffer_load_dwordx4 v[52:55], v2, s[8:11], s31 offen offset:0
  s_waitcnt vmcnt(52)
  v_mfma_f32_32x32x16_bf16 a[0:15], v[56:59], v[64:67], a[0:15]
  v_mfma_f32_32x32x16_bf16 a[16:31], v[56:59], v[68:71], a[16:31]
  v_mfma_f32_32x32x16_bf16 a[32:47], v[60:63], v[64:67], a[32:47]
  v_mfma_f32_32x32x16_bf16 a[48:63], v[60:63], v[68:71], a[48:63]
  buffer_load_dwordx4 v[56:59], v2, s[12:15], s32 offen offset:1024
  buffer_load_dwordx4 v[60:63], v2, s[12:15], s33 offen offset:1024
  buffer_load_dwordx4 v[64:67], v2, s[8:11], s30 offen offset:1024
  buffer_load_dwordx4 v[68:71], v2, s[8:11], s31 offen offset:1024
  s_waitcnt vmcnt(48)
  v_mfma_f32_32x32x16_bf16 a[0:15], v[72:75], v[80:83], a[0:15]
  v_mfma_f32_32x32x16_bf16 a[16:31], v[72:75], v[84:87], a[16:31]
  v_mfma_f32_32x32x16_bf16 a[32:47], v[76:79], v[80:83], a[32:47]
  v_mfma_f32_32x32x16_bf16 a[48:63], v[76:79], v[84:87], a[48:63]
  buffer_load_dwordx4 v[72:75], v2, s[12:15], s32 offen offset:2048
  buffer_load_dwordx4 v[76:79], v2, s[12:15], s33 offen offset:2048
  buffer_load_dwordx4 v[80:83], v2, s[8:11], s30 offen offset:2048
  buffer_load_dwordx4 v[84:87], v2, s[8:11], s31 offen offset:2048
  s_waitcnt vmcnt(48)
  v_mfma_f32_32x32x16_bf16 a[0:15], v[88:91], v[96:99], a[0:15]
  v_mfma_f32_32x32x16_bf16 a[16:31], v[88:91], v[100:103], a[16:31]
  v_mfma_f32_32x32x16_bf16 a[32:47], v[92:95], v[96:99], a[32:47]
  v_mfma_f32_32x32x16_bf16 a[48:63], v[92:95], v[100:103], a[48:63]
  buffer_load_dwordx4 v[88:91], v2, s[12:15], s32 offen offset:3072
  buffer_load_dwordx4 v[92:95], v2, s[12:15], s33 offen offset:3072
  buffer_load_dwordx4 v[96:99], v2, s[8:11], s30 offen offset:3072
  buffer_load_dwordx4 v[100:103], v2, s[8:11], s31 offen offset:3072
  s_waitcnt vmcnt(48)
  v_mfma_f32_32x32x16_bf16 a[0:15], v[104:107], v[112:115], a[0:15]
  v_mfma_f32_32x32x16_bf16 a[16:31], v[104:107], v[116:119], a[16:31]
  v_mfma_f32_32x32x16_bf16 a[32:47], v[108:111], v[112:115], a[32:47]
  v_mfma_f32_32x32x16_bf16 a[48:63], v[108:111], v[116:119], a[48:63]
  s_add_u32 s32, s32, 4096
  s_add_u32 s33, s33, 4096
  buffer_load_dwordx4 v[104:107], v2, s[12:15], s32 offen offset:0
  buffer_load_dwordx4 v[108:111], v2, s[12:15], s33 offen offset:0
  s_add_u32 s30, s30, 4096
  s_add_u32 s31, s31, 4096
  buffer_load_dwordx4 v[112:115], v2, s[8:11], s30 offen offset:0
  buffer_load_dwordx4 v[116:119], v2, s[8:11], s31 offen offset:0
  s_waitcnt vmcnt(63)
  v_and_b32 v34, v34, v35
  v_and_b32 v36, v36, v37
  v_and_b32 v34, v34, v36
  v_cmp_ne_u32 vcc, 1, v34
  s_mov_b32 s38, 1
  s_nop 3
  s_cbranch_vccnz D_ylate
  s_mov_b32 s38, 0
  v_bfe_u32 v249, v0, 4, 3
  v_lshlrev_b32 v249, 11, v249
  v_and_b32 v253, 15, v0
  v_lshl_add_u32 v249, v253, 4, v249
  s_lshl_b32 s34, s29, 8
  s_add_u32 s34, s34, 32768
  buffer_load_dwordx4 v[18:21], v249, s[20:23], s34 offen sc1
D_ylate:
  s_waitcnt vmcnt(48)
  v_mfma_f32_32x32x16_bf16 a[0:15], v[120:123], v[128:131], a[0:15]
  v_mfma_f32_32x32x16_bf16 a[16:31], v[120:123], v[132:135], a[16:31]
  v_mfma_f32_32x32x16_bf16 a[32:47], v[124:127], v[128:131], a[32:47]
  v_mfma_f32_32x32x16_bf16 a[48:63], v[124:127], v[132:135], a[48:63]
  buffer_load_dwordx4 v[120:123], v2, s[12:15], s32 offen offset:1024
  buffer_load_dwordx4 v[124:127], v2, s[12:15], s33 offen offset:1024
  buffer_load_dwordx4 v[128:131], v2, s[8:11], s30 offen offset:1024
  buffer_load_dwordx4 v[132:135], v2, s[8:11], s31 offen offset:1024
  s_waitcnt vmcnt(48)
  v_mfma_f32_32x32x16_bf16 a[0:15], v[136:139], v[144:147], a[0:15]
  v_mfma_f32_32x32x16_bf16 a[16:31], v[136:139], v[148:151], a[16:31]
  v_mfma_f32_32x32x16_bf16 a[32:47], v[140:143], v[144:147], a[32:47]
  v_mfma_f32_32x32x16_bf16 a[48:63], v[140:143], v[148:151], a[48:63]
  buffer_load_dwordx4 v[136:139], v2, s[12:15], s32 offen offset:2048
  buffer_load_dwordx4 v[140:143], v2, s[12:15], s33 offen offset:2048
  buffer_load_dwordx4 v[144:147], v2, s[8:11], s30 offen offset:2048
  buffer_load_dwordx4 v[148:151], v2, s[8:11], s31 offen offset:2048
  s_waitcnt vmcnt(48)
  v_mfma_f32_32x32x16_bf16 a[0:15], v[152:155], v[160:163], a[0:15]
  v_mfma_f32_32x32x16_bf16 a[16:31], v[152:155], v[164:167], a[16:31]
  v_mfma_f32_32x32x16_bf16 a[32:47], v[156:159], v[160:163], a[32:47]
  v_mfma_f32_32x32x16_bf16 a[48:63], v[156:159], v[164:167], a[48:63]
  buffer_load_dwordx4 v[152:155], v2, s[12:15], s32 offen offset:3072
  buffer_load_dwordx4 v[156:159], v2, s[12:15], s33 offen offset:3072
  buffer_load_dwordx4 v[160:163], v2, s[8:11], s30 offen offset:3072
  buffer_load_dwordx4 v[164:167], v2, s[8:11], s31 offen offset:3072
  s_waitcnt vmcnt(48)
  v_mfma_f32_32x32x16_bf16 a[0:15], v[168:171], v[176:179], a[0:15]
  v_mfma_f32_32x32x16_bf16 a[16:31], v[168:171], v[180:183], a[16:31]
  v_mfma_f32_32x32x16_bf16 a[32:47], v[172:175], v[176:179], a[32:47]
  v_mfma_f32_32x32x16_bf16 a[48:63], v[172:175], v[180:183], a[48:63]
  s_add_u32 s32, s32, 4096
  s_add_u32 s33, s33, 4096
  buffer_load_dwordx4 v[168:171], v2, s[12:15], s32 offen offset:0
  buffer_load_dwordx4 v[172:175], v2, s[12:15], s33 offen offset:0
  s_add_u32 s30, s30, 4096
  s_add_u32 s31, s31, 4096
  buffer_load_dwordx4 v[176:179], v2, s[8:11], s30 offen offset:0
  buffer_load_dwordx4 v[180:183], v2, s[8:11], s31 offen offset:0
  s_waitcnt vmcnt(48)
  v_mfma_f32_32x32x16_bf16 a[0:15], v[184:187], v[192:195], a[0:15]
  v_mfma_f32_32x32x16_bf16 a[16:31], v[184:187], v[196:199], a[16:31]
  v_mfma_f32_32x32x16_bf16 a[32:47], v[188:191], v[192:195], a[32:47]
  v_mfma_f32_32x32x16_bf16 a[48:63], v[188:191], v[196:199], a[48:63]
  buffer_load_dwordx4 v[184:187], v2, s[12:15], s32 offen offset:1024
  buffer_load_dwordx4 v[188:191], v2, s[12:15], s33 offen offset:1024
  buffer_load_dwordx4 v[192:195], v2, s[8:11], s30 offen offset:1024
  buffer_load_dwordx4 v[196:199], v2, s[8:11], s31 offen offset:1024
  s_waitcnt vmcnt(48)
  v_mfma_f32_32x32x16_bf16 a[0:15], v[200:203], v[208:211], a[0:15]
  v_mfma_f32_32x32x16_bf16 a[16:31], v[200:203], v[212:215], a[16:31]
  v_mfma_f32_32x32x16_bf16 a[32:47], v[204:207], v[208:211], a[32:47]
  v_mfma_f32_32x32x16_bf16 a[48:63], v[204:207], v[212:215], a[48:63]
  buffer_load_dwordx4 v[200:203], v2, s[12:15], s32 offen offset:2048
  buffer_load_dwordx4 v[204:207], v2, s[12:15], s33 offen offset:2048
  buffer_load_dwordx4 v[208:211], v2, s[8:11], s30 offen offset:2048
  buffer_load_dwordx4 v[212:215], v2, s[8:11], s31 offen offset:2048
  s_waitcnt vmcnt(48)
  v_mfma_f32_32x32x16_bf16 a[0:15], v[216:219], v[224:227], a[0:15]
  v_mfma_f32_32x32x16_bf16 a[16:31], v[216:219], v[228:231], a[16:31]
  v_mfma_f32_32x32x16_bf16 a[32:47], v[220:223], v[224:227], a[32:47]
  v_mfma_f32_32x32x16_bf16 a[48:63], v[220:223], v[228:231], a[48:63]
  buffer_load_dwordx4 v[216:219], v2, s[12:15], s32 offen offset:3072
  buffer_load_dwordx4 v[220:223], v2, s[12:15], s33 offen offset:3072
  buffer_load_dwordx4 v[224:227], v2, s[8:11], s30 offen offset:3072
  buffer_load_dwordx4 v[228:231], v2, s[8:11], s31 offen offset:3072
  s_waitcnt vmcnt(48)
  v_mfma_f32_32x32x16_bf16 a[0:15], v[232:235], v[240:243], a[0:15]
  v_mfma_f32_32x32x16_bf16 a[16:31], v[232:235], v[244:247], a[16:31]
  v_mfma_f32_32x32x16_bf16 a[32:47], v[236:239], v[240:243], a[32:47]
  v_mfma_f32_32x32x16_bf16 a[48:63], v[236:239], v[244:247], a[48:63]
  s_waitcnt vmcnt(44)
  v_mfma_f32_32x32x16_bf16 a[0:15], v[40:43], v[48:51], a[0:15]
  v_mfma_f32_32x32x16_bf16 a[16:31], v[40:43], v[52:55], a[16:31]
  v_mfma_f32_32x32x16_bf16 a[32:47], v[44:47], v[48:51], a[32:47]
  v_mfma_f32_32x32x16_bf16 a[48:63], v[44:47], v[52:55], a[48:63]
  s_waitcnt vmcnt(40)
  v_mfma_f32_32x32x16_bf16 a[0:15], v[56:59], v[64:67], a[0:15]
  v_mfma_f32_32x32x16_bf16 a[16:31], v[56:59], v[68:71], a[16:31]
  v_mfma_f32_32x32x16_bf16 a[32:47], v[60:63], v[64:67], a[32:47]
  v_mfma_f32_32x32x16_bf16 a[48:63], v[60:63], v[68:71], a[48:63]
  s_waitcnt vmcnt(36)
  v_mfma_f32_32x32x16_bf16 a[0:15], v[72:75], v[80:83], a[0:15]
  v_mfma_f32_32x32x16_bf16 a[16:31], v[72:75], v[84:87], a[16:31]
  v_mfma_f32_32x32x16_bf16 a[32:47], v[76:79], v[80:83], a[32:47]
  v_mfma_f32_32x32x16_bf16 a[48:63], v[76:79], v[84:87], a[48:63]
  s_waitcnt vmcnt(32)
  v_mfma_f32_32x32x16_bf16 a[0:15], v[88:91], v[96:99], a[0:15]
  v_mfma_f32_32x32x16_bf16 a[16:31], v[88:91], v[100:103], a[16:31]
  v_mfma_f32_32x32x16_bf16 a[32:47], v[92:95], v[96:99], a[32:47]
  v_mfma_f32_32x32x16_bf16 a[48:63], v[92:95], v[100:103], a[48:63]
  s_waitcnt vmcnt(28)
  v_mfma_f32_32x32x16_bf16 a[0:15], v[104:107], v[112:115], a[0:15]
  v_mfma_f32_32x32x16_bf16 a[16:31], v[104:107], v[116:119], a[16:31]
  v_mfma_f32_32x32x16_bf16 a[32:47], v[108:111], v[112:115], a[32:47]
  v_mfma_f32_32x32x16_bf16 a[48:63], v[108:111], v[116:119], a[48:63]
  s_waitcnt vmcnt(24)
  v_mfma_f32_32x32x16_bf16 a[0:15], v[120:123], v[128:131], a[0:15]
  v_mfma_f32_32x32x16_bf16 a[16:31], v[120:123], v[132:135], a[16:31]
  v_mfma_f32_32x32x16_bf16 a[32:47], v[124:127], v[128:131], a[32:47]
  v_mfma_f32_32x32x16_bf16 a[48:63], v[124:127], v[132:135], a[48:63]
  s_waitcnt vmcnt(20)
  v_mfma_f32_32x32x16_bf16 a[0:15], v[136:139], v[144:147], a[0:15]
  v_mfma_f32_32x32x16_bf16 a[16:31], v[136:139], v[148:151], a[16:31]
  v_mfma_f32_32x32x16_bf16 a[32:47], v[140:143], v[144:147], a[32:47]
  v_mfma_f32_32x32x16_bf16 a[48:63], v[140:143], v[148:151], a[48:63]
  s_waitcnt vmcnt(16)
  v_mfma_f32_32x32x16_bf16 a[0:15], v[152:155], v[160:163], a[0:15]
  v_mfma_f32_32x32x16_bf16 a[16:31], v[152:155], v[164:167], a[16:31]
  v_mfma_f32_32x32x16_bf16 a[32:47], v[156:159], v[160:163], a[32:47]
  v_mfma_f32_32x32x16_bf16 a[48:63], v[156:159], v[164:167], a[48:63]
  s_waitcnt vmcnt(12)
  v_mfma_f32_32x32x16_bf16 a[0:15], v[168:171], v[176:179], a[0:15]
  v_mfma_f32_32x32x16_bf16 a[16:31], v[168:171], v[180:183], a[16:31]
  v_mfma_f32_32x32x16_bf16 a[32:47], v[172:175], v[176:179], a[32:47]
  v_mfma_f32_32x32x16_bf16 a[48:63], v[172:175], v[180:183], a[48:63]
  s_waitcnt vmcnt(8)
  v_mfma_f32_32x32x16_bf16 a[0:15], v[184:187], v[192:195], a[0:15]
  v_mfma_f32_32x32x16_bf16 a[16:31], v[184:187], v[196:199], a[16:31]
  v_mfma_f32_32x32x16_bf16 a[32:47], v[188:191], v[192:195], a[32:47]
  v_mfma_f32_32x32x16_bf16 a[48:63], v[188:191], v[196:199], a[48:63]
  s_waitcnt vmcnt(4)
  v_mfma_f32_32x32x16_bf16 a[0:15], v[200:203], v[208:211], a[0:15]
  v_mfma_f32_32x32x16_bf16 a[16:31], v[200:203], v[212:215], a[16:31]
  v_mfma_f32_32x32x16_bf16 a[32:47], v[204:207], v[208:211], a[32:47]
  v_mfma_f32_32x32x16_bf16 a[48:63], v[204:207], v[212:215], a[48:63]
  s_waitcnt vmcnt(0)
  v_mfma_f32_32x32x16_bf16 a[0:15], v[216:219], v[224:227], a[0:15]
  v_mfma_f32_32x32x16_bf16 a[16:31], v[216:219], v[228:231], a[16:31]
  v_mfma_f32_32x32x16_bf16 a[32:47], v[220:223], v[224:227], a[32:47]
  v_mfma_f32_32x32x16_bf16 a[48:63], v[220:223], v[228:231], a[48:63]
  s_cmp_eq_u32 s38, 0
  s_cbranch_scc1 D_ydone
  s_mov_b32 s35, 0
D_poll2:
  buffer_load_dword v34, v38, s[20:23], s39 offen offset:0 sc1
  s_waitcnt vmcnt(0)
  v_cmp_ne_u32 vcc, 1, v34
  s_add_u32 s35, s35, 1
  s_nop 3
  s_cbranch_vccz D_poll2_nx
  s_cmp_ge_u32 s35, 4194304
  s_cbranch_scc1 D_poll2_nx
  s_sleep 2
  s_branch D_poll2
D_poll2_nx:
  s_add_u32 s39, s39, 8192
  s_add_u32 s38, s38, 1
  s_cmp_lt_u32 s38, 5
  s_cbranch_scc1 D_poll2
  v_bfe_u32 v249, v0, 4, 3
  v_lshlrev_b32 v249, 11, v249
  v_and_b32 v253, 15, v0
  v_lshl_add_u32 v249, v253, 4, v249
  s_lshl_b32 s34, s29, 8
  s_add_u32 s34, s34, 32768
  buffer_load_dwordx4 v[18:21], v249, s[20:23], s34 offen sc1
D_ydone:
  s_waitcnt vmcnt(0)
  s_nop 15
  s_lshl_b32 s34, s5, 12
  v_add_u32 v253, s34, v2
  s_cmp_eq_u32 s5, 0
  s_cbranch_scc1 D_skipw_0
  ds_write_b128 v253, a[0:3] offset:0
  ds_write_b128 v253, a[4:7] offset:1024
  ds_write_b128 v253, a[8:11] offset:2048
  ds_write_b128 v253, a[12:15] offset:3072
D_skipw_0:
  s_cmp_eq_u32 s5, 1
  s_cbranch_scc1 D_skipw_1
  ds_write_b128 v253, a[16:19] offset:16384
  ds_write_b128 v253, a[20:23] offset:17408
  ds_write_b128 v253, a[24:27] offset:18432
  ds_write_b128 v253, a[28:31] offset:19456
D_skipw_1:
  s_cmp_eq_u32 s5, 2
  s_cbranch_scc1 D_skipw_2
  ds_write_b128 v253, a[32:35] offset:32768
  ds_write_b128 v253, a[36:39] offset:33792
  ds_write_b128 v253, a[40:43] offset:34816
  ds_write_b128 v253, a[44:47] offset:35840
D_skipw_2:
  s_cmp_eq_u32 s5, 3
  s_cbranch_scc1 D_skipw_3
  ds_write_b128 v253, a[48:51] offset:49152
  ds_write_b128 v253, a[52:55] offset:50176
  ds_write_b128 v253, a[56:59] offset:51200
  ds_write_b128 v253, a[60:63] offset:52224
D_skipw_3:
  v_mov_b32 v22, v18
  v_mov_b32 v23, v19
  v_mov_b32 v24, v20
  v_mov_b32 v25, v21
  s_nop 1
  v_permlane32_swap_b32 v18, v22
  v_permlane32_swap_b32 v19, v23
  v_permlane32_swap_b32 v20, v24
  v_permlane32_swap_b32 v21, v25
  s_nop 1
  v_add_f32 v18, v18, v22
  v_add_f32 v19, v19, v23
  v_add_f32 v20, v20, v24
  v_add_f32 v21, v21, v25
  v_mov_b32 v22, v18
  v_mov_b32 v23, v19
  v_mov_b32 v24, v20
  v_mov_b32 v25, v21
  s_nop 1
  v_permlane16_swap_b32 v18, v22
  v_permlane16_swap_b32 v19, v23
  v_permlane16_swap_b32 v20, v24
  v_permlane16_swap_b32 v21, v25
  s_nop 1
  v_add_f32 v18, v18, v22
  v_add_f32 v19, v19, v23
  v_add_f32 v20, v20, v24
  v_add_f32 v21, v21, v25
  s_and_b32 s34, s5, 1
  s_lshl_b32 s34, s34, 8
  s_add_u32 s34, s34, 0x10000
  v_and_b32 v254, 15, v1
  v_lshlrev_b32 v254, 4, v254
  v_add_u32 v254, s34, v254
  ds_write_b128 v254, v[18:21]
  s_waitcnt lgkmcnt(0)
  s_barrier
  s_lshr_b32 s34, s5, 1
  s_lshl_b32 s34, s34, 7
  s_add_u32 s34, s34, 0x10000
  v_lshrrev_b32 v254, 5, v1
  v_lshlrev_b32 v254, 4, v254
  v_add_u32 v254, s34, v254
  ds_read_b128 v[18:21], v254 offset:0
  ds_read_b128 v[224:227], v254 offset:256
  ds_read_b128 v[22:25], v254 offset:32
  ds_read_b128 v[228:231], v254 offset:288
  ds_read_b128 v[26:29], v254 offset:64
  ds_read_b128 v[232:235], v254 offset:320
  ds_read_b128 v[30:33], v254 offset:96
  ds_read_b128 v[236:239], v254 offset:352
  s_lshl_b32 s34, s5, 14
  v_add_u32 v253, s34, v2
  ds_read_b128 v[56:59], v253 offset:0
  ds_read_b128 v[60:63], v253 offset:1024
  ds_read_b128 v[64:67], v253 offset:2048
  ds_read_b128 v[68:71], v253 offset:3072
  ds_read_b128 v[72:75], v253 offset:4096
  ds_read_b128 v[76:79], v253 offset:5120
  ds_read_b128 v[80:83], v253 offset:6144
  ds_read_b128 v[84:87], v253 offset:7168
  ds_read_b128 v[88:91], v253 offset:8192
  ds_read_b128 v[92:95], v253 offset:9216
  ds_read_b128 v[96:99], v253 offset:10240
  ds_read_b128 v[100:103], v253 offset:11264
  ds_read_b128 v[104:107], v253 offset:12288
  ds_read_b128 v[108:111], v253 offset:13312
  ds_read_b128 v[112:115], v253 offset:14336
  ds_read_b128 v[116:119], v253 offset:15360
  s_cmp_lg_u32 s5, 0
  s_cbranch_scc1 D_skipr_0
  v_accvgpr_read_b32 v40, a0
  v_accvgpr_read_b32 v41, a1
  v_accvgpr_read_b32 v42, a2
  v_accvgpr_read_b32 v43, a3
  v_accvgpr_read_b32 v44, a4
  v_accvgpr_read_b32 v45, a5
  v_accvgpr_read_b32 v46, a6
  v_accvgpr_read_b32 v47, a7
  v_accvgpr_read_b32 v48, a8
  v_accvgpr_read_b32 v49, a9
  v_accvgpr_read_b32 v50, a10
  v_accvgpr_read_b32 v51, a11
  v_accvgpr_read_b32 v52, a12
  v_accvgpr_read_b32 v53, a13
  v_accvgpr_read_b32 v54, a14
  v_accvgpr_read_b32 v55, a15
D_skipr_0:
  s_cmp_lg_u32 s5, 1
  s_cbranch_scc1 D_skipr_1
  v_accvgpr_read_b32 v40, a16
  v_accvgpr_read_b32 v41, a17
  v_accvgpr_read_b32 v42, a18
  v_accvgpr_read_b32 v43, a19
  v_accvgpr_read_b32 v44, a20
  v_accvgpr_read_b32 v45, a21
  v_accvgpr_read_b32 v46, a22
  v_accvgpr_read_b32 v47, a23
  v_accvgpr_read_b32 v48, a24
  v_accvgpr_read_b32 v49, a25
  v_accvgpr_read_b32 v50, a26
  v_accvgpr_read_b32 v51, a27
  v_accvgpr_read_b32 v52, a28
  v_accvgpr_read_b32 v53, a29
  v_accvgpr_read_b32 v54, a30
  v_accvgpr_read_b32 v55, a31
D_skipr_1:
  s_cmp_lg_u32 s5, 2
  s_cbranch_scc1 D_skipr_2
  v_accvgpr_read_b32 v40, a32
  v_accvgpr_read_b32 v41, a33
  v_accvgpr_read_b32 v42, a34
  v_accvgpr_read_b32 v43, a35
  v_accvgpr_read_b32 v44, a36
  v_accvgpr_read_b32 v45, a37
  v_accvgpr_read_b32 v46, a38
  v_accvgpr_read_b32 v47, a39
  v_accvgpr_read_b32 v48, a40
  v_accvgpr_read_b32 v49, a41
  v_accvgpr_read_b32 v50, a42
  v_accvgpr_read_b32 v51, a43
  v_accvgpr_read_b32 v52, a44
  v_accvgpr_read_b32 v53, a45
  v_accvgpr_read_b32 v54, a46
  v_accvgpr_read_b32 v55, a47
D_skipr_2:
  s_cmp_lg_u32 s5, 3
  s_cbranch_scc1 D_skipr_3
  v_accvgpr_read_b32 v40, a48
  v_accvgpr_read_b32 v41, a49
  v_accvgpr_read_b32 v42, a50
  v_accvgpr_read_b32 v43, a51
  v_accvgpr_read_b32 v44, a52
  v_accvgpr_read_b32 v45, a53
  v_accvgpr_read_b32 v46, a54
  v_accvgpr_read_b32 v47, a55
  v_accvgpr_read_b32 v48, a56
  v_accvgpr_read_b32 v49, a57
  v_accvgpr_read_b32 v50, a58
  v_accvgpr_read_b32 v51, a59
  v_accvgpr_read_b32 v52, a60
  v_accvgpr_read_b32 v53, a61
  v_accvgpr_read_b32 v54, a62
  v_accvgpr_read_b32 v55, a63
D_skipr_3:
  s_waitcnt lgkmcnt(0)
  s_cmp_eq_u32 s5, 0
  s_cbranch_scc1 D_skipa_0
  v_add_f32 v40, v40, v56
  v_add_f32 v41, v41, v57
  v_add_f32 v42, v42, v58
  v_add_f32 v43, v43, v59
  v_add_f32 v44, v44, v60
  v_add_f32 v45, v45, v61
  v_add_f32 v46, v46, v62
  v_add_f32 v47, v47, v63
  v_add_f32 v48, v48, v64
  v_add_f32 v49, v49, v65
  v_add_f32 v50, v50, v66
  v_add_f32 v51, v51, v67
  v_add_f32 v52, v52, v68
  v_add_f32 v53, v53, v69
  v_add_f32 v54, v54, v70
  v_add_f32 v55, v55, v71
D_skipa_0:
  s_cmp_eq_u32 s5, 1
  s_cbranch_scc1 D_skipa_1
  v_add_f32 v40, v40, v72
  v_add_f32 v41, v41, v73
  v_add_f32 v42, v42, v74
  v_add_f32 v43, v43, v75
  v_add_f32 v44, v44, v76
  v_add_f32 v45, v45, v77
  v_add_f32 v46, v46, v78
  v_add_f32 v47, v47, v79
  v_add_f32 v48, v48, v80
  v_add_f32 v49, v49, v81
  v_add_f32 v50, v50, v82
  v_add_f32 v51, v51, v83
  v_add_f32 v52, v52, v84
  v_add_f32 v53, v53, v85
  v_add_f32 v54, v54, v86
  v_add_f32 v55, v55, v87
D_skipa_1:
  s_cmp_eq_u32 s5, 2
  s_cbranch_scc1 D_skipa_2
  v_add_f32 v40, v40, v88
  v_add_f32 v41, v41, v89
  v_add_f32 v42, v42, v90
  v_add_f32 v43, v43, v91
  v_add_f32 v44, v44, v92
  v_add_f32 v45, v45, v93
  v_add_f32 v46, v46, v94
  v_add_f32 v47, v47, v95
  v_add_f32 v48, v48, v96
  v_add_f32 v49, v49, v97
  v_add_f32 v50, v50, v98
  v_add_f32 v51, v51, v99
  v_add_f32 v52, v52, v100
  v_add_f32 v53, v53, v101
  v_add_f32 v54, v54, v102
  v_add_f32 v55, v55, v103
D_skipa_2:
  s_cmp_eq_u32 s5, 3
  s_cbranch_scc1 D_skipa_3
  v_add_f32 v40, v40, v104
  v_add_f32 v41, v41, v105
  v_add_f32 v42, v42, v106
  v_add_f32 v43, v43, v107
  v_add_f32 v44, v44, v108
  v_add_f32 v45, v45, v109
  v_add_f32 v46, v46, v110
  v_add_f32 v47, v47, v111
  v_add_f32 v48, v48, v112
  v_add_f32 v49, v49, v113
  v_add_f32 v50, v50, v114
  v_add_f32 v51, v51, v115
  v_add_f32 v52, v52, v116
  v_add_f32 v53, v53, v117
  v_add_f32 v54, v54, v118
  v_add_f32 v55, v55, v119
D_skipa_3:
  v_add_f32 v18, v18, v224
  v_add_f32 v19, v19, v225
  v_add_f32 v20, v20, v226
  v_add_f32 v21, v21, v227
  v_add_f32 v22, v22, v228
  v_add_f32 v23, v23, v229
  v_add_f32 v24, v24, v230
  v_add_f32 v25, v25, v231
  v_add_f32 v26, v26, v232
  v_add_f32 v27, v27, v233
  v_add_f32 v28, v28, v234
  v_add_f32 v29, v29, v235
  v_add_f32 v30, v30, v236
  v_add_f32 v31, v31, v237
  v_add_f32 v32, v32, v238
  v_add_f32 v33, v33, v239
  v_cmp_eq_u32 vcc, v17, v251
  v_sub_f32 v255, 1.0, v16
  s_nop 0
  v_cndmask_b32 v254, 0, 1.0, vcc
  v_lshlrev_b32 v56, 16, v8
  v_fmac_f32 v56, v254, v18
  v_mul_f32 v56, v56, v255
  v_fmac_f32 v56, v16, v40
  v_and_b32 v57, 0xffff0000, v8
  v_fmac_f32 v57, v254, v19
  v_mul_f32 v57, v57, v255
  v_fmac_f32 v57, v16, v41
  v_lshlrev_b32 v58, 16, v9
  v_fmac_f32 v58, v254, v20
  v_mul_f32 v58, v58, v255
  v_fmac_f32 v58, v16, v42
  v_and_b32 v59, 0xffff0000, v9
  v_fmac_f32 v59, v254, v21
  v_mul_f32 v59, v59, v255
  v_fmac_f32 v59, v16, v43
  v_cvt_pk_bf16_f32 v64, v56, v57
  v_cvt_pk_bf16_f32 v65, v58, v59
  buffer_store_dwordx2 v[64:65], v3, s[16:19], 0 offen offset:0
  v_lshlrev_b32 v56, 16, v10
  v_fmac_f32 v56, v254, v22
  v_mul_f32 v56, v56, v255
  v_fmac_f32 v56, v16, v44
  v_and_b32 v57, 0xffff0000, v10
  v_fmac_f32 v57, v254, v23
  v_mul_f32 v57, v57, v255
  v_fmac_f32 v57, v16, v45
  v_lshlrev_b32 v58, 16, v11
  v_fmac_f32 v58, v254, v24
  v_mul_f32 v58, v58, v255
  v_fmac_f32 v58, v16, v46
  v_and_b32 v59, 0xffff0000, v11
  v_fmac_f32 v59, v254, v25
  v_mul_f32 v59, v59, v255
  v_fmac_f32 v59, v16, v47
  v_cvt_pk_bf16_f32 v66, v56, v57
  v_cvt_pk_bf16_f32 v67, v58, v59
  buffer_store_dwordx2 v[66:67], v3, s[16:19], 0 offen offset:16
  v_lshlrev_b32 v56, 16, v12
  v_fmac_f32 v56, v254, v26
  v_mul_f32 v56, v56, v255
  v_fmac_f32 v56, v16, v48
  v_and_b32 v57, 0xffff0000, v12
  v_fmac_f32 v57, v254, v27
  v_mul_f32 v57, v57, v255
  v_fmac_f32 v57, v16, v49
  v_lshlrev_b32 v58, 16, v13
  v_fmac_f32 v58, v254, v28
  v_mul_f32 v58, v58, v255
  v_fmac_f32 v58, v16, v50
  v_and_b32 v59, 0xffff0000, v13
  v_fmac_f32 v59, v254, v29
  v_mul_f32 v59, v59, v255
  v_fmac_f32 v59, v16, v51
  v_cvt_pk_bf16_f32 v68, v56, v57
  v_cvt_pk_bf16_f32 v69, v58, v59
  buffer_store_dwordx2 v[68:69], v3, s[16:19], 0 offen offset:32
  v_lshlrev_b32 v56, 16, v14
  v_fmac_f32 v56, v254, v30
  v_mul_f32 v56, v56, v255
  v_fmac_f32 v56, v16, v52
  v_and_b32 v57, 0xffff0000, v14
  v_fmac_f32 v57, v254, v31
  v_mul_f32 v57, v57, v255
  v_fmac_f32 v57, v16, v53
  v_lshlrev_b32 v58, 16, v15
  v_fmac_f32 v58, v254, v32
  v_mul_f32 v58, v58, v255
  v_fmac_f32 v58, v16, v54
  v_and_b32 v59, 0xffff0000, v15
  v_fmac_f32 v59, v254, v33
  v_mul_f32 v59, v59, v255
  v_fmac_f32 v59, v16, v55
  v_cvt_pk_bf16_f32 v70, v56, v57
  v_cvt_pk_bf16_f32 v71, v58, v59
  buffer_store_dwordx2 v[70:71], v3, s[16:19], 0 offen offset:48
  s_branch F_end
K2_rare_C:
  s_nop 15
  s_nop 15
  v_max_f32 v56, v64, v65
  v_max3_f32 v56, v56, v66, v67
  v_max3_f32 v56, v56, v68, v69
  v_max3_f32 v56, v56, v70, v71
  v_max3_f32 v56, v56, v72, v73
  v_max3_f32 v56, v56, v74, v75
  v_max3_f32 v56, v56, v76, v77
  v_max3_f32 v56, v56, v78, v79
  v_max3_f32 v56, v56, v80, v81
  v_max3_f32 v56, v56, v82, v83
  v_max3_f32 v56, v56, v84, v85
  v_max3_f32 v56, v56, v86, v87
  v_max3_f32 v56, v56, v88, v89
  v_max3_f32 v56, v56, v90, v91
  v_max3_f32 v56, v56, v92, v93
  v_max3_f32 v56, v56, v94, v95
  v_mov_b32 v57, v56
  s_nop 1
  v_permlane32_swap_b32 v56, v57
  s_nop 1
  v_max_f32 v56, v56, v57
  v_mov_b32 v57, v56
  s_nop 1
  v_permlane16_swap_b32 v56, v57
  s_nop 1
  v_max_f32 v56, v56, v57
  v_max_f32 v56, 0, v56
  v_sub_f32 v16, v16, v56
  v_sub_f32 v17, v17, v56
  v_sub_f32 v18, v18, v56
  v_sub_f32 v19, v19, v56
  v_sub_f32 v64, v64, v56
  v_sub_f32 v65, v65, v56
  v_sub_f32 v66, v66, v56
  v_sub_f32 v67, v67, v56
  v_sub_f32 v68, v68, v56
  v_sub_f32 v69, v69, v56
  v_sub_f32 v70, v70, v56
  v_sub_f32 v71, v71, v56
  v_sub_f32 v72, v72, v56
  v_sub_f32 v73, v73, v56
  v_sub_f32 v74, v74, v56
  v_sub_f32 v75, v75, v56
  v_sub_f32 v76, v76, v56
  v_sub_f32 v77, v77, v56
  v_sub_f32 v78, v78, v56
  v_sub_f32 v79, v79, v56
  v_sub_f32 v80, v80, v56
  v_sub_f32 v81, v81, v56
  v_sub_f32 v82, v82, v56
  v_sub_f32 v83, v83, v56
  v_sub_f32 v84, v84, v56
  v_sub_f32 v85, v85, v56
  v_sub_f32 v86, v86, v56
  v_sub_f32 v87, v87, v56
  v_sub_f32 v88, v88, v56
  v_sub_f32 v89, v89, v56
  v_sub_f32 v90, v90, v56
  v_sub_f32 v91, v91, v56
  v_sub_f32 v92, v92, v56
  v_sub_f32 v93, v93, v56
  v_sub_f32 v94, v94, v56
  v_sub_f32 v95, v95, v56
  v_sub_f32 v128, v128, v56
  v_sub_f32 v129, v129, v56
  v_sub_f32 v130, v130, v56
  v_sub_f32 v131, v131, v56
  v_sub_f32 v132, v132, v56
  v_sub_f32 v133, v133, v56
  v_sub_f32 v134, v134, v56
  v_sub_f32 v135, v135, v56
  v_sub_f32 v136, v136, v56
  v_sub_f32 v137, v137, v56
  v_sub_f32 v138, v138, v56
  v_sub_f32 v139, v139, v56
  v_sub_f32 v140, v140, v56
  v_sub_f32 v141, v141, v56
  v_sub_f32 v142, v142, v56
  v_sub_f32 v143, v143, v56
  v_sub_f32 v58, 0, v56
  v_exp_f32 v58, v58
  s_nop 0
  v_mul_f32 v32, v32, v58
  v_mul_f32 v33, v33, v58
  v_mul_f32 v34, v34, v58
  v_mul_f32 v35, v35, v58
  v_accvgpr_read_b32 v57, a0
  v_mul_f32 v57, v57, v58
  v_accvgpr_write_b32 a0, v57
  v_accvgpr_read_b32 v57, a1
  v_mul_f32 v57, v57, v58
  v_accvgpr_write_b32 a1, v57
  v_accvgpr_read_b32 v57, a2
  v_mul_f32 v57, v57, v58
  v_accvgpr_write_b32 a2, v57
  v_accvgpr_read_b32 v57, a3
  v_mul_f32 v57, v57, v58
  v_accvgpr_write_b32 a3, v57
  v_accvgpr_read_b32 v57, a4
  v_mul_f32 v57, v57, v58
  v_accvgpr_write_b32 a4, v57
  v_accvgpr_read_b32 v57, a5
  v_mul_f32 v57, v57, v58
  v_accvgpr_write_b32 a5, v57
  v_accvgpr_read_b32 v57, a6
  v_mul_f32 v57, v57, v58
  v_accvgpr_write_b32 a6, v57
  v_accvgpr_read_b32 v57, a7
  v_mul_f32 v57, v57, v58
  v_accvgpr_write_b32 a7, v57
  v_accvgpr_read_b32 v57, a8
  v_mul_f32 v57, v57, v58
  v_accvgpr_write_b32 a8, v57
  v_accvgpr_read_b32 v57, a9
  v_mul_f32 v57, v57, v58
  v_accvgpr_write_b32 a9, v57
  v_accvgpr_read_b32 v57, a10
  v_mul_f32 v57, v57, v58
  v_accvgpr_write_b32 a10, v57
  v_accvgpr_read_b32 v57, a11
  v_mul_f32 v57, v57, v58
  v_accvgpr_write_b32 a11, v57
  v_accvgpr_read_b32 v57, a12
  v_mul_f32 v57, v57, v58
  v_accvgpr_write_b32 a12, v57
  v_accvgpr_read_b32 v57, a13
  v_mul_f32 v57, v57, v58
  v_accvgpr_write_b32 a13, v57
  v_accvgpr_read_b32 v57, a14
  v_mul_f32 v57, v57, v58
  v_accvgpr_write_b32 a14, v57
  v_accvgpr_read_b32 v57, a15
  v_mul_f32 v57, v57, v58
  v_accvgpr_write_b32 a15, v57
  v_accvgpr_read_b32 v57, a16
  v_mul_f32 v57, v57, v58
  v_accvgpr_write_b32 a16, v57
  v_accvgpr_read_b32 v57, a17
  v_mul_f32 v57, v57, v58
  v_accvgpr_write_b32 a17, v57
  v_accvgpr_read_b32 v57, a18
  v_mul_f32 v57, v57, v58
  v_accvgpr_write_b32 a18, v57
  v_accvgpr_read_b32 v57, a19
  v_mul_f32 v57, v57, v58
  v_accvgpr_write_b32 a19, v57
  v_accvgpr_read_b32 v57, a20
  v_mul_f32 v57, v57, v58
  v_accvgpr_write_b32 a20, v57
  v_accvgpr_read_b32 v57, a21
  v_mul_f32 v57, v57, v58
  v_accvgpr_write_b32 a21, v57
  v_accvgpr_read_b32 v57, a22
  v_mul_f32 v57, v57, v58
  v_accvgpr_write_b32 a22, v57
  v_accvgpr_read_b32 v57, a23
  v_mul_f32 v57, v57, v58
  v_accvgpr_write_b32 a23, v57
  v_accvgpr_read_b32 v57, a24
  v_mul_f32 v57, v57, v58
  v_accvgpr_write_b32 a24, v57
  v_accvgpr_read_b32 v57, a25
  v_mul_f32 v57, v57, v58
  v_accvgpr_write_b32 a25, v57
  v_accvgpr_read_b32 v57, a26
  v_mul_f32 v57, v57, v58
  v_accvgpr_write_b32 a26, v57
  v_accvgpr_read_b32 v57, a27
  v_mul_f32 v57, v57, v58
  v_accvgpr_write_b32 a27, v57
  v_accvgpr_read_b32 v57, a28
  v_mul_f32 v57, v57, v58
  v_accvgpr_write_b32 a28, v57
  v_accvgpr_read_b32 v57, a29
  v_mul_f32 v57, v57, v58
  v_accvgpr_write_b32 a29, v57
  v_accvgpr_read_b32 v57, a30
  v_mul_f32 v57, v57, v58
  v_accvgpr_write_b32 a30, v57
  v_accvgpr_read_b32 v57, a31
  v_mul_f32 v57, v57, v58
  v_accvgpr_write_b32 a31, v57
  v_max_f32 v56, v96, v97
  v_max3_f32 v56, v56, v98, v99
  v_max3_f32 v56, v56, v100, v101
  v_max3_f32 v56, v56, v102, v103
  v_max3_f32 v56, v56, v104, v105
  v_max3_f32 v56, v56, v106, v107
  v_max3_f32 v56, v56, v108, v109
  v_max3_f32 v56, v56, v110, v111
  v_max3_f32 v56, v56, v112, v113
  v_max3_f32 v56, v56, v114, v115
  v_max3_f32 v56, v56, v116, v117
  v_max3_f32 v56, v56, v118, v119
  v_max3_f32 v56, v56, v120, v121
  v_max3_f32 v56, v56, v122, v123
  v_max3_f32 v56, v56, v124, v125
  v_max3_f32 v56, v56, v126, v127
  v_mov_b32 v57, v56
  s_nop 1
  v_permlane32_swap_b32 v56, v57
  s_nop 1
  v_max_f32 v56, v56, v57
  v_mov_b32 v57, v56
  s_nop 1
  v_permlane16_swap_b32 v56, v57
  s_nop 1
  v_max_f32 v56, v56, v57
  v_max_f32 v56, 0, v56
  v_sub_f32 v20, v20, v56
  v_sub_f32 v21, v21, v56
  v_sub_f32 v22, v22, v56
  v_sub_f32 v23, v23, v56
  v_sub_f32 v96, v96, v56
  v_sub_f32 v97, v97, v56
  v_sub_f32 v98, v98, v56
  v_sub_f32 v99, v99, v56
  v_sub_f32 v100, v100, v56
  v_sub_f32 v101, v101, v56
  v_sub_f32 v102, v102, v56
  v_sub_f32 v103, v103, v56
  v_sub_f32 v104, v104, v56
  v_sub_f32 v105, v105, v56
  v_sub_f32 v106, v106, v56
  v_sub_f32 v107, v107, v56
  v_sub_f32 v108, v108, v56
  v_sub_f32 v109, v109, v56
  v_sub_f32 v110, v110, v56
  v_sub_f32 v111, v111, v56
  v_sub_f32 v112, v112, v56
  v_sub_f32 v113, v113, v56
  v_sub_f32 v114, v114, v56
  v_sub_f32 v115, v115, v56
  v_sub_f32 v116, v116, v56
  v_sub_f32 v117, v117, v56
  v_sub_f32 v118, v118, v56
  v_sub_f32 v119, v119, v56
  v_sub_f32 v120, v120, v56
  v_sub_f32 v121, v121, v56
  v_sub_f32 v122, v122, v56
  v_sub_f32 v123, v123, v56
  v_sub_f32 v124, v124, v56
  v_sub_f32 v125, v125, v56
  v_sub_f32 v126, v126, v56
  v_sub_f32 v127, v127, v56
  v_sub_f32 v144, v144, v56
  v_sub_f32 v145, v145, v56
  v_sub_f32 v146, v146, v56
  v_sub_f32 v147, v147, v56
  v_sub_f32 v148, v148, v56
  v_sub_f32 v149, v149, v56
  v_sub_f32 v150, v150, v56
  v_sub_f32 v151, v151, v56
  v_sub_f32 v152, v152, v56
  v_sub_f32 v153, v153, v56
  v_sub_f32 v154, v154, v56
  v_sub_f32 v155, v155, v56
  v_sub_f32 v156, v156, v56
  v_sub_f32 v157, v157, v56
  v_sub_f32 v158, v158, v56
  v_sub_f32 v159, v159, v56
  v_sub_f32 v58, 0, v56
  v_exp_f32 v58, v58
  s_nop 0
  v_mul_f32 v36, v36, v58
  v_mul_f32 v37, v37, v58
  v_mul_f32 v38, v38, v58
  v_mul_f32 v39, v39, v58
  v_accvgpr_read_b32 v57, a32
  v_mul_f32 v57, v57, v58
  v_accvgpr_write_b32 a32, v57
  v_accvgpr_read_b32 v57, a33
  v_mul_f32 v57, v57, v58
  v_accvgpr_write_b32 a33, v57
  v_accvgpr_read_b32 v57, a34
  v_mul_f32 v57, v57, v58
  v_accvgpr_write_b32 a34, v57
  v_accvgpr_read_b32 v57, a35
  v_mul_f32 v57, v57, v58
  v_accvgpr_write_b32 a35, v57
  v_accvgpr_read_b32 v57, a36
  v_mul_f32 v57, v57, v58
  v_accvgpr_write_b32 a36, v57
  v_accvgpr_read_b32 v57, a37
  v_mul_f32 v57, v57, v58
  v_accvgpr_write_b32 a37, v57
  v_accvgpr_read_b32 v57, a38
  v_mul_f32 v57, v57, v58
  v_accvgpr_write_b32 a38, v57
  v_accvgpr_read_b32 v57, a39
  v_mul_f32 v57, v57, v58
  v_accvgpr_write_b32 a39, v57
  v_accvgpr_read_b32 v57, a40
  v_mul_f32 v57, v57, v58
  v_accvgpr_write_b32 a40, v57
  v_accvgpr_read_b32 v57, a41
  v_mul_f32 v57, v57, v58
  v_accvgpr_write_b32 a41, v57
  v_accvgpr_read_b32 v57, a42
  v_mul_f32 v57, v57, v58
  v_accvgpr_write_b32 a42, v57
  v_accvgpr_read_b32 v57, a43
  v_mul_f32 v57, v57, v58
  v_accvgpr_write_b32 a43, v57
  v_accvgpr_read_b32 v57, a44
  v_mul_f32 v57, v57, v58
  v_accvgpr_write_b32 a44, v57
  v_accvgpr_read_b32 v57, a45
  v_mul_f32 v57, v57, v58
  v_accvgpr_write_b32 a45, v57
  v_accvgpr_read_b32 v57, a46
  v_mul_f32 v57, v57, v58
  v_accvgpr_write_b32 a46, v57
  v_accvgpr_read_b32 v57, a47
  v_mul_f32 v57, v57, v58
  v_accvgpr_write_b32 a47, v57
  v_accvgpr_read_b32 v57, a48
  v_mul_f32 v57, v57, v58
  v_accvgpr_write_b32 a48, v57
  v_accvgpr_read_b32 v57, a49
  v_mul_f32 v57, v57, v58
  v_accvgpr_write_b32 a49, v57
  v_accvgpr_read_b32 v57, a50
  v_mul_f32 v57, v57, v58
  v_accvgpr_write_b32 a50, v57
  v_accvgpr_read_b32 v57, a51
  v_mul_f32 v57, v57, v58
  v_accvgpr_write_b32 a51, v57
  v_accvgpr_read_b32 v57, a52
  v_mul_f32 v57, v57, v58
  v_accvgpr_write_b32 a52, v57
  v_accvgpr_read_b32 v57, a53
  v_mul_f32 v57, v57, v58
  v_accvgpr_write_b32 a53, v57
  v_accvgpr_read_b32 v57, a54
  v_mul_f32 v57, v57, v58
  v_accvgpr_write_b32 a54, v57
  v_accvgpr_read_b32 v57, a55
  v_mul_f32 v57, v57, v58
  v_accvgpr_write_b32 a55, v57
  v_accvgpr_read_b32 v57, a56
  v_mul_f32 v57, v57, v58
  v_accvgpr_write_b32 a56, v57
  v_accvgpr_read_b32 v57, a57
  v_mul_f32 v57, v57, v58
  v_accvgpr_write_b32 a57, v57
  v_accvgpr_read_b32 v57, a58
  v_mul_f32 v57, v57, v58
  v_accvgpr_write_b32 a58, v57
  v_accvgpr_read_b32 v57, a59
  v_mul_f32 v57, v57, v58
  v_accvgpr_write_b32 a59, v57
  v_accvgpr_read_b32 v57, a60
  v_mul_f32 v57, v57, v58
  v_accvgpr_write_b32 a60, v57
  v_accvgpr_read_b32 v57, a61
  v_mul_f32 v57, v57, v58
  v_accvgpr_write_b32 a61, v57
  v_accvgpr_read_b32 v57, a62
  v_mul_f32 v57, v57, v58
  v_accvgpr_write_b32 a62, v57
  v_accvgpr_read_b32 v57, a63
  v_mul_f32 v57, v57, v58
  v_accvgpr_write_b32 a63, v57
  v_exp_f32 v48, v64
  v_exp_f32 v49, v65
  v_exp_f32 v50, v66
  v_exp_f32 v51, v67
  v_cvt_pk_bf16_f32 v192, v48, v49
  v_exp_f32 v52, v68
  v_exp_f32 v53, v69
  v_cvt_pk_bf16_f32 v193, v50, v51
  v_pk_maximum3_f16 v11, v192, v192, v193
  v_exp_f32 v54, v70
  v_exp_f32 v55, v71
  v_cvt_pk_bf16_f32 v194, v52, v53
  v_exp_f32 v48, v96
  v_exp_f32 v49, v97
  v_cvt_pk_bf16_f32 v195, v54, v55
  v_pk_maximum3_f16 v11, v11, v194, v195
  v_exp_f32 v50, v98
  v_exp_f32 v51, v99
  v_cvt_pk_bf16_f32 v208, v48, v49
  v_exp_f32 v52, v100
  v_exp_f32 v53, v101
  v_cvt_pk_bf16_f32 v209, v50, v51
  v_pk_maximum3_f16 v11, v11, v208, v209
  v_exp_f32 v54, v102
  v_exp_f32 v55, v103
  v_cvt_pk_bf16_f32 v210, v52, v53
  v_exp_f32 v48, v72
  v_exp_f32 v49, v73
  v_cvt_pk_bf16_f32 v211, v54, v55
  v_pk_maximum3_f16 v11, v11, v210, v211
  v_exp_f32 v50, v74
  v_exp_f32 v51, v75
  v_cvt_pk_bf16_f32 v196, v48, v49
  v_exp_f32 v52, v76
  v_exp_f32 v53, v77
  v_cvt_pk_bf16_f32 v197, v50, v51
  v_pk_maximum3_f16 v11, v11, v196, v197
  v_exp_f32 v54, v78
  v_exp_f32 v55, v79
  v_cvt_pk_bf16_f32 v198, v52, v53
  v_exp_f32 v48, v104
  v_exp_f32 v49, v105
  v_cvt_pk_bf16_f32 v199, v54, v55
  v_pk_maximum3_f16 v11, v11, v198, v199
  v_exp_f32 v50, v106
  v_exp_f32 v51, v107
  v_cvt_pk_bf16_f32 v212, v48, v49
  v_exp_f32 v52, v108
  v_exp_f32 v53, v109
  v_cvt_pk_bf16_f32 v213, v50, v51
  v_pk_maximum3_f16 v11, v11, v212, v213
  v_exp_f32 v54, v110
  v_exp_f32 v55, v111
  v_cvt_pk_bf16_f32 v214, v52, v53
  v_exp_f32 v48, v80
  v_exp_f32 v49, v81
  v_cvt_pk_bf16_f32 v215, v54, v55
  v_pk_maximum3_f16 v11, v11, v214, v215
  v_exp_f32 v50, v82
  v_exp_f32 v51, v83
  v_cvt_pk_bf16_f32 v200, v48, v49
  v_exp_f32 v52, v84
  v_exp_f32 v53, v85
  v_cvt_pk_bf16_f32 v201, v50, v51
  v_pk_maximum3_f16 v11, v11, v200, v201
  v_exp_f32 v54, v86
  v_exp_f32 v55, v87
  v_cvt_pk_bf16_f32 v202, v52, v53
  v_exp_f32 v48, v112
  v_exp_f32 v49, v113
  v_cvt_pk_bf16_f32 v203, v54, v55
  v_pk_maximum3_f16 v11, v11, v202, v203
  v_exp_f32 v50, v114
  v_exp_f32 v51, v115
  v_cvt_pk_bf16_f32 v216, v48, v49
  v_exp_f32 v52, v116
  v_exp_f32 v53, v117
  v_cvt_pk_bf16_f32 v217, v50, v51
  v_pk_maximum3_f16 v11, v11, v216, v217
  v_exp_f32 v54, v118
  v_exp_f32 v55, v119
  v_cvt_pk_bf16_f32 v218, v52, v53
  v_exp_f32 v48, v88
  v_exp_f32 v49, v89
  v_cvt_pk_bf16_f32 v219, v54, v55
  v_pk_maximum3_f16 v11, v11, v218, v219
  v_exp_f32 v50, v90
  v_exp_f32 v51, v91
  v_cvt_pk_bf16_f32 v204, v48, v49
  v_exp_f32 v52, v92
  v_exp_f32 v53, v93
  v_cvt_pk_bf16_f32 v205, v50, v51
  v_pk_maximum3_f16 v11, v11, v204, v205
  v_exp_f32 v54, v94
  v_exp_f32 v55, v95
  v_cvt_pk_bf16_f32 v206, v52, v53
  v_exp_f32 v48, v120
  v_exp_f32 v49, v121
  v_cvt_pk_bf16_f32 v207, v54, v55
  v_pk_maximum3_f16 v11, v11, v206, v207
  v_exp_f32 v50, v122
  v_exp_f32 v51, v123
  v_cvt_pk_bf16_f32 v220, v48, v49
  v_exp_f32 v52, v124
  v_exp_f32 v53, v125
  v_cvt_pk_bf16_f32 v221, v50, v51
  v_pk_maximum3_f16 v11, v11, v220, v221
  v_exp_f32 v54, v126
  v_exp_f32 v55, v127
  v_cvt_pk_bf16_f32 v222, v52, v53
  s_nop 0
  v_cvt_pk_bf16_f32 v223, v54, v55
  v_pk_maximum3_f16 v11, v11, v222, v223
  s_nop 3
  s_branch K2_ret_C
K2_rare_D:
  s_nop 15
  s_nop 15
  v_max_f32 v56, v128, v129
  v_max3_f32 v56, v56, v130, v131
  v_max3_f32 v56, v56, v132, v133
  v_max3_f32 v56, v56, v134, v135
  v_max3_f32 v56, v56, v136, v137
  v_max3_f32 v56, v56, v138, v139
  v_max3_f32 v56, v56, v140, v141
  v_max3_f32 v56, v56, v142, v143
  v_mov_b32 v57, v56
  s_nop 1
  v_permlane32_swap_b32 v56, v57
  s_nop 1
  v_max_f32 v56, v56, v57
  v_mov_b32 v57, v56
  s_nop 1
  v_permlane16_swap_b32 v56, v57
  s_nop 1
  v_max_f32 v56, v56, v57
  v_max_f32 v56, 0, v56
  v_sub_f32 v16, v16, v56
  v_sub_f32 v17, v17, v56
  v_sub_f32 v18, v18, v56
  v_sub_f32 v19, v19, v56
  v_sub_f32 v128, v128, v56
  v_sub_f32 v129, v129, v56
  v_sub_f32 v130, v130, v56
  v_sub_f32 v131, v131, v56
  v_sub_f32 v132, v132, v56
  v_sub_f32 v133, v133, v56
  v_sub_f32 v134, v134, v56
  v_sub_f32 v135, v135, v56
  v_sub_f32 v136, v136, v56
  v_sub_f32 v137, v137, v56
  v_sub_f32 v138, v138, v56
  v_sub_f32 v139, v139, v56
  v_sub_f32 v140, v140, v56
  v_sub_f32 v141, v141, v56
  v_sub_f32 v142, v142, v56
  v_sub_f32 v143, v143, v56
  v_sub_f32 v64, v64, v56
  v_sub_f32 v65, v65, v56
  v_sub_f32 v66, v66, v56
  v_sub_f32 v67, v67, v56
  v_sub_f32 v68, v68, v56
  v_sub_f32 v69, v69, v56
  v_sub_f32 v70, v70, v56
  v_sub_f32 v71, v71, v56
  v_sub_f32 v72, v72, v56
  v_sub_f32 v73, v73, v56
  v_sub_f32 v74, v74, v56
  v_sub_f32 v75, v75, v56
  v_sub_f32 v76, v76, v56
  v_sub_f32 v77, v77, v56
  v_sub_f32 v78, v78, v56
  v_sub_f32 v79, v79, v56
  v_sub_f32 v58, 0, v56
  v_exp_f32 v58, v58
  s_nop 0
  v_mul_f32 v32, v32, v58
  v_mul_f32 v33, v33, v58
  v_mul_f32 v34, v34, v58
  v_mul_f32 v35, v35, v58
  v_accvgpr_read_b32 v57, a0
  v_mul_f32 v57, v57, v58
  v_accvgpr_write_b32 a0, v57
  v_accvgpr_read_b32 v57, a1
  v_mul_f32 v57, v57, v58
  v_accvgpr_write_b32 a1, v57
  v_accvgpr_read_b32 v57, a2
  v_mul_f32 v57, v57, v58
  v_accvgpr_write_b32 a2, v57
  v_accvgpr_read_b32 v57, a3
  v_mul_f32 v57, v57, v58
  v_accvgpr_write_b32 a3, v57
  v_accvgpr_read_b32 v57, a4
  v_mul_f32 v57, v57, v58
  v_accvgpr_write_b32 a4, v57
  v_accvgpr_read_b32 v57, a5
  v_mul_f32 v57, v57, v58
  v_accvgpr_write_b32 a5, v57
  v_accvgpr_read_b32 v57, a6
  v_mul_f32 v57, v57, v58
  v_accvgpr_write_b32 a6, v57
  v_accvgpr_read_b32 v57, a7
  v_mul_f32 v57, v57, v58
  v_accvgpr_write_b32 a7, v57
  v_accvgpr_read_b32 v57, a8
  v_mul_f32 v57, v57, v58
  v_accvgpr_write_b32 a8, v57
  v_accvgpr_read_b32 v57, a9
  v_mul_f32 v57, v57, v58
  v_accvgpr_write_b32 a9, v57
  v_accvgpr_read_b32 v57, a10
  v_mul_f32 v57, v57, v58
  v_accvgpr_write_b32 a10, v57
  v_accvgpr_read_b32 v57, a11
  v_mul_f32 v57, v57, v58
  v_accvgpr_write_b32 a11, v57
  v_accvgpr_read_b32 v57, a12
  v_mul_f32 v57, v57, v58
  v_accvgpr_write_b32 a12, v57
  v_accvgpr_read_b32 v57, a13
  v_mul_f32 v57, v57, v58
  v_accvgpr_write_b32 a13, v57
  v_accvgpr_read_b32 v57, a14
  v_mul_f32 v57, v57, v58
  v_accvgpr_write_b32 a14, v57
  v_accvgpr_read_b32 v57, a15
  v_mul_f32 v57, v57, v58
  v_accvgpr_write_b32 a15, v57
  v_accvgpr_read_b32 v57, a16
  v_mul_f32 v57, v57, v58
  v_accvgpr_write_b32 a16, v57
  v_accvgpr_read_b32 v57, a17
  v_mul_f32 v57, v57, v58
  v_accvgpr_write_b32 a17, v57
  v_accvgpr_read_b32 v57, a18
  v_mul_f32 v57, v57, v58
  v_accvgpr_write_b32 a18, v57
  v_accvgpr_read_b32 v57, a19
  v_mul_f32 v57, v57, v58
  v_accvgpr_write_b32 a19, v57
  v_accvgpr_read_b32 v57, a20
  v_mul_f32 v57, v57, v58
  v_accvgpr_write_b32 a20, v57
  v_accvgpr_read_b32 v57, a21
  v_mul_f32 v57, v57, v58
  v_accvgpr_write_b32 a21, v57
  v_accvgpr_read_b32 v57, a22
  v_mul_f32 v57, v57, v58
  v_accvgpr_write_b32 a22, v57
  v_accvgpr_read_b32 v57, a23
  v_mul_f32 v57, v57, v58
  v_accvgpr_write_b32 a23, v57
  v_accvgpr_read_b32 v57, a24
  v_mul_f32 v57, v57, v58
  v_accvgpr_write_b32 a24, v57
  v_accvgpr_read_b32 v57, a25
  v_mul_f32 v57, v57, v58
  v_accvgpr_write_b32 a25, v57
  v_accvgpr_read_b32 v57, a26
  v_mul_f32 v57, v57, v58
  v_accvgpr_write_b32 a26, v57
  v_accvgpr_read_b32 v57, a27
  v_mul_f32 v57, v57, v58
  v_accvgpr_write_b32 a27, v57
  v_accvgpr_read_b32 v57, a28
  v_mul_f32 v57, v57, v58
  v_accvgpr_write_b32 a28, v57
  v_accvgpr_read_b32 v57, a29
  v_mul_f32 v57, v57, v58
  v_accvgpr_write_b32 a29, v57
  v_accvgpr_read_b32 v57, a30
  v_mul_f32 v57, v57, v58
  v_accvgpr_write_b32 a30, v57
  v_accvgpr_read_b32 v57, a31
  v_mul_f32 v57, v57, v58
  v_accvgpr_write_b32 a31, v57
  v_max_f32 v56, v144, v145
  v_max3_f32 v56, v56, v146, v147
  v_max3_f32 v56, v56, v148, v149
  v_max3_f32 v56, v56, v150, v151
  v_max3_f32 v56, v56, v152, v153
  v_max3_f32 v56, v56, v154, v155
  v_max3_f32 v56, v56, v156, v157
  v_max3_f32 v56, v56, v158, v159
  v_mov_b32 v57, v56
  s_nop 1
  v_permlane32_swap_b32 v56, v57
  s_nop 1
  v_max_f32 v56, v56, v57
  v_mov_b32 v57, v56
  s_nop 1
  v_permlane16_swap_b32 v56, v57
  s_nop 1
  v_max_f32 v56, v56, v57
  v_max_f32 v56, 0, v56
  v_sub_f32 v20, v20, v56
  v_sub_f32 v21, v21, v56
  v_sub_f32 v22, v22, v56
  v_sub_f32 v23, v23, v56
  v_sub_f32 v144, v144, v56
  v_sub_f32 v145, v145, v56
  v_sub_f32 v146, v146, v56
  v_sub_f32 v147, v147, v56
  v_sub_f32 v148, v148, v56
  v_sub_f32 v149, v149, v56
  v_sub_f32 v150, v150, v56
  v_sub_f32 v151, v151, v56
  v_sub_f32 v152, v152, v56
  v_sub_f32 v153, v153, v56
  v_sub_f32 v154, v154, v56
  v_sub_f32 v155, v155, v56
  v_sub_f32 v156, v156, v56
  v_sub_f32 v157, v157, v56
  v_sub_f32 v158, v158, v56
  v_sub_f32 v159, v159, v56
  v_sub_f32 v80, v80, v56
  v_sub_f32 v81, v81, v56
  v_sub_f32 v82, v82, v56
  v_sub_f32 v83, v83, v56
  v_sub_f32 v84, v84, v56
  v_sub_f32 v85, v85, v56
  v_sub_f32 v86, v86, v56
  v_sub_f32 v87, v87, v56
  v_sub_f32 v88, v88, v56
  v_sub_f32 v89, v89, v56
  v_sub_f32 v90, v90, v56
  v_sub_f32 v91, v91, v56
  v_sub_f32 v92, v92, v56
  v_sub_f32 v93, v93, v56
  v_sub_f32 v94, v94, v56
  v_sub_f32 v95, v95, v56
  v_sub_f32 v58, 0, v56
  v_exp_f32 v58, v58
  s_nop 0
  v_mul_f32 v36, v36, v58
  v_mul_f32 v37, v37, v58
  v_mul_f32 v38, v38, v58
  v_mul_f32 v39, v39, v58
  v_accvgpr_read_b32 v57, a32
  v_mul_f32 v57, v57, v58
  v_accvgpr_write_b32 a32, v57
  v_accvgpr_read_b32 v57, a33
  v_mul_f32 v57, v57, v58
  v_accvgpr_write_b32 a33, v57
  v_accvgpr_read_b32 v57, a34
  v_mul_f32 v57, v57, v58
  v_accvgpr_write_b32 a34, v57
  v_accvgpr_read_b32 v57, a35
  v_mul_f32 v57, v57, v58
  v_accvgpr_write_b32 a35, v57
  v_accvgpr_read_b32 v57, a36
  v_mul_f32 v57, v57, v58
  v_accvgpr_write_b32 a36, v57
  v_accvgpr_read_b32 v57, a37
  v_mul_f32 v57, v57, v58
  v_accvgpr_write_b32 a37, v57
  v_accvgpr_read_b32 v57, a38
  v_mul_f32 v57, v57, v58
  v_accvgpr_write_b32 a38, v57
  v_accvgpr_read_b32 v57, a39
  v_mul_f32 v57, v57, v58
  v_accvgpr_write_b32 a39, v57
  v_accvgpr_read_b32 v57, a40
  v_mul_f32 v57, v57, v58
  v_accvgpr_write_b32 a40, v57
  v_accvgpr_read_b32 v57, a41
  v_mul_f32 v57, v57, v58
  v_accvgpr_write_b32 a41, v57
  v_accvgpr_read_b32 v57, a42
  v_mul_f32 v57, v57, v58
  v_accvgpr_write_b32 a42, v57
  v_accvgpr_read_b32 v57, a43
  v_mul_f32 v57, v57, v58
  v_accvgpr_write_b32 a43, v57
  v_accvgpr_read_b32 v57, a44
  v_mul_f32 v57, v57, v58
  v_accvgpr_write_b32 a44, v57
  v_accvgpr_read_b32 v57, a45
  v_mul_f32 v57, v57, v58
  v_accvgpr_write_b32 a45, v57
  v_accvgpr_read_b32 v57, a46
  v_mul_f32 v57, v57, v58
  v_accvgpr_write_b32 a46, v57
  v_accvgpr_read_b32 v57, a47
  v_mul_f32 v57, v57, v58
  v_accvgpr_write_b32 a47, v57
  v_accvgpr_read_b32 v57, a48
  v_mul_f32 v57, v57, v58
  v_accvgpr_write_b32 a48, v57
  v_accvgpr_read_b32 v57, a49
  v_mul_f32 v57, v57, v58
  v_accvgpr_write_b32 a49, v57
  v_accvgpr_read_b32 v57, a50
  v_mul_f32 v57, v57, v58
  v_accvgpr_write_b32 a50, v57
  v_accvgpr_read_b32 v57, a51
  v_mul_f32 v57, v57, v58
  v_accvgpr_write_b32 a51, v57
  v_accvgpr_read_b32 v57, a52
  v_mul_f32 v57, v57, v58
  v_accvgpr_write_b32 a52, v57
  v_accvgpr_read_b32 v57, a53
  v_mul_f32 v57, v57, v58
  v_accvgpr_write_b32 a53, v57
  v_accvgpr_read_b32 v57, a54
  v_mul_f32 v57, v57, v58
  v_accvgpr_write_b32 a54, v57
  v_accvgpr_read_b32 v57, a55
  v_mul_f32 v57, v57, v58
  v_accvgpr_write_b32 a55, v57
  v_accvgpr_read_b32 v57, a56
  v_mul_f32 v57, v57, v58
  v_accvgpr_write_b32 a56, v57
  v_accvgpr_read_b32 v57, a57
  v_mul_f32 v57, v57, v58
  v_accvgpr_write_b32 a57, v57
  v_accvgpr_read_b32 v57, a58
  v_mul_f32 v57, v57, v58
  v_accvgpr_write_b32 a58, v57
  v_accvgpr_read_b32 v57, a59
  v_mul_f32 v57, v57, v58
  v_accvgpr_write_b32 a59, v57
  v_accvgpr_read_b32 v57, a60
  v_mul_f32 v57, v57, v58
  v_accvgpr_write_b32 a60, v57
  v_accvgpr_read_b32 v57, a61
  v_mul_f32 v57, v57, v58
  v_accvgpr_write_b32 a61, v57
  v_accvgpr_read_b32 v57, a62
  v_mul_f32 v57, v57, v58
  v_accvgpr_write_b32 a62, v57
  v_accvgpr_read_b32 v57, a63
  v_mul_f32 v57, v57, v58
  v_accvgpr_write_b32 a63, v57
  v_max_f32 v56, v160, v161
  v_max3_f32 v56, v56, v162, v163
  v_max3_f32 v56, v56, v164, v165
  v_max3_f32 v56, v56, v166, v167
  v_max3_f32 v56, v56, v168, v169
  v_max3_f32 v56, v56, v170, v171
  v_max3_f32 v56, v56, v172, v173
  v_max3_f32 v56, v56, v174, v175
  v_mov_b32 v57, v56
  s_nop 1
  v_permlane32_swap_b32 v56, v57
  s_nop 1
  v_max_f32 v56, v56, v57
  v_mov_b32 v57, v56
  s_nop 1
  v_permlane16_swap_b32 v56, v57
  s_nop 1
  v_max_f32 v56, v56, v57
  v_max_f32 v56, 0, v56
  v_sub_f32 v24, v24, v56
  v_sub_f32 v25, v25, v56
  v_sub_f32 v26, v26, v56
  v_sub_f32 v27, v27, v56
  v_sub_f32 v160, v160, v56
  v_sub_f32 v161, v161, v56
  v_sub_f32 v162, v162, v56
  v_sub_f32 v163, v163, v56
  v_sub_f32 v164, v164, v56
  v_sub_f32 v165, v165, v56
  v_sub_f32 v166, v166, v56
  v_sub_f32 v167, v167, v56
  v_sub_f32 v168, v168, v56
  v_sub_f32 v169, v169, v56
  v_sub_f32 v170, v170, v56
  v_sub_f32 v171, v171, v56
  v_sub_f32 v172, v172, v56
  v_sub_f32 v173, v173, v56
  v_sub_f32 v174, v174, v56
  v_sub_f32 v175, v175, v56
  v_sub_f32 v96, v96, v56
  v_sub_f32 v97, v97, v56
  v_sub_f32 v98, v98, v56
  v_sub_f32 v99, v99, v56
  v_sub_f32 v100, v100, v56
  v_sub_f32 v101, v101, v56
  v_sub_f32 v102, v102, v56
  v_sub_f32 v103, v103, v56
  v_sub_f32 v104, v104, v56
  v_sub_f32 v105, v105, v56
  v_sub_f32 v106, v106, v56
  v_sub_f32 v107, v107, v56
  v_sub_f32 v108, v108, v56
  v_sub_f32 v109, v109, v56
  v_sub_f32 v110, v110, v56
  v_sub_f32 v111, v111, v56
  v_sub_f32 v58, 0, v56
  v_exp_f32 v58, v58
  s_nop 0
  v_mul_f32 v40, v40, v58
  v_mul_f32 v41, v41, v58
  v_mul_f32 v42, v42, v58
  v_mul_f32 v43, v43, v58
  v_accvgpr_read_b32 v57, a64
  v_mul_f32 v57, v57, v58
  v_accvgpr_write_b32 a64, v57
  v_accvgpr_read_b32 v57, a65
  v_mul_f32 v57, v57, v58
  v_accvgpr_write_b32 a65, v57
  v_accvgpr_read_b32 v57, a66
  v_mul_f32 v57, v57, v58
  v_accvgpr_write_b32 a66, v57
  v_accvgpr_read_b32 v57, a67
  v_mul_f32 v57, v57, v58
  v_accvgpr_write_b32 a67, v57
  v_accvgpr_read_b32 v57, a68
  v_mul_f32 v57, v57, v58
  v_accvgpr_write_b32 a68, v57
  v_accvgpr_read_b32 v57, a69
  v_mul_f32 v57, v57, v58
  v_accvgpr_write_b32 a69, v57
  v_accvgpr_read_b32 v57, a70
  v_mul_f32 v57, v57, v58
  v_accvgpr_write_b32 a70, v57
  v_accvgpr_read_b32 v57, a71
  v_mul_f32 v57, v57, v58
  v_accvgpr_write_b32 a71, v57
  v_accvgpr_read_b32 v57, a72
  v_mul_f32 v57, v57, v58
  v_accvgpr_write_b32 a72, v57
  v_accvgpr_read_b32 v57, a73
  v_mul_f32 v57, v57, v58
  v_accvgpr_write_b32 a73, v57
  v_accvgpr_read_b32 v57, a74
  v_mul_f32 v57, v57, v58
  v_accvgpr_write_b32 a74, v57
  v_accvgpr_read_b32 v57, a75
  v_mul_f32 v57, v57, v58
  v_accvgpr_write_b32 a75, v57
  v_accvgpr_read_b32 v57, a76
  v_mul_f32 v57, v57, v58
  v_accvgpr_write_b32 a76, v57
  v_accvgpr_read_b32 v57, a77
  v_mul_f32 v57, v57, v58
  v_accvgpr_write_b32 a77, v57
  v_accvgpr_read_b32 v57, a78
  v_mul_f32 v57, v57, v58
  v_accvgpr_write_b32 a78, v57
  v_accvgpr_read_b32 v57, a79
  v_mul_f32 v57, v57, v58
  v_accvgpr_write_b32 a79, v57
  v_accvgpr_read_b32 v57, a80
  v_mul_f32 v57, v57, v58
  v_accvgpr_write_b32 a80, v57
  v_accvgpr_read_b32 v57, a81
  v_mul_f32 v57, v57, v58
  v_accvgpr_write_b32 a81, v57
  v_accvgpr_read_b32 v57, a82
  v_mul_f32 v57, v57, v58
  v_accvgpr_write_b32 a82, v57
  v_accvgpr_read_b32 v57, a83
  v_mul_f32 v57, v57, v58
  v_accvgpr_write_b32 a83, v57
  v_accvgpr_read_b32 v57, a84
  v_mul_f32 v57, v57, v58
  v_accvgpr_write_b32 a84, v57
  v_accvgpr_read_b32 v57, a85
  v_mul_f32 v57, v57, v58
  v_accvgpr_write_b32 a85, v57
  v_accvgpr_read_b32 v57, a86
  v_mul_f32 v57, v57, v58
  v_accvgpr_write_b32 a86, v57
  v_accvgpr_read_b32 v57, a87
  v_mul_f32 v57, v57, v58
  v_accvgpr_write_b32 a87, v57
  v_accvgpr_read_b32 v57, a88
  v_mul_f32 v57, v57, v58
  v_accvgpr_write_b32 a88, v57
  v_accvgpr_read_b32 v57, a89
  v_mul_f32 v57, v57, v58
  v_accvgpr_write_b32 a89, v57
  v_accvgpr_read_b32 v57, a90
  v_mul_f32 v57, v57, v58
  v_accvgpr_write_b32 a90, v57
  v_accvgpr_read_b32 v57, a91
  v_mul_f32 v57, v57, v58
  v_accvgpr_write_b32 a91, v57
  v_accvgpr_read_b32 v57, a92
  v_mul_f32 v57, v57, v58
  v_accvgpr_write_b32 a92, v57
  v_accvgpr_read_b32 v57, a93
  v_mul_f32 v57, v57, v58
  v_accvgpr_write_b32 a93, v57
  v_accvgpr_read_b32 v57, a94
  v_mul_f32 v57, v57, v58
  v_accvgpr_write_b32 a94, v57
  v_accvgpr_read_b32 v57, a95
  v_mul_f32 v57, v57, v58
  v_accvgpr_write_b32 a95, v57
  v_max_f32 v56, v176, v177
  v_max3_f32 v56, v56, v178, v179
  v_max3_f32 v56, v56, v180, v181
  v_max3_f32 v56, v56, v182, v183
  v_max3_f32 v56, v56, v184, v185
  v_max3_f32 v56, v56, v186, v187
  v_max3_f32 v56, v56, v188, v189
  v_max3_f32 v56, v56, v190, v191
  v_mov_b32 v57, v56
  s_nop 1
  v_permlane32_swap_b32 v56, v57
  s_nop 1
  v_max_f32 v56, v56, v57
  v_mov_b32 v57, v56
  s_nop 1
  v_permlane16_swap_b32 v56, v57
  s_nop 1
  v_max_f32 v56, v56, v57
  v_max_f32 v56, 0, v56
  v_sub_f32 v28, v28, v56
  v_sub_f32 v29, v29, v56
  v_sub_f32 v30, v30, v56
  v_sub_f32 v31, v31, v56
  v_sub_f32 v176, v176, v56
  v_sub_f32 v177, v177, v56
  v_sub_f32 v178, v178, v56
  v_sub_f32 v179, v179, v56
  v_sub_f32 v180, v180, v56
  v_sub_f32 v181, v181, v56
  v_sub_f32 v182, v182, v56
  v_sub_f32 v183, v183, v56
  v_sub_f32 v184, v184, v56
  v_sub_f32 v185, v185, v56
  v_sub_f32 v186, v186, v56
  v_sub_f32 v187, v187, v56
  v_sub_f32 v188, v188, v56
  v_sub_f32 v189, v189, v56
  v_sub_f32 v190, v190, v56
  v_sub_f32 v191, v191, v56
  v_sub_f32 v112, v112, v56
  v_sub_f32 v113, v113, v56
  v_sub_f32 v114, v114, v56
  v_sub_f32 v115, v115, v56
  v_sub_f32 v116, v116, v56
  v_sub_f32 v117, v117, v56
  v_sub_f32 v118, v118, v56
  v_sub_f32 v119, v119, v56
  v_sub_f32 v120, v120, v56
  v_sub_f32 v121, v121, v56
  v_sub_f32 v122, v122, v56
  v_sub_f32 v123, v123, v56
  v_sub_f32 v124, v124, v56
  v_sub_f32 v125, v125, v56
  v_sub_f32 v126, v126, v56
  v_sub_f32 v127, v127, v56
  v_sub_f32 v58, 0, v56
  v_exp_f32 v58, v58
  s_nop 0
  v_mul_f32 v44, v44, v58
  v_mul_f32 v45, v45, v58
  v_mul_f32 v46, v46, v58
  v_mul_f32 v47, v47, v58
  v_accvgpr_read_b32 v57, a96
  v_mul_f32 v57, v57, v58
  v_accvgpr_write_b32 a96, v57
  v_accvgpr_read_b32 v57, a97
  v_mul_f32 v57, v57, v58
  v_accvgpr_write_b32 a97, v57
  v_accvgpr_read_b32 v57, a98
  v_mul_f32 v57, v57, v58
  v_accvgpr_write_b32 a98, v57
  v_accvgpr_read_b32 v57, a99
  v_mul_f32 v57, v57, v58
  v_accvgpr_write_b32 a99, v57
  v_accvgpr_read_b32 v57, a100
  v_mul_f32 v57, v57, v58
  v_accvgpr_write_b32 a100, v57
  v_accvgpr_read_b32 v57, a101
  v_mul_f32 v57, v57, v58
  v_accvgpr_write_b32 a101, v57
  v_accvgpr_read_b32 v57, a102
  v_mul_f32 v57, v57, v58
  v_accvgpr_write_b32 a102, v57
  v_accvgpr_read_b32 v57, a103
  v_mul_f32 v57, v57, v58
  v_accvgpr_write_b32 a103, v57
  v_accvgpr_read_b32 v57, a104
  v_mul_f32 v57, v57, v58
  v_accvgpr_write_b32 a104, v57
  v_accvgpr_read_b32 v57, a105
  v_mul_f32 v57, v57, v58
  v_accvgpr_write_b32 a105, v57
  v_accvgpr_read_b32 v57, a106
  v_mul_f32 v57, v57, v58
  v_accvgpr_write_b32 a106, v57
  v_accvgpr_read_b32 v57, a107
  v_mul_f32 v57, v57, v58
  v_accvgpr_write_b32 a107, v57
  v_accvgpr_read_b32 v57, a108
  v_mul_f32 v57, v57, v58
  v_accvgpr_write_b32 a108, v57
  v_accvgpr_read_b32 v57, a109
  v_mul_f32 v57, v57, v58
  v_accvgpr_write_b32 a109, v57
  v_accvgpr_read_b32 v57, a110
  v_mul_f32 v57, v57, v58
  v_accvgpr_write_b32 a110, v57
  v_accvgpr_read_b32 v57, a111
  v_mul_f32 v57, v57, v58
  v_accvgpr_write_b32 a111, v57
  v_accvgpr_read_b32 v57, a112
  v_mul_f32 v57, v57, v58
  v_accvgpr_write_b32 a112, v57
  v_accvgpr_read_b32 v57, a113
  v_mul_f32 v57, v57, v58
  v_accvgpr_write_b32 a113, v57
  v_accvgpr_read_b32 v57, a114
  v_mul_f32 v57, v57, v58
  v_accvgpr_write_b32 a114, v57
  v_accvgpr_read_b32 v57, a115
  v_mul_f32 v57, v57, v58
  v_accvgpr_write_b32 a115, v57
  v_accvgpr_read_b32 v57, a116
  v_mul_f32 v57, v57, v58
  v_accvgpr_write_b32 a116, v57
  v_accvgpr_read_b32 v57, a117
  v_mul_f32 v57, v57, v58
  v_accvgpr_write_b32 a117, v57
  v_accvgpr_read_b32 v57, a118
  v_mul_f32 v57, v57, v58
  v_accvgpr_write_b32 a118, v57
  v_accvgpr_read_b32 v57, a119
  v_mul_f32 v57, v57, v58
  v_accvgpr_write_b32 a119, v57
  v_accvgpr_read_b32 v57, a120
  v_mul_f32 v57, v57, v58
  v_accvgpr_write_b32 a120, v57
  v_accvgpr_read_b32 v57, a121
  v_mul_f32 v57, v57, v58
  v_accvgpr_write_b32 a121, v57
  v_accvgpr_read_b32 v57, a122
  v_mul_f32 v57, v57, v58
  v_accvgpr_write_b32 a122, v57
  v_accvgpr_read_b32 v57, a123
  v_mul_f32 v57, v57, v58
  v_accvgpr_write_b32 a123, v57
  v_accvgpr_read_b32 v57, a124
  v_mul_f32 v57, v57, v58
  v_accvgpr_write_b32 a124, v57
  v_accvgpr_read_b32 v57, a125
  v_mul_f32 v57, v57, v58
  v_accvgpr_write_b32 a125, v57
  v_accvgpr_read_b32 v57, a126
  v_mul_f32 v57, v57, v58
  v_accvgpr_write_b32 a126, v57
  v_accvgpr_read_b32 v57, a127
  v_mul_f32 v57, v57, v58
  v_accvgpr_write_b32 a127, v57
  v_exp_f32 v48, v128
  v_exp_f32 v49, v129
  v_exp_f32 v50, v130
  v_exp_f32 v51, v131
  v_cvt_pk_bf16_f32 v224, v48, v49
  v_exp_f32 v52, v132
  v_exp_f32 v53, v133
  v_cvt_pk_bf16_f32 v225, v50, v51
  v_pk_maximum3_f16 v11, v224, v224, v225
  v_exp_f32 v54, v134
  v_exp_f32 v55, v135
  v_cvt_pk_bf16_f32 v226, v52, v53
  v_exp_f32 v48, v144
  v_exp_f32 v49, v145
  v_cvt_pk_bf16_f32 v227, v54, v55
  v_pk_maximum3_f16 v11, v11, v226, v227
  v_exp_f32 v50, v146
  v_exp_f32 v51, v147
  v_cvt_pk_bf16_f32 v232, v48, v49
  v_exp_f32 v52, v148
  v_exp_f32 v53, v149
  v_cvt_pk_bf16_f32 v233, v50, v51
  v_pk_maximum3_f16 v11, v11, v232, v233
  v_exp_f32 v54, v150
  v_exp_f32 v55, v151
  v_cvt_pk_bf16_f32 v234, v52, v53
  v_exp_f32 v48, v160
  v_exp_f32 v49, v161
  v_cvt_pk_bf16_f32 v235, v54, v55
  v_pk_maximum3_f16 v11, v11, v234, v235
  v_exp_f32 v50, v162
  v_exp_f32 v51, v163
  v_cvt_pk_bf16_f32 v240, v48, v49
  v_exp_f32 v52, v164
  v_exp_f32 v53, v165
  v_cvt_pk_bf16_f32 v241, v50, v51
  v_pk_maximum3_f16 v11, v11, v240, v241
  v_exp_f32 v54, v166
  v_exp_f32 v55, v167
  v_cvt_pk_bf16_f32 v242, v52, v53
  v_exp_f32 v48, v176
  v_exp_f32 v49, v177
  v_cvt_pk_bf16_f32 v243, v54, v55
  v_pk_maximum3_f16 v11, v11, v242, v243
  v_exp_f32 v50, v178
  v_exp_f32 v51, v179
  v_cvt_pk_bf16_f32 v248, v48, v49
  v_exp_f32 v52, v180
  v_exp_f32 v53, v181
  v_cvt_pk_bf16_f32 v249, v50, v51
  v_pk_maximum3_f16 v11, v11, v248, v249
  v_exp_f32 v54, v182
  v_exp_f32 v55, v183
  v_cvt_pk_bf16_f32 v250, v52, v53
  v_exp_f32 v48, v136
  v_exp_f32 v49, v137
  v_cvt_pk_bf16_f32 v251, v54, v55
  v_pk_maximum3_f16 v11, v11, v250, v251
  v_exp_f32 v50, v138
  v_exp_f32 v51, v139
  v_cvt_pk_bf16_f32 v228, v48, v49
  v_exp_f32 v52, v140
  v_exp_f32 v53, v141
  v_cvt_pk_bf16_f32 v229, v50, v51
  v_pk_maximum3_f16 v11, v11, v228, v229
  v_exp_f32 v54, v142
  v_exp_f32 v55, v143
  v_cvt_pk_bf16_f32 v230, v52, v53
  v_exp_f32 v48, v152
  v_exp_f32 v49, v153
  v_cvt_pk_bf16_f32 v231, v54, v55
  v_pk_maximum3_f16 v11, v11, v230, v231
  v_exp_f32 v50, v154
  v_exp_f32 v51, v155
  v_cvt_pk_bf16_f32 v236, v48, v49
  v_exp_f32 v52, v156
  v_exp_f32 v53, v157
  v_cvt_pk_bf16_f32 v237, v50, v51
  v_pk_maximum3_f16 v11, v11, v236, v237
  v_exp_f32 v54, v158
  v_exp_f32 v55, v159
  v_cvt_pk_bf16_f32 v238, v52, v53
  v_exp_f32 v48, v168
  v_exp_f32 v49, v169
  v_cvt_pk_bf16_f32 v239, v54, v55
  v_pk_maximum3_f16 v11, v11, v238, v239
  v_exp_f32 v50, v170
  v_exp_f32 v51, v171
  v_cvt_pk_bf16_f32 v244, v48, v49
  v_exp_f32 v52, v172
  v_exp_f32 v53, v173
  v_cvt_pk_bf16_f32 v245, v50, v51
  v_pk_maximum3_f16 v11, v11, v244, v245
  v_exp_f32 v54, v174
  v_exp_f32 v55, v175
  v_cvt_pk_bf16_f32 v246, v52, v53
  v_exp_f32 v48, v184
  v_exp_f32 v49, v185
  v_cvt_pk_bf16_f32 v247, v54, v55
  v_pk_maximum3_f16 v11, v11, v246, v247
  v_exp_f32 v50, v186
  v_exp_f32 v51, v187
  v_cvt_pk_bf16_f32 v252, v48, v49
  v_exp_f32 v52, v188
  v_exp_f32 v53, v189
  v_cvt_pk_bf16_f32 v253, v50, v51
  v_pk_maximum3_f16 v11, v11, v252, v253
  v_exp_f32 v54, v190
  v_exp_f32 v55, v191
  v_cvt_pk_bf16_f32 v254, v52, v53
  s_nop 0
  v_cvt_pk_bf16_f32 v255, v54, v55
  v_pk_maximum3_f16 v11, v11, v254, v255
  s_nop 3
  s_branch K2_ret_D
K2_rare_E:
  s_nop 15
  s_nop 15
  v_max_f32 v56, v64, v65
  v_max3_f32 v56, v56, v66, v67
  v_max3_f32 v56, v56, v68, v69
  v_max3_f32 v56, v56, v70, v71
  v_max3_f32 v56, v56, v72, v73
  v_max3_f32 v56, v56, v74, v75
  v_max3_f32 v56, v56, v76, v77
  v_max3_f32 v56, v56, v78, v79
  v_mov_b32 v57, v56
  s_nop 1
  v_permlane32_swap_b32 v56, v57
  s_nop 1
  v_max_f32 v56, v56, v57
  v_mov_b32 v57, v56
  s_nop 1
  v_permlane16_swap_b32 v56, v57
  s_nop 1
  v_max_f32 v56, v56, v57
  v_max_f32 v56, 0, v56
  v_sub_f32 v16, v16, v56
  v_sub_f32 v17, v17, v56
  v_sub_f32 v18, v18, v56
  v_sub_f32 v19, v19, v56
  v_sub_f32 v64, v64, v56
  v_sub_f32 v65, v65, v56
  v_sub_f32 v66, v66, v56
  v_sub_f32 v67, v67, v56
  v_sub_f32 v68, v68, v56
  v_sub_f32 v69, v69, v56
  v_sub_f32 v70, v70, v56
  v_sub_f32 v71, v71, v56
  v_sub_f32 v72, v72, v56
  v_sub_f32 v73, v73, v56
  v_sub_f32 v74, v74, v56
  v_sub_f32 v75, v75, v56
  v_sub_f32 v76, v76, v56
  v_sub_f32 v77, v77, v56
  v_sub_f32 v78, v78, v56
  v_sub_f32 v79, v79, v56
  v_sub_f32 v128, v128, v56
  v_sub_f32 v129, v129, v56
  v_sub_f32 v130, v130, v56
  v_sub_f32 v131, v131, v56
  v_sub_f32 v132, v132, v56
  v_sub_f32 v133, v133, v56
  v_sub_f32 v134, v134, v56
  v_sub_f32 v135, v135, v56
  v_sub_f32 v136, v136, v56
  v_sub_f32 v137, v137, v56
  v_sub_f32 v138, v138, v56
  v_sub_f32 v139, v139, v56
  v_sub_f32 v140, v140, v56
  v_sub_f32 v141, v141, v56
  v_sub_f32 v142, v142, v56
  v_sub_f32 v143, v143, v56
  v_sub_f32 v58, 0, v56
  v_exp_f32 v58, v58
  s_nop 0
  v_mul_f32 v32, v32, v58
  v_mul_f32 v33, v33, v58
  v_mul_f32 v34, v34, v58
  v_mul_f32 v35, v35, v58
  v_accvgpr_read_b32 v57, a0
  v_mul_f32 v57, v57, v58
  v_accvgpr_write_b32 a0, v57
  v_accvgpr_read_b32 v57, a1
  v_mul_f32 v57, v57, v58
  v_accvgpr_write_b32 a1, v57
  v_accvgpr_read_b32 v57, a2
  v_mul_f32 v57, v57, v58
  v_accvgpr_write_b32 a2, v57
  v_accvgpr_read_b32 v57, a3
  v_mul_f32 v57, v57, v58
  v_accvgpr_write_b32 a3, v57
  v_accvgpr_read_b32 v57, a4
  v_mul_f32 v57, v57, v58
  v_accvgpr_write_b32 a4, v57
  v_accvgpr_read_b32 v57, a5
  v_mul_f32 v57, v57, v58
  v_accvgpr_write_b32 a5, v57
  v_accvgpr_read_b32 v57, a6
  v_mul_f32 v57, v57, v58
  v_accvgpr_write_b32 a6, v57
  v_accvgpr_read_b32 v57, a7
  v_mul_f32 v57, v57, v58
  v_accvgpr_write_b32 a7, v57
  v_accvgpr_read_b32 v57, a8
  v_mul_f32 v57, v57, v58
  v_accvgpr_write_b32 a8, v57
  v_accvgpr_read_b32 v57, a9
  v_mul_f32 v57, v57, v58
  v_accvgpr_write_b32 a9, v57
  v_accvgpr_read_b32 v57, a10
  v_mul_f32 v57, v57, v58
  v_accvgpr_write_b32 a10, v57
  v_accvgpr_read_b32 v57, a11
  v_mul_f32 v57, v57, v58
  v_accvgpr_write_b32 a11, v57
  v_accvgpr_read_b32 v57, a12
  v_mul_f32 v57, v57, v58
  v_accvgpr_write_b32 a12, v57
  v_accvgpr_read_b32 v57, a13
  v_mul_f32 v57, v57, v58
  v_accvgpr_write_b32 a13, v57
  v_accvgpr_read_b32 v57, a14
  v_mul_f32 v57, v57, v58
  v_accvgpr_write_b32 a14, v57
  v_accvgpr_read_b32 v57, a15
  v_mul_f32 v57, v57, v58
  v_accvgpr_write_b32 a15, v57
  v_accvgpr_read_b32 v57, a16
  v_mul_f32 v57, v57, v58
  v_accvgpr_write_b32 a16, v57
  v_accvgpr_read_b32 v57, a17
  v_mul_f32 v57, v57, v58
  v_accvgpr_write_b32 a17, v57
  v_accvgpr_read_b32 v57, a18
  v_mul_f32 v57, v57, v58
  v_accvgpr_write_b32 a18, v57
  v_accvgpr_read_b32 v57, a19
  v_mul_f32 v57, v57, v58
  v_accvgpr_write_b32 a19, v57
  v_accvgpr_read_b32 v57, a20
  v_mul_f32 v57, v57, v58
  v_accvgpr_write_b32 a20, v57
  v_accvgpr_read_b32 v57, a21
  v_mul_f32 v57, v57, v58
  v_accvgpr_write_b32 a21, v57
  v_accvgpr_read_b32 v57, a22
  v_mul_f32 v57, v57, v58
  v_accvgpr_write_b32 a22, v57
  v_accvgpr_read_b32 v57, a23
  v_mul_f32 v57, v57, v58
  v_accvgpr_write_b32 a23, v57
  v_accvgpr_read_b32 v57, a24
  v_mul_f32 v57, v57, v58
  v_accvgpr_write_b32 a24, v57
  v_accvgpr_read_b32 v57, a25
  v_mul_f32 v57, v57, v58
  v_accvgpr_write_b32 a25, v57
  v_accvgpr_read_b32 v57, a26
  v_mul_f32 v57, v57, v58
  v_accvgpr_write_b32 a26, v57
  v_accvgpr_read_b32 v57, a27
  v_mul_f32 v57, v57, v58
  v_accvgpr_write_b32 a27, v57
  v_accvgpr_read_b32 v57, a28
  v_mul_f32 v57, v57, v58
  v_accvgpr_write_b32 a28, v57
  v_accvgpr_read_b32 v57, a29
  v_mul_f32 v57, v57, v58
  v_accvgpr_write_b32 a29, v57
  v_accvgpr_read_b32 v57, a30
  v_mul_f32 v57, v57, v58
  v_accvgpr_write_b32 a30, v57
  v_accvgpr_read_b32 v57, a31
  v_mul_f32 v57, v57, v58
  v_accvgpr_write_b32 a31, v57
  v_max_f32 v56, v80, v81
  v_max3_f32 v56, v56, v82, v83
  v_max3_f32 v56, v56, v84, v85
  v_max3_f32 v56, v56, v86, v87
  v_max3_f32 v56, v56, v88, v89
  v_max3_f32 v56, v56, v90, v91
  v_max3_f32 v56, v56, v92, v93
  v_max3_f32 v56, v56, v94, v95
  v_mov_b32 v57, v56
  s_nop 1
  v_permlane32_swap_b32 v56, v57
  s_nop 1
  v_max_f32 v56, v56, v57
  v_mov_b32 v57, v56
  s_nop 1
  v_permlane16_swap_b32 v56, v57
  s_nop 1
  v_max_f32 v56, v56, v57
  v_max_f32 v56, 0, v56
  v_sub_f32 v20, v20, v56
  v_sub_f32 v21, v21, v56
  v_sub_f32 v22, v22, v56
  v_sub_f32 v23, v23, v56
  v_sub_f32 v80, v80, v56
  v_sub_f32 v81, v81, v56
  v_sub_f32 v82, v82, v56
  v_sub_f32 v83, v83, v56
  v_sub_f32 v84, v84, v56
  v_sub_f32 v85, v85, v56
  v_sub_f32 v86, v86, v56
  v_sub_f32 v87, v87, v56
  v_sub_f32 v88, v88, v56
  v_sub_f32 v89, v89, v56
  v_sub_f32 v90, v90, v56
  v_sub_f32 v91, v91, v56
  v_sub_f32 v92, v92, v56
  v_sub_f32 v93, v93, v56
  v_sub_f32 v94, v94, v56
  v_sub_f32 v95, v95, v56
  v_sub_f32 v144, v144, v56
  v_sub_f32 v145, v145, v56
  v_sub_f32 v146, v146, v56
  v_sub_f32 v147, v147, v56
  v_sub_f32 v148, v148, v56
  v_sub_f32 v149, v149, v56
  v_sub_f32 v150, v150, v56
  v_sub_f32 v151, v151, v56
  v_sub_f32 v152, v152, v56
  v_sub_f32 v153, v153, v56
  v_sub_f32 v154, v154, v56
  v_sub_f32 v155, v155, v56
  v_sub_f32 v156, v156, v56
  v_sub_f32 v157, v157, v56
  v_sub_f32 v158, v158, v56
  v_sub_f32 v159, v159, v56
  v_sub_f32 v58, 0, v56
  v_exp_f32 v58, v58
  s_nop 0
  v_mul_f32 v36, v36, v58
  v_mul_f32 v37, v37, v58
  v_mul_f32 v38, v38, v58
  v_mul_f32 v39, v39, v58
  v_accvgpr_read_b32 v57, a32
  v_mul_f32 v57, v57, v58
  v_accvgpr_write_b32 a32, v57
  v_accvgpr_read_b32 v57, a33
  v_mul_f32 v57, v57, v58
  v_accvgpr_write_b32 a33, v57
  v_accvgpr_read_b32 v57, a34
  v_mul_f32 v57, v57, v58
  v_accvgpr_write_b32 a34, v57
  v_accvgpr_read_b32 v57, a35
  v_mul_f32 v57, v57, v58
  v_accvgpr_write_b32 a35, v57
  v_accvgpr_read_b32 v57, a36
  v_mul_f32 v57, v57, v58
  v_accvgpr_write_b32 a36, v57
  v_accvgpr_read_b32 v57, a37
  v_mul_f32 v57, v57, v58
  v_accvgpr_write_b32 a37, v57
  v_accvgpr_read_b32 v57, a38
  v_mul_f32 v57, v57, v58
  v_accvgpr_write_b32 a38, v57
  v_accvgpr_read_b32 v57, a39
  v_mul_f32 v57, v57, v58
  v_accvgpr_write_b32 a39, v57
  v_accvgpr_read_b32 v57, a40
  v_mul_f32 v57, v57, v58
  v_accvgpr_write_b32 a40, v57
  v_accvgpr_read_b32 v57, a41
  v_mul_f32 v57, v57, v58
  v_accvgpr_write_b32 a41, v57
  v_accvgpr_read_b32 v57, a42
  v_mul_f32 v57, v57, v58
  v_accvgpr_write_b32 a42, v57
  v_accvgpr_read_b32 v57, a43
  v_mul_f32 v57, v57, v58
  v_accvgpr_write_b32 a43, v57
  v_accvgpr_read_b32 v57, a44
  v_mul_f32 v57, v57, v58
  v_accvgpr_write_b32 a44, v57
  v_accvgpr_read_b32 v57, a45
  v_mul_f32 v57, v57, v58
  v_accvgpr_write_b32 a45, v57
  v_accvgpr_read_b32 v57, a46
  v_mul_f32 v57, v57, v58
  v_accvgpr_write_b32 a46, v57
  v_accvgpr_read_b32 v57, a47
  v_mul_f32 v57, v57, v58
  v_accvgpr_write_b32 a47, v57
  v_accvgpr_read_b32 v57, a48
  v_mul_f32 v57, v57, v58
  v_accvgpr_write_b32 a48, v57
  v_accvgpr_read_b32 v57, a49
  v_mul_f32 v57, v57, v58
  v_accvgpr_write_b32 a49, v57
  v_accvgpr_read_b32 v57, a50
  v_mul_f32 v57, v57, v58
  v_accvgpr_write_b32 a50, v57
  v_accvgpr_read_b32 v57, a51
  v_mul_f32 v57, v57, v58
  v_accvgpr_write_b32 a51, v57
  v_accvgpr_read_b32 v57, a52
  v_mul_f32 v57, v57, v58
  v_accvgpr_write_b32 a52, v57
  v_accvgpr_read_b32 v57, a53
  v_mul_f32 v57, v57, v58
  v_accvgpr_write_b32 a53, v57
  v_accvgpr_read_b32 v57, a54
  v_mul_f32 v57, v57, v58
  v_accvgpr_write_b32 a54, v57
  v_accvgpr_read_b32 v57, a55
  v_mul_f32 v57, v57, v58
  v_accvgpr_write_b32 a55, v57
  v_accvgpr_read_b32 v57, a56
  v_mul_f32 v57, v57, v58
  v_accvgpr_write_b32 a56, v57
  v_accvgpr_read_b32 v57, a57
  v_mul_f32 v57, v57, v58
  v_accvgpr_write_b32 a57, v57
  v_accvgpr_read_b32 v57, a58
  v_mul_f32 v57, v57, v58
  v_accvgpr_write_b32 a58, v57
  v_accvgpr_read_b32 v57, a59
  v_mul_f32 v57, v57, v58
  v_accvgpr_write_b32 a59, v57
  v_accvgpr_read_b32 v57, a60
  v_mul_f32 v57, v57, v58
  v_accvgpr_write_b32 a60, v57
  v_accvgpr_read_b32 v57, a61
  v_mul_f32 v57, v57, v58
  v_accvgpr_write_b32 a61, v57
  v_accvgpr_read_b32 v57, a62
  v_mul_f32 v57, v57, v58
  v_accvgpr_write_b32 a62, v57
  v_accvgpr_read_b32 v57, a63
  v_mul_f32 v57, v57, v58
  v_accvgpr_write_b32 a63, v57
  v_max_f32 v56, v96, v97
  v_max3_f32 v56, v56, v98, v99
  v_max3_f32 v56, v56, v100, v101
  v_max3_f32 v56, v56, v102, v103
  v_max3_f32 v56, v56, v104, v105
  v_max3_f32 v56, v56, v106, v107
  v_max3_f32 v56, v56, v108, v109
  v_max3_f32 v56, v56, v110, v111
  v_mov_b32 v57, v56
  s_nop 1
  v_permlane32_swap_b32 v56, v57
  s_nop 1
  v_max_f32 v56, v56, v57
  v_mov_b32 v57, v56
  s_nop 1
  v_permlane16_swap_b32 v56, v57
  s_nop 1
  v_max_f32 v56, v56, v57
  v_max_f32 v56, 0, v56
  v_sub_f32 v24, v24, v56
  v_sub_f32 v25, v25, v56
  v_sub_f32 v26, v26, v56
  v_sub_f32 v27, v27, v56
  v_sub_f32 v96, v96, v56
  v_sub_f32 v97, v97, v56
  v_sub_f32 v98, v98, v56
  v_sub_f32 v99, v99, v56
  v_sub_f32 v100, v100, v56
  v_sub_f32 v101, v101, v56
  v_sub_f32 v102, v102, v56
  v_sub_f32 v103, v103, v56
  v_sub_f32 v104, v104, v56
  v_sub_f32 v105, v105, v56
  v_sub_f32 v106, v106, v56
  v_sub_f32 v107, v107, v56
  v_sub_f32 v108, v108, v56
  v_sub_f32 v109, v109, v56
  v_sub_f32 v110, v110, v56
  v_sub_f32 v111, v111, v56
  v_sub_f32 v160, v160, v56
  v_sub_f32 v161, v161, v56
  v_sub_f32 v162, v162, v56
  v_sub_f32 v163, v163, v56
  v_sub_f32 v164, v164, v56
  v_sub_f32 v165, v165, v56
  v_sub_f32 v166, v166, v56
  v_sub_f32 v167, v167, v56
  v_sub_f32 v168, v168, v56
  v_sub_f32 v169, v169, v56
  v_sub_f32 v170, v170, v56
  v_sub_f32 v171, v171, v56
  v_sub_f32 v172, v172, v56
  v_sub_f32 v173, v173, v56
  v_sub_f32 v174, v174, v56
  v_sub_f32 v175, v175, v56
  v_sub_f32 v58, 0, v56
  v_exp_f32 v58, v58
  s_nop 0
  v_mul_f32 v40, v40, v58
  v_mul_f32 v41, v41, v58
  v_mul_f32 v42, v42, v58
  v_mul_f32 v43, v43, v58
  v_accvgpr_read_b32 v57, a64
  v_mul_f32 v57, v57, v58
  v_accvgpr_write_b32 a64, v57
  v_accvgpr_read_b32 v57, a65
  v_mul_f32 v57, v57, v58
  v_accvgpr_write_b32 a65, v57
  v_accvgpr_read_b32 v57, a66
  v_mul_f32 v57, v57, v58
  v_accvgpr_write_b32 a66, v57
  v_accvgpr_read_b32 v57, a67
  v_mul_f32 v57, v57, v58
  v_accvgpr_write_b32 a67, v57
  v_accvgpr_read_b32 v57, a68
  v_mul_f32 v57, v57, v58
  v_accvgpr_write_b32 a68, v57
  v_accvgpr_read_b32 v57, a69
  v_mul_f32 v57, v57, v58
  v_accvgpr_write_b32 a69, v57
  v_accvgpr_read_b32 v57, a70
  v_mul_f32 v57, v57, v58
  v_accvgpr_write_b32 a70, v57
  v_accvgpr_read_b32 v57, a71
  v_mul_f32 v57, v57, v58
  v_accvgpr_write_b32 a71, v57
  v_accvgpr_read_b32 v57, a72
  v_mul_f32 v57, v57, v58
  v_accvgpr_write_b32 a72, v57
  v_accvgpr_read_b32 v57, a73
  v_mul_f32 v57, v57, v58
  v_accvgpr_write_b32 a73, v57
  v_accvgpr_read_b32 v57, a74
  v_mul_f32 v57, v57, v58
  v_accvgpr_write_b32 a74, v57
  v_accvgpr_read_b32 v57, a75
  v_mul_f32 v57, v57, v58
  v_accvgpr_write_b32 a75, v57
  v_accvgpr_read_b32 v57, a76
  v_mul_f32 v57, v57, v58
  v_accvgpr_write_b32 a76, v57
  v_accvgpr_read_b32 v57, a77
  v_mul_f32 v57, v57, v58
  v_accvgpr_write_b32 a77, v57
  v_accvgpr_read_b32 v57, a78
  v_mul_f32 v57, v57, v58
  v_accvgpr_write_b32 a78, v57
  v_accvgpr_read_b32 v57, a79
  v_mul_f32 v57, v57, v58
  v_accvgpr_write_b32 a79, v57
  v_accvgpr_read_b32 v57, a80
  v_mul_f32 v57, v57, v58
  v_accvgpr_write_b32 a80, v57
  v_accvgpr_read_b32 v57, a81
  v_mul_f32 v57, v57, v58
  v_accvgpr_write_b32 a81, v57
  v_accvgpr_read_b32 v57, a82
  v_mul_f32 v57, v57, v58
  v_accvgpr_write_b32 a82, v57
  v_accvgpr_read_b32 v57, a83
  v_mul_f32 v57, v57, v58
  v_accvgpr_write_b32 a83, v57
  v_accvgpr_read_b32 v57, a84
  v_mul_f32 v57, v57, v58
  v_accvgpr_write_b32 a84, v57
  v_accvgpr_read_b32 v57, a85
  v_mul_f32 v57, v57, v58
  v_accvgpr_write_b32 a85, v57
  v_accvgpr_read_b32 v57, a86
  v_mul_f32 v57, v57, v58
  v_accvgpr_write_b32 a86, v57
  v_accvgpr_read_b32 v57, a87
  v_mul_f32 v57, v57, v58
  v_accvgpr_write_b32 a87, v57
  v_accvgpr_read_b32 v57, a88
  v_mul_f32 v57, v57, v58
  v_accvgpr_write_b32 a88, v57
  v_accvgpr_read_b32 v57, a89
  v_mul_f32 v57, v57, v58
  v_accvgpr_write_b32 a89, v57
  v_accvgpr_read_b32 v57, a90
  v_mul_f32 v57, v57, v58
  v_accvgpr_write_b32 a90, v57
  v_accvgpr_read_b32 v57, a91
  v_mul_f32 v57, v57, v58
  v_accvgpr_write_b32 a91, v57
  v_accvgpr_read_b32 v57, a92
  v_mul_f32 v57, v57, v58
  v_accvgpr_write_b32 a92, v57
  v_accvgpr_read_b32 v57, a93
  v_mul_f32 v57, v57, v58
  v_accvgpr_write_b32 a93, v57
  v_accvgpr_read_b32 v57, a94
  v_mul_f32 v57, v57, v58
  v_accvgpr_write_b32 a94, v57
  v_accvgpr_read_b32 v57, a95
  v_mul_f32 v57, v57, v58
  v_accvgpr_write_b32 a95, v57
  v_max_f32 v56, v112, v113
  v_max3_f32 v56, v56, v114, v115
  v_max3_f32 v56, v56, v116, v117
  v_max3_f32 v56, v56, v118, v119
  v_max3_f32 v56, v56, v120, v121
  v_max3_f32 v56, v56, v122, v123
  v_max3_f32 v56, v56, v124, v125
  v_max3_f32 v56, v56, v126, v127
  v_mov_b32 v57, v56
  s_nop 1
  v_permlane32_swap_b32 v56, v57
  s_nop 1
  v_max_f32 v56, v56, v57
  v_mov_b32 v57, v56
  s_nop 1
  v_permlane16_swap_b32 v56, v57
  s_nop 1
  v_max_f32 v56, v56, v57
  v_max_f32 v56, 0, v56
  v_sub_f32 v28, v28, v56
  v_sub_f32 v29, v29, v56
  v_sub_f32 v30, v30, v56
  v_sub_f32 v31, v31, v56
  v_sub_f32 v112, v112, v56
  v_sub_f32 v113, v113, v56
  v_sub_f32 v114, v114, v56
  v_sub_f32 v115, v115, v56
  v_sub_f32 v116, v116, v56
  v_sub_f32 v117, v117, v56
  v_sub_f32 v118, v118, v56
  v_sub_f32 v119, v119, v56
  v_sub_f32 v120, v120, v56
  v_sub_f32 v121, v121, v56
  v_sub_f32 v122, v122, v56
  v_sub_f32 v123, v123, v56
  v_sub_f32 v124, v124, v56
  v_sub_f32 v125, v125, v56
  v_sub_f32 v126, v126, v56
  v_sub_f32 v127, v127, v56
  v_sub_f32 v176, v176, v56
  v_sub_f32 v177, v177, v56
  v_sub_f32 v178, v178, v56
  v_sub_f32 v179, v179, v56
  v_sub_f32 v180, v180, v56
  v_sub_f32 v181, v181, v56
  v_sub_f32 v182, v182, v56
  v_sub_f32 v183, v183, v56
  v_sub_f32 v184, v184, v56
  v_sub_f32 v185, v185, v56
  v_sub_f32 v186, v186, v56
  v_sub_f32 v187, v187, v56
  v_sub_f32 v188, v188, v56
  v_sub_f32 v189, v189, v56
  v_sub_f32 v190, v190, v56
  v_sub_f32 v191, v191, v56
  v_sub_f32 v58, 0, v56
  v_exp_f32 v58, v58
  s_nop 0
  v_mul_f32 v44, v44, v58
  v_mul_f32 v45, v45, v58
  v_mul_f32 v46, v46, v58
  v_mul_f32 v47, v47, v58
  v_accvgpr_read_b32 v57, a96
  v_mul_f32 v57, v57, v58
  v_accvgpr_write_b32 a96, v57
  v_accvgpr_read_b32 v57, a97
  v_mul_f32 v57, v57, v58
  v_accvgpr_write_b32 a97, v57
  v_accvgpr_read_b32 v57, a98
  v_mul_f32 v57, v57, v58
  v_accvgpr_write_b32 a98, v57
  v_accvgpr_read_b32 v57, a99
  v_mul_f32 v57, v57, v58
  v_accvgpr_write_b32 a99, v57
  v_accvgpr_read_b32 v57, a100
  v_mul_f32 v57, v57, v58
  v_accvgpr_write_b32 a100, v57
  v_accvgpr_read_b32 v57, a101
  v_mul_f32 v57, v57, v58
  v_accvgpr_write_b32 a101, v57
  v_accvgpr_read_b32 v57, a102
  v_mul_f32 v57, v57, v58
  v_accvgpr_write_b32 a102, v57
  v_accvgpr_read_b32 v57, a103
  v_mul_f32 v57, v57, v58
  v_accvgpr_write_b32 a103, v57
  v_accvgpr_read_b32 v57, a104
  v_mul_f32 v57, v57, v58
  v_accvgpr_write_b32 a104, v57
  v_accvgpr_read_b32 v57, a105
  v_mul_f32 v57, v57, v58
  v_accvgpr_write_b32 a105, v57
  v_accvgpr_read_b32 v57, a106
  v_mul_f32 v57, v57, v58
  v_accvgpr_write_b32 a106, v57
  v_accvgpr_read_b32 v57, a107
  v_mul_f32 v57, v57, v58
  v_accvgpr_write_b32 a107, v57
  v_accvgpr_read_b32 v57, a108
  v_mul_f32 v57, v57, v58
  v_accvgpr_write_b32 a108, v57
  v_accvgpr_read_b32 v57, a109
  v_mul_f32 v57, v57, v58
  v_accvgpr_write_b32 a109, v57
  v_accvgpr_read_b32 v57, a110
  v_mul_f32 v57, v57, v58
  v_accvgpr_write_b32 a110, v57
  v_accvgpr_read_b32 v57, a111
  v_mul_f32 v57, v57, v58
  v_accvgpr_write_b32 a111, v57
  v_accvgpr_read_b32 v57, a112
  v_mul_f32 v57, v57, v58
  v_accvgpr_write_b32 a112, v57
  v_accvgpr_read_b32 v57, a113
  v_mul_f32 v57, v57, v58
  v_accvgpr_write_b32 a113, v57
  v_accvgpr_read_b32 v57, a114
  v_mul_f32 v57, v57, v58
  v_accvgpr_write_b32 a114, v57
  v_accvgpr_read_b32 v57, a115
  v_mul_f32 v57, v57, v58
  v_accvgpr_write_b32 a115, v57
  v_accvgpr_read_b32 v57, a116
  v_mul_f32 v57, v57, v58
  v_accvgpr_write_b32 a116, v57
  v_accvgpr_read_b32 v57, a117
  v_mul_f32 v57, v57, v58
  v_accvgpr_write_b32 a117, v57
  v_accvgpr_read_b32 v57, a118
  v_mul_f32 v57, v57, v58
  v_accvgpr_write_b32 a118, v57
  v_accvgpr_read_b32 v57, a119
  v_mul_f32 v57, v57, v58
  v_accvgpr_write_b32 a119, v57
  v_accvgpr_read_b32 v57, a120
  v_mul_f32 v57, v57, v58
  v_accvgpr_write_b32 a120, v57
  v_accvgpr_read_b32 v57, a121
  v_mul_f32 v57, v57, v58
  v_accvgpr_write_b32 a121, v57
  v_accvgpr_read_b32 v57, a122
  v_mul_f32 v57, v57, v58
  v_accvgpr_write_b32 a122, v57
  v_accvgpr_read_b32 v57, a123
  v_mul_f32 v57, v57, v58
  v_accvgpr_write_b32 a123, v57
  v_accvgpr_read_b32 v57, a124
  v_mul_f32 v57, v57, v58
  v_accvgpr_write_b32 a124, v57
  v_accvgpr_read_b32 v57, a125
  v_mul_f32 v57, v57, v58
  v_accvgpr_write_b32 a125, v57
  v_accvgpr_read_b32 v57, a126
  v_mul_f32 v57, v57, v58
  v_accvgpr_write_b32 a126, v57
  v_accvgpr_read_b32 v57, a127
  v_mul_f32 v57, v57, v58
  v_accvgpr_write_b32 a127, v57
  v_exp_f32 v48, v64
  v_exp_f32 v49, v65
  v_exp_f32 v50, v66
  v_exp_f32 v51, v67
  v_cvt_pk_bf16_f32 v192, v48, v49
  v_exp_f32 v52, v68
  v_exp_f32 v53, v69
  v_cvt_pk_bf16_f32 v193, v50, v51
  v_pk_maximum3_f16 v11, v192, v192, v193
  v_exp_f32 v54, v70
  v_exp_f32 v55, v71
  v_cvt_pk_bf16_f32 v194, v52, v53
  v_exp_f32 v48, v80
  v_exp_f32 v49, v81
  v_cvt_pk_bf16_f32 v195, v54, v55
  v_pk_maximum3_f16 v11, v11, v194, v195
  v_exp_f32 v50, v82
  v_exp_f32 v51, v83
  v_cvt_pk_bf16_f32 v200, v48, v49
  v_exp_f32 v52, v84
  v_exp_f32 v53, v85
  v_cvt_pk_bf16_f32 v201, v50, v51
  v_pk_maximum3_f16 v11, v11, v200, v201
  v_exp_f32 v54, v86
  v_exp_f32 v55, v87
  v_cvt_pk_bf16_f32 v202, v52, v53
  v_exp_f32 v48, v96
  v_exp_f32 v49, v97
  v_cvt_pk_bf16_f32 v203, v54, v55
  v_pk_maximum3_f16 v11, v11, v202, v203
  v_exp_f32 v50, v98
  v_exp_f32 v51, v99
  v_cvt_pk_bf16_f32 v208, v48, v49
  v_exp_f32 v52, v100
  v_exp_f32 v53, v101
  v_cvt_pk_bf16_f32 v209, v50, v51
  v_pk_maximum3_f16 v11, v11, v208, v209
  v_exp_f32 v54, v102
  v_exp_f32 v55, v103
  v_cvt_pk_bf16_f32 v210, v52, v53
  v_exp_f32 v48, v112
  v_exp_f32 v49, v113
  v_cvt_pk_bf16_f32 v211, v54, v55
  v_pk_maximum3_f16 v11, v11, v210, v211
  v_exp_f32 v50, v114
  v_exp_f32 v51, v115
  v_cvt_pk_bf16_f32 v216, v48, v49
  v_exp_f32 v52, v116
  v_exp_f32 v53, v117
  v_cvt_pk_bf16_f32 v217, v50, v51
  v_pk_maximum3_f16 v11, v11, v216, v217
  v_exp_f32 v54, v118
  v_exp_f32 v55, v119
  v_cvt_pk_bf16_f32 v218, v52, v53
  v_exp_f32 v48, v72
  v_exp_f32 v49, v73
  v_cvt_pk_bf16_f32 v219, v54, v55
  v_pk_maximum3_f16 v11, v11, v218, v219
  v_exp_f32 v50, v74
  v_exp_f32 v51, v75
  v_cvt_pk_bf16_f32 v196, v48, v49
  v_exp_f32 v52, v76
  v_exp_f32 v53, v77
  v_cvt_pk_bf16_f32 v197, v50, v51
  v_pk_maximum3_f16 v11, v11, v196, v197
  v_exp_f32 v54, v78
  v_exp_f32 v55, v79
  v_cvt_pk_bf16_f32 v198, v52, v53
  v_exp_f32 v48, v88
  v_exp_f32 v49, v89
  v_cvt_pk_bf16_f32 v199, v54, v55
  v_pk_maximum3_f16 v11, v11, v198, v199
  v_exp_f32 v50, v90
  v_exp_f32 v51, v91
  v_cvt_pk_bf16_f32 v204, v48, v49
  v_exp_f32 v52, v92
  v_exp_f32 v53, v93
  v_cvt_pk_bf16_f32 v205, v50, v51
  v_pk_maximum3_f16 v11, v11, v204, v205
  v_exp_f32 v54, v94
  v_exp_f32 v55, v95
  v_cvt_pk_bf16_f32 v206, v52, v53
  v_exp_f32 v48, v104
  v_exp_f32 v49, v105
  v_cvt_pk_bf16_f32 v207, v54, v55
  v_pk_maximum3_f16 v11, v11, v206, v207
  v_exp_f32 v50, v106
  v_exp_f32 v51, v107
  v_cvt_pk_bf16_f32 v212, v48, v49
  v_exp_f32 v52, v108
  v_exp_f32 v53, v109
  v_cvt_pk_bf16_f32 v213, v50, v51
  v_pk_maximum3_f16 v11, v11, v212, v213
  v_exp_f32 v54, v110
  v_exp_f32 v55, v111
  v_cvt_pk_bf16_f32 v214, v52, v53
  v_exp_f32 v48, v120
  v_exp_f32 v49, v121
  v_cvt_pk_bf16_f32 v215, v54, v55
  v_pk_maximum3_f16 v11, v11, v214, v215
  v_exp_f32 v50, v122
  v_exp_f32 v51, v123
  v_cvt_pk_bf16_f32 v220, v48, v49
  v_exp_f32 v52, v124
  v_exp_f32 v53, v125
  v_cvt_pk_bf16_f32 v221, v50, v51
  v_pk_maximum3_f16 v11, v11, v220, v221
  v_exp_f32 v54, v126
  v_exp_f32 v55, v127
  v_cvt_pk_bf16_f32 v222, v52, v53
  s_nop 0
  v_cvt_pk_bf16_f32 v223, v54, v55
  v_pk_maximum3_f16 v11, v11, v222, v223
  s_nop 3
  s_branch K2_ret_E
K2_rare_F:
  s_nop 15
  s_nop 15
  v_max_f32 v56, v128, v129
  v_max3_f32 v56, v56, v130, v131
  v_max3_f32 v56, v56, v132, v133
  v_max3_f32 v56, v56, v134, v135
  v_max3_f32 v56, v56, v136, v137
  v_max3_f32 v56, v56, v138, v139
  v_max3_f32 v56, v56, v140, v141
  v_max3_f32 v56, v56, v142, v143
  v_mov_b32 v57, v56
  s_nop 1
  v_permlane32_swap_b32 v56, v57
  s_nop 1
  v_max_f32 v56, v56, v57
  v_mov_b32 v57, v56
  s_nop 1
  v_permlane16_swap_b32 v56, v57
  s_nop 1
  v_max_f32 v56, v56, v57
  v_max_f32 v56, 0, v56
  v_sub_f32 v16, v16, v56
  v_sub_f32 v17, v17, v56
  v_sub_f32 v18, v18, v56
  v_sub_f32 v19, v19, v56
  v_sub_f32 v128, v128, v56
  v_sub_f32 v129, v129, v56
  v_sub_f32 v130, v130, v56
  v_sub_f32 v131, v131, v56
  v_sub_f32 v132, v132, v56
  v_sub_f32 v133, v133, v56
  v_sub_f32 v134, v134, v56
  v_sub_f32 v135, v135, v56
  v_sub_f32 v136, v136, v56
  v_sub_f32 v137, v137, v56
  v_sub_f32 v138, v138, v56
  v_sub_f32 v139, v139, v56
  v_sub_f32 v140, v140, v56
  v_sub_f32 v141, v141, v56
  v_sub_f32 v142, v142, v56
  v_sub_f32 v143, v143, v56
  v_sub_f32 v64, v64, v56
  v_sub_f32 v65, v65, v56
  v_sub_f32 v66, v66, v56
  v_sub_f32 v67, v67, v56
  v_sub_f32 v68, v68, v56
  v_sub_f32 v69, v69, v56
  v_sub_f32 v70, v70, v56
  v_sub_f32 v71, v71, v56
  v_sub_f32 v72, v72, v56
  v_sub_f32 v73, v73, v56
  v_sub_f32 v74, v74, v56
  v_sub_f32 v75, v75, v56
  v_sub_f32 v76, v76, v56
  v_sub_f32 v77, v77, v56
  v_sub_f32 v78, v78, v56
  v_sub_f32 v79, v79, v56
  v_sub_f32 v58, 0, v56
  v_exp_f32 v58, v58
  s_nop 0
  v_mul_f32 v32, v32, v58
  v_mul_f32 v33, v33, v58
  v_mul_f32 v34, v34, v58
  v_mul_f32 v35, v35, v58
  v_accvgpr_read_b32 v57, a0
  v_mul_f32 v57, v57, v58
  v_accvgpr_write_b32 a0, v57
  v_accvgpr_read_b32 v57, a1
  v_mul_f32 v57, v57, v58
  v_accvgpr_write_b32 a1, v57
  v_accvgpr_read_b32 v57, a2
  v_mul_f32 v57, v57, v58
  v_accvgpr_write_b32 a2, v57
  v_accvgpr_read_b32 v57, a3
  v_mul_f32 v57, v57, v58
  v_accvgpr_write_b32 a3, v57
  v_accvgpr_read_b32 v57, a4
  v_mul_f32 v57, v57, v58
  v_accvgpr_write_b32 a4, v57
  v_accvgpr_read_b32 v57, a5
  v_mul_f32 v57, v57, v58
  v_accvgpr_write_b32 a5, v57
  v_accvgpr_read_b32 v57, a6
  v_mul_f32 v57, v57, v58
  v_accvgpr_write_b32 a6, v57
  v_accvgpr_read_b32 v57, a7
  v_mul_f32 v57, v57, v58
  v_accvgpr_write_b32 a7, v57
  v_accvgpr_read_b32 v57, a8
  v_mul_f32 v57, v57, v58
  v_accvgpr_write_b32 a8, v57
  v_accvgpr_read_b32 v57, a9
  v_mul_f32 v57, v57, v58
  v_accvgpr_write_b32 a9, v57
  v_accvgpr_read_b32 v57, a10
  v_mul_f32 v57, v57, v58
  v_accvgpr_write_b32 a10, v57
  v_accvgpr_read_b32 v57, a11
  v_mul_f32 v57, v57, v58
  v_accvgpr_write_b32 a11, v57
  v_accvgpr_read_b32 v57, a12
  v_mul_f32 v57, v57, v58
  v_accvgpr_write_b32 a12, v57
  v_accvgpr_read_b32 v57, a13
  v_mul_f32 v57, v57, v58
  v_accvgpr_write_b32 a13, v57
  v_accvgpr_read_b32 v57, a14
  v_mul_f32 v57, v57, v58
  v_accvgpr_write_b32 a14, v57
  v_accvgpr_read_b32 v57, a15
  v_mul_f32 v57, v57, v58
  v_accvgpr_write_b32 a15, v57
  v_accvgpr_read_b32 v57, a16
  v_mul_f32 v57, v57, v58
  v_accvgpr_write_b32 a16, v57
  v_accvgpr_read_b32 v57, a17
  v_mul_f32 v57, v57, v58
  v_accvgpr_write_b32 a17, v57
  v_accvgpr_read_b32 v57, a18
  v_mul_f32 v57, v57, v58
  v_accvgpr_write_b32 a18, v57
  v_accvgpr_read_b32 v57, a19
  v_mul_f32 v57, v57, v58
  v_accvgpr_write_b32 a19, v57
  v_accvgpr_read_b32 v57, a20
  v_mul_f32 v57, v57, v58
  v_accvgpr_write_b32 a20, v57
  v_accvgpr_read_b32 v57, a21
  v_mul_f32 v57, v57, v58
  v_accvgpr_write_b32 a21, v57
  v_accvgpr_read_b32 v57, a22
  v_mul_f32 v57, v57, v58
  v_accvgpr_write_b32 a22, v57
  v_accvgpr_read_b32 v57, a23
  v_mul_f32 v57, v57, v58
  v_accvgpr_write_b32 a23, v57
  v_accvgpr_read_b32 v57, a24
  v_mul_f32 v57, v57, v58
  v_accvgpr_write_b32 a24, v57
  v_accvgpr_read_b32 v57, a25
  v_mul_f32 v57, v57, v58
  v_accvgpr_write_b32 a25, v57
  v_accvgpr_read_b32 v57, a26
  v_mul_f32 v57, v57, v58
  v_accvgpr_write_b32 a26, v57
  v_accvgpr_read_b32 v57, a27
  v_mul_f32 v57, v57, v58
  v_accvgpr_write_b32 a27, v57
  v_accvgpr_read_b32 v57, a28
  v_mul_f32 v57, v57, v58
  v_accvgpr_write_b32 a28, v57
  v_accvgpr_read_b32 v57, a29
  v_mul_f32 v57, v57, v58
  v_accvgpr_write_b32 a29, v57
  v_accvgpr_read_b32 v57, a30
  v_mul_f32 v57, v57, v58
  v_accvgpr_write_b32 a30, v57
  v_accvgpr_read_b32 v57, a31
  v_mul_f32 v57, v57, v58
  v_accvgpr_write_b32 a31, v57
  v_max_f32 v56, v144, v145
  v_max3_f32 v56, v56, v146, v147
  v_max3_f32 v56, v56, v148, v149
  v_max3_f32 v56, v56, v150, v151
  v_max3_f32 v56, v56, v152, v153
  v_max3_f32 v56, v56, v154, v155
  v_max3_f32 v56, v56, v156, v157
  v_max3_f32 v56, v56, v158, v159
  v_mov_b32 v57, v56
  s_nop 1
  v_permlane32_swap_b32 v56, v57
  s_nop 1
  v_max_f32 v56, v56, v57
  v_mov_b32 v57, v56
  s_nop 1
  v_permlane16_swap_b32 v56, v57
  s_nop 1
  v_max_f32 v56, v56, v57
  v_max_f32 v56, 0, v56
  v_sub_f32 v20, v20, v56
  v_sub_f32 v21, v21, v56
  v_sub_f32 v22, v22, v56
  v_sub_f32 v23, v23, v56
  v_sub_f32 v144, v144, v56
  v_sub_f32 v145, v145, v56
  v_sub_f32 v146, v146, v56
  v_sub_f32 v147, v147, v56
  v_sub_f32 v148, v148, v56
  v_sub_f32 v149, v149, v56
  v_sub_f32 v150, v150, v56
  v_sub_f32 v151, v151, v56
  v_sub_f32 v152, v152, v56
  v_sub_f32 v153, v153, v56
  v_sub_f32 v154, v154, v56
  v_sub_f32 v155, v155, v56
  v_sub_f32 v156, v156, v56
  v_sub_f32 v157, v157, v56
  v_sub_f32 v158, v158, v56
  v_sub_f32 v159, v159, v56
  v_sub_f32 v80, v80, v56
  v_sub_f32 v81, v81, v56
  v_sub_f32 v82, v82, v56
  v_sub_f32 v83, v83, v56
  v_sub_f32 v84, v84, v56
  v_sub_f32 v85, v85, v56
  v_sub_f32 v86, v86, v56
  v_sub_f32 v87, v87, v56
  v_sub_f32 v88, v88, v56
  v_sub_f32 v89, v89, v56
  v_sub_f32 v90, v90, v56
  v_sub_f32 v91, v91, v56
  v_sub_f32 v92, v92, v56
  v_sub_f32 v93, v93, v56
  v_sub_f32 v94, v94, v56
  v_sub_f32 v95, v95, v56
  v_sub_f32 v58, 0, v56
  v_exp_f32 v58, v58
  s_nop 0
  v_mul_f32 v36, v36, v58
  v_mul_f32 v37, v37, v58
  v_mul_f32 v38, v38, v58
  v_mul_f32 v39, v39, v58
  v_accvgpr_read_b32 v57, a32
  v_mul_f32 v57, v57, v58
  v_accvgpr_write_b32 a32, v57
  v_accvgpr_read_b32 v57, a33
  v_mul_f32 v57, v57, v58
  v_accvgpr_write_b32 a33, v57
  v_accvgpr_read_b32 v57, a34
  v_mul_f32 v57, v57, v58
  v_accvgpr_write_b32 a34, v57
  v_accvgpr_read_b32 v57, a35
  v_mul_f32 v57, v57, v58
  v_accvgpr_write_b32 a35, v57
  v_accvgpr_read_b32 v57, a36
  v_mul_f32 v57, v57, v58
  v_accvgpr_write_b32 a36, v57
  v_accvgpr_read_b32 v57, a37
  v_mul_f32 v57, v57, v58
  v_accvgpr_write_b32 a37, v57
  v_accvgpr_read_b32 v57, a38
  v_mul_f32 v57, v57, v58
  v_accvgpr_write_b32 a38, v57
  v_accvgpr_read_b32 v57, a39
  v_mul_f32 v57, v57, v58
  v_accvgpr_write_b32 a39, v57
  v_accvgpr_read_b32 v57, a40
  v_mul_f32 v57, v57, v58
  v_accvgpr_write_b32 a40, v57
  v_accvgpr_read_b32 v57, a41
  v_mul_f32 v57, v57, v58
  v_accvgpr_write_b32 a41, v57
  v_accvgpr_read_b32 v57, a42
  v_mul_f32 v57, v57, v58
  v_accvgpr_write_b32 a42, v57
  v_accvgpr_read_b32 v57, a43
  v_mul_f32 v57, v57, v58
  v_accvgpr_write_b32 a43, v57
  v_accvgpr_read_b32 v57, a44
  v_mul_f32 v57, v57, v58
  v_accvgpr_write_b32 a44, v57
  v_accvgpr_read_b32 v57, a45
  v_mul_f32 v57, v57, v58
  v_accvgpr_write_b32 a45, v57
  v_accvgpr_read_b32 v57, a46
  v_mul_f32 v57, v57, v58
  v_accvgpr_write_b32 a46, v57
  v_accvgpr_read_b32 v57, a47
  v_mul_f32 v57, v57, v58
  v_accvgpr_write_b32 a47, v57
  v_accvgpr_read_b32 v57, a48
  v_mul_f32 v57, v57, v58
  v_accvgpr_write_b32 a48, v57
  v_accvgpr_read_b32 v57, a49
  v_mul_f32 v57, v57, v58
  v_accvgpr_write_b32 a49, v57
  v_accvgpr_read_b32 v57, a50
  v_mul_f32 v57, v57, v58
  v_accvgpr_write_b32 a50, v57
  v_accvgpr_read_b32 v57, a51
  v_mul_f32 v57, v57, v58
  v_accvgpr_write_b32 a51, v57
  v_accvgpr_read_b32 v57, a52
  v_mul_f32 v57, v57, v58
  v_accvgpr_write_b32 a52, v57
  v_accvgpr_read_b32 v57, a53
  v_mul_f32 v57, v57, v58
  v_accvgpr_write_b32 a53, v57
  v_accvgpr_read_b32 v57, a54
  v_mul_f32 v57, v57, v58
  v_accvgpr_write_b32 a54, v57
  v_accvgpr_read_b32 v57, a55
  v_mul_f32 v57, v57, v58
  v_accvgpr_write_b32 a55, v57
  v_accvgpr_read_b32 v57, a56
  v_mul_f32 v57, v57, v58
  v_accvgpr_write_b32 a56, v57
  v_accvgpr_read_b32 v57, a57
  v_mul_f32 v57, v57, v58
  v_accvgpr_write_b32 a57, v57
  v_accvgpr_read_b32 v57, a58
  v_mul_f32 v57, v57, v58
  v_accvgpr_write_b32 a58, v57
  v_accvgpr_read_b32 v57, a59
  v_mul_f32 v57, v57, v58
  v_accvgpr_write_b32 a59, v57
  v_accvgpr_read_b32 v57, a60
  v_mul_f32 v57, v57, v58
  v_accvgpr_write_b32 a60, v57
  v_accvgpr_read_b32 v57, a61
  v_mul_f32 v57, v57, v58
  v_accvgpr_write_b32 a61, v57
  v_accvgpr_read_b32 v57, a62
  v_mul_f32 v57, v57, v58
  v_accvgpr_write_b32 a62, v57
  v_accvgpr_read_b32 v57, a63
  v_mul_f32 v57, v57, v58
  v_accvgpr_write_b32 a63, v57
  v_max_f32 v56, v160, v161
  v_max3_f32 v56, v56, v162, v163
  v_max3_f32 v56, v56, v164, v165
  v_max3_f32 v56, v56, v166, v167
  v_max3_f32 v56, v56, v168, v169
  v_max3_f32 v56, v56, v170, v171
  v_max3_f32 v56, v56, v172, v173
  v_max3_f32 v56, v56, v174, v175
  v_mov_b32 v57, v56
  s_nop 1
  v_permlane32_swap_b32 v56, v57
  s_nop 1
  v_max_f32 v56, v56, v57
  v_mov_b32 v57, v56
  s_nop 1
  v_permlane16_swap_b32 v56, v57
  s_nop 1
  v_max_f32 v56, v56, v57
  v_max_f32 v56, 0, v56
  v_sub_f32 v24, v24, v56
  v_sub_f32 v25, v25, v56
  v_sub_f32 v26, v26, v56
  v_sub_f32 v27, v27, v56
  v_sub_f32 v160, v160, v56
  v_sub_f32 v161, v161, v56
  v_sub_f32 v162, v162, v56
  v_sub_f32 v163, v163, v56
  v_sub_f32 v164, v164, v56
  v_sub_f32 v165, v165, v56
  v_sub_f32 v166, v166, v56
  v_sub_f32 v167, v167, v56
  v_sub_f32 v168, v168, v56
  v_sub_f32 v169, v169, v56
  v_sub_f32 v170, v170, v56
  v_sub_f32 v171, v171, v56
  v_sub_f32 v172, v172, v56
  v_sub_f32 v173, v173, v56
  v_sub_f32 v174, v174, v56
  v_sub_f32 v175, v175, v56
  v_sub_f32 v96, v96, v56
  v_sub_f32 v97, v97, v56
  v_sub_f32 v98, v98, v56
  v_sub_f32 v99, v99, v56
  v_sub_f32 v100, v100, v56
  v_sub_f32 v101, v101, v56
  v_sub_f32 v102, v102, v56
  v_sub_f32 v103, v103, v56
  v_sub_f32 v104, v104, v56
  v_sub_f32 v105, v105, v56
  v_sub_f32 v106, v106, v56
  v_sub_f32 v107, v107, v56
  v_sub_f32 v108, v108, v56
  v_sub_f32 v109, v109, v56
  v_sub_f32 v110, v110, v56
  v_sub_f32 v111, v111, v56
  v_sub_f32 v58, 0, v56
  v_exp_f32 v58, v58
  s_nop 0
  v_mul_f32 v40, v40, v58
  v_mul_f32 v41, v41, v58
  v_mul_f32 v42, v42, v58
  v_mul_f32 v43, v43, v58
  v_accvgpr_read_b32 v57, a64
  v_mul_f32 v57, v57, v58
  v_accvgpr_write_b32 a64, v57
  v_accvgpr_read_b32 v57, a65
  v_mul_f32 v57, v57, v58
  v_accvgpr_write_b32 a65, v57
  v_accvgpr_read_b32 v57, a66
  v_mul_f32 v57, v57, v58
  v_accvgpr_write_b32 a66, v57
  v_accvgpr_read_b32 v57, a67
  v_mul_f32 v57, v57, v58
  v_accvgpr_write_b32 a67, v57
  v_accvgpr_read_b32 v57, a68
  v_mul_f32 v57, v57, v58
  v_accvgpr_write_b32 a68, v57
  v_accvgpr_read_b32 v57, a69
  v_mul_f32 v57, v57, v58
  v_accvgpr_write_b32 a69, v57
  v_accvgpr_read_b32 v57, a70
  v_mul_f32 v57, v57, v58
  v_accvgpr_write_b32 a70, v57
  v_accvgpr_read_b32 v57, a71
  v_mul_f32 v57, v57, v58
  v_accvgpr_write_b32 a71, v57
  v_accvgpr_read_b32 v57, a72
  v_mul_f32 v57, v57, v58
  v_accvgpr_write_b32 a72, v57
  v_accvgpr_read_b32 v57, a73
  v_mul_f32 v57, v57, v58
  v_accvgpr_write_b32 a73, v57
  v_accvgpr_read_b32 v57, a74
  v_mul_f32 v57, v57, v58
  v_accvgpr_write_b32 a74, v57
  v_accvgpr_read_b32 v57, a75
  v_mul_f32 v57, v57, v58
  v_accvgpr_write_b32 a75, v57
  v_accvgpr_read_b32 v57, a76
  v_mul_f32 v57, v57, v58
  v_accvgpr_write_b32 a76, v57
  v_accvgpr_read_b32 v57, a77
  v_mul_f32 v57, v57, v58
  v_accvgpr_write_b32 a77, v57
  v_accvgpr_read_b32 v57, a78
  v_mul_f32 v57, v57, v58
  v_accvgpr_write_b32 a78, v57
  v_accvgpr_read_b32 v57, a79
  v_mul_f32 v57, v57, v58
  v_accvgpr_write_b32 a79, v57
  v_accvgpr_read_b32 v57, a80
  v_mul_f32 v57, v57, v58
  v_accvgpr_write_b32 a80, v57
  v_accvgpr_read_b32 v57, a81
  v_mul_f32 v57, v57, v58
  v_accvgpr_write_b32 a81, v57
  v_accvgpr_read_b32 v57, a82
  v_mul_f32 v57, v57, v58
  v_accvgpr_write_b32 a82, v57
  v_accvgpr_read_b32 v57, a83
  v_mul_f32 v57, v57, v58
  v_accvgpr_write_b32 a83, v57
  v_accvgpr_read_b32 v57, a84
  v_mul_f32 v57, v57, v58
  v_accvgpr_write_b32 a84, v57
  v_accvgpr_read_b32 v57, a85
  v_mul_f32 v57, v57, v58
  v_accvgpr_write_b32 a85, v57
  v_accvgpr_read_b32 v57, a86
  v_mul_f32 v57, v57, v58
  v_accvgpr_write_b32 a86, v57
  v_accvgpr_read_b32 v57, a87
  v_mul_f32 v57, v57, v58
  v_accvgpr_write_b32 a87, v57
  v_accvgpr_read_b32 v57, a88
  v_mul_f32 v57, v57, v58
  v_accvgpr_write_b32 a88, v57
  v_accvgpr_read_b32 v57, a89
  v_mul_f32 v57, v57, v58
  v_accvgpr_write_b32 a89, v57
  v_accvgpr_read_b32 v57, a90
  v_mul_f32 v57, v57, v58
  v_accvgpr_write_b32 a90, v57
  v_accvgpr_read_b32 v57, a91
  v_mul_f32 v57, v57, v58
  v_accvgpr_write_b32 a91, v57
  v_accvgpr_read_b32 v57, a92
  v_mul_f32 v57, v57, v58
  v_accvgpr_write_b32 a92, v57
  v_accvgpr_read_b32 v57, a93
  v_mul_f32 v57, v57, v58
  v_accvgpr_write_b32 a93, v57
  v_accvgpr_read_b32 v57, a94
  v_mul_f32 v57, v57, v58
  v_accvgpr_write_b32 a94, v57
  v_accvgpr_read_b32 v57, a95
  v_mul_f32 v57, v57, v58
  v_accvgpr_write_b32 a95, v57
  v_max_f32 v56, v176, v177
  v_max3_f32 v56, v56, v178, v179
  v_max3_f32 v56, v56, v180, v181
  v_max3_f32 v56, v56, v182, v183
  v_max3_f32 v56, v56, v184, v185
  v_max3_f32 v56, v56, v186, v187
  v_max3_f32 v56, v56, v188, v189
  v_max3_f32 v56, v56, v190, v191
  v_mov_b32 v57, v56
  s_nop 1
  v_permlane32_swap_b32 v56, v57
  s_nop 1
  v_max_f32 v56, v56, v57
  v_mov_b32 v57, v56
  s_nop 1
  v_permlane16_swap_b32 v56, v57
  s_nop 1
  v_max_f32 v56, v56, v57
  v_max_f32 v56, 0, v56
  v_sub_f32 v28, v28, v56
  v_sub_f32 v29, v29, v56
  v_sub_f32 v30, v30, v56
  v_sub_f32 v31, v31, v56
  v_sub_f32 v176, v176, v56
  v_sub_f32 v177, v177, v56
  v_sub_f32 v178, v178, v56
  v_sub_f32 v179, v179, v56
  v_sub_f32 v180, v180, v56
  v_sub_f32 v181, v181, v56
  v_sub_f32 v182, v182, v56
  v_sub_f32 v183, v183, v56
  v_sub_f32 v184, v184, v56
  v_sub_f32 v185, v185, v56
  v_sub_f32 v186, v186, v56
  v_sub_f32 v187, v187, v56
  v_sub_f32 v188, v188, v56
  v_sub_f32 v189, v189, v56
  v_sub_f32 v190, v190, v56
  v_sub_f32 v191, v191, v56
  v_sub_f32 v112, v112, v56
  v_sub_f32 v113, v113, v56
  v_sub_f32 v114, v114, v56
  v_sub_f32 v115, v115, v56
  v_sub_f32 v116, v116, v56
  v_sub_f32 v117, v117, v56
  v_sub_f32 v118, v118, v56
  v_sub_f32 v119, v119, v56
  v_sub_f32 v120, v120, v56
  v_sub_f32 v121, v121, v56
  v_sub_f32 v122, v122, v56
  v_sub_f32 v123, v123, v56
  v_sub_f32 v124, v124, v56
  v_sub_f32 v125, v125, v56
  v_sub_f32 v126, v126, v56
  v_sub_f32 v127, v127, v56
  v_sub_f32 v58, 0, v56
  v_exp_f32 v58, v58
  s_nop 0
  v_mul_f32 v44, v44, v58
  v_mul_f32 v45, v45, v58
  v_mul_f32 v46, v46, v58
  v_mul_f32 v47, v47, v58
  v_accvgpr_read_b32 v57, a96
  v_mul_f32 v57, v57, v58
  v_accvgpr_write_b32 a96, v57
  v_accvgpr_read_b32 v57, a97
  v_mul_f32 v57, v57, v58
  v_accvgpr_write_b32 a97, v57
  v_accvgpr_read_b32 v57, a98
  v_mul_f32 v57, v57, v58
  v_accvgpr_write_b32 a98, v57
  v_accvgpr_read_b32 v57, a99
  v_mul_f32 v57, v57, v58
  v_accvgpr_write_b32 a99, v57
  v_accvgpr_read_b32 v57, a100
  v_mul_f32 v57, v57, v58
  v_accvgpr_write_b32 a100, v57
  v_accvgpr_read_b32 v57, a101
  v_mul_f32 v57, v57, v58
  v_accvgpr_write_b32 a101, v57
  v_accvgpr_read_b32 v57, a102
  v_mul_f32 v57, v57, v58
  v_accvgpr_write_b32 a102, v57
  v_accvgpr_read_b32 v57, a103
  v_mul_f32 v57, v57, v58
  v_accvgpr_write_b32 a103, v57
  v_accvgpr_read_b32 v57, a104
  v_mul_f32 v57, v57, v58
  v_accvgpr_write_b32 a104, v57
  v_accvgpr_read_b32 v57, a105
  v_mul_f32 v57, v57, v58
  v_accvgpr_write_b32 a105, v57
  v_accvgpr_read_b32 v57, a106
  v_mul_f32 v57, v57, v58
  v_accvgpr_write_b32 a106, v57
  v_accvgpr_read_b32 v57, a107
  v_mul_f32 v57, v57, v58
  v_accvgpr_write_b32 a107, v57
  v_accvgpr_read_b32 v57, a108
  v_mul_f32 v57, v57, v58
  v_accvgpr_write_b32 a108, v57
  v_accvgpr_read_b32 v57, a109
  v_mul_f32 v57, v57, v58
  v_accvgpr_write_b32 a109, v57
  v_accvgpr_read_b32 v57, a110
  v_mul_f32 v57, v57, v58
  v_accvgpr_write_b32 a110, v57
  v_accvgpr_read_b32 v57, a111
  v_mul_f32 v57, v57, v58
  v_accvgpr_write_b32 a111, v57
  v_accvgpr_read_b32 v57, a112
  v_mul_f32 v57, v57, v58
  v_accvgpr_write_b32 a112, v57
  v_accvgpr_read_b32 v57, a113
  v_mul_f32 v57, v57, v58
  v_accvgpr_write_b32 a113, v57
  v_accvgpr_read_b32 v57, a114
  v_mul_f32 v57, v57, v58
  v_accvgpr_write_b32 a114, v57
  v_accvgpr_read_b32 v57, a115
  v_mul_f32 v57, v57, v58
  v_accvgpr_write_b32 a115, v57
  v_accvgpr_read_b32 v57, a116
  v_mul_f32 v57, v57, v58
  v_accvgpr_write_b32 a116, v57
  v_accvgpr_read_b32 v57, a117
  v_mul_f32 v57, v57, v58
  v_accvgpr_write_b32 a117, v57
  v_accvgpr_read_b32 v57, a118
  v_mul_f32 v57, v57, v58
  v_accvgpr_write_b32 a118, v57
  v_accvgpr_read_b32 v57, a119
  v_mul_f32 v57, v57, v58
  v_accvgpr_write_b32 a119, v57
  v_accvgpr_read_b32 v57, a120
  v_mul_f32 v57, v57, v58
  v_accvgpr_write_b32 a120, v57
  v_accvgpr_read_b32 v57, a121
  v_mul_f32 v57, v57, v58
  v_accvgpr_write_b32 a121, v57
  v_accvgpr_read_b32 v57, a122
  v_mul_f32 v57, v57, v58
  v_accvgpr_write_b32 a122, v57
  v_accvgpr_read_b32 v57, a123
  v_mul_f32 v57, v57, v58
  v_accvgpr_write_b32 a123, v57
  v_accvgpr_read_b32 v57, a124
  v_mul_f32 v57, v57, v58
  v_accvgpr_write_b32 a124, v57
  v_accvgpr_read_b32 v57, a125
  v_mul_f32 v57, v57, v58
  v_accvgpr_write_b32 a125, v57
  v_accvgpr_read_b32 v57, a126
  v_mul_f32 v57, v57, v58
  v_accvgpr_write_b32 a126, v57
  v_accvgpr_read_b32 v57, a127
  v_mul_f32 v57, v57, v58
  v_accvgpr_write_b32 a127, v57
  v_exp_f32 v48, v128
  v_exp_f32 v49, v129
  v_exp_f32 v50, v130
  v_exp_f32 v51, v131
  v_cvt_pk_bf16_f32 v224, v48, v49
  v_exp_f32 v52, v132
  v_exp_f32 v53, v133
  v_cvt_pk_bf16_f32 v225, v50, v51
  v_pk_maximum3_f16 v11, v224, v224, v225
  v_exp_f32 v54, v134
  v_exp_f32 v55, v135
  v_cvt_pk_bf16_f32 v226, v52, v53
  v_exp_f32 v48, v144
  v_exp_f32 v49, v145
  v_cvt_pk_bf16_f32 v227, v54, v55
  v_pk_maximum3_f16 v11, v11, v226, v227
  v_exp_f32 v50, v146
  v_exp_f32 v51, v147
  v_cvt_pk_bf16_f32 v232, v48, v49
  v_exp_f32 v52, v148
  v_exp_f32 v53, v149
  v_cvt_pk_bf16_f32 v233, v50, v51
  v_pk_maximum3_f16 v11, v11, v232, v233
  v_exp_f32 v54, v150
  v_exp_f32 v55, v151
  v_cvt_pk_bf16_f32 v234, v52, v53
  v_exp_f32 v48, v160
  v_exp_f32 v49, v161
  v_cvt_pk_bf16_f32 v235, v54, v55
  v_pk_maximum3_f16 v11, v11, v234, v235
  v_exp_f32 v50, v162
  v_exp_f32 v51, v163
  v_cvt_pk_bf16_f32 v240, v48, v49
  v_exp_f32 v52, v164
  v_exp_f32 v53, v165
  v_cvt_pk_bf16_f32 v241, v50, v51
  v_pk_maximum3_f16 v11, v11, v240, v241
  v_exp_f32 v54, v166
  v_exp_f32 v55, v167
  v_cvt_pk_bf16_f32 v242, v52, v53
  v_exp_f32 v48, v176
  v_exp_f32 v49, v177
  v_cvt_pk_bf16_f32 v243, v54, v55
  v_pk_maximum3_f16 v11, v11, v242, v243
  v_exp_f32 v50, v178
  v_exp_f32 v51, v179
  v_cvt_pk_bf16_f32 v248, v48, v49
  v_exp_f32 v52, v180
  v_exp_f32 v53, v181
  v_cvt_pk_bf16_f32 v249, v50, v51
  v_pk_maximum3_f16 v11, v11, v248, v249
  v_exp_f32 v54, v182
  v_exp_f32 v55, v183
  v_cvt_pk_bf16_f32 v250, v52, v53
  v_exp_f32 v48, v136
  v_exp_f32 v49, v137
  v_cvt_pk_bf16_f32 v251, v54, v55
  v_pk_maximum3_f16 v11, v11, v250, v251
  v_exp_f32 v50, v138
  v_exp_f32 v51, v139
  v_cvt_pk_bf16_f32 v228, v48, v49
  v_exp_f32 v52, v140
  v_exp_f32 v53, v141
  v_cvt_pk_bf16_f32 v229, v50, v51
  v_pk_maximum3_f16 v11, v11, v228, v229
  v_exp_f32 v54, v142
  v_exp_f32 v55, v143
  v_cvt_pk_bf16_f32 v230, v52, v53
  v_exp_f32 v48, v152
  v_exp_f32 v49, v153
  v_cvt_pk_bf16_f32 v231, v54, v55
  v_pk_maximum3_f16 v11, v11, v230, v231
  v_exp_f32 v50, v154
  v_exp_f32 v51, v155
  v_cvt_pk_bf16_f32 v236, v48, v49
  v_exp_f32 v52, v156
  v_exp_f32 v53, v157
  v_cvt_pk_bf16_f32 v237, v50, v51
  v_pk_maximum3_f16 v11, v11, v236, v237
  v_exp_f32 v54, v158
  v_exp_f32 v55, v159
  v_cvt_pk_bf16_f32 v238, v52, v53
  v_exp_f32 v48, v168
  v_exp_f32 v49, v169
  v_cvt_pk_bf16_f32 v239, v54, v55
  v_pk_maximum3_f16 v11, v11, v238, v239
  v_exp_f32 v50, v170
  v_exp_f32 v51, v171
  v_cvt_pk_bf16_f32 v244, v48, v49
  v_exp_f32 v52, v172
  v_exp_f32 v53, v173
  v_cvt_pk_bf16_f32 v245, v50, v51
  v_pk_maximum3_f16 v11, v11, v244, v245
  v_exp_f32 v54, v174
  v_exp_f32 v55, v175
  v_cvt_pk_bf16_f32 v246, v52, v53
  v_exp_f32 v48, v184
  v_exp_f32 v49, v185
  v_cvt_pk_bf16_f32 v247, v54, v55
  v_pk_maximum3_f16 v11, v11, v246, v247
  v_exp_f32 v50, v186
  v_exp_f32 v51, v187
  v_cvt_pk_bf16_f32 v252, v48, v49
  v_exp_f32 v52, v188
  v_exp_f32 v53, v189
  v_cvt_pk_bf16_f32 v253, v50, v51
  v_pk_maximum3_f16 v11, v11, v252, v253
  v_exp_f32 v54, v190
  v_exp_f32 v55, v191
  v_cvt_pk_bf16_f32 v254, v52, v53
  s_nop 0
  v_cvt_pk_bf16_f32 v255, v54, v55
  v_pk_maximum3_f16 v11, v11, v254, v255
  s_nop 3
  s_branch K2_ret_F
K2_rare_H:
  s_nop 15
  s_nop 15
  v_max_f32 v56, v64, v65
  v_max3_f32 v56, v56, v66, v67
  v_max3_f32 v56, v56, v68, v69
  v_max3_f32 v56, v56, v70, v71
  v_max3_f32 v56, v56, v72, v73
  v_max3_f32 v56, v56, v74, v75
  v_max3_f32 v56, v56, v76, v77
  v_max3_f32 v56, v56, v78, v79
  v_mov_b32 v57, v56
  s_nop 1
  v_permlane32_swap_b32 v56, v57
  s_nop 1
  v_max_f32 v56, v56, v57
  v_mov_b32 v57, v56
  s_nop 1
  v_permlane16_swap_b32 v56, v57
  s_nop 1
  v_max_f32 v56, v56, v57
  v_max_f32 v56, 0, v56
  v_sub_f32 v16, v16, v56
  v_sub_f32 v17, v17, v56
  v_sub_f32 v18, v18, v56
  v_sub_f32 v19, v19, v56
  v_sub_f32 v64, v64, v56
  v_sub_f32 v65, v65, v56
  v_sub_f32 v66, v66, v56
  v_sub_f32 v67, v67, v56
  v_sub_f32 v68, v68, v56
  v_sub_f32 v69, v69, v56
  v_sub_f32 v70, v70, v56
  v_sub_f32 v71, v71, v56
  v_sub_f32 v72, v72, v56
  v_sub_f32 v73, v73, v56
  v_sub_f32 v74, v74, v56
  v_sub_f32 v75, v75, v56
  v_sub_f32 v76, v76, v56
  v_sub_f32 v77, v77, v56
  v_sub_f32 v78, v78, v56
  v_sub_f32 v79, v79, v56
  v_sub_f32 v128, v128, v56
  v_sub_f32 v129, v129, v56
  v_sub_f32 v130, v130, v56
  v_sub_f32 v131, v131, v56
  v_sub_f32 v132, v132, v56
  v_sub_f32 v133, v133, v56
  v_sub_f32 v134, v134, v56
  v_sub_f32 v135, v135, v56
  v_sub_f32 v136, v136, v56
  v_sub_f32 v137, v137, v56
  v_sub_f32 v138, v138, v56
  v_sub_f32 v139, v139, v56
  v_sub_f32 v140, v140, v56
  v_sub_f32 v141, v141, v56
  v_sub_f32 v142, v142, v56
  v_sub_f32 v143, v143, v56
  v_sub_f32 v144, v144, v56
  v_sub_f32 v145, v145, v56
  v_sub_f32 v146, v146, v56
  v_sub_f32 v147, v147, v56
  v_sub_f32 v148, v148, v56
  v_sub_f32 v149, v149, v56
  v_sub_f32 v150, v150, v56
  v_sub_f32 v151, v151, v56
  v_sub_f32 v152, v152, v56
  v_sub_f32 v153, v153, v56
  v_sub_f32 v154, v154, v56
  v_sub_f32 v155, v155, v56
  v_sub_f32 v156, v156, v56
  v_sub_f32 v157, v157, v56
  v_sub_f32 v158, v158, v56
  v_sub_f32 v159, v159, v56
  v_sub_f32 v58, 0, v56
  v_exp_f32 v58, v58
  s_nop 0
  v_mul_f32 v32, v32, v58
  v_mul_f32 v33, v33, v58
  v_mul_f32 v34, v34, v58
  v_mul_f32 v35, v35, v58
  v_accvgpr_read_b32 v57, a0
  v_mul_f32 v57, v57, v58
  v_accvgpr_write_b32 a0, v57
  v_accvgpr_read_b32 v57, a1
  v_mul_f32 v57, v57, v58
  v_accvgpr_write_b32 a1, v57
  v_accvgpr_read_b32 v57, a2
  v_mul_f32 v57, v57, v58
  v_accvgpr_write_b32 a2, v57
  v_accvgpr_read_b32 v57, a3
  v_mul_f32 v57, v57, v58
  v_accvgpr_write_b32 a3, v57
  v_accvgpr_read_b32 v57, a4
  v_mul_f32 v57, v57, v58
  v_accvgpr_write_b32 a4, v57
  v_accvgpr_read_b32 v57, a5
  v_mul_f32 v57, v57, v58
  v_accvgpr_write_b32 a5, v57
  v_accvgpr_read_b32 v57, a6
  v_mul_f32 v57, v57, v58
  v_accvgpr_write_b32 a6, v57
  v_accvgpr_read_b32 v57, a7
  v_mul_f32 v57, v57, v58
  v_accvgpr_write_b32 a7, v57
  v_accvgpr_read_b32 v57, a8
  v_mul_f32 v57, v57, v58
  v_accvgpr_write_b32 a8, v57
  v_accvgpr_read_b32 v57, a9
  v_mul_f32 v57, v57, v58
  v_accvgpr_write_b32 a9, v57
  v_accvgpr_read_b32 v57, a10
  v_mul_f32 v57, v57, v58
  v_accvgpr_write_b32 a10, v57
  v_accvgpr_read_b32 v57, a11
  v_mul_f32 v57, v57, v58
  v_accvgpr_write_b32 a11, v57
  v_accvgpr_read_b32 v57, a12
  v_mul_f32 v57, v57, v58
  v_accvgpr_write_b32 a12, v57
  v_accvgpr_read_b32 v57, a13
  v_mul_f32 v57, v57, v58
  v_accvgpr_write_b32 a13, v57
  v_accvgpr_read_b32 v57, a14
  v_mul_f32 v57, v57, v58
  v_accvgpr_write_b32 a14, v57
  v_accvgpr_read_b32 v57, a15
  v_mul_f32 v57, v57, v58
  v_accvgpr_write_b32 a15, v57
  v_accvgpr_read_b32 v57, a16
  v_mul_f32 v57, v57, v58
  v_accvgpr_write_b32 a16, v57
  v_accvgpr_read_b32 v57, a17
  v_mul_f32 v57, v57, v58
  v_accvgpr_write_b32 a17, v57
  v_accvgpr_read_b32 v57, a18
  v_mul_f32 v57, v57, v58
  v_accvgpr_write_b32 a18, v57
  v_accvgpr_read_b32 v57, a19
  v_mul_f32 v57, v57, v58
  v_accvgpr_write_b32 a19, v57
  v_accvgpr_read_b32 v57, a20
  v_mul_f32 v57, v57, v58
  v_accvgpr_write_b32 a20, v57
  v_accvgpr_read_b32 v57, a21
  v_mul_f32 v57, v57, v58
  v_accvgpr_write_b32 a21, v57
  v_accvgpr_read_b32 v57, a22
  v_mul_f32 v57, v57, v58
  v_accvgpr_write_b32 a22, v57
  v_accvgpr_read_b32 v57, a23
  v_mul_f32 v57, v57, v58
  v_accvgpr_write_b32 a23, v57
  v_accvgpr_read_b32 v57, a24
  v_mul_f32 v57, v57, v58
  v_accvgpr_write_b32 a24, v57
  v_accvgpr_read_b32 v57, a25
  v_mul_f32 v57, v57, v58
  v_accvgpr_write_b32 a25, v57
  v_accvgpr_read_b32 v57, a26
  v_mul_f32 v57, v57, v58
  v_accvgpr_write_b32 a26, v57
  v_accvgpr_read_b32 v57, a27
  v_mul_f32 v57, v57, v58
  v_accvgpr_write_b32 a27, v57
  v_accvgpr_read_b32 v57, a28
  v_mul_f32 v57, v57, v58
  v_accvgpr_write_b32 a28, v57
  v_accvgpr_read_b32 v57, a29
  v_mul_f32 v57, v57, v58
  v_accvgpr_write_b32 a29, v57
  v_accvgpr_read_b32 v57, a30
  v_mul_f32 v57, v57, v58
  v_accvgpr_write_b32 a30, v57
  v_accvgpr_read_b32 v57, a31
  v_mul_f32 v57, v57, v58
  v_accvgpr_write_b32 a31, v57
  v_max_f32 v56, v80, v81
  v_max3_f32 v56, v56, v82, v83
  v_max3_f32 v56, v56, v84, v85
  v_max3_f32 v56, v56, v86, v87
  v_max3_f32 v56, v56, v88, v89
  v_max3_f32 v56, v56, v90, v91
  v_max3_f32 v56, v56, v92, v93
  v_max3_f32 v56, v56, v94, v95
  v_mov_b32 v57, v56
  s_nop 1
  v_permlane32_swap_b32 v56, v57
  s_nop 1
  v_max_f32 v56, v56, v57
  v_mov_b32 v57, v56
  s_nop 1
  v_permlane16_swap_b32 v56, v57
  s_nop 1
  v_max_f32 v56, v56, v57
  v_max_f32 v56, 0, v56
  v_sub_f32 v20, v20, v56
  v_sub_f32 v21, v21, v56
  v_sub_f32 v22, v22, v56
  v_sub_f32 v23, v23, v56
  v_sub_f32 v80, v80, v56
  v_sub_f32 v81, v81, v56
  v_sub_f32 v82, v82, v56
  v_sub_f32 v83, v83, v56
  v_sub_f32 v84, v84, v56
  v_sub_f32 v85, v85, v56
  v_sub_f32 v86, v86, v56
  v_sub_f32 v87, v87, v56
  v_sub_f32 v88, v88, v56
  v_sub_f32 v89, v89, v56
  v_sub_f32 v90, v90, v56
  v_sub_f32 v91, v91, v56
  v_sub_f32 v92, v92, v56
  v_sub_f32 v93, v93, v56
  v_sub_f32 v94, v94, v56
  v_sub_f32 v95, v95, v56
  v_sub_f32 v160, v160, v56
  v_sub_f32 v161, v161, v56
  v_sub_f32 v162, v162, v56
  v_sub_f32 v163, v163, v56
  v_sub_f32 v164, v164, v56
  v_sub_f32 v165, v165, v56
  v_sub_f32 v166, v166, v56
  v_sub_f32 v167, v167, v56
  v_sub_f32 v168, v168, v56
  v_sub_f32 v169, v169, v56
  v_sub_f32 v170, v170, v56
  v_sub_f32 v171, v171, v56
  v_sub_f32 v172, v172, v56
  v_sub_f32 v173, v173, v56
  v_sub_f32 v174, v174, v56
  v_sub_f32 v175, v175, v56
  v_sub_f32 v176, v176, v56
  v_sub_f32 v177, v177, v56
  v_sub_f32 v178, v178, v56
  v_sub_f32 v179, v179, v56
  v_sub_f32 v180, v180, v56
  v_sub_f32 v181, v181, v56
  v_sub_f32 v182, v182, v56
  v_sub_f32 v183, v183, v56
  v_sub_f32 v184, v184, v56
  v_sub_f32 v185, v185, v56
  v_sub_f32 v186, v186, v56
  v_sub_f32 v187, v187, v56
  v_sub_f32 v188, v188, v56
  v_sub_f32 v189, v189, v56
  v_sub_f32 v190, v190, v56
  v_sub_f32 v191, v191, v56
  v_sub_f32 v58, 0, v56
  v_exp_f32 v58, v58
  s_nop 0
  v_mul_f32 v36, v36, v58
  v_mul_f32 v37, v37, v58
  v_mul_f32 v38, v38, v58
  v_mul_f32 v39, v39, v58
  v_accvgpr_read_b32 v57, a32
  v_mul_f32 v57, v57, v58
  v_accvgpr_write_b32 a32, v57
  v_accvgpr_read_b32 v57, a33
  v_mul_f32 v57, v57, v58
  v_accvgpr_write_b32 a33, v57
  v_accvgpr_read_b32 v57, a34
  v_mul_f32 v57, v57, v58
  v_accvgpr_write_b32 a34, v57
  v_accvgpr_read_b32 v57, a35
  v_mul_f32 v57, v57, v58
  v_accvgpr_write_b32 a35, v57
  v_accvgpr_read_b32 v57, a36
  v_mul_f32 v57, v57, v58
  v_accvgpr_write_b32 a36, v57
  v_accvgpr_read_b32 v57, a37
  v_mul_f32 v57, v57, v58
  v_accvgpr_write_b32 a37, v57
  v_accvgpr_read_b32 v57, a38
  v_mul_f32 v57, v57, v58
  v_accvgpr_write_b32 a38, v57
  v_accvgpr_read_b32 v57, a39
  v_mul_f32 v57, v57, v58
  v_accvgpr_write_b32 a39, v57
  v_accvgpr_read_b32 v57, a40
  v_mul_f32 v57, v57, v58
  v_accvgpr_write_b32 a40, v57
  v_accvgpr_read_b32 v57, a41
  v_mul_f32 v57, v57, v58
  v_accvgpr_write_b32 a41, v57
  v_accvgpr_read_b32 v57, a42
  v_mul_f32 v57, v57, v58
  v_accvgpr_write_b32 a42, v57
  v_accvgpr_read_b32 v57, a43
  v_mul_f32 v57, v57, v58
  v_accvgpr_write_b32 a43, v57
  v_accvgpr_read_b32 v57, a44
  v_mul_f32 v57, v57, v58
  v_accvgpr_write_b32 a44, v57
  v_accvgpr_read_b32 v57, a45
  v_mul_f32 v57, v57, v58
  v_accvgpr_write_b32 a45, v57
  v_accvgpr_read_b32 v57, a46
  v_mul_f32 v57, v57, v58
  v_accvgpr_write_b32 a46, v57
  v_accvgpr_read_b32 v57, a47
  v_mul_f32 v57, v57, v58
  v_accvgpr_write_b32 a47, v57
  v_accvgpr_read_b32 v57, a48
  v_mul_f32 v57, v57, v58
  v_accvgpr_write_b32 a48, v57
  v_accvgpr_read_b32 v57, a49
  v_mul_f32 v57, v57, v58
  v_accvgpr_write_b32 a49, v57
  v_accvgpr_read_b32 v57, a50
  v_mul_f32 v57, v57, v58
  v_accvgpr_write_b32 a50, v57
  v_accvgpr_read_b32 v57, a51
  v_mul_f32 v57, v57, v58
  v_accvgpr_write_b32 a51, v57
  v_accvgpr_read_b32 v57, a52
  v_mul_f32 v57, v57, v58
  v_accvgpr_write_b32 a52, v57
  v_accvgpr_read_b32 v57, a53
  v_mul_f32 v57, v57, v58
  v_accvgpr_write_b32 a53, v57
  v_accvgpr_read_b32 v57, a54
  v_mul_f32 v57, v57, v58
  v_accvgpr_write_b32 a54, v57
  v_accvgpr_read_b32 v57, a55
  v_mul_f32 v57, v57, v58
  v_accvgpr_write_b32 a55, v57
  v_accvgpr_read_b32 v57, a56
  v_mul_f32 v57, v57, v58
  v_accvgpr_write_b32 a56, v57
  v_accvgpr_read_b32 v57, a57
  v_mul_f32 v57, v57, v58
  v_accvgpr_write_b32 a57, v57
  v_accvgpr_read_b32 v57, a58
  v_mul_f32 v57, v57, v58
  v_accvgpr_write_b32 a58, v57
  v_accvgpr_read_b32 v57, a59
  v_mul_f32 v57, v57, v58
  v_accvgpr_write_b32 a59, v57
  v_accvgpr_read_b32 v57, a60
  v_mul_f32 v57, v57, v58
  v_accvgpr_write_b32 a60, v57
  v_accvgpr_read_b32 v57, a61
  v_mul_f32 v57, v57, v58
  v_accvgpr_write_b32 a61, v57
  v_accvgpr_read_b32 v57, a62
  v_mul_f32 v57, v57, v58
  v_accvgpr_write_b32 a62, v57
  v_accvgpr_read_b32 v57, a63
  v_mul_f32 v57, v57, v58
  v_accvgpr_write_b32 a63, v57
  v_max_f32 v56, v96, v97
  v_max3_f32 v56, v56, v98, v99
  v_max3_f32 v56, v56, v100, v101
  v_max3_f32 v56, v56, v102, v103
  v_max3_f32 v56, v56, v104, v105
  v_max3_f32 v56, v56, v106, v107
  v_max3_f32 v56, v56, v108, v109
  v_max3_f32 v56, v56, v110, v111
  v_mov_b32 v57, v56
  s_nop 1
  v_permlane32_swap_b32 v56, v57
  s_nop 1
  v_max_f32 v56, v56, v57
  v_mov_b32 v57, v56
  s_nop 1
  v_permlane16_swap_b32 v56, v57
  s_nop 1
  v_max_f32 v56, v56, v57
  v_max_f32 v56, 0, v56
  v_sub_f32 v24, v24, v56
  v_sub_f32 v25, v25, v56
  v_sub_f32 v26, v26, v56
  v_sub_f32 v27, v27, v56
  v_sub_f32 v96, v96, v56
  v_sub_f32 v97, v97, v56
  v_sub_f32 v98, v98, v56
  v_sub_f32 v99, v99, v56
  v_sub_f32 v100, v100, v56
  v_sub_f32 v101, v101, v56
  v_sub_f32 v102, v102, v56
  v_sub_f32 v103, v103, v56
  v_sub_f32 v104, v104, v56
  v_sub_f32 v105, v105, v56
  v_sub_f32 v106, v106, v56
  v_sub_f32 v107, v107, v56
  v_sub_f32 v108, v108, v56
  v_sub_f32 v109, v109, v56
  v_sub_f32 v110, v110, v56
  v_sub_f32 v111, v111, v56
  v_sub_f32 v58, 0, v56
  v_exp_f32 v58, v58
  s_nop 0
  v_mul_f32 v40, v40, v58
  v_mul_f32 v41, v41, v58
  v_mul_f32 v42, v42, v58
  v_mul_f32 v43, v43, v58
  v_accvgpr_read_b32 v57, a64
  v_mul_f32 v57, v57, v58
  v_accvgpr_write_b32 a64, v57
  v_accvgpr_read_b32 v57, a65
  v_mul_f32 v57, v57, v58
  v_accvgpr_write_b32 a65, v57
  v_accvgpr_read_b32 v57, a66
  v_mul_f32 v57, v57, v58
  v_accvgpr_write_b32 a66, v57
  v_accvgpr_read_b32 v57, a67
  v_mul_f32 v57, v57, v58
  v_accvgpr_write_b32 a67, v57
  v_accvgpr_read_b32 v57, a68
  v_mul_f32 v57, v57, v58
  v_accvgpr_write_b32 a68, v57
  v_accvgpr_read_b32 v57, a69
  v_mul_f32 v57, v57, v58
  v_accvgpr_write_b32 a69, v57
  v_accvgpr_read_b32 v57, a70
  v_mul_f32 v57, v57, v58
  v_accvgpr_write_b32 a70, v57
  v_accvgpr_read_b32 v57, a71
  v_mul_f32 v57, v57, v58
  v_accvgpr_write_b32 a71, v57
  v_accvgpr_read_b32 v57, a72
  v_mul_f32 v57, v57, v58
  v_accvgpr_write_b32 a72, v57
  v_accvgpr_read_b32 v57, a73
  v_mul_f32 v57, v57, v58
  v_accvgpr_write_b32 a73, v57
  v_accvgpr_read_b32 v57, a74
  v_mul_f32 v57, v57, v58
  v_accvgpr_write_b32 a74, v57
  v_accvgpr_read_b32 v57, a75
  v_mul_f32 v57, v57, v58
  v_accvgpr_write_b32 a75, v57
  v_accvgpr_read_b32 v57, a76
  v_mul_f32 v57, v57, v58
  v_accvgpr_write_b32 a76, v57
  v_accvgpr_read_b32 v57, a77
  v_mul_f32 v57, v57, v58
  v_accvgpr_write_b32 a77, v57
  v_accvgpr_read_b32 v57, a78
  v_mul_f32 v57, v57, v58
  v_accvgpr_write_b32 a78, v57
  v_accvgpr_read_b32 v57, a79
  v_mul_f32 v57, v57, v58
  v_accvgpr_write_b32 a79, v57
  v_accvgpr_read_b32 v57, a80
  v_mul_f32 v57, v57, v58
  v_accvgpr_write_b32 a80, v57
  v_accvgpr_read_b32 v57, a81
  v_mul_f32 v57, v57, v58
  v_accvgpr_write_b32 a81, v57
  v_accvgpr_read_b32 v57, a82
  v_mul_f32 v57, v57, v58
  v_accvgpr_write_b32 a82, v57
  v_accvgpr_read_b32 v57, a83
  v_mul_f32 v57, v57, v58
  v_accvgpr_write_b32 a83, v57
  v_accvgpr_read_b32 v57, a84
  v_mul_f32 v57, v57, v58
  v_accvgpr_write_b32 a84, v57
  v_accvgpr_read_b32 v57, a85
  v_mul_f32 v57, v57, v58
  v_accvgpr_write_b32 a85, v57
  v_accvgpr_read_b32 v57, a86
  v_mul_f32 v57, v57, v58
  v_accvgpr_write_b32 a86, v57
  v_accvgpr_read_b32 v57, a87
  v_mul_f32 v57, v57, v58
  v_accvgpr_write_b32 a87, v57
  v_accvgpr_read_b32 v57, a88
  v_mul_f32 v57, v57, v58
  v_accvgpr_write_b32 a88, v57
  v_accvgpr_read_b32 v57, a89
  v_mul_f32 v57, v57, v58
  v_accvgpr_write_b32 a89, v57
  v_accvgpr_read_b32 v57, a90
  v_mul_f32 v57, v57, v58
  v_accvgpr_write_b32 a90, v57
  v_accvgpr_read_b32 v57, a91
  v_mul_f32 v57, v57, v58
  v_accvgpr_write_b32 a91, v57
  v_accvgpr_read_b32 v57, a92
  v_mul_f32 v57, v57, v58
  v_accvgpr_write_b32 a92, v57
  v_accvgpr_read_b32 v57, a93
  v_mul_f32 v57, v57, v58
  v_accvgpr_write_b32 a93, v57
  v_accvgpr_read_b32 v57, a94
  v_mul_f32 v57, v57, v58
  v_accvgpr_write_b32 a94, v57
  v_accvgpr_read_b32 v57, a95
  v_mul_f32 v57, v57, v58
  v_accvgpr_write_b32 a95, v57
  v_max_f32 v56, v112, v113
  v_max3_f32 v56, v56, v114, v115
  v_max3_f32 v56, v56, v116, v117
  v_max3_f32 v56, v56, v118, v119
  v_max3_f32 v56, v56, v120, v121
  v_max3_f32 v56, v56, v122, v123
  v_max3_f32 v56, v56, v124, v125
  v_max3_f32 v56, v56, v126, v127
  v_mov_b32 v57, v56
  s_nop 1
  v_permlane32_swap_b32 v56, v57
  s_nop 1
  v_max_f32 v56, v56, v57
  v_mov_b32 v57, v56
  s_nop 1
  v_permlane16_swap_b32 v56, v57
  s_nop 1
  v_max_f32 v56, v56, v57
  v_max_f32 v56, 0, v56
  v_sub_f32 v28, v28, v56
  v_sub_f32 v29, v29, v56
  v_sub_f32 v30, v30, v56
  v_sub_f32 v31, v31, v56
  v_sub_f32 v112, v112, v56
  v_sub_f32 v113, v113, v56
  v_sub_f32 v114, v114, v56
  v_sub_f32 v115, v115, v56
  v_sub_f32 v116, v116, v56
  v_sub_f32 v117, v117, v56
  v_sub_f32 v118, v118, v56
  v_sub_f32 v119, v119, v56
  v_sub_f32 v120, v120, v56
  v_sub_f32 v121, v121, v56
  v_sub_f32 v122, v122, v56
  v_sub_f32 v123, v123, v56
  v_sub_f32 v124, v124, v56
  v_sub_f32 v125, v125, v56
  v_sub_f32 v126, v126, v56
  v_sub_f32 v127, v127, v56
  v_sub_f32 v58, 0, v56
  v_exp_f32 v58, v58
  s_nop 0
  v_mul_f32 v44, v44, v58
  v_mul_f32 v45, v45, v58
  v_mul_f32 v46, v46, v58
  v_mul_f32 v47, v47, v58
  v_accvgpr_read_b32 v57, a96
  v_mul_f32 v57, v57, v58
  v_accvgpr_write_b32 a96, v57
  v_accvgpr_read_b32 v57, a97
  v_mul_f32 v57, v57, v58
  v_accvgpr_write_b32 a97, v57
  v_accvgpr_read_b32 v57, a98
  v_mul_f32 v57, v57, v58
  v_accvgpr_write_b32 a98, v57
  v_accvgpr_read_b32 v57, a99
  v_mul_f32 v57, v57, v58
  v_accvgpr_write_b32 a99, v57
  v_accvgpr_read_b32 v57, a100
  v_mul_f32 v57, v57, v58
  v_accvgpr_write_b32 a100, v57
  v_accvgpr_read_b32 v57, a101
  v_mul_f32 v57, v57, v58
  v_accvgpr_write_b32 a101, v57
  v_accvgpr_read_b32 v57, a102
  v_mul_f32 v57, v57, v58
  v_accvgpr_write_b32 a102, v57
  v_accvgpr_read_b32 v57, a103
  v_mul_f32 v57, v57, v58
  v_accvgpr_write_b32 a103, v57
  v_accvgpr_read_b32 v57, a104
  v_mul_f32 v57, v57, v58
  v_accvgpr_write_b32 a104, v57
  v_accvgpr_read_b32 v57, a105
  v_mul_f32 v57, v57, v58
  v_accvgpr_write_b32 a105, v57
  v_accvgpr_read_b32 v57, a106
  v_mul_f32 v57, v57, v58
  v_accvgpr_write_b32 a106, v57
  v_accvgpr_read_b32 v57, a107
  v_mul_f32 v57, v57, v58
  v_accvgpr_write_b32 a107, v57
  v_accvgpr_read_b32 v57, a108
  v_mul_f32 v57, v57, v58
  v_accvgpr_write_b32 a108, v57
  v_accvgpr_read_b32 v57, a109
  v_mul_f32 v57, v57, v58
  v_accvgpr_write_b32 a109, v57
  v_accvgpr_read_b32 v57, a110
  v_mul_f32 v57, v57, v58
  v_accvgpr_write_b32 a110, v57
  v_accvgpr_read_b32 v57, a111
  v_mul_f32 v57, v57, v58
  v_accvgpr_write_b32 a111, v57
  v_accvgpr_read_b32 v57, a112
  v_mul_f32 v57, v57, v58
  v_accvgpr_write_b32 a112, v57
  v_accvgpr_read_b32 v57, a113
  v_mul_f32 v57, v57, v58
  v_accvgpr_write_b32 a113, v57
  v_accvgpr_read_b32 v57, a114
  v_mul_f32 v57, v57, v58
  v_accvgpr_write_b32 a114, v57
  v_accvgpr_read_b32 v57, a115
  v_mul_f32 v57, v57, v58
  v_accvgpr_write_b32 a115, v57
  v_accvgpr_read_b32 v57, a116
  v_mul_f32 v57, v57, v58
  v_accvgpr_write_b32 a116, v57
  v_accvgpr_read_b32 v57, a117
  v_mul_f32 v57, v57, v58
  v_accvgpr_write_b32 a117, v57
  v_accvgpr_read_b32 v57, a118
  v_mul_f32 v57, v57, v58
  v_accvgpr_write_b32 a118, v57
  v_accvgpr_read_b32 v57, a119
  v_mul_f32 v57, v57, v58
  v_accvgpr_write_b32 a119, v57
  v_accvgpr_read_b32 v57, a120
  v_mul_f32 v57, v57, v58
  v_accvgpr_write_b32 a120, v57
  v_accvgpr_read_b32 v57, a121
  v_mul_f32 v57, v57, v58
  v_accvgpr_write_b32 a121, v57
  v_accvgpr_read_b32 v57, a122
  v_mul_f32 v57, v57, v58
  v_accvgpr_write_b32 a122, v57
  v_accvgpr_read_b32 v57, a123
  v_mul_f32 v57, v57, v58
  v_accvgpr_write_b32 a123, v57
  v_accvgpr_read_b32 v57, a124
  v_mul_f32 v57, v57, v58
  v_accvgpr_write_b32 a124, v57
  v_accvgpr_read_b32 v57, a125
  v_mul_f32 v57, v57, v58
  v_accvgpr_write_b32 a125, v57
  v_accvgpr_read_b32 v57, a126
  v_mul_f32 v57, v57, v58
  v_accvgpr_write_b32 a126, v57
  v_accvgpr_read_b32 v57, a127
  v_mul_f32 v57, v57, v58
  v_accvgpr_write_b32 a127, v57
  v_exp_f32 v48, v64
  v_exp_f32 v49, v65
  v_exp_f32 v50, v66
  v_exp_f32 v51, v67
  v_cvt_pk_bf16_f32 v192, v48, v49
  v_exp_f32 v52, v68
  v_exp_f32 v53, v69
  v_cvt_pk_bf16_f32 v193, v50, v51
  v_pk_maximum3_f16 v11, v192, v192, v193
  v_exp_f32 v54, v70
  v_exp_f32 v55, v71
  v_cvt_pk_bf16_f32 v194, v52, v53
  v_exp_f32 v48, v80
  v_exp_f32 v49, v81
  v_cvt_pk_bf16_f32 v195, v54, v55
  v_pk_maximum3_f16 v11, v11, v194, v195
  v_exp_f32 v50, v82
  v_exp_f32 v51, v83
  v_cvt_pk_bf16_f32 v200, v48, v49
  v_exp_f32 v52, v84
  v_exp_f32 v53, v85
  v_cvt_pk_bf16_f32 v201, v50, v51
  v_pk_maximum3_f16 v11, v11, v200, v201
  v_exp_f32 v54, v86
  v_exp_f32 v55, v87
  v_cvt_pk_bf16_f32 v202, v52, v53
  v_exp_f32 v48, v96
  v_exp_f32 v49, v97
  v_cvt_pk_bf16_f32 v203, v54, v55
  v_pk_maximum3_f16 v11, v11, v202, v203
  v_exp_f32 v50, v98
  v_exp_f32 v51, v99
  v_cvt_pk_bf16_f32 v208, v48, v49
  v_exp_f32 v52, v100
  v_exp_f32 v53, v101
  v_cvt_pk_bf16_f32 v209, v50, v51
  v_pk_maximum3_f16 v11, v11, v208, v209
  v_exp_f32 v54, v102
  v_exp_f32 v55, v103
  v_cvt_pk_bf16_f32 v210, v52, v53
  v_exp_f32 v48, v112
  v_exp_f32 v49, v113
  v_cvt_pk_bf16_f32 v211, v54, v55
  v_pk_maximum3_f16 v11, v11, v210, v211
  v_exp_f32 v50, v114
  v_exp_f32 v51, v115
  v_cvt_pk_bf16_f32 v216, v48, v49
  v_exp_f32 v52, v116
  v_exp_f32 v53, v117
  v_cvt_pk_bf16_f32 v217, v50, v51
  v_pk_maximum3_f16 v11, v11, v216, v217
  v_exp_f32 v54, v118
  v_exp_f32 v55, v119
  v_cvt_pk_bf16_f32 v218, v52, v53
  v_exp_f32 v48, v72
  v_exp_f32 v49, v73
  v_cvt_pk_bf16_f32 v219, v54, v55
  v_pk_maximum3_f16 v11, v11, v218, v219
  v_exp_f32 v50, v74
  v_exp_f32 v51, v75
  v_cvt_pk_bf16_f32 v196, v48, v49
  v_exp_f32 v52, v76
  v_exp_f32 v53, v77
  v_cvt_pk_bf16_f32 v197, v50, v51
  v_pk_maximum3_f16 v11, v11, v196, v197
  v_exp_f32 v54, v78
  v_exp_f32 v55, v79
  v_cvt_pk_bf16_f32 v198, v52, v53
  v_exp_f32 v48, v88
  v_exp_f32 v49, v89
  v_cvt_pk_bf16_f32 v199, v54, v55
  v_pk_maximum3_f16 v11, v11, v198, v199
  v_exp_f32 v50, v90
  v_exp_f32 v51, v91
  v_cvt_pk_bf16_f32 v204, v48, v49
  v_exp_f32 v52, v92
  v_exp_f32 v53, v93
  v_cvt_pk_bf16_f32 v205, v50, v51
  v_pk_maximum3_f16 v11, v11, v204, v205
  v_exp_f32 v54, v94
  v_exp_f32 v55, v95
  v_cvt_pk_bf16_f32 v206, v52, v53
  v_exp_f32 v48, v104
  v_exp_f32 v49, v105
  v_cvt_pk_bf16_f32 v207, v54, v55
  v_pk_maximum3_f16 v11, v11, v206, v207
  v_exp_f32 v50, v106
  v_exp_f32 v51, v107
  v_cvt_pk_bf16_f32 v212, v48, v49
  v_exp_f32 v52, v108
  v_exp_f32 v53, v109
  v_cvt_pk_bf16_f32 v213, v50, v51
  v_pk_maximum3_f16 v11, v11, v212, v213
  v_exp_f32 v54, v110
  v_exp_f32 v55, v111
  v_cvt_pk_bf16_f32 v214, v52, v53
  v_exp_f32 v48, v120
  v_exp_f32 v49, v121
  v_cvt_pk_bf16_f32 v215, v54, v55
  v_pk_maximum3_f16 v11, v11, v214, v215
  v_exp_f32 v50, v122
  v_exp_f32 v51, v123
  v_cvt_pk_bf16_f32 v220, v48, v49
  v_exp_f32 v52, v124
  v_exp_f32 v53, v125
  v_cvt_pk_bf16_f32 v221, v50, v51
  v_pk_maximum3_f16 v11, v11, v220, v221
  v_exp_f32 v54, v126
  v_exp_f32 v55, v127
  v_cvt_pk_bf16_f32 v222, v52, v53
  s_nop 0
  v_cvt_pk_bf16_f32 v223, v54, v55
  v_pk_maximum3_f16 v11, v11, v222, v223
  s_nop 3
  s_branch K2_ret_H
K2_rare_B1:
  s_nop 15
  s_nop 15
  v_max_f32 v56, v128, v129
  v_max3_f32 v56, v56, v130, v131
  v_max3_f32 v56, v56, v132, v133
  v_max3_f32 v56, v56, v134, v135
  v_max3_f32 v56, v56, v136, v137
  v_max3_f32 v56, v56, v138, v139
  v_max3_f32 v56, v56, v140, v141
  v_max3_f32 v56, v56, v142, v143
  v_max3_f32 v56, v56, v144, v145
  v_max3_f32 v56, v56, v146, v147
  v_max3_f32 v56, v56, v148, v149
  v_max3_f32 v56, v56, v150, v151
  v_max3_f32 v56, v56, v152, v153
  v_max3_f32 v56, v56, v154, v155
  v_max3_f32 v56, v56, v156, v157
  v_max3_f32 v56, v56, v158, v159
  v_mov_b32 v57, v56
  s_nop 1
  v_permlane32_swap_b32 v56, v57
  s_nop 1
  v_max_f32 v56, v56, v57
  v_mov_b32 v57, v56
  s_nop 1
  v_permlane16_swap_b32 v56, v57
  s_nop 1
  v_max_f32 v56, v56, v57
  v_max_f32 v56, 0, v56
  v_sub_f32 v16, v16, v56
  v_sub_f32 v17, v17, v56
  v_sub_f32 v18, v18, v56
  v_sub_f32 v19, v19, v56
  v_sub_f32 v128, v128, v56
  v_sub_f32 v129, v129, v56
  v_sub_f32 v130, v130, v56
  v_sub_f32 v131, v131, v56
  v_sub_f32 v132, v132, v56
  v_sub_f32 v133, v133, v56
  v_sub_f32 v134, v134, v56
  v_sub_f32 v135, v135, v56
  v_sub_f32 v136, v136, v56
  v_sub_f32 v137, v137, v56
  v_sub_f32 v138, v138, v56
  v_sub_f32 v139, v139, v56
  v_sub_f32 v140, v140, v56
  v_sub_f32 v141, v141, v56
  v_sub_f32 v142, v142, v56
  v_sub_f32 v143, v143, v56
  v_sub_f32 v144, v144, v56
  v_sub_f32 v145, v145, v56
  v_sub_f32 v146, v146, v56
  v_sub_f32 v147, v147, v56
  v_sub_f32 v148, v148, v56
  v_sub_f32 v149, v149, v56
  v_sub_f32 v150, v150, v56
  v_sub_f32 v151, v151, v56
  v_sub_f32 v152, v152, v56
  v_sub_f32 v153, v153, v56
  v_sub_f32 v154, v154, v56
  v_sub_f32 v155, v155, v56
  v_sub_f32 v156, v156, v56
  v_sub_f32 v157, v157, v56
  v_sub_f32 v158, v158, v56
  v_sub_f32 v159, v159, v56
  v_sub_f32 v64, v64, v56
  v_sub_f32 v65, v65, v56
  v_sub_f32 v66, v66, v56
  v_sub_f32 v67, v67, v56
  v_sub_f32 v68, v68, v56
  v_sub_f32 v69, v69, v56
  v_sub_f32 v70, v70, v56
  v_sub_f32 v71, v71, v56
  v_sub_f32 v72, v72, v56
  v_sub_f32 v73, v73, v56
  v_sub_f32 v74, v74, v56
  v_sub_f32 v75, v75, v56
  v_sub_f32 v76, v76, v56
  v_sub_f32 v77, v77, v56
  v_sub_f32 v78, v78, v56
  v_sub_f32 v79, v79, v56
  v_sub_f32 v80, v80, v56
  v_sub_f32 v81, v81, v56
  v_sub_f32 v82, v82, v56
  v_sub_f32 v83, v83, v56
  v_sub_f32 v84, v84, v56
  v_sub_f32 v85, v85, v56
  v_sub_f32 v86, v86, v56
  v_sub_f32 v87, v87, v56
  v_sub_f32 v88, v88, v56
  v_sub_f32 v89, v89, v56
  v_sub_f32 v90, v90, v56
  v_sub_f32 v91, v91, v56
  v_sub_f32 v92, v92, v56
  v_sub_f32 v93, v93, v56
  v_sub_f32 v94, v94, v56
  v_sub_f32 v95, v95, v56
  v_sub_f32 v58, 0, v56
  v_exp_f32 v58, v58
  s_nop 0
  v_mul_f32 v32, v32, v58
  v_mul_f32 v33, v33, v58
  v_mul_f32 v34, v34, v58
  v_mul_f32 v35, v35, v58
  v_accvgpr_read_b32 v57, a0
  v_mul_f32 v57, v57, v58
  v_accvgpr_write_b32 a0, v57
  v_accvgpr_read_b32 v57, a1
  v_mul_f32 v57, v57, v58
  v_accvgpr_write_b32 a1, v57
  v_accvgpr_read_b32 v57, a2
  v_mul_f32 v57, v57, v58
  v_accvgpr_write_b32 a2, v57
  v_accvgpr_read_b32 v57, a3
  v_mul_f32 v57, v57, v58
  v_accvgpr_write_b32 a3, v57
  v_accvgpr_read_b32 v57, a4
  v_mul_f32 v57, v57, v58
  v_accvgpr_write_b32 a4, v57
  v_accvgpr_read_b32 v57, a5
  v_mul_f32 v57, v57, v58
  v_accvgpr_write_b32 a5, v57
  v_accvgpr_read_b32 v57, a6
  v_mul_f32 v57, v57, v58
  v_accvgpr_write_b32 a6, v57
  v_accvgpr_read_b32 v57, a7
  v_mul_f32 v57, v57, v58
  v_accvgpr_write_b32 a7, v57
  v_accvgpr_read_b32 v57, a8
  v_mul_f32 v57, v57, v58
  v_accvgpr_write_b32 a8, v57
  v_accvgpr_read_b32 v57, a9
  v_mul_f32 v57, v57, v58
  v_accvgpr_write_b32 a9, v57
  v_accvgpr_read_b32 v57, a10
  v_mul_f32 v57, v57, v58
  v_accvgpr_write_b32 a10, v57
  v_accvgpr_read_b32 v57, a11
  v_mul_f32 v57, v57, v58
  v_accvgpr_write_b32 a11, v57
  v_accvgpr_read_b32 v57, a12
  v_mul_f32 v57, v57, v58
  v_accvgpr_write_b32 a12, v57
  v_accvgpr_read_b32 v57, a13
  v_mul_f32 v57, v57, v58
  v_accvgpr_write_b32 a13, v57
  v_accvgpr_read_b32 v57, a14
  v_mul_f32 v57, v57, v58
  v_accvgpr_write_b32 a14, v57
  v_accvgpr_read_b32 v57, a15
  v_mul_f32 v57, v57, v58
  v_accvgpr_write_b32 a15, v57
  v_accvgpr_read_b32 v57, a16
  v_mul_f32 v57, v57, v58
  v_accvgpr_write_b32 a16, v57
  v_accvgpr_read_b32 v57, a17
  v_mul_f32 v57, v57, v58
  v_accvgpr_write_b32 a17, v57
  v_accvgpr_read_b32 v57, a18
  v_mul_f32 v57, v57, v58
  v_accvgpr_write_b32 a18, v57
  v_accvgpr_read_b32 v57, a19
  v_mul_f32 v57, v57, v58
  v_accvgpr_write_b32 a19, v57
  v_accvgpr_read_b32 v57, a20
  v_mul_f32 v57, v57, v58
  v_accvgpr_write_b32 a20, v57
  v_accvgpr_read_b32 v57, a21
  v_mul_f32 v57, v57, v58
  v_accvgpr_write_b32 a21, v57
  v_accvgpr_read_b32 v57, a22
  v_mul_f32 v57, v57, v58
  v_accvgpr_write_b32 a22, v57
  v_accvgpr_read_b32 v57, a23
  v_mul_f32 v57, v57, v58
  v_accvgpr_write_b32 a23, v57
  v_accvgpr_read_b32 v57, a24
  v_mul_f32 v57, v57, v58
  v_accvgpr_write_b32 a24, v57
  v_accvgpr_read_b32 v57, a25
  v_mul_f32 v57, v57, v58
  v_accvgpr_write_b32 a25, v57
  v_accvgpr_read_b32 v57, a26
  v_mul_f32 v57, v57, v58
  v_accvgpr_write_b32 a26, v57
  v_accvgpr_read_b32 v57, a27
  v_mul_f32 v57, v57, v58
  v_accvgpr_write_b32 a27, v57
  v_accvgpr_read_b32 v57, a28
  v_mul_f32 v57, v57, v58
  v_accvgpr_write_b32 a28, v57
  v_accvgpr_read_b32 v57, a29
  v_mul_f32 v57, v57, v58
  v_accvgpr_write_b32 a29, v57
  v_accvgpr_read_b32 v57, a30
  v_mul_f32 v57, v57, v58
  v_accvgpr_write_b32 a30, v57
  v_accvgpr_read_b32 v57, a31
  v_mul_f32 v57, v57, v58
  v_accvgpr_write_b32 a31, v57
  v_max_f32 v56, v160, v161
  v_max3_f32 v56, v56, v162, v163
  v_max3_f32 v56, v56, v164, v165
  v_max3_f32 v56, v56, v166, v167
  v_max3_f32 v56, v56, v168, v169
  v_max3_f32 v56, v56, v170, v171
  v_max3_f32 v56, v56, v172, v173
  v_max3_f32 v56, v56, v174, v175
  v_max3_f32 v56, v56, v176, v177
  v_max3_f32 v56, v56, v178, v179
  v_max3_f32 v56, v56, v180, v181
  v_max3_f32 v56, v56, v182, v183
  v_max3_f32 v56, v56, v184, v185
  v_max3_f32 v56, v56, v186, v187
  v_max3_f32 v56, v56, v188, v189
  v_max3_f32 v56, v56, v190, v191
  v_mov_b32 v57, v56
  s_nop 1
  v_permlane32_swap_b32 v56, v57
  s_nop 1
  v_max_f32 v56, v56, v57
  v_mov_b32 v57, v56
  s_nop 1
  v_permlane16_swap_b32 v56, v57
  s_nop 1
  v_max_f32 v56, v56, v57
  v_max_f32 v56, 0, v56
  v_sub_f32 v20, v20, v56
  v_sub_f32 v21, v21, v56
  v_sub_f32 v22, v22, v56
  v_sub_f32 v23, v23, v56
  v_sub_f32 v160, v160, v56
  v_sub_f32 v161, v161, v56
  v_sub_f32 v162, v162, v56
  v_sub_f32 v163, v163, v56
  v_sub_f32 v164, v164, v56
  v_sub_f32 v165, v165, v56
  v_sub_f32 v166, v166, v56
  v_sub_f32 v167, v167, v56
  v_sub_f32 v168, v168, v56
  v_sub_f32 v169, v169, v56
  v_sub_f32 v170, v170, v56
  v_sub_f32 v171, v171, v56
  v_sub_f32 v172, v172, v56
  v_sub_f32 v173, v173, v56
  v_sub_f32 v174, v174, v56
  v_sub_f32 v175, v175, v56
  v_sub_f32 v176, v176, v56
  v_sub_f32 v177, v177, v56
  v_sub_f32 v178, v178, v56
  v_sub_f32 v179, v179, v56
  v_sub_f32 v180, v180, v56
  v_sub_f32 v181, v181, v56
  v_sub_f32 v182, v182, v56
  v_sub_f32 v183, v183, v56
  v_sub_f32 v184, v184, v56
  v_sub_f32 v185, v185, v56
  v_sub_f32 v186, v186, v56
  v_sub_f32 v187, v187, v56
  v_sub_f32 v188, v188, v56
  v_sub_f32 v189, v189, v56
  v_sub_f32 v190, v190, v56
  v_sub_f32 v191, v191, v56
  v_sub_f32 v96, v96, v56
  v_sub_f32 v97, v97, v56
  v_sub_f32 v98, v98, v56
  v_sub_f32 v99, v99, v56
  v_sub_f32 v100, v100, v56
  v_sub_f32 v101, v101, v56
  v_sub_f32 v102, v102, v56
  v_sub_f32 v103, v103, v56
  v_sub_f32 v104, v104, v56
  v_sub_f32 v105, v105, v56
  v_sub_f32 v106, v106, v56
  v_sub_f32 v107, v107, v56
  v_sub_f32 v108, v108, v56
  v_sub_f32 v109, v109, v56
  v_sub_f32 v110, v110, v56
  v_sub_f32 v111, v111, v56
  v_sub_f32 v112, v112, v56
  v_sub_f32 v113, v113, v56
  v_sub_f32 v114, v114, v56
  v_sub_f32 v115, v115, v56
  v_sub_f32 v116, v116, v56
  v_sub_f32 v117, v117, v56
  v_sub_f32 v118, v118, v56
  v_sub_f32 v119, v119, v56
  v_sub_f32 v120, v120, v56
  v_sub_f32 v121, v121, v56
  v_sub_f32 v122, v122, v56
  v_sub_f32 v123, v123, v56
  v_sub_f32 v124, v124, v56
  v_sub_f32 v125, v125, v56
  v_sub_f32 v126, v126, v56
  v_sub_f32 v127, v127, v56
  v_sub_f32 v58, 0, v56
  v_exp_f32 v58, v58
  s_nop 0
  v_mul_f32 v36, v36, v58
  v_mul_f32 v37, v37, v58
  v_mul_f32 v38, v38, v58
  v_mul_f32 v39, v39, v58
  v_accvgpr_read_b32 v57, a32
  v_mul_f32 v57, v57, v58
  v_accvgpr_write_b32 a32, v57
  v_accvgpr_read_b32 v57, a33
  v_mul_f32 v57, v57, v58
  v_accvgpr_write_b32 a33, v57
  v_accvgpr_read_b32 v57, a34
  v_mul_f32 v57, v57, v58
  v_accvgpr_write_b32 a34, v57
  v_accvgpr_read_b32 v57, a35
  v_mul_f32 v57, v57, v58
  v_accvgpr_write_b32 a35, v57
  v_accvgpr_read_b32 v57, a36
  v_mul_f32 v57, v57, v58
  v_accvgpr_write_b32 a36, v57
  v_accvgpr_read_b32 v57, a37
  v_mul_f32 v57, v57, v58
  v_accvgpr_write_b32 a37, v57
  v_accvgpr_read_b32 v57, a38
  v_mul_f32 v57, v57, v58
  v_accvgpr_write_b32 a38, v57
  v_accvgpr_read_b32 v57, a39
  v_mul_f32 v57, v57, v58
  v_accvgpr_write_b32 a39, v57
  v_accvgpr_read_b32 v57, a40
  v_mul_f32 v57, v57, v58
  v_accvgpr_write_b32 a40, v57
  v_accvgpr_read_b32 v57, a41
  v_mul_f32 v57, v57, v58
  v_accvgpr_write_b32 a41, v57
  v_accvgpr_read_b32 v57, a42
  v_mul_f32 v57, v57, v58
  v_accvgpr_write_b32 a42, v57
  v_accvgpr_read_b32 v57, a43
  v_mul_f32 v57, v57, v58
  v_accvgpr_write_b32 a43, v57
  v_accvgpr_read_b32 v57, a44
  v_mul_f32 v57, v57, v58
  v_accvgpr_write_b32 a44, v57
  v_accvgpr_read_b32 v57, a45
  v_mul_f32 v57, v57, v58
  v_accvgpr_write_b32 a45, v57
  v_accvgpr_read_b32 v57, a46
  v_mul_f32 v57, v57, v58
  v_accvgpr_write_b32 a46, v57
  v_accvgpr_read_b32 v57, a47
  v_mul_f32 v57, v57, v58
  v_accvgpr_write_b32 a47, v57
  v_accvgpr_read_b32 v57, a48
  v_mul_f32 v57, v57, v58
  v_accvgpr_write_b32 a48, v57
  v_accvgpr_read_b32 v57, a49
  v_mul_f32 v57, v57, v58
  v_accvgpr_write_b32 a49, v57
  v_accvgpr_read_b32 v57, a50
  v_mul_f32 v57, v57, v58
  v_accvgpr_write_b32 a50, v57
  v_accvgpr_read_b32 v57, a51
  v_mul_f32 v57, v57, v58
  v_accvgpr_write_b32 a51, v57
  v_accvgpr_read_b32 v57, a52
  v_mul_f32 v57, v57, v58
  v_accvgpr_write_b32 a52, v57
  v_accvgpr_read_b32 v57, a53
  v_mul_f32 v57, v57, v58
  v_accvgpr_write_b32 a53, v57
  v_accvgpr_read_b32 v57, a54
  v_mul_f32 v57, v57, v58
  v_accvgpr_write_b32 a54, v57
  v_accvgpr_read_b32 v57, a55
  v_mul_f32 v57, v57, v58
  v_accvgpr_write_b32 a55, v57
  v_accvgpr_read_b32 v57, a56
  v_mul_f32 v57, v57, v58
  v_accvgpr_write_b32 a56, v57
  v_accvgpr_read_b32 v57, a57
  v_mul_f32 v57, v57, v58
  v_accvgpr_write_b32 a57, v57
  v_accvgpr_read_b32 v57, a58
  v_mul_f32 v57, v57, v58
  v_accvgpr_write_b32 a58, v57
  v_accvgpr_read_b32 v57, a59
  v_mul_f32 v57, v57, v58
  v_accvgpr_write_b32 a59, v57
  v_accvgpr_read_b32 v57, a60
  v_mul_f32 v57, v57, v58
  v_accvgpr_write_b32 a60, v57
  v_accvgpr_read_b32 v57, a61
  v_mul_f32 v57, v57, v58
  v_accvgpr_write_b32 a61, v57
  v_accvgpr_read_b32 v57, a62
  v_mul_f32 v57, v57, v58
  v_accvgpr_write_b32 a62, v57
  v_accvgpr_read_b32 v57, a63
  v_mul_f32 v57, v57, v58
  v_accvgpr_write_b32 a63, v57
  v_exp_f32 v48, v128
  v_exp_f32 v49, v129
  v_exp_f32 v50, v130
  v_exp_f32 v51, v131
  v_cvt_pk_bf16_f32 v224, v48, v49
  v_exp_f32 v52, v132
  v_exp_f32 v53, v133
  v_cvt_pk_bf16_f32 v225, v50, v51
  v_pk_maximum3_f16 v11, v224, v224, v225
  v_exp_f32 v54, v134
  v_exp_f32 v55, v135
  v_cvt_pk_bf16_f32 v226, v52, v53
  v_exp_f32 v48, v160
  v_exp_f32 v49, v161
  v_cvt_pk_bf16_f32 v227, v54, v55
  v_pk_maximum3_f16 v11, v11, v226, v227
  v_exp_f32 v50, v162
  v_exp_f32 v51, v163
  v_cvt_pk_bf16_f32 v240, v48, v49
  v_exp_f32 v52, v164
  v_exp_f32 v53, v165
  v_cvt_pk_bf16_f32 v241, v50, v51
  v_pk_maximum3_f16 v11, v11, v240, v241
  v_exp_f32 v54, v166
  v_exp_f32 v55, v167
  v_cvt_pk_bf16_f32 v242, v52, v53
  v_exp_f32 v48, v136
  v_exp_f32 v49, v137
  v_cvt_pk_bf16_f32 v243, v54, v55
  v_pk_maximum3_f16 v11, v11, v242, v243
  v_exp_f32 v50, v138
  v_exp_f32 v51, v139
  v_cvt_pk_bf16_f32 v228, v48, v49
  v_exp_f32 v52, v140
  v_exp_f32 v53, v141
  v_cvt_pk_bf16_f32 v229, v50, v51
  v_pk_maximum3_f16 v11, v11, v228, v229
  v_exp_f32 v54, v142
  v_exp_f32 v55, v143
  v_cvt_pk_bf16_f32 v230, v52, v53
  v_exp_f32 v48, v168
  v_exp_f32 v49, v169
  v_cvt_pk_bf16_f32 v231, v54, v55
  v_pk_maximum3_f16 v11, v11, v230, v231
  v_exp_f32 v50, v170
  v_exp_f32 v51, v171
  v_cvt_pk_bf16_f32 v244, v48, v49
  v_exp_f32 v52, v172
  v_exp_f32 v53, v173
  v_cvt_pk_bf16_f32 v245, v50, v51
  v_pk_maximum3_f16 v11, v11, v244, v245
  v_exp_f32 v54, v174
  v_exp_f32 v55, v175
  v_cvt_pk_bf16_f32 v246, v52, v53
  v_exp_f32 v48, v144
  v_exp_f32 v49, v145
  v_cvt_pk_bf16_f32 v247, v54, v55
  v_pk_maximum3_f16 v11, v11, v246, v247
  v_exp_f32 v50, v146
  v_exp_f32 v51, v147
  v_cvt_pk_bf16_f32 v232, v48, v49
  v_exp_f32 v52, v148
  v_exp_f32 v53, v149
  v_cvt_pk_bf16_f32 v233, v50, v51
  v_pk_maximum3_f16 v11, v11, v232, v233
  v_exp_f32 v54, v150
  v_exp_f32 v55, v151
  v_cvt_pk_bf16_f32 v234, v52, v53
  v_exp_f32 v48, v176
  v_exp_f32 v49, v177
  v_cvt_pk_bf16_f32 v235, v54, v55
  v_pk_maximum3_f16 v11, v11, v234, v235
  v_exp_f32 v50, v178
  v_exp_f32 v51, v179
  v_cvt_pk_bf16_f32 v248, v48, v49
  v_exp_f32 v52, v180
  v_exp_f32 v53, v181
  v_cvt_pk_bf16_f32 v249, v50, v51
  v_pk_maximum3_f16 v11, v11, v248, v249
  v_exp_f32 v54, v182
  v_exp_f32 v55, v183
  v_cvt_pk_bf16_f32 v250, v52, v53
  v_exp_f32 v48, v152
  v_exp_f32 v49, v153
  v_cvt_pk_bf16_f32 v251, v54, v55
  v_pk_maximum3_f16 v11, v11, v250, v251
  v_exp_f32 v50, v154
  v_exp_f32 v51, v155
  v_cvt_pk_bf16_f32 v236, v48, v49
  v_exp_f32 v52, v156
  v_exp_f32 v53, v157
  v_cvt_pk_bf16_f32 v237, v50, v51
  v_pk_maximum3_f16 v11, v11, v236, v237
  v_exp_f32 v54, v158
  v_exp_f32 v55, v159
  v_cvt_pk_bf16_f32 v238, v52, v53
  v_exp_f32 v48, v184
  v_exp_f32 v49, v185
  v_cvt_pk_bf16_f32 v239, v54, v55
  v_pk_maximum3_f16 v11, v11, v238, v239
  v_exp_f32 v50, v186
  v_exp_f32 v51, v187
  v_cvt_pk_bf16_f32 v252, v48, v49
  v_exp_f32 v52, v188
  v_exp_f32 v53, v189
  v_cvt_pk_bf16_f32 v253, v50, v51
  v_pk_maximum3_f16 v11, v11, v252, v253
  v_exp_f32 v54, v190
  v_exp_f32 v55, v191
  v_cvt_pk_bf16_f32 v254, v52, v53
  s_nop 0
  v_cvt_pk_bf16_f32 v255, v54, v55
  v_pk_maximum3_f16 v11, v11, v254, v255
  s_nop 3
  s_branch K2_ret_B1
K2_rare_A:
  s_nop 15
  s_nop 15
  v_max_f32 v56, v64, v65
  v_max3_f32 v56, v56, v66, v67
  v_max3_f32 v56, v56, v68, v69
  v_max3_f32 v56, v56, v70, v71
  v_max3_f32 v56, v56, v72, v73
  v_max3_f32 v56, v56, v74, v75
  v_max3_f32 v56, v56, v76, v77
  v_max3_f32 v56, v56, v78, v79
  v_max3_f32 v56, v56, v80, v81
  v_max3_f32 v56, v56, v82, v83
  v_max3_f32 v56, v56, v84, v85
  v_max3_f32 v56, v56, v86, v87
  v_max3_f32 v56, v56, v88, v89
  v_max3_f32 v56, v56, v90, v91
  v_max3_f32 v56, v56, v92, v93
  v_max3_f32 v56, v56, v94, v95
  v_mov_b32 v57, v56
  s_nop 1
  v_permlane32_swap_b32 v56, v57
  s_nop 1
  v_max_f32 v56, v56, v57
  v_mov_b32 v57, v56
  s_nop 1
  v_permlane16_swap_b32 v56, v57
  s_nop 1
  v_max_f32 v56, v56, v57
  v_max_f32 v56, 0, v56
  v_sub_f32 v16, v16, v56
  v_sub_f32 v17, v17, v56
  v_sub_f32 v18, v18, v56
  v_sub_f32 v19, v19, v56
  v_sub_f32 v64, v64, v56
  v_sub_f32 v65, v65, v56
  v_sub_f32 v66, v66, v56
  v_sub_f32 v67, v67, v56
  v_sub_f32 v68, v68, v56
  v_sub_f32 v69, v69, v56
  v_sub_f32 v70, v70, v56
  v_sub_f32 v71, v71, v56
  v_sub_f32 v72, v72, v56
  v_sub_f32 v73, v73, v56
  v_sub_f32 v74, v74, v56
  v_sub_f32 v75, v75, v56
  v_sub_f32 v76, v76, v56
  v_sub_f32 v77, v77, v56
  v_sub_f32 v78, v78, v56
  v_sub_f32 v79, v79, v56
  v_sub_f32 v80, v80, v56
  v_sub_f32 v81, v81, v56
  v_sub_f32 v82, v82, v56
  v_sub_f32 v83, v83, v56
  v_sub_f32 v84, v84, v56
  v_sub_f32 v85, v85, v56
  v_sub_f32 v86, v86, v56
  v_sub_f32 v87, v87, v56
  v_sub_f32 v88, v88, v56
  v_sub_f32 v89, v89, v56
  v_sub_f32 v90, v90, v56
  v_sub_f32 v91, v91, v56
  v_sub_f32 v92, v92, v56
  v_sub_f32 v93, v93, v56
  v_sub_f32 v94, v94, v56
  v_sub_f32 v95, v95, v56
  v_sub_f32 v128, v128, v56
  v_sub_f32 v129, v129, v56
  v_sub_f32 v130, v130, v56
  v_sub_f32 v131, v131, v56
  v_sub_f32 v132, v132, v56
  v_sub_f32 v133, v133, v56
  v_sub_f32 v134, v134, v56
  v_sub_f32 v135, v135, v56
  v_sub_f32 v136, v136, v56
  v_sub_f32 v137, v137, v56
  v_sub_f32 v138, v138, v56
  v_sub_f32 v139, v139, v56
  v_sub_f32 v140, v140, v56
  v_sub_f32 v141, v141, v56
  v_sub_f32 v142, v142, v56
  v_sub_f32 v143, v143, v56
  v_sub_f32 v144, v144, v56
  v_sub_f32 v145, v145, v56
  v_sub_f32 v146, v146, v56
  v_sub_f32 v147, v147, v56
  v_sub_f32 v148, v148, v56
  v_sub_f32 v149, v149, v56
  v_sub_f32 v150, v150, v56
  v_sub_f32 v151, v151, v56
  v_sub_f32 v152, v152, v56
  v_sub_f32 v153, v153, v56
  v_sub_f32 v154, v154, v56
  v_sub_f32 v155, v155, v56
  v_sub_f32 v156, v156, v56
  v_sub_f32 v157, v157, v56
  v_sub_f32 v158, v158, v56
  v_sub_f32 v159, v159, v56
  v_sub_f32 v58, 0, v56
  v_exp_f32 v58, v58
  s_nop 0
  v_mul_f32 v32, v32, v58
  v_mul_f32 v33, v33, v58
  v_mul_f32 v34, v34, v58
  v_mul_f32 v35, v35, v58
  v_accvgpr_read_b32 v57, a0
  v_mul_f32 v57, v57, v58
  v_accvgpr_write_b32 a0, v57
  v_accvgpr_read_b32 v57, a1
  v_mul_f32 v57, v57, v58
  v_accvgpr_write_b32 a1, v57
  v_accvgpr_read_b32 v57, a2
  v_mul_f32 v57, v57, v58
  v_accvgpr_write_b32 a2, v57
  v_accvgpr_read_b32 v57, a3
  v_mul_f32 v57, v57, v58
  v_accvgpr_write_b32 a3, v57
  v_accvgpr_read_b32 v57, a4
  v_mul_f32 v57, v57, v58
  v_accvgpr_write_b32 a4, v57
  v_accvgpr_read_b32 v57, a5
  v_mul_f32 v57, v57, v58
  v_accvgpr_write_b32 a5, v57
  v_accvgpr_read_b32 v57, a6
  v_mul_f32 v57, v57, v58
  v_accvgpr_write_b32 a6, v57
  v_accvgpr_read_b32 v57, a7
  v_mul_f32 v57, v57, v58
  v_accvgpr_write_b32 a7, v57
  v_accvgpr_read_b32 v57, a8
  v_mul_f32 v57, v57, v58
  v_accvgpr_write_b32 a8, v57
  v_accvgpr_read_b32 v57, a9
  v_mul_f32 v57, v57, v58
  v_accvgpr_write_b32 a9, v57
  v_accvgpr_read_b32 v57, a10
  v_mul_f32 v57, v57, v58
  v_accvgpr_write_b32 a10, v57
  v_accvgpr_read_b32 v57, a11
  v_mul_f32 v57, v57, v58
  v_accvgpr_write_b32 a11, v57
  v_accvgpr_read_b32 v57, a12
  v_mul_f32 v57, v57, v58
  v_accvgpr_write_b32 a12, v57
  v_accvgpr_read_b32 v57, a13
  v_mul_f32 v57, v57, v58
  v_accvgpr_write_b32 a13, v57
  v_accvgpr_read_b32 v57, a14
  v_mul_f32 v57, v57, v58
  v_accvgpr_write_b32 a14, v57
  v_accvgpr_read_b32 v57, a15
  v_mul_f32 v57, v57, v58
  v_accvgpr_write_b32 a15, v57
  v_accvgpr_read_b32 v57, a16
  v_mul_f32 v57, v57, v58
  v_accvgpr_write_b32 a16, v57
  v_accvgpr_read_b32 v57, a17
  v_mul_f32 v57, v57, v58
  v_accvgpr_write_b32 a17, v57
  v_accvgpr_read_b32 v57, a18
  v_mul_f32 v57, v57, v58
  v_accvgpr_write_b32 a18, v57
  v_accvgpr_read_b32 v57, a19
  v_mul_f32 v57, v57, v58
  v_accvgpr_write_b32 a19, v57
  v_accvgpr_read_b32 v57, a20
  v_mul_f32 v57, v57, v58
  v_accvgpr_write_b32 a20, v57
  v_accvgpr_read_b32 v57, a21
  v_mul_f32 v57, v57, v58
  v_accvgpr_write_b32 a21, v57
  v_accvgpr_read_b32 v57, a22
  v_mul_f32 v57, v57, v58
  v_accvgpr_write_b32 a22, v57
  v_accvgpr_read_b32 v57, a23
  v_mul_f32 v57, v57, v58
  v_accvgpr_write_b32 a23, v57
  v_accvgpr_read_b32 v57, a24
  v_mul_f32 v57, v57, v58
  v_accvgpr_write_b32 a24, v57
  v_accvgpr_read_b32 v57, a25
  v_mul_f32 v57, v57, v58
  v_accvgpr_write_b32 a25, v57
  v_accvgpr_read_b32 v57, a26
  v_mul_f32 v57, v57, v58
  v_accvgpr_write_b32 a26, v57
  v_accvgpr_read_b32 v57, a27
  v_mul_f32 v57, v57, v58
  v_accvgpr_write_b32 a27, v57
  v_accvgpr_read_b32 v57, a28
  v_mul_f32 v57, v57, v58
  v_accvgpr_write_b32 a28, v57
  v_accvgpr_read_b32 v57, a29
  v_mul_f32 v57, v57, v58
  v_accvgpr_write_b32 a29, v57
  v_accvgpr_read_b32 v57, a30
  v_mul_f32 v57, v57, v58
  v_accvgpr_write_b32 a30, v57
  v_accvgpr_read_b32 v57, a31
  v_mul_f32 v57, v57, v58
  v_accvgpr_write_b32 a31, v57
  v_max_f32 v56, v96, v97
  v_max3_f32 v56, v56, v98, v99
  v_max3_f32 v56, v56, v100, v101
  v_max3_f32 v56, v56, v102, v103
  v_max3_f32 v56, v56, v104, v105
  v_max3_f32 v56, v56, v106, v107
  v_max3_f32 v56, v56, v108, v109
  v_max3_f32 v56, v56, v110, v111
  v_max3_f32 v56, v56, v112, v113
  v_max3_f32 v56, v56, v114, v115
  v_max3_f32 v56, v56, v116, v117
  v_max3_f32 v56, v56, v118, v119
  v_max3_f32 v56, v56, v120, v121
  v_max3_f32 v56, v56, v122, v123
  v_max3_f32 v56, v56, v124, v125
  v_max3_f32 v56, v56, v126, v127
  v_mov_b32 v57, v56
  s_nop 1
  v_permlane32_swap_b32 v56, v57
  s_nop 1
  v_max_f32 v56, v56, v57
  v_mov_b32 v57, v56
  s_nop 1
  v_permlane16_swap_b32 v56, v57
  s_nop 1
  v_max_f32 v56, v56, v57
  v_max_f32 v56, 0, v56
  v_sub_f32 v20, v20, v56
  v_sub_f32 v21, v21, v56
  v_sub_f32 v22, v22, v56
  v_sub_f32 v23, v23, v56
  v_sub_f32 v96, v96, v56
  v_sub_f32 v97, v97, v56
  v_sub_f32 v98, v98, v56
  v_sub_f32 v99, v99, v56
  v_sub_f32 v100, v100, v56
  v_sub_f32 v101, v101, v56
  v_sub_f32 v102, v102, v56
  v_sub_f32 v103, v103, v56
  v_sub_f32 v104, v104, v56
  v_sub_f32 v105, v105, v56
  v_sub_f32 v106, v106, v56
  v_sub_f32 v107, v107, v56
  v_sub_f32 v108, v108, v56
  v_sub_f32 v109, v109, v56
  v_sub_f32 v110, v110, v56
  v_sub_f32 v111, v111, v56
  v_sub_f32 v112, v112, v56
  v_sub_f32 v113, v113, v56
  v_sub_f32 v114, v114, v56
  v_sub_f32 v115, v115, v56
  v_sub_f32 v116, v116, v56
  v_sub_f32 v117, v117, v56
  v_sub_f32 v118, v118, v56
  v_sub_f32 v119, v119, v56
  v_sub_f32 v120, v120, v56
  v_sub_f32 v121, v121, v56
  v_sub_f32 v122, v122, v56
  v_sub_f32 v123, v123, v56
  v_sub_f32 v124, v124, v56
  v_sub_f32 v125, v125, v56
  v_sub_f32 v126, v126, v56
  v_sub_f32 v127, v127, v56
  v_sub_f32 v160, v160, v56
  v_sub_f32 v161, v161, v56
  v_sub_f32 v162, v162, v56
  v_sub_f32 v163, v163, v56
  v_sub_f32 v164, v164, v56
  v_sub_f32 v165, v165, v56
  v_sub_f32 v166, v166, v56
  v_sub_f32 v167, v167, v56
  v_sub_f32 v168, v168, v56
  v_sub_f32 v169, v169, v56
  v_sub_f32 v170, v170, v56
  v_sub_f32 v171, v171, v56
  v_sub_f32 v172, v172, v56
  v_sub_f32 v173, v173, v56
  v_sub_f32 v174, v174, v56
  v_sub_f32 v175, v175, v56
  v_sub_f32 v176, v176, v56
  v_sub_f32 v177, v177, v56
  v_sub_f32 v178, v178, v56
  v_sub_f32 v179, v179, v56
  v_sub_f32 v180, v180, v56
  v_sub_f32 v181, v181, v56
  v_sub_f32 v182, v182, v56
  v_sub_f32 v183, v183, v56
  v_sub_f32 v184, v184, v56
  v_sub_f32 v185, v185, v56
  v_sub_f32 v186, v186, v56
  v_sub_f32 v187, v187, v56
  v_sub_f32 v188, v188, v56
  v_sub_f32 v189, v189, v56
  v_sub_f32 v190, v190, v56
  v_sub_f32 v191, v191, v56
  v_sub_f32 v58, 0, v56
  v_exp_f32 v58, v58
  s_nop 0
  v_mul_f32 v36, v36, v58
  v_mul_f32 v37, v37, v58
  v_mul_f32 v38, v38, v58
  v_mul_f32 v39, v39, v58
  v_accvgpr_read_b32 v57, a32
  v_mul_f32 v57, v57, v58
  v_accvgpr_write_b32 a32, v57
  v_accvgpr_read_b32 v57, a33
  v_mul_f32 v57, v57, v58
  v_accvgpr_write_b32 a33, v57
  v_accvgpr_read_b32 v57, a34
  v_mul_f32 v57, v57, v58
  v_accvgpr_write_b32 a34, v57
  v_accvgpr_read_b32 v57, a35
  v_mul_f32 v57, v57, v58
  v_accvgpr_write_b32 a35, v57
  v_accvgpr_read_b32 v57, a36
  v_mul_f32 v57, v57, v58
  v_accvgpr_write_b32 a36, v57
  v_accvgpr_read_b32 v57, a37
  v_mul_f32 v57, v57, v58
  v_accvgpr_write_b32 a37, v57
  v_accvgpr_read_b32 v57, a38
  v_mul_f32 v57, v57, v58
  v_accvgpr_write_b32 a38, v57
  v_accvgpr_read_b32 v57, a39
  v_mul_f32 v57, v57, v58
  v_accvgpr_write_b32 a39, v57
  v_accvgpr_read_b32 v57, a40
  v_mul_f32 v57, v57, v58
  v_accvgpr_write_b32 a40, v57
  v_accvgpr_read_b32 v57, a41
  v_mul_f32 v57, v57, v58
  v_accvgpr_write_b32 a41, v57
  v_accvgpr_read_b32 v57, a42
  v_mul_f32 v57, v57, v58
  v_accvgpr_write_b32 a42, v57
  v_accvgpr_read_b32 v57, a43
  v_mul_f32 v57, v57, v58
  v_accvgpr_write_b32 a43, v57
  v_accvgpr_read_b32 v57, a44
  v_mul_f32 v57, v57, v58
  v_accvgpr_write_b32 a44, v57
  v_accvgpr_read_b32 v57, a45
  v_mul_f32 v57, v57, v58
  v_accvgpr_write_b32 a45, v57
  v_accvgpr_read_b32 v57, a46
  v_mul_f32 v57, v57, v58
  v_accvgpr_write_b32 a46, v57
  v_accvgpr_read_b32 v57, a47
  v_mul_f32 v57, v57, v58
  v_accvgpr_write_b32 a47, v57
  v_accvgpr_read_b32 v57, a48
  v_mul_f32 v57, v57, v58
  v_accvgpr_write_b32 a48, v57
  v_accvgpr_read_b32 v57, a49
  v_mul_f32 v57, v57, v58
  v_accvgpr_write_b32 a49, v57
  v_accvgpr_read_b32 v57, a50
  v_mul_f32 v57, v57, v58
  v_accvgpr_write_b32 a50, v57
  v_accvgpr_read_b32 v57, a51
  v_mul_f32 v57, v57, v58
  v_accvgpr_write_b32 a51, v57
  v_accvgpr_read_b32 v57, a52
  v_mul_f32 v57, v57, v58
  v_accvgpr_write_b32 a52, v57
  v_accvgpr_read_b32 v57, a53
  v_mul_f32 v57, v57, v58
  v_accvgpr_write_b32 a53, v57
  v_accvgpr_read_b32 v57, a54
  v_mul_f32 v57, v57, v58
  v_accvgpr_write_b32 a54, v57
  v_accvgpr_read_b32 v57, a55
  v_mul_f32 v57, v57, v58
  v_accvgpr_write_b32 a55, v57
  v_accvgpr_read_b32 v57, a56
  v_mul_f32 v57, v57, v58
  v_accvgpr_write_b32 a56, v57
  v_accvgpr_read_b32 v57, a57
  v_mul_f32 v57, v57, v58
  v_accvgpr_write_b32 a57, v57
  v_accvgpr_read_b32 v57, a58
  v_mul_f32 v57, v57, v58
  v_accvgpr_write_b32 a58, v57
  v_accvgpr_read_b32 v57, a59
  v_mul_f32 v57, v57, v58
  v_accvgpr_write_b32 a59, v57
  v_accvgpr_read_b32 v57, a60
  v_mul_f32 v57, v57, v58
  v_accvgpr_write_b32 a60, v57
  v_accvgpr_read_b32 v57, a61
  v_mul_f32 v57, v57, v58
  v_accvgpr_write_b32 a61, v57
  v_accvgpr_read_b32 v57, a62
  v_mul_f32 v57, v57, v58
  v_accvgpr_write_b32 a62, v57
  v_accvgpr_read_b32 v57, a63
  v_mul_f32 v57, v57, v58
  v_accvgpr_write_b32 a63, v57
  v_exp_f32 v48, v64
  v_exp_f32 v49, v65
  v_exp_f32 v50, v66
  v_exp_f32 v51, v67
  v_cvt_pk_bf16_f32 v192, v48, v49
  v_exp_f32 v52, v68
  v_exp_f32 v53, v69
  v_cvt_pk_bf16_f32 v193, v50, v51
  v_pk_maximum3_f16 v11, v192, v192, v193
  v_exp_f32 v54, v70
  v_exp_f32 v55, v71
  v_cvt_pk_bf16_f32 v194, v52, v53
  v_exp_f32 v48, v96
  v_exp_f32 v49, v97
  v_cvt_pk_bf16_f32 v195, v54, v55
  v_pk_maximum3_f16 v11, v11, v194, v195
  v_exp_f32 v50, v98
  v_exp_f32 v51, v99
  v_cvt_pk_bf16_f32 v208, v48, v49
  v_exp_f32 v52, v100
  v_exp_f32 v53, v101
  v_cvt_pk_bf16_f32 v209, v50, v51
  v_pk_maximum3_f16 v11, v11, v208, v209
  v_exp_f32 v54, v102
  v_exp_f32 v55, v103
  v_cvt_pk_bf16_f32 v210, v52, v53
  v_exp_f32 v48, v72
  v_exp_f32 v49, v73
  v_cvt_pk_bf16_f32 v211, v54, v55
  v_pk_maximum3_f16 v11, v11, v210, v211
  v_exp_f32 v50, v74
  v_exp_f32 v51, v75
  v_cvt_pk_bf16_f32 v196, v48, v49
  v_exp_f32 v52, v76
  v_exp_f32 v53, v77
  v_cvt_pk_bf16_f32 v197, v50, v51
  v_pk_maximum3_f16 v11, v11, v196, v197
  v_exp_f32 v54, v78
  v_exp_f32 v55, v79
  v_cvt_pk_bf16_f32 v198, v52, v53
  v_exp_f32 v48, v104
  v_exp_f32 v49, v105
  v_cvt_pk_bf16_f32 v199, v54, v55
  v_pk_maximum3_f16 v11, v11, v198, v199
  v_exp_f32 v50, v106
  v_exp_f32 v51, v107
  v_cvt_pk_bf16_f32 v212, v48, v49
  v_exp_f32 v52, v108
  v_exp_f32 v53, v109
  v_cvt_pk_bf16_f32 v213, v50, v51
  v_pk_maximum3_f16 v11, v11, v212, v213
  v_exp_f32 v54, v110
  v_exp_f32 v55, v111
  v_cvt_pk_bf16_f32 v214, v52, v53
  v_exp_f32 v48, v80
  v_exp_f32 v49, v81
  v_cvt_pk_bf16_f32 v215, v54, v55
  v_pk_maximum3_f16 v11, v11, v214, v215
  v_exp_f32 v50, v82
  v_exp_f32 v51, v83
  v_cvt_pk_bf16_f32 v200, v48, v49
  v_exp_f32 v52, v84
  v_exp_f32 v53, v85
  v_cvt_pk_bf16_f32 v201, v50, v51
  v_pk_maximum3_f16 v11, v11, v200, v201
  v_exp_f32 v54, v86
  v_exp_f32 v55, v87
  v_cvt_pk_bf16_f32 v202, v52, v53
  v_exp_f32 v48, v112
  v_exp_f32 v49, v113
  v_cvt_pk_bf16_f32 v203, v54, v55
  v_pk_maximum3_f16 v11, v11, v202, v203
  v_exp_f32 v50, v114
  v_exp_f32 v51, v115
  v_cvt_pk_bf16_f32 v216, v48, v49
  v_exp_f32 v52, v116
  v_exp_f32 v53, v117
  v_cvt_pk_bf16_f32 v217, v50, v51
  v_pk_maximum3_f16 v11, v11, v216, v217
  v_exp_f32 v54, v118
  v_exp_f32 v55, v119
  v_cvt_pk_bf16_f32 v218, v52, v53
  v_exp_f32 v48, v88
  v_exp_f32 v49, v89
  v_cvt_pk_bf16_f32 v219, v54, v55
  v_pk_maximum3_f16 v11, v11, v218, v219
  v_exp_f32 v50, v90
  v_exp_f32 v51, v91
  v_cvt_pk_bf16_f32 v204, v48, v49
  v_exp_f32 v52, v92
  v_exp_f32 v53, v93
  v_cvt_pk_bf16_f32 v205, v50, v51
  v_pk_maximum3_f16 v11, v11, v204, v205
  v_exp_f32 v54, v94
  v_exp_f32 v55, v95
  v_cvt_pk_bf16_f32 v206, v52, v53
  v_exp_f32 v48, v120
  v_exp_f32 v49, v121
  v_cvt_pk_bf16_f32 v207, v54, v55
  v_pk_maximum3_f16 v11, v11, v206, v207
  v_exp_f32 v50, v122
  v_exp_f32 v51, v123
  v_cvt_pk_bf16_f32 v220, v48, v49
  v_exp_f32 v52, v124
  v_exp_f32 v53, v125
  v_cvt_pk_bf16_f32 v221, v50, v51
  v_pk_maximum3_f16 v11, v11, v220, v221
  v_exp_f32 v54, v126
  v_exp_f32 v55, v127
  v_cvt_pk_bf16_f32 v222, v52, v53
  s_nop 0
  v_cvt_pk_bf16_f32 v223, v54, v55
  v_pk_maximum3_f16 v11, v11, v222, v223
  s_nop 3
  s_branch K2_ret_A
K2_rare_B:
  s_nop 15
  s_nop 15
  v_max_f32 v56, v128, v129
  v_max3_f32 v56, v56, v130, v131
  v_max3_f32 v56, v56, v132, v133
  v_max3_f32 v56, v56, v134, v135
  v_max3_f32 v56, v56, v136, v137
  v_max3_f32 v56, v56, v138, v139
  v_max3_f32 v56, v56, v140, v141
  v_max3_f32 v56, v56, v142, v143
  v_max3_f32 v56, v56, v144, v145
  v_max3_f32 v56, v56, v146, v147
  v_max3_f32 v56, v56, v148, v149
  v_max3_f32 v56, v56, v150, v151
  v_max3_f32 v56, v56, v152, v153
  v_max3_f32 v56, v56, v154, v155
  v_max3_f32 v56, v56, v156, v157
  v_max3_f32 v56, v56, v158, v159
  v_mov_b32 v57, v56
  s_nop 1
  v_permlane32_swap_b32 v56, v57
  s_nop 1
  v_max_f32 v56, v56, v57
  v_mov_b32 v57, v56
  s_nop 1
  v_permlane16_swap_b32 v56, v57
  s_nop 1
  v_max_f32 v56, v56, v57
  v_max_f32 v56, 0, v56
  v_sub_f32 v16, v16, v56
  v_sub_f32 v17, v17, v56
  v_sub_f32 v18, v18, v56
  v_sub_f32 v19, v19, v56
  v_sub_f32 v128, v128, v56
  v_sub_f32 v129, v129, v56
  v_sub_f32 v130, v130, v56
  v_sub_f32 v131, v131, v56
  v_sub_f32 v132, v132, v56
  v_sub_f32 v133, v133, v56
  v_sub_f32 v134, v134, v56
  v_sub_f32 v135, v135, v56
  v_sub_f32 v136, v136, v56
  v_sub_f32 v137, v137, v56
  v_sub_f32 v138, v138, v56
  v_sub_f32 v139, v139, v56
  v_sub_f32 v140, v140, v56
  v_sub_f32 v141, v141, v56
  v_sub_f32 v142, v142, v56
  v_sub_f32 v143, v143, v56
  v_sub_f32 v144, v144, v56
  v_sub_f32 v145, v145, v56
  v_sub_f32 v146, v146, v56
  v_sub_f32 v147, v147, v56
  v_sub_f32 v148, v148, v56
  v_sub_f32 v149, v149, v56
  v_sub_f32 v150, v150, v56
  v_sub_f32 v151, v151, v56
  v_sub_f32 v152, v152, v56
  v_sub_f32 v153, v153, v56
  v_sub_f32 v154, v154, v56
  v_sub_f32 v155, v155, v56
  v_sub_f32 v156, v156, v56
  v_sub_f32 v157, v157, v56
  v_sub_f32 v158, v158, v56
  v_sub_f32 v159, v159, v56
  v_sub_f32 v64, v64, v56
  v_sub_f32 v65, v65, v56
  v_sub_f32 v66, v66, v56
  v_sub_f32 v67, v67, v56
  v_sub_f32 v68, v68, v56
  v_sub_f32 v69, v69, v56
  v_sub_f32 v70, v70, v56
  v_sub_f32 v71, v71, v56
  v_sub_f32 v72, v72, v56
  v_sub_f32 v73, v73, v56
  v_sub_f32 v74, v74, v56
  v_sub_f32 v75, v75, v56
  v_sub_f32 v76, v76, v56
  v_sub_f32 v77, v77, v56
  v_sub_f32 v78, v78, v56
  v_sub_f32 v79, v79, v56
  v_sub_f32 v80, v80, v56
  v_sub_f32 v81, v81, v56
  v_sub_f32 v82, v82, v56
  v_sub_f32 v83, v83, v56
  v_sub_f32 v84, v84, v56
  v_sub_f32 v85, v85, v56
  v_sub_f32 v86, v86, v56
  v_sub_f32 v87, v87, v56
  v_sub_f32 v88, v88, v56
  v_sub_f32 v89, v89, v56
  v_sub_f32 v90, v90, v56
  v_sub_f32 v91, v91, v56
  v_sub_f32 v92, v92, v56
  v_sub_f32 v93, v93, v56
  v_sub_f32 v94, v94, v56
  v_sub_f32 v95, v95, v56
  v_sub_f32 v58, 0, v56
  v_exp_f32 v58, v58
  s_nop 0
  v_mul_f32 v32, v32, v58
  v_mul_f32 v33, v33, v58
  v_mul_f32 v34, v34, v58
  v_mul_f32 v35, v35, v58
  v_accvgpr_read_b32 v57, a0
  v_mul_f32 v57, v57, v58
  v_accvgpr_write_b32 a0, v57
  v_accvgpr_read_b32 v57, a1
  v_mul_f32 v57, v57, v58
  v_accvgpr_write_b32 a1, v57
  v_accvgpr_read_b32 v57, a2
  v_mul_f32 v57, v57, v58
  v_accvgpr_write_b32 a2, v57
  v_accvgpr_read_b32 v57, a3
  v_mul_f32 v57, v57, v58
  v_accvgpr_write_b32 a3, v57
  v_accvgpr_read_b32 v57, a4
  v_mul_f32 v57, v57, v58
  v_accvgpr_write_b32 a4, v57
  v_accvgpr_read_b32 v57, a5
  v_mul_f32 v57, v57, v58
  v_accvgpr_write_b32 a5, v57
  v_accvgpr_read_b32 v57, a6
  v_mul_f32 v57, v57, v58
  v_accvgpr_write_b32 a6, v57
  v_accvgpr_read_b32 v57, a7
  v_mul_f32 v57, v57, v58
  v_accvgpr_write_b32 a7, v57
  v_accvgpr_read_b32 v57, a8
  v_mul_f32 v57, v57, v58
  v_accvgpr_write_b32 a8, v57
  v_accvgpr_read_b32 v57, a9
  v_mul_f32 v57, v57, v58
  v_accvgpr_write_b32 a9, v57
  v_accvgpr_read_b32 v57, a10
  v_mul_f32 v57, v57, v58
  v_accvgpr_write_b32 a10, v57
  v_accvgpr_read_b32 v57, a11
  v_mul_f32 v57, v57, v58
  v_accvgpr_write_b32 a11, v57
  v_accvgpr_read_b32 v57, a12
  v_mul_f32 v57, v57, v58
  v_accvgpr_write_b32 a12, v57
  v_accvgpr_read_b32 v57, a13
  v_mul_f32 v57, v57, v58
  v_accvgpr_write_b32 a13, v57
  v_accvgpr_read_b32 v57, a14
  v_mul_f32 v57, v57, v58
  v_accvgpr_write_b32 a14, v57
  v_accvgpr_read_b32 v57, a15
  v_mul_f32 v57, v57, v58
  v_accvgpr_write_b32 a15, v57
  v_accvgpr_read_b32 v57, a16
  v_mul_f32 v57, v57, v58
  v_accvgpr_write_b32 a16, v57
  v_accvgpr_read_b32 v57, a17
  v_mul_f32 v57, v57, v58
  v_accvgpr_write_b32 a17, v57
  v_accvgpr_read_b32 v57, a18
  v_mul_f32 v57, v57, v58
  v_accvgpr_write_b32 a18, v57
  v_accvgpr_read_b32 v57, a19
  v_mul_f32 v57, v57, v58
  v_accvgpr_write_b32 a19, v57
  v_accvgpr_read_b32 v57, a20
  v_mul_f32 v57, v57, v58
  v_accvgpr_write_b32 a20, v57
  v_accvgpr_read_b32 v57, a21
  v_mul_f32 v57, v57, v58
  v_accvgpr_write_b32 a21, v57
  v_accvgpr_read_b32 v57, a22
  v_mul_f32 v57, v57, v58
  v_accvgpr_write_b32 a22, v57
  v_accvgpr_read_b32 v57, a23
  v_mul_f32 v57, v57, v58
  v_accvgpr_write_b32 a23, v57
  v_accvgpr_read_b32 v57, a24
  v_mul_f32 v57, v57, v58
  v_accvgpr_write_b32 a24, v57
  v_accvgpr_read_b32 v57, a25
  v_mul_f32 v57, v57, v58
  v_accvgpr_write_b32 a25, v57
  v_accvgpr_read_b32 v57, a26
  v_mul_f32 v57, v57, v58
  v_accvgpr_write_b32 a26, v57
  v_accvgpr_read_b32 v57, a27
  v_mul_f32 v57, v57, v58
  v_accvgpr_write_b32 a27, v57
  v_accvgpr_read_b32 v57, a28
  v_mul_f32 v57, v57, v58
  v_accvgpr_write_b32 a28, v57
  v_accvgpr_read_b32 v57, a29
  v_mul_f32 v57, v57, v58
  v_accvgpr_write_b32 a29, v57
  v_accvgpr_read_b32 v57, a30
  v_mul_f32 v57, v57, v58
  v_accvgpr_write_b32 a30, v57
  v_accvgpr_read_b32 v57, a31
  v_mul_f32 v57, v57, v58
  v_accvgpr_write_b32 a31, v57
  v_max_f32 v56, v160, v161
  v_max3_f32 v56, v56, v162, v163
  v_max3_f32 v56, v56, v164, v165
  v_max3_f32 v56, v56, v166, v167
  v_max3_f32 v56, v56, v168, v169
  v_max3_f32 v56, v56, v170, v171
  v_max3_f32 v56, v56, v172, v173
  v_max3_f32 v56, v56, v174, v175
  v_max3_f32 v56, v56, v176, v177
  v_max3_f32 v56, v56, v178, v179
  v_max3_f32 v56, v56, v180, v181
  v_max3_f32 v56, v56, v182, v183
  v_max3_f32 v56, v56, v184, v185
  v_max3_f32 v56, v56, v186, v187
  v_max3_f32 v56, v56, v188, v189
  v_max3_f32 v56, v56, v190, v191
  v_mov_b32 v57, v56
  s_nop 1
  v_permlane32_swap_b32 v56, v57
  s_nop 1
  v_max_f32 v56, v56, v57
  v_mov_b32 v57, v56
  s_nop 1
  v_permlane16_swap_b32 v56, v57
  s_nop 1
  v_max_f32 v56, v56, v57
  v_max_f32 v56, 0, v56
  v_sub_f32 v20, v20, v56
  v_sub_f32 v21, v21, v56
  v_sub_f32 v22, v22, v56
  v_sub_f32 v23, v23, v56
  v_sub_f32 v160, v160, v56
  v_sub_f32 v161, v161, v56
  v_sub_f32 v162, v162, v56
  v_sub_f32 v163, v163, v56
  v_sub_f32 v164, v164, v56
  v_sub_f32 v165, v165, v56
  v_sub_f32 v166, v166, v56
  v_sub_f32 v167, v167, v56
  v_sub_f32 v168, v168, v56
  v_sub_f32 v169, v169, v56
  v_sub_f32 v170, v170, v56
  v_sub_f32 v171, v171, v56
  v_sub_f32 v172, v172, v56
  v_sub_f32 v173, v173, v56
  v_sub_f32 v174, v174, v56
  v_sub_f32 v175, v175, v56
  v_sub_f32 v176, v176, v56
  v_sub_f32 v177, v177, v56
  v_sub_f32 v178, v178, v56
  v_sub_f32 v179, v179, v56
  v_sub_f32 v180, v180, v56
  v_sub_f32 v181, v181, v56
  v_sub_f32 v182, v182, v56
  v_sub_f32 v183, v183, v56
  v_sub_f32 v184, v184, v56
  v_sub_f32 v185, v185, v56
  v_sub_f32 v186, v186, v56
  v_sub_f32 v187, v187, v56
  v_sub_f32 v188, v188, v56
  v_sub_f32 v189, v189, v56
  v_sub_f32 v190, v190, v56
  v_sub_f32 v191, v191, v56
  v_sub_f32 v96, v96, v56
  v_sub_f32 v97, v97, v56
  v_sub_f32 v98, v98, v56
  v_sub_f32 v99, v99, v56
  v_sub_f32 v100, v100, v56
  v_sub_f32 v101, v101, v56
  v_sub_f32 v102, v102, v56
  v_sub_f32 v103, v103, v56
  v_sub_f32 v104, v104, v56
  v_sub_f32 v105, v105, v56
  v_sub_f32 v106, v106, v56
  v_sub_f32 v107, v107, v56
  v_sub_f32 v108, v108, v56
  v_sub_f32 v109, v109, v56
  v_sub_f32 v110, v110, v56
  v_sub_f32 v111, v111, v56
  v_sub_f32 v112, v112, v56
  v_sub_f32 v113, v113, v56
  v_sub_f32 v114, v114, v56
  v_sub_f32 v115, v115, v56
  v_sub_f32 v116, v116, v56
  v_sub_f32 v117, v117, v56
  v_sub_f32 v118, v118, v56
  v_sub_f32 v119, v119, v56
  v_sub_f32 v120, v120, v56
  v_sub_f32 v121, v121, v56
  v_sub_f32 v122, v122, v56
  v_sub_f32 v123, v123, v56
  v_sub_f32 v124, v124, v56
  v_sub_f32 v125, v125, v56
  v_sub_f32 v126, v126, v56
  v_sub_f32 v127, v127, v56
  v_sub_f32 v58, 0, v56
  v_exp_f32 v58, v58
  s_nop 0
  v_mul_f32 v36, v36, v58
  v_mul_f32 v37, v37, v58
  v_mul_f32 v38, v38, v58
  v_mul_f32 v39, v39, v58
  v_accvgpr_read_b32 v57, a32
  v_mul_f32 v57, v57, v58
  v_accvgpr_write_b32 a32, v57
  v_accvgpr_read_b32 v57, a33
  v_mul_f32 v57, v57, v58
  v_accvgpr_write_b32 a33, v57
  v_accvgpr_read_b32 v57, a34
  v_mul_f32 v57, v57, v58
  v_accvgpr_write_b32 a34, v57
  v_accvgpr_read_b32 v57, a35
  v_mul_f32 v57, v57, v58
  v_accvgpr_write_b32 a35, v57
  v_accvgpr_read_b32 v57, a36
  v_mul_f32 v57, v57, v58
  v_accvgpr_write_b32 a36, v57
  v_accvgpr_read_b32 v57, a37
  v_mul_f32 v57, v57, v58
  v_accvgpr_write_b32 a37, v57
  v_accvgpr_read_b32 v57, a38
  v_mul_f32 v57, v57, v58
  v_accvgpr_write_b32 a38, v57
  v_accvgpr_read_b32 v57, a39
  v_mul_f32 v57, v57, v58
  v_accvgpr_write_b32 a39, v57
  v_accvgpr_read_b32 v57, a40
  v_mul_f32 v57, v57, v58
  v_accvgpr_write_b32 a40, v57
  v_accvgpr_read_b32 v57, a41
  v_mul_f32 v57, v57, v58
  v_accvgpr_write_b32 a41, v57
  v_accvgpr_read_b32 v57, a42
  v_mul_f32 v57, v57, v58
  v_accvgpr_write_b32 a42, v57
  v_accvgpr_read_b32 v57, a43
  v_mul_f32 v57, v57, v58
  v_accvgpr_write_b32 a43, v57
  v_accvgpr_read_b32 v57, a44
  v_mul_f32 v57, v57, v58
  v_accvgpr_write_b32 a44, v57
  v_accvgpr_read_b32 v57, a45
  v_mul_f32 v57, v57, v58
  v_accvgpr_write_b32 a45, v57
  v_accvgpr_read_b32 v57, a46
  v_mul_f32 v57, v57, v58
  v_accvgpr_write_b32 a46, v57
  v_accvgpr_read_b32 v57, a47
  v_mul_f32 v57, v57, v58
  v_accvgpr_write_b32 a47, v57
  v_accvgpr_read_b32 v57, a48
  v_mul_f32 v57, v57, v58
  v_accvgpr_write_b32 a48, v57
  v_accvgpr_read_b32 v57, a49
  v_mul_f32 v57, v57, v58
  v_accvgpr_write_b32 a49, v57
  v_accvgpr_read_b32 v57, a50
  v_mul_f32 v57, v57, v58
  v_accvgpr_write_b32 a50, v57
  v_accvgpr_read_b32 v57, a51
  v_mul_f32 v57, v57, v58
  v_accvgpr_write_b32 a51, v57
  v_accvgpr_read_b32 v57, a52
  v_mul_f32 v57, v57, v58
  v_accvgpr_write_b32 a52, v57
  v_accvgpr_read_b32 v57, a53
  v_mul_f32 v57, v57, v58
  v_accvgpr_write_b32 a53, v57
  v_accvgpr_read_b32 v57, a54
  v_mul_f32 v57, v57, v58
  v_accvgpr_write_b32 a54, v57
  v_accvgpr_read_b32 v57, a55
  v_mul_f32 v57, v57, v58
  v_accvgpr_write_b32 a55, v57
  v_accvgpr_read_b32 v57, a56
  v_mul_f32 v57, v57, v58
  v_accvgpr_write_b32 a56, v57
  v_accvgpr_read_b32 v57, a57
  v_mul_f32 v57, v57, v58
  v_accvgpr_write_b32 a57, v57
  v_accvgpr_read_b32 v57, a58
  v_mul_f32 v57, v57, v58
  v_accvgpr_write_b32 a58, v57
  v_accvgpr_read_b32 v57, a59
  v_mul_f32 v57, v57, v58
  v_accvgpr_write_b32 a59, v57
  v_accvgpr_read_b32 v57, a60
  v_mul_f32 v57, v57, v58
  v_accvgpr_write_b32 a60, v57
  v_accvgpr_read_b32 v57, a61
  v_mul_f32 v57, v57, v58
  v_accvgpr_write_b32 a61, v57
  v_accvgpr_read_b32 v57, a62
  v_mul_f32 v57, v57, v58
  v_accvgpr_write_b32 a62, v57
  v_accvgpr_read_b32 v57, a63
  v_mul_f32 v57, v57, v58
  v_accvgpr_write_b32 a63, v57
  v_exp_f32 v48, v128
  v_exp_f32 v49, v129
  v_exp_f32 v50, v130
  v_exp_f32 v51, v131
  v_cvt_pk_bf16_f32 v224, v48, v49
  v_exp_f32 v52, v132
  v_exp_f32 v53, v133
  v_cvt_pk_bf16_f32 v225, v50, v51
  v_pk_maximum3_f16 v11, v224, v224, v225
  v_exp_f32 v54, v134
  v_exp_f32 v55, v135
  v_cvt_pk_bf16_f32 v226, v52, v53
  v_exp_f32 v48, v160
  v_exp_f32 v49, v161
  v_cvt_pk_bf16_f32 v227, v54, v55
  v_pk_maximum3_f16 v11, v11, v226, v227
  v_exp_f32 v50, v162
  v_exp_f32 v51, v163
  v_cvt_pk_bf16_f32 v240, v48, v49
  v_exp_f32 v52, v164
  v_exp_f32 v53, v165
  v_cvt_pk_bf16_f32 v241, v50, v51
  v_pk_maximum3_f16 v11, v11, v240, v241
  v_exp_f32 v54, v166
  v_exp_f32 v55, v167
  v_cvt_pk_bf16_f32 v242, v52, v53
  v_exp_f32 v48, v136
  v_exp_f32 v49, v137
  v_cvt_pk_bf16_f32 v243, v54, v55
  v_pk_maximum3_f16 v11, v11, v242, v243
  v_exp_f32 v50, v138
  v_exp_f32 v51, v139
  v_cvt_pk_bf16_f32 v228, v48, v49
  v_exp_f32 v52, v140
  v_exp_f32 v53, v141
  v_cvt_pk_bf16_f32 v229, v50, v51
  v_pk_maximum3_f16 v11, v11, v228, v229
  v_exp_f32 v54, v142
  v_exp_f32 v55, v143
  v_cvt_pk_bf16_f32 v230, v52, v53
  v_exp_f32 v48, v168
  v_exp_f32 v49, v169
  v_cvt_pk_bf16_f32 v231, v54, v55
  v_pk_maximum3_f16 v11, v11, v230, v231
  v_exp_f32 v50, v170
  v_exp_f32 v51, v171
  v_cvt_pk_bf16_f32 v244, v48, v49
  v_exp_f32 v52, v172
  v_exp_f32 v53, v173
  v_cvt_pk_bf16_f32 v245, v50, v51
  v_pk_maximum3_f16 v11, v11, v244, v245
  v_exp_f32 v54, v174
  v_exp_f32 v55, v175
  v_cvt_pk_bf16_f32 v246, v52, v53
  v_exp_f32 v48, v144
  v_exp_f32 v49, v145
  v_cvt_pk_bf16_f32 v247, v54, v55
  v_pk_maximum3_f16 v11, v11, v246, v247
  v_exp_f32 v50, v146
  v_exp_f32 v51, v147
  v_cvt_pk_bf16_f32 v232, v48, v49
  v_exp_f32 v52, v148
  v_exp_f32 v53, v149
  v_cvt_pk_bf16_f32 v233, v50, v51
  v_pk_maximum3_f16 v11, v11, v232, v233
  v_exp_f32 v54, v150
  v_exp_f32 v55, v151
  v_cvt_pk_bf16_f32 v234, v52, v53
  v_exp_f32 v48, v176
  v_exp_f32 v49, v177
  v_cvt_pk_bf16_f32 v235, v54, v55
  v_pk_maximum3_f16 v11, v11, v234, v235
  v_exp_f32 v50, v178
  v_exp_f32 v51, v179
  v_cvt_pk_bf16_f32 v248, v48, v49
  v_exp_f32 v52, v180
  v_exp_f32 v53, v181
  v_cvt_pk_bf16_f32 v249, v50, v51
  v_pk_maximum3_f16 v11, v11, v248, v249
  v_exp_f32 v54, v182
  v_exp_f32 v55, v183
  v_cvt_pk_bf16_f32 v250, v52, v53
  v_exp_f32 v48, v152
  v_exp_f32 v49, v153
  v_cvt_pk_bf16_f32 v251, v54, v55
  v_pk_maximum3_f16 v11, v11, v250, v251
  v_exp_f32 v50, v154
  v_exp_f32 v51, v155
  v_cvt_pk_bf16_f32 v236, v48, v49
  v_exp_f32 v52, v156
  v_exp_f32 v53, v157
  v_cvt_pk_bf16_f32 v237, v50, v51
  v_pk_maximum3_f16 v11, v11, v236, v237
  v_exp_f32 v54, v158
  v_exp_f32 v55, v159
  v_cvt_pk_bf16_f32 v238, v52, v53
  v_exp_f32 v48, v184
  v_exp_f32 v49, v185
  v_cvt_pk_bf16_f32 v239, v54, v55
  v_pk_maximum3_f16 v11, v11, v238, v239
  v_exp_f32 v50, v186
  v_exp_f32 v51, v187
  v_cvt_pk_bf16_f32 v252, v48, v49
  v_exp_f32 v52, v188
  v_exp_f32 v53, v189
  v_cvt_pk_bf16_f32 v253, v50, v51
  v_pk_maximum3_f16 v11, v11, v252, v253
  v_exp_f32 v54, v190
  v_exp_f32 v55, v191
  v_cvt_pk_bf16_f32 v254, v52, v53
  s_nop 0
  v_cvt_pk_bf16_f32 v255, v54, v55
  v_pk_maximum3_f16 v11, v11, v254, v255
  s_nop 3
  s_branch K2_ret_B
K2_rare_G2:
  s_nop 15
  s_nop 15
  v_max_f32 v56, v64, v65
  v_max3_f32 v56, v56, v66, v67
  v_max3_f32 v56, v56, v68, v69
  v_max3_f32 v56, v56, v70, v71
  v_max3_f32 v56, v56, v72, v73
  v_max3_f32 v56, v56, v74, v75
  v_max3_f32 v56, v56, v76, v77
  v_max3_f32 v56, v56, v78, v79
  v_max3_f32 v56, v56, v80, v81
  v_max3_f32 v56, v56, v82, v83
  v_max3_f32 v56, v56, v84, v85
  v_max3_f32 v56, v56, v86, v87
  v_max3_f32 v56, v56, v88, v89
  v_max3_f32 v56, v56, v90, v91
  v_max3_f32 v56, v56, v92, v93
  v_max3_f32 v56, v56, v94, v95
  v_mov_b32 v57, v56
  s_nop 1
  v_permlane32_swap_b32 v56, v57
  s_nop 1
  v_max_f32 v56, v56, v57
  v_mov_b32 v57, v56
  s_nop 1
  v_permlane16_swap_b32 v56, v57
  s_nop 1
  v_max_f32 v56, v56, v57
  v_max_f32 v56, 0, v56
  v_sub_f32 v16, v16, v56
  v_sub_f32 v17, v17, v56
  v_sub_f32 v18, v18, v56
  v_sub_f32 v19, v19, v56
  v_sub_f32 v64, v64, v56
  v_sub_f32 v65, v65, v56
  v_sub_f32 v66, v66, v56
  v_sub_f32 v67, v67, v56
  v_sub_f32 v68, v68, v56
  v_sub_f32 v69, v69, v56
  v_sub_f32 v70, v70, v56
  v_sub_f32 v71, v71, v56
  v_sub_f32 v72, v72, v56
  v_sub_f32 v73, v73, v56
  v_sub_f32 v74, v74, v56
  v_sub_f32 v75, v75, v56
  v_sub_f32 v76, v76, v56
  v_sub_f32 v77, v77, v56
  v_sub_f32 v78, v78, v56
  v_sub_f32 v79, v79, v56
  v_sub_f32 v80, v80, v56
  v_sub_f32 v81, v81, v56
  v_sub_f32 v82, v82, v56
  v_sub_f32 v83, v83, v56
  v_sub_f32 v84, v84, v56
  v_sub_f32 v85, v85, v56
  v_sub_f32 v86, v86, v56
  v_sub_f32 v87, v87, v56
  v_sub_f32 v88, v88, v56
  v_sub_f32 v89, v89, v56
  v_sub_f32 v90, v90, v56
  v_sub_f32 v91, v91, v56
  v_sub_f32 v92, v92, v56
  v_sub_f32 v93, v93, v56
  v_sub_f32 v94, v94, v56
  v_sub_f32 v95, v95, v56
  v_sub_f32 v58, 0, v56
  v_exp_f32 v58, v58
  s_nop 0
  v_mul_f32 v32, v32, v58
  v_mul_f32 v33, v33, v58
  v_mul_f32 v34, v34, v58
  v_mul_f32 v35, v35, v58
  v_accvgpr_read_b32 v57, a0
  v_mul_f32 v57, v57, v58
  v_accvgpr_write_b32 a0, v57
  v_accvgpr_read_b32 v57, a1
  v_mul_f32 v57, v57, v58
  v_accvgpr_write_b32 a1, v57
  v_accvgpr_read_b32 v57, a2
  v_mul_f32 v57, v57, v58
  v_accvgpr_write_b32 a2, v57
  v_accvgpr_read_b32 v57, a3
  v_mul_f32 v57, v57, v58
  v_accvgpr_write_b32 a3, v57
  v_accvgpr_read_b32 v57, a4
  v_mul_f32 v57, v57, v58
  v_accvgpr_write_b32 a4, v57
  v_accvgpr_read_b32 v57, a5
  v_mul_f32 v57, v57, v58
  v_accvgpr_write_b32 a5, v57
  v_accvgpr_read_b32 v57, a6
  v_mul_f32 v57, v57, v58
  v_accvgpr_write_b32 a6, v57
  v_accvgpr_read_b32 v57, a7
  v_mul_f32 v57, v57, v58
  v_accvgpr_write_b32 a7, v57
  v_accvgpr_read_b32 v57, a8
  v_mul_f32 v57, v57, v58
  v_accvgpr_write_b32 a8, v57
  v_accvgpr_read_b32 v57, a9
  v_mul_f32 v57, v57, v58
  v_accvgpr_write_b32 a9, v57
  v_accvgpr_read_b32 v57, a10
  v_mul_f32 v57, v57, v58
  v_accvgpr_write_b32 a10, v57
  v_accvgpr_read_b32 v57, a11
  v_mul_f32 v57, v57, v58
  v_accvgpr_write_b32 a11, v57
  v_accvgpr_read_b32 v57, a12
  v_mul_f32 v57, v57, v58
  v_accvgpr_write_b32 a12, v57
  v_accvgpr_read_b32 v57, a13
  v_mul_f32 v57, v57, v58
  v_accvgpr_write_b32 a13, v57
  v_accvgpr_read_b32 v57, a14
  v_mul_f32 v57, v57, v58
  v_accvgpr_write_b32 a14, v57
  v_accvgpr_read_b32 v57, a15
  v_mul_f32 v57, v57, v58
  v_accvgpr_write_b32 a15, v57
  v_accvgpr_read_b32 v57, a16
  v_mul_f32 v57, v57, v58
  v_accvgpr_write_b32 a16, v57
  v_accvgpr_read_b32 v57, a17
  v_mul_f32 v57, v57, v58
  v_accvgpr_write_b32 a17, v57
  v_accvgpr_read_b32 v57, a18
  v_mul_f32 v57, v57, v58
  v_accvgpr_write_b32 a18, v57
  v_accvgpr_read_b32 v57, a19
  v_mul_f32 v57, v57, v58
  v_accvgpr_write_b32 a19, v57
  v_accvgpr_read_b32 v57, a20
  v_mul_f32 v57, v57, v58
  v_accvgpr_write_b32 a20, v57
  v_accvgpr_read_b32 v57, a21
  v_mul_f32 v57, v57, v58
  v_accvgpr_write_b32 a21, v57
  v_accvgpr_read_b32 v57, a22
  v_mul_f32 v57, v57, v58
  v_accvgpr_write_b32 a22, v57
  v_accvgpr_read_b32 v57, a23
  v_mul_f32 v57, v57, v58
  v_accvgpr_write_b32 a23, v57
  v_accvgpr_read_b32 v57, a24
  v_mul_f32 v57, v57, v58
  v_accvgpr_write_b32 a24, v57
  v_accvgpr_read_b32 v57, a25
  v_mul_f32 v57, v57, v58
  v_accvgpr_write_b32 a25, v57
  v_accvgpr_read_b32 v57, a26
  v_mul_f32 v57, v57, v58
  v_accvgpr_write_b32 a26, v57
  v_accvgpr_read_b32 v57, a27
  v_mul_f32 v57, v57, v58
  v_accvgpr_write_b32 a27, v57
  v_accvgpr_read_b32 v57, a28
  v_mul_f32 v57, v57, v58
  v_accvgpr_write_b32 a28, v57
  v_accvgpr_read_b32 v57, a29
  v_mul_f32 v57, v57, v58
  v_accvgpr_write_b32 a29, v57
  v_accvgpr_read_b32 v57, a30
  v_mul_f32 v57, v57, v58
  v_accvgpr_write_b32 a30, v57
  v_accvgpr_read_b32 v57, a31
  v_mul_f32 v57, v57, v58
  v_accvgpr_write_b32 a31, v57
  v_max_f32 v56, v96, v97
  v_max3_f32 v56, v56, v98, v99
  v_max3_f32 v56, v56, v100, v101
  v_max3_f32 v56, v56, v102, v103
  v_max3_f32 v56, v56, v104, v105
  v_max3_f32 v56, v56, v106, v107
  v_max3_f32 v56, v56, v108, v109
  v_max3_f32 v56, v56, v110, v111
  v_max3_f32 v56, v56, v112, v113
  v_max3_f32 v56, v56, v114, v115
  v_max3_f32 v56, v56, v116, v117
  v_max3_f32 v56, v56, v118, v119
  v_max3_f32 v56, v56, v120, v121
  v_max3_f32 v56, v56, v122, v123
  v_max3_f32 v56, v56, v124, v125
  v_max3_f32 v56, v56, v126, v127
  v_mov_b32 v57, v56
  s_nop 1
  v_permlane32_swap_b32 v56, v57
  s_nop 1
  v_max_f32 v56, v56, v57
  v_mov_b32 v57, v56
  s_nop 1
  v_permlane16_swap_b32 v56, v57
  s_nop 1
  v_max_f32 v56, v56, v57
  v_max_f32 v56, 0, v56
  v_sub_f32 v20, v20, v56
  v_sub_f32 v21, v21, v56
  v_sub_f32 v22, v22, v56
  v_sub_f32 v23, v23, v56
  v_sub_f32 v96, v96, v56
  v_sub_f32 v97, v97, v56
  v_sub_f32 v98, v98, v56
  v_sub_f32 v99, v99, v56
  v_sub_f32 v100, v100, v56
  v_sub_f32 v101, v101, v56
  v_sub_f32 v102, v102, v56
  v_sub_f32 v103, v103, v56
  v_sub_f32 v104, v104, v56
  v_sub_f32 v105, v105, v56
  v_sub_f32 v106, v106, v56
  v_sub_f32 v107, v107, v56
  v_sub_f32 v108, v108, v56
  v_sub_f32 v109, v109, v56
  v_sub_f32 v110, v110, v56
  v_sub_f32 v111, v111, v56
  v_sub_f32 v112, v112, v56
  v_sub_f32 v113, v113, v56
  v_sub_f32 v114, v114, v56
  v_sub_f32 v115, v115, v56
  v_sub_f32 v116, v116, v56
  v_sub_f32 v117, v117, v56
  v_sub_f32 v118, v118, v56
  v_sub_f32 v119, v119, v56
  v_sub_f32 v120, v120, v56
  v_sub_f32 v121, v121, v56
  v_sub_f32 v122, v122, v56
  v_sub_f32 v123, v123, v56
  v_sub_f32 v124, v124, v56
  v_sub_f32 v125, v125, v56
  v_sub_f32 v126, v126, v56
  v_sub_f32 v127, v127, v56
  v_sub_f32 v58, 0, v56
  v_exp_f32 v58, v58
  s_nop 0
  v_mul_f32 v36, v36, v58
  v_mul_f32 v37, v37, v58
  v_mul_f32 v38, v38, v58
  v_mul_f32 v39, v39, v58
  v_accvgpr_read_b32 v57, a32
  v_mul_f32 v57, v57, v58
  v_accvgpr_write_b32 a32, v57
  v_accvgpr_read_b32 v57, a33
  v_mul_f32 v57, v57, v58
  v_accvgpr_write_b32 a33, v57
  v_accvgpr_read_b32 v57, a34
  v_mul_f32 v57, v57, v58
  v_accvgpr_write_b32 a34, v57
  v_accvgpr_read_b32 v57, a35
  v_mul_f32 v57, v57, v58
  v_accvgpr_write_b32 a35, v57
  v_accvgpr_read_b32 v57, a36
  v_mul_f32 v57, v57, v58
  v_accvgpr_write_b32 a36, v57
  v_accvgpr_read_b32 v57, a37
  v_mul_f32 v57, v57, v58
  v_accvgpr_write_b32 a37, v57
  v_accvgpr_read_b32 v57, a38
  v_mul_f32 v57, v57, v58
  v_accvgpr_write_b32 a38, v57
  v_accvgpr_read_b32 v57, a39
  v_mul_f32 v57, v57, v58
  v_accvgpr_write_b32 a39, v57
  v_accvgpr_read_b32 v57, a40
  v_mul_f32 v57, v57, v58
  v_accvgpr_write_b32 a40, v57
  v_accvgpr_read_b32 v57, a41
  v_mul_f32 v57, v57, v58
  v_accvgpr_write_b32 a41, v57
  v_accvgpr_read_b32 v57, a42
  v_mul_f32 v57, v57, v58
  v_accvgpr_write_b32 a42, v57
  v_accvgpr_read_b32 v57, a43
  v_mul_f32 v57, v57, v58
  v_accvgpr_write_b32 a43, v57
  v_accvgpr_read_b32 v57, a44
  v_mul_f32 v57, v57, v58
  v_accvgpr_write_b32 a44, v57
  v_accvgpr_read_b32 v57, a45
  v_mul_f32 v57, v57, v58
  v_accvgpr_write_b32 a45, v57
  v_accvgpr_read_b32 v57, a46
  v_mul_f32 v57, v57, v58
  v_accvgpr_write_b32 a46, v57
  v_accvgpr_read_b32 v57, a47
  v_mul_f32 v57, v57, v58
  v_accvgpr_write_b32 a47, v57
  v_accvgpr_read_b32 v57, a48
  v_mul_f32 v57, v57, v58
  v_accvgpr_write_b32 a48, v57
  v_accvgpr_read_b32 v57, a49
  v_mul_f32 v57, v57, v58
  v_accvgpr_write_b32 a49, v57
  v_accvgpr_read_b32 v57, a50
  v_mul_f32 v57, v57, v58
  v_accvgpr_write_b32 a50, v57
  v_accvgpr_read_b32 v57, a51
  v_mul_f32 v57, v57, v58
  v_accvgpr_write_b32 a51, v57
  v_accvgpr_read_b32 v57, a52
  v_mul_f32 v57, v57, v58
  v_accvgpr_write_b32 a52, v57
  v_accvgpr_read_b32 v57, a53
  v_mul_f32 v57, v57, v58
  v_accvgpr_write_b32 a53, v57
  v_accvgpr_read_b32 v57, a54
  v_mul_f32 v57, v57, v58
  v_accvgpr_write_b32 a54, v57
  v_accvgpr_read_b32 v57, a55
  v_mul_f32 v57, v57, v58
  v_accvgpr_write_b32 a55, v57
  v_accvgpr_read_b32 v57, a56
  v_mul_f32 v57, v57, v58
  v_accvgpr_write_b32 a56, v57
  v_accvgpr_read_b32 v57, a57
  v_mul_f32 v57, v57, v58
  v_accvgpr_write_b32 a57, v57
  v_accvgpr_read_b32 v57, a58
  v_mul_f32 v57, v57, v58
  v_accvgpr_write_b32 a58, v57
  v_accvgpr_read_b32 v57, a59
  v_mul_f32 v57, v57, v58
  v_accvgpr_write_b32 a59, v57
  v_accvgpr_read_b32 v57, a60
  v_mul_f32 v57, v57, v58
  v_accvgpr_write_b32 a60, v57
  v_accvgpr_read_b32 v57, a61
  v_mul_f32 v57, v57, v58
  v_accvgpr_write_b32 a61, v57
  v_accvgpr_read_b32 v57, a62
  v_mul_f32 v57, v57, v58
  v_accvgpr_write_b32 a62, v57
  v_accvgpr_read_b32 v57, a63
  v_mul_f32 v57, v57, v58
  v_accvgpr_write_b32 a63, v57
  v_exp_f32 v48, v64
  v_exp_f32 v49, v65
  v_exp_f32 v50, v66
  v_exp_f32 v51, v67
  v_cvt_pk_bf16_f32 v192, v48, v49
  v_exp_f32 v52, v68
  v_exp_f32 v53, v69
  v_cvt_pk_bf16_f32 v193, v50, v51
  v_pk_maximum3_f16 v11, v192, v192, v193
  v_exp_f32 v54, v70
  v_exp_f32 v55, v71
  v_cvt_pk_bf16_f32 v194, v52, v53
  v_exp_f32 v48, v96
  v_exp_f32 v49, v97
  v_cvt_pk_bf16_f32 v195, v54, v55
  v_pk_maximum3_f16 v11, v11, v194, v195
  v_exp_f32 v50, v98
  v_exp_f32 v51, v99
  v_cvt_pk_bf16_f32 v208, v48, v49
  v_exp_f32 v52, v100
  v_exp_f32 v53, v101
  v_cvt_pk_bf16_f32 v209, v50, v51
  v_pk_maximum3_f16 v11, v11, v208, v209
  v_exp_f32 v54, v102
  v_exp_f32 v55, v103
  v_cvt_pk_bf16_f32 v210, v52, v53
  v_exp_f32 v48, v72
  v_exp_f32 v49, v73
  v_cvt_pk_bf16_f32 v211, v54, v55
  v_pk_maximum3_f16 v11, v11, v210, v211
  v_exp_f32 v50, v74
  v_exp_f32 v51, v75
  v_cvt_pk_bf16_f32 v196, v48, v49
  v_exp_f32 v52, v76
  v_exp_f32 v53, v77
  v_cvt_pk_bf16_f32 v197, v50, v51
  v_pk_maximum3_f16 v11, v11, v196, v197
  v_exp_f32 v54, v78
  v_exp_f32 v55, v79
  v_cvt_pk_bf16_f32 v198, v52, v53
  v_exp_f32 v48, v104
  v_exp_f32 v49, v105
  v_cvt_pk_bf16_f32 v199, v54, v55
  v_pk_maximum3_f16 v11, v11, v198, v199
  v_exp_f32 v50, v106
  v_exp_f32 v51, v107
  v_cvt_pk_bf16_f32 v212, v48, v49
  v_exp_f32 v52, v108
  v_exp_f32 v53, v109
  v_cvt_pk_bf16_f32 v213, v50, v51
  v_pk_maximum3_f16 v11, v11, v212, v213
  v_exp_f32 v54, v110
  v_exp_f32 v55, v111
  v_cvt_pk_bf16_f32 v214, v52, v53
  v_exp_f32 v48, v80
  v_exp_f32 v49, v81
  v_cvt_pk_bf16_f32 v215, v54, v55
  v_pk_maximum3_f16 v11, v11, v214, v215
  v_exp_f32 v50, v82
  v_exp_f32 v51, v83
  v_cvt_pk_bf16_f32 v200, v48, v49
  v_exp_f32 v52, v84
  v_exp_f32 v53, v85
  v_cvt_pk_bf16_f32 v201, v50, v51
  v_pk_maximum3_f16 v11, v11, v200, v201
  v_exp_f32 v54, v86
  v_exp_f32 v55, v87
  v_cvt_pk_bf16_f32 v202, v52, v53
  v_exp_f32 v48, v112
  v_exp_f32 v49, v113
  v_cvt_pk_bf16_f32 v203, v54, v55
  v_pk_maximum3_f16 v11, v11, v202, v203
  v_exp_f32 v50, v114
  v_exp_f32 v51, v115
  v_cvt_pk_bf16_f32 v216, v48, v49
  v_exp_f32 v52, v116
  v_exp_f32 v53, v117
  v_cvt_pk_bf16_f32 v217, v50, v51
  v_pk_maximum3_f16 v11, v11, v216, v217
  v_exp_f32 v54, v118
  v_exp_f32 v55, v119
  v_cvt_pk_bf16_f32 v218, v52, v53
  v_exp_f32 v48, v88
  v_exp_f32 v49, v89
  v_cvt_pk_bf16_f32 v219, v54, v55
  v_pk_maximum3_f16 v11, v11, v218, v219
  v_exp_f32 v50, v90
  v_exp_f32 v51, v91
  v_cvt_pk_bf16_f32 v204, v48, v49
  v_exp_f32 v52, v92
  v_exp_f32 v53, v93
  v_cvt_pk_bf16_f32 v205, v50, v51
  v_pk_maximum3_f16 v11, v11, v204, v205
  v_exp_f32 v54, v94
  v_exp_f32 v55, v95
  v_cvt_pk_bf16_f32 v206, v52, v53
  v_exp_f32 v48, v120
  v_exp_f32 v49, v121
  v_cvt_pk_bf16_f32 v207, v54, v55
  v_pk_maximum3_f16 v11, v11, v206, v207
  v_exp_f32 v50, v122
  v_exp_f32 v51, v123
  v_cvt_pk_bf16_f32 v220, v48, v49
  v_exp_f32 v52, v124
  v_exp_f32 v53, v125
  v_cvt_pk_bf16_f32 v221, v50, v51
  v_pk_maximum3_f16 v11, v11, v220, v221
  v_exp_f32 v54, v126
  v_exp_f32 v55, v127
  v_cvt_pk_bf16_f32 v222, v52, v53
  s_nop 0
  v_cvt_pk_bf16_f32 v223, v54, v55
  v_pk_maximum3_f16 v11, v11, v222, v223
  s_nop 3
  s_branch K2_ret_G2
K2_rare_G:
  s_nop 15
  s_nop 15
  v_max_f32 v56, v64, v65
  v_max3_f32 v56, v56, v66, v67
  v_max3_f32 v56, v56, v68, v69
  v_max3_f32 v56, v56, v70, v71
  v_max3_f32 v56, v56, v72, v73
  v_max3_f32 v56, v56, v74, v75
  v_max3_f32 v56, v56, v76, v77
  v_max3_f32 v56, v56, v78, v79
  v_mov_b32 v57, v56
  s_nop 1
  v_permlane32_swap_b32 v56, v57
  s_nop 1
  v_max_f32 v56, v56, v57
  v_mov_b32 v57, v56
  s_nop 1
  v_permlane16_swap_b32 v56, v57
  s_nop 1
  v_max_f32 v56, v56, v57
  v_max_f32 v56, 0, v56
  v_sub_f32 v16, v16, v56
  v_sub_f32 v17, v17, v56
  v_sub_f32 v18, v18, v56
  v_sub_f32 v19, v19, v56
  v_sub_f32 v64, v64, v56
  v_sub_f32 v65, v65, v56
  v_sub_f32 v66, v66, v56
  v_sub_f32 v67, v67, v56
  v_sub_f32 v68, v68, v56
  v_sub_f32 v69, v69, v56
  v_sub_f32 v70, v70, v56
  v_sub_f32 v71, v71, v56
  v_sub_f32 v72, v72, v56
  v_sub_f32 v73, v73, v56
  v_sub_f32 v74, v74, v56
  v_sub_f32 v75, v75, v56
  v_sub_f32 v76, v76, v56
  v_sub_f32 v77, v77, v56
  v_sub_f32 v78, v78, v56
  v_sub_f32 v79, v79, v56
  v_sub_f32 v58, 0, v56
  v_exp_f32 v58, v58
  s_nop 0
  v_mul_f32 v32, v32, v58
  v_mul_f32 v33, v33, v58
  v_mul_f32 v34, v34, v58
  v_mul_f32 v35, v35, v58
  v_accvgpr_read_b32 v57, a0
  v_mul_f32 v57, v57, v58
  v_accvgpr_write_b32 a0, v57
  v_accvgpr_read_b32 v57, a1
  v_mul_f32 v57, v57, v58
  v_accvgpr_write_b32 a1, v57
  v_accvgpr_read_b32 v57, a2
  v_mul_f32 v57, v57, v58
  v_accvgpr_write_b32 a2, v57
  v_accvgpr_read_b32 v57, a3
  v_mul_f32 v57, v57, v58
  v_accvgpr_write_b32 a3, v57
  v_accvgpr_read_b32 v57, a4
  v_mul_f32 v57, v57, v58
  v_accvgpr_write_b32 a4, v57
  v_accvgpr_read_b32 v57, a5
  v_mul_f32 v57, v57, v58
  v_accvgpr_write_b32 a5, v57
  v_accvgpr_read_b32 v57, a6
  v_mul_f32 v57, v57, v58
  v_accvgpr_write_b32 a6, v57
  v_accvgpr_read_b32 v57, a7
  v_mul_f32 v57, v57, v58
  v_accvgpr_write_b32 a7, v57
  v_accvgpr_read_b32 v57, a8
  v_mul_f32 v57, v57, v58
  v_accvgpr_write_b32 a8, v57
  v_accvgpr_read_b32 v57, a9
  v_mul_f32 v57, v57, v58
  v_accvgpr_write_b32 a9, v57
  v_accvgpr_read_b32 v57, a10
  v_mul_f32 v57, v57, v58
  v_accvgpr_write_b32 a10, v57
  v_accvgpr_read_b32 v57, a11
  v_mul_f32 v57, v57, v58
  v_accvgpr_write_b32 a11, v57
  v_accvgpr_read_b32 v57, a12
  v_mul_f32 v57, v57, v58
  v_accvgpr_write_b32 a12, v57
  v_accvgpr_read_b32 v57, a13
  v_mul_f32 v57, v57, v58
  v_accvgpr_write_b32 a13, v57
  v_accvgpr_read_b32 v57, a14
  v_mul_f32 v57, v57, v58
  v_accvgpr_write_b32 a14, v57
  v_accvgpr_read_b32 v57, a15
  v_mul_f32 v57, v57, v58
  v_accvgpr_write_b32 a15, v57
  v_accvgpr_read_b32 v57, a16
  v_mul_f32 v57, v57, v58
  v_accvgpr_write_b32 a16, v57
  v_accvgpr_read_b32 v57, a17
  v_mul_f32 v57, v57, v58
  v_accvgpr_write_b32 a17, v57
  v_accvgpr_read_b32 v57, a18
  v_mul_f32 v57, v57, v58
  v_accvgpr_write_b32 a18, v57
  v_accvgpr_read_b32 v57, a19
  v_mul_f32 v57, v57, v58
  v_accvgpr_write_b32 a19, v57
  v_accvgpr_read_b32 v57, a20
  v_mul_f32 v57, v57, v58
  v_accvgpr_write_b32 a20, v57
  v_accvgpr_read_b32 v57, a21
  v_mul_f32 v57, v57, v58
  v_accvgpr_write_b32 a21, v57
  v_accvgpr_read_b32 v57, a22
  v_mul_f32 v57, v57, v58
  v_accvgpr_write_b32 a22, v57
  v_accvgpr_read_b32 v57, a23
  v_mul_f32 v57, v57, v58
  v_accvgpr_write_b32 a23, v57
  v_accvgpr_read_b32 v57, a24
  v_mul_f32 v57, v57, v58
  v_accvgpr_write_b32 a24, v57
  v_accvgpr_read_b32 v57, a25
  v_mul_f32 v57, v57, v58
  v_accvgpr_write_b32 a25, v57
  v_accvgpr_read_b32 v57, a26
  v_mul_f32 v57, v57, v58
  v_accvgpr_write_b32 a26, v57
  v_accvgpr_read_b32 v57, a27
  v_mul_f32 v57, v57, v58
  v_accvgpr_write_b32 a27, v57
  v_accvgpr_read_b32 v57, a28
  v_mul_f32 v57, v57, v58
  v_accvgpr_write_b32 a28, v57
  v_accvgpr_read_b32 v57, a29
  v_mul_f32 v57, v57, v58
  v_accvgpr_write_b32 a29, v57
  v_accvgpr_read_b32 v57, a30
  v_mul_f32 v57, v57, v58
  v_accvgpr_write_b32 a30, v57
  v_accvgpr_read_b32 v57, a31
  v_mul_f32 v57, v57, v58
  v_accvgpr_write_b32 a31, v57
  v_max_f32 v56, v80, v81
  v_max3_f32 v56, v56, v82, v83
  v_max3_f32 v56, v56, v84, v85
  v_max3_f32 v56, v56, v86, v87
  v_max3_f32 v56, v56, v88, v89
  v_max3_f32 v56, v56, v90, v91
  v_max3_f32 v56, v56, v92, v93
  v_max3_f32 v56, v56, v94, v95
  v_mov_b32 v57, v56
  s_nop 1
  v_permlane32_swap_b32 v56, v57
  s_nop 1
  v_max_f32 v56, v56, v57
  v_mov_b32 v57, v56
  s_nop 1
  v_permlane16_swap_b32 v56, v57
  s_nop 1
  v_max_f32 v56, v56, v57
  v_max_f32 v56, 0, v56
  v_sub_f32 v20, v20, v56
  v_sub_f32 v21, v21, v56
  v_sub_f32 v22, v22, v56
  v_sub_f32 v23, v23, v56
  v_sub_f32 v80, v80, v56
  v_sub_f32 v81, v81, v56
  v_sub_f32 v82, v82, v56
  v_sub_f32 v83, v83, v56
  v_sub_f32 v84, v84, v56
  v_sub_f32 v85, v85, v56
  v_sub_f32 v86, v86, v56
  v_sub_f32 v87, v87, v56
  v_sub_f32 v88, v88, v56
  v_sub_f32 v89, v89, v56
  v_sub_f32 v90, v90, v56
  v_sub_f32 v91, v91, v56
  v_sub_f32 v92, v92, v56
  v_sub_f32 v93, v93, v56
  v_sub_f32 v94, v94, v56
  v_sub_f32 v95, v95, v56
  v_sub_f32 v58, 0, v56
  v_exp_f32 v58, v58
  s_nop 0
  v_mul_f32 v36, v36, v58
  v_mul_f32 v37, v37, v58
  v_mul_f32 v38, v38, v58
  v_mul_f32 v39, v39, v58
  v_accvgpr_read_b32 v57, a32
  v_mul_f32 v57, v57, v58
  v_accvgpr_write_b32 a32, v57
  v_accvgpr_read_b32 v57, a33
  v_mul_f32 v57, v57, v58
  v_accvgpr_write_b32 a33, v57
  v_accvgpr_read_b32 v57, a34
  v_mul_f32 v57, v57, v58
  v_accvgpr_write_b32 a34, v57
  v_accvgpr_read_b32 v57, a35
  v_mul_f32 v57, v57, v58
  v_accvgpr_write_b32 a35, v57
  v_accvgpr_read_b32 v57, a36
  v_mul_f32 v57, v57, v58
  v_accvgpr_write_b32 a36, v57
  v_accvgpr_read_b32 v57, a37
  v_mul_f32 v57, v57, v58
  v_accvgpr_write_b32 a37, v57
  v_accvgpr_read_b32 v57, a38
  v_mul_f32 v57, v57, v58
  v_accvgpr_write_b32 a38, v57
  v_accvgpr_read_b32 v57, a39
  v_mul_f32 v57, v57, v58
  v_accvgpr_write_b32 a39, v57
  v_accvgpr_read_b32 v57, a40
  v_mul_f32 v57, v57, v58
  v_accvgpr_write_b32 a40, v57
  v_accvgpr_read_b32 v57, a41
  v_mul_f32 v57, v57, v58
  v_accvgpr_write_b32 a41, v57
  v_accvgpr_read_b32 v57, a42
  v_mul_f32 v57, v57, v58
  v_accvgpr_write_b32 a42, v57
  v_accvgpr_read_b32 v57, a43
  v_mul_f32 v57, v57, v58
  v_accvgpr_write_b32 a43, v57
  v_accvgpr_read_b32 v57, a44
  v_mul_f32 v57, v57, v58
  v_accvgpr_write_b32 a44, v57
  v_accvgpr_read_b32 v57, a45
  v_mul_f32 v57, v57, v58
  v_accvgpr_write_b32 a45, v57
  v_accvgpr_read_b32 v57, a46
  v_mul_f32 v57, v57, v58
  v_accvgpr_write_b32 a46, v57
  v_accvgpr_read_b32 v57, a47
  v_mul_f32 v57, v57, v58
  v_accvgpr_write_b32 a47, v57
  v_accvgpr_read_b32 v57, a48
  v_mul_f32 v57, v57, v58
  v_accvgpr_write_b32 a48, v57
  v_accvgpr_read_b32 v57, a49
  v_mul_f32 v57, v57, v58
  v_accvgpr_write_b32 a49, v57
  v_accvgpr_read_b32 v57, a50
  v_mul_f32 v57, v57, v58
  v_accvgpr_write_b32 a50, v57
  v_accvgpr_read_b32 v57, a51
  v_mul_f32 v57, v57, v58
  v_accvgpr_write_b32 a51, v57
  v_accvgpr_read_b32 v57, a52
  v_mul_f32 v57, v57, v58
  v_accvgpr_write_b32 a52, v57
  v_accvgpr_read_b32 v57, a53
  v_mul_f32 v57, v57, v58
  v_accvgpr_write_b32 a53, v57
  v_accvgpr_read_b32 v57, a54
  v_mul_f32 v57, v57, v58
  v_accvgpr_write_b32 a54, v57
  v_accvgpr_read_b32 v57, a55
  v_mul_f32 v57, v57, v58
  v_accvgpr_write_b32 a55, v57
  v_accvgpr_read_b32 v57, a56
  v_mul_f32 v57, v57, v58
  v_accvgpr_write_b32 a56, v57
  v_accvgpr_read_b32 v57, a57
  v_mul_f32 v57, v57, v58
  v_accvgpr_write_b32 a57, v57
  v_accvgpr_read_b32 v57, a58
  v_mul_f32 v57, v57, v58
  v_accvgpr_write_b32 a58, v57
  v_accvgpr_read_b32 v57, a59
  v_mul_f32 v57, v57, v58
  v_accvgpr_write_b32 a59, v57
  v_accvgpr_read_b32 v57, a60
  v_mul_f32 v57, v57, v58
  v_accvgpr_write_b32 a60, v57
  v_accvgpr_read_b32 v57, a61
  v_mul_f32 v57, v57, v58
  v_accvgpr_write_b32 a61, v57
  v_accvgpr_read_b32 v57, a62
  v_mul_f32 v57, v57, v58
  v_accvgpr_write_b32 a62, v57
  v_accvgpr_read_b32 v57, a63
  v_mul_f32 v57, v57, v58
  v_accvgpr_write_b32 a63, v57
  v_max_f32 v56, v96, v97
  v_max3_f32 v56, v56, v98, v99
  v_max3_f32 v56, v56, v100, v101
  v_max3_f32 v56, v56, v102, v103
  v_max3_f32 v56, v56, v104, v105
  v_max3_f32 v56, v56, v106, v107
  v_max3_f32 v56, v56, v108, v109
  v_max3_f32 v56, v56, v110, v111
  v_mov_b32 v57, v56
  s_nop 1
  v_permlane32_swap_b32 v56, v57
  s_nop 1
  v_max_f32 v56, v56, v57
  v_mov_b32 v57, v56
  s_nop 1
  v_permlane16_swap_b32 v56, v57
  s_nop 1
  v_max_f32 v56, v56, v57
  v_max_f32 v56, 0, v56
  v_sub_f32 v24, v24, v56
  v_sub_f32 v25, v25, v56
  v_sub_f32 v26, v26, v56
  v_sub_f32 v27, v27, v56
  v_sub_f32 v96, v96, v56
  v_sub_f32 v97, v97, v56
  v_sub_f32 v98, v98, v56
  v_sub_f32 v99, v99, v56
  v_sub_f32 v100, v100, v56
  v_sub_f32 v101, v101, v56
  v_sub_f32 v102, v102, v56
  v_sub_f32 v103, v103, v56
  v_sub_f32 v104, v104, v56
  v_sub_f32 v105, v105, v56
  v_sub_f32 v106, v106, v56
  v_sub_f32 v107, v107, v56
  v_sub_f32 v108, v108, v56
  v_sub_f32 v109, v109, v56
  v_sub_f32 v110, v110, v56
  v_sub_f32 v111, v111, v56
  v_sub_f32 v58, 0, v56
  v_exp_f32 v58, v58
  s_nop 0
  v_mul_f32 v40, v40, v58
  v_mul_f32 v41, v41, v58
  v_mul_f32 v42, v42, v58
  v_mul_f32 v43, v43, v58
  v_accvgpr_read_b32 v57, a64
  v_mul_f32 v57, v57, v58
  v_accvgpr_write_b32 a64, v57
  v_accvgpr_read_b32 v57, a65
  v_mul_f32 v57, v57, v58
  v_accvgpr_write_b32 a65, v57
  v_accvgpr_read_b32 v57, a66
  v_mul_f32 v57, v57, v58
  v_accvgpr_write_b32 a66, v57
  v_accvgpr_read_b32 v57, a67
  v_mul_f32 v57, v57, v58
  v_accvgpr_write_b32 a67, v57
  v_accvgpr_read_b32 v57, a68
  v_mul_f32 v57, v57, v58
  v_accvgpr_write_b32 a68, v57
  v_accvgpr_read_b32 v57, a69
  v_mul_f32 v57, v57, v58
  v_accvgpr_write_b32 a69, v57
  v_accvgpr_read_b32 v57, a70
  v_mul_f32 v57, v57, v58
  v_accvgpr_write_b32 a70, v57
  v_accvgpr_read_b32 v57, a71
  v_mul_f32 v57, v57, v58
  v_accvgpr_write_b32 a71, v57
  v_accvgpr_read_b32 v57, a72
  v_mul_f32 v57, v57, v58
  v_accvgpr_write_b32 a72, v57
  v_accvgpr_read_b32 v57, a73
  v_mul_f32 v57, v57, v58
  v_accvgpr_write_b32 a73, v57
  v_accvgpr_read_b32 v57, a74
  v_mul_f32 v57, v57, v58
  v_accvgpr_write_b32 a74, v57
  v_accvgpr_read_b32 v57, a75
  v_mul_f32 v57, v57, v58
  v_accvgpr_write_b32 a75, v57
  v_accvgpr_read_b32 v57, a76
  v_mul_f32 v57, v57, v58
  v_accvgpr_write_b32 a76, v57
  v_accvgpr_read_b32 v57, a77
  v_mul_f32 v57, v57, v58
  v_accvgpr_write_b32 a77, v57
  v_accvgpr_read_b32 v57, a78
  v_mul_f32 v57, v57, v58
  v_accvgpr_write_b32 a78, v57
  v_accvgpr_read_b32 v57, a79
  v_mul_f32 v57, v57, v58
  v_accvgpr_write_b32 a79, v57
  v_accvgpr_read_b32 v57, a80
  v_mul_f32 v57, v57, v58
  v_accvgpr_write_b32 a80, v57
  v_accvgpr_read_b32 v57, a81
  v_mul_f32 v57, v57, v58
  v_accvgpr_write_b32 a81, v57
  v_accvgpr_read_b32 v57, a82
  v_mul_f32 v57, v57, v58
  v_accvgpr_write_b32 a82, v57
  v_accvgpr_read_b32 v57, a83
  v_mul_f32 v57, v57, v58
  v_accvgpr_write_b32 a83, v57
  v_accvgpr_read_b32 v57, a84
  v_mul_f32 v57, v57, v58
  v_accvgpr_write_b32 a84, v57
  v_accvgpr_read_b32 v57, a85
  v_mul_f32 v57, v57, v58
  v_accvgpr_write_b32 a85, v57
  v_accvgpr_read_b32 v57, a86
  v_mul_f32 v57, v57, v58
  v_accvgpr_write_b32 a86, v57
  v_accvgpr_read_b32 v57, a87
  v_mul_f32 v57, v57, v58
  v_accvgpr_write_b32 a87, v57
  v_accvgpr_read_b32 v57, a88
  v_mul_f32 v57, v57, v58
  v_accvgpr_write_b32 a88, v57
  v_accvgpr_read_b32 v57, a89
  v_mul_f32 v57, v57, v58
  v_accvgpr_write_b32 a89, v57
  v_accvgpr_read_b32 v57, a90
  v_mul_f32 v57, v57, v58
  v_accvgpr_write_b32 a90, v57
  v_accvgpr_read_b32 v57, a91
  v_mul_f32 v57, v57, v58
  v_accvgpr_write_b32 a91, v57
  v_accvgpr_read_b32 v57, a92
  v_mul_f32 v57, v57, v58
  v_accvgpr_write_b32 a92, v57
  v_accvgpr_read_b32 v57, a93
  v_mul_f32 v57, v57, v58
  v_accvgpr_write_b32 a93, v57
  v_accvgpr_read_b32 v57, a94
  v_mul_f32 v57, v57, v58
  v_accvgpr_write_b32 a94, v57
  v_accvgpr_read_b32 v57, a95
  v_mul_f32 v57, v57, v58
  v_accvgpr_write_b32 a95, v57
  v_max_f32 v56, v112, v113
  v_max3_f32 v56, v56, v114, v115
  v_max3_f32 v56, v56, v116, v117
  v_max3_f32 v56, v56, v118, v119
  v_max3_f32 v56, v56, v120, v121
  v_max3_f32 v56, v56, v122, v123
  v_max3_f32 v56, v56, v124, v125
  v_max3_f32 v56, v56, v126, v127
  v_mov_b32 v57, v56
  s_nop 1
  v_permlane32_swap_b32 v56, v57
  s_nop 1
  v_max_f32 v56, v56, v57
  v_mov_b32 v57, v56
  s_nop 1
  v_permlane16_swap_b32 v56, v57
  s_nop 1
  v_max_f32 v56, v56, v57
  v_max_f32 v56, 0, v56
  v_sub_f32 v28, v28, v56
  v_sub_f32 v29, v29, v56
  v_sub_f32 v30, v30, v56
  v_sub_f32 v31, v31, v56
  v_sub_f32 v112, v112, v56
  v_sub_f32 v113, v113, v56
  v_sub_f32 v114, v114, v56
  v_sub_f32 v115, v115, v56
  v_sub_f32 v116, v116, v56
  v_sub_f32 v117, v117, v56
  v_sub_f32 v118, v118, v56
  v_sub_f32 v119, v119, v56
  v_sub_f32 v120, v120, v56
  v_sub_f32 v121, v121, v56
  v_sub_f32 v122, v122, v56
  v_sub_f32 v123, v123, v56
  v_sub_f32 v124, v124, v56
  v_sub_f32 v125, v125, v56
  v_sub_f32 v126, v126, v56
  v_sub_f32 v127, v127, v56
  v_sub_f32 v58, 0, v56
  v_exp_f32 v58, v58
  s_nop 0
  v_mul_f32 v44, v44, v58
  v_mul_f32 v45, v45, v58
  v_mul_f32 v46, v46, v58
  v_mul_f32 v47, v47, v58
  v_accvgpr_read_b32 v57, a96
  v_mul_f32 v57, v57, v58
  v_accvgpr_write_b32 a96, v57
  v_accvgpr_read_b32 v57, a97
  v_mul_f32 v57, v57, v58
  v_accvgpr_write_b32 a97, v57
  v_accvgpr_read_b32 v57, a98
  v_mul_f32 v57, v57, v58
  v_accvgpr_write_b32 a98, v57
  v_accvgpr_read_b32 v57, a99
  v_mul_f32 v57, v57, v58
  v_accvgpr_write_b32 a99, v57
  v_accvgpr_read_b32 v57, a100
  v_mul_f32 v57, v57, v58
  v_accvgpr_write_b32 a100, v57
  v_accvgpr_read_b32 v57, a101
  v_mul_f32 v57, v57, v58
  v_accvgpr_write_b32 a101, v57
  v_accvgpr_read_b32 v57, a102
  v_mul_f32 v57, v57, v58
  v_accvgpr_write_b32 a102, v57
  v_accvgpr_read_b32 v57, a103
  v_mul_f32 v57, v57, v58
  v_accvgpr_write_b32 a103, v57
  v_accvgpr_read_b32 v57, a104
  v_mul_f32 v57, v57, v58
  v_accvgpr_write_b32 a104, v57
  v_accvgpr_read_b32 v57, a105
  v_mul_f32 v57, v57, v58
  v_accvgpr_write_b32 a105, v57
  v_accvgpr_read_b32 v57, a106
  v_mul_f32 v57, v57, v58
  v_accvgpr_write_b32 a106, v57
  v_accvgpr_read_b32 v57, a107
  v_mul_f32 v57, v57, v58
  v_accvgpr_write_b32 a107, v57
  v_accvgpr_read_b32 v57, a108
  v_mul_f32 v57, v57, v58
  v_accvgpr_write_b32 a108, v57
  v_accvgpr_read_b32 v57, a109
  v_mul_f32 v57, v57, v58
  v_accvgpr_write_b32 a109, v57
  v_accvgpr_read_b32 v57, a110
  v_mul_f32 v57, v57, v58
  v_accvgpr_write_b32 a110, v57
  v_accvgpr_read_b32 v57, a111
  v_mul_f32 v57, v57, v58
  v_accvgpr_write_b32 a111, v57
  v_accvgpr_read_b32 v57, a112
  v_mul_f32 v57, v57, v58
  v_accvgpr_write_b32 a112, v57
  v_accvgpr_read_b32 v57, a113
  v_mul_f32 v57, v57, v58
  v_accvgpr_write_b32 a113, v57
  v_accvgpr_read_b32 v57, a114
  v_mul_f32 v57, v57, v58
  v_accvgpr_write_b32 a114, v57
  v_accvgpr_read_b32 v57, a115
  v_mul_f32 v57, v57, v58
  v_accvgpr_write_b32 a115, v57
  v_accvgpr_read_b32 v57, a116
  v_mul_f32 v57, v57, v58
  v_accvgpr_write_b32 a116, v57
  v_accvgpr_read_b32 v57, a117
  v_mul_f32 v57, v57, v58
  v_accvgpr_write_b32 a117, v57
  v_accvgpr_read_b32 v57, a118
  v_mul_f32 v57, v57, v58
  v_accvgpr_write_b32 a118, v57
  v_accvgpr_read_b32 v57, a119
  v_mul_f32 v57, v57, v58
  v_accvgpr_write_b32 a119, v57
  v_accvgpr_read_b32 v57, a120
  v_mul_f32 v57, v57, v58
  v_accvgpr_write_b32 a120, v57
  v_accvgpr_read_b32 v57, a121
  v_mul_f32 v57, v57, v58
  v_accvgpr_write_b32 a121, v57
  v_accvgpr_read_b32 v57, a122
  v_mul_f32 v57, v57, v58
  v_accvgpr_write_b32 a122, v57
  v_accvgpr_read_b32 v57, a123
  v_mul_f32 v57, v57, v58
  v_accvgpr_write_b32 a123, v57
  v_accvgpr_read_b32 v57, a124
  v_mul_f32 v57, v57, v58
  v_accvgpr_write_b32 a124, v57
  v_accvgpr_read_b32 v57, a125
  v_mul_f32 v57, v57, v58
  v_accvgpr_write_b32 a125, v57
  v_accvgpr_read_b32 v57, a126
  v_mul_f32 v57, v57, v58
  v_accvgpr_write_b32 a126, v57
  v_accvgpr_read_b32 v57, a127
  v_mul_f32 v57, v57, v58
  v_accvgpr_write_b32 a127, v57
  v_exp_f32 v48, v64
  v_exp_f32 v49, v65
  v_exp_f32 v50, v66
  v_exp_f32 v51, v67
  v_cvt_pk_bf16_f32 v192, v48, v49
  v_exp_f32 v52, v68
  v_exp_f32 v53, v69
  v_cvt_pk_bf16_f32 v193, v50, v51
  v_pk_maximum3_f16 v11, v192, v192, v193
  v_exp_f32 v54, v70
  v_exp_f32 v55, v71
  v_cvt_pk_bf16_f32 v194, v52, v53
  v_exp_f32 v48, v80
  v_exp_f32 v49, v81
  v_cvt_pk_bf16_f32 v195, v54, v55
  v_pk_maximum3_f16 v11, v11, v194, v195
  v_exp_f32 v50, v82
  v_exp_f32 v51, v83
  v_cvt_pk_bf16_f32 v200, v48, v49
  v_exp_f32 v52, v84
  v_exp_f32 v53, v85
  v_cvt_pk_bf16_f32 v201, v50, v51
  v_pk_maximum3_f16 v11, v11, v200, v201
  v_exp_f32 v54, v86
  v_exp_f32 v55, v87
  v_cvt_pk_bf16_f32 v202, v52, v53
  v_exp_f32 v48, v96
  v_exp_f32 v49, v97
  v_cvt_pk_bf16_f32 v203, v54, v55
  v_pk_maximum3_f16 v11, v11, v202, v203
  v_exp_f32 v50, v98
  v_exp_f32 v51, v99
  v_cvt_pk_bf16_f32 v208, v48, v49
  v_exp_f32 v52, v100
  v_exp_f32 v53, v101
  v_cvt_pk_bf16_f32 v209, v50, v51
  v_pk_maximum3_f16 v11, v11, v208, v209
  v_exp_f32 v54, v102
  v_exp_f32 v55, v103
  v_cvt_pk_bf16_f32 v210, v52, v53
  v_exp_f32 v48, v112
  v_exp_f32 v49, v113
  v_cvt_pk_bf16_f32 v211, v54, v55
  v_pk_maximum3_f16 v11, v11, v210, v211
  v_exp_f32 v50, v114
  v_exp_f32 v51, v115
  v_cvt_pk_bf16_f32 v216, v48, v49
  v_exp_f32 v52, v116
  v_exp_f32 v53, v117
  v_cvt_pk_bf16_f32 v217, v50, v51
  v_pk_maximum3_f16 v11, v11, v216, v217
  v_exp_f32 v54, v118
  v_exp_f32 v55, v119
  v_cvt_pk_bf16_f32 v218, v52, v53
  v_exp_f32 v48, v72
  v_exp_f32 v49, v73
  v_cvt_pk_bf16_f32 v219, v54, v55
  v_pk_maximum3_f16 v11, v11, v218, v219
  v_exp_f32 v50, v74
  v_exp_f32 v51, v75
  v_cvt_pk_bf16_f32 v196, v48, v49
  v_exp_f32 v52, v76
  v_exp_f32 v53, v77
  v_cvt_pk_bf16_f32 v197, v50, v51
  v_pk_maximum3_f16 v11, v11, v196, v197
  v_exp_f32 v54, v78
  v_exp_f32 v55, v79
  v_cvt_pk_bf16_f32 v198, v52, v53
  v_exp_f32 v48, v88
  v_exp_f32 v49, v89
  v_cvt_pk_bf16_f32 v199, v54, v55
  v_pk_maximum3_f16 v11, v11, v198, v199
  v_exp_f32 v50, v90
  v_exp_f32 v51, v91
  v_cvt_pk_bf16_f32 v204, v48, v49
  v_exp_f32 v52, v92
  v_exp_f32 v53, v93
  v_cvt_pk_bf16_f32 v205, v50, v51
  v_pk_maximum3_f16 v11, v11, v204, v205
  v_exp_f32 v54, v94
  v_exp_f32 v55, v95
  v_cvt_pk_bf16_f32 v206, v52, v53
  v_exp_f32 v48, v104
  v_exp_f32 v49, v105
  v_cvt_pk_bf16_f32 v207, v54, v55
  v_pk_maximum3_f16 v11, v11, v206, v207
  v_exp_f32 v50, v106
  v_exp_f32 v51, v107
  v_cvt_pk_bf16_f32 v212, v48, v49
  v_exp_f32 v52, v108
  v_exp_f32 v53, v109
  v_cvt_pk_bf16_f32 v213, v50, v51
  v_pk_maximum3_f16 v11, v11, v212, v213
  v_exp_f32 v54, v110
  v_exp_f32 v55, v111
  v_cvt_pk_bf16_f32 v214, v52, v53
  v_exp_f32 v48, v120
  v_exp_f32 v49, v121
  v_cvt_pk_bf16_f32 v215, v54, v55
  v_pk_maximum3_f16 v11, v11, v214, v215
  v_exp_f32 v50, v122
  v_exp_f32 v51, v123
  v_cvt_pk_bf16_f32 v220, v48, v49
  v_exp_f32 v52, v124
  v_exp_f32 v53, v125
  v_cvt_pk_bf16_f32 v221, v50, v51
  v_pk_maximum3_f16 v11, v11, v220, v221
  v_exp_f32 v54, v126
  v_exp_f32 v55, v127
  v_cvt_pk_bf16_f32 v222, v52, v53
  s_nop 0
  v_cvt_pk_bf16_f32 v223, v54, v55
  v_pk_maximum3_f16 v11, v11, v222, v223
  s_nop 3
  s_branch K2_ret_G
F_end:
  s_endpgm
.section .rodata,"a"
.p2align 6
.amdhsa_kernel gated_mix__compressed_kv_cla__moe_arch_mod__prompt_kernel
  .amdhsa_next_free_vgpr 512
  .amdhsa_next_free_sgpr 80
  .amdhsa_accum_offset 256
  .amdhsa_group_segment_fixed_size 0
  .amdhsa_kernarg_size 120
  .amdhsa_user_sgpr_count 2
  .amdhsa_user_sgpr_kernarg_segment_ptr 1
  .amdhsa_system_sgpr_workgroup_id_x 1
  .amdhsa_float_denorm_mode_32 3
  .amdhsa_float_denorm_mode_16_64 3
.end_amdhsa_kernel
```
